```python
import torch

def _softmax(x, axis=-1):
    return torch.softmax(x, dim=axis)
def _gelu(x):
    return torch.nn.functional.gelu(x, approximate="tanh")
def _silu(x):
    return torch.nn.functional.silu(x)
def _sigmoid(x):
    return torch.sigmoid(x)
def _layernorm(x, axis=-1, eps=1e-5):
    m = x.mean(dim=axis, keepdim=True)
    v = x.var(dim=axis, keepdim=True, unbiased=False)
    return (x - m) / torch.sqrt(v + eps)
def _scatter_add(tgt, idx, src, axis=0):
    return tgt.clone().index_add_(axis, idx, src)
def _segment_sum(src, seg, n):
    out = torch.zeros((n,) + src.shape[1:], dtype=src.dtype)
    return out.index_add_(0, seg, src)
def _pad(x, pw):
    flat = tuple(v for pair in reversed(pw) for v in pair)
    return torch.nn.functional.pad(x, flat)

kernel_name = 'standalone__deformable_dcnv1__vision'

def setup_inputs():

    _w = (lambda a: (lambda t: t.to(torch.bfloat16) if t.is_floating_point() else t)(torch.as_tensor(a)))
    H = W = 224
    C = 96
    K = 5
    return {
        "x": _w((lambda *s: torch.randn(*s, dtype=torch.bfloat16) * 0.05)(1, H, W, C)),
        "offset": _w((lambda *s: torch.randn(*s, dtype=torch.bfloat16) * 0.05)(1, H, W, 2 * K * K) * 0.5),
        "w": _w((lambda *s: torch.randn(*s, dtype=torch.bfloat16) * 0.05)(K, K, C, C) * (K * K * C) ** -0.5),
    }

def reference(x, offset, w):
    B, H, W, C = x.shape
    K = 5
    hh = (lambda x, dt: x.to(dt))(torch.arange(H), x.dtype).reshape(1, H, 1)
    ww = (lambda x, dt: x.to(dt))(torch.arange(W), x.dtype).reshape(1, 1, W)
    xf = x.reshape(B, H * W, C)
    def _gather(yi, xi):
        lin = (yi * W + xi).reshape(B, H * W)
        idx = (lambda x, n, axis: torch.repeat_interleave(x, n, dim=axis))(lin[..., None], C, axis=-1)
        return (lambda x, i, axis: torch.take_along_dim(x, i, dim=axis))(xf, idx, axis=1).reshape(B, H, W, C)
    taps = []
    for ki in range(K):
        for kj in range(K):
            t = ki * K + kj
            dy = offset[..., 2 * t]
            dx = offset[..., 2 * t + 1]
            py = torch.clip(hh + (ki - 0.5 * (K - 1)) + dy, 0.0, H - 1.0)
            px = torch.clip(ww + (kj - 0.5 * (K - 1)) + dx, 0.0, W - 1.0)
            y0 = torch.floor(py)
            x0 = torch.floor(px)
            y1 = torch.clip(y0 + 1.0, 0.0, H - 1.0)
            x1 = torch.clip(x0 + 1.0, 0.0, W - 1.0)
            wy = (py - y0)[..., None]
            wx = (px - x0)[..., None]
            y0i = (lambda x, dt: x.to(dt))(y0, torch.int64)
            y1i = (lambda x, dt: x.to(dt))(y1, torch.int64)
            x0i = (lambda x, dt: x.to(dt))(x0, torch.int64)
            x1i = (lambda x, dt: x.to(dt))(x1, torch.int64)
            v = (1 - wy) * (1 - wx) * _gather(y0i, x0i) + (1 - wy) * wx * _gather(y0i, x1i) + wy * (1 - wx) * _gather(y1i, x0i) + wy * wx * _gather(y1i, x1i)
            taps.append(v)
    samp = torch.stack(taps, 3)
    return torch.einsum("bhwkc,kco->bhwo", samp, w.reshape(K * K, C, C))
```

```asm
; @launch grid=(256,1,1) block=(256,1,1) lds=163840
.amdgcn_target "amdgcn-amd-amdhsa--gfx950"
.macro za a,b,c
v_mfma_f32_16x16x32_bf16 a[\a:\a+3], v[\b:\b+3], v[\c:\c+3], a[\a:\a+3]
.endm
.macro zb a,b,c
ds_read_b64_tr_b16 v[\a:\a+1], v\b offset:\c
.endm
.macro zc a,b,c
v_cvt_pk_bf16_f32 v\a, v\b, v\c
.endm
.macro zd a,b
v_mov_b32 v\a, v\b
.endm
.macro ze a
s_waitcnt lgkmcnt(\a)
.endm
.macro zf a,b,c
v_mfma_f32_16x16x32_bf16 v[\a:\a+3], v[\b:\b+3], v[\c:\c+3], v[\a:\a+3]
.endm
.macro zg a,b
v_add_f32 v\a, v\a, v\b
.endm
.macro zh a,b,c
v_mfma_f32_16x16x32_bf16 v[\a:\a+3], v[\b:\b+3], v[\c:\c+3], 0
.endm
.macro zi a,b,c
ds_read_b64 v[\a:\a+1], v\b offset:\c
.endm
.macro zj a,b,c
v_mfma_f32_16x16x32_bf16 v[\a:\a+3], a[\b:\b+3], v[\c:\c+3], v[\a:\a+3]
.endm
.macro zk a,b,c
ds_write_b128 v\b, a[\a:\a+3] offset:\c
.endm
.macro zl a,b,c
ds_read_b128 v[\a:\a+3], v\b offset:\c
.endm
.macro zm a,b
v_add_f32 v\a, v\b, v\a
.endm
.macro zn a,b
buffer_load_dwordx4 v\a, s[12:15], s92 offen offset:\b lds
.endm
.macro zo a,b
ds_read_b64_tr_b16 v[\a:\a+1], v\b
.endm
.macro zp a,b,c
v_mfma_f32_16x16x32_bf16 a[\a:\a+3], v[\b:\b+3], v[\c:\c+3], 0
.endm
.macro zq a,b
v_cvt_pk_bf16_f32 v\a, v\a, v\b
.endm
.macro zr a,b
v_and_b32 v\a, 0xffff0000, v\b
.endm
.macro zs a
v_med3_f32 v\a, v\a, 0, s74
.endm
.macro zt a,b,c
v_mfma_f32_16x16x32_bf16 a[\a:\a+3], a[\b:\b+3], v[\c:\c+3], a[\a:\a+3]
.endm
.macro zu a
s_waitcnt vmcnt(\a)
.endm
.macro zv
s_nop 0
.endm
.macro zw a,b,c
v_mul_f32 v\a, v\b, v\c
.endm
.macro zx a,b
v_lshlrev_b32 v\a, 16, v\b
.endm
.macro zy a,b,c
v_fmac_f32 v\a, v\b, v\c
.endm
.macro zz a,b,c
v_mfma_f32_16x16x32_bf16 v[\a:\a+3], a[\b:\b+3], a[\c:\c+3], v[\a:\a+3]
.endm
.macro z0 a
buffer_load_dwordx4 v\a, s[12:15], s92 offen lds
.endm
.macro z1 a,b,c
ds_read_b64_tr_b16 a[\a:\a+1], v\b offset:\c
.endm
.macro z2 a
v_cvt_f32_i32 v\a, v\a
.endm
.macro z3 a,b
v_floor_f32 v\a, v\b
.endm
.macro z4 a,b,c
v_sub_f32 v\a, v\b, v\c
.endm
.macro z5 a,b
v_sub_f32 v\a, 1.0, v\b
.endm
.macro z6 a
s_add_u32 m0, s73, \a
.endm
.macro z7 a,b
v_mfma_f32_16x16x32_bf16 a[\a:\a+3], v[\b:\b+3], v[\a:\a+3], a[\a:\a+3]
.endm
.macro z8 a,b,c
v_alignbit_b32 v\a, v\b, v\b, v\c
.endm
.macro z9 a,b
v_accvgpr_read_b32 v\a, a\b
.endm
.macro zaa a,b,c
v_add_u32_dpp v\a, v\b, v\c quad_perm:[0,0,0,0] row_mask:0xf bank_mask:0xf
.endm
.macro zab a,b,c
v_and_b32_dpp v\a, v\b, v\c quad_perm:[0,0,0,0] row_mask:0xf bank_mask:0xf
.endm
.macro zac a,b,c
v_add_u32_dpp v\a, v\b, v\c quad_perm:[1,1,1,1] row_mask:0xf bank_mask:0xf
.endm
.macro zad a,b,c
v_and_b32_dpp v\a, v\b, v\c quad_perm:[1,1,1,1] row_mask:0xf bank_mask:0xf
.endm
.macro zae a
buffer_load_dwordx4 v\a, s[4:7], s97 offen lds
.endm
.macro zaf a,b,c
v_mfma_f32_16x16x32_bf16 a[\a:\a+3], a[\b:\b+3], a[\c:\c+3], a[\a:\a+3]
.endm
.macro zag a
s_add_u32 s92, s71, \a
.endm
.macro zah a,b,c
v_cndmask_b32_e64 v\a, v\b, v\c, s[68:69]
.endm
.macro zai a,b
v_cndmask_b32_e64 v\a, v\a, v\b, s[68:69]
.endm
.macro zaj a,b,c
v_add_u32_dpp v\a, v\b, v\c quad_perm:[2,2,2,2] row_mask:0xf bank_mask:0xf
.endm
.macro zak a,b,c
v_and_b32_dpp v\a, v\b, v\c quad_perm:[2,2,2,2] row_mask:0xf bank_mask:0xf
.endm
.macro zal a,b
v_lshl_add_u32 v\a, v\b, 4, s95
.endm
.macro zam
s_nop 1
.endm
.macro zan a
s_add_u32 m0, s42, \a
.endm
.macro zao
s_mov_b32 s96, s65
.endm
.macro zap a
s_add_u32 s91, s66, \a
.endm
.macro zaq a,b,c
v_add_u32_dpp v\a, v\b, v\c quad_perm:[3,3,3,3] row_mask:0xf bank_mask:0xf
.endm
.macro zar a,b,c
v_and_b32_dpp v\a, v\b, v\c quad_perm:[3,3,3,3] row_mask:0xf bank_mask:0xf
.endm
.macro zas a
v_cndmask_b32 v\a, 0, v\a, vcc
.endm
.macro zat a,b,c
ds_write_b128 v\b, v[\a:\a+3] offset:\c
.endm
.macro zau a,b,c
v_lshl_add_u32 v\a, v\b, 4, v\c
.endm
.macro zav a,b
v_cmp_ne_u32_e64 s[60:61], v\a, v\b
.endm
.macro zaw a
v_lshlrev_b32 v\a, 16, v\a
.endm
.macro zax a
v_cmp_neq_f32 vcc, 0, v\a
.endm
.macro zay a,b,c
v_med3_f32 v\a, v\b, v\c, s76
.endm
.macro zaz a,b
v_mul_f32 v\a, v\a, v\b
.endm
.macro za0 a,b
v_mul_f32 v\a, v\b, v\a
.endm
.macro za1 a,b
v_cmp_neq_f32_e64 s[62:63], v\a, v\b
.endm
.macro za2 a,b
v_fmamk_f32 v\a, v\a, 0x43500000, v\b
.endm
.macro za3 a,b
v_cndmask_b32 v\a, v\b, v\a, vcc
.endm
.macro za4 a,b
v_fmamk_f32 v\a, v\b, 0x45900000, v\a
.endm
.macro za5 a,b
v_cndmask_b32_e64 v\a, v\b, 13, vcc
.endm
.macro za6 a,b
v_cvt_u32_f32 v\a, v\b
.endm
.macro za7 a,b
ds_read_b128 v[\a:\a+3], v\b
.endm
.macro za8 a,b
v_mov_b32_dpp v\a, v\b quad_perm:[0,0,0,0] row_mask:0xf bank_mask:0xf
.endm
.macro za9 a,b
v_mov_b32_dpp v\a, v\b quad_perm:[1,1,1,1] row_mask:0xf bank_mask:0xf
.endm
.macro zba a,b,c
v_mfma_f32_16x16x32_bf16 v[\a:\a+3], v[\b:\b+3], a[\c:\c+3], v[\a:\a+3]
.endm
.macro zbb a
v_add_u32 v\a, s87, v\a
.endm
.macro zbc a
s_add_u32 s95, s73, \a
.endm
.macro zbd
s_cselect_b32 s97, 0xd800, 0
.endm
.macro zbe
s_sub_u32 s95, s95, s97
.endm
.macro zbf a,b
buffer_store_dwordx4 v[\a:\a+3], v\b, s[16:19], s95 offen sc1
.endm
.macro zbg a,b,c
v_med3_f32 v\a, v\b, v\c, s75
.endm
.macro zbh a
s_add_u32 s95, s93, \a
.endm
.macro zbi a,b,c
buffer_load_dwordx2 v[\a:\a+1], v\b, s[4:7], 0 offen offset:\c
.endm
.macro zbj a
v_mov_b32 v\a, 0
.endm
.macro zbk a,b
v_lshl_add_u32 v\a, v\b, 4, v\a
.endm
.macro zbl
s_nop 3
.endm
.macro zbm a,b
v_mov_b32_dpp v\a, v\b quad_perm:[2,2,2,2] row_mask:0xf bank_mask:0xf
.endm
.macro zbn
s_mov_b32 s64, s67
.endm
.macro zbo
s_mov_b32 s65, s68
.endm
.macro zbp
s_mov_b32 s66, s69
.endm
.macro zbq a,b
v_add_u32 v\a, s70, v\b
.endm
.macro zbr a
s_sub_u32 s87, s73, \a
.endm
.macro zbs a,b
v_add_u32 v\a, s65, v\b
.endm
.macro zbt a
s_mul_i32 s97, s97, \a
.endm
.macro zbu a,b
v_mov_b32_dpp v\a, v\b quad_perm:[3,3,3,3] row_mask:0xf bank_mask:0xf
.endm
.macro zbv a,b
v_mul_u32_u24 v\a, 48, v\b
.endm
.macro zbw
s_cmp_ge_u32 s20, 2
.endm
.macro zbx a,b,c
v_mfma_f32_16x16x32_bf16 v[\a:\a+3], a[\b:\b+3], v[\c:\c+3], 0
.endm
.macro zby
s_cmp_ge_u32 s20, 1
.endm
.macro zbz a,b
v_lshl_add_u32 v\a, v\b, 4, s73
.endm
.macro zb0
s_nop 2
.endm
.macro zb1 a,b,c
ds_read_b128 a[\a:\a+3], v\b offset:\c
.endm
.macro zb2 a
v_mbcnt_lo_u32_b32 v\a, -1, 0
.endm
.macro zb3 a
v_mbcnt_hi_u32_b32 v\a, -1, v\a
.endm
.macro zb4 a,b,c
v_mfma_f32_16x16x32_bf16 a[\a:\a+3], v[\b:\b+3], a[\c:\c+3], a[\a:\a+3]
.endm
.macro zb5
s_lshl_b32 s95, s20, 11
.endm
.macro zb6 a
s_add_u32 s95, s95, \a
.endm
.macro zb7 a
v_lshrrev_b32 v\a, 4, v\a
.endm
.macro zb8
s_lshl_b32 s95, s20, 6
.endm
.macro zb9 a
v_add_u32 v\a, s95, v\a
.endm
.macro zca a,b
v_cmp_neq_f32_e64 s[54:55], v\a, v\b
.endm
.macro zcb a
v_cmp_neq_f32_e64 s[46:47], 0, v\a
.endm
.macro zcc
s_or_b64 s[54:55], s[54:55], s[62:63]
.endm
.macro zcd
s_or_b64 s[46:47], s[46:47], s[54:55]
.endm
.macro zce
s_mov_b64 s[38:39], s[60:61]
.endm
.macro zcf
s_and_b64 s[50:51], s[36:37], s[26:27]
.endm
.macro zcg
s_add_u32 m0, s73, 0
.endm
.macro zch a,b,c
v_cndmask_b32_e64 v\a, v\b, v\c, s[56:57]
.endm
.macro zci a,b
v_add3_u32 v\a, v\b, s64, 4
.endm
.macro zcj a,b
v_add_u32 v\a, s68, v\b
.endm
.macro zck a
v_mul_u32_u24 v\a, 0xc0, v\a
.endm
.macro zcl a,b
v_add3_u32 v\a, v\b, s64, 8
.endm
.macro zcm a,b
v_cmp_neq_f32_e64 s[56:57], v\a, v\b
.endm
.macro zcn a
v_cmp_neq_f32_e64 s[48:49], 0, v\a
.endm
.macro zco
s_or_b64 s[56:57], s[56:57], s[62:63]
.endm
.macro zcp
s_or_b64 s[48:49], s[48:49], s[56:57]
.endm
.macro zcq
s_mov_b64 s[40:41], s[60:61]
.endm
.macro zcr
s_nop 4
.endm
.macro zcs a,b,c
v_cndmask_b32 v\a, v\b, v\c, vcc
.endm
.macro zct
s_and_b64 s[50:51], s[44:45], s[26:27]
.endm
.macro zcu
s_add_u32 s92, s71, 0
.endm
.macro zcv
s_max_i32 s97, s97, 0
.endm
.macro zcw a
s_min_i32 s97, s97, \a
.endm
.macro zcx
s_add_u32 m0, s42, 0
.endm
.macro zcy a
s_mov_b64 exec, \a
.endm
.macro zcz
s_mov_b64 exec, -1
.endm
.macro zc0
s_and_b64 s[50:51], s[38:39], s[28:29]
.endm
.macro zc1
s_and_b64 s[50:51], s[40:41], s[28:29]
.endm
.macro zc2
s_and_b64 s[50:51], s[46:47], s[28:29]
.endm
.macro zc3 a,b,c
v_and_b32 v\a, v\b, v\c
.endm
.macro zc4 a
s_add_u32 s92, s65, \a
.endm
.macro zc5
s_and_b64 s[50:51], s[38:39], s[26:27]
.endm
.macro zc6 a,b,c
buffer_load_dwordx2 v[\a:\a+1], v\b, s[8:11], s95 offen offset:\c
.endm
.macro zc7 a
s_add_u32 s92, s58, \a
.endm
.macro zc8 a
s_add_u32 s95, s66, \a
.endm
.macro zc9 a,b
v_mov_b32 v\a, \b
.endm
.macro zda
s_and_b64 s[50:51], s[36:37], s[28:29]
.endm
.macro zdb
s_and_b64 s[50:51], s[36:37], s[30:31]
.endm
.macro zdc
s_and_b64 s[50:51], s[36:37], s[32:33]
.endm
.macro zdd a
s_add_u32 s42, s35, \a
.endm
.macro zde
s_cmp_eq_u32 s20, 3
.endm
.macro zdf a,b
v_cmp_neq_f32_e64 s[52:53], v\a, v\b
.endm
.macro zdg a
v_cmp_neq_f32_e64 s[44:45], 0, v\a
.endm
.macro zdh
s_or_b64 s[52:53], s[52:53], s[62:63]
.endm
.macro zdi
s_or_b64 s[44:45], s[44:45], s[52:53]
.endm
.macro zdj
s_mov_b64 s[36:37], s[60:61]
.endm
.macro zdk a,b
ds_read_b64 v[\a:\a+1], v\b
.endm
.macro zdl a,b
ds_write_b128 v\b, v[\a:\a+3]
.endm
.macro zdm a,b
v_mfma_f32_16x16x32_bf16 a[\a:\a+3], v[\a:\a+3], v[\b:\b+3], a[\a:\a+3]
.endm
.macro zdn a
s_min_u32 s97, s97, \a
.endm
.macro zdo a,b,c
v_mfma_f32_16x16x32_bf16 a[\a:\a+3], a[\b:\b+3], v[\c:\c+3], 0
.endm
.macro zdp a,b
v_mfma_f32_16x16x32_bf16 v[\a:\a+3], a[\b:\b+3], v[\b:\b+3], v[\a:\a+3]
.endm
.macro zdq a
v_and_b32 v\a, 0x7fff7fff, v\a
.endm
.macro zdr a,b
v_pk_max_u16 v\a, v\a, v\b
.endm
.macro zds a,b
v_permlane16_swap_b32 v\a, v\b
.endm
.macro zdt
s_and_b64 s[50:51], s[46:47], s[26:27]
.endm
.macro zdu
s_mov_b32 s96, 0
.endm
.macro zdv a
s_add_u32 m0, s35, \a
.endm
.macro zdw a
v_subrev_u32 v\a, s87, v\a
.endm
.macro zdx a,b
v_add3_u32 v\a, v\b, s67, 0
.endm
.macro zdy
s_and_b64 s[50:51], s[40:41], s[26:27]
.endm
.macro zdz
s_and_b64 s[50:51], s[52:53], s[26:27]
.endm
.macro zd0 a,b
v_sub_u32 v\a, v\a, v\b
.endm
.macro zd1 a,b
v_add_f32 v\a, 0x40c00000, v\b
.endm
.macro zd2 a,b
v_med3_f32 v\a, v\a, v\b, s75
.endm
.macro zd3 a,b,c,d
v_med3_f32 v\a, v\b, v\c, v\d
.endm
.macro zd4
s_and_b64 s[50:51], s[38:39], s[30:31]
.endm
.macro zd5
s_and_b64 s[50:51], s[38:39], s[32:33]
.endm
.macro zd6
s_and_b64 s[50:51], s[44:45], s[28:29]
.endm
.macro zd7
s_and_b64 s[50:51], s[44:45], s[30:31]
.endm
.macro zd8
s_and_b64 s[50:51], s[44:45], s[32:33]
.endm
.macro zd9 a
v_lshrrev_b32 v\a, 16, v\a
.endm
.macro zea a
v_add_u32 v\a, s82, v\a
.endm
.macro zeb a
v_min_i32 v\a, 0xdf, v\a
.endm
.macro zec a
s_add_u32 s91, s79, \a
.endm
.macro zed
s_mul_i32 s83, s25, 52
.endm
.macro zee a
s_mul_i32 s71, s25, \a
.endm
.macro zef
s_lshr_b32 s83, s83, 8
.endm
.macro zeg
s_mul_i32 s84, s83, 5
.endm
.macro zeh a
s_mul_i32 s70, s83, \a
.endm
.macro zei
s_sub_u32 s34, s25, s84
.endm
.macro zej a
s_mul_i32 s84, s34, \a
.endm
.macro zek a
s_add_u32 s70, s70, \a
.endm
.macro zel
s_add_u32 s70, s70, s84
.endm
.macro zem
s_sub_u32 s67, s83, 2
.endm
.macro zen
s_sub_u32 s68, s34, 2
.endm
.macro zeo
s_lshl2_add_u32 s69, s25, s77
.endm
.macro zep a,b
v_mul_u32_u24 v\a, 0x13b2, v\b
.endm
.macro zeq a,b
v_mul_u32_u24 v\a, 13, v\b
.endm
.macro zer a
v_cmp_eq_u32 vcc, 12, v\a
.endm
.macro zes a
v_max_i32 v\a, 0, v\a
.endm
.macro zet
s_add_u32 s90, s67, 0
.endm
.macro zeu
s_add_u32 s91, s69, 0
.endm
.macro zev
s_mov_b32 s96, s68
.endm
.macro zew a,b,c,d
v_add3_u32 v\a, v\b, v\c, v\d
.endm
.macro zex a,b
v_mfma_f32_16x16x32_bf16 a[\a:\a+3], v[\b:\b+3], v[\a:\a+3], 0
.endm
.macro zey
s_and_b64 s[50:51], s[46:47], s[30:31]
.endm
.macro zez
s_and_b64 s[50:51], s[46:47], s[32:33]
.endm
.macro ze0
s_and_b64 s[50:51], s[54:55], s[28:29]
.endm
.macro ze1
s_and_b64 s[50:51], s[54:55], s[26:27]
.endm
.macro ze2 a,b
v_add_u32 v\a, 0, v\b
.endm
.macro ze3
s_add_u32 s25, s25, 1
.endm
.macro ze4
s_cselect_b64 s[50:51], 0, s[38:39]
.endm
.macro ze5
s_add_u32 s95, s66, 0
.endm
.macro ze6
s_and_b64 s[50:51], s[40:41], s[30:31]
.endm
.macro ze7
s_and_b64 s[50:51], s[48:49], s[28:29]
.endm
.macro ze8
s_and_b64 s[50:51], s[52:53], s[28:29]
.endm
.macro ze9
s_add_u32 s90, s64, 1
.endm
.macro zfa
s_and_b64 s[50:51], s[52:53], s[30:31]
.endm
.macro zfb
s_add_u32 s90, s64, 2
.endm
.macro zfc
s_and_b64 s[50:51], s[52:53], s[32:33]
.endm
.macro zfd
s_add_u32 s90, s64, 3
.endm
.macro zfe
s_add_u32 s90, s64, 4
.endm
.macro zff
s_and_b64 s[50:51], s[56:57], s[28:29]
.endm
.macro zfg
s_add_u32 s90, s78, 1
.endm
.macro zfh a,b
buffer_load_dwordx2 v[\a:\a+1], v\b, s[4:7], 0 offen
.endm
.macro zfi a,b
buffer_load_dwordx4 v[\a:\a+3], v\b, s[8:11], s95 offen
.endm
.macro zfj a
s_add_u32 s92, s64, \a
.endm
.macro zfk a,b
v_and_b32 v\a, 1, v\b
.endm
.macro zfl a,b
v_add3_u32 v\a, v\b, s67, 4
.endm
.macro zfm
s_cselect_b64 s[50:51], 0, s[36:37]
.endm
.macro zfn
s_add_u32 s95, s93, 0
.endm
.macro zfo a
s_mov_b32 s68, \a
.endm
.macro zfp a,b
v_mfma_f32_16x16x32_bf16 v[\a:\a+3], a[\a:\a+3], v[\b:\b+3], v[\a:\a+3]
.endm
.macro zfq a,b
buffer_store_dwordx2 v[\a:\a+1], v\b, s[16:19], s95 offen sc1
.endm
.macro zfr a,b
ds_write_b128 v\b, a[\a:\a+3]
.endm
.macro zfs
s_add_u32 s90, s64, 5
.endm
.macro zft
s_and_b64 s[50:51], s[54:55], s[30:31]
.endm
.macro zfu
s_add_u32 s90, s64, 6
.endm
.macro zfv
s_and_b64 s[50:51], s[54:55], s[32:33]
.endm
.macro zfw
s_add_u32 s90, s64, 7
.endm
.macro zfx a,b
v_bfe_u32 v\a, s82, v\b, 1
.endm
.macro zfy a,b
v_mad_i32_i24 v\a, v\b, s84, v\a
.endm
.macro zfz
s_cmp_eq_u32 s20, 1
.endm
.macro zf0
s_cmp_eq_u32 s20, 2
.endm
.macro zf1
s_add_u32 s97, s85, 8
.endm
.macro zf2 a,b
buffer_load_dword v\a, v\b, s[8:11], s79 offen
.endm
.macro zf3 a,b
v_add3_u32 v\a, v\b, s78, 0
.endm
.macro zf4 a,b
v_add_u32 v\a, s94, v\b
.endm
.macro zf5
s_add_u32 s80, s80, 1
.endm
.macro zf6 a
s_mov_b32 s69, \a
.endm
.macro zf7
s_and_b64 s[50:51], s[48:49], s[26:27]
.endm
.macro zf8
s_and_b64 s[50:51], s[56:57], s[26:27]
.endm
.macro zf9 a,b
v_lshlrev_b32 v\a, 4, v\b
.endm
.macro zga a,b
v_mfma_f32_16x16x32_bf16 a[\a:\a+3], a[\b:\b+3], v[\b:\b+3], a[\a:\a+3]
.endm
.macro zgb
s_setpc_b64 s[88:89]
.endm
.macro zgc a,b
v_lshrrev_b32 v\a, 1, v\b
.endm
.macro zgd a,b
v_and_b32 v\a, 3, v\b
.endm
.macro zge a,b
ds_read_b64_tr_b16 a[\a:\a+1], v\b
.endm
.macro zgf a
v_cvt_u32_f32 v\a, v\a
.endm
.macro zgg a,b
v_add_u32 v\a, 1, v\b
.endm
.macro zgh a
v_min_u32 v\a, 0xdf, v\a
.endm
.macro zgi a
v_mul_u32_u24 v\a, 0xa800, v\a
.endm
.macro zgj
s_add_u32 s97, s85, 12
.endm
.macro zgk
s_cselect_b32 s97, 0x40000000, s97
.endm
.macro zgl
s_add_u32 s90, s64, 8
.endm
.macro zgm
s_and_b64 s[50:51], s[50:51], s[28:29]
.endm
.macro zgn a,b
v_lshl_add_u32 v\a, v\b, 5, v\a
.endm
.macro zgo
s_nop 7
.endm
.macro zgp a,b
v_lshlrev_b32 v\a, 3, v\b
.endm
.macro zgq a,b,c
v_xor_b32 v\a, v\b, v\c
.endm
.macro zgr a,b
v_lshrrev_b32 v\a, 2, v\b
.endm
.macro zgs
s_and_b64 s[50:51], s[50:51], s[26:27]
.endm
.macro zgt a
s_add_u32 m0, s65, \a
.endm
.macro zgu a,b,c
v_add_u32 v\a, v\b, v\c
.endm
.macro zgv
s_lshr_b32 s82, s82, 1
.endm
.macro zgw a,b
v_add3_u32 v\a, v\b, s64, 0
.endm
.macro zgx
s_cmp_lt_u32 s80, 4
.endm
.macro zgy
s_and_b64 s[50:51], s[48:49], s[30:31]
.endm
.macro zgz
s_and_b64 s[50:51], s[56:57], s[30:31]
.endm
.macro zg0 a
v_alignbit_b32 v\a, v\a, v\a, 16
.endm
.macro zg1 a,b
v_xor_b32 v\a, v\a, v\b
.endm
.macro zg2 a,b
v_lshl_add_u32 v\a, v\b, 2, v\a
.endm
.macro zg3 a,b
v_lshlrev_b32 v\a, 2, v\b
.endm
.macro zg4 a,b
v_mfma_f32_16x16x32_bf16 v[\a:\a+3], a[\a:\a+3], a[\b:\b+3], v[\a:\a+3]
.endm
.macro zg5 a,b,c
buffer_store_dwordx4 v[\a:\a+3], v\b, s[16:19], s95 offen offset:\c sc1
.endm
.macro zg6 a,b,c
buffer_load_dwordx4 v[\a:\a+3], v\b, s[4:7], 0 offen offset:\c
.endm
.macro zg7
s_add_u32 s90, s64, 9
.endm
.macro zg8
s_and_b64 s[50:51], s[50:51], s[30:31]
.endm
.macro zg9
s_and_b64 s[50:51], s[50:51], s[32:33]
.endm
.macro zha a
s_mov_b32 s14, \a
.endm
.macro zhb a,b
v_and_b32 v\a, 15, v\b
.endm
.macro zhc a,b
v_lshrrev_b32 v\a, 4, v\b
.endm
.macro zhd a,b
v_bfe_u32 v\a, v\b, 2, 2
.endm
.macro zhe a,b
v_add_u32 v\a, v\a, v\b
.endm
.macro zhf a,b
v_and_b32 v\a, 63, v\b
.endm
.macro zhg a
s_mov_b32 s6, \a
.endm
.macro zhh a
s_mov_b32 s7, \a
.endm
.macro zhi a
s_mov_b32 s11, \a
.endm
.macro zhj a
s_mov_b32 s15, \a
.endm
.macro zhk a
s_mov_b32 s19, \a
.endm
.macro zhl a
s_and_b32 s5, s5, \a
.endm
.macro zhm a
s_sub_u32 s12, s12, \a
.endm
.macro zhn
s_subb_u32 s13, s13, 0
.endm
.macro zho a
s_and_b32 s13, s13, \a
.endm
.macro zhp a
s_and_b32 s9, s9, \a
.endm
.macro zhq a
s_and_b32 s17, s17, \a
.endm
.macro zhr a
s_mul_i32 s73, s20, \a
.endm
.macro zhs a,b
v_add_u32 v\a, 64, v\b
.endm
.macro zht a,b
v_add_u32 v\a, 0x80, v\b
.endm
.macro zhu a
v_and_b32 v\a, 16, v\a
.endm
.macro zhv a
v_lshlrev_b32 v\a, 1, v\a
.endm
.macro zhw
s_sub_u32 s82, s22, 3
.endm
.macro zhx a
s_mov_b32 s92, \a
.endm
.macro zhy
s_mov_b32 s81, 0
.endm
.macro zhz a
s_mul_i32 s35, s20, \a
.endm
.macro zh0 a,b
v_xor_b32 v\a, 1, v\b
.endm
.macro zh1 a
s_mov_b32 s74, \a
.endm
.macro zh2 a,b,c
v_lshl_add_u32 v\a, v\b, 3, v\c
.endm
.macro zh3 a,b
v_xor_b32 v\a, 8, v\b
.endm
.macro zh4 a,b
v_mul_u32_u24 v\a, 0x5780, v\b
.endm
.macro zh5 a,b
v_mul_u32_u24 v\a, 0x64, v\b
.endm
.macro zh6 a,b
v_mul_u32_u24 v\a, 25, v\b
.endm
.macro zh7 a,b
buffer_load_dword v\a, v\b, s[8:11], s91 offen
.endm
.macro zh8
s_add_u32 s90, s90, s21
.endm
.macro zh9
s_add_u32 s96, s96, s22
.endm
.macro zia a
v_cvt_f32_i32 v\a, s90
.endm
.macro zib a
v_add_u32 v\a, s96, v\a
.endm
.macro zic
s_add_u32 s90, s78, 2
.endm
.macro zid
s_cmp_ge_u32 s20, 3
.endm
.text
.globl standalone__deformable_dcnv1__vision_kernel
.p2align 8
.type standalone__deformable_dcnv1__vision_kernel,@function
standalone__deformable_dcnv1__vision_kernel:
s_load_dwordx2 s[4:5], s[0:1], 0
s_load_dwordx2 s[8:9], s[0:1], 8
s_load_dwordx2 s[12:13], s[0:1], 16
s_load_dwordx2 s[16:17], s[0:1], 24
s_getpc_b64 s[88:89]
Lpc0:
s_cmp_ge_u32 s2, 256
s_cbranch_scc1 Lexit
s_mov_b32 s36, s88
s_and_b32 s37, s89, 0xffff
s_mov_b32 s38, Lend-Lpc0
s_mov_b32 s39, 0x20000
s_lshr_b32 s83, s2, 3
v_lshlrev_b32 v3, 6, v0
s_lshl_b32 s3, s83, 14
v_lshrrev_b32 v1, 6, v0
s_and_b32 s81, s2, 7
s_lshl_b32 s81, s81, 2
s_lshr_b32 s81, 102048823, s81
s_and_b32 s81, s81, 7
s_lshl_b32 s81, s81, 5
s_add_u32 s81, s81, s83
s_add_u32 s81, s81, 4
s_and_b32 s81, s81, 255
buffer_load_dword v251, v3, s[36:39], s3 offen
v_readfirstlane_b32 s20, v1
s_cmp_lt_u32 s81, 124
s_cbranch_scc1 Lc0
s_cmp_ge_u32 s81, 256
s_cbranch_scc1 Lexit
s_sub_u32 s82, s81, 0x7c
s_mul_i32 s83, s82, 0x1556
s_lshr_b32 s83, s83, 16
s_mul_i32 s84, s83, 12
s_sub_u32 s82, s82, s84
s_add_u32 s83, s83, 3
s_lshl_b32 s22, s83, 4
s_mov_b32 s21, 35
s_mov_b32 s85, 16
s_mov_b32 s84, Lln16_start-Lpc0
Ldec:
s_add_u32 s88, s88, s84
s_addc_u32 s89, s89, 0
s_mul_i32 s83, s82, s85
s_add_u32 s21, s21, s83
s_add_u32 s83, s21, s85
s_min_u32 s83, s83, 0xe0
s_mul_i32 s10, s83, 0x5780
s_mul_i32 s18, s83, 0xa800
s_cmp_eq_u32 s84, Lln16_start-Lpc0
s_cbranch_scc1 Lln16_start
zgb
Lln16_start:
zhf 64,0
s_lshl_b32 s35, s20, 10
s_add_u32 s35, s35, 0x12000
s_lshl_b32 s83, s20, 6
s_sub_u32 s82, s22, 2
s_add_u32 s97, s21, 1
zdn 0xdf
zbt 0xa800
zdv 0x3000
v_add_u32 v69, s83, v64
v_mul_u32_u24 v70, 0x1556, v69
zd9 70
v_mul_u32_u24 v6, 12, v70
zd0 69,6
v_cmp_le_u32 vcc, 20, v70
zgc 71,70
v_and_b32 v71, 2, v71
zg1 69,71
zea 70
zeb 70
zck 70
zbk 70,69
zc9 69,0x40000000
zcs 6,70,69
zhg 0x930000
zhh 0x20000
zhi 0x20000
zha 0x71000
zhj 0x20000
zhk 0x20000
ze 0
zhl 0xffff
zae 6
s_add_u32 s97, s21, 2
zdn 0xdf
zbt 0xa800
zdv 0x4000
zv
zae 6
s_add_u32 s97, s21, 3
zdn 0xdf
zbt 0xa800
zdv 0x5000
zv
zae 6
s_add_u32 s97, s21, 4
zdn 0xdf
zbt 0xa800
zdv 0x6000
zv
zae 6
s_add_u32 s97, s21, 5
zdn 0xdf
zbt 0xa800
zdv 0x7000
zv
zae 6
s_add_u32 s97, s21, 6
zdn 0xdf
zbt 0xa800
zdv 0x8000
zv
zae 6
zhm 0x800
zhn
zho 0xffff
zhp 0xffff
zhq 0xffff
zhr 0x4800
s_lshr_b32 s81, s20, 1
s_and_b32 s82, s20, 1
s_mul_i32 s64, s81, 0x43800
s_add_u32 s64, s64, 0x9000
s_mul_i32 s65, s81, 0xd800
s_mul_i32 s66, s81, 3
s_mul_i32 s83, s82, 0x60
s_mul_i32 s84, s82, 0xffbc2222
s_add_u32 s84, s84, 0x543210
ze2 69,64
v_mul_u32_u24 v70, 0xab, v69
v_lshrrev_b32 v70, 10, v70
v_mad_i32_i24 v69, v70, -6, v69
v_bfe_u32 v71, v70, 2, 1
v_bfe_u32 v67, v70, 3, 1
zd0 71,67
zg2 70,71
v_lshlrev_b32 v69, 2, v69
v_bfe_u32 v69, s84, v69, 3
zck 70
zbk 70,69
s_add_u32 s85, s83, 0x800
v_add_u32 v3, s85, v70
zcg
s_add_u32 s92, s64, 0
z0 3
zhs 69,64
v_mul_u32_u24 v70, 0xab, v69
v_lshrrev_b32 v70, 10, v70
v_mad_i32_i24 v69, v70, -6, v69
v_bfe_u32 v71, v70, 2, 1
v_bfe_u32 v67, v70, 3, 1
zd0 71,67
zg2 70,71
v_lshlrev_b32 v69, 2, v69
v_bfe_u32 v69, s84, v69, 3
zck 70
zbk 70,69
s_add_u32 s85, s83, 0x400
v_add_u32 v4, s85, v70
zn 4,1024
zht 69,64
v_mul_u32_u24 v70, 0xab, v69
v_lshrrev_b32 v70, 10, v70
v_mad_i32_i24 v69, v70, -6, v69
v_bfe_u32 v71, v70, 2, 1
v_bfe_u32 v67, v70, 3, 1
zd0 71,67
zg2 70,71
v_lshlrev_b32 v69, 2, v69
v_bfe_u32 v69, s84, v69, 3
zck 70
zbk 70,69
s_add_u32 s85, s83, 0
v_add_u32 v5, s85, v70
zn 5,2048
z6 0xc00
zfj 0x1800
z0 3
zn 4,1024
zhb 65,64
zhc 66,64
zhd 67,64
zgd 68,64
zg3 7,65
zf9 8,66
v_and_b32 v69, 2, v66
v_lshl_add_u32 v69, v69, 1, v66
v_and_b32 v69, 5, v69
v_lshl_add_u32 v69, v69, 2, v67
v_mul_u32_u24 v69, 0x60, v69
v_lshl_add_u32 v69, v68, 3, v69
v_add_u32 v2, s73, v69
zfo 0x12000
v_lshl_add_u32 v9, 2, 2, v7
zbv 10,9
zhu 9
zhv 9
zg1 9,8
v_add3_u32 v0, v9, v10, s68
v_add_u32 v1, 0x10000, v0
s_mul_i32 s85, s21, 0xe0
s_add_u32 s85, s85, s22
s_mul_i32 s93, s85, 0xc0
s_mul_i32 s77, s85, 0x64
zbz 13,64
s_xor_b32 s85, s20, 2
s_mul_i32 s85, s85, 0x4800
v_lshl_add_u32 v14, v64, 4, s85
zg3 69,66
zg1 69,64
zbz 17,69
s_mul_i32 s85, s81, 0xa800
s_lshl_b32 s84, s82, 7
s_add_u32 s84, s84, s85
zfk 70,66
zgc 71,66
v_mad_u32_u24 v69, 48, v7, s84
zgn 69,70
zau 15,71,69
s_lshl_b32 s84, s82, 3
v_lshrrev_b32 v69, 3, v64
v_add_u32 v69, s84, v69
v_and_b32 v70, 7, v64
s_add_u32 s85, s85, 64
v_lshl_add_u32 v71, v70, 3, s85
s_mov_b32 s85, 0xc0
v_mad_u32_u24 v16, v69, s85, v71
v_mul_u32_u24 v71, 20, v68
zg1 69,71
v_lshlrev_b32 v69, 4, v69
v_bfe_u32 v70, v64, 2, 1
s_mov_b32 s85, 0x4800
v_mad_u32_u24 v18, v70, s85, v69
s_sub_u32 s81, s21, 3
s_flbit_i32_b32 s81, s81
zhw
s_flbit_i32_b32 s82, s82
s_sub_u32 s81, 0x96, s81
s_sub_u32 s82, 0x96, s82
s_lshl_b32 s81, s81, 7
s_lshl_b32 s82, s82, 23
s_or_b32 s23, s81, s82
s_sub_u32 s23, s23, 0x10001
v_min_u32 v11, 49, v64
v_lshlrev_b32 v11, 4, v11
s_mul_i32 s67, s20, 0x5780
s_add_u32 s67, s67, s77
zbj 12
zn 5,2048
z6 0x1800
zfj 0x3000
z0 3
zn 4,1024
zn 5,2048
s_add_u32 s97, s21, 7
zdn 0xdf
zbt 0xa800
zdv 0x9000
zv
zae 6
s_add_u32 s97, s21, 8
zdn 0xdf
zbt 0xa800
zdv 0xa000
zv
zae 6
zbw
s_cbranch_scc1 Lln16_q1
Lln16_q0:
zu 11
s_barrier
zl 64,0,12288
zl 68,0,16384
zl 72,0,20480
zl 20,0,24576
zl 24,0,28672
zl 80,0,32768
s_add_u32 s97, s21, 9
zdn 0xdf
zbt 0xa800
zdv 0xb000
zv
zae 6
z6 0x2400
zfj 0x16800
z0 3
zu 10
z1 8,2,64
z1 10,2,832
z1 4,2,32
z1 6,2,800
zge 0,2
ds_read_b64_tr_b16 a[2:3], v2 offset:768
Lln16_h0_0:
ze 4
zdo 192,8,64
zl 52,0,12352
zl 56,0,16448
ze 4
zbx 112,4,64
zl 60,0,20544
ze 3
zbx 108,0,64
zn 4,1024
zdo 196,8,68
zbx 120,4,68
zbx 116,0,68
zdo 200,8,72
zn 5,2048
zbx 128,4,72
zbx 124,0,72
zu 9
z1 20,2,3136
z1 22,2,3904
Lln16_h0_1:
zdo 204,8,20
z6 0x3000
zl 28,0,24640
zl 32,0,28736
zbx 136,4,20
zfj 0x18000
zl 36,0,32832
zbx 132,0,20
z1 16,2,3104
zdo 208,8,24
z1 18,2,3872
zbx 144,4,24
z1 12,2,3072
zbx 140,0,24
z1 14,2,3840
zdo 212,8,80
z0 3
zbx 152,4,80
zbx 148,0,80
Lln16_h0_2:
ze 7
zt 192,20,52
ze 2
zl 40,0,12416
zl 44,0,16512
zj 112,16,52
zl 48,0,20608
ze 3
zj 108,12,52
zn 4,1024
zt 196,20,56
zj 120,16,56
zj 116,12,56
zt 200,20,60
zn 5,2048
zj 128,16,60
zj 124,12,60
zu 9
z1 32,2,6208
z1 34,2,6976
Lln16_h0_3:
zt 204,20,28
z6 0x3c00
zl 52,0,24704
zl 56,0,28800
zj 136,16,28
zfj 0x19800
zl 60,0,32896
zj 132,12,28
z1 28,2,6176
zt 208,20,32
z1 30,2,6944
zj 144,16,32
z1 24,2,6144
zj 140,12,32
z1 26,2,6912
zt 212,20,36
z0 3
zj 152,16,36
zj 148,12,36
Lln16_h0_4:
ze 7
zt 192,32,40
ze 2
zn 4,1024
zj 112,28,40
ze 0
zj 108,24,40
zt 196,32,44
zj 120,28,44
zj 116,24,44
zt 200,32,48
zn 5,2048
zj 128,28,48
zu 9
s_barrier
zl 28,0,36864
zl 32,0,36928
zl 36,0,36992
zj 124,24,48
Lln16_h0_5:
zt 204,32,52
s_add_u32 s97, s21, 10
zl 40,0,40960
zj 136,28,52
zdn 0xdf
zl 44,0,41024
zj 132,24,52
zbt 0xa800
zl 48,0,41088
zt 208,32,56
zdv 0xc000
zv
zae 6
zj 144,28,56
zj 140,24,56
zt 212,32,60
zj 152,28,60
zj 148,24,60
Lln16_h0_6:
ze 3
zdo 216,8,28
s_add_u32 s97, s21, 11
zl 52,0,45056
zt 216,20,32
zdn 0xdf
zl 56,0,45120
zt 216,32,36
zbt 0xa800
zl 60,0,45184
zbx 160,4,28
zdv 0xd000
zv
zae 6
zj 160,16,32
s_add_u32 s97, s21, 12
zdn 0xdf
zj 160,28,36
zbt 0xa800
zdv 0xe000
zbx 156,0,28
zj 156,12,32
zae 6
zj 156,24,36
Lln16_h0_7:
ze 3
zdo 220,8,40
s_add_u32 s97, s21, 13
zl 28,0,12288
zt 220,20,44
zdn 0xdf
zl 32,0,16384
zt 220,32,48
zbt 0xa800
zl 36,0,20480
zbx 168,4,40
zdv 0xf000
zj 168,16,44
zae 6
zj 168,28,48
zbx 164,0,40
zj 164,12,44
zj 164,24,48
zu 10
z1 44,2,9280
z1 46,2,10048
Lln16_h0_8:
ze 5
zdo 224,8,52
s_add_u32 s97, s21, 14
zl 40,0,24576
zl 44,0,28672
zt 224,20,56
zdn 0xdf
zl 48,0,32768
z1 40,2,9248
zt 224,32,60
zbt 0xa800
z1 42,2,10016
z1 36,2,9216
zbx 176,4,52
zdv 0x10000
z1 38,2,9984
zj 176,16,56
zae 6
zj 176,28,60
s_add_u32 s97, s21, 15
zdn 0xdf
zbx 172,0,52
zbt 0xa800
zdv 0x11000
zj 172,12,56
zae 6
zj 172,24,60
Lln16_h0_9:
ze 7
zdo 188,44,28
s_add_u32 s97, s21, 16
zl 52,0,12352
ze 3
zbx 104,40,28
zdn 0xdf
zl 56,0,16448
ze 2
zbx 100,36,28
zbt 0xa800
zl 60,0,20544
zt 192,44,32
zdv 0x12000
zj 112,40,32
zae 6
zj 108,36,32
zt 196,44,36
zj 120,40,36
zdp 116,36
zu 10
z1 56,2,12352
z1 58,2,13120
Lln16_h0_10:
zt 200,44,40
s_add_u32 s97, s21, 17
zl 28,0,24640
zl 32,0,28736
zdp 128,40
zdn 0xdf
zl 36,0,32832
z1 52,2,12320
zj 124,36,40
zbt 0xa800
z1 54,2,13088
z1 48,2,12288
zga 204,44
zdv 0x13000
z1 50,2,13056
zj 136,40,44
zae 6
zj 132,36,44
s_sub_u32 s97, s21, 2
zdn 0xdf
zt 208,44,48
zbt 0xa800
s_add_u32 m0, s35, 0
zj 144,40,48
zae 6
zj 140,36,48
Lln16_h0_11:
ze 7
zt 188,56,52
s_sub_u32 s97, s21, 1
zl 40,0,12416
ze 3
zdp 104,52
zdn 0xdf
zl 44,0,16512
ze 2
zj 100,48,52
zbt 0xa800
zl 48,0,20608
zga 192,56
zdv 0x1000
zj 112,52,56
zae 6
zj 108,48,56
zt 196,56,60
zj 120,52,60
zj 116,48,60
zu 10
z1 68,2,15424
z1 70,2,16192
Lln16_h0_12:
zt 200,56,28
s_add_u32 s97, s21, 0
zl 52,0,24704
zl 56,0,28800
zj 128,52,28
zdn 0xdf
zl 60,0,32896
z1 64,2,15392
zj 124,48,28
zbt 0xa800
z1 66,2,16160
z1 60,2,15360
zt 204,56,32
zdv 0x2000
z1 62,2,16128
zj 136,52,32
zae 6
zj 132,48,32
zcg
zhx 0x36000
zt 208,56,36
zj 144,52,36
z0 3
zj 140,48,36
Lln16_h0_13:
ze 7
zt 188,68,40
ze 2
zl 28,0,36864
zj 104,64,40
ze 1
zl 32,0,36928
zj 100,60,40
zl 36,0,36992
zt 192,68,44
zj 112,64,44
zn 4,1024
zj 108,60,44
zt 196,68,48
zj 120,64,48
zj 116,60,48
Lln16_h0_14:
zt 200,68,52
zl 40,0,40960
zj 128,64,52
zl 44,0,41024
zj 124,60,52
zl 48,0,41088
zt 204,68,56
zj 136,64,56
zn 5,2048
zj 132,60,56
zt 208,68,60
zj 144,64,60
zdp 140,60
Lln16_h0_15:
ze 3
zt 212,44,28
z6 0xc00
zl 52,0,45056
zt 212,56,32
zhx 0x37800
zl 56,0,45120
zt 212,68,36
zl 60,0,45184
zj 152,40,28
zj 152,52,32
z0 3
zj 152,64,36
zj 148,36,28
zj 148,48,32
zu 11
s_barrier
zj 148,60,36
Lln16_h0_16:
ze 3
zt 216,44,40
zl 28,0,49152
zt 216,56,44
zl 32,0,49216
zt 216,68,48
zl 36,0,49280
zdp 160,40
zj 160,52,44
zn 4,1024
zj 160,64,48
zj 156,36,40
zj 156,48,44
zj 156,60,48
Lln16_h0_17:
ze 3
zt 220,44,52
zl 40,0,53248
zga 220,56
zl 44,0,53312
zt 220,68,60
zl 48,0,53376
zj 168,40,52
zj 168,52,56
zn 5,2048
zj 168,64,60
zj 164,36,52
zj 164,48,56
zdp 164,60
Lln16_h0_18:
ze 3
zdo 228,8,28
z6 0x1800
zl 52,0,57344
zt 228,20,32
zhx 0x39000
zl 56,0,57408
zt 228,32,36
zl 60,0,57472
zbx 184,4,28
zj 184,16,32
z0 3
zj 184,28,36
zbx 180,0,28
zj 180,12,32
zj 180,24,36
zt 224,44,28
zt 224,56,32
zt 224,68,36
zj 176,40,28
zj 176,52,32
zn 4,1024
zj 176,64,36
zj 172,36,28
zj 172,48,32
zj 172,60,36
Lln16_h0_19:
ze 0
zdo 232,8,40
zl 28,0,61440
zt 232,20,44
zl 32,0,61504
zt 232,32,48
zl 36,0,61568
zbx 192,4,40
zj 192,16,44
zn 5,2048
zj 192,28,48
z6 0x2400
s_add_u32 s92, s65, 0
zbx 188,0,40
zj 188,12,44
zj 188,24,48
zt 228,44,40
zt 228,56,44
zt 228,68,48
zdp 184,40
zj 184,52,44
z0 3
zj 184,64,48
zj 180,36,40
zj 180,48,44
zj 180,60,48
Lln16_h0_20:
zdo 236,8,52
zt 236,20,56
zt 236,32,60
zbx 200,4,52
zj 200,16,56
zn 4,1024
zj 200,28,60
zbx 196,0,52
zj 196,12,56
zj 196,24,60
zt 232,44,52
zga 232,56
zt 232,68,60
zj 192,40,52
zj 192,52,56
zn 5,2048
zj 192,64,60
zj 188,36,52
zj 188,48,56
zu 12
s_barrier
za7 40,1
zl 44,1,64
zl 48,1,128
zdp 188,60
Lln16_h0_21:
ze 3
zdo 240,8,28
z6 0x3000
za7 52,0
zt 240,20,32
zc4 0x1800
zl 56,0,64
zt 240,32,36
zl 60,0,128
zbx 208,4,28
z0 3
zj 208,16,32
zj 208,28,36
zn 4,1024
zbx 204,0,28
zj 204,12,32
zj 204,24,36
zu 11
z1 80,2,64
z1 82,2,832
zt 236,44,28
z1 76,2,32
zt 236,56,32
z1 78,2,800
zt 236,68,36
zge 72,2
zj 200,40,28
z1 74,2,768
zj 200,52,32
zn 5,2048
zj 200,64,36
z6 0x3c00
zc4 0x3000
zj 196,36,28
z0 3
zj 196,48,32
zj 196,60,36
Lln16_h0_22:
ze 6
zt 240,44,40
zl 28,0,4096
zl 32,0,4160
zt 240,56,44
zl 36,0,4224
zt 240,68,48
zn 4,1024
zdp 208,40
zj 208,52,44
zu 11
z1 92,2,3136
z1 94,2,3904
zj 208,64,48
z1 88,2,3104
z1 90,2,3872
zj 204,36,40
z1 84,2,3072
z1 86,2,3840
zj 204,48,44
zn 5,2048
zj 204,60,48
Lln16_h0_23:
zdo 180,8,52
zcg
zl 40,0,8192
zl 44,0,8256
zt 180,20,56
zc4 0x16800
zl 48,0,8320
zt 180,32,60
zbx 88,4,52
ze 9
z0 3
zj 88,16,56
zj 88,28,60
zbx 84,0,52
zj 84,12,56
zj 84,24,60
zu 10
z1 104,2,6208
z1 106,2,6976
zn 4,1024
Lln16_h0_24:
zdo 184,8,28
zl 52,0,12288
zl 56,0,12352
zt 184,20,32
zl 60,0,12416
z1 100,2,6176
zt 184,32,36
z1 102,2,6944
zbx 96,4,28
z1 96,2,6144
zj 96,16,32
z1 98,2,6912
zj 96,28,36
zn 5,2048
zbx 92,0,28
z6 0xc00
zc4 0x18000
zj 92,12,32
zj 92,24,36
zt 180,44,28
ze 7
z0 3
zt 180,56,32
zt 180,68,36
zj 88,40,28
zj 88,52,32
zu 10
z1 116,2,9280
z1 118,2,10048
zj 88,64,36
z1 112,2,9248
z1 114,2,10016
zj 84,36,28
z1 108,2,9216
z1 110,2,9984
zj 84,48,32
zn 4,1024
zj 84,60,36
Lln16_h0_25:
zt 188,8,40
zl 28,0,16384
zl 32,0,16448
zt 188,20,44
zl 36,0,16512
zt 188,32,48
zn 5,2048
zj 104,4,40
z6 0x1800
zc4 0x19800
zj 104,16,44
zj 104,28,48
zj 100,0,40
ze 5
z0 3
zj 100,12,44
zj 100,24,48
zu 10
z1 128,2,12352
z1 130,2,13120
zt 184,44,40
z1 124,2,12320
z1 126,2,13088
zt 184,56,44
z1 120,2,12288
zt 184,68,48
z1 122,2,13056
zdp 96,40
zn 4,1024
zj 96,52,44
zj 96,64,48
zj 92,36,40
zj 92,48,44
zn 5,2048
zj 92,60,48
z6 0x2400
zc4 0x2d000
zt 180,80,40
zt 180,92,44
zt 180,104,48
zj 88,76,40
ze 0
z0 3
zfp 88,44
zu 10
z1 140,2,15424
z1 142,2,16192
zj 88,100,48
z1 136,2,15392
z1 138,2,16160
zj 84,72,40
z1 132,2,15360
z1 134,2,16128
zfp 84,44
zj 84,96,48
zn 4,1024
Lln16_h0_26:
zt 184,80,52
zl 40,0,20480
zt 184,92,56
zl 44,0,20544
zt 184,104,60
zl 48,0,20608
zj 96,76,52
zj 96,88,56
zn 5,2048
zj 96,100,60
zj 92,72,52
zj 92,84,56
zj 92,96,60
zu 9
z1 152,2,64
z1 154,2,832
Lln16_h0_27:
zt 188,80,28
z6 0x3000
zl 52,0,24576
zl 56,0,24640
zt 188,92,32
zc4 0x2e800
zl 60,0,24704
z1 148,2,32
zt 188,104,36
z1 150,2,800
zge 144,2
zj 104,76,28
z1 146,2,768
zj 104,88,32
z0 3
zj 104,100,36
zn 4,1024
zj 100,72,28
zj 100,84,32
zj 100,96,36
Lln16_h0_28:
ze 7
zt 192,80,40
zl 28,0,28672
zl 32,0,28736
zt 192,92,44
zl 36,0,28800
zn 5,2048
zt 192,104,48
z6 0x3c00
zc4 0x30000
zj 112,76,40
zj 112,88,44
zu 9
z1 164,2,3136
z1 166,2,3904
zj 112,100,48
z1 160,2,3104
z1 162,2,3872
zj 108,72,40
z1 156,2,3072
z1 158,2,3840
zj 108,84,44
z0 3
zj 108,96,48
Lln16_h0_29:
ze 9
zt 196,80,52
zl 40,0,32768
zl 44,0,32832
zt 196,92,56
zl 48,0,32896
zt 196,104,60
zn 4,1024
zj 120,76,52
zj 120,88,56
zj 120,100,60
zj 116,72,52
zj 116,84,56
zn 5,2048
zj 116,96,60
zu 9
z1 176,2,6208
z1 178,2,6976
Lln16_h0_30:
ze 5
zt 200,80,28
zcg
zl 52,0,36864
zl 56,0,36928
zt 200,92,32
zc4 0x43800
zl 60,0,36992
z1 172,2,6176
zt 200,104,36
z1 174,2,6944
z1 168,2,6144
zj 128,76,28
z1 170,2,6912
zj 128,88,32
z0 3
zj 128,100,36
zj 124,72,28
zj 124,84,32
zj 124,96,36
zn 4,1024
Lln16_h0_31:
ze 7
zt 204,80,40
v_lshl_add_u32 v9, s66, 2, v7
zbv 10,9
zhu 9
zt 204,92,44
zhv 9
zg1 9,8
v_add3_u32 v0, v9, v10, s68
zt 204,104,48
v_add_u32 v1, 0x10000, v0
zj 136,76,40
za7 28,0
zl 32,0,64
zl 36,0,128
zj 136,88,44
zu 8
zb 220,2,9280
zb 222,2,10048
zj 136,100,48
zb 216,2,9248
zb 218,2,10016
zj 132,72,40
zb 212,2,9216
zb 214,2,9984
zj 132,84,44
zn 5,2048
zj 132,96,48
Lln16_h0_32:
ze 9
zt 208,80,52
z6 0xc00
zl 40,0,4096
zt 208,92,56
zc4 0x45000
zl 44,0,4160
zt 208,104,60
zl 48,0,4224
zj 144,76,52
z0 3
zj 144,88,56
zj 144,100,60
zn 4,1024
zj 140,72,52
zj 140,84,56
zj 140,96,60
Lln16_a0:
ze 3
zt 180,116,28
zl 52,0,8192
zl 56,0,8256
zt 180,128,32
zu 8
zl 60,0,8320
zb 232,2,12352
zt 180,140,36
zb 234,2,13120
zb 228,2,12320
zj 88,112,28
zb 230,2,13088
zb 224,2,12288
zj 88,124,32
zb 226,2,13056
zn 5,2048
zj 88,136,36
z6 0x1800
zc4 0x46800
zj 84,108,28
z0 3
zj 84,120,32
zj 84,132,36
Lln16_a1:
ze 9
zt 184,116,40
zl 28,0,12288
zt 184,128,44
zl 32,0,12352
zt 184,140,48
zl 36,0,12416
zj 96,112,40
zn 4,1024
zj 96,124,44
zj 96,136,48
zj 92,108,40
zj 92,120,44
zu 8
zb 244,2,15424
zb 246,2,16192
zj 92,132,48
zb 240,2,15392
zb 242,2,16160
zt 180,152,40
zb 236,2,15360
zt 180,164,44
zb 238,2,16128
zt 180,176,48
zn 5,2048
zj 88,148,40
z6 0x2400
zc4 0x5a000
zj 88,160,44
z0 3
zj 88,172,48
zj 84,144,40
zj 84,156,44
zj 84,168,48
zn 4,1024
Lln16_a2:
ze 2
zt 188,116,52
zl 40,0,16384
zt 188,128,56
zl 44,0,16448
zt 188,140,60
zl 48,0,16512
zj 104,112,52
zj 104,124,56
zu 8
z1 8,2,64
zj 104,136,60
z1 10,2,832
zj 100,108,52
z1 4,2,32
zj 100,120,56
z1 6,2,800
zj 100,132,60
zge 0,2
zt 184,152,52
ds_read_b64_tr_b16 a[2:3], v2 offset:768
zt 184,164,56
zn 5,2048
zt 184,176,60
z6 0x3000
zc4 0x5b800
zj 96,148,52
z0 3
zj 96,160,56
zj 96,172,60
zn 4,1024
zj 92,144,52
zj 92,156,56
zj 92,168,60
za 180,220,52
za 180,232,56
zu 8
z1 20,2,3136
z1 22,2,3904
za 180,244,60
z1 16,2,3104
z1 18,2,3872
zf 88,216,52
z1 12,2,3072
z1 14,2,3840
zf 88,228,56
zn 5,2048
zf 88,240,60
z6 0x3c00
zc4 0x5d000
zf 84,212,52
ze 6
z0 3
zf 84,224,56
zf 84,236,60
Lln16_a3:
zt 192,116,28
zb1 84,0,20480
zt 192,128,32
zb1 88,0,20544
zt 192,140,36
zb1 92,0,20608
zfp 112,28
zn 4,1024
zj 112,124,32
zj 112,136,36
zfp 108,28
zj 108,120,32
zu 8
z1 32,2,6208
zj 108,132,36
z1 34,2,6976
zt 188,152,28
z1 28,2,6176
zt 188,164,32
z1 30,2,6944
zt 188,176,36
z1 24,2,6144
zj 104,148,28
z1 26,2,6912
zj 104,160,32
zn 5,2048
zj 104,172,36
zj 100,144,28
zj 100,156,32
zj 100,168,36
za 184,220,28
za 184,232,32
za 184,244,36
zf 96,216,28
zf 96,228,32
zu 6
z1 44,2,9280
zf 96,240,36
z1 46,2,10048
zf 92,212,28
z1 40,2,9248
zf 92,224,32
z1 42,2,10016
zf 92,236,36
z1 36,2,9216
zt 180,8,28
ze 5
z1 38,2,9984
zt 180,20,32
zt 180,32,36
zj 88,4,28
zj 88,16,32
zj 88,28,36
zj 84,0,28
zj 84,12,32
zj 84,24,36
Lln16_a4:
zt 196,116,40
zb1 96,0,24576
zt 196,128,44
zb1 100,0,24640
zt 196,140,48
zb1 104,0,24704
zj 120,112,40
zu 3
z1 56,2,12352
zj 120,124,44
z1 58,2,13120
zj 120,136,48
z1 52,2,12320
zj 116,108,40
z1 54,2,13088
zj 116,120,44
z1 48,2,12288
zj 116,132,48
z1 50,2,13056
zt 192,152,40
zt 192,164,44
zt 192,176,48
zj 112,148,40
zj 112,160,44
zj 112,172,48
zj 108,144,40
zj 108,156,44
zu 0
z1 68,2,15424
zj 108,168,48
z1 70,2,16192
za 188,220,40
z1 64,2,15392
za 188,232,44
z1 66,2,16160
za 188,244,48
z1 60,2,15360
zf 104,216,40
z1 62,2,16128
zf 104,228,44
zf 104,240,48
zf 100,212,40
zf 100,224,44
zf 100,236,48
zt 184,8,40
zt 184,20,44
zt 184,32,48
zj 96,4,40
zj 96,16,44
zj 96,28,48
zj 92,0,40
zj 92,12,44
zj 92,24,48
ze 0
zt 180,44,40
zt 180,56,44
zt 180,68,48
zdp 88,40
zj 88,52,44
zj 88,64,48
zj 84,36,40
zj 84,48,44
zj 84,60,48
Lln16_a5:
zaf 184,44,84
zl 28,0,28672
zaf 184,56,88
zl 32,0,28736
zaf 184,68,92
zl 36,0,28800
zz 96,40,84
zz 96,52,88
zz 96,64,92
zz 92,36,84
zz 92,48,88
v_mfma_f32_16x16x32_bf16 v[92:95], a[60:63], a[92:95], v[92:95]
Lln16_a6:
zaf 188,8,84
zl 40,0,32768
zaf 188,20,88
zl 44,0,32832
zaf 188,32,92
zl 48,0,32896
zaf 188,44,96
zaf 188,56,100
zaf 188,68,104
zz 104,4,84
zz 104,16,88
zz 104,28,92
zz 104,40,96
buffer_load_dwordx4 v[20:23], v11, s[8:11], s67 offen
zz 104,52,100
buffer_load_dwordx4 v[24:27], v11, s[8:11], s67 offen offset:800
v_mfma_f32_16x16x32_bf16 v[104:107], a[64:67], a[104:107], v[104:107]
s_add_u32 s67, s67, 0x15e00
zz 100,0,84
zz 100,12,88
zz 100,24,92
zz 100,36,96
v_mfma_f32_16x16x32_bf16 v[100:103], a[48:51], a[100:103], v[100:103]
zz 100,60,104
Lln16_a7:
zb4 192,220,84
zl 52,0,36864
zb4 192,232,88
zl 56,0,36928
zb4 192,244,92
zl 60,0,36992
zaf 192,8,96
zaf 192,20,100
zaf 192,32,104
ze 3
zt 192,44,28
zt 192,56,32
zt 192,68,36
zba 112,216,84
zba 112,228,88
zba 112,240,92
zz 112,4,96
zz 112,16,100
zz 112,28,104
zj 112,40,28
zj 112,52,32
zj 112,64,36
zba 108,212,84
zba 108,224,88
zba 108,236,92
zz 108,0,96
zz 108,12,100
zz 108,24,104
zj 108,36,28
zj 108,48,32
zj 108,60,36
Lln16_a8:
zaf 196,152,84
zb1 72,0,40960
zaf 196,164,88
zb1 76,0,41024
zaf 196,176,92
zb1 80,0,41088
zb4 196,220,96
zb4 196,232,100
zb4 196,244,104
zt 196,8,28
zt 196,20,32
zt 196,32,36
zt 196,44,40
zt 196,56,44
zt 196,68,48
zz 120,148,84
zz 120,160,88
zz 120,172,92
zba 120,216,96
zba 120,228,100
zba 120,240,104
zj 120,4,28
zj 120,16,32
zj 120,28,36
zdp 120,40
zj 120,52,44
zj 120,64,48
zz 116,144,84
zz 116,156,88
zz 116,168,92
zba 116,212,96
zba 116,224,100
zba 116,236,104
zj 116,0,28
zj 116,12,32
zj 116,24,36
zj 116,36,40
zj 116,48,44
zj 116,60,48
Lln16_a9:
zaf 200,116,84
zaf 200,128,88
zaf 200,140,92
zaf 200,152,96
zaf 200,164,100
zaf 200,176,104
za 200,220,28
za 200,232,32
za 200,244,36
zt 200,8,40
zt 200,20,44
zt 200,32,48
ze 0
zt 200,44,52
zga 200,56
zt 200,68,60
zz 128,112,84
zz 128,124,88
zz 128,136,92
zz 128,148,96
zz 128,160,100
zz 128,172,104
zf 128,216,28
zf 128,228,32
zf 128,240,36
zj 128,4,40
zj 128,16,44
zj 128,28,48
zj 128,40,52
zj 128,52,56
zj 128,64,60
zz 124,108,84
zz 124,120,88
zz 124,132,92
zz 124,144,96
zz 124,156,100
zz 124,168,104
zf 124,212,28
zf 124,224,32
zf 124,236,36
zj 124,0,40
zj 124,12,44
zj 124,24,48
zj 124,36,52
zj 124,48,56
zdp 124,60
Lln16_a10:
zaf 204,116,96
zb1 84,0,45056
zaf 204,128,100
zb1 88,0,45120
zaf 204,140,104
zb1 92,0,45184
zt 204,152,28
zu 1
zdq 20
zt 204,164,32
zdr 12,20
zt 204,176,36
zdq 21
za 204,220,40
zdr 12,21
za 204,232,44
zdq 22
za 204,244,48
zdr 12,22
zt 204,8,52
zdq 23
zt 204,20,56
zdr 12,23
zt 204,32,60
zu 0
zdq 24
zaf 204,44,72
zdr 12,24
zaf 204,56,76
zdq 25
zaf 204,68,80
zdr 12,25
zz 136,112,96
zdq 26
zz 136,124,100
zdr 12,26
zg4 136,104
zdq 27
zj 136,148,28
zdr 12,27
zj 136,160,32
zj 136,172,36
zf 136,216,40
zf 136,228,44
buffer_load_dwordx4 v[20:23], v11, s[8:11], s67 offen
zf 136,240,48
buffer_load_dwordx4 v[24:27], v11, s[8:11], s67 offen offset:800
zj 136,4,52
s_add_u32 s67, s67, 0x15e00
zj 136,16,56
zj 136,28,60
zz 136,40,72
zz 136,52,76
zz 136,64,80
zz 132,108,96
zz 132,120,100
zg4 132,104
zj 132,144,28
zj 132,156,32
zj 132,168,36
zf 132,212,40
zf 132,224,44
zf 132,236,48
zj 132,0,52
zj 132,12,56
zj 132,24,60
zz 132,36,72
zz 132,48,76
zz 132,60,80
Lln16_a11:
zt 208,116,28
zcg
zb1 96,0,49152
zt 208,128,32
zc4 0x4800
zb1 100,0,49216
zt 208,140,36
zb1 104,0,49280
zt 208,152,40
zt 208,164,44
zt 208,176,48
z0 3
za 208,220,52
za 208,232,56
za 208,244,60
zaf 208,8,72
zaf 208,20,76
zn 4,1024
zaf 208,32,80
ze 1
zaf 208,44,84
zaf 208,56,88
zaf 208,68,92
zj 144,112,28
zn 5,2048
zj 144,124,32
z6 0xc00
zc4 0x6000
zj 144,136,36
zj 144,148,40
zj 144,160,44
zj 144,172,48
z0 3
zf 144,216,52
zf 144,228,56
zf 144,240,60
zz 144,4,72
zz 144,16,76
zn 4,1024
zz 144,28,80
zz 144,40,84
zz 144,52,88
zz 144,64,92
zj 140,108,28
zn 5,2048
zj 140,120,32
z6 0x1800
zc4 0x7800
zj 140,132,36
zj 140,144,40
zj 140,156,44
zj 140,168,48
z0 3
zf 140,212,52
zf 140,224,56
zf 140,236,60
zz 140,0,72
zz 140,12,76
zn 4,1024
zz 140,24,80
zz 140,36,84
zz 140,48,88
zz 140,60,92
Lln16_a12:
zt 212,116,40
zl 28,0,53248
zt 212,128,44
zl 32,0,53312
zt 212,140,48
zl 36,0,53376
zt 212,152,52
zn 5,2048
zt 212,164,56
z6 0x2400
zc4 0x1b000
zt 212,176,60
z0 3
zb4 212,220,72
zb4 212,232,76
zb4 212,244,80
zaf 212,8,84
zaf 212,20,88
zn 4,1024
zaf 212,32,92
zaf 212,44,96
zaf 212,56,100
ze 0
zaf 212,68,104
zj 152,112,40
zn 5,2048
zj 152,124,44
z6 0x3000
zc4 0x1c800
zj 152,136,48
zj 152,148,52
zj 152,160,56
zj 152,172,60
z0 3
zba 152,216,72
zba 152,228,76
zba 152,240,80
zz 152,4,84
zz 152,16,88
zn 4,1024
zz 152,28,92
zz 152,40,96
zz 152,52,100
zz 152,64,104
zj 148,108,40
zn 5,2048
zj 148,120,44
z6 0x3c00
zc4 0x1e000
zj 148,132,48
zj 148,144,52
zj 148,156,56
zj 148,168,60
z0 3
zba 148,212,72
zba 148,224,76
zba 148,236,80
zz 148,0,84
zz 148,12,88
zn 4,1024
zz 148,24,92
zz 148,36,96
zz 148,48,100
zz 148,60,104
Lln16_a13:
zt 216,116,52
zl 40,0,57344
zt 216,128,56
zl 44,0,57408
zt 216,140,60
zl 48,0,57472
zaf 216,152,72
zn 5,2048
zaf 216,164,76
zu 19
zdq 20
zaf 216,176,80
zdr 12,20
zb4 216,220,84
zdq 21
zb4 216,232,88
zdr 12,21
zb4 216,244,92
zdq 22
zaf 216,8,96
zdr 12,22
zaf 216,20,100
zdq 23
zaf 216,32,104
zdr 12,23
zt 216,44,28
zu 18
zdq 24
zt 216,56,32
zdr 12,24
zt 216,68,36
zdq 25
zj 160,112,52
zdr 12,25
zj 160,124,56
zdq 26
zj 160,136,60
zdr 12,26
zz 160,148,72
zdq 27
zg4 160,76
zdr 12,27
zz 160,172,80
zba 160,216,84
zba 160,228,88
buffer_load_dwordx4 v[20:23], v11, s[8:11], s67 offen
zba 160,240,92
buffer_load_dwordx4 v[24:27], v11, s[8:11], s67 offen offset:800
zz 160,4,96
s_add_u32 s67, s67, 0x15e00
zz 160,16,100
zz 160,28,104
zj 160,40,28
zj 160,52,32
zj 160,64,36
zj 156,108,52
zj 156,120,56
zj 156,132,60
zz 156,144,72
zg4 156,76
zz 156,168,80
zba 156,212,84
zba 156,224,88
zba 156,236,92
zz 156,0,96
zz 156,12,100
zz 156,24,104
zj 156,36,28
zj 156,48,32
zj 156,60,36
Lln16_a14:
zaf 220,116,72
zcg
zl 52,0,61440
zaf 220,128,76
zc4 0x31800
zl 56,0,61504
zaf 220,140,80
zl 60,0,61568
zaf 220,152,84
zaf 220,164,88
zaf 220,176,92
v_mfma_f32_16x16x32_bf16 a[220:223], v[220:223], a[96:99], a[220:223]
zb4 220,232,100
zb4 220,244,104
zt 220,8,28
zt 220,20,32
zt 220,32,36
ze 1
zt 220,44,40
zt 220,56,44
zt 220,68,48
zz 168,112,72
zz 168,124,76
zz 168,136,80
zz 168,148,84
zz 168,160,88
zz 168,172,92
zba 168,216,96
zba 168,228,100
zba 168,240,104
zj 168,4,28
zj 168,16,32
zj 168,28,36
zdp 168,40
zj 168,52,44
zj 168,64,48
zz 164,108,72
zz 164,120,76
zz 164,132,80
zz 164,144,84
zu 17
z1 80,2,64
zz 164,156,88
z1 82,2,832
zz 164,168,92
z1 76,2,32
zba 164,212,96
z1 78,2,800
zba 164,224,100
zge 72,2
zba 164,236,104
z1 74,2,768
zj 164,0,28
zj 164,12,32
zj 164,24,36
zj 164,36,40
zj 164,48,44
ze 0
z0 3
zj 164,60,48
Lln16_a15:
zaf 224,116,84
zaf 224,128,88
zaf 224,140,92
zaf 224,152,96
zn 4,1024
zaf 224,164,100
zaf 224,176,104
za 224,220,28
za 224,232,32
za 224,244,36
zn 5,2048
zt 224,8,40
z6 0xc00
zc4 0x33000
zt 224,20,44
zt 224,32,48
zt 224,44,52
zga 224,56
zt 224,68,60
zz 176,112,84
zz 176,124,88
zz 176,136,92
zz 176,148,96
zz 176,160,100
zz 176,172,104
zf 176,216,28
zf 176,228,32
zf 176,240,36
zj 176,4,40
zj 176,16,44
zj 176,28,48
zj 176,40,52
zj 176,52,56
zj 176,64,60
zz 172,108,84
zz 172,120,88
zz 172,132,92
zz 172,144,96
zu 17
z1 92,2,3136
zz 172,156,100
z1 94,2,3904
zz 172,168,104
z1 88,2,3104
zf 172,212,28
z1 90,2,3872
zf 172,224,32
z1 84,2,3072
zf 172,236,36
z1 86,2,3840
zj 172,0,40
zj 172,12,44
zj 172,24,48
zj 172,36,52
zj 172,48,56
ze 0
z0 3
zdp 172,60
Lln16_a16:
zaf 228,116,96
zu 5
zdq 20
zaf 228,128,100
zdr 12,20
zaf 228,140,104
zdq 21
zt 228,152,28
zn 4,1024
zt 228,164,32
zdr 12,21
zt 228,176,36
zdq 22
za 228,220,40
zdr 12,22
za 228,232,44
zdq 23
za 228,244,48
zn 5,2048
zt 228,8,52
zdr 12,23
zt 228,20,56
zu 6
zdq 24
zt 228,32,60
zdr 12,24
zz 184,112,96
zdq 25
zz 184,124,100
zdr 12,25
zz 184,136,104
zdq 26
zj 184,148,28
zdr 12,26
zj 184,160,32
zdq 27
zj 184,172,36
zdr 12,27
zf 184,216,40
buffer_load_dwordx4 v[20:23], v11, s[8:11], s67 offen
zf 184,228,44
buffer_load_dwordx4 v[24:27], v11, s[8:11], s67 offen offset:800
zf 184,240,48
s_add_u32 s67, s67, 0x15e00
zj 184,4,52
zj 184,16,56
zj 184,28,60
zz 180,108,96
zz 180,120,100
zz 180,132,104
zj 180,144,28
z1 104,2,6208
zj 180,156,32
z1 106,2,6976
zj 180,168,36
z1 100,2,6176
zf 180,212,40
z1 102,2,6944
zf 180,224,44
z1 96,2,6144
zf 180,236,48
z1 98,2,6912
zj 180,0,52
zj 180,12,56
zj 180,24,60
Lln16_a17:
zt 232,116,28
z6 0x1800
zc4 0x34800
zt 232,128,32
ze 0
z0 3
zt 232,140,36
zt 232,152,40
zt 232,164,44
zt 232,176,48
za 232,220,52
zn 4,1024
zdm 232,56
za 232,244,60
zj 192,112,28
zj 192,124,32
zj 192,136,36
zn 5,2048
zj 192,148,40
zj 192,160,44
zj 192,172,48
zf 192,216,52
zf 192,228,56
zf 192,240,60
zj 188,108,28
zj 188,120,32
zj 188,132,36
zj 188,144,40
zj 188,156,44
zj 188,168,48
zf 188,212,52
zf 188,224,56
zf 188,236,60
Lln16_a18:
zt 236,116,40
za7 28,1
zt 236,128,44
zl 32,1,64
zt 236,140,48
zl 36,1,128
zt 236,152,52
zt 236,164,56
zt 236,176,60
zj 200,112,40
zj 200,124,44
zj 200,136,48
zj 200,148,52
zj 200,160,56
zj 200,172,60
zj 196,108,40
zj 196,120,44
zj 196,132,48
zj 196,144,52
zj 196,156,56
zj 196,168,60
Lln16_a19:
zt 240,116,52
zl 40,1,4096
zt 240,128,56
zl 44,1,4160
zt 240,140,60
zl 48,1,4224
zj 208,112,52
zj 208,124,56
zj 208,136,60
zj 204,108,52
zj 204,120,56
z1 116,2,9280
z1 118,2,10048
zj 204,132,60
z1 112,2,9248
z1 114,2,10016
Lln16_a20:
ze 7
zt 240,152,28
z6 0x2400
zl 52,1,8192
zl 56,1,8256
zt 240,164,32
zc4 0x48000
zl 60,1,8320
z1 108,2,9216
zt 240,176,36
z1 110,2,9984
z1 128,2,12352
zj 208,148,28
z1 130,2,13120
z1 124,2,12320
zj 208,160,32
z1 126,2,13088
z1 120,2,12288
zj 208,172,36
z1 122,2,13056
z1 140,2,15424
zj 204,144,28
z1 142,2,16192
z1 136,2,15392
zj 204,156,32
z1 138,2,16160
z1 132,2,15360
zj 204,168,36
zu 8
z1 134,2,16128
z1 152,2,64
za 236,220,28
z1 154,2,832
z1 148,2,32
za 236,232,32
z1 150,2,800
zge 144,2
za 236,244,36
zu 5
z1 146,2,768
z1 164,2,3136
zf 200,216,28
z1 166,2,3904
zf 200,228,32
z1 160,2,3104
zf 200,240,36
z1 162,2,3872
zf 196,212,28
z1 156,2,3072
zf 196,224,32
z1 158,2,3840
zf 196,236,36
zu 0
z1 176,2,6208
zt 232,8,28
z1 178,2,6976
zt 232,20,32
z1 172,2,6176
zt 232,32,36
z1 174,2,6944
zj 192,4,28
z1 168,2,6144
zj 192,16,32
z1 170,2,6912
zj 192,28,36
ze 9
z0 3
zj 188,0,28
zn 4,1024
zj 188,12,32
zn 5,2048
zj 188,24,36
z6 0x3000
zc4 0x49800
zt 228,44,28
z0 3
zt 228,56,32
zn 4,1024
zt 228,68,36
zj 184,40,28
zj 184,52,32
zj 184,64,36
zj 180,36,28
zn 5,2048
zj 180,48,32
zj 180,60,36
Lln16_a21:
za 240,220,40
z6 0x3c00
zl 28,1,12288
zl 32,1,12352
za 240,232,44
zc4 0x4b000
zl 36,1,12416
zdq 20
za 240,244,48
z0 3
zf 208,216,40
zdr 12,20
zf 208,228,44
zdq 21
zf 208,240,48
zdr 12,21
zf 204,212,40
zdq 22
zf 204,224,44
zn 4,1024
zf 204,236,48
zdr 12,22
zt 236,8,40
zdq 23
zt 236,20,44
zdr 12,23
zt 236,32,48
zdq 24
zj 200,4,40
zn 5,2048
zj 200,16,44
zcg
zc4 0x5e800
zj 200,28,48
zdr 12,24
zj 196,0,40
zdq 25
zj 196,12,44
zdr 12,25
zj 196,24,48
z0 3
zt 232,44,40
zdq 26
zt 232,56,44
zdr 12,26
zt 232,68,48
zdq 27
zdp 192,40
zdr 12,27
zj 192,52,44
zn 4,1024
zj 192,64,48
zj 188,36,40
zj 188,48,44
zj 188,60,48
Lln16_a22:
zt 240,8,52
s_add_u32 s66, s66, 1
v_lshl_add_u32 v9, s66, 2, v7
zbv 10,9
zt 240,20,56
zhu 9
zhv 9
zt 240,32,60
zg1 9,8
v_add3_u32 v0, v9, v10, s68
zj 208,4,52
zu 8
zb 220,2,9280
v_add_u32 v1, 0x10000, v0
zj 208,16,56
za7 40,0
zl 44,0,64
zj 208,28,60
zl 48,0,128
zb 222,2,10048
zj 204,0,52
zb 216,2,9248
zb 218,2,10016
zj 204,12,56
zb 212,2,9216
zb 214,2,9984
zj 204,24,60
zn 5,2048
zt 236,44,52
z6 0xc00
zc4 0x60000
ze 9
z0 3
zga 236,56
zn 4,1024
zt 236,68,60
zj 200,40,52
zj 200,52,56
zj 200,64,60
zj 196,36,52
zu 8
zb 232,2,12352
zb 234,2,13120
zn 5,2048
zj 196,48,56
zb 228,2,12320
zb 230,2,13088
zdp 196,60
zb 224,2,12288
zb 226,2,13056
Lln16_a23:
zt 240,44,28
z6 0x1800
zl 52,0,4096
zt 240,56,32
zc4 0x61800
zl 56,0,4160
zt 240,68,36
zl 60,0,4224
zj 208,40,28
z0 3
zj 208,52,32
zj 208,64,36
zj 204,36,28
zj 204,48,32
zn 4,1024
zj 204,60,36
zbw
s_cbranch_scc1 Lln16_zb0
Lln16_za0:
ze 5
zt 180,80,40
zl 28,0,8192
zl 32,0,8256
zt 180,92,44
zl 36,0,8320
zt 180,104,48
zj 88,76,40
zu 8
zb 244,2,15424
zb 246,2,16192
zfp 88,44
zb 240,2,15392
zb 242,2,16160
zj 88,100,48
zb 236,2,15360
zb 238,2,16128
zj 84,72,40
zn 5,2048
zfp 84,44
zj 84,96,48
Lln16_za1:
ze 9
zt 184,80,52
zl 40,0,12288
zt 184,92,56
zl 44,0,12352
zt 184,104,60
zl 48,0,12416
zj 96,76,52
v_pk_sub_u16 v12, v12, s23 clamp
zj 96,88,56
v_cmp_ne_u32_e64 s[62:63], 0, v12
zj 96,100,60
s_lshl2_add_u32 s81, s20, 0x12f00
v_mov_b32 v11, s81
zj 92,72,52
s_cmp_lg_u64 s[62:63], 0
s_cselect_b32 s81, 1, 0
zj 92,84,56
v_mov_b32 v12, s81
zj 92,96,60
ds_write_b32 v11, v12
zt 180,116,52
zu 6
z1 8,2,64
zt 180,128,56
z1 10,2,832
zt 180,140,60
z1 4,2,32
zj 88,112,52
z1 6,2,800
zj 88,124,56
zge 0,2
zj 88,136,60
ds_read_b64_tr_b16 a[2:3], v2 offset:768
zj 84,108,52
v_and_b32 v11, -16, v11
zj 84,120,56
zj 84,132,60
Lln16_za2:
ze 7
zt 188,80,28
zl 52,0,16384
zt 188,92,32
zl 56,0,16448
zt 188,104,36
zl 60,0,16512
zj 104,76,28
zj 104,88,32
zj 104,100,36
zj 100,72,28
zu 3
z1 20,2,3136
zj 100,84,32
z1 22,2,3904
zj 100,96,36
z1 16,2,3104
zt 184,116,28
z1 18,2,3872
zt 184,128,32
z1 12,2,3072
zt 184,140,36
z1 14,2,3840
zj 96,112,28
zj 96,124,32
zj 96,136,36
zj 92,108,28
zj 92,120,32
zj 92,132,36
zt 180,152,28
zt 180,164,32
zt 180,176,36
zj 88,148,28
zu 0
z1 32,2,6208
z1 34,2,6976
zj 88,160,32
z1 28,2,6176
zj 88,172,36
z1 30,2,6944
zj 84,144,28
z1 24,2,6144
zj 84,156,32
z1 26,2,6912
zj 84,168,36
Lln16_za3:
zt 192,80,40
zb1 48,0,20480
zt 192,92,44
zb1 52,0,20544
zt 192,104,48
zb1 56,0,20608
zj 112,76,40
zj 112,88,44
zj 112,100,48
zj 108,72,40
zj 108,84,44
zj 108,96,48
zt 188,116,40
zt 188,128,44
zt 188,140,48
zj 104,112,40
zj 104,124,44
zj 104,136,48
zj 100,108,40
zj 100,120,44
zj 100,132,48
zt 184,152,40
zt 184,164,44
zt 184,176,48
zj 96,148,40
zj 96,160,44
zj 96,172,48
zj 92,144,40
zj 92,156,44
zj 92,168,48
za 180,220,40
za 180,232,44
za 180,244,48
zf 88,216,40
zf 88,228,44
zf 88,240,48
zf 84,212,40
zf 84,224,44
zf 84,236,48
Lln16_za4:
ze 0
zt 196,80,52
zb1 60,0,24576
zt 196,92,56
zb1 64,0,24640
zt 196,104,60
zb1 68,0,24704
zj 120,76,52
zj 120,88,56
zj 120,100,60
zj 116,72,52
zj 116,84,56
zj 116,96,60
zt 192,116,52
zt 192,128,56
zt 192,140,60
zfp 112,52
zj 112,124,56
zj 112,136,60
zfp 108,52
zj 108,120,56
zj 108,132,60
zt 188,152,52
zt 188,164,56
zt 188,176,60
zj 104,148,52
zj 104,160,56
zj 104,172,60
zj 100,144,52
zj 100,156,56
zj 100,168,60
za 184,220,52
za 184,232,56
za 184,244,60
zf 96,216,52
zf 96,228,56
zf 96,240,60
zf 92,212,52
zf 92,224,56
zf 92,236,60
zt 180,8,52
zt 180,20,56
zt 180,32,60
zj 88,4,52
zj 88,16,56
zj 88,28,60
zj 84,0,52
zj 84,12,56
zj 84,24,60
Lln16_za5:
zaf 184,8,48
zl 28,0,28672
zaf 184,20,52
zk 180,17,2048
zaf 184,32,56
zl 32,0,28736
zz 96,4,48
zl 36,0,28800
zz 96,16,52
zz 96,28,56
zz 92,0,48
zz 92,12,52
zz 92,24,56
Lln16_za6:
zb4 188,220,48
zl 40,0,32768
zl 44,0,32832
zb4 188,232,52
zk 184,17,3072
zb4 188,244,56
ze 5
zl 48,0,32896
zaf 188,8,60
zaf 188,20,64
zat 96,13,1024
zaf 188,32,68
zba 104,216,48
zba 104,228,52
zdl 92,13
zba 104,240,56
zz 104,4,60
zz 104,16,64
zz 104,28,68
zba 100,212,48
zba 100,224,52
zk 188,17,6144
zba 100,236,56
zz 100,0,60
zz 100,12,64
zz 100,24,68
Lln16_za7:
zaf 192,152,48
zl 52,0,36864
zaf 192,164,52
zl 56,0,36928
zaf 192,176,56
zl 60,0,36992
zb4 192,220,60
zb4 192,232,64
zb4 192,244,68
zt 192,8,28
ze 3
zt 192,20,32
zt 192,32,36
zz 112,148,48
zz 112,160,52
zz 112,172,56
zba 112,216,60
zba 112,228,64
zba 112,240,68
zj 112,4,28
zj 112,16,32
zk 192,17,7168
zj 112,28,36
zz 108,144,48
zz 108,156,52
zz 108,168,56
zba 108,212,60
zba 108,224,64
zba 108,236,68
zj 108,0,28
zj 108,12,32
zat 112,13,5120
zj 108,24,36
Lln16_za8:
zaf 196,116,48
zb1 36,0,40960
zb1 40,0,41024
zaf 196,128,52
zb1 44,0,41088
zaf 196,140,56
zaf 196,152,60
zaf 196,164,64
zaf 196,176,68
za 196,220,28
za 196,232,32
zat 108,13,4096
za 196,244,36
zt 196,8,40
zt 196,20,44
ze 0
s_barrier
za7 80,11
zt 196,32,48
zl 72,18,2048
zl 76,18,38912
zz 120,112,48
za7 64,14
zl 68,14,1024
zz 120,124,52
zz 120,136,56
zz 120,148,60
zz 120,160,64
zz 120,172,68
zf 120,216,28
ze 4
v_or3_b32 v80, v80, v81, v82
v_or_b32 v80, v80, v83
zf 120,228,32
zk 196,17,10240
zf 120,240,36
v_readfirstlane_b32 s24, v80
zj 120,4,40
zj 120,16,44
zj 120,28,48
ze 1
zg 72,76
zg 73,77
zg 74,78
zz 116,108,48
zg 75,79
zg 64,84
zz 116,120,52
zg 65,85
zg 66,86
zz 116,132,56
zg 67,87
zg 68,88
zz 116,144,60
zg 69,89
zg 70,90
zz 116,156,64
zg 71,91
zq 72,73
zz 116,168,68
zc 73,74,75
zq 64,65
zf 116,212,28
zfn
zfq 72,16
zc 65,66,67
zf 116,224,32
zc 66,68,69
zc 67,70,71
zf 116,236,36
zds 64,66
zds 65,67
zj 116,0,40
zbf 64,15
zj 116,12,44
zj 116,24,48
Lln16_za9:
s_cmp_lg_u32 s24, 0
s_cbranch_scc1 Lln16_slow
zaf 200,80,48
zhy
zl 248,18,6144
zaf 200,92,52
zl 80,18,43008
zaf 200,104,56
zl 20,14,4096
zaf 200,116,60
zl 24,14,5120
zaf 200,128,64
zaf 200,140,68
zt 200,152,28
zt 200,164,32
zt 200,176,36
za 200,220,40
za 200,232,44
za 200,244,48
zt 200,8,52
zt 200,20,56
ze 0
zg 248,80
zg 249,81
zt 200,32,60
zg 250,82
zg 251,83
zz 128,76,48
zg 20,100
zz 128,88,52
zg 21,101
zz 128,100,56
zg 22,102
zz 128,112,60
zg 23,103
zz 128,124,64
zg 24,104
zz 128,136,68
zg 25,105
zj 128,148,28
zg 26,106
zj 128,160,32
zk 200,17,11264
zj 128,172,36
zg 27,107
zf 128,216,40
zq 248,249
zf 128,228,44
zc 249,250,251
zf 128,240,48
zbh 0x15000
zfq 248,16
zj 128,4,52
zq 20,21
zj 128,16,56
zc 21,22,23
zj 128,28,60
zc 22,24,25
zz 124,72,48
zc 23,26,27
zz 124,84,52
zds 20,22
zz 124,96,56
zds 21,23
zz 124,108,60
zbf 20,15
zz 124,120,64
zz 124,132,68
zj 124,144,28
zj 124,156,32
zat 128,13,9216
zj 124,168,36
zf 124,212,40
zf 124,224,44
zf 124,236,48
zj 124,0,52
zj 124,12,56
zj 124,24,60
Lln16_za10:
zaf 204,80,60
zb1 48,0,45056
zaf 204,92,64
zb1 52,0,45120
zaf 204,104,68
zb1 56,0,45184
zt 204,116,28
zt 204,128,32
zt 204,140,36
zt 204,152,40
zt 204,164,44
zat 124,13,8192
zt 204,176,48
za 204,220,52
za 204,232,56
za 204,244,60
zaf 204,8,36
zaf 204,20,40
zaf 204,32,44
zz 136,76,60
zz 136,88,64
zz 136,100,68
zj 136,112,28
zj 136,124,32
zfp 136,36
zj 136,148,40
zj 136,160,44
zk 204,17,14336
zj 136,172,48
zf 136,216,52
zf 136,228,56
zf 136,240,60
zz 136,4,36
zz 136,16,40
zz 136,28,44
zz 132,72,60
zz 132,84,64
zz 132,96,68
zj 132,108,28
zj 132,120,32
zfp 132,36
zj 132,144,40
zj 132,156,44
zj 132,168,48
zf 132,212,52
zf 132,224,56
zf 132,236,60
zz 132,0,36
zz 132,12,40
zz 132,24,44
Lln16_za11:
zt 208,80,28
zb1 60,0,49152
zt 208,92,32
zb1 64,0,49216
zt 208,104,36
zb1 68,0,49280
zt 208,116,40
zt 208,128,44
zt 208,140,48
zt 208,152,52
zt 208,164,56
zt 208,176,60
zb4 208,220,36
zb4 208,232,40
zb4 208,244,44
ze 1
zaf 208,8,48
zaf 208,20,52
zaf 208,32,56
zj 144,76,28
zj 144,88,32
zj 144,100,36
zj 144,112,40
zj 144,124,44
zj 144,136,48
zj 144,148,52
zj 144,160,56
zk 208,17,15360
zj 144,172,60
zba 144,216,36
zba 144,228,40
zba 144,240,44
zz 144,4,48
zz 144,16,52
zz 144,28,56
zj 140,72,28
zj 140,84,32
zj 140,96,36
zj 140,108,40
zj 140,120,44
zj 140,132,48
zj 140,144,52
zj 140,156,56
zat 144,13,13312
zj 140,168,60
zba 140,212,36
zba 140,224,40
zba 140,236,44
zz 140,0,48
zz 140,12,52
zz 140,24,56
Lln16_za12:
zt 212,80,40
zl 28,0,53248
zt 212,92,44
zl 32,0,53312
zt 212,104,48
zl 36,0,53376
zt 212,116,52
zt 212,128,56
zt 212,140,60
zaf 212,152,36
zaf 212,164,40
zat 140,13,12288
zaf 212,176,44
zb4 212,220,48
zb4 212,232,52
ze 0
s_barrier
zb4 212,244,56
zl 72,18,10240
zaf 212,8,60
zl 76,18,47104
zaf 212,20,64
zl 64,14,8192
zaf 212,32,68
zl 68,14,9216
zj 152,76,40
zj 152,88,44
zj 152,100,48
zj 152,112,52
zj 152,124,56
zj 152,136,60
zz 152,148,36
zz 152,160,40
zk 212,17,2048
zz 152,172,44
ze 2
zg 72,76
zg 73,77
zba 152,216,48
zg 74,78
zg 75,79
zba 152,228,52
zg 64,116
zg 65,117
zba 152,240,56
zg 66,118
zg 67,119
zz 152,4,60
ze 1
zg 68,120
zz 152,16,64
zg 69,121
zz 152,28,68
zg 70,122
zj 148,72,40
zg 71,123
zj 148,84,44
zq 72,73
zj 148,96,48
zc 73,74,75
zj 148,108,52
zbh 0x2a000
zfq 72,16
zj 148,120,56
zq 64,65
zj 148,132,60
zc 65,66,67
zz 148,144,36
zc 66,68,69
zz 148,156,40
zc 67,70,71
zz 148,168,44
zds 64,66
zba 148,212,48
zds 65,67
zba 148,224,52
zbf 64,15
zba 148,236,56
zz 148,0,60
zz 148,12,64
zz 148,24,68
Lln16_za13:
zt 216,80,52
zhy
zl 248,18,14336
zt 216,92,56
zl 80,18,51200
zt 216,104,60
zl 20,14,12288
zaf 216,116,36
zl 24,14,13312
zaf 216,128,40
zl 40,0,57344
zaf 216,140,44
zl 44,0,57408
zaf 216,152,48
zl 48,0,57472
zaf 216,164,52
zaf 216,176,56
zb4 216,220,60
zb4 216,232,64
zb4 216,244,68
zt 216,8,28
zt 216,20,32
ze 3
zg 248,80
zg 249,81
zt 216,32,36
zg 250,82
zg 251,83
zj 160,76,52
zg 20,132
zj 160,88,56
zg 21,133
zj 160,100,60
zg 22,134
zz 160,112,36
zg 23,135
zz 160,124,40
zg 24,136
zz 160,136,44
zg 25,137
zz 160,148,48
zg 26,138
zg4 160,52
zk 216,17,3072
zz 160,172,56
zg 27,139
zba 160,216,60
zq 248,249
zba 160,228,64
zc 249,250,251
zba 160,240,68
zbh 0x3f000
zfq 248,16
zj 160,4,28
zq 20,21
zj 160,16,32
zc 21,22,23
zj 160,28,36
zc 22,24,25
zj 156,72,52
zc 23,26,27
zj 156,84,56
zds 20,22
zj 156,96,60
zds 21,23
zz 156,108,36
zbf 20,15
zz 156,120,40
zz 156,132,44
zz 156,144,48
zg4 156,52
zat 160,13,1024
zz 156,168,56
zba 156,212,60
zba 156,224,64
zba 156,236,68
zj 156,0,28
zj 156,12,32
zj 156,24,36
Lln16_za14:
zaf 220,80,36
zl 52,0,61440
zaf 220,92,40
zl 56,0,61504
zaf 220,104,44
zl 60,0,61568
zaf 220,116,48
zaf 220,128,52
zaf 220,140,56
zaf 220,152,60
zaf 220,164,64
zdl 156,13
zaf 220,176,68
zdm 220,28
za 220,232,32
za 220,244,36
ze 2
zt 220,8,40
zt 220,20,44
zt 220,32,48
zz 168,76,36
zz 168,88,40
zz 168,100,44
zz 168,112,48
zz 168,124,52
zz 168,136,56
zz 168,148,60
zz 168,160,64
zk 220,17,6144
zz 168,172,68
zf 168,216,28
zf 168,228,32
zf 168,240,36
zj 168,4,40
zj 168,16,44
zj 168,28,48
zz 164,72,36
zz 164,84,40
zz 164,96,44
zz 164,108,48
zz 164,120,52
zz 164,132,56
zz 164,144,60
zz 164,156,64
zz 164,168,68
zf 164,212,28
zf 164,224,32
zf 164,236,36
zj 164,0,40
zj 164,12,44
zj 164,24,48
Lln16_za15:
zaf 224,80,48
ds_read_b128 a[36:39], v1
zaf 224,92,52
zb1 40,1,64
zaf 224,104,56
zb1 44,1,128
zaf 224,116,60
zaf 224,128,64
zaf 224,140,68
zt 224,152,28
zt 224,164,32
zt 224,176,36
za 224,220,40
za 224,232,44
za 224,244,48
zt 224,8,52
zt 224,20,56
ze 0
zt 224,32,60
zz 176,76,48
zz 176,88,52
zz 176,100,56
zz 176,112,60
zz 176,124,64
zz 176,136,68
zj 176,148,28
zj 176,160,32
zk 224,17,7168
zj 176,172,36
zf 176,216,40
zf 176,228,44
zf 176,240,48
zj 176,4,52
zj 176,16,56
zj 176,28,60
zz 172,72,48
zz 172,84,52
zz 172,96,56
zz 172,108,60
zz 172,120,64
zz 172,132,68
zj 172,144,28
zj 172,156,32
zat 176,13,5120
zj 172,168,36
zf 172,212,40
zf 172,224,44
zf 172,236,48
zj 172,0,52
zj 172,12,56
zj 172,24,60
Lln16_za16:
zaf 228,80,60
zb1 48,1,4096
zaf 228,92,64
zb1 52,1,4160
zaf 228,104,68
zb1 56,1,4224
zt 228,116,28
zt 228,128,32
zt 228,140,36
zt 228,152,40
zt 228,164,44
zat 172,13,4096
zt 228,176,48
za 228,220,52
za 228,232,56
ze 0
s_barrier
za 228,244,60
zl 72,18,2048
zaf 228,8,36
zl 76,18,38912
zaf 228,20,40
za7 64,14
zaf 228,32,44
zl 68,14,1024
zz 184,76,60
zz 184,88,64
zz 184,100,68
zj 184,112,28
zj 184,124,32
zj 184,136,36
zj 184,148,40
zj 184,160,44
zk 228,17,10240
zj 184,172,48
ze 2
zg 72,76
zg 73,77
zf 184,216,52
zg 74,78
zg 75,79
zf 184,228,56
zg 64,148
zg 65,149
zf 184,240,60
zg 66,150
zg 67,151
zz 184,4,36
ze 1
zg 68,152
zz 184,16,40
zg 69,153
zz 184,28,44
zg 70,154
zz 180,72,60
zg 71,155
zz 180,84,64
zq 72,73
zz 180,96,68
zc 73,74,75
zj 180,108,28
zbh 0x54000
zfq 72,16
zj 180,120,32
zq 64,65
zj 180,132,36
zc 65,66,67
zj 180,144,40
zc 66,68,69
zj 180,156,44
zc 67,70,71
zj 180,168,48
zds 64,66
zf 180,212,52
zds 65,67
zf 180,224,56
zbf 64,15
zf 180,236,60
zz 180,0,36
zz 180,12,40
zz 180,24,44
Lln16_za17:
zt 232,80,28
zhy
zl 248,18,6144
zt 232,92,32
zl 80,18,43008
zt 232,104,36
zl 20,14,4096
zt 232,116,40
zl 24,14,5120
zt 232,128,44
zb1 60,1,8192
zt 232,140,48
zb1 64,1,8256
zt 232,152,52
zb1 68,1,8320
zt 232,164,56
zt 232,176,60
zb4 232,220,36
v_mfma_f32_16x16x32_bf16 a[232:235], v[232:235], a[40:43], a[232:235]
zb4 232,244,44
zaf 232,8,48
zaf 232,20,52
ze 3
zg 248,80
zg 249,81
zaf 232,32,56
zg 250,82
zg 251,83
zj 192,76,28
zg 20,164
zj 192,88,32
zg 21,165
zj 192,100,36
zg 22,166
zj 192,112,40
zg 23,167
zj 192,124,44
zg 24,168
zj 192,136,48
zg 25,169
zj 192,148,52
zg 26,170
zj 192,160,56
zk 232,17,11264
zj 192,172,60
zg 27,171
zba 192,216,36
zq 248,249
zba 192,228,40
zc 249,250,251
zba 192,240,44
zbh 0x69000
zfq 248,16
zz 192,4,48
zq 20,21
zz 192,16,52
zc 21,22,23
zz 192,28,56
zc 22,24,25
zj 188,72,28
zc 23,26,27
zj 188,84,32
zds 20,22
zj 188,96,36
zds 21,23
zj 188,108,40
zbf 20,15
zj 188,120,44
zj 188,132,48
zj 188,144,52
zj 188,156,56
zat 192,13,9216
zj 188,168,60
zba 188,212,36
zba 188,224,40
zba 188,236,44
zz 188,0,48
zz 188,12,52
zz 188,24,56
Lln16_za18:
zt 236,80,40
zl 28,1,12288
zt 236,92,44
zl 32,1,12352
zt 236,104,48
zl 36,1,12416
zt 236,116,52
zt 236,128,56
zt 236,140,60
zaf 236,152,36
zaf 236,164,40
zat 188,13,8192
zaf 236,176,44
zb4 236,220,48
zb4 236,232,52
ze 0
s_barrier
zb4 236,244,56
zl 72,18,10240
zaf 236,8,60
zl 76,18,47104
zaf 236,20,64
zl 64,14,8192
zaf 236,32,68
zl 68,14,9216
zt 240,80,52
zt 240,92,56
zt 240,104,60
zaf 240,116,36
zaf 240,128,40
zaf 240,140,44
zaf 240,152,48
zaf 240,164,52
zk 236,17,14336
zaf 240,176,56
ze 2
zg 72,76
zb4 240,220,60
zg 73,77
zb4 240,232,64
zg 74,78
zb4 240,244,68
zg 75,79
zt 240,8,28
zg 64,180
zt 240,20,32
zg 65,181
zt 240,32,36
zg 66,182
zj 208,76,52
zg 67,183
zj 208,88,56
ze 1
zg 68,184
zj 208,100,60
zg 69,185
zz 208,112,36
zg 70,186
zz 208,124,40
zg 71,187
zz 208,136,44
zq 72,73
zz 208,148,48
zc 73,74,75
zz 208,160,52
zk 240,17,15360
zz 208,172,56
zbh 0x7e000
zfq 72,16
zba 208,216,60
zq 64,65
zba 208,228,64
zc 65,66,67
zba 208,240,68
zc 66,68,69
zj 208,4,28
zc 67,70,71
zj 208,16,32
zds 64,66
zj 208,28,36
zds 65,67
zj 204,72,52
zbf 64,15
zj 204,84,56
zj 204,96,60
zz 204,108,36
zz 204,120,40
zz 204,132,44
zz 204,144,48
zz 204,156,52
zat 208,13,13312
zz 204,168,56
zba 204,212,60
zba 204,224,64
zba 204,236,68
zj 204,0,28
zj 204,12,32
zj 204,24,36
zj 196,72,40
zj 196,84,44
zj 196,96,48
zj 196,108,52
zj 196,120,56
zj 196,132,60
zz 196,144,36
zz 196,156,40
zat 204,13,12288
zz 196,168,44
zba 196,212,48
zba 196,224,52
ze 0
s_barrier
zba 196,236,56
zl 248,18,14336
zz 196,0,60
zl 80,18,51200
zz 196,12,64
zl 20,14,12288
zz 196,24,68
zl 24,14,13312
zj 200,76,40
zj 200,88,44
zj 200,100,48
zj 200,112,52
zj 200,124,56
zj 200,136,60
zz 200,148,36
zz 200,160,40
zz 200,172,44
ze 1
zg 248,80
zba 200,216,48
zg 249,81
zba 200,228,52
zg 250,82
zba 200,240,56
zg 251,83
zz 200,4,60
zg 20,196
zz 200,16,64
zg 21,197
zz 200,28,68
zg 22,198
zg 23,199
zq 248,249
zc 249,250,251
zq 20,21
zc 21,22,23
zbh 0x93000
zfq 248,16
ze 0
zg 24,200
zg 25,201
zg 26,202
zg 27,203
zc 22,24,25
zc 23,26,27
zv
zds 20,22
zds 21,23
zbf 20,15
s_endpgm
Lln16_zb0:
ze 5
zt 180,80,40
zl 28,0,8192
zl 32,0,8256
zt 180,92,44
zl 36,0,8320
zt 180,104,48
zj 88,76,40
zu 8
zb 244,2,15424
zb 246,2,16192
zfp 88,44
zb 240,2,15392
zb 242,2,16160
zj 88,100,48
zb 236,2,15360
zb 238,2,16128
zj 84,72,40
zn 5,2048
zfp 84,44
zj 84,96,48
Lln16_zb1:
ze 9
zt 184,80,52
zl 40,0,12288
zt 184,92,56
zl 44,0,12352
zt 184,104,60
zl 48,0,12416
zj 96,76,52
v_pk_sub_u16 v12, v12, s23 clamp
zj 96,88,56
v_cmp_ne_u32_e64 s[62:63], 0, v12
zj 96,100,60
s_lshl2_add_u32 s81, s20, 0x12f00
v_mov_b32 v11, s81
zj 92,72,52
s_cmp_lg_u64 s[62:63], 0
s_cselect_b32 s81, 1, 0
zj 92,84,56
v_mov_b32 v12, s81
zj 92,96,60
ds_write_b32 v11, v12
zt 180,116,52
zu 6
z1 8,2,64
zt 180,128,56
z1 10,2,832
zt 180,140,60
z1 4,2,32
zj 88,112,52
z1 6,2,800
zj 88,124,56
zge 0,2
zj 88,136,60
ds_read_b64_tr_b16 a[2:3], v2 offset:768
zj 84,108,52
v_and_b32 v11, -16, v11
zj 84,120,56
zj 84,132,60
Lln16_zb2:
ze 7
zt 188,80,28
zl 52,0,16384
zt 188,92,32
zl 56,0,16448
zt 188,104,36
zl 60,0,16512
zj 104,76,28
zj 104,88,32
zj 104,100,36
zj 100,72,28
zu 3
z1 20,2,3136
zj 100,84,32
z1 22,2,3904
zj 100,96,36
z1 16,2,3104
zt 184,116,28
z1 18,2,3872
zt 184,128,32
z1 12,2,3072
zt 184,140,36
z1 14,2,3840
zj 96,112,28
zj 96,124,32
zj 96,136,36
zj 92,108,28
zj 92,120,32
zj 92,132,36
zt 180,152,28
zt 180,164,32
zt 180,176,36
zj 88,148,28
zu 0
z1 32,2,6208
z1 34,2,6976
zj 88,160,32
z1 28,2,6176
zj 88,172,36
z1 30,2,6944
zj 84,144,28
z1 24,2,6144
zj 84,156,32
z1 26,2,6912
zj 84,168,36
Lln16_zb3:
zt 192,80,40
zb1 48,0,20480
zt 192,92,44
zb1 52,0,20544
zt 192,104,48
zb1 56,0,20608
zj 112,76,40
zj 112,88,44
zj 112,100,48
zj 108,72,40
zj 108,84,44
zj 108,96,48
zt 188,116,40
zt 188,128,44
zt 188,140,48
zj 104,112,40
zj 104,124,44
zj 104,136,48
zj 100,108,40
zj 100,120,44
zj 100,132,48
zt 184,152,40
zt 184,164,44
zt 184,176,48
zj 96,148,40
zj 96,160,44
zj 96,172,48
zj 92,144,40
zj 92,156,44
zj 92,168,48
za 180,220,40
za 180,232,44
za 180,244,48
zf 88,216,40
zf 88,228,44
zf 88,240,48
zf 84,212,40
zf 84,224,44
zf 84,236,48
Lln16_zb4:
ze 0
zt 196,80,52
zb1 60,0,24576
zt 196,92,56
zb1 64,0,24640
zt 196,104,60
zb1 68,0,24704
zj 120,76,52
zj 120,88,56
zj 120,100,60
zj 116,72,52
zj 116,84,56
zj 116,96,60
zt 192,116,52
zt 192,128,56
zt 192,140,60
zfp 112,52
zj 112,124,56
zj 112,136,60
zfp 108,52
zj 108,120,56
zj 108,132,60
zt 188,152,52
zt 188,164,56
zt 188,176,60
zj 104,148,52
zj 104,160,56
zj 104,172,60
zj 100,144,52
zj 100,156,56
zj 100,168,60
za 184,220,52
za 184,232,56
za 184,244,60
zf 96,216,52
zf 96,228,56
zf 96,240,60
zf 92,212,52
zf 92,224,56
zf 92,236,60
zt 180,8,52
zt 180,20,56
zt 180,32,60
zj 88,4,52
zj 88,16,56
zj 88,28,60
zj 84,0,52
zj 84,12,56
zj 84,24,60
Lln16_zb5:
zaf 184,8,48
zl 28,0,28672
zl 32,0,28736
zaf 184,20,52
zk 180,17,2048
zaf 184,32,56
zl 36,0,28800
zz 96,4,48
zz 96,16,52
zat 88,13,1024
zz 96,28,56
zz 92,0,48
zz 92,12,52
zdl 84,13
zz 92,24,56
Lln16_zb6:
zb4 188,220,48
zl 40,0,32768
zb4 188,232,52
zk 184,17,3072
zb4 188,244,56
ze 5
zl 44,0,32832
zaf 188,8,60
zl 48,0,32896
zaf 188,20,64
zaf 188,32,68
zba 104,216,48
zba 104,228,52
zba 104,240,56
zz 104,4,60
zz 104,16,64
zz 104,28,68
zba 100,212,48
zba 100,224,52
zk 188,17,6144
zba 100,236,56
zz 100,0,60
zz 100,12,64
zz 100,24,68
Lln16_zb7:
zaf 192,152,48
zl 52,0,36864
zaf 192,164,52
zat 104,13,5120
zaf 192,176,56
zl 56,0,36928
zb4 192,220,60
zl 60,0,36992
zb4 192,232,64
zb4 192,244,68
zt 192,8,28
zt 192,20,32
ze 4
zat 100,13,4096
zt 192,32,36
zz 112,148,48
zz 112,160,52
zz 112,172,56
zba 112,216,60
zba 112,228,64
zba 112,240,68
zj 112,4,28
zj 112,16,32
zk 192,17,7168
zj 112,28,36
zz 108,144,48
zz 108,156,52
zz 108,168,56
zba 108,212,60
zba 108,224,64
zba 108,236,68
zj 108,0,28
zj 108,12,32
zj 108,24,36
Lln16_zb8:
zaf 196,116,48
zb1 36,0,40960
zb1 40,0,41024
zaf 196,128,52
zb1 44,0,41088
zaf 196,140,56
zaf 196,152,60
zaf 196,164,64
zaf 196,176,68
za 196,220,28
za 196,232,32
za 196,244,36
zt 196,8,40
zt 196,20,44
ze 1
s_barrier
za7 80,11
zt 196,32,48
zl 72,18,3072
zl 76,18,39936
zz 120,112,48
za7 64,14
zl 68,14,1024
zz 120,124,52
zz 120,136,56
zz 120,148,60
zz 120,160,64
zz 120,172,68
zf 120,216,28
ze 4
v_or3_b32 v80, v80, v81, v82
v_or_b32 v80, v80, v83
zv
v_readfirstlane_b32 s24, v80
zf 120,228,32
zk 196,17,10240
zf 120,240,36
zj 120,4,40
zj 120,16,44
zj 120,28,48
ze 1
zg 72,76
zg 73,77
zg 74,78
zz 116,108,48
zg 75,79
zg 64,92
zg 65,93
zz 116,120,52
zg 66,94
zg 67,95
zg 68,96
zz 116,132,56
zg 69,97
zg 70,98
zg 71,99
zz 116,144,60
zq 72,73
zc 73,74,75
zq 64,65
zz 116,156,64
zfn
zfq 72,16
zc 65,66,67
zz 116,168,68
zc 66,68,69
zc 67,70,71
zf 116,212,28
zds 64,66
zds 65,67
zf 116,224,32
zat 120,13,9216
zf 116,236,36
zbf 64,15
zj 116,0,40
zj 116,12,44
zj 116,24,48
Lln16_zb9:
s_cmp_lg_u32 s24, 0
s_cbranch_scc1 Lln16_slow
zaf 200,80,48
zhy
zl 248,18,7168
zaf 200,92,52
zl 80,18,44032
zaf 200,104,56
zl 20,14,4096
zaf 200,116,60
zl 24,14,5120
zaf 200,128,64
zaf 200,140,68
zt 200,152,28
zt 200,164,32
zat 116,13,8192
zt 200,176,36
za 200,220,40
za 200,232,44
za 200,244,48
zt 200,8,52
zt 200,20,56
ze 1
zg 248,80
zt 200,32,60
zg 249,81
zz 128,76,48
zg 250,82
zz 128,88,52
zg 251,83
zz 128,100,56
zg 20,108
zz 128,112,60
zg 21,109
zz 128,124,64
zg 22,110
zz 128,136,68
zg 23,111
zj 128,148,28
zg 24,112
zj 128,160,32
zk 200,17,11264
zj 128,172,36
zg 25,113
zf 128,216,40
zg 26,114
zf 128,228,44
zg 27,115
zf 128,240,48
zq 248,249
zj 128,4,52
zc 249,250,251
zj 128,16,56
zbh 0x15000
zfq 248,16
zj 128,28,60
zq 20,21
zz 124,72,48
zc 21,22,23
zz 124,84,52
zc 22,24,25
zz 124,96,56
zc 23,26,27
zz 124,108,60
zds 20,22
zz 124,120,64
zds 21,23
zz 124,132,68
zbf 20,15
zj 124,144,28
zj 124,156,32
zj 124,168,36
zf 124,212,40
zf 124,224,44
zf 124,236,48
zj 124,0,52
zj 124,12,56
zj 124,24,60
Lln16_zb10:
zaf 204,80,60
zb1 48,0,45056
zaf 204,92,64
zb1 52,0,45120
zaf 204,104,68
zb1 56,0,45184
zt 204,116,28
zt 204,128,32
zt 204,140,36
zt 204,152,40
zt 204,164,44
zt 204,176,48
za 204,220,52
za 204,232,56
za 204,244,60
zaf 204,8,36
zaf 204,20,40
zaf 204,32,44
zz 136,76,60
zz 136,88,64
zz 136,100,68
zj 136,112,28
zj 136,124,32
zfp 136,36
zj 136,148,40
zj 136,160,44
zk 204,17,14336
zj 136,172,48
zf 136,216,52
zf 136,228,56
zf 136,240,60
zz 136,4,36
zz 136,16,40
zz 136,28,44
zz 132,72,60
zz 132,84,64
zz 132,96,68
zj 132,108,28
zj 132,120,32
zfp 132,36
zj 132,144,40
zj 132,156,44
zat 136,13,13312
zj 132,168,48
zf 132,212,52
zf 132,224,56
zf 132,236,60
zz 132,0,36
zz 132,12,40
zz 132,24,44
Lln16_zb11:
zt 208,80,28
zb1 60,0,49152
zt 208,92,32
zb1 64,0,49216
zt 208,104,36
zb1 68,0,49280
zt 208,116,40
zt 208,128,44
zt 208,140,48
zt 208,152,52
zt 208,164,56
zat 132,13,12288
zt 208,176,60
zb4 208,220,36
zb4 208,232,40
zb4 208,244,44
ze 2
zaf 208,8,48
zaf 208,20,52
zaf 208,32,56
zj 144,76,28
zj 144,88,32
zj 144,100,36
zj 144,112,40
zj 144,124,44
zj 144,136,48
zj 144,148,52
zj 144,160,56
zk 208,17,15360
zj 144,172,60
zba 144,216,36
zba 144,228,40
zba 144,240,44
zz 144,4,48
zz 144,16,52
zz 144,28,56
zj 140,72,28
zj 140,84,32
zj 140,96,36
zj 140,108,40
zj 140,120,44
zj 140,132,48
zj 140,144,52
zj 140,156,56
zj 140,168,60
zba 140,212,36
zba 140,224,40
zba 140,236,44
zz 140,0,48
zz 140,12,52
zz 140,24,56
Lln16_zb12:
zt 212,80,40
zl 28,0,53248
zt 212,92,44
zl 32,0,53312
zt 212,104,48
zl 36,0,53376
zt 212,116,52
zt 212,128,56
zt 212,140,60
zaf 212,152,36
zaf 212,164,40
zaf 212,176,44
zb4 212,220,48
zb4 212,232,52
ze 2
s_barrier
zl 72,18,11264
zb4 212,244,56
zl 76,18,48128
zl 64,14,8192
zaf 212,8,60
zl 68,14,9216
zaf 212,20,64
zaf 212,32,68
zj 152,76,40
zj 152,88,44
zj 152,100,48
zj 152,112,52
zj 152,124,56
zj 152,136,60
zz 152,148,36
zz 152,160,40
zk 212,17,2048
zz 152,172,44
ze 1
zg 72,76
zg 73,77
zba 152,216,48
zg 74,78
zg 75,79
zba 152,228,52
zg 64,124
zg 65,125
zba 152,240,56
zg 66,126
zg 67,127
zz 152,4,60
zg 68,128
zg 69,129
zz 152,16,64
zg 70,130
zg 71,131
zz 152,28,68
zq 72,73
zc 73,74,75
zj 148,72,40
zbh 0x2a000
zfq 72,16
zq 64,65
zj 148,84,44
zc 65,66,67
zj 148,96,48
zc 66,68,69
zj 148,108,52
zc 67,70,71
zj 148,120,56
zds 64,66
zj 148,132,60
zds 65,67
zz 148,144,36
zbf 64,15
zz 148,156,40
zat 152,13,1024
zz 148,168,44
zba 148,212,48
zba 148,224,52
zba 148,236,56
zz 148,0,60
zz 148,12,64
zz 148,24,68
Lln16_zb13:
zt 216,80,52
zhy
zl 248,18,15360
zt 216,92,56
zl 80,18,52224
zt 216,104,60
zl 20,14,12288
zaf 216,116,36
zl 24,14,13312
zaf 216,128,40
zl 40,0,57344
zaf 216,140,44
zl 44,0,57408
zaf 216,152,48
zl 48,0,57472
zaf 216,164,52
zdl 148,13
zaf 216,176,56
zb4 216,220,60
zb4 216,232,64
zb4 216,244,68
zt 216,8,28
zt 216,20,32
ze 4
zg 248,80
zt 216,32,36
zg 249,81
zj 160,76,52
zg 250,82
zj 160,88,56
zg 251,83
zj 160,100,60
zg 20,140
zz 160,112,36
zg 21,141
zz 160,124,40
zg 22,142
zz 160,136,44
zg 23,143
zz 160,148,48
zg 24,144
zg4 160,52
zk 216,17,3072
zz 160,172,56
zg 25,145
zba 160,216,60
zg 26,146
zba 160,228,64
zg 27,147
zba 160,240,68
zq 248,249
zj 160,4,28
zc 249,250,251
zj 160,16,32
zbh 0x3f000
zfq 248,16
zj 160,28,36
zq 20,21
zj 156,72,52
zc 21,22,23
zj 156,84,56
zc 22,24,25
zj 156,96,60
zc 23,26,27
zz 156,108,36
zds 20,22
zz 156,120,40
zds 21,23
zz 156,132,44
zbf 20,15
zz 156,144,48
zg4 156,52
zz 156,168,56
zba 156,212,60
zba 156,224,64
zba 156,236,68
zj 156,0,28
zj 156,12,32
zj 156,24,36
Lln16_zb14:
zaf 220,80,36
zl 52,0,61440
zaf 220,92,40
zl 56,0,61504
zaf 220,104,44
zl 60,0,61568
zaf 220,116,48
zaf 220,128,52
zaf 220,140,56
zaf 220,152,60
zaf 220,164,64
zaf 220,176,68
zdm 220,28
za 220,232,32
za 220,244,36
ze 1
zt 220,8,40
zt 220,20,44
zt 220,32,48
zz 168,76,36
zz 168,88,40
zz 168,100,44
zz 168,112,48
zz 168,124,52
zz 168,136,56
zz 168,148,60
zz 168,160,64
zk 220,17,6144
zz 168,172,68
zf 168,216,28
zf 168,228,32
zf 168,240,36
zj 168,4,40
zj 168,16,44
zj 168,28,48
zz 164,72,36
zz 164,84,40
zz 164,96,44
zz 164,108,48
zz 164,120,52
zz 164,132,56
zz 164,144,60
zz 164,156,64
zat 168,13,5120
zz 164,168,68
zf 164,212,28
zf 164,224,32
zf 164,236,36
zj 164,0,40
zj 164,12,44
zj 164,24,48
Lln16_zb15:
zaf 224,80,48
ds_read_b128 a[36:39], v1
zaf 224,92,52
zb1 40,1,64
zaf 224,104,56
zb1 44,1,128
zaf 224,116,60
zaf 224,128,64
zaf 224,140,68
zt 224,152,28
zt 224,164,32
zat 164,13,4096
zt 224,176,36
za 224,220,40
za 224,232,44
za 224,244,48
zt 224,8,52
zt 224,20,56
ze 1
zt 224,32,60
zz 176,76,48
zz 176,88,52
zz 176,100,56
zz 176,112,60
zz 176,124,64
zz 176,136,68
zj 176,148,28
zj 176,160,32
zk 224,17,7168
zj 176,172,36
zf 176,216,40
zf 176,228,44
zf 176,240,48
zj 176,4,52
zj 176,16,56
zj 176,28,60
zz 172,72,48
zz 172,84,52
zz 172,96,56
zz 172,108,60
zz 172,120,64
zz 172,132,68
zj 172,144,28
zj 172,156,32
zj 172,168,36
zf 172,212,40
zf 172,224,44
zf 172,236,48
zj 172,0,52
zj 172,12,56
zj 172,24,60
Lln16_zb16:
zaf 228,80,60
zb1 48,1,4096
zaf 228,92,64
zb1 52,1,4160
zaf 228,104,68
zb1 56,1,4224
zt 228,116,28
zt 228,128,32
zt 228,140,36
zt 228,152,40
zt 228,164,44
zt 228,176,48
za 228,220,52
za 228,232,56
ze 2
s_barrier
zl 72,18,3072
za 228,244,60
zl 76,18,39936
za7 64,14
zaf 228,8,36
zl 68,14,1024
zaf 228,20,40
zaf 228,32,44
zz 184,76,60
zz 184,88,64
zz 184,100,68
zj 184,112,28
zj 184,124,32
zj 184,136,36
zj 184,148,40
zj 184,160,44
zk 228,17,10240
zj 184,172,48
ze 1
zg 72,76
zg 73,77
zf 184,216,52
zg 74,78
zg 75,79
zf 184,228,56
zg 64,156
zg 65,157
zf 184,240,60
zg 66,158
zg 67,159
zz 184,4,36
zg 68,160
zg 69,161
zz 184,16,40
zg 70,162
zg 71,163
zz 184,28,44
zq 72,73
zc 73,74,75
zz 180,72,60
zbh 0x54000
zfq 72,16
zq 64,65
zz 180,84,64
zc 65,66,67
zz 180,96,68
zc 66,68,69
zj 180,108,28
zc 67,70,71
zj 180,120,32
zds 64,66
zj 180,132,36
zds 65,67
zj 180,144,40
zbf 64,15
zj 180,156,44
zat 184,13,9216
zj 180,168,48
zf 180,212,52
zf 180,224,56
zf 180,236,60
zz 180,0,36
zz 180,12,40
zz 180,24,44
Lln16_zb17:
zt 232,80,28
zhy
zl 248,18,7168
zt 232,92,32
zl 80,18,44032
zt 232,104,36
zl 20,14,4096
zt 232,116,40
zl 24,14,5120
zt 232,128,44
zb1 60,1,8192
zt 232,140,48
zb1 64,1,8256
zt 232,152,52
zb1 68,1,8320
zt 232,164,56
zat 180,13,8192
zt 232,176,60
zb4 232,220,36
v_mfma_f32_16x16x32_bf16 a[232:235], v[232:235], a[40:43], a[232:235]
zb4 232,244,44
zaf 232,8,48
zaf 232,20,52
ze 4
zg 248,80
zaf 232,32,56
zg 249,81
zj 192,76,28
zg 250,82
zj 192,88,32
zg 251,83
zj 192,100,36
zg 20,172
zj 192,112,40
zg 21,173
zj 192,124,44
zg 22,174
zj 192,136,48
zg 23,175
zj 192,148,52
zg 24,176
zj 192,160,56
zk 232,17,11264
zj 192,172,60
zg 25,177
zba 192,216,36
zg 26,178
zba 192,228,40
zg 27,179
zba 192,240,44
zq 248,249
zz 192,4,48
zc 249,250,251
zz 192,16,52
zbh 0x69000
zfq 248,16
zz 192,28,56
zq 20,21
zj 188,72,28
zc 21,22,23
zj 188,84,32
zc 22,24,25
zj 188,96,36
zc 23,26,27
zj 188,108,40
zds 20,22
zj 188,120,44
zds 21,23
zj 188,132,48
zbf 20,15
zj 188,144,52
zj 188,156,56
zj 188,168,60
zba 188,212,36
zba 188,224,40
zba 188,236,44
zz 188,0,48
zz 188,12,52
zz 188,24,56
Lln16_zb18:
zt 236,80,40
zl 28,1,12288
zt 236,92,44
zl 32,1,12352
zt 236,104,48
zl 36,1,12416
zt 236,116,52
zt 236,128,56
zt 236,140,60
zaf 236,152,36
zaf 236,164,40
zaf 236,176,44
zb4 236,220,48
zb4 236,232,52
ze 2
s_barrier
zb4 236,244,56
zl 72,18,11264
zaf 236,8,60
zl 76,18,48128
zaf 236,20,64
zl 64,14,8192
zaf 236,32,68
zl 68,14,9216
zj 200,76,40
zj 200,88,44
zj 200,100,48
zj 200,112,52
zj 200,124,56
zj 200,136,60
zz 200,148,36
zz 200,160,40
zk 236,17,14336
zz 200,172,44
ze 2
zg 72,76
zba 200,216,48
zg 73,77
zba 200,228,52
zg 74,78
zba 200,240,56
zg 75,79
zz 200,4,60
zg 64,188
zz 200,16,64
zg 65,189
zz 200,28,68
zg 66,190
zj 196,72,40
zg 67,191
zj 196,84,44
ze 1
zg 68,192
zj 196,96,48
zg 69,193
zj 196,108,52
zg 70,194
zj 196,120,56
zg 71,195
zj 196,132,60
zq 72,73
zz 196,144,36
zc 73,74,75
zz 196,156,40
zat 200,13,13312
zz 196,168,44
zbh 0x7e000
zfq 72,16
zba 196,212,48
zq 64,65
zba 196,224,52
zc 65,66,67
zba 196,236,56
zc 66,68,69
zz 196,0,60
zc 67,70,71
zz 196,12,64
zds 64,66
zz 196,24,68
zds 65,67
zt 240,80,52
zbf 64,15
zt 240,92,56
zt 240,104,60
zaf 240,116,36
zaf 240,128,40
zaf 240,140,44
zaf 240,152,48
zaf 240,164,52
zat 196,13,12288
zaf 240,176,56
zb4 240,220,60
zb4 240,232,64
zb4 240,244,68
zt 240,8,28
zt 240,20,32
zt 240,32,36
zj 204,72,52
zj 204,84,56
zj 204,96,60
zz 204,108,36
zz 204,120,40
zz 204,132,44
zz 204,144,48
zz 204,156,52
zk 240,17,15360
zz 204,168,56
zba 204,212,60
zba 204,224,64
ze 0
s_barrier
zba 204,236,68
zl 248,18,15360
zj 204,0,28
zl 80,18,52224
zj 204,12,32
zl 20,14,12288
zj 204,24,36
zl 24,14,13312
zj 208,76,52
zj 208,88,56
zj 208,100,60
zz 208,112,36
zz 208,124,40
zz 208,136,44
zz 208,148,48
zz 208,160,52
zz 208,172,56
ze 1
zg 248,80
zba 208,216,60
zg 249,81
zba 208,228,64
zg 250,82
zba 208,240,68
zg 251,83
zj 208,4,28
zg 20,204
zj 208,16,32
zg 21,205
zj 208,28,36
zg 22,206
zg 23,207
zq 248,249
zc 249,250,251
zq 20,21
zc 21,22,23
zbh 0x93000
zfq 248,16
ze 0
zg 24,208
zg 25,209
zg 26,210
zg 27,211
zc 22,24,25
zc 23,26,27
zv
zds 20,22
zds 21,23
zbf 20,15
s_endpgm
Lln16_q1:
zu 11
s_barrier
zl 64,0,12288
zl 68,0,16384
zl 72,0,20480
zl 20,0,24576
zl 24,0,28672
zl 80,0,32768
s_add_u32 s97, s21, 9
zdn 0xdf
zbt 0xa800
zdv 0xb000
zv
zae 6
z6 0x2400
zfj 0x16800
z0 3
zu 10
z1 8,2,64
z1 10,2,832
z1 4,2,32
z1 6,2,800
zge 0,2
ds_read_b64_tr_b16 a[2:3], v2 offset:768
Lln16_h1_0:
ze 4
zdo 180,8,64
zl 52,0,12352
zl 56,0,16448
ze 4
zbx 88,4,64
zl 60,0,20544
ze 3
zbx 84,0,64
zn 4,1024
zdo 184,8,68
zbx 96,4,68
zbx 92,0,68
zdo 188,8,72
zn 5,2048
zbx 104,4,72
zbx 100,0,72
zu 9
z1 20,2,3136
z1 22,2,3904
Lln16_h1_1:
zdo 192,8,20
z6 0x3000
zl 28,0,24640
zl 32,0,28736
zbx 112,4,20
zfj 0x18000
zl 36,0,32832
zbx 108,0,20
z1 16,2,3104
zdo 196,8,24
z1 18,2,3872
zbx 120,4,24
z1 12,2,3072
zbx 116,0,24
z1 14,2,3840
zdo 200,8,80
z0 3
zbx 128,4,80
zbx 124,0,80
Lln16_h1_2:
ze 7
zt 180,20,52
ze 2
zl 40,0,12416
zl 44,0,16512
zj 88,16,52
zl 48,0,20608
ze 3
zj 84,12,52
zn 4,1024
zt 184,20,56
zj 96,16,56
zj 92,12,56
zt 188,20,60
zn 5,2048
zj 104,16,60
zj 100,12,60
zu 9
z1 32,2,6208
z1 34,2,6976
Lln16_h1_3:
zt 192,20,28
z6 0x3c00
zl 52,0,24704
zl 56,0,28800
zj 112,16,28
zfj 0x19800
zl 60,0,32896
zj 108,12,28
z1 28,2,6176
zt 196,20,32
z1 30,2,6944
zj 120,16,32
z1 24,2,6144
zj 116,12,32
z1 26,2,6912
zt 200,20,36
z0 3
zj 128,16,36
zj 124,12,36
Lln16_h1_4:
ze 7
zt 180,32,40
ze 2
zn 4,1024
zj 88,28,40
ze 0
zj 84,24,40
zt 184,32,44
zj 96,28,44
zj 92,24,44
zt 188,32,48
zn 5,2048
zj 104,28,48
zu 9
s_barrier
zl 28,0,36864
zl 32,0,36928
zl 36,0,36992
zj 100,24,48
Lln16_h1_5:
zt 192,32,52
s_add_u32 s97, s21, 10
zl 40,0,40960
zj 112,28,52
zdn 0xdf
zl 44,0,41024
zj 108,24,52
zbt 0xa800
zl 48,0,41088
zt 196,32,56
zdv 0xc000
zv
zae 6
zj 120,28,56
zj 116,24,56
zt 200,32,60
zj 128,28,60
zj 124,24,60
Lln16_h1_6:
ze 3
zdo 204,8,28
s_add_u32 s97, s21, 11
zl 52,0,45056
zt 204,20,32
zdn 0xdf
zl 56,0,45120
zt 204,32,36
zbt 0xa800
zl 60,0,45184
zbx 136,4,28
zdv 0xd000
zv
zae 6
zj 136,16,32
s_add_u32 s97, s21, 12
zdn 0xdf
zj 136,28,36
zbt 0xa800
zdv 0xe000
zbx 132,0,28
zj 132,12,32
zae 6
zj 132,24,36
Lln16_h1_7:
ze 3
zdo 208,8,40
s_add_u32 s97, s21, 13
zl 28,0,16384
zt 208,20,44
zdn 0xdf
zl 32,0,20480
zt 208,32,48
zbt 0xa800
zl 36,0,24576
zbx 144,4,40
zdv 0xf000
zj 144,16,44
zae 6
zj 144,28,48
zbx 140,0,40
zj 140,12,44
zj 140,24,48
zu 10
z1 44,2,9280
z1 46,2,10048
Lln16_h1_8:
ze 5
zdo 212,8,52
s_add_u32 s97, s21, 14
zl 40,0,28672
zl 44,0,32768
zt 212,20,56
zdn 0xdf
zl 48,0,36864
z1 40,2,9248
zt 212,32,60
zbt 0xa800
z1 42,2,10016
z1 36,2,9216
zbx 152,4,52
zdv 0x10000
z1 38,2,9984
zj 152,16,56
zae 6
zj 152,28,60
s_add_u32 s97, s21, 15
zdn 0xdf
zbx 148,0,52
zbt 0xa800
zdv 0x11000
zj 148,12,56
zae 6
zj 148,24,60
Lln16_h1_9:
ze 7
zt 180,44,28
s_add_u32 s97, s21, 16
zl 52,0,16448
ze 3
zj 88,40,28
zdn 0xdf
zl 56,0,20544
ze 2
zj 84,36,28
zbt 0xa800
zl 60,0,24640
zt 184,44,32
zdv 0x12000
zj 96,40,32
zae 6
zj 92,36,32
zt 188,44,36
zj 104,40,36
zdp 100,36
zu 10
z1 56,2,12352
z1 58,2,13120
Lln16_h1_10:
zt 192,44,40
s_add_u32 s97, s21, 17
zl 28,0,28736
zl 32,0,32832
zdp 112,40
zdn 0xdf
zl 36,0,36928
z1 52,2,12320
zj 108,36,40
zbt 0xa800
z1 54,2,13088
z1 48,2,12288
zga 196,44
zdv 0x13000
z1 50,2,13056
zj 120,40,44
zae 6
zj 116,36,44
s_sub_u32 s97, s21, 2
zdn 0xdf
zt 200,44,48
zbt 0xa800
s_add_u32 m0, s35, 0
zj 128,40,48
zae 6
zj 124,36,48
Lln16_h1_11:
ze 7
zt 180,56,52
s_sub_u32 s97, s21, 1
zl 40,0,16512
ze 3
zdp 88,52
zdn 0xdf
zl 44,0,20608
ze 2
zj 84,48,52
zbt 0xa800
zl 48,0,24704
zga 184,56
zdv 0x1000
zj 96,52,56
zae 6
zj 92,48,56
zt 188,56,60
zj 104,52,60
zj 100,48,60
zu 10
z1 68,2,15424
z1 70,2,16192
Lln16_h1_12:
zt 192,56,28
s_add_u32 s97, s21, 0
zl 52,0,28800
zl 56,0,32896
zj 112,52,28
zdn 0xdf
zl 60,0,36992
z1 64,2,15392
zj 108,48,28
zbt 0xa800
z1 66,2,16160
z1 60,2,15360
zt 196,56,32
zdv 0x2000
z1 62,2,16128
zj 120,52,32
zae 6
zj 116,48,32
zcg
zhx 0x36000
zt 200,56,36
zj 128,52,36
z0 3
zj 124,48,36
Lln16_h1_13:
ze 7
zt 180,68,40
ze 2
zl 28,0,40960
zj 88,64,40
ze 1
zl 32,0,41024
zj 84,60,40
zl 36,0,41088
zt 184,68,44
zj 96,64,44
zn 4,1024
zj 92,60,44
zt 188,68,48
zj 104,64,48
zj 100,60,48
Lln16_h1_14:
zt 192,68,52
zl 40,0,45056
zj 112,64,52
zl 44,0,45120
zj 108,60,52
zl 48,0,45184
zt 196,68,56
zj 120,64,56
zn 5,2048
zj 116,60,56
zt 200,68,60
zj 128,64,60
zdp 124,60
Lln16_h1_15:
ze 3
zt 204,44,28
z6 0xc00
zhx 0x37800
zt 204,56,32
zt 204,68,36
zj 136,40,28
zj 136,52,32
z0 3
zj 136,64,36
zj 132,36,28
zj 132,48,32
zu 11
s_barrier
zl 52,0,49152
zl 56,0,49216
zl 60,0,49280
zj 132,60,36
Lln16_h1_16:
ze 3
zt 208,44,40
zl 28,0,53248
zt 208,56,44
zl 32,0,53312
zt 208,68,48
zl 36,0,53376
zdp 144,40
zj 144,52,44
zn 4,1024
zj 144,64,48
zj 140,36,40
zj 140,48,44
zj 140,60,48
Lln16_h1_17:
ze 3
zdo 216,8,52
zl 40,0,57344
zt 216,20,56
zl 44,0,57408
zt 216,32,60
zl 48,0,57472
zbx 160,4,52
zj 160,16,56
zn 5,2048
zj 160,28,60
z6 0x1800
zhx 0x39000
zbx 156,0,52
zj 156,12,56
zj 156,24,60
zt 212,44,52
zga 212,56
zt 212,68,60
zj 152,40,52
zj 152,52,56
z0 3
zj 152,64,60
zj 148,36,52
zj 148,48,56
zdp 148,60
Lln16_h1_18:
ze 0
zdo 220,8,28
zl 52,0,61440
zt 220,20,32
zl 56,0,61504
zt 220,32,36
zl 60,0,61568
zbx 168,4,28
zj 168,16,32
zn 4,1024
zj 168,28,36
zbx 164,0,28
zj 164,12,32
zj 164,24,36
zt 216,44,28
zt 216,56,32
zt 216,68,36
zj 160,40,28
zj 160,52,32
zn 5,2048
zj 160,64,36
zj 156,36,28
zj 156,48,32
zj 156,60,36
Lln16_h1_19:
zdo 224,8,40
z6 0x2400
s_add_u32 s92, s65, 0
zt 224,20,44
zt 224,32,48
zbx 176,4,40
zj 176,16,44
z0 3
zj 176,28,48
zbx 172,0,40
zj 172,12,44
zj 172,24,48
zt 220,44,40
zt 220,56,44
zt 220,68,48
zdp 168,40
zj 168,52,44
zn 4,1024
zj 168,64,48
zj 164,36,40
zj 164,48,44
zj 164,60,48
Lln16_h1_20:
ze 0
zdo 228,8,52
zt 228,20,56
zt 228,32,60
zbx 184,4,52
zj 184,16,56
zn 5,2048
zj 184,28,60
z6 0x3000
zc4 0x1800
zbx 180,0,52
zj 180,12,56
zu 12
s_barrier
za7 28,1
zj 180,24,60
zl 32,1,64
zl 36,1,128
zt 224,44,52
zl 40,1,4096
zl 44,1,4160
zga 224,56
zl 48,1,4224
zt 224,68,60
z0 3
zj 176,40,52
zj 176,52,56
zj 176,64,60
zn 4,1024
zj 172,36,52
zj 172,48,56
zdp 172,60
zu 11
z1 80,2,64
z1 82,2,832
Lln16_h1_21:
ze 5
zdo 232,8,28
zl 52,1,8192
zl 56,1,8256
zt 232,20,32
zl 60,1,8320
z1 76,2,32
zt 232,32,36
z1 78,2,800
zge 72,2
zbx 192,4,28
z1 74,2,768
zn 5,2048
zj 192,16,32
z6 0x3c00
zc4 0x3000
zj 192,28,36
zbx 188,0,28
z0 3
zj 188,12,32
zj 188,24,36
zt 228,44,28
zt 228,56,32
zt 228,68,36
zn 4,1024
zj 184,40,28
zj 184,52,32
zu 11
z1 92,2,3136
z1 94,2,3904
zj 184,64,36
z1 88,2,3104
z1 90,2,3872
zj 180,36,28
z1 84,2,3072
z1 86,2,3840
zj 180,48,32
zn 5,2048
zj 180,60,36
Lln16_h1_22:
ze 6
zdo 236,8,40
zcg
zl 28,0,40960
zt 236,20,44
zc4 0x16800
zl 32,0,41024
zt 236,32,48
zl 36,0,41088
zbx 200,4,40
z0 3
zj 200,16,44
zj 200,28,48
zbx 196,0,40
zj 196,12,44
zj 196,24,48
zu 10
z1 104,2,6208
z1 106,2,6976
zt 232,44,40
z1 100,2,6176
zt 232,56,44
z1 102,2,6944
zt 232,68,48
z1 96,2,6144
zdp 192,40
z1 98,2,6912
zj 192,52,44
zn 4,1024
zj 192,64,48
zn 5,2048
zj 188,36,40
zj 188,48,44
zj 188,60,48
Lln16_h1_23:
zdo 240,8,52
z6 0xc00
zl 40,0,45056
zl 44,0,45120
zt 240,20,56
zc4 0x18000
zl 48,0,45184
ze 5
z0 3
zt 240,32,60
zbx 208,4,52
zj 208,16,56
zu 10
z1 116,2,9280
z1 118,2,10048
zj 208,28,60
z1 112,2,9248
zbx 204,0,52
z1 114,2,10016
zj 204,12,56
z1 108,2,9216
zj 204,24,60
z1 110,2,9984
zt 236,44,52
zn 4,1024
zga 236,56
zn 5,2048
zt 236,68,60
z6 0x1800
zc4 0x19800
zj 200,40,52
zj 200,52,56
zj 200,64,60
zj 196,36,52
ze 3
z0 3
zj 196,48,56
zdp 196,60
zu 10
z1 128,2,12352
z1 130,2,13120
Lln16_h1_24:
zt 212,80,28
zl 52,0,49152
zl 56,0,49216
zt 212,92,32
zl 60,0,49280
z1 124,2,12320
zt 212,104,36
z1 126,2,13088
z1 120,2,12288
zj 152,76,28
z1 122,2,13056
zj 152,88,32
zn 4,1024
zj 152,100,36
zj 148,72,28
zj 148,84,32
zn 5,2048
zj 148,96,36
Lln16_h1_25:
zt 216,80,40
z6 0x2400
zl 28,0,53248
zl 32,0,53312
zt 216,92,44
zc4 0x2d000
zl 36,0,53376
zt 216,104,48
zj 160,76,40
ze 3
z0 3
zj 160,88,44
zu 10
z1 140,2,15424
z1 142,2,16192
zj 160,100,48
z1 136,2,15392
z1 138,2,16160
zj 156,72,40
z1 132,2,15360
z1 134,2,16128
zj 156,84,44
zj 156,96,48
zn 4,1024
Lln16_h1_26:
zt 220,80,52
zl 40,0,57344
zt 220,92,56
zl 44,0,57408
zt 220,104,60
zl 48,0,57472
zj 168,76,52
zj 168,88,56
zn 5,2048
zj 168,100,60
zj 164,72,52
zj 164,84,56
zj 164,96,60
zu 9
z1 152,2,64
z1 154,2,832
Lln16_h1_27:
ze 5
zt 224,80,28
z6 0x3000
zl 52,0,61440
zl 56,0,61504
zt 224,92,32
zc4 0x2e800
zl 60,0,61568
z1 148,2,32
zt 224,104,36
z1 150,2,800
zge 144,2
zj 176,76,28
z1 146,2,768
zj 176,88,32
z0 3
zj 176,100,36
zn 4,1024
zj 172,72,28
zj 172,84,32
zj 172,96,36
Lln16_h1_28:
ze 7
zt 228,80,40
za7 28,1
zl 32,1,64
zt 228,92,44
zl 36,1,128
zn 5,2048
zt 228,104,48
z6 0x3c00
zc4 0x30000
zj 184,76,40
zj 184,88,44
zu 9
z1 164,2,3136
z1 166,2,3904
zj 184,100,48
z1 160,2,3104
z1 162,2,3872
zj 180,72,40
z1 156,2,3072
z1 158,2,3840
zj 180,84,44
z0 3
zj 180,96,48
Lln16_h1_29:
ze 9
zt 232,80,52
zl 40,1,4096
zl 44,1,4160
zt 232,92,56
zl 48,1,4224
zt 232,104,60
zn 4,1024
zj 192,76,52
zj 192,88,56
zj 192,100,60
zj 188,72,52
zj 188,84,56
zn 5,2048
zj 188,96,60
zu 9
z1 176,2,6208
z1 178,2,6976
Lln16_h1_30:
ze 5
zt 236,80,28
zcg
zl 52,1,12288
zl 56,1,12352
zt 236,92,32
zc4 0x43800
zl 60,1,12416
z1 172,2,6176
zt 236,104,36
z1 174,2,6944
z1 168,2,6144
zj 200,76,28
z1 170,2,6912
zj 200,88,32
z0 3
zj 200,100,36
zj 196,72,28
zj 196,84,32
zj 196,96,36
zn 4,1024
Lln16_h1_31:
ze 7
zt 240,80,40
v_lshl_add_u32 v9, s66, 2, v7
zbv 10,9
zhu 9
zt 240,92,44
zhv 9
zg1 9,8
v_add3_u32 v0, v9, v10, s68
zt 240,104,48
v_add_u32 v1, 0x10000, v0
zj 208,76,40
za7 28,0
zl 32,0,64
zl 36,0,128
zj 208,88,44
zu 8
zb 220,2,9280
zb 222,2,10048
zj 208,100,48
zb 216,2,9248
zb 218,2,10016
zj 204,72,40
zb 212,2,9216
zb 214,2,9984
zj 204,84,44
zn 5,2048
zj 204,96,48
Lln16_h1_32:
ze 9
zt 240,44,52
z6 0xc00
zl 40,0,4096
zga 240,56
zc4 0x45000
zl 44,0,4160
zt 240,68,60
zl 48,0,4224
zj 208,40,52
z0 3
zj 208,52,56
zj 208,64,60
zn 4,1024
zj 204,36,52
zj 204,48,56
zdp 204,60
s_branch Lln16_a0
Lc0:
s_cmp_ge_u32 s81, 4
s_cbranch_scc1 Lc1
s_sub_u32 s82, s81, 0
s_mov_b32 s22, 32
s_mov_b32 s21, 0
s_mov_b32 s85, 8
s_mov_b32 s84, Lf8_start-Lpc0
s_cmp_ge_u32 s82, 2
s_cselect_b32 s21, -4, s21
s_cselect_b32 s85, 10, s85
s_cselect_b32 s84, Lf10_start-Lpc0, s84
s_cmp_ge_u32 s82, 3
s_cselect_b32 s21, -7, s21
s_cselect_b32 s85, 11, s85
s_cselect_b32 s84, Lf11_start-Lpc0, s84
s_branch Ldec
Lc1:
s_cmp_ge_u32 s81, 31
s_cbranch_scc1 Lc2
s_sub_u32 s82, s81, 4
s_mov_b32 s22, 16
s_mov_b32 s21, 0
s_mov_b32 s85, 5
s_mov_b32 s84, Lf5_start-Lpc0
s_cmp_ge_u32 s82, 4
s_cselect_b32 s21, -12, s21
s_cselect_b32 s85, 8, s85
s_cselect_b32 s84, Lf8_start-Lpc0, s84
s_cmp_ge_u32 s82, 5
s_cselect_b32 s21, 0xffffffef, s21
s_cselect_b32 s85, 9, s85
s_cselect_b32 s84, Lf9_start-Lpc0, s84
s_branch Ldec
Lc2:
s_cmp_ge_u32 s81, 48
s_cbranch_scc1 Lc3
s_sub_u32 s82, s81, 31
s_mov_b32 s22, 32
s_mov_b32 s21, 37
s_mov_b32 s85, 11
s_mov_b32 s84, Lf11_start-Lpc0
s_branch Ldec
Lc3:
s_cmp_ge_u32 s81, 70
s_cbranch_scc1 Lc4
s_sub_u32 s82, s81, 48
s_mul_i32 s83, s82, 0x8000
s_lshr_b32 s83, s83, 16
s_mul_i32 s84, s83, 2
s_sub_u32 s82, s82, s84
s_add_u32 s83, s83, 3
s_lshl_b32 s22, s83, 4
s_mov_b32 s21, 16
s_mov_b32 s85, 9
s_mov_b32 s84, Lf9_start-Lpc0
s_cmp_ge_u32 s82, 1
s_cselect_b32 s21, 15, s21
s_cselect_b32 s85, 10, s85
s_cselect_b32 s84, Lf10_start-Lpc0, s84
s_branch Ldec
Lc4:
s_cmp_ge_u32 s81, 92
s_cbranch_scc1 Lc5
s_sub_u32 s82, s81, 0x46
s_mul_i32 s83, s82, 0x8000
s_lshr_b32 s83, s83, 16
s_mul_i32 s84, s83, 2
s_sub_u32 s82, s82, s84
s_add_u32 s83, s83, 3
s_lshl_b32 s22, s83, 4
s_mov_b32 s21, 0
s_mov_b32 s85, 8
s_mov_b32 s84, Lf8_start-Lpc0
s_branch Ldec
Lc5:
s_sub_u32 s82, s81, 0x5c
s_mov_b32 s22, 0
s_mov_b32 s21, 0
s_mov_b32 s85, 3
s_mov_b32 s84, Lf5_start-Lpc0
s_cmp_ge_u32 s82, 4
s_cselect_b32 s21, -4, s21
s_cselect_b32 s85, 4, s85
s_cselect_b32 s84, Lf5_start-Lpc0, s84
s_cmp_ge_u32 s82, 5
s_cselect_b32 s21, -9, s21
s_cselect_b32 s85, 5, s85
s_cselect_b32 s84, Lf5_start-Lpc0, s84
s_cmp_ge_u32 s82, 7
s_cselect_b32 s21, -16, s21
s_cselect_b32 s85, 6, s85
s_cselect_b32 s84, Lf8_start-Lpc0, s84
s_cmp_ge_u32 s82, 8
s_cselect_b32 s21, 0xffffffe0, s21
s_cselect_b32 s85, 8, s85
s_cselect_b32 s84, Lf8_start-Lpc0, s84
s_branch Ldec
Lexit:
ze 0
s_endpgm
Lln16_slow:
s_waitcnt vmcnt(0) lgkmcnt(0)
zgo
zgo
zb2 48
zb3 48
s_add_u32 s12, s12, 0x780
s_addc_u32 s13, s13, 0
zha 0x70880
s_mul_i32 s81, s20, 0xa800
s_add_u32 s70, s93, s81
zhb 49,48
zhc 50,48
zhz 0x1000
s_add_u32 s35, s35, 0x12000
zh0 53,48
zf9 54,48
v_lshlrev_b32 v53, 4, v53
v_add_u32 v54, 0x80, v54
v_add_u32 v53, 0x80, v53
v_cmp_le_u32 vcc, 32, v48
zd 4,54
zd 6,53
zcs 5,54,53
zhd 51,48
zgd 52,48
zfk 55,50
zg3 2,49
zh1 0x435f0000
zf9 10,50
zgp 53,50
zhe 53,51
zck 53
zgq 54,52,55
zbk 53,54
zfk 54,52
zh2 0,54,53
zh3 1,0
zbv 7,2
zbk 7,50
zd 8,7
s_mov_b32 s56, 0xffff0000
s_mov_b32 s57, 0xffff0000
v_lshl_add_u32 v53, v50, 2, s20
zh4 9,53
zh5 53,49
zhe 9,53
Lln16s_slow:
s_waitcnt vmcnt(0) lgkmcnt(0)
s_barrier
s_mul_i32 s65, s20, 0x4800
s_mov_b32 s64, 0
s_mov_b32 s67, s77
v_add_u32 v0, s65, v0
v_add_u32 v1, s65, v1
buffer_load_dword v15, v9, s[8:11], s67 offen
s_add_u32 m0, s65, 0
s_add_u32 s92, s64, 0
z0 4
zn 5,1024
zn 6,2048
zgt 0xc00
zfj 0xc00
z0 4
zn 5,1024
zn 6,2048
zgt 0x1800
zfj 0x1800
z0 4
zn 5,1024
zn 6,2048
zgt 0x2400
zfj 0x2400
z0 4
zn 5,1024
zn 6,2048
zgt 0x3000
zfj 0x3000
z0 4
zn 5,1024
zn 6,2048
zgt 0x3c00
zfj 0x3c00
z0 4
zn 5,1024
zn 6,2048
s_add_u32 s64, s64, 0x4800
s_add_u32 s67, s67, 4
zbj 96
zbj 97
zbj 98
zbj 99
zbj 100
zbj 101
zbj 102
zbj 103
zbj 104
zbj 105
zbj 106
zbj 107
zbj 108
zbj 109
zbj 110
zbj 111
zbj 112
zbj 113
zbj 114
zbj 115
zbj 116
zbj 117
zbj 118
zbj 119
zbj 120
zbj 121
zbj 122
zbj 123
zbj 124
zbj 125
zbj 126
zbj 127
zbj 128
zbj 129
zbj 130
zbj 131
zbj 132
zbj 133
zbj 134
zbj 135
zbj 136
zbj 137
zbj 138
zbj 139
zbj 140
zbj 141
zbj 142
zbj 143
zbj 144
zbj 145
zbj 146
zbj 147
zbj 148
zbj 149
zbj 150
zbj 151
zbj 152
zbj 153
zbj 154
zbj 155
zbj 156
zbj 157
zbj 158
zbj 159
zbj 160
zbj 161
zbj 162
zbj 163
zbj 164
zbj 165
zbj 166
zbj 167
zbj 168
zbj 169
zbj 170
zbj 171
zbj 172
zbj 173
zbj 174
zbj 175
zbj 176
zbj 177
zbj 178
zbj 179
zbj 180
zbj 181
zbj 182
zbj 183
zbj 184
zbj 185
zbj 186
zbj 187
zbj 188
zbj 189
zbj 190
zbj 191
s_mov_b32 s25, 0
s_mov_b32 s34, 0
s_mov_b32 s73, s35
v_lshl_add_u32 v11, s34, 2, v2
zbv 12,11
zhu 11
zhv 11
zg1 11,10
v_add3_u32 v3, v11, v12, s73
Lln16s_sl:
zu 0
ds_read_b64_tr_b16 a[0:1], v0
z1 2,0,768
zge 4,1
z1 6,1,768
z1 8,0,64
z1 10,0,832
z1 12,1,64
z1 14,1,832
z1 16,0,128
z1 18,0,896
z1 20,1,128
z1 22,1,896
z1 24,0,6144
z1 26,0,6912
z1 28,1,6144
z1 30,1,6912
z1 32,0,6208
z1 34,0,6976
z1 36,1,6208
z1 38,1,6976
z1 40,0,6272
z1 42,0,7040
z1 44,1,6272
z1 46,1,7040
z1 48,0,12288
z1 50,0,13056
z1 52,1,12288
z1 54,1,13056
z1 56,0,12352
z1 58,0,13120
z1 60,1,12352
z1 62,1,13120
z1 64,0,12416
z1 66,0,13184
z1 68,1,12416
z1 70,1,13184
v_and_b32 v11, 0x7fff7fff, v15
v_pk_sub_u16 v11, v11, s23 clamp
v_cmp_ne_u32_e64 s[36:37], 0, v11
ze 0
buffer_load_dword v15, v9, s[8:11], s67 offen
s_add_u32 m0, s65, 0
s_add_u32 s92, s64, 0
z0 4
zn 5,1024
zn 6,2048
zgt 0xc00
zfj 0xc00
z0 4
zn 5,1024
zn 6,2048
zgt 0x1800
zfj 0x1800
z0 4
zn 5,1024
zn 6,2048
zgt 0x2400
zfj 0x2400
z0 4
zn 5,1024
zn 6,2048
zgt 0x3000
zfj 0x3000
z0 4
zn 5,1024
zn 6,2048
zgt 0x3c00
zfj 0x3c00
z0 4
zn 5,1024
zn 6,2048
s_add_u32 s64, s64, 0x4800
s_add_u32 s67, s67, 4
s_and_b32 s87, s36, 0xffff
s_cbranch_scc0 Lln16s_sa0
s_mov_b32 s78, s25
s_mov_b32 s79, 0
s_call_b64 s[88:89], Lln16s_far
s_branch Lln16s_sb0
Lln16s_sa0:
zgo
za7 48,3
zl 52,3,64
zl 56,3,128
ze 0
Lln16s_sb0:
zj 96,0,48
zj 100,4,48
zj 104,8,48
zj 108,12,48
zj 112,16,48
zj 116,20,48
zj 96,24,52
zj 100,28,52
zj 104,32,52
zj 108,36,52
zj 112,40,52
zj 116,44,52
zj 96,48,56
zj 100,52,56
zdp 104,56
zj 108,60,56
zj 112,64,56
zj 116,68,56
zgo
s_and_b32 s87, s36, 0xffff0000
s_cbranch_scc0 Lln16s_sa1
s_mov_b32 s78, s25
s_mov_b32 s79, 4
s_call_b64 s[88:89], Lln16s_far
s_branch Lln16s_sb1
Lln16s_sa1:
zgo
zl 48,3,16384
zl 52,3,16448
zl 56,3,16512
ze 0
Lln16s_sb1:
zj 120,0,48
zj 124,4,48
zj 128,8,48
zj 132,12,48
zj 136,16,48
zj 140,20,48
zj 120,24,52
zj 124,28,52
zj 128,32,52
zj 132,36,52
zj 136,40,52
zj 140,44,52
zj 120,48,56
zj 124,52,56
zdp 128,56
zj 132,60,56
zj 136,64,56
zj 140,68,56
zgo
s_and_b32 s87, s37, 0xffff
s_cbranch_scc0 Lln16s_sa2
s_mov_b32 s78, s25
s_mov_b32 s79, 8
s_call_b64 s[88:89], Lln16s_far
s_branch Lln16s_sb2
Lln16s_sa2:
zgo
zl 48,3,32768
zl 52,3,32832
zl 56,3,32896
ze 0
Lln16s_sb2:
zj 144,0,48
zj 148,4,48
zj 152,8,48
zj 156,12,48
zj 160,16,48
zj 164,20,48
zj 144,24,52
zj 148,28,52
zj 152,32,52
zj 156,36,52
zj 160,40,52
zj 164,44,52
zj 144,48,56
zj 148,52,56
zdp 152,56
zj 156,60,56
zj 160,64,56
zj 164,68,56
zgo
s_and_b32 s87, s37, 0xffff0000
s_cbranch_scc0 Lln16s_sa3
s_mov_b32 s78, s25
s_mov_b32 s79, 12
s_call_b64 s[88:89], Lln16s_far
s_branch Lln16s_sb3
Lln16s_sa3:
zgo
zl 48,3,49152
zl 52,3,49216
zl 56,3,49280
ze 0
Lln16s_sb3:
zj 168,0,48
zj 172,4,48
zj 176,8,48
zj 180,12,48
zj 184,16,48
zj 188,20,48
zj 168,24,52
zj 172,28,52
zj 176,32,52
zj 180,36,52
zj 184,40,52
zj 188,44,52
zj 168,48,56
zj 172,52,56
zdp 176,56
zj 180,60,56
zj 184,64,56
zj 188,68,56
zgo
s_add_u32 s34, s34, 1
s_cmp_eq_u32 s34, 5
s_cselect_b32 s34, 0, s34
s_cselect_b32 s68, 0x1000, 0
s_add_u32 s73, s73, s68
v_lshl_add_u32 v11, s34, 2, v2
zbv 12,11
zhu 11
zhv 11
zg1 11,10
v_add3_u32 v3, v11, v12, s73
ze3
s_cmp_lt_u32 s25, 25
s_cbranch_scc1 Lln16s_sl
zgo
zq 96,97
zc 97,98,99
zc 98,100,101
zc 99,102,103
zch 100,96,98
zch 101,97,99
zch 102,98,96
zch 103,99,97
s_add_u32 s95, s70, 0
zbf 100,8
zq 104,105
zc 105,106,107
zc 106,108,109
zc 107,110,111
zch 108,104,106
zch 109,105,107
zch 110,106,104
zch 111,107,105
zg5 108,8,64
zq 112,113
zc 113,114,115
zc 114,116,117
zc 115,118,119
zch 116,112,114
zch 117,113,115
zch 118,114,112
zch 119,115,113
zg5 116,8,128
zq 120,121
zc 121,122,123
zc 122,124,125
zc 123,126,127
zch 124,120,122
zch 125,121,123
zch 126,122,120
zch 127,123,121
s_add_u32 s95, s70, 0x2a000
zbf 124,8
zq 128,129
zc 129,130,131
zc 130,132,133
zc 131,134,135
zch 132,128,130
zch 133,129,131
zch 134,130,128
zch 135,131,129
zg5 132,8,64
zq 136,137
zc 137,138,139
zc 138,140,141
zc 139,142,143
zch 140,136,138
zch 141,137,139
zch 142,138,136
zch 143,139,137
zg5 140,8,128
zq 144,145
zc 145,146,147
zc 146,148,149
zc 147,150,151
zch 148,144,146
zch 149,145,147
zch 150,146,144
zch 151,147,145
s_add_u32 s95, s70, 0x54000
zbf 148,8
zq 152,153
zc 153,154,155
zc 154,156,157
zc 155,158,159
zch 156,152,154
zch 157,153,155
zch 158,154,152
zch 159,155,153
zg5 156,8,64
zq 160,161
zc 161,162,163
zc 162,164,165
zc 163,166,167
zch 164,160,162
zch 165,161,163
zch 166,162,160
zch 167,163,161
zg5 164,8,128
zq 168,169
zc 169,170,171
zc 170,172,173
zc 171,174,175
zch 172,168,170
zch 173,169,171
zch 174,170,168
zch 175,171,169
s_add_u32 s95, s70, 0x7e000
zbf 172,8
zq 176,177
zc 177,178,179
zc 178,180,181
zc 179,182,183
zch 180,176,178
zch 181,177,179
zch 182,178,176
zch 183,179,177
zg5 180,8,64
zq 184,185
zc 185,186,187
zc 186,188,189
zc 187,190,191
zch 188,184,186
zch 189,185,187
zch 190,186,184
zch 191,187,185
zg5 188,8,128
s_endpgm
Lln16s_far:
ze 0
s_add_u32 s79, s79, s20
s_mul_i32 s91, s79, 0x5780
s_add_u32 s91, s91, s77
s_lshl2_add_u32 s91, s78, s91
zh6 58,2
zh7 48,58
s_mul_i32 s90, s78, 52
s_lshr_b32 s90, s90, 8
s_mul_i32 s96, s90, 5
s_sub_u32 s96, s78, s96
s_add_u32 s90, s90, s79
zh8
s_sub_u32 s90, s90, 2
zh9
s_sub_u32 s96, s96, 2
zgr 52,2
zia 51
zib 52
z2 52
zu 0
zx 49,48
zr 50,48
zg 49,51
zg 50,52
zs 49
zs 50
zc 48,49,50
zx 49,48
zr 50,48
z3 51,49
z3 52,50
z4 53,49,51
z4 54,50,52
z5 49,53
z5 50,54
zw 92,49,50
zw 93,49,54
zw 94,53,50
zw 95,53,54
zgf 51
zgf 52
zgg 56,51
zgg 57,52
zgh 56
zgh 57
zgi 51
zgi 56
zck 52
zck 57
zew 88,51,52,10
zew 89,51,57,10
zew 90,56,52,10
zew 91,56,57,10
buffer_load_dwordx4 v[72:75], v88, s[4:7], 0 offen
zg6 76,88,64
zg6 80,88,128
zu 2
zx 88,72
zw 48,92,88
zr 88,72
zw 49,92,88
zx 88,73
zw 50,92,88
zr 88,73
zw 51,92,88
zx 88,74
zw 52,92,88
zr 88,74
zw 53,92,88
zx 88,75
zw 54,92,88
zr 88,75
zw 55,92,88
zu 1
zx 88,76
zw 56,92,88
zr 88,76
zw 57,92,88
zx 88,77
zw 58,92,88
zr 88,77
zw 59,92,88
zx 88,78
zw 60,92,88
zr 88,78
zw 61,92,88
zx 88,79
zw 62,92,88
zr 88,79
zw 63,92,88
zu 0
zx 88,80
zw 64,92,88
zr 88,80
zw 65,92,88
zx 88,81
zw 66,92,88
zr 88,81
zw 67,92,88
zx 88,82
zw 68,92,88
zr 88,82
zw 69,92,88
zx 88,83
zw 70,92,88
zr 88,83
zw 71,92,88
buffer_load_dwordx4 v[72:75], v89, s[4:7], 0 offen
zg6 76,89,64
zg6 80,89,128
zu 2
zx 89,72
zy 48,93,89
zr 89,72
zy 49,93,89
zx 89,73
zy 50,93,89
zr 89,73
zy 51,93,89
zx 89,74
zy 52,93,89
zr 89,74
zy 53,93,89
zx 89,75
zy 54,93,89
zr 89,75
zy 55,93,89
zu 1
zx 89,76
zy 56,93,89
zr 89,76
zy 57,93,89
zx 89,77
zy 58,93,89
zr 89,77
zy 59,93,89
zx 89,78
zy 60,93,89
zr 89,78
zy 61,93,89
zx 89,79
zy 62,93,89
zr 89,79
zy 63,93,89
zu 0
zx 89,80
zy 64,93,89
zr 89,80
zy 65,93,89
zx 89,81
zy 66,93,89
zr 89,81
zy 67,93,89
zx 89,82
zy 68,93,89
zr 89,82
zy 69,93,89
zx 89,83
zy 70,93,89
zr 89,83
zy 71,93,89
buffer_load_dwordx4 v[72:75], v90, s[4:7], 0 offen
zg6 76,90,64
zg6 80,90,128
zu 2
zx 90,72
zy 48,94,90
zr 90,72
zy 49,94,90
zx 90,73
zy 50,94,90
zr 90,73
zy 51,94,90
zx 90,74
zy 52,94,90
zr 90,74
zy 53,94,90
zx 90,75
zy 54,94,90
zr 90,75
zy 55,94,90
zu 1
zx 90,76
zy 56,94,90
zr 90,76
zy 57,94,90
zx 90,77
zy 58,94,90
zr 90,77
zy 59,94,90
zx 90,78
zy 60,94,90
zr 90,78
zy 61,94,90
zx 90,79
zy 62,94,90
zr 90,79
zy 63,94,90
zu 0
zx 90,80
zy 64,94,90
zr 90,80
zy 65,94,90
zx 90,81
zy 66,94,90
zr 90,81
zy 67,94,90
zx 90,82
zy 68,94,90
zr 90,82
zy 69,94,90
zx 90,83
zy 70,94,90
zr 90,83
zy 71,94,90
buffer_load_dwordx4 v[72:75], v91, s[4:7], 0 offen
zg6 76,91,64
zg6 80,91,128
zu 2
zx 91,72
zy 48,95,91
zr 91,72
zy 49,95,91
zx 91,73
zy 50,95,91
zr 91,73
zy 51,95,91
zx 91,74
zy 52,95,91
zr 91,74
zy 53,95,91
zx 91,75
zy 54,95,91
zr 91,75
zy 55,95,91
zu 1
zx 91,76
zy 56,95,91
zr 91,76
zy 57,95,91
zx 91,77
zy 58,95,91
zr 91,77
zy 59,95,91
zx 91,78
zy 60,95,91
zr 91,78
zy 61,95,91
zx 91,79
zy 62,95,91
zr 91,79
zy 63,95,91
zu 0
zx 91,80
zy 64,95,91
zr 91,80
zy 65,95,91
zx 91,81
zy 66,95,91
zr 91,81
zy 67,95,91
zx 91,82
zy 68,95,91
zr 91,82
zy 69,95,91
zx 91,83
zy 70,95,91
zr 91,83
zy 71,95,91
zq 48,49
zc 49,50,51
zc 50,52,53
zc 51,54,55
zc 52,56,57
zc 53,58,59
zc 54,60,61
zc 55,62,63
zc 56,64,65
zc 57,66,67
zc 58,68,69
zc 59,70,71
zam
zgb
Lf11_start:
zhf 124,0
zhr 0x4800
s_add_u32 s73, s73, 0x13800
s_mul_i32 s81, s21, 0xe0
s_add_u32 s81, s81, s22
s_mul_i32 s93, s81, 0xc0
s_mul_i32 s77, s81, 0x64
zhb 125,124
zhc 126,124
zgd 128,124
v_and_b32 v130, 12, v124
zgu 127,130,126
v_add_u32 v48, s21, v128
v_add_u32 v33, s22, v127
zh4 129,128
zh5 130,127
zgu 35,129,130
s_mul_i32 s25, s20, 13
s_lshr_b32 s25, s25, 1
zed
zee 0x4800
zef
zeg
zeh 0x1200
zei
zej 0xd0
zek 0x12d0
zel
zem
zen
zeo
zbn
zbo
zbp
zhg 0x930000
zhh 0x20000
zhi 0x20000
zha 0x70880
zhj 0x20000
zhk 0x20000
zhw
zhz 0x1200
s_sub_u32 s85, s21, 3
s_add_u32 s85, s85, s20
s_add_u32 s97, s85, 0
zcv
zcw 0xdf
zbt 0xa800
s_add_u32 s42, s35, 0
ze2 129,124
zep 130,129
zd9 130
zeq 25,130
zd0 129,25
zer 129
zea 130
zes 130
zeb 130
zck 130
zbk 130,129
zc9 129,0x40000000
zcs 25,130,129
ze 0
zhl 0xffff
zhp 0xffff
zcx
zv
zae 25
ze5
zfi 56,35
zhs 129,124
zep 130,129
zd9 130
zeq 26,130
zd0 129,26
zer 129
zea 130
zes 130
zeb 130
zck 130
zbk 130,129
zc9 129,0x40000000
zcs 26,130,129
zan 0x400
zv
zae 26
zht 129,124
zep 130,129
zd9 130
zeq 27,130
zd0 129,27
zer 129
zea 130
zes 130
zeb 130
zck 130
zbk 130,129
zc9 129,0x40000000
zcs 27,130,129
zan 0x800
zv
zae 27
v_add_u32 v129, 0xc0, v124
zep 130,129
zd9 130
zeq 28,130
zd0 129,28
zer 129
zea 130
zes 130
zeb 130
zck 130
zbk 130,129
zc9 129,0x40000000
zcs 28,130,129
zan 0xc00
zv
zae 28
v_add_u32 v129, 0x100, v124
zep 130,129
zd9 130
zeq 29,130
zd0 129,29
zer 129
zea 130
zes 130
zeb 130
zck 130
zbk 130,129
zc9 129,0x40000000
zcs 29,130,129
zcy 0x3fffffff
zan 0x1000
zv
zae 29
zcz
s_add_u32 s97, s85, 4
zcv
zcw 0xdf
zbt 0xa800
zdd 0x4800
zcx
zv
zae 25
zan 0x400
zv
zae 26
zan 0x800
zv
zae 27
zan 0xc00
zv
zae 28
zcy 0x3fffffff
zan 0x1000
zv
zae 29
zcz
zhm 0x80
zhn
zho 0xffff
zhq 0xffff
zde
s_cselect_b32 s82, 0, s20
s_lshl_b32 s83, s82, 6
s_add_u32 s83, s83, 0x80
s_mul_i32 s82, s82, 5
s_lshr_b32 s82, 0x5880, s82
zh0 129,124
v_lshl_add_u32 v130, v124, 4, s83
v_lshl_add_u32 v129, v129, 4, s83
zgr 127,124
v_mul_u32_u24 v128, 0x56, v127
v_lshrrev_b32 v128, 8, v128
v_mad_i32_i24 v127, v128, -3, v127
v_cmp_le_u32 vcc, 48, v124
zam
zcs 42,130,129
v_cmp_gt_u32 vcc, 32, v124
zam
zcs 43,130,129
v_cmp_le_u32 vcc, 16, v124
zam
zcs 53,130,129
s_mov_b32 s84, 0xffffff40
zfx 128,127
zfy 42,128
zgv
zfx 128,127
zfy 43,128
zgv
zfx 128,127
zfy 53,128
zcg
zcu
z0 42
zn 43,1024
zn 53,2048
zn 42,3072
z6 0x1000
zag 0x1000
z0 43
zn 53,1024
zn 42,2048
zn 43,3072
z6 0x2000
zag 0x2000
z0 53
zn 42,1024
zn 43,2048
zn 53,3072
z6 0x3000
zag 0x3000
z0 42
zn 43,1024
zn 53,2048
zn 42,3072
z6 0x4000
zag 0x4000
z0 43
zn 53,1024
zc8 0x15e00
zfi 62,35
zhd 127,124
zgd 128,124
zfk 131,126
zg3 4,125
zh1 0x435f0000
zgc 130,126
zgp 0,131
zgn 0,130
v_mul_u32_u24 v129, 0xd0, v125
v_add_u32 v0, v129, v0
zf9 129,130
zg2 129,131
zhe 129,127
zck 129
zgq 130,128,131
zbk 129,130
v_add_u32 v129, s73, v129
zfk 130,128
zh2 1,130,129
zh3 2,1
s_mov_b32 s3, 0
zfz
s_cselect_b32 s3, 3, s3
zf0
s_cselect_b32 s3, 6, s3
zde
s_cselect_b32 s3, 9, s3
s_mov_b32 s78, s3
s_mul_i32 s79, s3, 0x5780
s_add_u32 s79, s79, s77
s_add_u32 s79, s79, 48
s_mul_i32 s94, s3, 0x1200
s_add_u32 s94, s94, 0x3870
zbq 8,0
ze3
zed
zee 0x4800
zef
zeg
zeh 0x1200
zei
zej 0xd0
zek 0x12d0
zel
zem
zen
zeo
s_mov_b32 s80, 0
s_mul_i32 s58, s20, 0x1800
s_add_u32 s58, s58, 0x33000
zde
s_cselect_b32 s58, s71, s58
zgp 6,130
zgc 130,128
zgn 6,130
zfk 130,127
zf9 7,130
zc9 129,0xffff
v_lshlrev_b32 v129, v7, v129
v_cmp_eq_u32 vcc, v128, v126
zam
zas 129
v_cmp_gt_u32 vcc, 2, v127
zam
v_cndmask_b32 v3, 0, v129, vcc
zgq 5,3,129
s_sub_u32 s82, s21, 3
s_sub_u32 s83, s22, 3
v_cvt_f32_i32 v49, s82
v_cvt_f32_i32 v50, s83
v_add_f32 v129, 0x41700000, v49
v_add_f32 v130, 0x41a00000, v50
v_mul_f32 v51, 0xc3500000, v50
v_fmamk_f32 v51, v49, 0xc5900000, v51
v_readfirstlane_b32 s75, v129
v_readfirstlane_b32 s76, v130
zc9 52,0x120
s_mov_b32 s26, 0x11111111
s_mov_b32 s27, 0x11111111
s_mov_b32 s28, 0x22222222
s_mov_b32 s29, 0x22222222
s_mov_b32 s30, 0x44444444
s_mov_b32 s31, 0x44444444
s_mov_b32 s32, 0x88888888
s_mov_b32 s33, 0x88888888
zu 28
zx 36,56
zr 37,56
zgw 38,48
zbs 39,33
z2 38
z2 39
zg 36,38
zg 37,39
zs 38
zs 39
zs 36
zs 37
zq 38,39
zq 36,37
zr 37,36
zav 36,38
zaw 36
z3 45,37
z3 44,36
z4 47,37,45
z4 46,36,44
zgw 38,48
z2 38
zd1 39,49
zd2 38,39
zax 47
z5 36,46
z5 37,47
zd3 40,44,49,38
zay 41,45,50
zw 38,36,37
zaz 36,47
za0 37,46
zw 39,46,47
za1 41,45
za2 41,51
za3 36,37
zas 37
za4 41,40
zq 38,39
zq 36,37
za5 37,52
zdf 40,44
zdg 39
za6 9,41
z8 15,38,7
z8 18,36,7
zdh
zau 12,37,9
zdi
zdj
Lf11_aqR0:
zu 19
s_barrier
zcf
s_cbranch_scc1 Lf11_aqG0
Lf11_aqRb0:
zdk 76,8
zi 78,8,16
zi 80,8,64
zi 82,8,80
zi 84,8,128
zi 86,8,144
zu 13
zo 148,1
zb 150,1,1536
zo 152,2
zb 154,2,1536
zb 156,1,64
zb 158,1,1600
zb 160,2,64
zb 162,2,1600
zb 164,1,128
zb 166,1,1664
zb 168,2,128
zb 170,2,1664
zu 7
zb 172,1,6144
zb 174,1,7680
zb 176,2,6144
zb 178,2,7680
zb 180,1,6208
zb 182,1,7744
zb 184,2,6208
zb 186,2,7744
zb 188,1,6272
zb 190,1,7808
zb 192,2,6272
zb 194,2,7808
Lf11_atR0:
zda
s_cbranch_scc1 Lf11_atG0
Lf11_atRb0:
ze 15
zh 220,148,76
zu 1
zb 196,1,12288
zb 198,1,13824
zh 224,152,76
zb 200,2,12288
zb 202,2,13824
zp 0,156,76
zb 204,1,12352
zb 206,1,13888
zp 4,160,76
ze 15
zb 208,2,12352
zb 210,2,13888
zp 8,164,76
zb 212,1,12416
zb 214,1,13952
zp 12,168,76
zb 216,2,12416
zb 218,2,13952
zf 220,172,80
ze 15
zi 88,8,4608
zi 90,8,4624
zf 224,176,80
zi 92,8,4672
zi 94,8,4688
za 0,180,80
zi 96,8,4736
zi 98,8,4752
za 4,184,80
zf1
zcv
zcw 0xdf
zbt 0xa800
zdd 0x9000
ze 15
za 8,188,80
zcx
zv
zae 25
za 12,192,80
zan 0x400
zv
zae 26
zf 220,196,84
zan 0x800
zv
zae 27
ze 5
zf 224,200,84
zan 0xc00
zv
zae 28
za 0,204,84
zcy 0x3fffffff
zan 0x1000
zv
zae 29
zcz
za 4,208,84
za 8,212,84
za 12,216,84
Lf11_atR1:
zdb
s_cbranch_scc1 Lf11_atG1
Lf11_atRb1:
ze 0
zh 228,148,88
zi 76,8,9216
zi 78,8,9232
zf 228,172,92
zi 80,8,9280
zi 82,8,9296
zf 228,196,96
zi 84,8,9344
zi 86,8,9360
zh 232,152,88
zgj
zcv
zcw 0xdf
zbt 0xa800
zdd 0xd800
zf 232,176,92
zcx
zv
zae 25
zf 232,200,96
zan 0x400
zv
zae 26
zp 16,156,88
zan 0x800
zv
zae 27
za 16,180,92
zan 0xc00
zv
zae 28
za 16,204,96
zcy 0x3fffffff
zan 0x1000
zv
zae 29
zcz
zp 20,160,88
zc8 0x2bc00
zfi 68,35
zu 11
zx 36,62
za 20,184,92
zr 37,62
zci 38,48
za 20,208,96
zbs 39,33
z2 38
zp 24,164,88
z2 39
zg 36,38
za 24,188,92
zg 37,39
zs 38
za 24,212,96
zbr 0x13800
zdw 1
zdw 2
zp 28,168,88
za 28,192,92
za 28,216,96
Lf11_atR2:
zu 6
s_barrier
zdc
s_cbranch_scc1 Lf11_atG2
Lf11_atRb2:
ze 0
zh 236,148,76
zi 88,8,13824
zi 90,8,13840
zi 92,8,13888
zi 94,8,13904
zf 236,172,80
s_add_u32 s97, s85, 16
zcv
zcw 0xdf
zbt 0xa800
zdd 0x12000
zi 96,8,13952
zi 98,8,13968
zf 236,196,84
zby
zgk
s_cselect_b32 s42, 0x25800, s42
zcx
zv
zae 25
zh 240,152,76
zan 0x400
zv
zae 26
zan 0x800
zv
zae 27
zf 240,176,80
zan 0xc00
zv
zae 28
zcy 0x3fffffff
zan 0x1000
zv
zae 29
zcz
zf 240,200,84
zf2 32,35
zs 39
zs 36
zs 37
zp 32,156,76
zq 38,39
zq 36,37
zr 37,36
zav 36,38
za 32,180,80
zaw 36
z3 45,37
z3 44,36
z4 47,37,45
za 32,204,84
z4 46,36,44
zci 38,48
z2 38
zd1 39,49
zp 36,160,76
zd2 38,39
zax 47
z5 36,46
za 36,184,80
z5 37,47
zd3 40,44,49,38
zay 41,45,50
za 36,208,84
zw 38,36,37
zaz 36,47
za0 37,46
zp 40,164,76
zw 39,46,47
za1 41,45
za2 41,51
za 40,188,80
za3 36,37
zas 37
za4 41,40
za 40,212,84
zq 38,39
zq 36,37
za5 37,52
zp 44,168,76
zca 40,44
zcb 39
za6 10,41
z8 16,38,7
za 44,192,80
z8 19,36,7
zcc
zau 13,37,10
zcd
za 44,216,84
zce
Lf11_atR3:
zc5
s_cbranch_scc1 Lf11_atG3
Lf11_atRb3:
ze 0
zh 244,148,88
zi 76,8,18432
zi 78,8,18448
zf 244,172,92
zi 80,8,18496
zi 82,8,18512
zf 244,196,96
zi 84,8,18560
zi 86,8,18576
zh 248,152,88
ze5
zc6 60,35,16
z6 0x3000
zc7 0x3000
z0 42
zf 248,176,92
zn 43,1024
zf 248,200,96
zn 53,2048
zp 48,156,88
za 48,180,92
za 48,204,96
zp 52,160,88
za 52,184,92
za 52,208,96
zp 56,164,88
za 56,188,92
za 56,212,96
zp 60,168,88
za 60,192,92
za 60,216,96
Lf11_atR4:
zc0
s_cbranch_scc1 Lf11_atG4
Lf11_atRb4:
ze 0
zh 252,148,76
zi 88,8,23040
zi 90,8,23056
zi 92,8,23104
zf 252,172,80
zi 94,8,23120
zi 96,8,23168
zi 98,8,23184
zf 252,196,84
zc8 0x15e00
zc6 66,35,16
z6 0x3000
zc7 0x3000
zn 42,3072
zp 64,152,76
z6 0x4000
zc7 0x4000
z0 43
za 64,176,80
zn 53,1024
za 64,200,84
zu 14
zx 36,68
zr 37,68
zp 68,156,76
zcl 38,48
zbs 39,33
za 68,180,80
z2 38
z2 39
za 68,204,84
zg 36,38
zg 37,39
zp 72,160,76
zs 38
zs 39
za 72,184,80
zs 36
zs 37
za 72,208,84
zq 38,39
zq 36,37
zex 76,164
zr 37,36
zav 36,38
za 76,188,80
zaw 36
z3 45,37
za 76,212,84
z3 44,36
z4 47,37,45
zp 80,168,76
z4 46,36,44
z7 80,192
za 80,216,84
Lf11_atR5:
zd4
s_cbranch_scc1 Lf11_atG5
Lf11_atRb5:
ze 0
zp 84,148,88
zi 76,8,27648
zi 78,8,27664
zi 80,8,27712
za 84,172,92
zi 82,8,27728
zi 84,8,27776
zi 86,8,27792
za 84,196,96
zc8 0x2bc00
zc6 72,35,16
zcg
zcu
z0 42
zex 88,152
zn 43,1024
zn 53,2048
za 88,176,92
zcl 38,48
z2 38
za 88,200,96
zd1 39,49
zd2 38,39
zp 92,156,88
zax 47
z5 36,46
z7 92,180
z5 37,47
zd3 40,44,49,38
za 92,204,96
zay 41,45,50
zw 38,36,37
zp 96,160,88
zaz 36,47
za0 37,46
za 96,184,92
zw 39,46,47
za1 41,45
z7 96,208
za2 41,51
za3 36,37
zp 100,164,88
zas 37
za4 41,40
za 100,188,92
zq 38,39
zq 36,37
za 100,212,96
za5 37,52
zcm 40,44
zp 104,168,88
zcn 39
za6 11,41
za 104,192,92
z8 17,38,7
z8 20,36,7
za 104,216,96
zco
Lf11_atR6:
s_barrier
zd5
s_cbranch_scc1 Lf11_atG6
Lf11_atRb6:
ze 0
zp 108,148,76
zi 88,8,32256
zi 90,8,32272
zi 92,8,32320
za 108,172,80
zi 94,8,32336
zi 96,8,32384
zi 98,8,32400
za 108,196,84
zn 42,3072
z6 0x1000
zag 0x1000
z0 43
zp 112,152,76
zn 53,1024
zau 14,37,11
za 112,176,80
zcp
zcq
zx 36,57
zr 37,57
za 112,200,84
zdx 38,48
zcj 39,33
z2 38
zp 116,156,76
z2 39
zg 36,38
za 116,180,80
zg 37,39
zs 38
za 116,204,84
zs 39
zs 36
zp 120,160,76
zs 37
zq 38,39
za 120,184,80
zq 36,37
zr 37,36
za 120,208,84
zav 36,38
zaw 36
zp 124,164,76
z3 45,37
z3 44,36
za 124,188,80
z4 47,37,45
z4 46,36,44
za 124,212,84
zax 47
z5 36,46
zp 128,168,76
z5 37,47
zbg 40,44,49
za 128,192,80
zay 41,45,50
zw 38,36,37
za 128,216,84
Lf11_atR7:
zdy
s_cbranch_scc1 Lf11_atG7
Lf11_atRb7:
ze 0
zp 132,148,88
zi 76,8,36864
zi 78,8,36880
zi 80,8,36928
za 132,172,92
zi 82,8,36944
zi 84,8,36992
zi 86,8,37008
za 132,196,96
zn 42,2048
zn 43,3072
zp 136,152,88
z6 0x2000
zag 0x2000
z0 53
za 136,176,92
zaz 36,47
za0 37,46
zw 39,46,47
za 136,200,96
za1 41,45
za2 41,51
zp 140,156,88
za3 36,37
zas 37
za 140,180,92
za4 41,40
zq 38,39
za 140,204,96
zq 36,37
za5 37,52
zp 144,160,88
zdf 40,44
zdg 39
za 144,184,92
za6 9,41
z8 15,38,7
za 144,208,96
z8 18,36,7
zdh
zp 148,164,88
zau 12,37,9
zdi
zdj
za 148,188,92
zx 36,63
zr 37,63
zfl 38,48
za 148,212,96
zcj 39,33
z2 38
z2 39
zp 152,168,88
zg 36,38
zg 37,39
za 152,192,92
zs 38
zs 39
za 152,216,96
Lf11_atR8:
zc1
s_cbranch_scc1 Lf11_atG8
Lf11_atRb8:
ze 0
zp 156,148,76
zi 88,8,41472
zi 90,8,41488
zi 92,8,41536
zp 160,152,76
zi 94,8,41552
zn 42,1024
zp 164,156,76
zn 43,2048
zn 53,3072
zp 168,160,76
zs 36
zs 37
zq 38,39
zp 172,164,76
zq 36,37
zr 37,36
zav 36,38
zp 176,168,76
zi 76,8,41600
zi 78,8,41616
zaw 36
za 156,172,80
z3 45,37
z3 44,36
z4 47,37,45
za 160,176,80
z4 46,36,44
zax 47
z5 36,46
za 164,180,80
z5 37,47
zbg 40,44,49
za 168,184,80
zay 41,45,50
zw 38,36,37
za 172,188,80
zaz 36,47
za0 37,46
za 176,192,80
zw 39,46,47
za1 41,45
za 156,196,84
za2 41,51
za3 36,37
za 160,200,84
zas 37
za4 41,40
za 164,204,84
zq 38,39
zq 36,37
za 168,208,84
za5 37,52
zca 40,44
za 172,212,84
zcb 39
za6 10,41
za 176,216,84
Lf11_atR9:
ze6
s_cbranch_scc1 Lf11_atG9
Lf11_atRb9:
ze 0
zp 180,148,88
zi 84,8,46080
zi 86,8,46096
zi 96,8,46144
zi 98,8,46160
zp 184,152,88
z8 16,38,7
z8 19,36,7
zcc
zau 13,37,10
zp 188,156,88
zcd
zce
zu 21
zx 36,32
zr 37,32
zf3 38,48
zp 192,160,88
ze2 39,33
z2 38
z2 39
zg 36,38
zp 196,164,88
zg 37,39
zs 38
zs 39
zp 200,168,88
zi 88,8,46208
zi 90,8,46224
zs 36
za 180,172,92
zs 37
zq 38,39
zq 36,37
za 184,176,92
zr 37,36
zav 36,38
zaw 36
za 188,180,92
z3 45,37
z3 44,36
z4 47,37,45
za 192,184,92
z4 46,36,44
zax 47
z5 36,46
za 196,188,92
z5 37,47
zbg 40,44,49
zay 41,45,50
za 200,192,92
zw 38,36,37
zaz 36,47
za0 37,46
za 180,196,76
zw 39,46,47
za1 41,45
za2 41,51
za 184,200,76
za3 36,37
zas 37
za4 41,40
za 188,204,76
zq 38,39
zq 36,37
za5 37,52
za 192,208,76
zcm 40,44
zcn 39
za6 11,41
z8 17,38,7
za 196,212,76
z8 20,36,7
zco
zau 14,37,11
zcp
za 200,216,76
zcq
Lf11_atR10:
zu 13
s_barrier
zdy
s_cbranch_scc1 Lf11_atG10
Lf11_atRb10:
ze 0
zp 204,148,84
zf4 8,0
zp 208,152,84
zdk 76,8
zi 78,8,16
zp 212,156,84
zi 80,8,64
zi 82,8,80
zp 216,160,84
zp 220,164,84
zp 224,168,84
zi 84,8,128
zi 86,8,144
zb 148,1,12288
za 204,172,96
zb 150,1,13824
zb 152,2,12288
zb 154,2,13824
za 208,176,96
zb 156,1,12352
zb 158,1,13888
za 212,180,96
zb 160,2,12352
zb 162,2,13888
za 216,184,96
zb 164,1,12416
zb 166,1,13952
za 220,188,96
zb 168,2,12416
zb 170,2,13952
za 224,192,96
zb 172,1,30720
zb 174,1,32256
za 204,196,88
zb 176,2,30720
zb 178,2,32256
za 208,200,88
zb 180,1,30784
zb 182,1,32320
za 212,204,88
zb 184,2,30784
zb 186,2,32320
za 216,208,88
zb 188,1,30848
zb 190,1,32384
za 220,212,88
zb 192,2,30848
zb 194,2,32384
za 224,216,88
zfz
s_cbranch_scc1 Lf11_as1R0
zf0
s_cbranch_scc1 Lf11_as2R0
zde
s_cbranch_scc1 Lf11_as3R0
Lf11_as0R0:
zc1
s_cbranch_scc1 Lf11_as0G0
Lf11_as0Rb0:
ze 15
zf 220,148,76
zb 204,1,49216
zb 206,1,50752
zb 208,2,49216
zf 224,152,76
zb 210,2,50752
zb 212,1,49280
zb 214,1,50816
za 0,156,76
zb 216,2,49280
zb 218,2,50816
zb 196,1,49152
za 4,160,76
ze 15
zb 198,1,50688
zb 200,2,49152
zb 202,2,50688
za 8,164,76
zi 88,8,4608
zi 90,8,4624
zi 92,8,4672
za 12,168,76
ze 15
zi 94,8,4688
zi 76,8,4736
zi 78,8,4752
zf 220,188,80
zbr 0x13800
zbb 1
zbb 2
zf 224,192,80
zb2 54
zb3 54
zbz 25,54
za 0,172,80
zbc 0x5800
zbw
zbd
zbe
za 4,176,80
ze 6
s_barrier
z6 0x3000
zag 0x3000
z0 42
za 8,180,80
zn 43,1024
zn 53,2048
za 12,184,80
zn 42,3072
z6 0x4000
zag 0x4000
z0 43
zf 220,204,84
zn 53,1024
zal 28,54
zf 224,208,84
zbc 0x9800
zby
zbd
zbe
za 0,212,84
zal 29,54
zb5
za 4,216,84
zb6 0x21000
zal 30,54
zb7 54
zbv 26,4
za 8,196,84
zbk 26,54
zb8
za 12,200,84
zb9 26
Lf11_as0R1:
ze6
s_cbranch_scc1 Lf11_as0G1
Lf11_as0Rb1:
ze 0
zf 228,148,88
zi 84,8,9216
zi 86,8,9232
zf 232,152,88
zi 96,8,9280
zi 98,8,9296
za 16,156,88
za 20,160,88
za 24,164,88
za 28,168,88
zi 88,8,9344
zi 90,8,9360
zf 228,188,92
zf 232,192,92
za 16,172,92
za 20,176,92
za 24,180,92
za 28,184,92
zf 228,204,76
zf 232,208,76
za 16,212,76
za 20,216,76
za 24,196,76
za 28,200,76
Lf11_as0R2:
zcf
s_cbranch_scc1 Lf11_as0G2
Lf11_as0Rb2:
ze 0
zf 236,148,84
zbn
zbo
zbq 8,0
zf 240,152,84
zbp
zdk 76,8
zi 78,8,16
za 32,156,84
zi 80,8,64
zi 82,8,80
za 36,160,84
za 40,164,84
za 44,168,84
zu 12
zi 84,8,128
zi 86,8,144
zo 148,1
zf 236,188,96
zb 150,1,1536
zo 152,2
zb 154,2,1536
zf 240,192,96
zb 156,1,64
zb 158,1,1600
za 32,172,96
zb 160,2,64
zb 162,2,1600
za 36,176,96
zb 164,1,128
zb 166,1,1664
za 40,180,96
zb 168,2,128
zb 170,2,1664
za 44,184,96
zu 6
zb 172,1,6144
zb 174,1,7680
zf 236,204,88
zb 176,2,6144
zb 178,2,7680
zf 240,208,88
zb 180,1,6208
zb 182,1,7744
za 32,212,88
zb 184,2,6208
zb 186,2,7744
za 36,216,88
zb 188,1,6272
zb 190,1,7808
za 40,196,88
zb 192,2,6272
zb 194,2,7808
za 44,200,88
s_branch Lf11_amR0
Lf11_as1R0:
zc1
s_cbranch_scc1 Lf11_as1G0
Lf11_as1Rb0:
ze 15
zf 244,156,76
zb 212,1,49280
zb 214,1,50816
zb 216,2,49280
zf 248,160,76
ze 15
zb 218,2,50816
zb 196,1,49152
zb 198,1,50688
za 48,164,76
zb 200,2,49152
zb 202,2,50688
zb 204,1,49216
za 52,168,76
zb 206,1,50752
zb 208,2,49216
zb 210,2,50752
za 56,148,76
zi 88,8,4608
zi 90,8,4624
zi 92,8,4672
za 60,152,76
ze 15
zi 94,8,4688
zi 76,8,4736
zi 78,8,4752
zf 244,172,80
zbr 0x13800
zbb 1
zbb 2
zf 248,176,80
zb2 54
zb3 54
zbz 25,54
za 48,180,80
zbc 0x5800
zbw
zbd
zbe
za 52,184,80
ze 6
s_barrier
z6 0x3000
zag 0x3000
z0 42
za 56,188,80
zn 43,1024
zn 53,2048
za 60,192,80
zn 42,3072
z6 0x4000
zag 0x4000
z0 43
zf 244,212,84
zn 53,1024
zal 28,54
zf 248,216,84
zbc 0x9800
zby
zbd
zbe
za 48,196,84
zal 29,54
zb5
za 52,200,84
zb6 0x21000
zal 30,54
zb7 54
zbv 26,4
za 56,204,84
zbk 26,54
zb8
za 60,208,84
zb9 26
Lf11_as1R1:
ze6
s_cbranch_scc1 Lf11_as1G1
Lf11_as1Rb1:
ze 0
zf 252,156,88
zi 84,8,9216
zi 86,8,9232
za 64,160,88
zi 96,8,9280
zi 98,8,9296
za 68,164,88
za 72,168,88
za 76,148,88
za 80,152,88
zi 88,8,9344
zi 90,8,9360
zf 252,172,92
za 64,176,92
za 68,180,92
za 72,184,92
za 76,188,92
za 80,192,92
zf 252,212,76
za 64,216,76
za 68,196,76
za 72,200,76
z7 76,204
za 80,208,76
Lf11_as1R2:
zcf
s_cbranch_scc1 Lf11_as1G2
Lf11_as1Rb2:
ze 0
z7 84,156
zbn
zbo
zbq 8,0
za 88,160,84
zbp
zdk 76,8
zi 78,8,16
za 92,164,84
zi 80,8,64
zi 82,8,80
za 96,168,84
za 100,148,84
za 104,152,84
zu 12
zi 84,8,128
zi 86,8,144
zo 148,1
za 84,172,96
zb 150,1,1536
zo 152,2
zb 154,2,1536
za 88,176,96
zb 156,1,64
zb 158,1,1600
za 92,180,96
zb 160,2,64
zb 162,2,1600
z7 96,184
zb 164,1,128
zb 166,1,1664
za 100,188,96
zb 168,2,128
zb 170,2,1664
za 104,192,96
zu 6
zb 172,1,6144
zb 174,1,7680
za 84,212,88
zb 176,2,6144
zb 178,2,7680
z7 88,216
zb 180,1,6208
zb 182,1,7744
za 92,196,88
zb 184,2,6208
zb 186,2,7744
za 96,200,88
zb 188,1,6272
zb 190,1,7808
za 100,204,88
zb 192,2,6272
zb 194,2,7808
za 104,208,88
s_branch Lf11_amR0
Lf11_as2R0:
zc1
s_cbranch_scc1 Lf11_as2G0
Lf11_as2Rb0:
ze 14
za 108,164,76
ze 12
zb 196,1,49152
zb 198,1,50688
zb 200,2,49152
za 112,168,76
zb 202,2,50688
zb 204,1,49216
zb 206,1,50752
za 116,148,76
zb 208,2,49216
zb 210,2,50752
zb 212,1,49280
za 120,152,76
zb 214,1,50816
zb 216,2,49280
zb 218,2,50816
za 124,156,76
zi 88,8,4608
zi 90,8,4624
zi 92,8,4672
za 128,160,76
ze 15
zi 94,8,4688
zi 76,8,4736
zi 78,8,4752
za 108,180,80
zbr 0x13800
zbb 1
zbb 2
za 112,184,80
zb2 54
zb3 54
zbz 25,54
za 116,188,80
zbc 0x5800
zbw
zbd
zbe
za 120,192,80
ze 6
s_barrier
z6 0x3000
zag 0x3000
z0 42
za 124,172,80
zn 43,1024
zn 53,2048
za 128,176,80
zn 42,3072
z6 0x4000
zag 0x4000
z0 43
za 108,196,84
zn 53,1024
zal 28,54
za 112,200,84
zbc 0x9800
zby
zbd
zbe
za 116,204,84
zal 29,54
zb5
za 120,208,84
zb6 0x21000
zal 30,54
zb7 54
zbv 26,4
za 124,212,84
zbk 26,54
zb8
za 128,216,84
zb9 26
Lf11_as2R1:
ze6
s_cbranch_scc1 Lf11_as2G1
Lf11_as2Rb1:
ze 0
za 132,164,88
zi 84,8,9216
zi 86,8,9232
za 136,168,88
zi 96,8,9280
zi 98,8,9296
za 140,148,88
za 144,152,88
za 148,156,88
za 152,160,88
zi 88,8,9344
zi 90,8,9360
za 132,180,92
za 136,184,92
za 140,188,92
za 144,192,92
za 148,172,92
za 152,176,92
za 132,196,76
za 136,200,76
za 140,204,76
za 144,208,76
za 148,212,76
za 152,216,76
Lf11_as2R2:
zcf
s_cbranch_scc1 Lf11_as2G2
Lf11_as2Rb2:
ze 0
za 156,164,84
zbn
zbo
zbq 8,0
za 160,168,84
zbp
zdk 76,8
zi 78,8,16
za 164,148,84
zi 80,8,64
zi 82,8,80
za 168,152,84
za 172,156,84
za 176,160,84
zu 12
zi 84,8,128
zi 86,8,144
zo 148,1
za 156,180,96
zb 150,1,1536
zo 152,2
zb 154,2,1536
za 160,184,96
zb 156,1,64
zb 158,1,1600
za 164,188,96
zb 160,2,64
zb 162,2,1600
za 168,192,96
zb 164,1,128
zb 166,1,1664
zdm 172,96
zb 168,2,128
zb 170,2,1664
zdm 176,96
zu 6
zb 172,1,6144
zb 174,1,7680
za 156,196,88
zb 176,2,6144
zb 178,2,7680
za 160,200,88
zb 180,1,6208
zb 182,1,7744
za 164,204,88
zb 184,2,6208
zb 186,2,7744
za 168,208,88
zb 188,1,6272
zb 190,1,7808
za 172,212,88
zb 192,2,6272
zb 194,2,7808
za 176,216,88
s_branch Lf11_amR0
Lf11_as3R0:
zc1
s_cbranch_scc1 Lf11_as3G0
Lf11_as3Rb0:
ze 15
za 180,148,76
zb 204,1,49216
zb 206,1,50752
za 184,152,76
zb 208,2,49216
zb 210,2,50752
za 188,156,76
zb 212,1,49280
zb 214,1,50816
za 192,160,76
ze 15
zb 216,2,49280
zb 218,2,50816
za 196,164,76
zb 196,1,49152
zb 198,1,50688
za 200,168,76
ze 12
zb 200,2,49152
zb 202,2,50688
za 180,188,80
ze 12
zi 88,8,4608
zi 90,8,4624
za 184,192,80
zi 92,8,4672
zi 94,8,4688
za 188,172,80
zi 96,8,4736
zi 98,8,4752
za 192,176,80
ze 6
s_barrier
zbr 0x13800
zbb 1
zbb 2
za 196,180,80
zb2 54
zb3 54
za 200,184,80
zbz 25,54
zbc 0x5800
zbw
zbd
za 180,204,84
zbe
zal 28,54
zbc 0x9800
za 184,208,84
zby
zbd
zbe
za 188,212,84
zal 29,54
zb5
za 192,216,84
zb6 0x21000
zal 30,54
zb7 54
zbv 26,4
zdm 196,84
zbk 26,54
zb8
zdm 200,84
zb9 26
Lf11_as3R1:
zcf
s_cbranch_scc1 Lf11_as3G1
Lf11_as3Rb1:
ze 0
za 204,148,88
zbn
zbo
zbq 8,0
za 208,152,88
zbp
zdk 76,8
zi 78,8,16
za 212,156,88
zi 80,8,64
zi 82,8,80
za 216,160,88
zi 84,8,128
zi 86,8,144
za 220,164,88
za 224,168,88
zu 6
zo 148,1
zb 150,1,1536
za 204,188,92
zo 152,2
zb 154,2,1536
za 208,192,92
zb 156,1,64
zb 158,1,1600
za 212,172,92
zb 160,2,64
zb 162,2,1600
za 216,176,92
zb 164,1,128
zb 166,1,1664
za 220,180,92
zb 168,2,128
zb 170,2,1664
za 224,184,92
zu 0
zb 172,1,6144
zb 174,1,7680
zdm 204,96
zb 176,2,6144
zb 178,2,7680
zdm 208,96
zb 180,1,6208
zb 182,1,7744
zdm 212,96
zb 184,2,6208
zb 186,2,7744
zdm 216,96
zb 188,1,6272
zb 190,1,7808
za 220,196,96
zb 192,2,6272
zb 194,2,7808
za 224,200,96
s_branch Lf11_amR0
.p2align 6
Lf11_amR0:
zda
s_cbranch_scc1 Lf11_amG0
Lf11_amRb0:
ze 15
zf 220,148,76
ze3
zu 0
zb 196,1,12288
zb 198,1,13824
zf 224,152,76
zed
zb 200,2,12288
zb 202,2,13824
za 0,156,76
zee 0x4800
zb 204,1,12352
zb 206,1,13888
za 4,160,76
zef
zb 208,2,12352
zb 210,2,13888
ze 15
za 8,164,76
zeg
zb 212,1,12416
zb 214,1,13952
za 12,168,76
zeh 0x1200
zb 216,2,12416
zb 218,2,13952
zf 220,172,80
zei
zi 88,8,4608
zi 90,8,4624
zf 224,176,80
zej 0xd0
zi 92,8,4672
zi 94,8,4688
ze 15
za 0,180,80
zek 0x12d0
zi 96,8,4736
zi 98,8,4752
za 4,184,80
zel
zx 36,69
zr 37,69
za 8,188,80
zem
zen
zd 69,70
za 12,192,80
zeo
ze 10
zf 220,196,84
zf 224,200,84
za 0,204,84
za 4,208,84
ze 4
za 8,212,84
za 12,216,84
Lf11_amR1:
zdb
s_cbranch_scc1 Lf11_amG1
Lf11_amRb1:
zf 228,148,88
ze 0
zi 76,8,9216
zi 78,8,9232
zf 228,172,92
zi 80,8,9280
zi 82,8,9296
zf 228,196,96
zi 84,8,9344
zi 86,8,9360
zf 232,152,88
zcg
zcu
z0 42
zf 232,176,92
zn 43,1024
zf 232,200,96
zd 70,71
zd 71,72
za 16,156,88
zd 72,73
zcl 38,48
za 16,180,92
zbs 39,33
z2 38
za 16,204,96
z2 39
zg 36,38
za 20,160,88
zg 37,39
zs 38
za 20,184,92
zs 39
zs 36
za 20,208,96
zs 37
zq 38,39
za 24,164,88
zq 36,37
zr 37,36
za 24,188,92
za 24,212,96
za 28,168,88
za 28,192,92
za 28,216,96
Lf11_amR2:
zdc
s_cbranch_scc1 Lf11_amG2
Lf11_amRb2:
ze 0
zf 236,148,76
zi 88,8,13824
zi 90,8,13840
zf 236,172,80
zi 92,8,13888
zi 94,8,13904
zf 236,196,84
zi 96,8,13952
zi 98,8,13968
zf 240,152,76
zn 53,2048
zf 240,176,80
zn 42,3072
zf 240,200,84
zav 36,38
zaw 36
za 32,156,76
z3 45,37
z3 44,36
za 32,180,80
z4 47,37,45
z4 46,36,44
za 32,204,84
zax 47
z5 36,46
za 36,160,76
z5 37,47
zbg 40,44,49
za 36,184,80
zay 41,45,50
zw 38,36,37
za 36,208,84
zaz 36,47
za0 37,46
za 40,164,76
zw 39,46,47
za1 41,45
za 40,188,80
za2 41,51
za 40,212,84
za 44,168,76
za 44,192,80
za 44,216,84
Lf11_amR3:
zc5
s_cbranch_scc1 Lf11_amG3
Lf11_amRb3:
ze 0
zf 244,148,88
zi 76,8,18432
zi 78,8,18448
zf 244,172,92
zi 80,8,18496
zi 82,8,18512
zf 244,196,96
zi 84,8,18560
zi 86,8,18576
zf 248,152,88
z6 0x1000
zag 0x1000
z0 43
zf 248,176,92
zn 53,1024
zf 248,200,96
za3 36,37
zas 37
za 48,156,88
za4 41,40
zq 38,39
za 48,180,92
zq 36,37
za5 37,52
za 48,204,96
zcm 40,44
zcn 39
za 52,160,88
za6 11,41
z8 17,38,7
za 52,184,92
z8 20,36,7
zco
za 52,208,96
zau 14,37,11
zcp
za 56,164,88
zcq
zx 36,58
za 56,188,92
za 56,212,96
za 60,168,88
za 60,192,92
za 60,216,96
Lf11_amR4:
zc0
s_cbranch_scc1 Lf11_amG4
Lf11_amRb4:
ze 0
zf 252,148,76
zi 88,8,23040
zi 90,8,23056
zf 252,172,80
zi 92,8,23104
zi 94,8,23120
zf 252,196,84
zi 96,8,23168
zi 98,8,23184
za 64,152,76
zn 42,2048
za 64,176,80
zn 43,3072
za 64,200,84
z6 0x2000
zag 0x2000
z0 53
za 68,156,76
zr 37,58
zd 58,59
za 68,180,80
zd 59,60
zd 60,61
za 68,204,84
zdx 38,48
zcj 39,33
za 72,160,76
z2 38
z2 39
za 72,184,80
zg 36,38
zg 37,39
za 72,208,84
zs 38
zs 39
z7 76,164
zs 36
za 76,188,80
za 76,212,84
za 80,168,76
z7 80,192
za 80,216,84
Lf11_amR5:
zd4
s_cbranch_scc1 Lf11_amG5
Lf11_amRb5:
ze 0
za 84,148,88
zi 76,8,27648
zi 78,8,27664
za 84,172,92
zi 80,8,27712
zi 82,8,27728
za 84,196,96
zi 84,8,27776
zi 86,8,27792
z7 88,152
zn 42,1024
za 88,176,92
zn 43,2048
za 88,200,96
zs 37
zq 38,39
za 92,156,88
zq 36,37
zr 37,36
z7 92,180
zav 36,38
zaw 36
za 92,204,96
z3 45,37
z3 44,36
za 96,160,88
z4 47,37,45
z4 46,36,44
za 96,184,92
zax 47
z5 36,46
z7 96,208
z5 37,47
zbg 40,44,49
za 100,164,88
zay 41,45,50
zw 38,36,37
za 100,188,92
zaz 36,47
za 100,212,96
za 104,168,88
za 104,192,92
za 104,216,96
Lf11_amR6:
zd5
s_cbranch_scc1 Lf11_amG6
Lf11_amRb6:
ze 0
za 108,148,76
zi 88,8,32256
zi 90,8,32272
za 108,172,80
zi 92,8,32320
zi 94,8,32336
za 108,196,84
zi 96,8,32384
zi 98,8,32400
za 112,152,76
zn 53,3072
za 112,176,80
z6 0x3000
zag 0x3000
z0 42
za 112,200,84
za0 37,46
zw 39,46,47
za 116,156,76
za1 41,45
za2 41,51
za 116,180,80
za3 36,37
zas 37
za 116,204,84
za4 41,40
zq 38,39
za 120,160,76
zq 36,37
za5 37,52
za 120,184,80
zdf 40,44
zdg 39
za 120,208,84
za6 9,41
z8 15,38,7
za 124,164,76
z8 18,36,7
zdh
za 124,188,80
za 124,212,84
za 128,168,76
za 128,192,80
za 128,216,84
Lf11_amR7:
zdy
s_cbranch_scc1 Lf11_amG7
Lf11_amRb7:
ze 0
za 132,148,88
zi 76,8,36864
zi 78,8,36880
za 132,172,92
zi 80,8,36928
zi 82,8,36944
za 132,196,96
zi 84,8,36992
zi 86,8,37008
za 136,152,88
zn 43,1024
za 136,176,92
zn 53,2048
za 136,200,96
zau 12,37,9
zdi
za 140,156,88
zdj
zx 36,64
zr 37,64
za 140,180,92
zd 64,65
zd 65,66
za 140,204,96
zd 66,67
zfl 38,48
za 144,160,88
zcj 39,33
z2 38
za 144,184,92
z2 39
zg 36,38
za 144,208,96
zg 37,39
zs 38
za 148,164,88
zs 39
zs 36
za 148,188,92
za 148,212,96
za 152,168,88
za 152,192,92
za 152,216,96
Lf11_amR8:
zc1
s_cbranch_scc1 Lf11_amG8
Lf11_amRb8:
ze 0
za 156,148,76
zi 88,8,41472
zi 90,8,41488
za 160,152,76
zi 92,8,41536
zi 94,8,41552
za 164,156,76
zn 42,3072
za 168,160,76
z6 0x4000
zag 0x4000
z0 43
za 172,164,76
zn 53,1024
za 176,168,76
zi 76,8,41600
zi 78,8,41616
za 156,172,80
zs 37
zq 38,39
za 160,176,80
zq 36,37
zr 37,36
za 164,180,80
zav 36,38
zaw 36
za 168,184,80
z3 45,37
z3 44,36
za 172,188,80
z4 47,37,45
z4 46,36,44
za 176,192,80
zax 47
z5 36,46
za 156,196,84
z5 37,47
za 160,200,84
za 164,204,84
za 168,208,84
za 172,212,84
za 176,216,84
Lf11_amR9:
ze6
s_cbranch_scc1 Lf11_amG9
Lf11_amRb9:
ze 0
za 180,148,88
zi 84,8,46080
zi 86,8,46096
za 184,152,88
zi 96,8,46144
zi 98,8,46160
za 188,156,88
zbg 40,44,49
zay 41,45,50
za 192,160,88
zw 38,36,37
zaz 36,47
za 196,164,88
za0 37,46
zw 39,46,47
za 200,168,88
zi 88,8,46208
zi 90,8,46224
za 180,172,92
za1 41,45
za2 41,51
za 184,176,92
za3 36,37
zas 37
za 188,180,92
za4 41,40
zq 38,39
za 192,184,92
zq 36,37
za5 37,52
za 196,188,92
zca 40,44
zcb 39
za 200,192,92
za6 10,41
z8 16,38,7
za 180,196,76
z8 19,36,7
zcc
za 184,200,76
zau 13,37,10
zcd
za 188,204,76
zce
za 192,208,76
za 196,212,76
za 200,216,76
Lf11_amR10:
zcf
s_cbranch_scc1 Lf11_amG10
Lf11_amRb10:
ze 0
za 204,148,84
zbn
zbo
zbq 8,0
za 208,152,84
zbp
zdk 76,8
zi 78,8,16
za 212,156,84
zf5
zi 80,8,64
zi 82,8,80
za 216,160,84
za 220,164,84
za 224,168,84
zu 12
zi 84,8,128
zi 86,8,144
zo 148,1
za 204,172,96
zb 150,1,1536
zo 152,2
zb 154,2,1536
za 208,176,96
zb 156,1,64
zb 158,1,1600
za 212,180,96
zb 160,2,64
zb 162,2,1600
za 216,184,96
zb 164,1,128
zb 166,1,1664
za 220,188,96
zb 168,2,128
zb 170,2,1664
za 224,192,96
zu 6
zb 172,1,6144
zb 174,1,7680
za 204,196,88
zb 176,2,6144
zb 178,2,7680
za 208,200,88
zb 180,1,6208
zb 182,1,7744
za 212,204,88
zb 184,2,6208
zb 186,2,7744
za 216,208,88
zb 188,1,6272
zb 190,1,7808
za 220,212,88
zb 192,2,6272
zb 194,2,7808
za 224,216,88
zgx
s_cbranch_scc1 Lf11_amR0
zde
s_cbranch_scc1 Lf11_ayR0
Lf11_azR0:
zda
s_cbranch_scc1 Lf11_azG0
Lf11_azRb0:
zi 88,8,4608
zi 90,8,4624
zi 92,8,4672
zi 94,8,4688
ze 15
za 0,156,76
zu 0
zi 96,8,4736
zi 98,8,4752
zb 204,1,12352
zb 206,1,13888
za 4,160,76
zb 208,2,12352
zb 210,2,13888
zb 212,1,12416
zb 214,1,13952
za 8,164,76
zb 216,2,12416
zb 218,2,13952
zb 196,1,12288
zb 198,1,13824
za 12,168,76
zb 200,2,12288
zb 202,2,13824
zx 36,69
zr 37,69
zf 220,148,76
zcl 38,48
zbs 39,33
z2 38
z2 39
zf 224,152,76
ze 15
zg 36,38
zg 37,39
zs 38
zs 39
za 0,180,80
zs 36
zs 37
zq 38,39
zq 36,37
za 4,184,80
zr 37,36
zav 36,38
zaw 36
z3 45,37
za 8,188,80
z3 44,36
z4 47,37,45
z4 46,36,44
zax 47
za 12,192,80
z5 36,46
z5 37,47
zbg 40,44,49
zay 41,45,50
zf 220,172,80
zw 38,36,37
zaz 36,47
za0 37,46
zw 39,46,47
zf 224,176,80
ze 0
za1 41,45
za2 41,51
za3 36,37
zas 37
za 0,204,84
za4 41,40
zq 38,39
zq 36,37
za5 37,52
za 4,208,84
zcm 40,44
zcn 39
za6 11,41
z8 17,38,7
za 8,212,84
zk 0,25,2048
za 12,216,84
zv
zk 4,25,3072
zf 220,196,84
z8 20,36,7
zco
zau 14,37,11
zcp
zf 224,200,84
zcq
Lf11_azR1:
zdb
s_cbranch_scc1 Lf11_azG1
Lf11_azRb1:
zi 76,8,9216
zi 78,8,9232
zi 80,8,9280
zi 82,8,9296
za 16,156,88
zfo 0xffff0000
zi 84,8,9344
zi 86,8,9360
za 16,180,92
zf6 0xffff0000
zk 8,25,4096
za 16,204,96
zk 12,25,5120
za 20,160,88
za 20,184,92
za 20,208,96
zbl
zk 16,25,8192
za 24,164,88
ze 1
s_barrier
za7 32,28
za 24,188,92
za7 36,29
zk 20,25,9216
za 24,212,96
za7 40,30
zl 44,28,1024
za 28,168,88
zl 48,29,1024
zl 52,30,1024
za 28,192,92
za 28,216,96
zv
zk 24,25,10240
zf 228,148,88
zf 228,172,92
zf 228,196,96
zb0
zk 28,25,11264
zf 232,152,88
zf 232,176,92
zf 232,200,96
Lf11_azR2:
zdc
s_cbranch_scc1 Lf11_azG2
Lf11_azRb2:
zi 88,8,13824
zi 90,8,13840
zi 92,8,13888
zi 94,8,13904
za 32,156,76
ze 9
zi 96,8,13952
zi 98,8,13968
zm 36,32
zg 40,220
za 32,180,80
zm 37,33
zg 41,221
zm 38,34
zg 42,222
za 32,204,84
zm 39,35
zg 43,223
zg 36,40
zg 37,41
za 36,160,76
zg 38,42
zg 39,43
zc 40,36,37
zc 41,38,39
za 36,184,80
zk 32,25,14336
za 36,208,84
ze 7
zm 48,44
zg 52,224
zm 49,45
zg 53,225
za 40,164,76
s_barrier
zl 32,28,6144
zl 36,29,6144
zm 50,46
za 40,188,80
zk 36,25,15360
za 40,212,84
zg 54,226
zm 51,47
zg 55,227
zg 48,52
za 44,168,76
zl 44,28,7168
zg 49,53
zg 50,54
zg 51,55
za 44,192,80
zk 40,25,16384
za 44,216,84
zc 52,48,49
zc 53,50,51
zah 42,52,40
zf 236,148,76
zl 48,29,7168
zah 43,53,41
zai 40,52
zf 236,172,80
zk 44,25,17408
zf 236,196,84
zai 41,53
zf 240,152,76
zfn
zbf 40,26
zl 52,30,7168
zf 240,176,80
zl 40,30,6144
zf 240,200,84
Lf11_azR3:
zc5
s_cbranch_scc1 Lf11_azG3
Lf11_azRb3:
zi 76,8,18432
zi 78,8,18448
zi 80,8,18496
zi 82,8,18512
ze 10
za 48,156,88
zi 84,8,18560
zi 86,8,18576
zm 36,32
ze 6
zg 40,228
za 48,180,92
zm 37,33
zg 41,229
zm 38,34
zg 42,230
za 48,204,96
zm 39,35
zg 43,231
zg 36,40
zg 37,41
za 52,160,88
zg 38,42
zg 39,43
zc 40,36,37
zc 41,38,39
za 52,184,92
zk 48,25,2048
za 52,208,96
zm 48,44
zg 52,232
zm 49,45
zg 53,233
za 56,164,88
s_barrier
zl 32,28,12288
zl 36,29,12288
zm 50,46
za 56,188,92
zk 52,25,3072
za 56,212,96
zg 54,234
zm 51,47
zg 55,235
zg 48,52
za 60,168,88
zl 44,28,13312
zg 49,53
zg 50,54
zg 51,55
za 60,192,92
zk 56,25,4096
za 60,216,96
zc 52,48,49
zc 53,50,51
zah 42,52,40
zf 244,148,88
zl 48,29,13312
zah 43,53,41
zai 40,52
zf 244,172,92
zk 60,25,5120
zf 244,196,96
zai 41,53
zf 248,152,88
zbh 0xa800
zbf 40,26
zl 52,30,13312
zf 248,176,92
zl 40,30,12288
zf 248,200,96
Lf11_azR4:
zc0
s_cbranch_scc1 Lf11_azG4
Lf11_azRb4:
zi 88,8,23040
zi 90,8,23056
zi 92,8,23104
zi 94,8,23120
ze 10
za 68,156,76
zi 96,8,23168
zi 98,8,23184
zm 36,32
ze 6
zg 40,236
za 68,180,80
zm 37,33
zg 41,237
zm 38,34
zg 42,238
za 68,204,84
zm 39,35
zg 43,239
zg 36,40
zg 37,41
za 72,160,76
zg 38,42
zg 39,43
zc 40,36,37
zc 41,38,39
za 72,184,80
zk 68,25,8192
za 72,208,84
zm 48,44
zg 52,240
zm 49,45
zg 53,241
z7 76,164
s_barrier
za7 32,28
za7 36,29
zm 50,46
za 76,188,80
zk 72,25,9216
za 76,212,84
zg 54,242
zm 51,47
zg 55,243
zg 48,52
za 80,168,76
zl 44,28,1024
zg 49,53
zg 50,54
zg 51,55
z7 80,192
zk 76,25,10240
za 80,216,84
zc 52,48,49
zc 53,50,51
zah 42,52,40
zf 252,148,76
zl 48,29,1024
zah 43,53,41
zai 40,52
zf 252,172,80
zk 80,25,11264
zf 252,196,84
zai 41,53
za 64,152,76
zbh 0x15000
zbf 40,26
zl 52,30,1024
za 64,176,80
za7 40,30
za 64,200,84
Lf11_azR5:
zd4
s_cbranch_scc1 Lf11_azG5
Lf11_azRb5:
zi 76,8,27648
zi 78,8,27664
zi 80,8,27712
zi 82,8,27728
ze 10
za 92,156,88
zi 84,8,27776
zi 86,8,27792
zm 36,32
ze 6
zg 40,244
z7 92,180
zm 37,33
zg 41,245
zm 38,34
zg 42,246
za 92,204,96
zm 39,35
zg 43,247
zg 36,40
zg 37,41
za 96,160,88
zg 38,42
zg 39,43
zc 40,36,37
zc 41,38,39
za 96,184,92
zk 92,25,14336
z7 96,208
zm 48,44
zg 52,248
zm 49,45
zg 53,249
za 100,164,88
s_barrier
zl 32,28,6144
zl 36,29,6144
zm 50,46
za 100,188,92
zk 96,25,15360
za 100,212,96
zg 54,250
zm 51,47
zg 55,251
zg 48,52
za 104,168,88
zl 44,28,7168
zg 49,53
zg 50,54
zg 51,55
za 104,192,92
zk 100,25,16384
za 104,216,96
zc 52,48,49
zc 53,50,51
zah 42,52,40
za 84,148,88
zl 48,29,7168
zah 43,53,41
zai 40,52
za 84,172,92
zk 104,25,17408
za 84,196,96
zai 41,53
z7 88,152
zbh 0x1f800
zbf 40,26
zl 52,30,7168
za 88,176,92
zl 40,30,6144
za 88,200,96
Lf11_azR6:
zd5
s_cbranch_scc1 Lf11_azG6
Lf11_azRb6:
zi 88,8,32256
zi 90,8,32272
zi 92,8,32320
zi 94,8,32336
ze 10
za 116,156,76
zi 96,8,32384
zi 98,8,32400
zm 36,32
ze 6
zg 40,252
za 116,180,80
zm 37,33
zg 41,253
zm 38,34
zg 42,254
za 116,204,84
zm 39,35
zg 43,255
zg 36,40
zg 37,41
za 120,160,76
zg 38,42
zg 39,43
zc 40,36,37
zc 41,38,39
za 120,184,80
zk 116,25,2048
za 120,208,84
zm 48,44
z9 44,64
zg 52,44
zm 49,45
za 124,164,76
s_barrier
zl 32,28,12288
zl 36,29,12288
z9 45,65
za 124,188,80
zk 120,25,3072
za 124,212,84
zg 53,45
zm 50,46
z9 46,66
zg 54,46
za 128,168,76
zm 51,47
z9 47,67
zg 55,47
zg 48,52
za 128,192,80
zk 124,25,4096
za 128,216,84
zl 44,28,13312
zg 49,53
zg 50,54
zg 51,55
za 108,148,76
zc 52,48,49
zc 53,50,51
zah 42,52,40
zah 43,53,41
za 108,172,80
zk 128,25,5120
za 108,196,84
zl 48,29,13312
zai 40,52
zai 41,53
za 112,152,76
zbh 0x2a000
zbf 40,26
zl 52,30,13312
za 112,176,80
zl 40,30,12288
za 112,200,84
Lf11_azR7:
zdy
s_cbranch_scc1 Lf11_azG7
Lf11_azRb7:
zi 76,8,36864
zi 78,8,36880
zi 80,8,36928
zi 82,8,36944
ze 10
za 140,156,88
zi 84,8,36992
zi 86,8,37008
zm 36,32
z9 32,84
ze 6
zg 40,32
za 140,180,92
zm 37,33
z9 33,85
zg 41,33
zm 38,34
za 140,204,96
z9 34,86
zg 42,34
zm 39,35
z9 35,87
za 144,160,88
zg 43,35
zg 36,40
zg 37,41
zg 38,42
za 144,184,92
zk 140,25,8192
za 144,208,96
zg 39,43
zc 40,36,37
zc 41,38,39
zm 48,44
za 148,164,88
s_barrier
za7 32,28
za7 36,29
z9 44,88
za 148,188,92
zk 144,25,9216
za 148,212,96
zg 52,44
zm 49,45
z9 45,89
zg 53,45
za 152,168,88
zm 50,46
z9 46,90
zg 54,46
zm 51,47
za 152,192,92
zk 148,25,10240
za 152,216,96
z9 47,91
zg 55,47
zg 48,52
zg 49,53
za 132,148,88
zl 44,28,1024
zg 50,54
zg 51,55
zc 52,48,49
za 132,172,92
zk 152,25,11264
za 132,196,96
zc 53,50,51
zah 42,52,40
zah 43,53,41
zai 40,52
za 136,152,88
zl 48,29,1024
zai 41,53
za 136,176,92
zbh 0x34800
zbf 40,26
zl 52,30,1024
za7 40,30
za 136,200,96
Lf11_azR8:
zc1
s_cbranch_scc1 Lf11_azG8
Lf11_azRb8:
zi 88,8,41472
zi 90,8,41488
zi 92,8,41536
zi 94,8,41552
ze 10
za 164,156,76
zi 96,8,41600
zi 98,8,41616
zm 36,32
z9 32,108
ze 6
zg 40,32
za 164,180,80
zm 37,33
z9 33,109
zg 41,33
zm 38,34
za 164,204,84
z9 34,110
zg 42,34
zm 39,35
z9 35,111
za 168,160,76
zg 43,35
zg 36,40
zg 37,41
zg 38,42
za 168,184,80
zk 164,25,14336
za 168,208,84
zg 39,43
zc 40,36,37
zc 41,38,39
zm 48,44
za 172,164,76
s_barrier
zl 32,28,6144
zl 36,29,6144
z9 44,112
za 172,188,80
zk 168,25,15360
za 172,212,84
zg 52,44
zm 49,45
z9 45,113
zg 53,45
za 176,168,76
zm 50,46
z9 46,114
zg 54,46
zm 51,47
za 176,192,80
zk 172,25,16384
za 176,216,84
z9 47,115
zg 55,47
zg 48,52
zg 49,53
za 156,148,76
zl 44,28,7168
zg 50,54
zg 51,55
zc 52,48,49
za 156,172,80
zk 176,25,17408
za 156,196,84
zc 53,50,51
zah 42,52,40
zah 43,53,41
zai 40,52
za 160,152,76
zl 48,29,7168
zai 41,53
za 160,176,80
zbh 0x3f000
zbf 40,26
zl 52,30,7168
zl 40,30,6144
za 160,200,84
Lf11_azR9:
ze6
s_cbranch_scc1 Lf11_azG9
Lf11_azRb9:
zi 76,8,46080
zi 78,8,46096
zi 80,8,46144
zi 82,8,46160
ze 10
za 188,156,88
zi 84,8,46208
zi 86,8,46224
zm 36,32
z9 32,132
ze 6
zg 40,32
za 188,180,92
zm 37,33
z9 33,133
zg 41,33
zm 38,34
za 188,204,96
z9 34,134
zg 42,34
zm 39,35
z9 35,135
za 192,160,88
zg 43,35
zg 36,40
zg 37,41
zg 38,42
za 192,184,92
zk 188,25,2048
za 192,208,96
zg 39,43
zc 40,36,37
zc 41,38,39
zm 48,44
za 196,164,88
s_barrier
zl 32,28,12288
zl 36,29,12288
z9 44,136
za 196,188,92
zk 192,25,3072
za 196,212,96
zg 52,44
zm 49,45
z9 45,137
zg 53,45
za 200,168,88
zm 50,46
z9 46,138
zg 54,46
zm 51,47
za 200,192,92
zk 196,25,4096
za 200,216,96
z9 47,139
zg 55,47
zg 48,52
zg 49,53
za 180,148,88
zl 44,28,13312
zg 50,54
zg 51,55
zc 52,48,49
za 180,172,92
zk 200,25,5120
za 180,196,96
zc 53,50,51
zah 42,52,40
zah 43,53,41
zai 40,52
za 184,152,88
zl 48,29,13312
zai 41,53
za 184,176,92
zbh 0x49800
zbf 40,26
zl 52,30,13312
zl 40,30,12288
za 184,200,96
Lf11_azR10:
Lf11_azH10:
ze 6
zm 36,32
z9 32,156
ze 0
zg 40,32
zm 37,33
za 212,156,76
z9 33,157
zg 41,33
zm 38,34
z9 34,158
za 212,180,80
zg 42,34
zm 39,35
z9 35,159
zg 43,35
za 212,204,84
zg 36,40
zg 37,41
zg 38,42
zg 39,43
za 216,160,76
zc 40,36,37
zc 41,38,39
zm 48,44
z9 44,160
za 216,184,80
zk 212,25,8192
za 216,208,84
zg 52,44
zm 49,45
z9 45,161
zg 53,45
za 220,164,76
s_barrier
za7 32,28
za7 36,29
zm 50,46
za 220,188,80
zk 216,25,9216
za 220,212,84
z9 46,162
zg 54,46
zm 51,47
z9 47,163
za 224,168,76
zg 55,47
zg 48,52
zg 49,53
zg 50,54
za 224,192,80
zk 220,25,10240
za 224,216,84
zl 44,28,1024
zg 51,55
zc 52,48,49
zc 53,50,51
za 204,148,76
zl 48,29,1024
zah 42,52,40
zah 43,53,41
za 204,172,80
zk 224,25,11264
za 204,196,84
zai 40,52
zai 41,53
za 208,152,76
zbh 0x54000
zbf 40,26
zl 52,30,1024
za 208,176,80
za7 40,30
za 208,200,84
ze 2
s_barrier
zm 36,32
z9 32,180
ze 0
zg 40,32
zm 37,33
z9 33,181
zg 41,33
zm 38,34
z9 34,182
zg 42,34
zm 39,35
z9 35,183
zg 43,35
zg 36,40
zg 37,41
zg 38,42
zg 39,43
zc 40,36,37
zc 41,38,39
zm 48,44
z9 44,184
zg 52,44
zm 49,45
z9 45,185
zg 53,45
zm 50,46
z9 46,186
zg 54,46
zm 51,47
z9 47,187
zg 55,47
zg 48,52
zg 49,53
zg 50,54
zg 51,55
zc 52,48,49
zc 53,50,51
zah 42,52,40
zah 43,53,41
zai 40,52
zai 41,53
zl 32,28,6144
zl 36,29,6144
zl 44,28,7168
zl 48,29,7168
zl 52,30,7168
zbh 0x5e800
zbf 40,26
zv
zl 40,30,6144
ze 4
zm 36,32
z9 32,204
zm 37,33
z9 33,205
zm 38,34
z9 34,206
zm 39,35
z9 35,207
ze 0
zg 40,32
zg 41,33
zg 42,34
zg 43,35
zg 36,40
zg 37,41
zg 38,42
zg 39,43
zc 40,36,37
zc 41,38,39
zm 48,44
z9 44,208
zg 52,44
zm 49,45
z9 45,209
zg 53,45
zm 50,46
z9 46,210
zg 54,46
zm 51,47
z9 47,211
zg 55,47
zg 48,52
zg 49,53
zg 50,54
zg 51,55
zc 52,48,49
zc 53,50,51
zah 42,52,40
zah 43,53,41
zai 40,52
zai 41,53
zbh 0x69000
zbf 40,26
s_endpgm
Lf11_ayR0:
zda
s_cbranch_scc1 Lf11_ayG0
Lf11_ayRb0:
zi 88,8,4608
zi 90,8,4624
zi 92,8,4672
zi 94,8,4688
ze 15
za 0,156,76
zu 0
zi 96,8,4736
zi 98,8,4752
zb 204,1,12352
zb 206,1,13888
za 4,160,76
zb 208,2,12352
zb 210,2,13888
zb 212,1,12416
zb 214,1,13952
za 8,164,76
zb 216,2,12416
zb 218,2,13952
zb 196,1,12288
zb 198,1,13824
za 12,168,76
zb 200,2,12288
zb 202,2,13824
zx 36,69
zr 37,69
zf 220,148,76
zcl 38,48
zbs 39,33
z2 38
z2 39
zf 224,152,76
ze 15
zg 36,38
zg 37,39
zs 38
zs 39
za 0,180,80
zs 36
zs 37
zq 38,39
zq 36,37
za 4,184,80
zr 37,36
zav 36,38
zaw 36
z3 45,37
za 8,188,80
z3 44,36
z4 47,37,45
z4 46,36,44
zax 47
za 12,192,80
z5 36,46
z5 37,47
zbg 40,44,49
zay 41,45,50
zf 220,172,80
zw 38,36,37
zaz 36,47
za0 37,46
zw 39,46,47
zf 224,176,80
ze 0
za1 41,45
za2 41,51
za3 36,37
zas 37
za 0,204,84
za4 41,40
zq 38,39
zq 36,37
za5 37,52
za 4,208,84
zcm 40,44
zcn 39
za6 11,41
z8 17,38,7
za 8,212,84
zk 0,25,2048
za 12,216,84
zv
zk 4,25,3072
zf 220,196,84
z8 20,36,7
zco
zau 14,37,11
zcp
zf 224,200,84
zcq
Lf11_ayR1:
zdb
s_cbranch_scc1 Lf11_ayG1
Lf11_ayRb1:
zi 76,8,9216
zi 78,8,9232
zi 80,8,9280
zi 82,8,9296
za 16,156,88
zi 84,8,9344
zi 86,8,9360
za 16,180,92
zk 8,25,4096
za 16,204,96
zk 12,25,5120
za 20,160,88
zdl 220,25
za 20,184,92
zat 224,25,1024
za 20,208,96
zam
zk 16,25,8192
za 24,164,88
za 24,188,92
za 24,212,96
ze 1
s_barrier
zk 20,25,9216
za 28,168,88
za 28,192,92
za 28,216,96
zam
zk 24,25,10240
zf 228,148,88
zf 228,172,92
zf 228,196,96
zam
zk 28,25,11264
zf 232,152,88
zf 232,176,92
zf 232,200,96
zam
zat 228,25,6144
Lf11_ayR2:
zdc
s_cbranch_scc1 Lf11_ayG2
Lf11_ayRb2:
zi 88,8,13824
zi 90,8,13840
zi 92,8,13888
zi 94,8,13904
za 32,156,76
zi 96,8,13952
zi 98,8,13968
za 32,180,80
zat 232,25,7168
za 32,204,84
za 36,160,76
za 36,184,80
za 36,208,84
za 40,164,76
ze 0
s_barrier
zam
zk 32,25,14336
za 40,188,80
zv
zk 36,25,15360
za 40,212,84
za 44,168,76
za 44,192,80
za 44,216,84
zf 236,148,76
zbl
zk 40,25,16384
zf 236,172,80
zv
zk 44,25,17408
zf 236,196,84
zf 240,152,76
zf 240,176,80
zf 240,200,84
zcr
zat 236,25,12288
Lf11_ayR3:
zc5
s_cbranch_scc1 Lf11_ayG3
Lf11_ayRb3:
zi 76,8,18432
zi 78,8,18448
zi 80,8,18496
zi 82,8,18512
za 48,156,88
zi 84,8,18560
zi 86,8,18576
za 48,180,92
zat 240,25,13312
za 48,204,96
za 52,160,88
za 52,184,92
za 52,208,96
za 56,164,88
ze 0
s_barrier
zam
zk 48,25,2048
za 56,188,92
zv
zk 52,25,3072
za 56,212,96
za 60,168,88
za 60,192,92
za 60,216,96
zf 244,148,88
zbl
zk 56,25,4096
zf 244,172,92
zv
zk 60,25,5120
zf 244,196,96
zf 248,152,88
zf 248,176,92
zf 248,200,96
zcr
zdl 244,25
Lf11_ayR4:
zc0
s_cbranch_scc1 Lf11_ayG4
Lf11_ayRb4:
zi 88,8,23040
zi 90,8,23056
zi 92,8,23104
zi 94,8,23120
za 68,156,76
zi 96,8,23168
zi 98,8,23184
za 68,180,80
zat 248,25,1024
za 68,204,84
za 72,160,76
za 72,184,80
za 72,208,84
z7 76,164
ze 0
s_barrier
zam
zk 68,25,8192
za 76,188,80
zv
zk 72,25,9216
za 76,212,84
za 80,168,76
z7 80,192
za 80,216,84
zf 252,148,76
zbl
zk 76,25,10240
zf 252,172,80
zv
zk 80,25,11264
zf 252,196,84
za 64,152,76
za 64,176,80
za 64,200,84
zcr
zat 252,25,6144
Lf11_ayR5:
zd4
s_cbranch_scc1 Lf11_ayG5
Lf11_ayRb5:
zi 76,8,27648
zi 78,8,27664
zi 80,8,27712
zi 82,8,27728
za 92,156,88
zi 84,8,27776
zi 86,8,27792
z7 92,180
zk 64,25,7168
za 92,204,96
za 96,160,88
za 96,184,92
z7 96,208
za 100,164,88
ze 0
s_barrier
zam
zk 92,25,14336
za 100,188,92
zv
zk 96,25,15360
za 100,212,96
za 104,168,88
za 104,192,92
za 104,216,96
za 84,148,88
zbl
zk 100,25,16384
za 84,172,92
zv
zk 104,25,17408
za 84,196,96
z7 88,152
za 88,176,92
za 88,200,96
zcr
zk 84,25,12288
Lf11_ayR6:
zd5
s_cbranch_scc1 Lf11_ayG6
Lf11_ayRb6:
zi 88,8,32256
zi 90,8,32272
zi 92,8,32320
zi 94,8,32336
za 116,156,76
zi 96,8,32384
zi 98,8,32400
za 116,180,80
zk 88,25,13312
za 116,204,84
za 120,160,76
za 120,184,80
za 120,208,84
za 124,164,76
ze 0
s_barrier
zam
zk 116,25,2048
za 124,188,80
zv
zk 120,25,3072
za 124,212,84
za 128,168,76
za 128,192,80
za 128,216,84
za 108,148,76
zbl
zk 124,25,4096
za 108,172,80
zv
zk 128,25,5120
za 108,196,84
za 112,152,76
za 112,176,80
za 112,200,84
zcr
zfr 108,25
Lf11_ayR7:
zdy
s_cbranch_scc1 Lf11_ayG7
Lf11_ayRb7:
zi 76,8,36864
zi 78,8,36880
zi 80,8,36928
zi 82,8,36944
za 140,156,88
zi 84,8,36992
zi 86,8,37008
za 140,180,92
zk 112,25,1024
za 140,204,96
za 144,160,88
za 144,184,92
za 144,208,96
za 148,164,88
ze 0
s_barrier
zam
zk 140,25,8192
za 148,188,92
zv
zk 144,25,9216
za 148,212,96
za 152,168,88
za 152,192,92
za 152,216,96
za 132,148,88
zbl
zk 148,25,10240
za 132,172,92
zv
zk 152,25,11264
za 132,196,96
za 136,152,88
za 136,176,92
za 136,200,96
zcr
zk 132,25,6144
Lf11_ayR8:
zc1
s_cbranch_scc1 Lf11_ayG8
Lf11_ayRb8:
zi 88,8,41472
zi 90,8,41488
zi 92,8,41536
zi 94,8,41552
za 164,156,76
zi 96,8,41600
zi 98,8,41616
za 164,180,80
zk 136,25,7168
za 164,204,84
za 168,160,76
za 168,184,80
za 168,208,84
za 172,164,76
ze 0
s_barrier
zam
zk 164,25,14336
za 172,188,80
zv
zk 168,25,15360
za 172,212,84
za 176,168,76
za 176,192,80
za 176,216,84
za 156,148,76
zbl
zk 172,25,16384
za 156,172,80
zv
zk 176,25,17408
za 156,196,84
za 160,152,76
za 160,176,80
za 160,200,84
zcr
zk 156,25,12288
Lf11_ayR9:
ze6
s_cbranch_scc1 Lf11_ayG9
Lf11_ayRb9:
zi 76,8,46080
zi 78,8,46096
zi 80,8,46144
zi 82,8,46160
za 188,156,88
zi 84,8,46208
zi 86,8,46224
za 188,180,92
zk 160,25,13312
za 188,204,96
za 192,160,88
za 192,184,92
za 192,208,96
za 196,164,88
ze 0
s_barrier
zam
zk 188,25,2048
za 196,188,92
zv
zk 192,25,3072
za 196,212,96
za 200,168,88
za 200,192,92
za 200,216,96
za 180,148,88
zbl
zk 196,25,4096
za 180,172,92
zv
zk 200,25,5120
za 180,196,96
za 184,152,88
za 184,176,92
za 184,200,96
zcr
zfr 180,25
Lf11_ayR10:
Lf11_ayH10:
za 212,156,76
za 212,180,80
za 212,204,84
zcr
zk 184,25,1024
za 216,160,76
za 216,184,80
za 216,208,84
zk 212,25,8192
za 220,164,76
ze 1
s_barrier
za 220,188,80
za 220,212,84
zam
zk 216,25,9216
za 224,168,76
za 224,192,80
za 224,216,84
zam
zk 220,25,10240
za 204,148,76
za 204,172,80
za 204,196,84
zam
zk 224,25,11264
za 208,152,76
za 208,176,80
za 208,200,84
zam
zk 204,25,6144
zcr
zk 208,25,7168
ze 0
s_barrier
s_endpgm
Lf11_amH0:
Lf11_amG0:
zd6
s_cbranch_scc1 Lf11_amS0
zda
s_cbranch_scc0 Lf11_amRb0
ze 15
zf 220,148,76
ze3
zac 21,9,6
zac 22,12,6
zf 224,152,76
zed
zo 100,21
zo 102,22
za 0,156,76
zee 0x4800
zb 104,21,16
zb 106,22,16
za 4,160,76
zef
zb 108,21,64
zb 110,22,64
ze 14
za 8,164,76
zeg
zb 112,21,80
zb 114,22,80
za 12,168,76
zeh 0x1200
zb 116,21,128
zb 118,22,128
zf 220,172,80
zei
zb 120,21,144
zb 122,22,144
zf 224,176,80
zej 0xd0
zad 140,15,3
zad 141,15,5
ze 12
za 0,180,80
zek 0x12d0
zad 142,18,3
zad 143,18,5
za 4,184,80
zu 0
zb 196,1,12288
zb 198,1,13824
ze 11
zh 124,100,140
ze 10
zb 200,2,12288
zb 202,2,13824
zh 128,104,140
ze 10
zb 204,1,12352
zb 206,1,13888
zh 132,108,140
ze 10
zb 208,2,12352
zc 88,124,125
zh 136,112,140
zel
zc 89,126,127
zc 90,128,129
za 8,188,80
zem
zc 91,130,131
zc 92,132,133
ze 7
zh 124,116,140
zc 93,134,135
zc 94,136,137
zh 128,120,140
zen
zb 210,2,13888
zc 95,138,139
za 12,192,80
ze 6
zb 212,1,12416
zc 96,124,125
zf 220,196,84
ze 5
zc 97,126,127
zc 98,128,129
zf 224,200,84
ze 3
zb 214,1,13952
zc 99,130,131
za 0,204,84
zb 216,2,12416
zb 218,2,13952
zx 36,69
zr 37,69
zd 69,70
zeo
ze 4
za 4,208,84
ze 2
za 8,212,84
ze 0
za 12,216,84
Lf11_amH1:
Lf11_amG1:
zd7
s_cbranch_scc1 Lf11_amS1
zdb
s_cbranch_scc0 Lf11_amRb1
zf 228,148,88
ze 0
zaj 21,9,6
zaj 22,12,6
zak 140,15,3
zf 228,172,92
zo 100,21
zo 102,22
zb 104,21,16
zf 228,196,96
zb 106,22,16
zb 108,21,64
zb 110,22,64
zf 232,152,88
zb 112,21,80
zb 114,22,80
zb 116,21,128
zf 232,176,92
zb 118,22,128
zb 120,21,144
zb 122,22,144
zf 232,200,96
zak 141,15,5
zak 142,18,3
za 16,156,88
zcg
zcu
z0 42
zak 143,18,5
za 16,180,92
zn 43,1024
za 16,204,96
ze 10
zd 70,71
zd 71,72
zh 124,100,140
ze 8
zd 72,73
zcl 38,48
zh 128,104,140
ze 6
zbs 39,33
z2 38
zh 132,108,140
ze 3
z2 39
zc 76,124,125
zh 136,112,140
zc 77,126,127
zc 78,128,129
za 20,160,88
ze 0
zc 79,130,131
zc 80,132,133
zh 124,116,140
zc 81,134,135
zc 82,136,137
zh 128,120,140
zc 83,138,139
zg 36,38
za 20,184,92
zg 37,39
zv
zc 84,124,125
za 20,208,96
zc 85,126,127
zc 86,128,129
za 24,164,88
zc 87,130,131
zs 38
za 24,188,92
zs 39
zs 36
za 24,212,96
zs 37
zq 38,39
za 28,168,88
zq 36,37
zr 37,36
za 28,192,92
za 28,216,96
Lf11_amH2:
Lf11_amG2:
zd8
s_cbranch_scc1 Lf11_amS2
zdc
s_cbranch_scc0 Lf11_amRb2
ze 0
zf 236,148,76
zaq 21,9,6
zaq 22,12,6
zar 140,15,3
zf 236,172,80
zo 100,21
zo 102,22
zb 104,21,16
zf 236,196,84
zb 106,22,16
zb 108,21,64
zb 110,22,64
zf 240,152,76
zb 112,21,80
zb 114,22,80
zb 116,21,128
zf 240,176,80
zb 118,22,128
zb 120,21,144
zb 122,22,144
zf 240,200,84
zar 141,15,5
zar 142,18,3
za 32,156,76
zn 53,2048
zar 143,18,5
za 32,180,80
zn 42,3072
za 32,204,84
ze 10
zav 36,38
zaw 36
zh 124,100,140
ze 8
z3 45,37
z3 44,36
zh 128,104,140
ze 6
z4 47,37,45
z4 46,36,44
zh 132,108,140
ze 4
zax 47
zc 88,124,125
zh 136,112,140
zc 89,126,127
zc 90,128,129
za 36,160,76
ze 0
zc 91,130,131
zc 92,132,133
zh 124,116,140
zc 93,134,135
zc 94,136,137
zh 128,120,140
zc 95,138,139
z5 36,46
za 36,184,80
z5 37,47
zv
zc 96,124,125
za 36,208,84
zc 97,126,127
zc 98,128,129
za 40,164,76
zc 99,130,131
zbg 40,44,49
za 40,188,80
zay 41,45,50
zw 38,36,37
za 40,212,84
zaz 36,47
za0 37,46
za 44,168,76
zw 39,46,47
za1 41,45
za 44,192,80
za2 41,51
za 44,216,84
Lf11_amH3:
Lf11_amG3:
zdt
s_cbranch_scc1 Lf11_amS3
zc5
s_cbranch_scc0 Lf11_amRb3
ze 0
zf 244,148,88
zaa 21,10,6
zaa 22,13,6
zab 140,16,3
zf 244,172,92
zo 100,21
zo 102,22
zb 104,21,16
zf 244,196,96
zb 106,22,16
zb 108,21,64
zf 248,152,88
zb 110,22,64
zb 112,21,80
zf 248,176,92
zb 114,22,80
zb 116,21,128
zf 248,200,96
zb 118,22,128
zb 120,21,144
za 48,156,88
zb 122,22,144
zab 141,16,5
za 48,180,92
zab 142,19,3
zab 143,19,5
za 48,204,96
z6 0x1000
zag 0x1000
z0 43
za 52,160,88
ze 10
zn 53,1024
zh 124,100,140
ze 8
za3 36,37
zas 37
zh 128,104,140
ze 6
za4 41,40
zq 38,39
zh 132,108,140
ze 4
zq 36,37
zc 76,124,125
zh 136,112,140
zc 77,126,127
zc 78,128,129
za 52,184,92
ze 0
zc 79,130,131
zc 80,132,133
zh 124,116,140
zc 81,134,135
zc 82,136,137
zh 128,120,140
zc 83,138,139
za5 37,52
za 52,208,96
zcm 40,44
zv
zc 84,124,125
za 56,164,88
zc 85,126,127
zc 86,128,129
za 56,188,92
zc 87,130,131
zcn 39
za 56,212,96
za6 11,41
z8 17,38,7
za 60,168,88
z8 20,36,7
zco
za 60,192,92
zau 14,37,11
zcp
zcq
za 60,216,96
zx 36,58
Lf11_amH4:
Lf11_amG4:
zc2
s_cbranch_scc1 Lf11_amS4
zc0
s_cbranch_scc0 Lf11_amRb4
ze 0
zf 252,148,76
zac 21,10,6
zac 22,13,6
zad 140,16,3
zf 252,172,80
zo 100,21
zo 102,22
zb 104,21,16
zf 252,196,84
zb 106,22,16
zb 108,21,64
zb 110,22,64
za 64,152,76
zb 112,21,80
zb 114,22,80
zb 116,21,128
za 64,176,80
zb 118,22,128
zb 120,21,144
za 64,200,84
zb 122,22,144
zad 141,16,5
za 68,156,76
zad 142,19,3
zad 143,19,5
za 68,180,80
zn 42,2048
za 68,204,84
ze 10
zn 43,3072
zh 124,100,140
z6 0x2000
zag 0x2000
z0 53
ze 8
zh 128,104,140
ze 6
zr 37,58
zd 58,59
zh 132,108,140
ze 3
zc 88,124,125
zc 89,126,127
zh 136,112,140
zd 59,60
zc 90,128,129
za 72,160,76
ze 0
zc 91,130,131
zc 92,132,133
zh 124,116,140
zc 93,134,135
zc 94,136,137
zh 128,120,140
zc 95,138,139
zd 60,61
za 72,184,80
zdx 38,48
zv
zc 96,124,125
za 72,208,84
zc 97,126,127
zc 98,128,129
z7 76,164
zc 99,130,131
zcj 39,33
za 76,188,80
z2 38
z2 39
za 76,212,84
zg 36,38
zg 37,39
za 80,168,76
zs 38
zs 39
z7 80,192
zs 36
za 80,216,84
Lf11_amH5:
Lf11_amG5:
zey
s_cbranch_scc1 Lf11_amS5
zd4
s_cbranch_scc0 Lf11_amRb5
ze 0
za 84,148,88
zaj 21,10,6
zaj 22,13,6
zak 140,16,3
za 84,172,92
zo 100,21
zo 102,22
zb 104,21,16
za 84,196,96
zb 106,22,16
zb 108,21,64
zb 110,22,64
z7 88,152
zb 112,21,80
zb 114,22,80
zb 116,21,128
za 88,176,92
zb 118,22,128
zb 120,21,144
zb 122,22,144
za 88,200,96
zak 141,16,5
zak 142,19,3
za 92,156,88
zn 42,1024
zak 143,19,5
z7 92,180
zn 43,2048
za 92,204,96
ze 10
zs 37
zq 38,39
zh 124,100,140
ze 8
zq 36,37
zr 37,36
zh 128,104,140
ze 6
zav 36,38
zaw 36
zh 132,108,140
ze 4
z3 45,37
zc 76,124,125
zh 136,112,140
zc 77,126,127
zc 78,128,129
za 96,160,88
ze 0
zc 79,130,131
zc 80,132,133
zh 124,116,140
zc 81,134,135
zc 82,136,137
zh 128,120,140
zc 83,138,139
z3 44,36
za 96,184,92
z4 47,37,45
zv
zc 84,124,125
z7 96,208
zc 85,126,127
zc 86,128,129
za 100,164,88
zc 87,130,131
z4 46,36,44
za 100,188,92
zax 47
z5 36,46
za 100,212,96
z5 37,47
zbg 40,44,49
za 104,168,88
zay 41,45,50
zw 38,36,37
za 104,192,92
zaz 36,47
za 104,216,96
Lf11_amH6:
Lf11_amG6:
zez
s_cbranch_scc1 Lf11_amS6
zd5
s_cbranch_scc0 Lf11_amRb6
ze 0
za 108,148,76
zaq 21,10,6
zaq 22,13,6
zar 140,16,3
za 108,172,80
zo 100,21
zo 102,22
zb 104,21,16
za 108,196,84
zb 106,22,16
zb 108,21,64
zb 110,22,64
za 112,152,76
zb 112,21,80
zb 114,22,80
zb 116,21,128
za 112,176,80
zb 118,22,128
zb 120,21,144
za 112,200,84
zb 122,22,144
zar 141,16,5
za 116,156,76
zar 142,19,3
zar 143,19,5
za 116,180,80
zn 53,3072
za 116,204,84
z6 0x3000
zag 0x3000
z0 42
ze 10
zh 124,100,140
ze 8
za0 37,46
zw 39,46,47
zh 128,104,140
ze 6
za1 41,45
za2 41,51
zh 132,108,140
ze 4
za3 36,37
zc 88,124,125
zh 136,112,140
zc 89,126,127
zc 90,128,129
za 120,160,76
ze 0
zc 91,130,131
zc 92,132,133
zh 124,116,140
zc 93,134,135
zc 94,136,137
zh 128,120,140
zc 95,138,139
zas 37
za 120,184,80
za4 41,40
zv
zc 96,124,125
za 120,208,84
zc 97,126,127
zc 98,128,129
za 124,164,76
zc 99,130,131
zq 38,39
za 124,188,80
zq 36,37
za5 37,52
za 124,212,84
zdf 40,44
zdg 39
za 128,168,76
za6 9,41
z8 15,38,7
za 128,192,80
z8 18,36,7
zdh
za 128,216,84
Lf11_amH7:
Lf11_amG7:
zf7
s_cbranch_scc1 Lf11_amS7
zdy
s_cbranch_scc0 Lf11_amRb7
ze 0
za 132,148,88
zaa 21,11,6
zaa 22,14,6
zab 140,17,3
za 132,172,92
zo 100,21
zo 102,22
zb 104,21,16
za 132,196,96
zb 106,22,16
zb 108,21,64
zb 110,22,64
za 136,152,88
zb 112,21,80
zb 114,22,80
za 136,176,92
zb 116,21,128
zb 118,22,128
za 136,200,96
zb 120,21,144
zb 122,22,144
za 140,156,88
zab 141,17,5
zab 142,20,3
za 140,180,92
zn 43,1024
zab 143,20,5
za 140,204,96
ze 10
zn 53,2048
zh 124,100,140
ze 8
zau 12,37,9
zdi
zh 128,104,140
zdj
zx 36,64
zr 37,64
ze 6
zh 132,108,140
ze 4
zc 76,124,125
zc 77,126,127
zh 136,112,140
ze 2
zc 78,128,129
zc 79,130,131
zh 124,116,140
ze 0
zc 80,132,133
zc 81,134,135
zh 128,120,140
zc 82,136,137
zc 83,138,139
za 144,160,88
zd 64,65
zc 84,124,125
za 144,184,92
zc 85,126,127
zv
zc 86,128,129
za 144,208,96
zc 87,130,131
zd 65,66
za 148,164,88
zd 66,67
zfl 38,48
za 148,188,92
zcj 39,33
z2 38
za 148,212,96
z2 39
zg 36,38
za 152,168,88
zg 37,39
zs 38
za 152,192,92
zs 39
zs 36
za 152,216,96
Lf11_amH8:
Lf11_amG8:
ze7
s_cbranch_scc1 Lf11_amS8
zc1
s_cbranch_scc0 Lf11_amRb8
ze 0
za 156,148,76
zac 21,11,6
zac 22,14,6
zad 140,17,3
za 160,152,76
zo 100,21
zo 102,22
zb 104,21,16
za 164,156,76
zb 106,22,16
zb 108,21,64
zb 110,22,64
za 168,160,76
zb 112,21,80
zb 114,22,80
zb 116,21,128
za 172,164,76
zb 118,22,128
zb 120,21,144
za 176,168,76
zb 122,22,144
zad 141,17,5
za 156,172,80
zad 142,20,3
zad 143,20,5
za 160,176,80
zn 42,3072
za 164,180,80
z6 0x4000
zag 0x4000
z0 43
ze 10
zh 124,100,140
ze 8
zn 53,1024
zh 128,104,140
ze 6
zs 37
zq 38,39
zh 132,108,140
ze 3
zq 36,37
zc 88,124,125
zh 136,112,140
zc 89,126,127
zc 90,128,129
za 168,184,80
ze 0
zc 91,130,131
zc 92,132,133
zh 124,116,140
zc 93,134,135
zc 94,136,137
zh 128,120,140
zc 95,138,139
zr 37,36
za 172,188,80
zav 36,38
zv
zc 76,124,125
za 176,192,80
zc 77,126,127
zc 78,128,129
za 156,196,84
zc 79,130,131
zaw 36
za 160,200,84
z3 45,37
z3 44,36
za 164,204,84
z4 47,37,45
z4 46,36,44
za 168,208,84
zax 47
z5 36,46
za 172,212,84
z5 37,47
za 176,216,84
Lf11_amH9:
Lf11_amG9:
zgy
s_cbranch_scc1 Lf11_amS9
ze6
s_cbranch_scc0 Lf11_amRb9
ze 0
za 180,148,88
zaj 21,11,6
zaj 22,14,6
zak 140,17,3
za 184,152,88
zo 100,21
zo 102,22
zb 104,21,16
za 188,156,88
zb 106,22,16
zb 108,21,64
zb 110,22,64
za 192,160,88
zb 112,21,80
zb 114,22,80
zb 116,21,128
za 196,164,88
zb 118,22,128
zb 120,21,144
za 200,168,88
zb 122,22,144
zak 141,17,5
za 180,172,92
zak 142,20,3
zak 143,20,5
za 184,176,92
zbg 40,44,49
zay 41,45,50
za 188,180,92
ze 10
zw 38,36,37
zaz 36,47
zh 124,100,140
ze 8
za0 37,46
zw 39,46,47
zh 128,104,140
ze 6
za1 41,45
za2 41,51
zh 132,108,140
ze 4
za3 36,37
zc 84,124,125
zh 136,112,140
zc 85,126,127
zc 86,128,129
za 192,184,92
ze 1
zc 87,130,131
zc 96,132,133
zh 124,116,140
ze 0
zc 97,134,135
zc 98,136,137
zh 128,120,140
zc 99,138,139
zas 37
za 196,188,92
za4 41,40
zc 88,124,125
za 200,192,92
zc 89,126,127
zv
zc 90,128,129
za 180,196,76
zc 91,130,131
zq 38,39
za 184,200,76
zq 36,37
za5 37,52
za 188,204,76
zca 40,44
zcb 39
za 192,208,76
za6 10,41
z8 16,38,7
z8 19,36,7
za 196,212,76
zcc
zau 13,37,10
zcd
zce
za 200,216,76
Lf11_amH10:
Lf11_amG10:
zct
s_cbranch_scc1 Lf11_amS10
zcf
s_cbranch_scc0 Lf11_amRb10
ze 0
za 204,148,84
zbn
zbq 8,0
zaa 21,9,6
zaa 22,12,6
za 208,152,84
zbo
zo 100,21
zo 102,22
zb 104,21,16
za 212,156,84
zbp
zb 106,22,16
zb 108,21,64
zb 110,22,64
za 216,160,84
zf5
zb 112,21,80
zb 114,22,80
zb 116,21,128
za 220,164,84
zb 118,22,128
zb 120,21,144
zb 122,22,144
za 224,168,84
zab 140,15,3
zab 141,15,5
zab 142,18,3
za 204,172,96
zu 12
zo 148,1
zb 150,1,1536
zab 143,18,5
za 208,176,96
ze 12
zo 152,2
zb 154,2,1536
zb 156,1,64
zh 124,100,140
ze 13
zb 158,1,1600
zb 160,2,64
zb 162,2,1600
zh 128,104,140
ze 14
zb 164,1,128
zb 166,1,1664
zh 132,108,140
ze 14
zc 76,124,125
zc 77,126,127
zh 136,112,140
zb 168,2,128
zc 78,128,129
za 212,180,96
ze 11
zc 79,130,131
zc 80,132,133
zh 124,116,140
zc 81,134,135
zc 82,136,137
zh 128,120,140
zb 170,2,1664
zc 83,138,139
za 216,184,96
za 220,188,96
zv
zc 84,124,125
zc 85,126,127
za 224,192,96
zu 6
zb 172,1,6144
zc 86,128,129
zc 87,130,131
za 204,196,88
zb 174,1,7680
zb 176,2,6144
zb 178,2,7680
za 208,200,88
zb 180,1,6208
zb 182,1,7744
za 212,204,88
zb 184,2,6208
zb 186,2,7744
za 216,208,88
zb 188,1,6272
zb 190,1,7808
za 220,212,88
zb 192,2,6272
zb 194,2,7808
za 224,216,88
Lf11_amE2:
zgx
s_cbranch_scc1 Lf11_amH0
zde
s_cbranch_scc1 Lf11_ayH0
s_branch Lf11_azH0
Lf11_azH0:
Lf11_azG0:
zd6
s_cbranch_scc1 Lf11_azS0
zda
s_cbranch_scc0 Lf11_azRb0
ze 15
za 0,156,76
zac 21,9,6
zac 22,12,6
zad 140,15,3
zad 141,15,5
zad 142,18,3
za 4,160,76
ze 12
zo 100,21
zo 102,22
zb 104,21,16
zb 106,22,16
zb 108,21,64
za 8,164,76
zb 110,22,64
zb 112,21,80
zb 114,22,80
zb 116,21,128
za 12,168,76
zb 118,22,128
zb 120,21,144
zb 122,22,144
zad 143,18,5
zf 220,148,76
zu 0
zb 204,1,12352
zb 206,1,13888
zb 208,2,12352
zb 210,2,13888
zf 224,152,76
ze 15
zb 212,1,12416
zb 214,1,13952
zb 216,2,12416
zb 218,2,13952
za 0,180,80
ze 15
zb 196,1,12288
zb 198,1,13824
zb 200,2,12288
zb 202,2,13824
zh 124,100,140
zx 36,69
zr 37,69
zcl 38,48
zbs 39,33
zh 128,104,140
ze 15
z2 38
z2 39
zg 36,38
zc 88,124,125
zh 132,108,140
zc 89,126,127
zg 37,39
zs 38
zc 90,128,129
zh 136,112,140
ze 11
zc 91,130,131
zs 39
zs 36
zc 92,132,133
zh 124,116,140
zc 93,134,135
zs 37
zc 94,136,137
zc 95,138,139
zh 128,120,140
zq 38,39
zq 36,37
zr 37,36
zc 96,124,125
za 4,184,80
zc 97,126,127
zav 36,38
zaw 36
zc 98,128,129
za 8,188,80
zc 99,130,131
z3 45,37
z3 44,36
z4 47,37,45
za 12,192,80
z4 46,36,44
zax 47
z5 36,46
z5 37,47
zf 220,172,80
zbg 40,44,49
zay 41,45,50
zw 38,36,37
zaz 36,47
zf 224,176,80
ze 0
za0 37,46
zw 39,46,47
za1 41,45
za2 41,51
za 0,204,84
za3 36,37
zas 37
za4 41,40
zq 38,39
za 4,208,84
zq 36,37
za5 37,52
zcm 40,44
zcn 39
za 8,212,84
zk 0,25,2048
za 12,216,84
zv
zk 4,25,3072
za6 11,41
zf 220,196,84
z8 17,38,7
z8 20,36,7
zco
zau 14,37,11
zcp
zf 224,200,84
zcq
Lf11_azH1:
Lf11_azG1:
zd7
s_cbranch_scc1 Lf11_azS1
zdb
s_cbranch_scc0 Lf11_azRb1
za 16,156,88
zfo 0xffff0000
zaj 21,9,6
zaj 22,12,6
zak 140,15,3
za 16,180,92
zf6 0xffff0000
zo 100,21
zo 102,22
zb 104,21,16
za 16,204,96
zb 106,22,16
zb 108,21,64
zb 110,22,64
za 20,160,88
zb 112,21,80
zb 114,22,80
zb 116,21,128
za 20,184,92
zb 118,22,128
zb 120,21,144
zb 122,22,144
za 20,208,96
zak 141,15,5
zak 142,18,3
zak 143,18,5
za 24,164,88
zk 8,25,4096
za 24,188,92
ze 11
zk 12,25,5120
zh 124,100,140
ze 10
zk 16,25,8192
zh 128,104,140
ze 9
zk 20,25,9216
zh 132,108,140
ze 2
s_barrier
za7 32,28
za7 36,29
zh 136,112,140
za7 40,30
zl 44,28,1024
za 24,212,96
zl 48,29,1024
zl 52,30,1024
za 28,168,88
zc 76,124,125
zc 77,126,127
za 28,192,92
zc 78,128,129
zc 79,130,131
zh 124,116,140
zk 24,25,10240
zh 128,120,140
zc 80,132,133
zc 81,134,135
za 28,216,96
zc 82,136,137
zc 83,138,139
zf 228,148,88
zc 84,124,125
zc 85,126,127
zf 228,172,92
zc 86,128,129
zc 87,130,131
zf 228,196,96
zk 28,25,11264
zf 232,152,88
zf 232,176,92
zf 232,200,96
Lf11_azH2:
Lf11_azG2:
zd8
s_cbranch_scc1 Lf11_azS2
zdc
s_cbranch_scc0 Lf11_azRb2
za 32,156,76
zaq 21,9,6
zaq 22,12,6
zar 140,15,3
zar 141,15,5
za 32,180,80
zo 100,21
zo 102,22
zb 104,21,16
zb 106,22,16
za 32,204,84
zb 108,21,64
zb 110,22,64
zb 112,21,80
zb 114,22,80
za 36,160,76
zb 116,21,128
zb 118,22,128
zb 120,21,144
zb 122,22,144
za 36,184,80
zk 32,25,14336
zar 142,18,3
zar 143,18,5
za 36,208,84
ze 13
zm 36,32
zg 40,220
zm 37,33
zg 41,221
za 40,164,76
s_barrier
zm 38,34
zg 42,222
zm 39,35
ze 11
zh 124,100,140
ze 9
zk 36,25,15360
zh 128,104,140
ze 8
zl 32,28,6144
zg 43,223
zg 36,40
zg 37,41
zh 132,108,140
ze 7
zg 38,42
zg 39,43
zc 40,36,37
zc 41,38,39
zh 136,112,140
zl 36,29,6144
zc 88,124,125
zc 89,126,127
zc 90,128,129
za 40,188,80
ze 4
zc 91,130,131
zc 92,132,133
zc 93,134,135
zc 94,136,137
zh 124,116,140
zc 95,138,139
zm 48,44
zg 52,224
zm 49,45
zh 128,120,140
zg 53,225
zm 50,46
zg 54,226
zc 96,124,125
za 40,212,84
zc 97,126,127
zm 51,47
zg 55,227
zc 98,128,129
za 44,168,76
zl 44,28,7168
zc 99,130,131
zg 48,52
zg 49,53
za 44,192,80
zk 40,25,16384
za 44,216,84
zg 50,54
zg 51,55
zc 52,48,49
zc 53,50,51
zf 236,148,76
zl 48,29,7168
zah 42,52,40
zah 43,53,41
zf 236,172,80
zk 44,25,17408
zf 236,196,84
zai 40,52
zai 41,53
zf 240,152,76
zfn
zbf 40,26
zl 52,30,7168
zf 240,176,80
zl 40,30,6144
zf 240,200,84
Lf11_azH3:
Lf11_azG3:
zdt
s_cbranch_scc1 Lf11_azS3
zc5
s_cbranch_scc0 Lf11_azRb3
ze 6
za 48,156,88
zaa 21,10,6
zaa 22,13,6
zab 140,16,3
zab 141,16,5
za 48,180,92
zo 100,21
zo 102,22
zb 104,21,16
zb 106,22,16
za 48,204,96
zb 108,21,64
zb 110,22,64
zb 112,21,80
zb 114,22,80
za 52,160,88
zb 116,21,128
zb 118,22,128
zb 120,21,144
zb 122,22,144
za 52,184,92
zk 48,25,2048
zab 142,19,3
zab 143,19,5
za 52,208,96
ze 13
zm 36,32
zg 40,228
zm 37,33
zg 41,229
za 56,164,88
s_barrier
zm 38,34
zg 42,230
zm 39,35
ze 11
zh 124,100,140
ze 9
zk 52,25,3072
zh 128,104,140
ze 8
zl 32,28,12288
zg 43,231
zg 36,40
zg 37,41
zh 132,108,140
ze 7
zg 38,42
zg 39,43
zc 40,36,37
zc 41,38,39
zh 136,112,140
zl 36,29,12288
zc 76,124,125
zc 77,126,127
zc 78,128,129
za 56,188,92
ze 4
zc 79,130,131
zc 80,132,133
zc 81,134,135
zc 82,136,137
zh 124,116,140
zc 83,138,139
zm 48,44
zg 52,232
zm 49,45
zh 128,120,140
zg 53,233
zm 50,46
zg 54,234
zc 84,124,125
za 56,212,96
zc 85,126,127
zm 51,47
zg 55,235
zc 86,128,129
za 60,168,88
zl 44,28,13312
zc 87,130,131
zg 48,52
zg 49,53
za 60,192,92
zk 56,25,4096
za 60,216,96
zg 50,54
zg 51,55
zc 52,48,49
zc 53,50,51
zf 244,148,88
zl 48,29,13312
zah 42,52,40
zah 43,53,41
zf 244,172,92
zk 60,25,5120
zf 244,196,96
zai 40,52
zai 41,53
zf 248,152,88
zbh 0xa800
zbf 40,26
zl 52,30,13312
zf 248,176,92
zl 40,30,12288
zf 248,200,96
Lf11_azH4:
Lf11_azG4:
zc2
s_cbranch_scc1 Lf11_azS4
zc0
s_cbranch_scc0 Lf11_azRb4
ze 6
za 68,156,76
zac 21,10,6
zac 22,13,6
zad 140,16,3
zad 141,16,5
za 68,180,80
zo 100,21
zo 102,22
zb 104,21,16
zb 106,22,16
za 68,204,84
zb 108,21,64
zb 110,22,64
zb 112,21,80
zb 114,22,80
za 72,160,76
zb 116,21,128
zb 118,22,128
zb 120,21,144
zb 122,22,144
za 72,184,80
zk 68,25,8192
zad 142,19,3
zad 143,19,5
za 72,208,84
ze 13
zm 36,32
zg 40,236
zm 37,33
zg 41,237
z7 76,164
s_barrier
zm 38,34
zg 42,238
zm 39,35
ze 11
zh 124,100,140
ze 9
zk 72,25,9216
zh 128,104,140
ze 8
za7 32,28
zg 43,239
zg 36,40
zg 37,41
zh 132,108,140
ze 7
zg 38,42
zg 39,43
zc 40,36,37
zc 41,38,39
zh 136,112,140
za7 36,29
zc 88,124,125
zc 89,126,127
zc 90,128,129
za 76,188,80
ze 4
zc 91,130,131
zc 92,132,133
zc 93,134,135
zc 94,136,137
zh 124,116,140
zc 95,138,139
zm 48,44
zg 52,240
zm 49,45
zh 128,120,140
zg 53,241
zm 50,46
zg 54,242
zc 96,124,125
za 76,212,84
zc 97,126,127
zm 51,47
zg 55,243
zc 98,128,129
za 80,168,76
zl 44,28,1024
zc 99,130,131
zg 48,52
zg 49,53
z7 80,192
zk 76,25,10240
za 80,216,84
zg 50,54
zg 51,55
zc 52,48,49
zc 53,50,51
zf 252,148,76
zl 48,29,1024
zah 42,52,40
zah 43,53,41
zf 252,172,80
zk 80,25,11264
zf 252,196,84
zai 40,52
zai 41,53
za 64,152,76
zbh 0x15000
zbf 40,26
zl 52,30,1024
za 64,176,80
za7 40,30
za 64,200,84
Lf11_azH5:
Lf11_azG5:
zey
s_cbranch_scc1 Lf11_azS5
zd4
s_cbranch_scc0 Lf11_azRb5
ze 6
za 92,156,88
zaj 21,10,6
zaj 22,13,6
zak 140,16,3
zak 141,16,5
z7 92,180
zo 100,21
zo 102,22
zb 104,21,16
zb 106,22,16
za 92,204,96
zb 108,21,64
zb 110,22,64
zb 112,21,80
zb 114,22,80
za 96,160,88
zb 116,21,128
zb 118,22,128
zb 120,21,144
zb 122,22,144
za 96,184,92
zk 92,25,14336
zak 142,19,3
zak 143,19,5
z7 96,208
ze 13
zm 36,32
zg 40,244
zm 37,33
zg 41,245
za 100,164,88
s_barrier
zm 38,34
zg 42,246
zm 39,35
ze 11
zh 124,100,140
ze 9
zk 96,25,15360
zh 128,104,140
ze 8
zl 32,28,6144
zg 43,247
zg 36,40
zg 37,41
zh 132,108,140
ze 7
zg 38,42
zg 39,43
zc 40,36,37
zc 41,38,39
zh 136,112,140
zl 36,29,6144
zc 76,124,125
zc 77,126,127
zc 78,128,129
za 100,188,92
ze 4
zc 79,130,131
zc 80,132,133
zc 81,134,135
zc 82,136,137
zh 124,116,140
zc 83,138,139
zm 48,44
zg 52,248
zm 49,45
zh 128,120,140
zg 53,249
zm 50,46
zg 54,250
zc 84,124,125
za 100,212,96
zc 85,126,127
zm 51,47
zg 55,251
zc 86,128,129
za 104,168,88
zl 44,28,7168
zc 87,130,131
zg 48,52
zg 49,53
za 104,192,92
zk 100,25,16384
za 104,216,96
zg 50,54
zg 51,55
zc 52,48,49
zc 53,50,51
za 84,148,88
zl 48,29,7168
zah 42,52,40
zah 43,53,41
za 84,172,92
zk 104,25,17408
za 84,196,96
zai 40,52
zai 41,53
z7 88,152
zbh 0x1f800
zbf 40,26
zl 52,30,7168
za 88,176,92
zl 40,30,6144
za 88,200,96
Lf11_azH6:
Lf11_azG6:
zez
s_cbranch_scc1 Lf11_azS6
zd5
s_cbranch_scc0 Lf11_azRb6
ze 6
za 116,156,76
zaq 21,10,6
zaq 22,13,6
zar 140,16,3
zar 141,16,5
zar 142,19,3
za 116,180,80
zo 100,21
zo 102,22
zb 104,21,16
zb 106,22,16
za 116,204,84
zb 108,21,64
zb 110,22,64
zb 112,21,80
zb 114,22,80
za 120,160,76
zb 116,21,128
zb 118,22,128
zb 120,21,144
zb 122,22,144
za 120,184,80
zk 116,25,2048
zar 143,19,5
za 120,208,84
ze 13
zm 36,32
zg 40,252
zm 37,33
zg 41,253
za 124,164,76
s_barrier
zm 38,34
zg 42,254
zm 39,35
ze 11
zh 124,100,140
ze 9
zk 120,25,3072
zh 128,104,140
ze 8
zl 32,28,12288
zg 43,255
zg 36,40
zg 37,41
zh 132,108,140
ze 7
zg 38,42
zg 39,43
zc 40,36,37
zc 41,38,39
zh 136,112,140
zl 36,29,12288
zc 88,124,125
zc 89,126,127
zc 90,128,129
za 124,188,80
ze 4
zc 91,130,131
zc 92,132,133
zc 93,134,135
zc 94,136,137
zh 124,116,140
zc 95,138,139
zm 48,44
z9 44,64
zg 52,44
zh 128,120,140
zm 49,45
z9 45,65
zg 53,45
zc 96,124,125
za 124,212,84
zc 97,126,127
zm 50,46
z9 46,66
zc 98,128,129
za 128,168,76
zc 99,130,131
zg 54,46
zm 51,47
z9 47,67
za 128,192,80
zk 124,25,4096
za 128,216,84
zg 55,47
zg 48,52
zg 49,53
zg 50,54
za 108,148,76
zl 44,28,13312
zg 51,55
zc 52,48,49
zc 53,50,51
za 108,172,80
zk 128,25,5120
za 108,196,84
zl 48,29,13312
zah 42,52,40
zah 43,53,41
zai 40,52
za 112,152,76
zai 41,53
za 112,176,80
zbh 0x2a000
zbf 40,26
zl 52,30,13312
zl 40,30,12288
za 112,200,84
Lf11_azH7:
Lf11_azG7:
zf7
s_cbranch_scc1 Lf11_azS7
zdy
s_cbranch_scc0 Lf11_azRb7
ze 6
za 140,156,88
zaa 21,11,6
zaa 22,14,6
zab 140,17,3
zab 141,17,5
zab 142,20,3
za 140,180,92
zo 100,21
zo 102,22
zb 104,21,16
zb 106,22,16
zb 108,21,64
za 140,204,96
zb 110,22,64
zb 112,21,80
zb 114,22,80
zb 116,21,128
zb 118,22,128
za 144,160,88
zb 120,21,144
zb 122,22,144
zk 140,25,8192
zab 143,20,5
za 144,184,92
ze 13
zm 36,32
z9 32,84
zg 40,32
zm 37,33
za 144,208,96
ze 11
z9 33,85
zg 41,33
zm 38,34
z9 34,86
zh 124,100,140
ze 9
zv
zk 144,25,9216
zg 42,34
zm 39,35
z9 35,87
zh 128,104,140
ze 8
zg 43,35
zg 36,40
zg 37,41
zg 38,42
zh 132,108,140
ze 5
zg 39,43
zc 40,36,37
zc 41,38,39
zc 76,124,125
zh 136,112,140
ze 2
zc 77,126,127
zc 78,128,129
zc 79,130,131
zc 80,132,133
zh 124,116,140
zc 81,134,135
zm 48,44
z9 44,88
zc 82,136,137
zh 128,120,140
zc 83,138,139
zg 52,44
zm 49,45
zc 84,124,125
za 148,164,88
s_barrier
za7 32,28
za7 36,29
zc 85,126,127
za 148,188,92
zc 86,128,129
zc 87,130,131
z9 45,89
zg 53,45
za 148,212,96
zm 50,46
z9 46,90
zg 54,46
zm 51,47
za 152,168,88
z9 47,91
zg 55,47
zg 48,52
zg 49,53
za 152,192,92
zk 148,25,10240
za 152,216,96
zl 44,28,1024
zg 50,54
zg 51,55
zc 52,48,49
za 132,148,88
zc 53,50,51
zah 42,52,40
zah 43,53,41
zai 40,52
za 132,172,92
zk 152,25,11264
za 132,196,96
zl 48,29,1024
zai 41,53
za 136,152,88
zbh 0x34800
zbf 40,26
zl 52,30,1024
za 136,176,92
za7 40,30
za 136,200,96
Lf11_azH8:
Lf11_azG8:
ze7
s_cbranch_scc1 Lf11_azS8
zc1
s_cbranch_scc0 Lf11_azRb8
ze 6
za 164,156,76
zac 21,11,6
zac 22,14,6
zad 140,17,3
zad 141,17,5
zad 142,20,3
za 164,180,80
zo 100,21
zo 102,22
zb 104,21,16
zb 106,22,16
zb 108,21,64
za 164,204,84
zb 110,22,64
zb 112,21,80
zb 114,22,80
zb 116,21,128
zb 118,22,128
za 168,160,76
zb 120,21,144
zb 122,22,144
zk 164,25,14336
zad 143,20,5
za 168,184,80
ze 13
zm 36,32
z9 32,108
zg 40,32
zm 37,33
za 168,208,84
ze 11
z9 33,109
zg 41,33
zm 38,34
z9 34,110
zh 124,100,140
ze 9
zv
zk 168,25,15360
zg 42,34
zm 39,35
z9 35,111
zh 128,104,140
ze 8
zg 43,35
zg 36,40
zg 37,41
zg 38,42
zh 132,108,140
ze 5
zg 39,43
zc 40,36,37
zc 41,38,39
zc 88,124,125
zh 136,112,140
ze 2
zc 89,126,127
zc 90,128,129
zc 91,130,131
zc 92,132,133
zh 124,116,140
zc 93,134,135
zm 48,44
z9 44,112
zc 94,136,137
zh 128,120,140
zc 95,138,139
zg 52,44
zm 49,45
zc 96,124,125
za 172,164,76
s_barrier
zl 32,28,6144
zl 36,29,6144
zc 97,126,127
za 172,188,80
zc 98,128,129
zc 99,130,131
z9 45,113
zg 53,45
za 172,212,84
zm 50,46
z9 46,114
zg 54,46
zm 51,47
za 176,168,76
z9 47,115
zg 55,47
zg 48,52
zg 49,53
za 176,192,80
zk 172,25,16384
za 176,216,84
zl 44,28,7168
zg 50,54
zg 51,55
zc 52,48,49
za 156,148,76
zc 53,50,51
zah 42,52,40
zah 43,53,41
zai 40,52
za 156,172,80
zk 176,25,17408
za 156,196,84
zl 48,29,7168
zai 41,53
za 160,152,76
zbh 0x3f000
zbf 40,26
zl 52,30,7168
za 160,176,80
zl 40,30,6144
za 160,200,84
Lf11_azH9:
Lf11_azG9:
zgy
s_cbranch_scc1 Lf11_azS9
ze6
s_cbranch_scc0 Lf11_azRb9
ze 6
za 188,156,88
zaj 21,11,6
zaj 22,14,6
zak 140,17,3
zak 141,17,5
zak 142,20,3
za 188,180,92
zo 100,21
zo 102,22
zb 104,21,16
zb 106,22,16
zb 108,21,64
za 188,204,96
zb 110,22,64
zb 112,21,80
zb 114,22,80
zb 116,21,128
zb 118,22,128
za 192,160,88
zb 120,21,144
zb 122,22,144
zk 188,25,2048
zak 143,20,5
za 192,184,92
ze 13
zm 36,32
z9 32,132
zg 40,32
zm 37,33
za 192,208,96
ze 11
z9 33,133
zg 41,33
zm 38,34
z9 34,134
zh 124,100,140
ze 9
zv
zk 192,25,3072
zg 42,34
zm 39,35
z9 35,135
zh 128,104,140
ze 8
zg 43,35
zg 36,40
zg 37,41
zg 38,42
zh 132,108,140
ze 5
zg 39,43
zc 40,36,37
zc 41,38,39
zc 76,124,125
zh 136,112,140
ze 2
zc 77,126,127
zc 78,128,129
zc 79,130,131
zc 80,132,133
zh 124,116,140
zc 81,134,135
zm 48,44
z9 44,136
zc 82,136,137
zh 128,120,140
zc 83,138,139
zg 52,44
zm 49,45
zc 84,124,125
za 196,164,88
s_barrier
zl 32,28,12288
zl 36,29,12288
zc 85,126,127
za 196,188,92
zc 86,128,129
zc 87,130,131
z9 45,137
zg 53,45
za 196,212,96
zm 50,46
z9 46,138
zg 54,46
zm 51,47
za 200,168,88
z9 47,139
zg 55,47
zg 48,52
zg 49,53
za 200,192,92
zk 196,25,4096
za 200,216,96
zl 44,28,13312
zg 50,54
zg 51,55
zc 52,48,49
za 180,148,88
zc 53,50,51
zah 42,52,40
zah 43,53,41
zai 40,52
za 180,172,92
zk 200,25,5120
za 180,196,96
zl 48,29,13312
zai 41,53
za 184,152,88
zbh 0x49800
zbf 40,26
zl 52,30,13312
za 184,176,92
zl 40,30,12288
za 184,200,96
s_branch Lf11_azR10
Lf11_azE2:
Lf11_ayH0:
Lf11_ayG0:
zd6
s_cbranch_scc1 Lf11_ayS0
zda
s_cbranch_scc0 Lf11_ayRb0
ze 15
za 0,156,76
zac 21,9,6
zac 22,12,6
zad 140,15,3
zad 141,15,5
zad 142,18,3
za 4,160,76
ze 12
zo 100,21
zo 102,22
zb 104,21,16
zb 106,22,16
zb 108,21,64
za 8,164,76
zb 110,22,64
zb 112,21,80
zb 114,22,80
zb 116,21,128
za 12,168,76
zb 118,22,128
zb 120,21,144
zb 122,22,144
zad 143,18,5
zf 220,148,76
zu 0
zb 204,1,12352
zb 206,1,13888
zb 208,2,12352
zb 210,2,13888
zf 224,152,76
ze 15
zb 212,1,12416
zb 214,1,13952
zb 216,2,12416
zb 218,2,13952
za 0,180,80
ze 15
zb 196,1,12288
zb 198,1,13824
zb 200,2,12288
zb 202,2,13824
zh 124,100,140
zx 36,69
zr 37,69
zcl 38,48
zbs 39,33
zh 128,104,140
ze 15
z2 38
z2 39
zg 36,38
zc 88,124,125
zh 132,108,140
zc 89,126,127
zg 37,39
zs 38
zc 90,128,129
zh 136,112,140
ze 11
zc 91,130,131
zs 39
zs 36
zc 92,132,133
zh 124,116,140
zc 93,134,135
zs 37
zc 94,136,137
zc 95,138,139
zh 128,120,140
zq 38,39
zq 36,37
zr 37,36
zc 96,124,125
za 4,184,80
zc 97,126,127
zav 36,38
zaw 36
zc 98,128,129
za 8,188,80
zc 99,130,131
z3 45,37
z3 44,36
z4 47,37,45
za 12,192,80
z4 46,36,44
zax 47
z5 36,46
z5 37,47
zf 220,172,80
zbg 40,44,49
zay 41,45,50
zw 38,36,37
zaz 36,47
zf 224,176,80
ze 0
za0 37,46
zw 39,46,47
za1 41,45
za2 41,51
za 0,204,84
za3 36,37
zas 37
za4 41,40
zq 38,39
za 4,208,84
zq 36,37
za5 37,52
zcm 40,44
zcn 39
za 8,212,84
zk 0,25,2048
za 12,216,84
zv
zk 4,25,3072
za6 11,41
zf 220,196,84
z8 17,38,7
z8 20,36,7
zco
zau 14,37,11
zcp
zf 224,200,84
zcq
Lf11_ayH1:
Lf11_ayG1:
zd7
s_cbranch_scc1 Lf11_ayS1
zdb
s_cbranch_scc0 Lf11_ayRb1
za 16,156,88
zaj 21,9,6
zaj 22,12,6
zak 140,15,3
za 16,180,92
zo 100,21
zo 102,22
zb 104,21,16
za 16,204,96
zb 106,22,16
zb 108,21,64
zb 110,22,64
za 20,160,88
zb 112,21,80
zb 114,22,80
zb 116,21,128
za 20,184,92
zb 118,22,128
zb 120,21,144
zb 122,22,144
za 20,208,96
zak 141,15,5
zak 142,18,3
zak 143,18,5
za 24,164,88
zk 8,25,4096
za 24,188,92
ze 11
zk 12,25,5120
zh 124,100,140
ze 10
zdl 220,25
zh 128,104,140
ze 9
zat 224,25,1024
zh 132,108,140
ze 8
zk 16,25,8192
zh 136,112,140
zk 20,25,9216
za 24,212,96
ze 2
s_barrier
zc 76,124,125
zc 77,126,127
za 28,168,88
zc 78,128,129
zc 79,130,131
zc 80,132,133
zh 124,116,140
zk 24,25,10240
zc 81,134,135
zh 128,120,140
zc 82,136,137
zc 83,138,139
za 28,192,92
zam
zc 84,124,125
zc 85,126,127
za 28,216,96
zf 228,148,88
zc 86,128,129
zc 87,130,131
zf 228,172,92
zf 228,196,96
zf 232,152,88
zam
zk 28,25,11264
zf 232,176,92
zb0
zat 228,25,6144
zf 232,200,96
Lf11_ayH2:
Lf11_ayG2:
zd8
s_cbranch_scc1 Lf11_ayS2
zdc
s_cbranch_scc0 Lf11_ayRb2
za 32,156,76
zaq 21,9,6
zaq 22,12,6
zar 140,15,3
za 32,180,80
zo 100,21
zo 102,22
zb 104,21,16
za 32,204,84
zb 106,22,16
zb 108,21,64
zb 110,22,64
za 36,160,76
zb 112,21,80
zb 114,22,80
zb 116,21,128
za 36,184,80
zb 118,22,128
zb 120,21,144
zb 122,22,144
za 36,208,84
zar 141,15,5
zar 142,18,3
zar 143,18,5
za 40,164,76
zat 232,25,7168
za 40,188,80
ze 11
zk 32,25,14336
zh 124,100,140
ze 10
zk 36,25,15360
zh 128,104,140
ze 2
s_barrier
zh 132,108,140
zh 136,112,140
zv
zc 88,124,125
zc 89,126,127
za 40,212,84
za 44,168,76
zc 90,128,129
zc 91,130,131
zc 92,132,133
zh 124,116,140
zb0
zk 40,25,16384
zc 93,134,135
zh 128,120,140
zc 94,136,137
zc 95,138,139
za 44,192,80
zc 96,124,125
zc 97,126,127
za 44,216,84
zf 236,148,76
zv
zc 98,128,129
zc 99,130,131
zf 236,172,80
zf 236,196,84
zf 240,152,76
zv
zk 44,25,17408
zf 240,176,80
zbl
zat 236,25,12288
zf 240,200,84
Lf11_ayH3:
Lf11_ayG3:
zdt
s_cbranch_scc1 Lf11_ayS3
zc5
s_cbranch_scc0 Lf11_ayRb3
za 48,156,88
zaa 21,10,6
zaa 22,13,6
zab 140,16,3
za 48,180,92
zo 100,21
zo 102,22
zb 104,21,16
za 48,204,96
zb 106,22,16
zb 108,21,64
zb 110,22,64
za 52,160,88
zb 112,21,80
zb 114,22,80
zb 116,21,128
za 52,184,92
zb 118,22,128
zb 120,21,144
zb 122,22,144
za 52,208,96
zab 141,16,5
zab 142,19,3
zab 143,19,5
za 56,164,88
zat 240,25,13312
za 56,188,92
ze 11
zk 48,25,2048
zh 124,100,140
ze 10
zk 52,25,3072
zh 128,104,140
ze 2
s_barrier
zh 132,108,140
zh 136,112,140
zv
zc 76,124,125
zc 77,126,127
za 56,212,96
za 60,168,88
zc 78,128,129
zc 79,130,131
zc 80,132,133
zh 124,116,140
zb0
zk 56,25,4096
zc 81,134,135
zh 128,120,140
zc 82,136,137
zc 83,138,139
za 60,192,92
zc 84,124,125
zc 85,126,127
za 60,216,96
zf 244,148,88
zv
zc 86,128,129
zc 87,130,131
zf 244,172,92
zf 244,196,96
zf 248,152,88
zv
zk 60,25,5120
zf 248,176,92
zbl
zdl 244,25
zf 248,200,96
Lf11_ayH4:
Lf11_ayG4:
zc2
s_cbranch_scc1 Lf11_ayS4
zc0
s_cbranch_scc0 Lf11_ayRb4
za 68,156,76
zac 21,10,6
zac 22,13,6
zad 140,16,3
za 68,180,80
zo 100,21
zo 102,22
zb 104,21,16
za 68,204,84
zb 106,22,16
zb 108,21,64
zb 110,22,64
za 72,160,76
zb 112,21,80
zb 114,22,80
zb 116,21,128
za 72,184,80
zb 118,22,128
zb 120,21,144
zb 122,22,144
za 72,208,84
zad 141,16,5
zad 142,19,3
zad 143,19,5
z7 76,164
zat 248,25,1024
za 76,188,80
ze 11
zk 68,25,8192
zh 124,100,140
ze 10
zk 72,25,9216
zh 128,104,140
ze 2
s_barrier
zh 132,108,140
zh 136,112,140
zv
zc 88,124,125
zc 89,126,127
za 76,212,84
za 80,168,76
zc 90,128,129
zc 91,130,131
zc 92,132,133
zh 124,116,140
zb0
zk 76,25,10240
zc 93,134,135
zh 128,120,140
zc 94,136,137
zc 95,138,139
z7 80,192
zc 96,124,125
zc 97,126,127
za 80,216,84
zf 252,148,76
zv
zc 98,128,129
zc 99,130,131
zf 252,172,80
zf 252,196,84
za 64,152,76
zv
zk 80,25,11264
za 64,176,80
zbl
zat 252,25,6144
za 64,200,84
Lf11_ayH5:
Lf11_ayG5:
zey
s_cbranch_scc1 Lf11_ayS5
zd4
s_cbranch_scc0 Lf11_ayRb5
za 92,156,88
zaj 21,10,6
zaj 22,13,6
zak 140,16,3
z7 92,180
zo 100,21
zo 102,22
zb 104,21,16
za 92,204,96
zb 106,22,16
zb 108,21,64
zb 110,22,64
za 96,160,88
zb 112,21,80
zb 114,22,80
zb 116,21,128
za 96,184,92
zb 118,22,128
zb 120,21,144
zb 122,22,144
z7 96,208
zak 141,16,5
zak 142,19,3
zak 143,19,5
za 100,164,88
zk 64,25,7168
za 100,188,92
ze 11
zk 92,25,14336
zh 124,100,140
ze 10
zk 96,25,15360
zh 128,104,140
ze 2
s_barrier
zh 132,108,140
zh 136,112,140
zv
zc 76,124,125
zc 77,126,127
za 100,212,96
za 104,168,88
zc 78,128,129
zc 79,130,131
zc 80,132,133
zh 124,116,140
zb0
zk 100,25,16384
zc 81,134,135
zh 128,120,140
zc 82,136,137
zc 83,138,139
za 104,192,92
zc 84,124,125
zc 85,126,127
za 104,216,96
za 84,148,88
zv
zc 86,128,129
zc 87,130,131
za 84,172,92
za 84,196,96
z7 88,152
zv
zk 104,25,17408
za 88,176,92
zbl
zk 84,25,12288
za 88,200,96
Lf11_ayH6:
Lf11_ayG6:
zez
s_cbranch_scc1 Lf11_ayS6
zd5
s_cbranch_scc0 Lf11_ayRb6
za 116,156,76
zaq 21,10,6
zaq 22,13,6
zar 140,16,3
za 116,180,80
zo 100,21
zo 102,22
zb 104,21,16
za 116,204,84
zb 106,22,16
zb 108,21,64
zb 110,22,64
za 120,160,76
zb 112,21,80
zb 114,22,80
zb 116,21,128
za 120,184,80
zb 118,22,128
zb 120,21,144
zb 122,22,144
za 120,208,84
zar 141,16,5
zar 142,19,3
zar 143,19,5
za 124,164,76
zk 88,25,13312
za 124,188,80
ze 11
zk 116,25,2048
zh 124,100,140
ze 10
zk 120,25,3072
zh 128,104,140
ze 2
s_barrier
zh 132,108,140
zh 136,112,140
zv
zc 88,124,125
zc 89,126,127
za 124,212,84
za 128,168,76
zc 90,128,129
zc 91,130,131
zc 92,132,133
zh 124,116,140
zb0
zk 124,25,4096
zc 93,134,135
zh 128,120,140
zc 94,136,137
zc 95,138,139
za 128,192,80
zc 96,124,125
zc 97,126,127
za 128,216,84
za 108,148,76
zv
zc 98,128,129
zc 99,130,131
za 108,172,80
za 108,196,84
za 112,152,76
zv
zk 128,25,5120
za 112,176,80
zbl
zfr 108,25
za 112,200,84
Lf11_ayH7:
Lf11_ayG7:
zf7
s_cbranch_scc1 Lf11_ayS7
zdy
s_cbranch_scc0 Lf11_ayRb7
za 140,156,88
zaa 21,11,6
zaa 22,14,6
zab 140,17,3
za 140,180,92
zo 100,21
zo 102,22
zb 104,21,16
za 140,204,96
zb 106,22,16
zb 108,21,64
zb 110,22,64
za 144,160,88
zb 112,21,80
zb 114,22,80
zb 116,21,128
za 144,184,92
zb 118,22,128
zb 120,21,144
zb 122,22,144
za 144,208,96
zab 141,17,5
zab 142,20,3
zab 143,20,5
za 148,164,88
zk 112,25,1024
za 148,188,92
ze 11
zk 140,25,8192
zh 124,100,140
ze 10
zk 144,25,9216
zh 128,104,140
ze 2
s_barrier
zh 132,108,140
zh 136,112,140
zv
zc 76,124,125
zc 77,126,127
za 148,212,96
za 152,168,88
zc 78,128,129
zc 79,130,131
zc 80,132,133
zh 124,116,140
zb0
zk 148,25,10240
zc 81,134,135
zh 128,120,140
zc 82,136,137
zc 83,138,139
za 152,192,92
zc 84,124,125
zc 85,126,127
za 152,216,96
za 132,148,88
zv
zc 86,128,129
zc 87,130,131
za 132,172,92
za 132,196,96
za 136,152,88
zv
zk 152,25,11264
za 136,176,92
zbl
zk 132,25,6144
za 136,200,96
Lf11_ayH8:
Lf11_ayG8:
ze7
s_cbranch_scc1 Lf11_ayS8
zc1
s_cbranch_scc0 Lf11_ayRb8
za 164,156,76
zac 21,11,6
zac 22,14,6
zad 140,17,3
za 164,180,80
zo 100,21
zo 102,22
zb 104,21,16
za 164,204,84
zb 106,22,16
zb 108,21,64
zb 110,22,64
za 168,160,76
zb 112,21,80
zb 114,22,80
zb 116,21,128
za 168,184,80
zb 118,22,128
zb 120,21,144
zb 122,22,144
za 168,208,84
zad 141,17,5
zad 142,20,3
zad 143,20,5
za 172,164,76
zk 136,25,7168
za 172,188,80
ze 11
zk 164,25,14336
zh 124,100,140
ze 10
zk 168,25,15360
zh 128,104,140
ze 2
s_barrier
zh 132,108,140
zh 136,112,140
zv
zc 88,124,125
zc 89,126,127
za 172,212,84
za 176,168,76
zc 90,128,129
zc 91,130,131
zc 92,132,133
zh 124,116,140
zb0
zk 172,25,16384
zc 93,134,135
zh 128,120,140
zc 94,136,137
zc 95,138,139
za 176,192,80
zc 96,124,125
zc 97,126,127
za 176,216,84
za 156,148,76
zv
zc 98,128,129
zc 99,130,131
za 156,172,80
za 156,196,84
za 160,152,76
zv
zk 176,25,17408
za 160,176,80
zbl
zk 156,25,12288
za 160,200,84
Lf11_ayH9:
Lf11_ayG9:
zgy
s_cbranch_scc1 Lf11_ayS9
ze6
s_cbranch_scc0 Lf11_ayRb9
za 188,156,88
zaj 21,11,6
zaj 22,14,6
zak 140,17,3
za 188,180,92
zo 100,21
zo 102,22
zb 104,21,16
za 188,204,96
zb 106,22,16
zb 108,21,64
zb 110,22,64
za 192,160,88
zb 112,21,80
zb 114,22,80
zb 116,21,128
za 192,184,92
zb 118,22,128
zb 120,21,144
zb 122,22,144
za 192,208,96
zak 141,17,5
zak 142,20,3
zak 143,20,5
za 196,164,88
zk 160,25,13312
za 196,188,92
ze 11
zk 188,25,2048
zh 124,100,140
ze 10
zk 192,25,3072
zh 128,104,140
ze 2
s_barrier
zh 132,108,140
zh 136,112,140
zv
zc 76,124,125
zc 77,126,127
za 196,212,96
za 200,168,88
zc 78,128,129
zc 79,130,131
zc 80,132,133
zh 124,116,140
zb0
zk 196,25,4096
zc 81,134,135
zh 128,120,140
zc 82,136,137
zc 83,138,139
za 200,192,92
zc 84,124,125
zc 85,126,127
za 200,216,96
za 180,148,88
zv
zc 86,128,129
zc 87,130,131
za 180,172,92
za 180,196,96
za 184,152,88
zv
zk 200,25,5120
za 184,176,92
zbl
zfr 180,25
za 184,200,96
s_branch Lf11_ayR10
Lf11_ayE2:
Lf11_aqH0:
zu 19
s_barrier
Lf11_aqG0:
zct
s_cbranch_scc1 Lf11_aqS0
zcf
s_cbranch_scc0 Lf11_aqRb0
zaa 21,9,6
zaa 22,12,6
zab 140,15,3
zab 141,15,5
zab 142,18,3
zab 143,18,5
zo 100,21
zo 102,22
zb 104,21,16
zb 106,22,16
zb 108,21,64
zb 110,22,64
zb 112,21,80
zb 114,22,80
zb 116,21,128
zb 118,22,128
zb 120,21,144
zb 122,22,144
zu 13
zo 148,1
zb 150,1,1536
zo 152,2
zb 154,2,1536
zb 156,1,64
zb 158,1,1600
zb 160,2,64
zb 162,2,1600
zb 164,1,128
zb 166,1,1664
zb 168,2,128
zb 170,2,1664
zu 7
zb 172,1,6144
zb 174,1,7680
zb 176,2,6144
zb 178,2,7680
zb 180,1,6208
zb 182,1,7744
zb 184,2,6208
zb 186,2,7744
zb 188,1,6272
ze 15
zh 124,100,140
zb 190,1,7808
zb 192,2,6272
zb 194,2,7808
zh 128,104,140
zh 132,108,140
zh 136,112,140
zam
zc 76,124,125
zc 77,126,127
zam
zc 78,128,129
zc 79,130,131
zh 124,116,140
zc 80,132,133
zc 81,134,135
zc 82,136,137
zc 83,138,139
zh 128,120,140
zb0
zc 84,124,125
zc 85,126,127
zb0
zc 86,128,129
zc 87,130,131
Lf11_aqE2:
s_branch Lf11_atH0
Lf11_atH0:
Lf11_atG0:
zd6
s_cbranch_scc1 Lf11_atS0
zda
s_cbranch_scc0 Lf11_atRb0
ze 15
zh 220,148,76
zac 21,9,6
zac 22,12,6
zad 140,15,3
zh 224,152,76
zo 100,21
zo 102,22
zb 104,21,16
zp 0,156,76
zb 106,22,16
zb 108,21,64
zb 110,22,64
zp 4,160,76
ze 15
zb 112,21,80
zb 114,22,80
zb 116,21,128
zp 8,164,76
zb 118,22,128
zb 120,21,144
zb 122,22,144
zp 12,168,76
zad 141,15,5
zad 142,18,3
zad 143,18,5
zf 220,172,80
zu 1
zb 196,1,12288
zb 198,1,13824
zb 200,2,12288
ze 15
zf 224,176,80
ze 13
zb 202,2,13824
zb 204,1,12352
zb 206,1,13888
zh 124,100,140
ze 14
zb 208,2,12352
zb 210,2,13888
zb 212,1,12416
zh 128,104,140
ze 15
zb 214,1,13952
zb 216,2,12416
zb 218,2,13952
zh 132,108,140
zf1
zcv
zcw 0xdf
zbt 0xa800
zdd 0x9000
zc 88,124,125
zc 89,126,127
ze 12
zh 136,112,140
zc 90,128,129
zc 91,130,131
zh 124,116,140
zc 92,132,133
zc 93,134,135
zh 128,120,140
zam
zc 94,136,137
zc 95,138,139
za 0,180,80
zcx
zv
zae 25
za 4,184,80
zc 96,124,125
zc 97,126,127
za 8,188,80
zc 98,128,129
zc 99,130,131
za 12,192,80
zan 0x400
zv
zae 26
ze 0
zf 220,196,84
zan 0x800
zv
zae 27
zf 224,200,84
zan 0xc00
zv
zae 28
za 0,204,84
zcy 0x3fffffff
zan 0x1000
zv
zae 29
zcz
za 4,208,84
za 8,212,84
za 12,216,84
Lf11_atH1:
Lf11_atG1:
zd7
s_cbranch_scc1 Lf11_atS1
zdb
s_cbranch_scc0 Lf11_atRb1
ze 0
zh 228,148,88
zaj 21,9,6
zaj 22,12,6
zak 140,15,3
zf 228,172,92
zo 100,21
zo 102,22
zb 104,21,16
zf 228,196,96
zb 106,22,16
zb 108,21,64
zb 110,22,64
zh 232,152,88
zb 112,21,80
zb 114,22,80
zb 116,21,128
zf 232,176,92
zb 118,22,128
zb 120,21,144
zb 122,22,144
zf 232,200,96
zak 141,15,5
zak 142,18,3
zak 143,18,5
zp 16,156,88
zgj
zcv
zcw 0xdf
zbt 0xa800
zdd 0xd800
za 16,180,92
zcx
zv
zae 25
zan 0x400
zv
zae 26
ze 9
zh 124,100,140
zan 0x800
zv
zae 27
zan 0xc00
zv
zae 28
ze 1
zh 128,104,140
zcy 0x3fffffff
zan 0x1000
zv
zae 29
zcz
zh 132,108,140
zc 76,124,125
zc 77,126,127
zh 136,112,140
zc 78,128,129
zc 79,130,131
zh 124,116,140
ze 0
zv
zc 80,132,133
zc 81,134,135
zh 128,120,140
zc 82,136,137
zc 83,138,139
za 16,204,96
zc8 0x2bc00
zfi 68,35
zc 84,124,125
zp 20,160,88
zc 85,126,127
zc 86,128,129
za 20,184,92
zu 11
zc 87,130,131
zx 36,62
za 20,208,96
zr 37,62
zci 38,48
zp 24,164,88
zbs 39,33
z2 38
za 24,188,92
z2 39
zg 36,38
za 24,212,96
zg 37,39
zs 38
zp 28,168,88
zbr 0x13800
zdw 1
zdw 2
za 28,192,92
za 28,216,96
Lf11_atH2:
zu 6
s_barrier
Lf11_atG2:
zd8
s_cbranch_scc1 Lf11_atS2
zdc
s_cbranch_scc0 Lf11_atRb2
ze 0
zh 236,148,76
zaq 21,9,6
zaq 22,12,6
zar 140,15,3
zar 141,15,5
zf 236,172,80
zo 100,21
zo 102,22
zb 104,21,16
zb 106,22,16
zf 236,196,84
zb 108,21,64
zb 110,22,64
zb 112,21,80
zb 114,22,80
zh 240,152,76
zb 116,21,128
zb 118,22,128
zb 120,21,144
zb 122,22,144
zf 240,176,80
s_add_u32 s97, s85, 16
zcv
zcw 0xdf
zbt 0xa800
zdd 0x12000
zar 142,18,3
zar 143,18,5
zf 240,200,84
zby
zgk
s_cselect_b32 s42, 0x25800, s42
zcx
zv
zae 25
zp 32,156,76
zan 0x400
zv
zae 26
zan 0x800
zv
zae 27
ze 5
zh 124,100,140
zan 0xc00
zv
zae 28
zcy 0x3fffffff
zan 0x1000
zv
zae 29
zcz
zh 128,104,140
zf2 32,35
zc 88,124,125
zc 89,126,127
zs 39
zh 132,108,140
ze 0
zs 36
zs 37
zq 38,39
zc 90,128,129
zh 136,112,140
zc 91,130,131
zq 36,37
zr 37,36
zc 92,132,133
zh 124,116,140
zc 93,134,135
zav 36,38
zv
zc 94,136,137
zc 95,138,139
zh 128,120,140
zaw 36
z3 45,37
z3 44,36
zc 96,124,125
za 32,180,80
zc 97,126,127
z4 47,37,45
z4 46,36,44
zc 98,128,129
za 32,204,84
zc 99,130,131
zci 38,48
z2 38
zd1 39,49
zp 36,160,76
zd2 38,39
zax 47
z5 36,46
za 36,184,80
z5 37,47
zd3 40,44,49,38
zay 41,45,50
za 36,208,84
zw 38,36,37
zaz 36,47
za0 37,46
zp 40,164,76
zw 39,46,47
za1 41,45
za2 41,51
za 40,188,80
za3 36,37
zas 37
za4 41,40
za 40,212,84
zq 38,39
zq 36,37
za5 37,52
zp 44,168,76
zca 40,44
zcb 39
za6 10,41
z8 16,38,7
za 44,192,80
z8 19,36,7
zcc
zau 13,37,10
zcd
za 44,216,84
zce
Lf11_atH3:
Lf11_atG3:
zdt
s_cbranch_scc1 Lf11_atS3
zc5
s_cbranch_scc0 Lf11_atRb3
ze 0
zh 244,148,88
zaa 21,10,6
zaa 22,13,6
zf 244,172,92
zo 100,21
zo 102,22
zf 244,196,96
zb 104,21,16
zb 106,22,16
zh 248,152,88
zb 108,21,64
zb 110,22,64
zf 248,176,92
zb 112,21,80
zb 114,22,80
zf 248,200,96
zb 116,21,128
zb 118,22,128
zp 48,156,88
zb 120,21,144
zb 122,22,144
za 48,180,92
zab 140,16,3
zab 141,16,5
za 48,204,96
zab 142,19,3
zab 143,19,5
zp 52,160,88
ze5
zc6 60,35,16
z6 0x3000
zc7 0x3000
z0 42
ze 10
zh 124,100,140
ze 8
zn 43,1024
zh 128,104,140
ze 6
zn 53,2048
zh 132,108,140
ze 4
zh 136,112,140
zc 76,124,125
zc 77,126,127
za 52,184,92
ze 0
zc 78,128,129
zc 79,130,131
zh 124,116,140
zc 80,132,133
zc 81,134,135
zh 128,120,140
zc 82,136,137
zc 83,138,139
za 52,208,96
zp 56,164,88
zv
zc 84,124,125
zc 85,126,127
za 56,188,92
zc 86,128,129
zc 87,130,131
za 56,212,96
zp 60,168,88
za 60,192,92
za 60,216,96
Lf11_atH4:
Lf11_atG4:
zc2
s_cbranch_scc1 Lf11_atS4
zc0
s_cbranch_scc0 Lf11_atRb4
ze 0
zh 252,148,76
zac 21,10,6
zac 22,13,6
zad 140,16,3
zf 252,172,80
zo 100,21
zo 102,22
zb 104,21,16
zf 252,196,84
zb 106,22,16
zb 108,21,64
zb 110,22,64
zp 64,152,76
zb 112,21,80
zb 114,22,80
zb 116,21,128
za 64,176,80
zb 118,22,128
zb 120,21,144
zb 122,22,144
za 64,200,84
zad 141,16,5
zad 142,19,3
zad 143,19,5
zp 68,156,76
zc8 0x15e00
zc6 66,35,16
z6 0x3000
zc7 0x3000
zn 42,3072
za 68,180,80
z6 0x4000
zc7 0x4000
z0 43
ze 10
zh 124,100,140
zu 13
zn 53,1024
zx 36,68
ze 6
zh 128,104,140
zr 37,68
zcl 38,48
zbs 39,33
zh 132,108,140
ze 1
zc 88,124,125
zc 89,126,127
z2 38
zh 136,112,140
zc 90,128,129
zc 91,130,131
z2 39
zh 124,116,140
ze 0
zc 92,132,133
zc 93,134,135
zg 36,38
zh 128,120,140
zc 94,136,137
zc 95,138,139
za 68,204,84
zc 96,124,125
zc 97,126,127
zp 72,160,76
zg 37,39
zv
zc 98,128,129
za 72,184,80
zc 99,130,131
zs 38
za 72,208,84
zs 39
zs 36
zex 76,164
zs 37
zq 38,39
za 76,188,80
zq 36,37
zr 37,36
za 76,212,84
zav 36,38
zaw 36
zp 80,168,76
z3 45,37
z3 44,36
z7 80,192
z4 47,37,45
z4 46,36,44
za 80,216,84
Lf11_atH5:
Lf11_atG5:
zey
s_cbranch_scc1 Lf11_atS5
zd4
s_cbranch_scc0 Lf11_atRb5
ze 0
zp 84,148,88
zaj 21,10,6
zaj 22,13,6
zak 140,16,3
za 84,172,92
zo 100,21
zo 102,22
zb 104,21,16
za 84,196,96
zb 106,22,16
zb 108,21,64
zb 110,22,64
zex 88,152
zb 112,21,80
zb 114,22,80
zb 116,21,128
za 88,176,92
zb 118,22,128
zb 120,21,144
zb 122,22,144
za 88,200,96
zak 141,16,5
zak 142,19,3
zak 143,19,5
zp 92,156,88
zc8 0x2bc00
zc6 72,35,16
zcg
zcu
z0 42
z7 92,180
ze 10
zn 43,1024
zn 53,2048
zh 124,100,140
ze 8
zcl 38,48
z2 38
zd1 39,49
zh 128,104,140
ze 5
zd2 38,39
zax 47
z5 36,46
zh 132,108,140
ze 1
zc 76,124,125
zc 77,126,127
z5 37,47
zh 136,112,140
zc 78,128,129
zc 79,130,131
zd3 40,44,49,38
zh 124,116,140
ze 0
zc 80,132,133
zc 81,134,135
zay 41,45,50
zh 128,120,140
zc 82,136,137
zc 83,138,139
zw 38,36,37
za 92,204,96
zc 84,124,125
zc 85,126,127
zaz 36,47
zp 96,160,88
zc 86,128,129
zc 87,130,131
za0 37,46
za 96,184,92
zw 39,46,47
za1 41,45
z7 96,208
za2 41,51
za3 36,37
zp 100,164,88
zas 37
za4 41,40
za 100,188,92
zq 38,39
zq 36,37
za 100,212,96
za5 37,52
zcm 40,44
zp 104,168,88
zcn 39
za6 11,41
za 104,192,92
z8 17,38,7
z8 20,36,7
za 104,216,96
zco
Lf11_atH6:
s_barrier
Lf11_atG6:
zez
s_cbranch_scc1 Lf11_atS6
zd5
s_cbranch_scc0 Lf11_atRb6
ze 0
zp 108,148,76
zaq 21,10,6
zaq 22,13,6
zar 140,16,3
za 108,172,80
zo 100,21
zo 102,22
zb 104,21,16
za 108,196,84
zb 106,22,16
zb 108,21,64
zb 110,22,64
zp 112,152,76
zb 112,21,80
zb 114,22,80
zb 116,21,128
za 112,176,80
zb 118,22,128
zb 120,21,144
zb 122,22,144
za 112,200,84
zar 141,16,5
zar 142,19,3
zar 143,19,5
zp 116,156,76
zn 42,3072
z6 0x1000
zag 0x1000
z0 43
za 116,180,80
ze 10
zn 53,1024
zau 14,37,11
zh 124,100,140
zcp
zcq
zx 36,57
zr 37,57
ze 6
zh 128,104,140
zdx 38,48
zcj 39,33
z2 38
zh 132,108,140
ze 2
zc 88,124,125
zc 89,126,127
z2 39
zh 136,112,140
zc 90,128,129
zc 91,130,131
zg 36,38
zh 124,116,140
ze 0
zc 92,132,133
zc 93,134,135
zg 37,39
zh 128,120,140
zc 94,136,137
zc 95,138,139
zs 38
za 116,204,84
zc 96,124,125
zc 97,126,127
zs 39
zp 120,160,76
zc 98,128,129
zc 99,130,131
zs 36
za 120,184,80
zs 37
zq 38,39
zq 36,37
za 120,208,84
zr 37,36
zav 36,38
zaw 36
zp 124,164,76
z3 45,37
z3 44,36
za 124,188,80
z4 47,37,45
z4 46,36,44
za 124,212,84
zax 47
z5 36,46
zp 128,168,76
z5 37,47
zbg 40,44,49
za 128,192,80
zay 41,45,50
zw 38,36,37
za 128,216,84
Lf11_atH7:
Lf11_atG7:
zf7
s_cbranch_scc1 Lf11_atS7
zdy
s_cbranch_scc0 Lf11_atRb7
ze 0
zp 132,148,88
zaa 21,11,6
zaa 22,14,6
zab 140,17,3
za 132,172,92
zo 100,21
zo 102,22
zb 104,21,16
za 132,196,96
zb 106,22,16
zb 108,21,64
zb 110,22,64
zp 136,152,88
zb 112,21,80
zb 114,22,80
zb 116,21,128
za 136,176,92
zb 118,22,128
zb 120,21,144
zb 122,22,144
za 136,200,96
zab 141,17,5
zab 142,20,3
zab 143,20,5
zp 140,156,88
zn 42,2048
zn 43,3072
za 140,180,92
z6 0x2000
zag 0x2000
z0 53
ze 10
zh 124,100,140
ze 8
zaz 36,47
za0 37,46
zw 39,46,47
zh 128,104,140
ze 6
za1 41,45
za2 41,51
za3 36,37
zh 132,108,140
ze 3
zc 76,124,125
zc 77,126,127
zas 37
zh 136,112,140
ze 0
zc 78,128,129
zc 79,130,131
za4 41,40
zh 124,116,140
zc 80,132,133
zc 81,134,135
zq 38,39
zh 128,120,140
zc 82,136,137
zc 83,138,139
zq 36,37
za 140,204,96
zc 84,124,125
zc 85,126,127
za5 37,52
zp 144,160,88
zc 86,128,129
zc 87,130,131
zdf 40,44
za 144,184,92
zdg 39
za6 9,41
z8 15,38,7
za 144,208,96
z8 18,36,7
zdh
zp 148,164,88
zau 12,37,9
zdi
zdj
za 148,188,92
zx 36,63
zr 37,63
zfl 38,48
za 148,212,96
zcj 39,33
z2 38
z2 39
zp 152,168,88
zg 36,38
zg 37,39
za 152,192,92
zs 38
zs 39
za 152,216,96
Lf11_atH8:
Lf11_atG8:
ze7
s_cbranch_scc1 Lf11_atS8
zc1
s_cbranch_scc0 Lf11_atRb8
ze 0
zp 156,148,76
zac 21,11,6
zac 22,14,6
zad 140,17,3
zp 160,152,76
zo 100,21
zo 102,22
zb 104,21,16
zp 164,156,76
zb 106,22,16
zb 108,21,64
zb 110,22,64
zp 168,160,76
zb 112,21,80
zb 114,22,80
zb 116,21,128
zp 172,164,76
zb 118,22,128
zb 120,21,144
zb 122,22,144
zp 176,168,76
zad 141,17,5
zad 142,20,3
zad 143,20,5
za 156,172,80
zn 42,1024
zn 43,2048
za 160,176,80
ze 10
zn 53,3072
zs 36
zh 124,100,140
ze 8
zs 37
zq 38,39
zq 36,37
zh 128,104,140
ze 6
zr 37,36
zav 36,38
zaw 36
zh 132,108,140
ze 3
zc 88,124,125
zc 89,126,127
z3 45,37
zh 136,112,140
ze 0
zc 90,128,129
zc 91,130,131
z3 44,36
zh 124,116,140
zc 92,132,133
zc 93,134,135
z4 47,37,45
zh 128,120,140
zc 94,136,137
zc 95,138,139
z4 46,36,44
za 164,180,80
zc 76,124,125
zc 77,126,127
zax 47
za 168,184,80
zc 78,128,129
zc 79,130,131
z5 36,46
za 172,188,80
z5 37,47
zbg 40,44,49
zay 41,45,50
za 176,192,80
zw 38,36,37
zaz 36,47
za0 37,46
za 156,196,84
zw 39,46,47
za1 41,45
za2 41,51
za 160,200,84
za3 36,37
zas 37
za4 41,40
za 164,204,84
zq 38,39
zq 36,37
za 168,208,84
za5 37,52
zca 40,44
za 172,212,84
zcb 39
za6 10,41
za 176,216,84
Lf11_atH9:
Lf11_atG9:
zgy
s_cbranch_scc1 Lf11_atS9
ze6
s_cbranch_scc0 Lf11_atRb9
ze 0
zp 180,148,88
zaj 21,11,6
zaj 22,14,6
zak 140,17,3
zak 141,17,5
zp 184,152,88
zo 100,21
zo 102,22
zb 104,21,16
zb 106,22,16
zp 188,156,88
zb 108,21,64
zb 110,22,64
zb 112,21,80
zb 114,22,80
zp 192,160,88
zb 116,21,128
zb 118,22,128
zb 120,21,144
zb 122,22,144
zp 196,164,88
zak 142,20,3
zak 143,20,5
z8 16,38,7
z8 19,36,7
zp 200,168,88
zcc
zau 13,37,10
zcd
zce
zu 21
zx 36,32
za 180,172,92
ze 10
zr 37,32
zf3 38,48
ze2 39,33
z2 38
zh 124,100,140
ze 8
z2 39
zg 36,38
zg 37,39
zs 38
zh 128,104,140
ze 6
zs 39
zs 36
zs 37
zc 84,124,125
zh 132,108,140
ze 1
zc 85,126,127
zq 38,39
zq 36,37
zc 86,128,129
zh 136,112,140
zc 87,130,131
zr 37,36
zav 36,38
zh 124,116,140
ze 0
zc 96,132,133
zc 97,134,135
zaw 36
zh 128,120,140
zc 98,136,137
zc 99,138,139
z3 45,37
za 184,176,92
zc 88,124,125
zc 89,126,127
z3 44,36
za 188,180,92
zc 90,128,129
zc 91,130,131
z4 47,37,45
za 192,184,92
z4 46,36,44
zax 47
z5 36,46
za 196,188,92
z5 37,47
zbg 40,44,49
zay 41,45,50
za 200,192,92
zw 38,36,37
zaz 36,47
za0 37,46
za 180,196,76
zw 39,46,47
za1 41,45
za2 41,51
za 184,200,76
za3 36,37
zas 37
za4 41,40
za 188,204,76
zq 38,39
zq 36,37
za5 37,52
za 192,208,76
zcm 40,44
zcn 39
za6 11,41
z8 17,38,7
za 196,212,76
z8 20,36,7
zco
zau 14,37,11
zcp
za 200,216,76
zcq
Lf11_atH10:
zu 13
s_barrier
Lf11_atG10:
zf7
s_cbranch_scc1 Lf11_atS10
zdy
s_cbranch_scc0 Lf11_atRb10
ze 0
zp 204,148,84
zf4 8,0
zaa 21,11,6
zaa 22,14,6
zp 208,152,84
zo 100,21
zo 102,22
zb 104,21,16
zp 212,156,84
zb 106,22,16
zb 108,21,64
zb 110,22,64
zp 216,160,84
zb 112,21,80
zb 114,22,80
zb 116,21,128
zp 220,164,84
zb 118,22,128
zb 120,21,144
zb 122,22,144
zp 224,168,84
zab 140,17,3
zab 141,17,5
zab 142,20,3
za 204,172,96
zb 148,1,12288
zb 150,1,13824
zab 143,20,5
za 208,176,96
ze 12
zb 152,2,12288
zb 154,2,13824
zb 156,1,12352
zh 124,100,140
ze 13
zb 158,1,13888
zb 160,2,12352
zb 162,2,13888
zh 128,104,140
ze 14
zb 164,1,12416
zb 166,1,13952
zh 132,108,140
ze 14
zc 76,124,125
zc 77,126,127
zh 136,112,140
zb 168,2,12416
zc 78,128,129
za 212,180,96
ze 11
zc 79,130,131
zc 80,132,133
zh 124,116,140
zc 81,134,135
zc 82,136,137
zh 128,120,140
zb 170,2,13952
zc 83,138,139
za 216,184,96
za 220,188,96
zv
zc 84,124,125
zc 85,126,127
za 224,192,96
zb 172,1,30720
zc 86,128,129
zc 87,130,131
za 204,196,88
zb 174,1,32256
zb 176,2,30720
zb 178,2,32256
za 208,200,88
zb 180,1,30784
zb 182,1,32320
za 212,204,88
zb 184,2,30784
zb 186,2,32320
za 216,208,88
zb 188,1,30848
zb 190,1,32384
za 220,212,88
zb 192,2,30848
zb 194,2,32384
za 224,216,88
Lf11_atE2:
zfz
s_cbranch_scc1 Lf11_as1H0
zf0
s_cbranch_scc1 Lf11_as2H0
zde
s_cbranch_scc1 Lf11_as3H0
s_branch Lf11_as0H0
Lf11_as0H0:
Lf11_as0G0:
ze7
s_cbranch_scc1 Lf11_as0S0
zc1
s_cbranch_scc0 Lf11_as0Rb0
ze 15
zf 220,148,76
zac 21,11,6
zac 22,14,6
zad 140,17,3
zad 141,17,5
zf 224,152,76
zo 100,21
zo 102,22
zb 104,21,16
zb 106,22,16
za 0,156,76
zb 108,21,64
zb 110,22,64
zb 112,21,80
za 4,160,76
ze 15
zb 114,22,80
zb 116,21,128
zb 118,22,128
za 8,164,76
zb 120,21,144
zb 122,22,144
zad 142,20,3
za 12,168,76
ze 14
zb 204,1,49216
zb 206,1,50752
zad 143,20,5
zf 220,188,80
ze 14
zb 208,2,49216
zb 210,2,50752
zb 212,1,49280
zf 224,192,80
ze 15
zb 214,1,50816
zb 216,2,49280
zb 218,2,50816
zh 124,100,140
ze 15
zb 196,1,49152
zb 198,1,50688
zb 200,2,49152
zh 128,104,140
ze 15
zb 202,2,50688
zbr 0x13800
zbb 1
zbb 2
zh 132,108,140
zc 88,124,125
zc 89,126,127
zb2 54
zh 136,112,140
ze 12
zc 90,128,129
zc 91,130,131
zb3 54
zh 124,116,140
zc 92,132,133
zc 93,134,135
zbz 25,54
zh 128,120,140
zbc 0x5800
zbw
zbd
zc 94,136,137
zc 95,138,139
za 0,172,80
zbe
zc 76,124,125
zc 77,126,127
zal 28,54
za 4,176,80
zc 78,128,129
zc 79,130,131
ze 0
s_barrier
za 8,180,80
z6 0x3000
zag 0x3000
z0 42
zn 43,1024
za 12,184,80
zn 53,2048
zn 42,3072
zf 220,204,84
z6 0x4000
zag 0x4000
z0 43
zf 224,208,84
zbc 0x9800
zn 53,1024
zby
zbd
za 0,212,84
zbe
zal 29,54
zb5
zb6 0x21000
za 4,216,84
zal 30,54
zb7 54
zbv 26,4
za 8,196,84
zbk 26,54
zb8
za 12,200,84
zb9 26
Lf11_as0H1:
Lf11_as0G1:
zgy
s_cbranch_scc1 Lf11_as0S1
ze6
s_cbranch_scc0 Lf11_as0Rb1
ze 0
zf 228,148,88
zaj 21,11,6
zaj 22,14,6
zf 232,152,88
zo 100,21
zo 102,22
za 16,156,88
zb 104,21,16
zb 106,22,16
za 20,160,88
zb 108,21,64
zb 110,22,64
za 24,164,88
zb 112,21,80
zb 114,22,80
za 28,168,88
zb 116,21,128
zb 118,22,128
zf 228,188,92
zb 120,21,144
zb 122,22,144
zf 232,192,92
zak 140,17,3
zak 141,17,5
za 16,172,92
zak 142,20,3
zak 143,20,5
za 20,176,92
za 24,180,92
ze 10
zh 124,100,140
ze 8
zh 128,104,140
ze 6
zh 132,108,140
ze 4
zh 136,112,140
zam
zc 84,124,125
zc 85,126,127
za 28,184,92
ze 2
zc 86,128,129
zc 87,130,131
zh 124,116,140
ze 0
zc 96,132,133
zc 97,134,135
zh 128,120,140
zc 98,136,137
zc 99,138,139
zf 228,204,76
zf 232,208,76
zc 88,124,125
zc 89,126,127
za 16,212,76
zv
zc 90,128,129
zc 91,130,131
za 20,216,76
za 24,196,76
za 28,200,76
Lf11_as0H2:
Lf11_as0G2:
zct
s_cbranch_scc1 Lf11_as0S2
zcf
s_cbranch_scc0 Lf11_as0Rb2
ze 0
zf 236,148,84
zbn
zbq 8,0
zaa 21,9,6
zaa 22,12,6
zf 240,152,84
zbo
zo 100,21
zo 102,22
zb 104,21,16
za 32,156,84
zbp
zb 106,22,16
zb 108,21,64
zb 110,22,64
za 36,160,84
zb 112,21,80
zb 114,22,80
zb 116,21,128
za 40,164,84
zb 118,22,128
zb 120,21,144
zb 122,22,144
za 44,168,84
zab 140,15,3
zab 141,15,5
zab 142,18,3
zf 236,188,96
zu 12
zo 148,1
zb 150,1,1536
zab 143,18,5
zf 240,192,96
ze 12
zo 152,2
zb 154,2,1536
zb 156,1,64
zh 124,100,140
ze 13
zb 158,1,1600
zb 160,2,64
zb 162,2,1600
zh 128,104,140
ze 14
zb 164,1,128
zb 166,1,1664
zh 132,108,140
ze 14
zc 76,124,125
zc 77,126,127
zh 136,112,140
zb 168,2,128
zc 78,128,129
za 32,172,96
ze 11
zc 79,130,131
zc 80,132,133
zh 124,116,140
zc 81,134,135
zc 82,136,137
zh 128,120,140
zb 170,2,1664
zc 83,138,139
za 36,176,96
za 40,180,96
zv
zc 84,124,125
zc 85,126,127
za 44,184,96
zu 6
zb 172,1,6144
zc 86,128,129
zc 87,130,131
zf 236,204,88
zb 174,1,7680
zb 176,2,6144
zb 178,2,7680
zf 240,208,88
zb 180,1,6208
zb 182,1,7744
za 32,212,88
zb 184,2,6208
zb 186,2,7744
za 36,216,88
zb 188,1,6272
zb 190,1,7808
za 40,196,88
zb 192,2,6272
zb 194,2,7808
za 44,200,88
Lf11_as0E2:
s_branch Lf11_amH0
Lf11_as1H0:
Lf11_as1G0:
ze7
s_cbranch_scc1 Lf11_as1S0
zc1
s_cbranch_scc0 Lf11_as1Rb0
ze 15
zf 244,156,76
zac 21,11,6
zac 22,14,6
zad 140,17,3
zad 141,17,5
zf 248,160,76
ze 14
zo 100,21
zo 102,22
zb 104,21,16
zb 106,22,16
za 48,164,76
ze 15
zb 108,21,64
zb 110,22,64
zb 112,21,80
za 52,168,76
zb 114,22,80
zb 116,21,128
zb 118,22,128
za 56,148,76
zb 120,21,144
zb 122,22,144
zad 142,20,3
za 60,152,76
ze 14
zb 212,1,49280
zb 214,1,50816
zad 143,20,5
zf 244,172,80
zb 216,2,49280
zb 218,2,50816
zb 196,1,49152
zf 248,176,80
ze 15
zb 198,1,50688
zb 200,2,49152
zb 202,2,50688
zh 124,100,140
ze 15
zb 204,1,49216
zb 206,1,50752
zb 208,2,49216
zh 128,104,140
ze 15
zb 210,2,50752
zbr 0x13800
zbb 1
zbb 2
zh 132,108,140
zc 88,124,125
zc 89,126,127
zb2 54
zh 136,112,140
ze 12
zc 90,128,129
zc 91,130,131
zb3 54
zh 124,116,140
zc 92,132,133
zc 93,134,135
zbz 25,54
zh 128,120,140
zbc 0x5800
zbw
zbd
zc 94,136,137
zc 95,138,139
za 48,180,80
zbe
zc 76,124,125
zc 77,126,127
zal 28,54
za 52,184,80
zc 78,128,129
zc 79,130,131
ze 0
s_barrier
za 56,188,80
z6 0x3000
zag 0x3000
z0 42
zn 43,1024
za 60,192,80
zn 53,2048
zn 42,3072
zf 244,212,84
z6 0x4000
zag 0x4000
z0 43
zf 248,216,84
zbc 0x9800
zn 53,1024
zby
zbd
za 48,196,84
zbe
zal 29,54
zb5
zb6 0x21000
za 52,200,84
zal 30,54
zb7 54
zbv 26,4
za 56,204,84
zbk 26,54
zb8
za 60,208,84
zb9 26
Lf11_as1H1:
Lf11_as1G1:
zgy
s_cbranch_scc1 Lf11_as1S1
ze6
s_cbranch_scc0 Lf11_as1Rb1
ze 0
zf 252,156,88
zaj 21,11,6
zaj 22,14,6
za 64,160,88
zo 100,21
zo 102,22
za 68,164,88
zb 104,21,16
zb 106,22,16
za 72,168,88
zb 108,21,64
zb 110,22,64
za 76,148,88
zb 112,21,80
zb 114,22,80
za 80,152,88
zb 116,21,128
zb 118,22,128
zf 252,172,92
zb 120,21,144
zb 122,22,144
za 64,176,92
zak 140,17,3
zak 141,17,5
za 68,180,92
zak 142,20,3
zak 143,20,5
za 72,184,92
za 76,188,92
ze 10
zh 124,100,140
ze 8
zh 128,104,140
ze 6
zh 132,108,140
ze 4
zh 136,112,140
zam
zc 84,124,125
zc 85,126,127
za 80,192,92
ze 2
zc 86,128,129
zc 87,130,131
zh 124,116,140
ze 0
zc 96,132,133
zc 97,134,135
zh 128,120,140
zc 98,136,137
zc 99,138,139
zf 252,212,76
za 64,216,76
zc 88,124,125
zc 89,126,127
za 68,196,76
zv
zc 90,128,129
zc 91,130,131
za 72,200,76
z7 76,204
za 80,208,76
Lf11_as1H2:
Lf11_as1G2:
zct
s_cbranch_scc1 Lf11_as1S2
zcf
s_cbranch_scc0 Lf11_as1Rb2
ze 0
z7 84,156
zbn
zbq 8,0
zaa 21,9,6
zaa 22,12,6
za 88,160,84
zbo
zo 100,21
zo 102,22
zb 104,21,16
za 92,164,84
zbp
zb 106,22,16
zb 108,21,64
zb 110,22,64
za 96,168,84
zb 112,21,80
zb 114,22,80
zb 116,21,128
za 100,148,84
zb 118,22,128
zb 120,21,144
zb 122,22,144
za 104,152,84
zab 140,15,3
zab 141,15,5
zab 142,18,3
za 84,172,96
zu 12
zo 148,1
zb 150,1,1536
zab 143,18,5
za 88,176,96
ze 12
zo 152,2
zb 154,2,1536
zb 156,1,64
zh 124,100,140
ze 13
zb 158,1,1600
zb 160,2,64
zb 162,2,1600
zh 128,104,140
ze 14
zb 164,1,128
zb 166,1,1664
zh 132,108,140
ze 14
zc 76,124,125
zc 77,126,127
zh 136,112,140
zb 168,2,128
zc 78,128,129
za 92,180,96
ze 11
zc 79,130,131
zc 80,132,133
zh 124,116,140
zc 81,134,135
zc 82,136,137
zh 128,120,140
zb 170,2,1664
zc 83,138,139
z7 96,184
za 100,188,96
zv
zc 84,124,125
zc 85,126,127
za 104,192,96
zu 6
zb 172,1,6144
zc 86,128,129
zc 87,130,131
za 84,212,88
zb 174,1,7680
zb 176,2,6144
zb 178,2,7680
z7 88,216
zb 180,1,6208
zb 182,1,7744
za 92,196,88
zb 184,2,6208
zb 186,2,7744
za 96,200,88
zb 188,1,6272
zb 190,1,7808
za 100,204,88
zb 192,2,6272
zb 194,2,7808
za 104,208,88
Lf11_as1E2:
s_branch Lf11_amH0
Lf11_as2H0:
Lf11_as2G0:
ze7
s_cbranch_scc1 Lf11_as2S0
zc1
s_cbranch_scc0 Lf11_as2Rb0
ze 14
za 108,164,76
ze 12
zac 21,11,6
zac 22,14,6
zad 140,17,3
zad 141,17,5
za 112,168,76
zo 100,21
zo 102,22
zb 104,21,16
zb 106,22,16
za 116,148,76
zb 108,21,64
zb 110,22,64
zb 112,21,80
za 120,152,76
zb 114,22,80
zb 116,21,128
zb 118,22,128
za 124,156,76
zb 120,21,144
zb 122,22,144
zad 142,20,3
za 128,160,76
ze 14
zb 196,1,49152
zb 198,1,50688
zad 143,20,5
za 108,180,80
zb 200,2,49152
zb 202,2,50688
zb 204,1,49216
za 112,184,80
ze 15
zb 206,1,50752
zb 208,2,49216
zb 210,2,50752
zh 124,100,140
ze 15
zb 212,1,49280
zb 214,1,50816
zb 216,2,49280
zh 128,104,140
ze 15
zb 218,2,50816
zbr 0x13800
zbb 1
zbb 2
zh 132,108,140
zc 88,124,125
zc 89,126,127
zb2 54
zh 136,112,140
ze 12
zc 90,128,129
zc 91,130,131
zb3 54
zh 124,116,140
zc 92,132,133
zc 93,134,135
zbz 25,54
zh 128,120,140
zbc 0x5800
zbw
zbd
zc 94,136,137
zc 95,138,139
za 116,188,80
zbe
zc 76,124,125
zc 77,126,127
zal 28,54
za 120,192,80
zc 78,128,129
zc 79,130,131
ze 0
s_barrier
za 124,172,80
z6 0x3000
zag 0x3000
z0 42
zn 43,1024
za 128,176,80
zn 53,2048
zn 42,3072
za 108,196,84
z6 0x4000
zag 0x4000
z0 43
za 112,200,84
zbc 0x9800
zn 53,1024
zby
zbd
za 116,204,84
zbe
zal 29,54
zb5
zb6 0x21000
za 120,208,84
zal 30,54
zb7 54
zbv 26,4
za 124,212,84
zbk 26,54
zb8
za 128,216,84
zb9 26
Lf11_as2H1:
Lf11_as2G1:
zgy
s_cbranch_scc1 Lf11_as2S1
ze6
s_cbranch_scc0 Lf11_as2Rb1
ze 0
za 132,164,88
zaj 21,11,6
zaj 22,14,6
za 136,168,88
zo 100,21
zo 102,22
za 140,148,88
zb 104,21,16
zb 106,22,16
za 144,152,88
zb 108,21,64
zb 110,22,64
za 148,156,88
zb 112,21,80
zb 114,22,80
za 152,160,88
zb 116,21,128
zb 118,22,128
za 132,180,92
zb 120,21,144
zb 122,22,144
za 136,184,92
zak 140,17,3
zak 141,17,5
za 140,188,92
zak 142,20,3
zak 143,20,5
za 144,192,92
za 148,172,92
ze 10
zh 124,100,140
ze 8
zh 128,104,140
ze 6
zh 132,108,140
ze 4
zh 136,112,140
zam
zc 84,124,125
zc 85,126,127
za 152,176,92
ze 2
zc 86,128,129
zc 87,130,131
zh 124,116,140
ze 0
zc 96,132,133
zc 97,134,135
zh 128,120,140
zc 98,136,137
zc 99,138,139
za 132,196,76
za 136,200,76
zc 88,124,125
zc 89,126,127
za 140,204,76
zv
zc 90,128,129
zc 91,130,131
za 144,208,76
za 148,212,76
za 152,216,76
Lf11_as2H2:
Lf11_as2G2:
zct
s_cbranch_scc1 Lf11_as2S2
zcf
s_cbranch_scc0 Lf11_as2Rb2
ze 0
za 156,164,84
zbn
zbq 8,0
zaa 21,9,6
zaa 22,12,6
za 160,168,84
zbo
zo 100,21
zo 102,22
zb 104,21,16
za 164,148,84
zbp
zb 106,22,16
zb 108,21,64
zb 110,22,64
za 168,152,84
zb 112,21,80
zb 114,22,80
zb 116,21,128
za 172,156,84
zb 118,22,128
zb 120,21,144
zb 122,22,144
za 176,160,84
zab 140,15,3
zab 141,15,5
zab 142,18,3
za 156,180,96
zu 12
zo 148,1
zb 150,1,1536
zab 143,18,5
za 160,184,96
ze 12
zo 152,2
zb 154,2,1536
zb 156,1,64
zh 124,100,140
ze 13
zb 158,1,1600
zb 160,2,64
zb 162,2,1600
zh 128,104,140
ze 14
zb 164,1,128
zb 166,1,1664
zh 132,108,140
ze 14
zc 76,124,125
zc 77,126,127
zh 136,112,140
zb 168,2,128
zc 78,128,129
za 164,188,96
ze 11
zc 79,130,131
zc 80,132,133
zh 124,116,140
zc 81,134,135
zc 82,136,137
zh 128,120,140
zb 170,2,1664
zc 83,138,139
za 168,192,96
zdm 172,96
zv
zc 84,124,125
zc 85,126,127
zdm 176,96
zu 6
zb 172,1,6144
zc 86,128,129
zc 87,130,131
za 156,196,88
zb 174,1,7680
zb 176,2,6144
zb 178,2,7680
za 160,200,88
zb 180,1,6208
zb 182,1,7744
za 164,204,88
zb 184,2,6208
zb 186,2,7744
za 168,208,88
zb 188,1,6272
zb 190,1,7808
za 172,212,88
zb 192,2,6272
zb 194,2,7808
za 176,216,88
Lf11_as2E2:
s_branch Lf11_amH0
Lf11_as3H0:
Lf11_as3G0:
ze7
s_cbranch_scc1 Lf11_as3S0
zc1
s_cbranch_scc0 Lf11_as3Rb0
ze 15
za 180,148,76
zac 21,11,6
zac 22,14,6
zad 140,17,3
za 184,152,76
zo 100,21
zo 102,22
zb 104,21,16
za 188,156,76
zb 106,22,16
zb 108,21,64
zb 110,22,64
za 192,160,76
ze 15
zb 112,21,80
zb 114,22,80
zb 116,21,128
za 196,164,76
zb 118,22,128
zb 120,21,144
zb 122,22,144
za 200,168,76
ze 14
zad 141,17,5
zad 142,20,3
zad 143,20,5
za 180,188,80
ze 12
zb 204,1,49216
zb 206,1,50752
zb 208,2,49216
za 184,192,80
ze 13
zb 210,2,50752
zb 212,1,49280
zb 214,1,50816
zh 124,100,140
ze 14
zb 216,2,49280
zb 218,2,50816
zb 196,1,49152
zh 128,104,140
ze 15
zb 198,1,50688
zb 200,2,49152
zb 202,2,50688
zh 132,108,140
ze 15
zc 88,124,125
zc 89,126,127
zbr 0x13800
zbb 1
zbb 2
zh 136,112,140
ze 12
zc 90,128,129
zc 91,130,131
zh 124,116,140
zc 92,132,133
zc 93,134,135
zh 128,120,140
zv
zc 94,136,137
zc 95,138,139
za 188,172,80
zb2 54
zc 96,124,125
za 192,176,80
zc 97,126,127
zc 98,128,129
za 196,180,80
zc 99,130,131
ze 0
s_barrier
zb3 54
za 200,184,80
zbz 25,54
zbc 0x5800
zbw
zbd
za 180,204,84
zbe
zal 28,54
zbc 0x9800
za 184,208,84
zby
zbd
zbe
za 188,212,84
zal 29,54
zb5
za 192,216,84
zb6 0x21000
zal 30,54
zb7 54
zbv 26,4
zdm 196,84
zbk 26,54
zb8
zdm 200,84
zb9 26
Lf11_as3H1:
Lf11_as3G1:
zct
s_cbranch_scc1 Lf11_as3S1
zcf
s_cbranch_scc0 Lf11_as3Rb1
ze 0
za 204,148,88
zbn
zbq 8,0
zaa 21,9,6
zaa 22,12,6
za 208,152,88
zbo
zo 100,21
zo 102,22
zb 104,21,16
za 212,156,88
zbp
zb 106,22,16
zb 108,21,64
zb 110,22,64
za 216,160,88
zb 112,21,80
zb 114,22,80
zb 116,21,128
za 220,164,88
zb 118,22,128
zb 120,21,144
zb 122,22,144
za 224,168,88
zab 140,15,3
zab 141,15,5
zab 142,18,3
za 204,188,92
zu 6
zo 148,1
zb 150,1,1536
zab 143,18,5
za 208,192,92
ze 12
zo 152,2
zb 154,2,1536
zb 156,1,64
zh 124,100,140
ze 13
zb 158,1,1600
zb 160,2,64
zb 162,2,1600
zh 128,104,140
ze 14
zb 164,1,128
zb 166,1,1664
zh 132,108,140
ze 14
zc 76,124,125
zc 77,126,127
zh 136,112,140
zb 168,2,128
zc 78,128,129
za 212,172,92
ze 11
zc 79,130,131
zc 80,132,133
zh 124,116,140
zc 81,134,135
zc 82,136,137
zh 128,120,140
zb 170,2,1664
zc 83,138,139
za 216,176,92
za 220,180,92
zv
zc 84,124,125
zc 85,126,127
za 224,184,92
zu 0
zb 172,1,6144
zc 86,128,129
zc 87,130,131
zdm 204,96
zb 174,1,7680
zb 176,2,6144
zb 178,2,7680
zdm 208,96
zb 180,1,6208
zb 182,1,7744
zdm 212,96
zb 184,2,6208
zb 186,2,7744
zdm 216,96
zb 188,1,6272
zb 190,1,7808
za 220,196,96
zb 192,2,6272
zb 194,2,7808
za 224,200,96
Lf11_as3E2:
s_branch Lf11_amH0
Lf11_amS0:
ze8
s_cbranch_scc0 Lf11_amY0
ze9
zap 0x5780
zao
s_call_b64 s[88:89], Lf11_far
s_branch Lf11_amXb0
Lf11_amY0:
zac 21,9,6
zac 22,12,6
za9 23,15
za9 24,18
s_call_b64 s[88:89], Lf11_four
Lf11_amXb0:
ze 15
zf 220,148,76
ze3
zd 88,100
zd 89,101
zf 224,152,76
zed
zd 90,102
zd 91,103
za 0,156,76
zee 0x4800
zd 92,104
zd 93,105
za 4,160,76
zef
zd 94,106
zd 95,107
ze 8
za 8,164,76
zeg
zd 96,108
zd 97,109
za 12,168,76
zeh 0x1200
zd 98,110
zd 99,111
zf 220,172,80
zei
zu 0
zb 196,1,12288
zb 198,1,13824
zf 224,176,80
zej 0xd0
zb 200,2,12288
zb 202,2,13824
ze 4
za 0,180,80
zek 0x12d0
zb 204,1,12352
zb 206,1,13888
za 4,184,80
zel
zb 208,2,12352
zb 210,2,13888
za 8,188,80
zem
zb 212,1,12416
zb 214,1,13952
za 12,192,80
zb 216,2,12416
zb 218,2,13952
zx 36,69
zr 37,69
zd 69,70
zen
zeo
ze 10
zf 220,196,84
ze 8
zf 224,200,84
ze 6
za 0,204,84
ze 4
za 4,208,84
ze 2
za 8,212,84
ze 0
za 12,216,84
s_branch Lf11_amH1
Lf11_amS1:
zfa
s_cbranch_scc0 Lf11_amY1
zfb
zap 0xaf00
zao
s_call_b64 s[88:89], Lf11_far
s_branch Lf11_amXb1
Lf11_amY1:
zaj 21,9,6
zaj 22,12,6
zbm 23,15
zbm 24,18
s_call_b64 s[88:89], Lf11_four
Lf11_amXb1:
zf 228,148,88
ze 0
zd 76,100
zd 77,101
zf 228,172,92
zd 78,102
zd 79,103
zf 228,196,96
zd 80,104
zd 81,105
zf 232,152,88
zd 82,106
zd 83,107
zf 232,176,92
zd 84,108
zd 85,109
zf 232,200,96
zd 86,110
zd 87,111
za 16,156,88
zcg
zcu
z0 42
za 16,180,92
zn 43,1024
za 16,204,96
zd 70,71
zd 71,72
za 20,160,88
zd 72,73
zcl 38,48
za 20,184,92
zbs 39,33
z2 38
za 20,208,96
z2 39
zg 36,38
za 24,164,88
zg 37,39
zs 38
za 24,188,92
zs 39
zs 36
za 24,212,96
zs 37
zq 38,39
za 28,168,88
zq 36,37
zr 37,36
za 28,192,92
za 28,216,96
s_branch Lf11_amH2
Lf11_amS2:
zfc
s_cbranch_scc0 Lf11_amY2
zfd
zap 0x10680
zao
s_call_b64 s[88:89], Lf11_far
s_branch Lf11_amXb2
Lf11_amY2:
zaq 21,9,6
zaq 22,12,6
zbu 23,15
zbu 24,18
s_call_b64 s[88:89], Lf11_four
Lf11_amXb2:
ze 0
zf 236,148,76
zd 88,100
zd 89,101
zf 236,172,80
zd 90,102
zd 91,103
zf 236,196,84
zd 92,104
zd 93,105
zf 240,152,76
zd 94,106
zd 95,107
zf 240,176,80
zd 96,108
zd 97,109
zf 240,200,84
zd 98,110
zd 99,111
za 32,156,76
zn 53,2048
za 32,180,80
zn 42,3072
za 32,204,84
zav 36,38
zaw 36
za 36,160,76
z3 45,37
z3 44,36
za 36,184,80
z4 47,37,45
z4 46,36,44
za 36,208,84
zax 47
z5 36,46
za 40,164,76
z5 37,47
zbg 40,44,49
za 40,188,80
zay 41,45,50
zw 38,36,37
za 40,212,84
zaz 36,47
za0 37,46
za 44,168,76
zw 39,46,47
za1 41,45
za 44,192,80
za2 41,51
za 44,216,84
s_branch Lf11_amH3
Lf11_amS3:
ze1
s_cbranch_scc0 Lf11_amY3
zfe
zap 0x15e00
zao
s_call_b64 s[88:89], Lf11_far
s_branch Lf11_amXb3
Lf11_amY3:
zaa 21,10,6
zaa 22,13,6
za8 23,16
za8 24,19
s_call_b64 s[88:89], Lf11_four
Lf11_amXb3:
ze 0
zf 244,148,88
zd 76,100
zd 77,101
zf 244,172,92
zd 78,102
zd 79,103
zf 244,196,96
zd 80,104
zd 81,105
zf 248,152,88
zd 82,106
zd 83,107
zf 248,176,92
zd 84,108
zd 85,109
zf 248,200,96
zd 86,110
zd 87,111
za 48,156,88
z6 0x1000
zag 0x1000
z0 43
za 48,180,92
zn 53,1024
za 48,204,96
za3 36,37
zas 37
za 52,160,88
za4 41,40
zq 38,39
za 52,184,92
zq 36,37
za5 37,52
za 52,208,96
zcm 40,44
zcn 39
za 56,164,88
za6 11,41
z8 17,38,7
za 56,188,92
z8 20,36,7
zco
za 56,212,96
zau 14,37,11
zcp
za 60,168,88
zcq
zx 36,58
za 60,192,92
za 60,216,96
s_branch Lf11_amH4
Lf11_amS4:
ze0
s_cbranch_scc0 Lf11_amY4
zfs
zap 0x1b580
zao
s_call_b64 s[88:89], Lf11_far
s_branch Lf11_amXb4
Lf11_amY4:
zac 21,10,6
zac 22,13,6
za9 23,16
za9 24,19
s_call_b64 s[88:89], Lf11_four
Lf11_amXb4:
ze 0
zf 252,148,76
zd 88,100
zd 89,101
zf 252,172,80
zd 90,102
zd 91,103
zf 252,196,84
zd 92,104
zd 93,105
za 64,152,76
zd 94,106
zd 95,107
za 64,176,80
zd 96,108
zd 97,109
za 64,200,84
zd 98,110
zd 99,111
za 68,156,76
zn 42,2048
za 68,180,80
zn 43,3072
za 68,204,84
z6 0x2000
zag 0x2000
z0 53
za 72,160,76
zr 37,58
zd 58,59
za 72,184,80
zd 59,60
zd 60,61
za 72,208,84
zdx 38,48
zcj 39,33
z7 76,164
z2 38
z2 39
za 76,188,80
zg 36,38
zg 37,39
za 76,212,84
zs 38
zs 39
za 80,168,76
zs 36
z7 80,192
za 80,216,84
s_branch Lf11_amH5
Lf11_amS5:
zft
s_cbranch_scc0 Lf11_amY5
zfu
zap 0x20d00
zao
s_call_b64 s[88:89], Lf11_far
s_branch Lf11_amXb5
Lf11_amY5:
zaj 21,10,6
zaj 22,13,6
zbm 23,16
zbm 24,19
s_call_b64 s[88:89], Lf11_four
Lf11_amXb5:
ze 0
za 84,148,88
zd 76,100
zd 77,101
za 84,172,92
zd 78,102
zd 79,103
za 84,196,96
zd 80,104
zd 81,105
z7 88,152
zd 82,106
zd 83,107
za 88,176,92
zd 84,108
zd 85,109
za 88,200,96
zd 86,110
zd 87,111
za 92,156,88
zn 42,1024
z7 92,180
zn 43,2048
za 92,204,96
zs 37
zq 38,39
za 96,160,88
zq 36,37
zr 37,36
za 96,184,92
zav 36,38
zaw 36
z7 96,208
z3 45,37
z3 44,36
za 100,164,88
z4 47,37,45
z4 46,36,44
za 100,188,92
zax 47
z5 36,46
za 100,212,96
z5 37,47
zbg 40,44,49
za 104,168,88
zay 41,45,50
zw 38,36,37
za 104,192,92
zaz 36,47
za 104,216,96
s_branch Lf11_amH6
Lf11_amS6:
zfv
s_cbranch_scc0 Lf11_amY6
zfw
zap 0x26480
zao
s_call_b64 s[88:89], Lf11_far
s_branch Lf11_amXb6
Lf11_amY6:
zaq 21,10,6
zaq 22,13,6
zbu 23,16
zbu 24,19
s_call_b64 s[88:89], Lf11_four
Lf11_amXb6:
ze 0
za 108,148,76
zd 88,100
zd 89,101
za 108,172,80
zd 90,102
zd 91,103
za 108,196,84
zd 92,104
zd 93,105
za 112,152,76
zd 94,106
zd 95,107
za 112,176,80
zd 96,108
zd 97,109
za 112,200,84
zd 98,110
zd 99,111
za 116,156,76
zn 53,3072
za 116,180,80
z6 0x3000
zag 0x3000
z0 42
za 116,204,84
za0 37,46
zw 39,46,47
za 120,160,76
za1 41,45
za2 41,51
za 120,184,80
za3 36,37
zas 37
za 120,208,84
za4 41,40
zq 38,39
za 124,164,76
zq 36,37
za5 37,52
za 124,188,80
zdf 40,44
zdg 39
za 124,212,84
za6 9,41
z8 15,38,7
za 128,168,76
z8 18,36,7
zdh
za 128,192,80
za 128,216,84
s_branch Lf11_amH7
Lf11_amS7:
zf8
s_cbranch_scc0 Lf11_amY7
zgl
zap 0x2bc00
zao
s_call_b64 s[88:89], Lf11_far
s_branch Lf11_amXb7
Lf11_amY7:
zaa 21,11,6
zaa 22,14,6
za8 23,17
za8 24,20
s_call_b64 s[88:89], Lf11_four
Lf11_amXb7:
ze 0
za 132,148,88
zd 76,100
zd 77,101
za 132,172,92
zd 78,102
zd 79,103
za 132,196,96
zd 80,104
zd 81,105
za 136,152,88
zd 82,106
zd 83,107
za 136,176,92
zd 84,108
zd 85,109
za 136,200,96
zd 86,110
zd 87,111
za 140,156,88
zn 43,1024
za 140,180,92
zn 53,2048
za 140,204,96
zau 12,37,9
zdi
za 144,160,88
zdj
zx 36,64
zr 37,64
za 144,184,92
zd 64,65
zd 65,66
za 144,208,96
zd 66,67
zfl 38,48
za 148,164,88
zcj 39,33
z2 38
za 148,188,92
z2 39
zg 36,38
za 148,212,96
zg 37,39
zs 38
za 152,168,88
zs 39
zs 36
za 152,192,92
za 152,216,96
s_branch Lf11_amH8
Lf11_amS8:
zff
s_cbranch_scc0 Lf11_amY8
zg7
zap 0x31380
zao
s_call_b64 s[88:89], Lf11_far
s_branch Lf11_amXb8
Lf11_amY8:
zac 21,11,6
zac 22,14,6
za9 23,17
za9 24,20
s_call_b64 s[88:89], Lf11_four
Lf11_amXb8:
ze 0
za 156,148,76
zd 88,100
zd 89,101
za 160,152,76
zd 90,102
zd 91,103
za 164,156,76
zd 92,104
zd 93,105
za 168,160,76
zd 94,106
zd 95,107
za 172,164,76
zn 42,3072
za 176,168,76
zd 76,108
zd 77,109
za 156,172,80
zd 78,110
zd 79,111
za 160,176,80
z6 0x4000
zag 0x4000
z0 43
za 164,180,80
zn 53,1024
za 168,184,80
zs 37
zq 38,39
za 172,188,80
zq 36,37
zr 37,36
za 176,192,80
zav 36,38
zaw 36
za 156,196,84
z3 45,37
z3 44,36
za 160,200,84
z4 47,37,45
z4 46,36,44
za 164,204,84
zax 47
z5 36,46
za 168,208,84
z5 37,47
za 172,212,84
za 176,216,84
s_branch Lf11_amH9
Lf11_amS9:
zgz
s_cbranch_scc0 Lf11_amY9
s_add_u32 s90, s64, 10
zap 0x36b00
zao
s_call_b64 s[88:89], Lf11_far
s_branch Lf11_amXb9
Lf11_amY9:
zaj 21,11,6
zaj 22,14,6
zbm 23,17
zbm 24,20
s_call_b64 s[88:89], Lf11_four
Lf11_amXb9:
ze 0
za 180,148,88
zd 84,100
zd 85,101
za 184,152,88
zd 86,102
zd 87,103
za 188,156,88
zd 96,104
zd 97,105
za 192,160,88
zd 98,106
zd 99,107
za 196,164,88
zbg 40,44,49
zay 41,45,50
za 200,168,88
zd 88,108
zd 89,109
za 180,172,92
zd 90,110
zd 91,111
za 184,176,92
zw 38,36,37
zaz 36,47
za 188,180,92
za0 37,46
zw 39,46,47
za 192,184,92
za1 41,45
za2 41,51
za 196,188,92
za3 36,37
zas 37
za 200,192,92
za4 41,40
zq 38,39
za 180,196,76
zq 36,37
za5 37,52
za 184,200,76
zca 40,44
zcb 39
za 188,204,76
za6 10,41
z8 16,38,7
za 192,208,76
z8 19,36,7
zcc
za 196,212,76
zau 13,37,10
zcd
za 200,216,76
zce
s_branch Lf11_amH10
Lf11_amS10:
zdz
s_cbranch_scc0 Lf11_amY10
zet
zeu
zev
s_call_b64 s[88:89], Lf11_far
s_branch Lf11_amXb10
Lf11_amY10:
zaa 21,9,6
zaa 22,12,6
za8 23,15
za8 24,18
s_call_b64 s[88:89], Lf11_four
Lf11_amXb10:
ze 0
za 204,148,84
zbn
zbq 8,0
zd 76,100
zd 77,101
za 208,152,84
zbo
zd 78,102
zd 79,103
zd 80,104
za 212,156,84
zbp
zd 81,105
zd 82,106
zd 83,107
za 216,160,84
zf5
za 220,164,84
za 224,168,84
zd 84,108
zd 85,109
zd 86,110
za 204,172,96
zu 12
zo 148,1
zb 150,1,1536
zd 87,111
za 208,176,96
zo 152,2
zb 154,2,1536
zb 156,1,64
za 212,180,96
zb 158,1,1600
zb 160,2,64
zb 162,2,1600
za 216,184,96
zb 164,1,128
zb 166,1,1664
za 220,188,96
zb 168,2,128
zb 170,2,1664
za 224,192,96
zu 6
zb 172,1,6144
zb 174,1,7680
za 204,196,88
zb 176,2,6144
zb 178,2,7680
za 208,200,88
zb 180,1,6208
zb 182,1,7744
za 212,204,88
zb 184,2,6208
zb 186,2,7744
za 216,208,88
zb 188,1,6272
zb 190,1,7808
za 220,212,88
zb 192,2,6272
zb 194,2,7808
za 224,216,88
s_branch Lf11_amE2
Lf11_azS0:
ze8
s_cbranch_scc0 Lf11_azY0
ze9
zap 0x5780
zao
s_call_b64 s[88:89], Lf11_far
s_branch Lf11_azXb0
Lf11_azY0:
zac 21,9,6
zac 22,12,6
za9 23,15
za9 24,18
s_call_b64 s[88:89], Lf11_four
Lf11_azXb0:
zd 88,100
zd 89,101
zd 90,102
zd 91,103
ze 15
za 0,156,76
zd 92,104
zd 93,105
zd 94,106
zd 95,107
zd 96,108
za 4,160,76
zu 0
zb 204,1,12352
zb 206,1,13888
zd 97,109
zd 98,110
zd 99,111
ze 10
za 8,164,76
zb 208,2,12352
zb 210,2,13888
zb 212,1,12416
zb 214,1,13952
zb 216,2,12416
za 12,168,76
zb 218,2,13952
zb 196,1,12288
zb 198,1,13824
zb 200,2,12288
zb 202,2,13824
zf 220,148,76
zx 36,69
zr 37,69
zcl 38,48
zbs 39,33
zf 224,152,76
ze 12
z2 38
z2 39
zg 36,38
zg 37,39
za 0,180,80
zs 38
zs 39
zs 36
zs 37
za 4,184,80
zq 38,39
zq 36,37
zr 37,36
zav 36,38
za 8,188,80
zaw 36
z3 45,37
z3 44,36
z4 47,37,45
za 12,192,80
z4 46,36,44
zax 47
z5 36,46
z5 37,47
zf 220,172,80
zbg 40,44,49
zay 41,45,50
zw 38,36,37
zaz 36,47
zf 224,176,80
ze 0
za0 37,46
zw 39,46,47
za1 41,45
za2 41,51
za 0,204,84
za3 36,37
zas 37
za4 41,40
zq 38,39
za 4,208,84
zq 36,37
za5 37,52
zcm 40,44
zcn 39
za 8,212,84
zk 0,25,2048
za 12,216,84
zv
zk 4,25,3072
za6 11,41
zf 220,196,84
z8 17,38,7
z8 20,36,7
zco
zau 14,37,11
zcp
zf 224,200,84
zcq
s_branch Lf11_azH1
Lf11_azS1:
zfa
s_cbranch_scc0 Lf11_azY1
zfb
zap 0xaf00
zao
s_call_b64 s[88:89], Lf11_far
s_branch Lf11_azXb1
Lf11_azY1:
zaj 21,9,6
zaj 22,12,6
zbm 23,15
zbm 24,18
s_call_b64 s[88:89], Lf11_four
Lf11_azXb1:
zd 76,100
zd 77,101
zd 78,102
zd 79,103
za 16,156,88
zfo 0xffff0000
zd 80,104
zd 81,105
zd 82,106
za 16,180,92
zf6 0xffff0000
zd 83,107
zd 84,108
zd 85,109
za 16,204,96
zk 8,25,4096
zd 86,110
zd 87,111
za 20,160,88
zk 12,25,5120
za 20,184,92
zam
zk 16,25,8192
za 20,208,96
za 24,164,88
za 24,188,92
ze 1
s_barrier
za7 32,28
za 24,212,96
za7 36,29
za7 40,30
za 28,168,88
zk 20,25,9216
za 28,192,92
zb0
zk 24,25,10240
za 28,216,96
zl 44,28,1024
zl 48,29,1024
zf 228,148,88
zl 52,30,1024
zf 228,172,92
zf 228,196,96
zf 232,152,88
zv
zk 28,25,11264
zf 232,176,92
zf 232,200,96
s_branch Lf11_azH2
Lf11_azS2:
zfc
s_cbranch_scc0 Lf11_azY2
zfd
zap 0x10680
zao
s_call_b64 s[88:89], Lf11_far
s_branch Lf11_azXb2
Lf11_azY2:
zaq 21,9,6
zaq 22,12,6
zbu 23,15
zbu 24,18
s_call_b64 s[88:89], Lf11_four
Lf11_azXb2:
zd 88,100
zd 89,101
zd 90,102
zd 91,103
za 32,156,76
zd 92,104
zd 93,105
zd 94,106
zd 95,107
za 32,180,80
zd 96,108
zd 97,109
zd 98,110
zd 99,111
za 32,204,84
ze 2
zm 36,32
zg 40,220
zm 37,33
zg 41,221
za 36,160,76
zm 38,34
zg 42,222
zm 39,35
zg 43,223
za 36,184,80
zk 32,25,14336
za 36,208,84
zg 36,40
zg 37,41
zg 38,42
zg 39,43
za 40,164,76
ze 1
s_barrier
zl 32,28,6144
zc 40,36,37
zc 41,38,39
za 40,188,80
zk 36,25,15360
za 40,212,84
zl 36,29,6144
zm 48,44
zg 52,224
zm 49,45
za 44,168,76
zg 53,225
zm 50,46
zg 54,226
zm 51,47
za 44,192,80
zk 40,25,16384
za 44,216,84
zl 44,28,7168
zg 55,227
zg 48,52
zg 49,53
zf 236,148,76
zg 50,54
zg 51,55
zc 52,48,49
zc 53,50,51
zf 236,172,80
zk 44,25,17408
zf 236,196,84
zl 48,29,7168
zah 42,52,40
zah 43,53,41
zai 40,52
zf 240,152,76
zai 41,53
zf 240,176,80
zfn
zbf 40,26
zl 52,30,7168
zl 40,30,6144
zf 240,200,84
s_branch Lf11_azH3
Lf11_azS3:
ze1
s_cbranch_scc0 Lf11_azY3
zfe
zap 0x15e00
zao
s_call_b64 s[88:89], Lf11_far
s_branch Lf11_azXb3
Lf11_azY3:
zaa 21,10,6
zaa 22,13,6
za8 23,16
za8 24,19
s_call_b64 s[88:89], Lf11_four
Lf11_azXb3:
zd 76,100
zd 77,101
zd 78,102
zd 79,103
ze 6
za 48,156,88
zd 80,104
zd 81,105
zd 82,106
zd 83,107
za 48,180,92
zd 84,108
zd 85,109
zd 86,110
zd 87,111
za 48,204,96
zm 36,32
ze 0
zg 40,228
zm 37,33
zg 41,229
za 52,160,88
zm 38,34
zg 42,230
zm 39,35
zg 43,231
za 52,184,92
zk 48,25,2048
za 52,208,96
zg 36,40
zg 37,41
zg 38,42
zg 39,43
za 56,164,88
s_barrier
zl 32,28,12288
zc 40,36,37
zc 41,38,39
za 56,188,92
zk 52,25,3072
za 56,212,96
zl 36,29,12288
zm 48,44
zg 52,232
zm 49,45
za 60,168,88
zg 53,233
zm 50,46
zg 54,234
zm 51,47
za 60,192,92
zk 56,25,4096
za 60,216,96
zl 44,28,13312
zg 55,235
zg 48,52
zg 49,53
zf 244,148,88
zg 50,54
zg 51,55
zc 52,48,49
zc 53,50,51
zf 244,172,92
zk 60,25,5120
zf 244,196,96
zl 48,29,13312
zah 42,52,40
zah 43,53,41
zai 40,52
zf 248,152,88
zai 41,53
zf 248,176,92
zbh 0xa800
zbf 40,26
zl 52,30,13312
zl 40,30,12288
zf 248,200,96
s_branch Lf11_azH4
Lf11_azS4:
ze0
s_cbranch_scc0 Lf11_azY4
zfs
zap 0x1b580
zao
s_call_b64 s[88:89], Lf11_far
s_branch Lf11_azXb4
Lf11_azY4:
zac 21,10,6
zac 22,13,6
za9 23,16
za9 24,19
s_call_b64 s[88:89], Lf11_four
Lf11_azXb4:
zd 88,100
zd 89,101
zd 90,102
zd 91,103
ze 6
za 68,156,76
zd 92,104
zd 93,105
zd 94,106
zd 95,107
za 68,180,80
zd 96,108
zd 97,109
zd 98,110
zd 99,111
za 68,204,84
zm 36,32
ze 0
zg 40,236
zm 37,33
zg 41,237
za 72,160,76
zm 38,34
zg 42,238
zm 39,35
zg 43,239
za 72,184,80
zk 68,25,8192
za 72,208,84
zg 36,40
zg 37,41
zg 38,42
zg 39,43
z7 76,164
s_barrier
za7 32,28
zc 40,36,37
zc 41,38,39
za 76,188,80
zk 72,25,9216
za 76,212,84
za7 36,29
zm 48,44
zg 52,240
zm 49,45
za 80,168,76
zg 53,241
zm 50,46
zg 54,242
zm 51,47
z7 80,192
zk 76,25,10240
za 80,216,84
zl 44,28,1024
zg 55,243
zg 48,52
zg 49,53
zf 252,148,76
zg 50,54
zg 51,55
zc 52,48,49
zc 53,50,51
zf 252,172,80
zk 80,25,11264
zf 252,196,84
zl 48,29,1024
zah 42,52,40
zah 43,53,41
zai 40,52
za 64,152,76
zai 41,53
za 64,176,80
zbh 0x15000
zbf 40,26
zl 52,30,1024
za7 40,30
za 64,200,84
s_branch Lf11_azH5
Lf11_azS5:
zft
s_cbranch_scc0 Lf11_azY5
zfu
zap 0x20d00
zao
s_call_b64 s[88:89], Lf11_far
s_branch Lf11_azXb5
Lf11_azY5:
zaj 21,10,6
zaj 22,13,6
zbm 23,16
zbm 24,19
s_call_b64 s[88:89], Lf11_four
Lf11_azXb5:
zd 76,100
zd 77,101
zd 78,102
zd 79,103
ze 6
za 92,156,88
zd 80,104
zd 81,105
zd 82,106
zd 83,107
z7 92,180
zd 84,108
zd 85,109
zd 86,110
zd 87,111
za 92,204,96
zm 36,32
ze 0
zg 40,244
zm 37,33
zg 41,245
za 96,160,88
zm 38,34
zg 42,246
zm 39,35
zg 43,247
za 96,184,92
zk 92,25,14336
z7 96,208
zg 36,40
zg 37,41
zg 38,42
zg 39,43
za 100,164,88
s_barrier
zl 32,28,6144
zc 40,36,37
zc 41,38,39
za 100,188,92
zk 96,25,15360
za 100,212,96
zl 36,29,6144
zm 48,44
zg 52,248
zm 49,45
za 104,168,88
zg 53,249
zm 50,46
zg 54,250
zm 51,47
za 104,192,92
zk 100,25,16384
za 104,216,96
zl 44,28,7168
zg 55,251
zg 48,52
zg 49,53
za 84,148,88
zg 50,54
zg 51,55
zc 52,48,49
zc 53,50,51
za 84,172,92
zk 104,25,17408
za 84,196,96
zl 48,29,7168
zah 42,52,40
zah 43,53,41
zai 40,52
z7 88,152
zai 41,53
za 88,176,92
zbh 0x1f800
zbf 40,26
zl 52,30,7168
zl 40,30,6144
za 88,200,96
s_branch Lf11_azH6
Lf11_azS6:
zfv
s_cbranch_scc0 Lf11_azY6
zfw
zap 0x26480
zao
s_call_b64 s[88:89], Lf11_far
s_branch Lf11_azXb6
Lf11_azY6:
zaq 21,10,6
zaq 22,13,6
zbu 23,16
zbu 24,19
s_call_b64 s[88:89], Lf11_four
Lf11_azXb6:
zd 88,100
zd 89,101
zd 90,102
zd 91,103
ze 6
za 116,156,76
zd 92,104
zd 93,105
zd 94,106
zd 95,107
zd 96,108
za 116,180,80
zd 97,109
zd 98,110
zd 99,111
zm 36,32
ze 0
zg 40,252
za 116,204,84
zm 37,33
zg 41,253
zm 38,34
zg 42,254
zm 39,35
za 120,160,76
zam
zk 116,25,2048
zg 43,255
zg 36,40
zg 37,41
za 120,184,80
zg 38,42
zg 39,43
zc 40,36,37
zc 41,38,39
za 120,208,84
zm 48,44
z9 44,64
zg 52,44
zm 49,45
za 124,164,76
s_barrier
zl 32,28,12288
zl 36,29,12288
z9 45,65
za 124,188,80
zk 120,25,3072
za 124,212,84
zg 53,45
zm 50,46
z9 46,66
zg 54,46
za 128,168,76
zm 51,47
z9 47,67
zg 55,47
zg 48,52
za 128,192,80
zk 124,25,4096
za 128,216,84
zl 44,28,13312
zg 49,53
zg 50,54
zg 51,55
za 108,148,76
zc 52,48,49
zc 53,50,51
zah 42,52,40
zah 43,53,41
za 108,172,80
zk 128,25,5120
za 108,196,84
zl 48,29,13312
zai 40,52
zai 41,53
za 112,152,76
zbh 0x2a000
zbf 40,26
zl 52,30,13312
za 112,176,80
zl 40,30,12288
za 112,200,84
s_branch Lf11_azH7
Lf11_azS7:
zf8
s_cbranch_scc0 Lf11_azY7
zgl
zap 0x2bc00
zao
s_call_b64 s[88:89], Lf11_far
s_branch Lf11_azXb7
Lf11_azY7:
zaa 21,11,6
zaa 22,14,6
za8 23,17
za8 24,20
s_call_b64 s[88:89], Lf11_four
Lf11_azXb7:
zd 76,100
zd 77,101
zd 78,102
zd 79,103
ze 6
za 140,156,88
zd 80,104
zd 81,105
zd 82,106
zd 83,107
zd 84,108
za 140,180,92
zd 85,109
zd 86,110
zd 87,111
zm 36,32
z9 32,84
za 140,204,96
ze 0
zg 40,32
zm 37,33
z9 33,85
zg 41,33
zm 38,34
za 144,160,88
zv
zk 140,25,8192
z9 34,86
zg 42,34
zm 39,35
za 144,184,92
z9 35,87
zg 43,35
zg 36,40
zg 37,41
zg 38,42
za 144,208,96
zg 39,43
zc 40,36,37
zc 41,38,39
zm 48,44
za 148,164,88
s_barrier
za7 32,28
za7 36,29
z9 44,88
za 148,188,92
zk 144,25,9216
za 148,212,96
zg 52,44
zm 49,45
z9 45,89
zg 53,45
za 152,168,88
zm 50,46
z9 46,90
zg 54,46
zm 51,47
za 152,192,92
zk 148,25,10240
za 152,216,96
z9 47,91
zg 55,47
zg 48,52
zg 49,53
za 132,148,88
zl 44,28,1024
zg 50,54
zg 51,55
zc 52,48,49
za 132,172,92
zk 152,25,11264
za 132,196,96
zc 53,50,51
zah 42,52,40
zah 43,53,41
zai 40,52
za 136,152,88
zl 48,29,1024
zai 41,53
za 136,176,92
zbh 0x34800
zbf 40,26
zl 52,30,1024
za7 40,30
za 136,200,96
s_branch Lf11_azH8
Lf11_azS8:
zff
s_cbranch_scc0 Lf11_azY8
zg7
zap 0x31380
zao
s_call_b64 s[88:89], Lf11_far
s_branch Lf11_azXb8
Lf11_azY8:
zac 21,11,6
zac 22,14,6
za9 23,17
za9 24,20
s_call_b64 s[88:89], Lf11_four
Lf11_azXb8:
zd 88,100
zd 89,101
zd 90,102
zd 91,103
ze 6
za 164,156,76
zd 92,104
zd 93,105
zd 94,106
zd 95,107
zd 96,108
za 164,180,80
zd 97,109
zd 98,110
zd 99,111
zm 36,32
z9 32,108
za 164,204,84
ze 0
zg 40,32
zm 37,33
z9 33,109
zg 41,33
zm 38,34
za 168,160,76
zv
zk 164,25,14336
z9 34,110
zg 42,34
zm 39,35
za 168,184,80
z9 35,111
zg 43,35
zg 36,40
zg 37,41
zg 38,42
za 168,208,84
zg 39,43
zc 40,36,37
zc 41,38,39
zm 48,44
za 172,164,76
s_barrier
zl 32,28,6144
zl 36,29,6144
z9 44,112
za 172,188,80
zk 168,25,15360
za 172,212,84
zg 52,44
zm 49,45
z9 45,113
zg 53,45
za 176,168,76
zm 50,46
z9 46,114
zg 54,46
zm 51,47
za 176,192,80
zk 172,25,16384
za 176,216,84
z9 47,115
zg 55,47
zg 48,52
zg 49,53
za 156,148,76
zl 44,28,7168
zg 50,54
zg 51,55
zc 52,48,49
za 156,172,80
zk 176,25,17408
za 156,196,84
zc 53,50,51
zah 42,52,40
zah 43,53,41
zai 40,52
za 160,152,76
zl 48,29,7168
zai 41,53
za 160,176,80
zbh 0x3f000
zbf 40,26
zl 52,30,7168
zl 40,30,6144
za 160,200,84
s_branch Lf11_azH9
Lf11_azS9:
zgz
s_cbranch_scc0 Lf11_azY9
s_add_u32 s90, s64, 10
zap 0x36b00
zao
s_call_b64 s[88:89], Lf11_far
s_branch Lf11_azXb9
Lf11_azY9:
zaj 21,11,6
zaj 22,14,6
zbm 23,17
zbm 24,20
s_call_b64 s[88:89], Lf11_four
Lf11_azXb9:
zd 76,100
zd 77,101
zd 78,102
zd 79,103
ze 6
za 188,156,88
zd 80,104
zd 81,105
zd 82,106
zd 83,107
zd 84,108
za 188,180,92
zd 85,109
zd 86,110
zd 87,111
zm 36,32
z9 32,132
za 188,204,96
ze 0
zg 40,32
zm 37,33
z9 33,133
zg 41,33
zm 38,34
za 192,160,88
zv
zk 188,25,2048
z9 34,134
zg 42,34
zm 39,35
za 192,184,92
z9 35,135
zg 43,35
zg 36,40
zg 37,41
zg 38,42
za 192,208,96
zg 39,43
zc 40,36,37
zc 41,38,39
zm 48,44
za 196,164,88
s_barrier
zl 32,28,12288
zl 36,29,12288
z9 44,136
za 196,188,92
zk 192,25,3072
za 196,212,96
zg 52,44
zm 49,45
z9 45,137
zg 53,45
za 200,168,88
zm 50,46
z9 46,138
zg 54,46
zm 51,47
za 200,192,92
zk 196,25,4096
za 200,216,96
z9 47,139
zg 55,47
zg 48,52
zg 49,53
za 180,148,88
zl 44,28,13312
zg 50,54
zg 51,55
zc 52,48,49
za 180,172,92
zk 200,25,5120
za 180,196,96
zc 53,50,51
zah 42,52,40
zah 43,53,41
zai 40,52
za 184,152,88
zl 48,29,13312
zai 41,53
za 184,176,92
zbh 0x49800
zbf 40,26
zl 52,30,13312
zl 40,30,12288
za 184,200,96
s_branch Lf11_azH10
Lf11_ayS0:
ze8
s_cbranch_scc0 Lf11_ayY0
ze9
zap 0x5780
zao
s_call_b64 s[88:89], Lf11_far
s_branch Lf11_ayXb0
Lf11_ayY0:
zac 21,9,6
zac 22,12,6
za9 23,15
za9 24,18
s_call_b64 s[88:89], Lf11_four
Lf11_ayXb0:
zd 88,100
zd 89,101
zd 90,102
zd 91,103
ze 15
za 0,156,76
zd 92,104
zd 93,105
zd 94,106
zd 95,107
zd 96,108
za 4,160,76
zu 0
zb 204,1,12352
zb 206,1,13888
zd 97,109
zd 98,110
zd 99,111
ze 10
za 8,164,76
zb 208,2,12352
zb 210,2,13888
zb 212,1,12416
zb 214,1,13952
zb 216,2,12416
za 12,168,76
zb 218,2,13952
zb 196,1,12288
zb 198,1,13824
zb 200,2,12288
zb 202,2,13824
zf 220,148,76
zx 36,69
zr 37,69
zcl 38,48
zbs 39,33
zf 224,152,76
ze 12
z2 38
z2 39
zg 36,38
zg 37,39
za 0,180,80
zs 38
zs 39
zs 36
zs 37
za 4,184,80
zq 38,39
zq 36,37
zr 37,36
zav 36,38
za 8,188,80
zaw 36
z3 45,37
z3 44,36
z4 47,37,45
za 12,192,80
z4 46,36,44
zax 47
z5 36,46
z5 37,47
zf 220,172,80
zbg 40,44,49
zay 41,45,50
zw 38,36,37
zaz 36,47
zf 224,176,80
ze 0
za0 37,46
zw 39,46,47
za1 41,45
za2 41,51
za 0,204,84
za3 36,37
zas 37
za4 41,40
zq 38,39
za 4,208,84
zq 36,37
za5 37,52
zcm 40,44
zcn 39
za 8,212,84
zk 0,25,2048
za 12,216,84
zv
zk 4,25,3072
za6 11,41
zf 220,196,84
z8 17,38,7
z8 20,36,7
zco
zau 14,37,11
zcp
zf 224,200,84
zcq
s_branch Lf11_ayH1
Lf11_ayS1:
zfa
s_cbranch_scc0 Lf11_ayY1
zfb
zap 0xaf00
zao
s_call_b64 s[88:89], Lf11_far
s_branch Lf11_ayXb1
Lf11_ayY1:
zaj 21,9,6
zaj 22,12,6
zbm 23,15
zbm 24,18
s_call_b64 s[88:89], Lf11_four
Lf11_ayXb1:
zd 76,100
zd 77,101
zd 78,102
zd 79,103
za 16,156,88
zd 80,104
zd 81,105
zd 82,106
za 16,180,92
zd 83,107
zd 84,108
zd 85,109
za 16,204,96
zk 8,25,4096
zd 86,110
zd 87,111
za 20,160,88
zk 12,25,5120
za 20,184,92
zdl 220,25
za 20,208,96
zat 224,25,1024
za 24,164,88
zk 16,25,8192
za 24,188,92
zbl
zk 20,25,9216
za 24,212,96
ze 2
s_barrier
za 28,168,88
za 28,192,92
za 28,216,96
zf 228,148,88
zam
zk 24,25,10240
zf 228,172,92
zb0
zk 28,25,11264
zf 228,196,96
zf 232,152,88
zf 232,176,92
zf 232,200,96
zcr
zat 228,25,6144
s_branch Lf11_ayH2
Lf11_ayS2:
zfc
s_cbranch_scc0 Lf11_ayY2
zfd
zap 0x10680
zao
s_call_b64 s[88:89], Lf11_far
s_branch Lf11_ayXb2
Lf11_ayY2:
zaq 21,9,6
zaq 22,12,6
zbu 23,15
zbu 24,18
s_call_b64 s[88:89], Lf11_four
Lf11_ayXb2:
zd 88,100
zd 89,101
zd 90,102
zd 91,103
za 32,156,76
zd 92,104
zd 93,105
za 32,180,80
zd 94,106
zd 95,107
za 32,204,84
zd 96,108
zd 97,109
za 36,160,76
zd 98,110
zd 99,111
za 36,184,80
zat 232,25,7168
za 36,208,84
zk 32,25,14336
za 40,164,76
za 40,188,80
za 40,212,84
ze 1
s_barrier
zam
zk 36,25,15360
za 44,168,76
za 44,192,80
za 44,216,84
zk 40,25,16384
zf 236,148,76
zf 236,172,80
zf 236,196,84
zbl
zk 44,25,17408
zf 240,152,76
zf 240,176,80
zf 240,200,84
zat 236,25,12288
s_branch Lf11_ayH3
Lf11_ayS3:
ze1
s_cbranch_scc0 Lf11_ayY3
zfe
zap 0x15e00
zao
s_call_b64 s[88:89], Lf11_far
s_branch Lf11_ayXb3
Lf11_ayY3:
zaa 21,10,6
zaa 22,13,6
za8 23,16
za8 24,19
s_call_b64 s[88:89], Lf11_four
Lf11_ayXb3:
zd 76,100
zd 77,101
zd 78,102
zd 79,103
za 48,156,88
zd 80,104
zd 81,105
za 48,180,92
zd 82,106
zd 83,107
za 48,204,96
zd 84,108
zd 85,109
za 52,160,88
zd 86,110
zd 87,111
za 52,184,92
zat 240,25,13312
za 52,208,96
zk 48,25,2048
za 56,164,88
za 56,188,92
za 56,212,96
ze 1
s_barrier
zam
zk 52,25,3072
za 60,168,88
za 60,192,92
za 60,216,96
zk 56,25,4096
zf 244,148,88
zf 244,172,92
zf 244,196,96
zbl
zk 60,25,5120
zf 248,152,88
zf 248,176,92
zf 248,200,96
zdl 244,25
s_branch Lf11_ayH4
Lf11_ayS4:
ze0
s_cbranch_scc0 Lf11_ayY4
zfs
zap 0x1b580
zao
s_call_b64 s[88:89], Lf11_far
s_branch Lf11_ayXb4
Lf11_ayY4:
zac 21,10,6
zac 22,13,6
za9 23,16
za9 24,19
s_call_b64 s[88:89], Lf11_four
Lf11_ayXb4:
zd 88,100
zd 89,101
zd 90,102
zd 91,103
za 68,156,76
zd 92,104
zd 93,105
za 68,180,80
zd 94,106
zd 95,107
za 68,204,84
zd 96,108
zd 97,109
za 72,160,76
zd 98,110
zd 99,111
za 72,184,80
zat 248,25,1024
za 72,208,84
zk 68,25,8192
z7 76,164
za 76,188,80
za 76,212,84
ze 1
s_barrier
zam
zk 72,25,9216
za 80,168,76
z7 80,192
za 80,216,84
zk 76,25,10240
zf 252,148,76
zf 252,172,80
zf 252,196,84
zbl
zk 80,25,11264
za 64,152,76
za 64,176,80
za 64,200,84
zat 252,25,6144
s_branch Lf11_ayH5
Lf11_ayS5:
zft
s_cbranch_scc0 Lf11_ayY5
zfu
zap 0x20d00
zao
s_call_b64 s[88:89], Lf11_far
s_branch Lf11_ayXb5
Lf11_ayY5:
zaj 21,10,6
zaj 22,13,6
zbm 23,16
zbm 24,19
s_call_b64 s[88:89], Lf11_four
Lf11_ayXb5:
zd 76,100
zd 77,101
zd 78,102
zd 79,103
za 92,156,88
zd 80,104
zd 81,105
z7 92,180
zd 82,106
zd 83,107
za 92,204,96
zd 84,108
zd 85,109
za 96,160,88
zd 86,110
zd 87,111
za 96,184,92
zk 64,25,7168
z7 96,208
zk 92,25,14336
za 100,164,88
za 100,188,92
za 100,212,96
ze 1
s_barrier
zam
zk 96,25,15360
za 104,168,88
za 104,192,92
za 104,216,96
zk 100,25,16384
za 84,148,88
za 84,172,92
za 84,196,96
zbl
zk 104,25,17408
z7 88,152
za 88,176,92
za 88,200,96
zk 84,25,12288
s_branch Lf11_ayH6
Lf11_ayS6:
zfv
s_cbranch_scc0 Lf11_ayY6
zfw
zap 0x26480
zao
s_call_b64 s[88:89], Lf11_far
s_branch Lf11_ayXb6
Lf11_ayY6:
zaq 21,10,6
zaq 22,13,6
zbu 23,16
zbu 24,19
s_call_b64 s[88:89], Lf11_four
Lf11_ayXb6:
zd 88,100
zd 89,101
zd 90,102
zd 91,103
za 116,156,76
zd 92,104
zd 93,105
za 116,180,80
zd 94,106
zd 95,107
za 116,204,84
zd 96,108
zd 97,109
za 120,160,76
zd 98,110
zd 99,111
za 120,184,80
zk 88,25,13312
za 120,208,84
zk 116,25,2048
za 124,164,76
za 124,188,80
za 124,212,84
ze 1
s_barrier
zam
zk 120,25,3072
za 128,168,76
za 128,192,80
za 128,216,84
zk 124,25,4096
za 108,148,76
za 108,172,80
za 108,196,84
zbl
zk 128,25,5120
za 112,152,76
za 112,176,80
za 112,200,84
zfr 108,25
s_branch Lf11_ayH7
Lf11_ayS7:
zf8
s_cbranch_scc0 Lf11_ayY7
zgl
zap 0x2bc00
zao
s_call_b64 s[88:89], Lf11_far
s_branch Lf11_ayXb7
Lf11_ayY7:
zaa 21,11,6
zaa 22,14,6
za8 23,17
za8 24,20
s_call_b64 s[88:89], Lf11_four
Lf11_ayXb7:
zd 76,100
zd 77,101
zd 78,102
zd 79,103
za 140,156,88
zd 80,104
zd 81,105
za 140,180,92
zd 82,106
zd 83,107
za 140,204,96
zd 84,108
zd 85,109
za 144,160,88
zd 86,110
zd 87,111
za 144,184,92
zk 112,25,1024
za 144,208,96
zk 140,25,8192
za 148,164,88
za 148,188,92
za 148,212,96
ze 1
s_barrier
zam
zk 144,25,9216
za 152,168,88
za 152,192,92
za 152,216,96
zk 148,25,10240
za 132,148,88
za 132,172,92
za 132,196,96
zbl
zk 152,25,11264
za 136,152,88
za 136,176,92
za 136,200,96
zk 132,25,6144
s_branch Lf11_ayH8
Lf11_ayS8:
zff
s_cbranch_scc0 Lf11_ayY8
zg7
zap 0x31380
zao
s_call_b64 s[88:89], Lf11_far
s_branch Lf11_ayXb8
Lf11_ayY8:
zac 21,11,6
zac 22,14,6
za9 23,17
za9 24,20
s_call_b64 s[88:89], Lf11_four
Lf11_ayXb8:
zd 88,100
zd 89,101
zd 90,102
zd 91,103
za 164,156,76
zd 92,104
zd 93,105
za 164,180,80
zd 94,106
zd 95,107
za 164,204,84
zd 96,108
zd 97,109
za 168,160,76
zd 98,110
zd 99,111
za 168,184,80
zk 136,25,7168
za 168,208,84
zk 164,25,14336
za 172,164,76
za 172,188,80
za 172,212,84
ze 1
s_barrier
zam
zk 168,25,15360
za 176,168,76
za 176,192,80
za 176,216,84
zk 172,25,16384
za 156,148,76
za 156,172,80
za 156,196,84
zbl
zk 176,25,17408
za 160,152,76
za 160,176,80
za 160,200,84
zk 156,25,12288
s_branch Lf11_ayH9
Lf11_ayS9:
zgz
s_cbranch_scc0 Lf11_ayY9
s_add_u32 s90, s64, 10
zap 0x36b00
zao
s_call_b64 s[88:89], Lf11_far
s_branch Lf11_ayXb9
Lf11_ayY9:
zaj 21,11,6
zaj 22,14,6
zbm 23,17
zbm 24,20
s_call_b64 s[88:89], Lf11_four
Lf11_ayXb9:
zd 76,100
zd 77,101
zd 78,102
zd 79,103
za 188,156,88
zd 80,104
zd 81,105
za 188,180,92
zd 82,106
zd 83,107
za 188,204,96
zd 84,108
zd 85,109
za 192,160,88
zd 86,110
zd 87,111
za 192,184,92
zk 160,25,13312
za 192,208,96
zk 188,25,2048
za 196,164,88
za 196,188,92
za 196,212,96
ze 1
s_barrier
zam
zk 192,25,3072
za 200,168,88
za 200,192,92
za 200,216,96
zk 196,25,4096
za 180,148,88
za 180,172,92
za 180,196,96
zbl
zk 200,25,5120
za 184,152,88
za 184,176,92
za 184,200,96
zfr 180,25
s_branch Lf11_ayH10
Lf11_aqS0:
zdz
s_cbranch_scc0 Lf11_aqY0
s_add_u32 s90, s64, 0
s_add_u32 s91, s66, 0
zao
s_call_b64 s[88:89], Lf11_far
s_branch Lf11_aqXb0
Lf11_aqY0:
zaa 21,9,6
zaa 22,12,6
za8 23,15
za8 24,18
s_call_b64 s[88:89], Lf11_four
Lf11_aqXb0:
zd 76,100
zd 77,101
zd 78,102
zd 79,103
zd 80,104
zd 81,105
zd 82,106
zd 83,107
zd 84,108
zd 85,109
zd 86,110
zd 87,111
zu 13
zo 148,1
zb 150,1,1536
zo 152,2
zb 154,2,1536
zb 156,1,64
zb 158,1,1600
zb 160,2,64
zb 162,2,1600
zb 164,1,128
zb 166,1,1664
zb 168,2,128
zb 170,2,1664
zu 7
zb 172,1,6144
zb 174,1,7680
zb 176,2,6144
zb 178,2,7680
zb 180,1,6208
zb 182,1,7744
zb 184,2,6208
zb 186,2,7744
zb 188,1,6272
zb 190,1,7808
zb 192,2,6272
zb 194,2,7808
s_branch Lf11_aqE2
Lf11_atS0:
ze8
s_cbranch_scc0 Lf11_atY0
ze9
zap 0x5780
zao
s_call_b64 s[88:89], Lf11_far
s_branch Lf11_atXb0
Lf11_atY0:
zac 21,9,6
zac 22,12,6
za9 23,15
za9 24,18
s_call_b64 s[88:89], Lf11_four
Lf11_atXb0:
ze 15
zh 220,148,76
zd 88,100
zd 89,101
zd 90,102
zh 224,152,76
zd 91,103
zd 92,104
zd 93,105
zp 0,156,76
zd 94,106
zd 95,107
zd 96,108
zp 4,160,76
ze 14
zd 97,109
zd 98,110
zd 99,111
zp 8,164,76
zu 1
zb 196,1,12288
zb 198,1,13824
zb 200,2,12288
ze 13
zp 12,168,76
zb 202,2,13824
zb 204,1,12352
zb 206,1,13888
zf 220,172,80
ze 8
zb 208,2,12352
zb 210,2,13888
zf 224,176,80
zb 212,1,12416
zb 214,1,13952
za 0,180,80
zb 216,2,12416
zb 218,2,13952
za 4,184,80
zf1
zcv
zcw 0xdf
zbt 0xa800
zdd 0x9000
za 8,188,80
zcx
zv
zae 25
ze 12
za 12,192,80
zan 0x400
zv
zae 26
ze 9
zf 220,196,84
zan 0x800
zv
zae 27
ze 4
zf 224,200,84
zan 0xc00
zv
zae 28
za 0,204,84
zcy 0x3fffffff
zan 0x1000
zv
zae 29
zcz
za 4,208,84
ze 0
za 8,212,84
za 12,216,84
s_branch Lf11_atH1
Lf11_atS1:
zfa
s_cbranch_scc0 Lf11_atY1
zfb
zap 0xaf00
zao
s_call_b64 s[88:89], Lf11_far
s_branch Lf11_atXb1
Lf11_atY1:
zaj 21,9,6
zaj 22,12,6
zbm 23,15
zbm 24,18
s_call_b64 s[88:89], Lf11_four
Lf11_atXb1:
ze 0
zh 228,148,88
zd 76,100
zd 77,101
zd 78,102
zf 228,172,92
zd 79,103
zd 80,104
zd 81,105
zf 228,196,96
zd 82,106
zd 83,107
zd 84,108
zh 232,152,88
zd 85,109
zd 86,110
zd 87,111
zf 232,176,92
zgj
zcv
zcw 0xdf
zbt 0xa800
zdd 0xd800
zf 232,200,96
zcx
zv
zae 25
zp 16,156,88
zan 0x400
zv
zae 26
za 16,180,92
zan 0x800
zv
zae 27
za 16,204,96
zan 0xc00
zv
zae 28
zp 20,160,88
zcy 0x3fffffff
zan 0x1000
zv
zae 29
zcz
za 20,184,92
zc8 0x2bc00
zfi 68,35
zu 11
zx 36,62
za 20,208,96
zr 37,62
zci 38,48
zp 24,164,88
zbs 39,33
z2 38
za 24,188,92
z2 39
zg 36,38
za 24,212,96
zg 37,39
zs 38
zp 28,168,88
zbr 0x13800
zdw 1
zdw 2
za 28,192,92
za 28,216,96
s_branch Lf11_atH2
Lf11_atS2:
zfc
s_cbranch_scc0 Lf11_atY2
zfd
zap 0x10680
zao
s_call_b64 s[88:89], Lf11_far
s_branch Lf11_atXb2
Lf11_atY2:
zaq 21,9,6
zaq 22,12,6
zbu 23,15
zbu 24,18
s_call_b64 s[88:89], Lf11_four
Lf11_atXb2:
ze 0
zh 236,148,76
zd 88,100
zd 89,101
zd 90,102
zd 91,103
zd 92,104
zf 236,172,80
zd 93,105
zd 94,106
zd 95,107
zd 96,108
zd 97,109
zf 236,196,84
s_add_u32 s97, s85, 16
zcv
zcw 0xdf
zbt 0xa800
zdd 0x12000
zd 98,110
zd 99,111
zh 240,152,76
zby
zgk
s_cselect_b32 s42, 0x25800, s42
zcx
zv
zae 25
zf 240,176,80
zan 0x400
zv
zae 26
zan 0x800
zv
zae 27
zf 240,200,84
zan 0xc00
zv
zae 28
zcy 0x3fffffff
zan 0x1000
zv
zae 29
zcz
zp 32,156,76
zf2 32,35
zs 39
zs 36
zs 37
za 32,180,80
zq 38,39
zq 36,37
zr 37,36
zav 36,38
za 32,204,84
zaw 36
z3 45,37
z3 44,36
z4 47,37,45
zp 36,160,76
z4 46,36,44
zci 38,48
z2 38
zd1 39,49
za 36,184,80
zd2 38,39
zax 47
z5 36,46
z5 37,47
za 36,208,84
zd3 40,44,49,38
zay 41,45,50
zw 38,36,37
zaz 36,47
zp 40,164,76
za0 37,46
zw 39,46,47
za1 41,45
za2 41,51
za 40,188,80
za3 36,37
zas 37
za4 41,40
za 40,212,84
zq 38,39
zq 36,37
za5 37,52
zp 44,168,76
zca 40,44
zcb 39
za6 10,41
z8 16,38,7
za 44,192,80
z8 19,36,7
zcc
zau 13,37,10
zcd
za 44,216,84
zce
s_branch Lf11_atH3
Lf11_atS3:
ze1
s_cbranch_scc0 Lf11_atY3
zfe
zap 0x15e00
zao
s_call_b64 s[88:89], Lf11_far
s_branch Lf11_atXb3
Lf11_atY3:
zaa 21,10,6
zaa 22,13,6
za8 23,16
za8 24,19
s_call_b64 s[88:89], Lf11_four
Lf11_atXb3:
ze 0
zh 244,148,88
zd 76,100
zd 77,101
zf 244,172,92
zd 78,102
zd 79,103
zf 244,196,96
zd 80,104
zd 81,105
zh 248,152,88
zd 82,106
zd 83,107
zf 248,176,92
zd 84,108
zd 85,109
zf 248,200,96
zd 86,110
zd 87,111
zp 48,156,88
ze5
zc6 60,35,16
z6 0x3000
zc7 0x3000
z0 42
za 48,180,92
zn 43,1024
za 48,204,96
zn 53,2048
zp 52,160,88
za 52,184,92
za 52,208,96
zp 56,164,88
za 56,188,92
za 56,212,96
zp 60,168,88
za 60,192,92
za 60,216,96
s_branch Lf11_atH4
Lf11_atS4:
ze0
s_cbranch_scc0 Lf11_atY4
zfs
zap 0x1b580
zao
s_call_b64 s[88:89], Lf11_far
s_branch Lf11_atXb4
Lf11_atY4:
zac 21,10,6
zac 22,13,6
za9 23,16
za9 24,19
s_call_b64 s[88:89], Lf11_four
Lf11_atXb4:
ze 0
zh 252,148,76
zd 88,100
zd 89,101
zd 90,102
zf 252,172,80
zd 91,103
zd 92,104
zd 93,105
zf 252,196,84
zd 94,106
zd 95,107
zd 96,108
zp 64,152,76
zd 97,109
zd 98,110
zd 99,111
za 64,176,80
zc8 0x15e00
zc6 66,35,16
z6 0x3000
zc7 0x3000
zn 42,3072
za 64,200,84
z6 0x4000
zc7 0x4000
z0 43
zp 68,156,76
zu 13
zn 53,1024
zx 36,68
za 68,180,80
zr 37,68
zcl 38,48
za 68,204,84
zbs 39,33
z2 38
zp 72,160,76
z2 39
zg 36,38
za 72,184,80
zg 37,39
zs 38
za 72,208,84
zs 39
zs 36
zex 76,164
zs 37
zq 38,39
za 76,188,80
zq 36,37
zr 37,36
za 76,212,84
zav 36,38
zaw 36
zp 80,168,76
z3 45,37
z3 44,36
z7 80,192
z4 47,37,45
z4 46,36,44
za 80,216,84
s_branch Lf11_atH5
Lf11_atS5:
zft
s_cbranch_scc0 Lf11_atY5
zfu
zap 0x20d00
zao
s_call_b64 s[88:89], Lf11_far
s_branch Lf11_atXb5
Lf11_atY5:
zaj 21,10,6
zaj 22,13,6
zbm 23,16
zbm 24,19
s_call_b64 s[88:89], Lf11_four
Lf11_atXb5:
ze 0
zp 84,148,88
zd 76,100
zd 77,101
zd 78,102
za 84,172,92
zd 79,103
zd 80,104
zd 81,105
za 84,196,96
zd 82,106
zd 83,107
zd 84,108
zex 88,152
zd 85,109
zd 86,110
zd 87,111
za 88,176,92
zc8 0x2bc00
zc6 72,35,16
zcg
zcu
z0 42
za 88,200,96
zn 43,1024
zn 53,2048
zp 92,156,88
zcl 38,48
z2 38
zd1 39,49
z7 92,180
zd2 38,39
zax 47
z5 36,46
za 92,204,96
z5 37,47
zd3 40,44,49,38
zay 41,45,50
zp 96,160,88
zw 38,36,37
zaz 36,47
za0 37,46
za 96,184,92
zw 39,46,47
za1 41,45
z7 96,208
za2 41,51
za3 36,37
zp 100,164,88
zas 37
za4 41,40
za 100,188,92
zq 38,39
zq 36,37
za 100,212,96
za5 37,52
zcm 40,44
zp 104,168,88
zcn 39
za6 11,41
za 104,192,92
z8 17,38,7
z8 20,36,7
za 104,216,96
zco
s_branch Lf11_atH6
Lf11_atS6:
zfv
s_cbranch_scc0 Lf11_atY6
zfw
zap 0x26480
zao
s_call_b64 s[88:89], Lf11_far
s_branch Lf11_atXb6
Lf11_atY6:
zaq 21,10,6
zaq 22,13,6
zbu 23,16
zbu 24,19
s_call_b64 s[88:89], Lf11_four
Lf11_atXb6:
ze 0
zp 108,148,76
zd 88,100
zd 89,101
zd 90,102
za 108,172,80
zd 91,103
zd 92,104
zd 93,105
za 108,196,84
zd 94,106
zd 95,107
zd 96,108
zp 112,152,76
zd 97,109
zd 98,110
zd 99,111
za 112,176,80
zn 42,3072
z6 0x1000
zag 0x1000
z0 43
za 112,200,84
zn 53,1024
zau 14,37,11
zp 116,156,76
zcp
zcq
zx 36,57
zr 37,57
za 116,180,80
zdx 38,48
zcj 39,33
z2 38
za 116,204,84
z2 39
zg 36,38
zg 37,39
zp 120,160,76
zs 38
zs 39
zs 36
za 120,184,80
zs 37
zq 38,39
zq 36,37
za 120,208,84
zr 37,36
zav 36,38
zaw 36
zp 124,164,76
z3 45,37
z3 44,36
za 124,188,80
z4 47,37,45
z4 46,36,44
za 124,212,84
zax 47
z5 36,46
zp 128,168,76
z5 37,47
zbg 40,44,49
za 128,192,80
zay 41,45,50
zw 38,36,37
za 128,216,84
s_branch Lf11_atH7
Lf11_atS7:
zf8
s_cbranch_scc0 Lf11_atY7
zgl
zap 0x2bc00
zao
s_call_b64 s[88:89], Lf11_far
s_branch Lf11_atXb7
Lf11_atY7:
zaa 21,11,6
zaa 22,14,6
za8 23,17
za8 24,20
s_call_b64 s[88:89], Lf11_four
Lf11_atXb7:
ze 0
zp 132,148,88
zd 76,100
zd 77,101
zd 78,102
za 132,172,92
zd 79,103
zd 80,104
zd 81,105
za 132,196,96
zd 82,106
zd 83,107
zd 84,108
zp 136,152,88
zd 85,109
zd 86,110
zd 87,111
za 136,176,92
zn 42,2048
zn 43,3072
za 136,200,96
z6 0x2000
zag 0x2000
z0 53
zp 140,156,88
zaz 36,47
za0 37,46
zw 39,46,47
za 140,180,92
za1 41,45
za2 41,51
za3 36,37
za 140,204,96
zas 37
za4 41,40
zq 38,39
zp 144,160,88
zq 36,37
za5 37,52
zdf 40,44
za 144,184,92
zdg 39
za6 9,41
z8 15,38,7
za 144,208,96
z8 18,36,7
zdh
zp 148,164,88
zau 12,37,9
zdi
zdj
za 148,188,92
zx 36,63
zr 37,63
zfl 38,48
za 148,212,96
zcj 39,33
z2 38
z2 39
zp 152,168,88
zg 36,38
zg 37,39
za 152,192,92
zs 38
zs 39
za 152,216,96
s_branch Lf11_atH8
Lf11_atS8:
zff
s_cbranch_scc0 Lf11_atY8
zg7
zap 0x31380
zao
s_call_b64 s[88:89], Lf11_far
s_branch Lf11_atXb8
Lf11_atY8:
zac 21,11,6
zac 22,14,6
za9 23,17
za9 24,20
s_call_b64 s[88:89], Lf11_four
Lf11_atXb8:
ze 0
zp 156,148,76
zd 88,100
zd 89,101
zd 90,102
zp 160,152,76
zd 91,103
zd 92,104
zd 93,105
zp 164,156,76
zn 42,1024
zd 94,106
zd 95,107
zp 168,160,76
zn 43,2048
zn 53,3072
zp 172,164,76
zs 36
zs 37
zq 38,39
zp 176,168,76
zd 76,108
zd 77,109
zd 78,110
za 156,172,80
zd 79,111
zq 36,37
zr 37,36
za 160,176,80
zav 36,38
zaw 36
z3 45,37
za 164,180,80
z3 44,36
z4 47,37,45
z4 46,36,44
za 168,184,80
zax 47
z5 36,46
z5 37,47
za 172,188,80
zbg 40,44,49
zay 41,45,50
zw 38,36,37
za 176,192,80
zaz 36,47
za0 37,46
zw 39,46,47
za 156,196,84
za1 41,45
za2 41,51
za3 36,37
za 160,200,84
zas 37
za4 41,40
za 164,204,84
zq 38,39
zq 36,37
za 168,208,84
za5 37,52
zca 40,44
za 172,212,84
zcb 39
za6 10,41
za 176,216,84
s_branch Lf11_atH9
Lf11_atS9:
zgz
s_cbranch_scc0 Lf11_atY9
s_add_u32 s90, s64, 10
zap 0x36b00
zao
s_call_b64 s[88:89], Lf11_far
s_branch Lf11_atXb9
Lf11_atY9:
zaj 21,11,6
zaj 22,14,6
zbm 23,17
zbm 24,20
s_call_b64 s[88:89], Lf11_four
Lf11_atXb9:
ze 0
zp 180,148,88
zd 84,100
zd 85,101
zd 86,102
zd 87,103
zp 184,152,88
zd 96,104
zd 97,105
zd 98,106
zd 99,107
zp 188,156,88
z8 16,38,7
z8 19,36,7
zcc
zau 13,37,10
zp 192,160,88
zcd
zce
zu 21
zx 36,32
zr 37,32
zf3 38,48
zp 196,164,88
ze2 39,33
z2 38
z2 39
zg 36,38
zp 200,168,88
zd 88,108
zd 89,109
zd 90,110
zd 91,111
za 180,172,92
zg 37,39
zs 38
zs 39
zs 36
za 184,176,92
zs 37
zq 38,39
zq 36,37
zr 37,36
za 188,180,92
zav 36,38
zaw 36
z3 45,37
z3 44,36
za 192,184,92
z4 47,37,45
z4 46,36,44
zax 47
z5 36,46
za 196,188,92
z5 37,47
zbg 40,44,49
zay 41,45,50
za 200,192,92
zw 38,36,37
zaz 36,47
za0 37,46
za 180,196,76
zw 39,46,47
za1 41,45
za2 41,51
za 184,200,76
za3 36,37
zas 37
za4 41,40
za 188,204,76
zq 38,39
zq 36,37
za5 37,52
za 192,208,76
zcm 40,44
zcn 39
za6 11,41
z8 17,38,7
za 196,212,76
z8 20,36,7
zco
zau 14,37,11
zcp
za 200,216,76
zcq
s_branch Lf11_atH10
Lf11_atS10:
zf8
s_cbranch_scc0 Lf11_atY10
s_add_u32 s90, s78, 0
s_add_u32 s91, s79, 0
zdu
s_call_b64 s[88:89], Lf11_far
s_branch Lf11_atXb10
Lf11_atY10:
zaa 21,11,6
zaa 22,14,6
za8 23,17
za8 24,20
s_call_b64 s[88:89], Lf11_four
Lf11_atXb10:
ze 0
zp 204,148,84
zf4 8,0
zd 76,100
zd 77,101
zp 208,152,84
zd 78,102
zd 79,103
zd 80,104
zp 212,156,84
zd 81,105
zd 82,106
zd 83,107
zp 216,160,84
zp 220,164,84
zp 224,168,84
zd 84,108
zd 85,109
zd 86,110
za 204,172,96
zb 148,1,12288
zb 150,1,13824
zd 87,111
za 208,176,96
zb 152,2,12288
zb 154,2,13824
zb 156,1,12352
za 212,180,96
zb 158,1,13888
zb 160,2,12352
zb 162,2,13888
za 216,184,96
zb 164,1,12416
zb 166,1,13952
za 220,188,96
zb 168,2,12416
zb 170,2,13952
za 224,192,96
zb 172,1,30720
zb 174,1,32256
za 204,196,88
zb 176,2,30720
zb 178,2,32256
za 208,200,88
zb 180,1,30784
zb 182,1,32320
za 212,204,88
zb 184,2,30784
zb 186,2,32320
za 216,208,88
zb 188,1,30848
zb 190,1,32384
za 220,212,88
zb 192,2,30848
zb 194,2,32384
za 224,216,88
s_branch Lf11_atE2
Lf11_as0S0:
zff
s_cbranch_scc0 Lf11_as0Y0
zfg
zec 0x5780
zdu
s_call_b64 s[88:89], Lf11_far
s_branch Lf11_as0Xb0
Lf11_as0Y0:
zac 21,11,6
zac 22,14,6
za9 23,17
za9 24,20
s_call_b64 s[88:89], Lf11_four
Lf11_as0Xb0:
ze 15
zf 220,148,76
zd 88,100
zd 89,101
zd 90,102
zd 91,103
zf 224,152,76
zd 92,104
zd 93,105
zd 94,106
zd 95,107
za 0,156,76
zb 204,1,49216
zb 206,1,50752
zb 208,2,49216
za 4,160,76
ze 11
zb 210,2,50752
zb 212,1,49280
zb 214,1,50816
za 8,164,76
zb 216,2,49280
zb 218,2,50816
zb 196,1,49152
za 12,168,76
ze 11
zd 76,108
zd 77,109
zd 78,110
zf 220,188,80
ze 9
zb 198,1,50688
zb 200,2,49152
zb 202,2,50688
zd 79,111
zf 224,192,80
zbr 0x13800
zbb 1
zbb 2
zb2 54
za 0,172,80
zb3 54
zbz 25,54
zbc 0x5800
zbw
zbd
za 4,176,80
ze 0
s_barrier
z6 0x3000
zag 0x3000
z0 42
za 8,180,80
zbe
zn 43,1024
zn 53,2048
za 12,184,80
zn 42,3072
z6 0x4000
zag 0x4000
z0 43
zf 220,204,84
zn 53,1024
zal 28,54
zf 224,208,84
zbc 0x9800
zby
zbd
zbe
za 0,212,84
zal 29,54
zb5
za 4,216,84
zb6 0x21000
zal 30,54
zb7 54
zbv 26,4
za 8,196,84
zbk 26,54
zb8
za 12,200,84
zb9 26
s_branch Lf11_as0H1
Lf11_as0S1:
zgz
s_cbranch_scc0 Lf11_as0Y1
zic
zec 0xaf00
zdu
s_call_b64 s[88:89], Lf11_far
s_branch Lf11_as0Xb1
Lf11_as0Y1:
zaj 21,11,6
zaj 22,14,6
zbm 23,17
zbm 24,20
s_call_b64 s[88:89], Lf11_four
Lf11_as0Xb1:
ze 0
zf 228,148,88
zd 84,100
zd 85,101
zf 232,152,88
zd 86,102
zd 87,103
za 16,156,88
zd 96,104
zd 97,105
za 20,160,88
zd 98,106
zd 99,107
za 24,164,88
za 28,168,88
zd 88,108
zd 89,109
zf 228,188,92
zd 90,110
zd 91,111
zf 232,192,92
za 16,172,92
za 20,176,92
za 24,180,92
za 28,184,92
zf 228,204,76
zf 232,208,76
za 16,212,76
za 20,216,76
za 24,196,76
za 28,200,76
s_branch Lf11_as0H2
Lf11_as0S2:
zdz
s_cbranch_scc0 Lf11_as0Y2
zet
zeu
zev
s_call_b64 s[88:89], Lf11_far
s_branch Lf11_as0Xb2
Lf11_as0Y2:
zaa 21,9,6
zaa 22,12,6
za8 23,15
za8 24,18
s_call_b64 s[88:89], Lf11_four
Lf11_as0Xb2:
ze 0
zf 236,148,84
zbn
zbq 8,0
zd 76,100
zd 77,101
zf 240,152,84
zbo
zd 78,102
zd 79,103
zd 80,104
za 32,156,84
zbp
zd 81,105
zd 82,106
zd 83,107
za 36,160,84
za 40,164,84
za 44,168,84
zd 84,108
zd 85,109
zd 86,110
zf 236,188,96
zu 12
zo 148,1
zb 150,1,1536
zd 87,111
zf 240,192,96
zo 152,2
zb 154,2,1536
zb 156,1,64
za 32,172,96
zb 158,1,1600
zb 160,2,64
zb 162,2,1600
za 36,176,96
zb 164,1,128
zb 166,1,1664
za 40,180,96
zb 168,2,128
zb 170,2,1664
za 44,184,96
zu 6
zb 172,1,6144
zb 174,1,7680
zf 236,204,88
zb 176,2,6144
zb 178,2,7680
zf 240,208,88
zb 180,1,6208
zb 182,1,7744
za 32,212,88
zb 184,2,6208
zb 186,2,7744
za 36,216,88
zb 188,1,6272
zb 190,1,7808
za 40,196,88
zb 192,2,6272
zb 194,2,7808
za 44,200,88
s_branch Lf11_as0E2
Lf11_as1S0:
zff
s_cbranch_scc0 Lf11_as1Y0
zfg
zec 0x5780
zdu
s_call_b64 s[88:89], Lf11_far
s_branch Lf11_as1Xb0
Lf11_as1Y0:
zac 21,11,6
zac 22,14,6
za9 23,17
za9 24,20
s_call_b64 s[88:89], Lf11_four
Lf11_as1Xb0:
ze 15
zf 244,156,76
zd 88,100
zd 89,101
zd 90,102
zd 91,103
zf 248,160,76
ze 14
zd 92,104
zd 93,105
zd 94,106
zd 95,107
za 48,164,76
ze 11
zb 212,1,49280
zb 214,1,50816
zb 216,2,49280
za 52,168,76
zb 218,2,50816
zb 196,1,49152
zb 198,1,50688
za 56,148,76
zb 200,2,49152
zb 202,2,50688
zb 204,1,49216
za 60,152,76
ze 11
zd 76,108
zd 77,109
zd 78,110
zf 244,172,80
zb 206,1,50752
zb 208,2,49216
zb 210,2,50752
zd 79,111
zf 248,176,80
zbr 0x13800
zbb 1
zbb 2
zb2 54
za 48,180,80
zb3 54
zbz 25,54
zbc 0x5800
zbw
zbd
za 52,184,80
ze 0
s_barrier
z6 0x3000
zag 0x3000
z0 42
za 56,188,80
zbe
zn 43,1024
zn 53,2048
za 60,192,80
zn 42,3072
z6 0x4000
zag 0x4000
z0 43
zf 244,212,84
zn 53,1024
zal 28,54
zf 248,216,84
zbc 0x9800
zby
zbd
zbe
za 48,196,84
zal 29,54
zb5
za 52,200,84
zb6 0x21000
zal 30,54
zb7 54
zbv 26,4
za 56,204,84
zbk 26,54
zb8
za 60,208,84
zb9 26
s_branch Lf11_as1H1
Lf11_as1S1:
zgz
s_cbranch_scc0 Lf11_as1Y1
zic
zec 0xaf00
zdu
s_call_b64 s[88:89], Lf11_far
s_branch Lf11_as1Xb1
Lf11_as1Y1:
zaj 21,11,6
zaj 22,14,6
zbm 23,17
zbm 24,20
s_call_b64 s[88:89], Lf11_four
Lf11_as1Xb1:
ze 0
zf 252,156,88
zd 84,100
zd 85,101
za 64,160,88
zd 86,102
zd 87,103
za 68,164,88
zd 96,104
zd 97,105
za 72,168,88
zd 98,106
zd 99,107
za 76,148,88
za 80,152,88
zd 88,108
zd 89,109
zf 252,172,92
zd 90,110
zd 91,111
za 64,176,92
za 68,180,92
za 72,184,92
za 76,188,92
za 80,192,92
zf 252,212,76
za 64,216,76
za 68,196,76
za 72,200,76
z7 76,204
za 80,208,76
s_branch Lf11_as1H2
Lf11_as1S2:
zdz
s_cbranch_scc0 Lf11_as1Y2
zet
zeu
zev
s_call_b64 s[88:89], Lf11_far
s_branch Lf11_as1Xb2
Lf11_as1Y2:
zaa 21,9,6
zaa 22,12,6
za8 23,15
za8 24,18
s_call_b64 s[88:89], Lf11_four
Lf11_as1Xb2:
ze 0
z7 84,156
zbn
zbq 8,0
zd 76,100
zd 77,101
za 88,160,84
zbo
zd 78,102
zd 79,103
zd 80,104
za 92,164,84
zbp
zd 81,105
zd 82,106
zd 83,107
za 96,168,84
za 100,148,84
za 104,152,84
zd 84,108
zd 85,109
zd 86,110
za 84,172,96
zu 12
zo 148,1
zb 150,1,1536
zd 87,111
za 88,176,96
zo 152,2
zb 154,2,1536
zb 156,1,64
za 92,180,96
zb 158,1,1600
zb 160,2,64
zb 162,2,1600
z7 96,184
zb 164,1,128
zb 166,1,1664
za 100,188,96
zb 168,2,128
zb 170,2,1664
za 104,192,96
zu 6
zb 172,1,6144
zb 174,1,7680
za 84,212,88
zb 176,2,6144
zb 178,2,7680
z7 88,216
zb 180,1,6208
zb 182,1,7744
za 92,196,88
zb 184,2,6208
zb 186,2,7744
za 96,200,88
zb 188,1,6272
zb 190,1,7808
za 100,204,88
zb 192,2,6272
zb 194,2,7808
za 104,208,88
s_branch Lf11_as1E2
Lf11_as2S0:
zff
s_cbranch_scc0 Lf11_as2Y0
zfg
zec 0x5780
zdu
s_call_b64 s[88:89], Lf11_far
s_branch Lf11_as2Xb0
Lf11_as2Y0:
zac 21,11,6
zac 22,14,6
za9 23,17
za9 24,20
s_call_b64 s[88:89], Lf11_four
Lf11_as2Xb0:
ze 14
za 108,164,76
ze 12
zd 88,100
zd 89,101
zd 90,102
zd 91,103
za 112,168,76
zd 92,104
zd 93,105
zd 94,106
zd 95,107
za 116,148,76
zb 196,1,49152
zb 198,1,50688
zb 200,2,49152
za 120,152,76
zb 202,2,50688
zb 204,1,49216
zb 206,1,50752
za 124,156,76
zb 208,2,49216
zb 210,2,50752
zb 212,1,49280
za 128,160,76
ze 11
zd 76,108
zd 77,109
zd 78,110
za 108,180,80
zb 214,1,50816
zb 216,2,49280
zb 218,2,50816
zd 79,111
za 112,184,80
zbr 0x13800
zbb 1
zbb 2
zb2 54
za 116,188,80
ze 12
zb3 54
zbz 25,54
zbc 0x5800
zbw
zbd
za 120,192,80
ze 0
s_barrier
z6 0x3000
zag 0x3000
z0 42
za 124,172,80
zbe
zn 43,1024
zn 53,2048
za 128,176,80
zn 42,3072
z6 0x4000
zag 0x4000
z0 43
za 108,196,84
zn 53,1024
zal 28,54
za 112,200,84
zbc 0x9800
zby
zbd
zbe
za 116,204,84
zal 29,54
zb5
za 120,208,84
zb6 0x21000
zal 30,54
zb7 54
zbv 26,4
za 124,212,84
zbk 26,54
zb8
za 128,216,84
zb9 26
s_branch Lf11_as2H1
Lf11_as2S1:
zgz
s_cbranch_scc0 Lf11_as2Y1
zic
zec 0xaf00
zdu
s_call_b64 s[88:89], Lf11_far
s_branch Lf11_as2Xb1
Lf11_as2Y1:
zaj 21,11,6
zaj 22,14,6
zbm 23,17
zbm 24,20
s_call_b64 s[88:89], Lf11_four
Lf11_as2Xb1:
ze 0
za 132,164,88
zd 84,100
zd 85,101
za 136,168,88
zd 86,102
zd 87,103
za 140,148,88
zd 96,104
zd 97,105
za 144,152,88
zd 98,106
zd 99,107
za 148,156,88
za 152,160,88
zd 88,108
zd 89,109
za 132,180,92
zd 90,110
zd 91,111
za 136,184,92
za 140,188,92
za 144,192,92
za 148,172,92
za 152,176,92
za 132,196,76
za 136,200,76
za 140,204,76
za 144,208,76
za 148,212,76
za 152,216,76
s_branch Lf11_as2H2
Lf11_as2S2:
zdz
s_cbranch_scc0 Lf11_as2Y2
zet
zeu
zev
s_call_b64 s[88:89], Lf11_far
s_branch Lf11_as2Xb2
Lf11_as2Y2:
zaa 21,9,6
zaa 22,12,6
za8 23,15
za8 24,18
s_call_b64 s[88:89], Lf11_four
Lf11_as2Xb2:
ze 0
za 156,164,84
zbn
zbq 8,0
zd 76,100
zd 77,101
za 160,168,84
zbo
zd 78,102
zd 79,103
zd 80,104
za 164,148,84
zbp
zd 81,105
zd 82,106
zd 83,107
za 168,152,84
za 172,156,84
za 176,160,84
zd 84,108
zd 85,109
zd 86,110
za 156,180,96
zu 12
zo 148,1
zb 150,1,1536
zd 87,111
za 160,184,96
zo 152,2
zb 154,2,1536
zb 156,1,64
za 164,188,96
zb 158,1,1600
zb 160,2,64
zb 162,2,1600
za 168,192,96
zb 164,1,128
zb 166,1,1664
zdm 172,96
zb 168,2,128
zb 170,2,1664
zdm 176,96
zu 6
zb 172,1,6144
zb 174,1,7680
za 156,196,88
zb 176,2,6144
zb 178,2,7680
za 160,200,88
zb 180,1,6208
zb 182,1,7744
za 164,204,88
zb 184,2,6208
zb 186,2,7744
za 168,208,88
zb 188,1,6272
zb 190,1,7808
za 172,212,88
zb 192,2,6272
zb 194,2,7808
za 176,216,88
s_branch Lf11_as2E2
Lf11_as3S0:
zff
s_cbranch_scc0 Lf11_as3Y0
zfg
zec 0x5780
zdu
s_call_b64 s[88:89], Lf11_far
s_branch Lf11_as3Xb0
Lf11_as3Y0:
zac 21,11,6
zac 22,14,6
za9 23,17
za9 24,20
s_call_b64 s[88:89], Lf11_four
Lf11_as3Xb0:
ze 15
za 180,148,76
zd 88,100
zd 89,101
zd 90,102
za 184,152,76
zd 91,103
zd 92,104
zd 93,105
za 188,156,76
zd 94,106
zd 95,107
zd 96,108
za 192,160,76
ze 9
zd 97,109
zd 98,110
zd 99,111
za 196,164,76
zb 204,1,49216
zb 206,1,50752
zb 208,2,49216
za 200,168,76
ze 5
zb 210,2,50752
zb 212,1,49280
za 180,188,80
ze 5
zb 214,1,50816
zb 216,2,49280
za 184,192,80
zb 218,2,50816
zb 196,1,49152
za 188,172,80
zb 198,1,50688
zb 200,2,49152
zb 202,2,50688
za 192,176,80
ze 0
s_barrier
zbr 0x13800
zbb 1
zbb 2
za 196,180,80
zb2 54
zb3 54
za 200,184,80
zbz 25,54
zbc 0x5800
zbw
zbd
za 180,204,84
zbe
zal 28,54
zbc 0x9800
za 184,208,84
zby
zbd
zbe
za 188,212,84
zal 29,54
zb5
za 192,216,84
zb6 0x21000
zal 30,54
zb7 54
zbv 26,4
zdm 196,84
zbk 26,54
zb8
zdm 200,84
zb9 26
s_branch Lf11_as3H1
Lf11_as3S1:
zdz
s_cbranch_scc0 Lf11_as3Y1
zet
zeu
zev
s_call_b64 s[88:89], Lf11_far
s_branch Lf11_as3Xb1
Lf11_as3Y1:
zaa 21,9,6
zaa 22,12,6
za8 23,15
za8 24,18
s_call_b64 s[88:89], Lf11_four
Lf11_as3Xb1:
ze 0
za 204,148,88
zbn
zbq 8,0
zd 76,100
zd 77,101
za 208,152,88
zbo
zd 78,102
zd 79,103
zd 80,104
za 212,156,88
zbp
zd 81,105
zd 82,106
zd 83,107
za 216,160,88
zd 84,108
zd 85,109
za 220,164,88
zd 86,110
zd 87,111
za 224,168,88
zu 6
zo 148,1
zb 150,1,1536
za 204,188,92
zo 152,2
zb 154,2,1536
za 208,192,92
zb 156,1,64
zb 158,1,1600
za 212,172,92
zb 160,2,64
zb 162,2,1600
za 216,176,92
zb 164,1,128
zb 166,1,1664
za 220,180,92
zb 168,2,128
zb 170,2,1664
za 224,184,92
zu 0
zb 172,1,6144
zb 174,1,7680
zdm 204,96
zb 176,2,6144
zb 178,2,7680
zdm 208,96
zb 180,1,6208
zb 182,1,7744
zdm 212,96
zb 184,2,6208
zb 186,2,7744
zdm 216,96
zb 188,1,6272
zb 190,1,7808
za 220,196,96
zb 192,2,6272
zb 194,2,7808
za 224,200,96
s_branch Lf11_as3E2
Lf11_four:
ze 0
zo 104,21
zo 106,22
zb 108,21,16
zb 110,22,16
zb 100,21,4608
zb 102,21,4816
zb 112,21,4624
zb 114,21,4832
zb 116,21,64
zb 118,22,64
zb 120,21,80
zb 122,22,80
zc3 140,23,3
zc3 141,23,5
zc3 142,24,3
zc3 143,24,5
zg0 23
zg0 24
zc3 144,24,3
zc3 145,24,5
zc3 146,23,3
ze 10
zh 124,104,140
zb 104,21,4672
zb 106,21,4880
ze 10
zh 128,108,140
zb 108,21,4688
zb 110,21,4896
ze 6
zh 132,116,140
zb 116,21,144
zb 118,22,144
ze 6
zh 136,120,140
zb 120,21,4736
zb 122,21,4944
zc3 147,23,5
zam
zf 124,100,144
zf 128,112,144
zb 112,21,128
zb 114,22,128
ze 8
zf 132,104,144
ze 6
zf 136,108,144
zb 108,21,4752
zb 110,21,4960
zc 100,124,125
zc 101,126,127
zc 102,128,129
zc 103,130,131
ze 6
zh 128,116,140
zc 104,132,133
zc 105,134,135
zc 106,136,137
zc 107,138,139
ze 2
zh 124,112,140
zf 124,120,144
ze 0
zf 128,108,144
s_nop 5
zc 108,124,125
zc 109,126,127
zc 110,128,129
zc 111,130,131
zgb
Lf11_far:
ze 0
zh6 110,4
zh7 100,110
zh8
v_mul_u32_u24 v107, 52, v4
v_sub_u32 v107, v0, v107
zh9
zgr 104,4
zia 103
zib 104
z2 104
zu 0
zx 101,100
zr 102,100
zg 101,103
zg 102,104
zs 101
zs 102
zc 100,101,102
zx 101,100
zr 102,100
z3 103,101
z3 104,102
z4 105,101,103
z4 106,102,104
z5 101,105
z5 102,106
zw 144,101,102
zw 145,101,106
zw 146,105,102
zw 147,105,106
zgf 103
zgf 104
zgg 108,103
zgg 109,104
zgh 108
zgh 109
zgi 103
zgi 108
zck 104
zck 109
ze 0
zew 140,103,104,107
zew 141,103,109,107
zew 142,108,104,107
zew 143,108,109,107
zfh 124,140
zbi 126,140,16
zbi 128,140,64
zbi 130,140,80
zbi 132,140,128
zbi 134,140,144
zu 5
zx 140,124
zw 100,144,140
zr 140,124
zw 101,144,140
zx 140,125
zw 102,144,140
zr 140,125
zw 103,144,140
zu 4
zx 140,126
zw 104,144,140
zr 140,126
zw 105,144,140
zx 140,127
zw 106,144,140
zr 140,127
zw 107,144,140
zu 3
zx 140,128
zw 108,144,140
zr 140,128
zw 109,144,140
zx 140,129
zw 110,144,140
zr 140,129
zw 111,144,140
zu 2
zx 140,130
zw 112,144,140
zr 140,130
zw 113,144,140
zx 140,131
zw 114,144,140
zr 140,131
zw 115,144,140
zu 1
zx 140,132
zw 116,144,140
zr 140,132
zw 117,144,140
zx 140,133
zw 118,144,140
zr 140,133
zw 119,144,140
zu 0
zx 140,134
zw 120,144,140
zr 140,134
zw 121,144,140
zx 140,135
zw 122,144,140
zr 140,135
zw 123,144,140
zfh 124,141
zbi 126,141,16
zbi 128,141,64
zbi 130,141,80
zbi 132,141,128
zbi 134,141,144
zu 5
zx 141,124
zy 100,145,141
zr 141,124
zy 101,145,141
zx 141,125
zy 102,145,141
zr 141,125
zy 103,145,141
zu 4
zx 141,126
zy 104,145,141
zr 141,126
zy 105,145,141
zx 141,127
zy 106,145,141
zr 141,127
zy 107,145,141
zu 3
zx 141,128
zy 108,145,141
zr 141,128
zy 109,145,141
zx 141,129
zy 110,145,141
zr 141,129
zy 111,145,141
zu 2
zx 141,130
zy 112,145,141
zr 141,130
zy 113,145,141
zx 141,131
zy 114,145,141
zr 141,131
zy 115,145,141
zu 1
zx 141,132
zy 116,145,141
zr 141,132
zy 117,145,141
zx 141,133
zy 118,145,141
zr 141,133
zy 119,145,141
zu 0
zx 141,134
zy 120,145,141
zr 141,134
zy 121,145,141
zx 141,135
zy 122,145,141
zr 141,135
zy 123,145,141
zfh 124,142
zbi 126,142,16
zbi 128,142,64
zbi 130,142,80
zbi 132,142,128
zbi 134,142,144
zu 5
zx 142,124
zy 100,146,142
zr 142,124
zy 101,146,142
zx 142,125
zy 102,146,142
zr 142,125
zy 103,146,142
zu 4
zx 142,126
zy 104,146,142
zr 142,126
zy 105,146,142
zx 142,127
zy 106,146,142
zr 142,127
zy 107,146,142
zu 3
zx 142,128
zy 108,146,142
zr 142,128
zy 109,146,142
zx 142,129
zy 110,146,142
zr 142,129
zy 111,146,142
zu 2
zx 142,130
zy 112,146,142
zr 142,130
zy 113,146,142
zx 142,131
zy 114,146,142
zr 142,131
zy 115,146,142
zu 1
zx 142,132
zy 116,146,142
zr 142,132
zy 117,146,142
zx 142,133
zy 118,146,142
zr 142,133
zy 119,146,142
zu 0
zx 142,134
zy 120,146,142
zr 142,134
zy 121,146,142
zx 142,135
zy 122,146,142
zr 142,135
zy 123,146,142
zfh 124,143
zbi 126,143,16
zbi 128,143,64
zbi 130,143,80
zbi 132,143,128
zbi 134,143,144
zu 5
zx 143,124
zy 100,147,143
zr 143,124
zy 101,147,143
zx 143,125
zy 102,147,143
zr 143,125
zy 103,147,143
zu 4
zx 143,126
zy 104,147,143
zr 143,126
zy 105,147,143
zx 143,127
zy 106,147,143
zr 143,127
zy 107,147,143
zu 3
zx 143,128
zy 108,147,143
zr 143,128
zy 109,147,143
zx 143,129
zy 110,147,143
zr 143,129
zy 111,147,143
zu 2
zx 143,130
zy 112,147,143
zr 143,130
zy 113,147,143
zx 143,131
zy 114,147,143
zr 143,131
zy 115,147,143
zu 1
zx 143,132
zy 116,147,143
zr 143,132
zy 117,147,143
zx 143,133
zy 118,147,143
zr 143,133
zy 119,147,143
zu 0
zx 143,134
zy 120,147,143
zr 143,134
zy 121,147,143
zx 143,135
zy 122,147,143
zr 143,135
zy 123,147,143
zq 100,101
zc 101,102,103
zc 102,104,105
zc 103,106,107
zc 104,108,109
zc 105,110,111
zc 106,112,113
zc 107,114,115
zc 108,116,117
zc 109,118,119
zc 110,120,121
zc 111,122,123
zgb
Lf10_start:
zhf 124,0
zhr 0x4800
s_add_u32 s73, s73, 0x12000
s_mul_i32 s81, s21, 0xe0
s_add_u32 s81, s81, s22
s_mul_i32 s93, s81, 0xc0
s_mul_i32 s77, s81, 0x64
zhb 125,124
zhc 126,124
zgd 128,124
v_and_b32 v130, 12, v124
zgu 127,130,126
v_add_u32 v48, s21, v128
v_add_u32 v33, s22, v127
zh4 129,128
zh5 130,127
zgu 35,129,130
s_mul_i32 s25, s20, 13
s_lshr_b32 s25, s25, 1
zed
zee 0x4800
zef
zeg
zeh 0x1200
zei
zej 0xd0
zek 0x12d0
zel
zem
zen
zeo
zbn
zbo
zbp
zhg 0x930000
zhh 0x20000
zhi 0x20000
zha 0x70880
zhj 0x20000
zhk 0x20000
zhw
zhz 0x1200
s_sub_u32 s85, s21, 3
s_add_u32 s85, s85, s20
s_add_u32 s97, s85, 0
zcv
zcw 0xdf
zbt 0xa800
s_add_u32 s42, s35, 0
ze2 129,124
zep 130,129
zd9 130
zeq 25,130
zd0 129,25
zer 129
zea 130
zes 130
zeb 130
zck 130
zbk 130,129
zc9 129,0x40000000
zcs 25,130,129
ze 0
zhl 0xffff
zhp 0xffff
zcx
zv
zae 25
ze5
zfi 56,35
zhs 129,124
zep 130,129
zd9 130
zeq 26,130
zd0 129,26
zer 129
zea 130
zes 130
zeb 130
zck 130
zbk 130,129
zc9 129,0x40000000
zcs 26,130,129
zan 0x400
zv
zae 26
zht 129,124
zep 130,129
zd9 130
zeq 27,130
zd0 129,27
zer 129
zea 130
zes 130
zeb 130
zck 130
zbk 130,129
zc9 129,0x40000000
zcs 27,130,129
zan 0x800
zv
zae 27
v_add_u32 v129, 0xc0, v124
zep 130,129
zd9 130
zeq 28,130
zd0 129,28
zer 129
zea 130
zes 130
zeb 130
zck 130
zbk 130,129
zc9 129,0x40000000
zcs 28,130,129
zan 0xc00
zv
zae 28
v_add_u32 v129, 0x100, v124
zep 130,129
zd9 130
zeq 29,130
zd0 129,29
zer 129
zea 130
zes 130
zeb 130
zck 130
zbk 130,129
zc9 129,0x40000000
zcs 29,130,129
zcy 0x3fffffff
zan 0x1000
zv
zae 29
zcz
s_add_u32 s97, s85, 4
zcv
zcw 0xdf
zbt 0xa800
zdd 0x4800
zcx
zv
zae 25
zan 0x400
zv
zae 26
zan 0x800
zv
zae 27
zan 0xc00
zv
zae 28
zcy 0x3fffffff
zan 0x1000
zv
zae 29
zcz
zhm 0x80
zhn
zho 0xffff
zhq 0xffff
zde
s_cselect_b32 s82, 0, s20
s_lshl_b32 s83, s82, 6
s_add_u32 s83, s83, 0x80
s_mul_i32 s82, s82, 5
s_lshr_b32 s82, 0x5880, s82
zh0 129,124
v_lshl_add_u32 v130, v124, 4, s83
v_lshl_add_u32 v129, v129, 4, s83
zgr 127,124
v_mul_u32_u24 v128, 0x56, v127
v_lshrrev_b32 v128, 8, v128
v_mad_i32_i24 v127, v128, -3, v127
v_cmp_le_u32 vcc, 48, v124
zam
zcs 42,130,129
v_cmp_gt_u32 vcc, 32, v124
zam
zcs 43,130,129
v_cmp_le_u32 vcc, 16, v124
zam
zcs 53,130,129
s_mov_b32 s84, 0xffffff40
zfx 128,127
zfy 42,128
zgv
zfx 128,127
zfy 43,128
zgv
zfx 128,127
zfy 53,128
zcg
zcu
z0 42
zn 43,1024
zn 53,2048
zn 42,3072
z6 0x1000
zag 0x1000
z0 43
zn 53,1024
zn 42,2048
zn 43,3072
z6 0x2000
zag 0x2000
z0 53
zn 42,1024
zn 43,2048
zn 53,3072
z6 0x3000
zag 0x3000
z0 42
zn 43,1024
zn 53,2048
zn 42,3072
z6 0x4000
zag 0x4000
z0 43
zn 53,1024
zc8 0x15e00
zfi 62,35
zhd 127,124
zgd 128,124
zfk 131,126
zg3 4,125
zh1 0x435f0000
zgc 130,126
zgp 0,131
zgn 0,130
v_mul_u32_u24 v129, 0xd0, v125
v_add_u32 v0, v129, v0
zf9 129,130
zg2 129,131
zhe 129,127
zck 129
zgq 130,128,131
zbk 129,130
v_add_u32 v129, s73, v129
zfk 130,128
zh2 1,130,129
zh3 2,1
s_mov_b32 s3, 0
zfz
s_cselect_b32 s3, 3, s3
zf0
s_cselect_b32 s3, 6, s3
zde
s_cselect_b32 s3, 8, s3
s_mov_b32 s78, s3
s_mul_i32 s79, s3, 0x5780
s_add_u32 s79, s79, s77
s_add_u32 s79, s79, 48
s_mul_i32 s94, s3, 0x1200
s_add_u32 s94, s94, 0x3870
zbq 8,0
ze3
zed
zee 0x4800
zef
zeg
zeh 0x1200
zei
zej 0xd0
zek 0x12d0
zel
zem
zen
zeo
s_mov_b32 s80, 0
s_mul_i32 s58, s20, 0x1800
s_add_u32 s58, s58, 0x33000
zde
s_cselect_b32 s58, s71, s58
zgp 6,130
zgc 130,128
zgn 6,130
zfk 130,127
zf9 7,130
zc9 129,0xffff
v_lshlrev_b32 v129, v7, v129
v_cmp_eq_u32 vcc, v128, v126
zam
zas 129
v_cmp_gt_u32 vcc, 2, v127
zam
v_cndmask_b32 v3, 0, v129, vcc
zgq 5,3,129
s_sub_u32 s82, s21, 3
s_sub_u32 s83, s22, 3
v_cvt_f32_i32 v49, s82
v_cvt_f32_i32 v50, s83
v_add_f32 v129, 0x41600000, v49
v_add_f32 v130, 0x41a00000, v50
v_mul_f32 v51, 0xc3500000, v50
v_fmamk_f32 v51, v49, 0xc5900000, v51
v_readfirstlane_b32 s75, v129
v_readfirstlane_b32 s76, v130
zc9 52,0x120
s_mov_b32 s26, 0x11111111
s_mov_b32 s27, 0x11111111
s_mov_b32 s28, 0x22222222
s_mov_b32 s29, 0x22222222
s_mov_b32 s30, 0x44444444
s_mov_b32 s31, 0x44444444
s_mov_b32 s32, 0x88888888
s_mov_b32 s33, 0x88888888
zu 28
zx 36,56
zr 37,56
zgw 38,48
zbs 39,33
z2 38
z2 39
zg 36,38
zg 37,39
zs 38
zs 39
zs 36
zs 37
zq 38,39
zq 36,37
zr 37,36
zav 36,38
zaw 36
z3 45,37
z3 44,36
z4 47,37,45
z4 46,36,44
zgw 38,48
z2 38
zd1 39,49
zd2 38,39
zax 47
z5 36,46
z5 37,47
zd3 40,44,49,38
zay 41,45,50
zw 38,36,37
zaz 36,47
za0 37,46
zw 39,46,47
za1 41,45
za2 41,51
za3 36,37
zas 37
za4 41,40
zq 38,39
zq 36,37
za5 37,52
zdf 40,44
zdg 39
za6 9,41
z8 15,38,7
z8 18,36,7
zdh
zau 12,37,9
zdi
zdj
Lf10_aqR0:
zu 19
s_barrier
zcf
s_cbranch_scc1 Lf10_aqG0
Lf10_aqRb0:
zdk 76,8
zi 78,8,16
zi 80,8,64
zi 82,8,80
zi 84,8,128
zi 86,8,144
zu 13
zo 148,1
zb 150,1,1536
zo 152,2
zb 154,2,1536
zb 156,1,64
zb 158,1,1600
zb 160,2,64
zb 162,2,1600
zb 164,1,128
zb 166,1,1664
zb 168,2,128
zb 170,2,1664
zu 7
zb 172,1,6144
zb 174,1,7680
zb 176,2,6144
zb 178,2,7680
zb 180,1,6208
zb 182,1,7744
zb 184,2,6208
zb 186,2,7744
zb 188,1,6272
zb 190,1,7808
zb 192,2,6272
zb 194,2,7808
Lf10_atR0:
zda
s_cbranch_scc1 Lf10_atG0
Lf10_atRb0:
ze 15
zh 220,148,76
zu 1
zb 196,1,12288
zb 198,1,13824
zh 224,152,76
zb 200,2,12288
zb 202,2,13824
zp 0,156,76
zb 204,1,12352
zb 206,1,13888
zp 4,160,76
ze 15
zb 208,2,12352
zb 210,2,13888
zp 8,164,76
zb 212,1,12416
zb 214,1,13952
zp 12,168,76
zb 216,2,12416
zb 218,2,13952
zf 220,172,80
ze 15
zi 88,8,4608
zi 90,8,4624
zf 224,176,80
zi 92,8,4672
zi 94,8,4688
za 0,180,80
zi 96,8,4736
zi 98,8,4752
za 4,184,80
zf1
zcv
zcw 0xdf
zbt 0xa800
zdd 0x9000
ze 15
za 8,188,80
zcx
zv
zae 25
za 12,192,80
zan 0x400
zv
zae 26
zf 220,196,84
zan 0x800
zv
zae 27
ze 5
zf 224,200,84
zan 0xc00
zv
zae 28
za 0,204,84
zcy 0x3fffffff
zan 0x1000
zv
zae 29
zcz
za 4,208,84
za 8,212,84
za 12,216,84
Lf10_atR1:
zdb
s_cbranch_scc1 Lf10_atG1
Lf10_atRb1:
ze 0
zh 228,148,88
zi 76,8,9216
zi 78,8,9232
zi 80,8,9280
zf 228,172,92
zi 82,8,9296
zi 84,8,9344
zi 86,8,9360
zf 228,196,96
zgj
zcv
zcw 0xdf
zbt 0xa800
zdd 0xd800
zh 232,152,88
zcx
zv
zae 25
zf 232,176,92
zan 0x400
zv
zae 26
zf 232,200,96
zan 0x800
zv
zae 27
zp 16,156,88
zan 0xc00
zv
zae 28
za 16,180,92
zcy 0x3fffffff
zan 0x1000
zv
zae 29
zcz
za 16,204,96
zc8 0x2bc00
zfi 68,35
zu 11
zx 36,62
zp 20,160,88
zr 37,62
zci 38,48
za 20,184,92
zbs 39,33
z2 38
za 20,208,96
z2 39
zg 36,38
zp 24,164,88
zg 37,39
zs 38
za 24,188,92
zs 39
zs 36
za 24,212,96
zbr 0x12000
zdw 1
zdw 2
zp 28,168,88
za 28,192,92
za 28,216,96
Lf10_atR2:
zu 6
s_barrier
zdc
s_cbranch_scc1 Lf10_atG2
Lf10_atRb2:
ze 0
zh 236,148,76
zi 88,8,13824
zi 90,8,13840
zi 92,8,13888
zf 236,172,80
zi 94,8,13904
zi 96,8,13952
zi 98,8,13968
zf 236,196,84
zf2 32,35
z6 0x3000
zc7 0x3000
z0 42
zh 240,152,76
zn 43,1024
zn 53,2048
zf 240,176,80
zs 37
zq 38,39
zq 36,37
zf 240,200,84
zr 37,36
zav 36,38
zaw 36
zp 32,156,76
z3 45,37
z3 44,36
z4 47,37,45
za 32,180,80
z4 46,36,44
zci 38,48
z2 38
za 32,204,84
zd1 39,49
zd2 38,39
zax 47
zp 36,160,76
z5 36,46
z5 37,47
zd3 40,44,49,38
za 36,184,80
zay 41,45,50
zw 38,36,37
zaz 36,47
za 36,208,84
za0 37,46
zw 39,46,47
za1 41,45
zp 40,164,76
za2 41,51
za3 36,37
zas 37
za 40,188,80
za4 41,40
zq 38,39
zq 36,37
za 40,212,84
za5 37,52
zca 40,44
zcb 39
zp 44,168,76
za6 10,41
z8 16,38,7
z8 19,36,7
za 44,192,80
zcc
zau 13,37,10
zcd
zce
za 44,216,84
Lf10_atR3:
zc5
s_cbranch_scc1 Lf10_atG3
Lf10_atRb3:
ze 0
zh 244,148,88
zi 76,8,18432
zi 78,8,18448
zf 244,172,92
zi 80,8,18496
zi 82,8,18512
zf 244,196,96
zi 84,8,18560
zi 86,8,18576
zh 248,152,88
ze5
zc6 60,35,16
z6 0x3000
zc7 0x3000
zn 42,3072
zf 248,176,92
z6 0x4000
zc7 0x4000
z0 43
zf 248,200,96
zn 53,1024
zp 48,156,88
zu 8
zx 36,68
zr 37,68
za 48,180,92
zcl 38,48
zbs 39,33
za 48,204,96
z2 38
z2 39
zp 52,160,88
zg 36,38
zg 37,39
za 52,184,92
zs 38
zs 39
za 52,208,96
zs 36
zs 37
zp 56,164,88
zq 38,39
zq 36,37
za 56,188,92
zr 37,36
zav 36,38
za 56,212,96
zaw 36
zp 60,168,88
za 60,192,92
za 60,216,96
Lf10_atR4:
zc0
s_cbranch_scc1 Lf10_atG4
Lf10_atRb4:
ze 0
zh 252,148,76
zi 88,8,23040
zi 90,8,23056
zi 92,8,23104
zf 252,172,80
zi 94,8,23120
zi 96,8,23168
zi 98,8,23184
zf 252,196,84
zc8 0x15e00
zc6 66,35,16
zcg
zcu
z0 42
zp 64,152,76
zn 43,1024
zn 53,2048
za 64,176,80
z3 45,37
z3 44,36
z4 47,37,45
za 64,200,84
z4 46,36,44
zcl 38,48
z2 38
zp 68,156,76
zd1 39,49
zd2 38,39
za 68,180,80
zax 47
z5 36,46
za 68,204,84
z5 37,47
zd3 40,44,49,38
zp 72,160,76
zay 41,45,50
zw 38,36,37
za 72,184,80
zaz 36,47
za0 37,46
za 72,208,84
zw 39,46,47
za1 41,45
zex 76,164
za2 41,51
za3 36,37
za 76,188,80
zas 37
za4 41,40
za 76,212,84
zq 38,39
zq 36,37
zp 80,168,76
za5 37,52
zcm 40,44
z7 80,192
zcn 39
za6 11,41
za 80,216,84
Lf10_atR5:
zd4
s_cbranch_scc1 Lf10_atG5
Lf10_atRb5:
ze 0
zp 84,148,88
zi 76,8,27648
zi 78,8,27664
zi 80,8,27712
za 84,172,92
zi 82,8,27728
zi 84,8,27776
zi 86,8,27792
za 84,196,96
zc8 0x2bc00
zc6 72,35,16
zcg
zcu
zn 42,3072
zex 88,152
z6 0x1000
zag 0x1000
z0 43
za 88,176,92
zn 53,1024
z8 17,38,7
za 88,200,96
z8 20,36,7
zco
zp 92,156,88
zau 14,37,11
zcp
zcq
z7 92,180
zx 36,57
zr 37,57
zdx 38,48
za 92,204,96
zcj 39,33
z2 38
z2 39
zp 96,160,88
zg 36,38
zg 37,39
za 96,184,92
zs 38
zs 39
z7 96,208
zs 36
zs 37
zp 100,164,88
zq 38,39
zq 36,37
za 100,188,92
zr 37,36
zav 36,38
za 100,212,96
zaw 36
z3 45,37
zp 104,168,88
z3 44,36
z4 47,37,45
za 104,192,92
z4 46,36,44
zax 47
za 104,216,96
Lf10_atR6:
s_barrier
zd5
s_cbranch_scc1 Lf10_atG6
Lf10_atRb6:
ze 0
zp 108,148,76
zi 88,8,32256
zi 90,8,32272
zi 92,8,32320
za 108,172,80
zi 94,8,32336
zi 96,8,32384
zi 98,8,32400
za 108,196,84
zn 42,2048
zn 43,3072
zp 112,152,76
z6 0x2000
zag 0x2000
z0 53
za 112,176,80
z5 36,46
z5 37,47
zbg 40,44,49
za 112,200,84
zay 41,45,50
zw 38,36,37
zaz 36,47
zp 116,156,76
za0 37,46
zw 39,46,47
za1 41,45
za 116,180,80
za2 41,51
za3 36,37
za 116,204,84
zas 37
za4 41,40
zp 120,160,76
zq 38,39
zq 36,37
za 120,184,80
za5 37,52
zdf 40,44
za 120,208,84
zdg 39
za6 9,41
zp 124,164,76
z8 15,38,7
z8 18,36,7
za 124,188,80
zdh
zau 12,37,9
zdi
za 124,212,84
zdj
zx 36,63
zr 37,63
zfl 38,48
zp 128,168,76
zcj 39,33
z2 38
za 128,192,80
z2 39
zg 36,38
za 128,216,84
Lf10_atR7:
zdy
s_cbranch_scc1 Lf10_atG7
Lf10_atRb7:
ze 0
zp 132,148,88
zi 76,8,36864
zi 78,8,36880
zi 80,8,36928
za 132,172,92
zi 82,8,36944
zi 84,8,36992
zi 86,8,37008
za 132,196,96
zn 42,1024
zn 43,2048
zp 136,152,88
zn 53,3072
zg 37,39
za 136,176,92
zs 38
zs 39
zs 36
za 136,200,96
zs 37
zq 38,39
zq 36,37
zp 140,156,88
zr 37,36
zav 36,38
zaw 36
za 140,180,92
z3 45,37
z3 44,36
z4 47,37,45
za 140,204,96
z4 46,36,44
zax 47
zp 144,160,88
z5 36,46
z5 37,47
za 144,184,92
zbg 40,44,49
zay 41,45,50
za 144,208,96
zw 38,36,37
zaz 36,47
zp 148,164,88
za0 37,46
zw 39,46,47
za 148,188,92
za1 41,45
za2 41,51
za 148,212,96
za3 36,37
zas 37
zp 152,168,88
za4 41,40
zq 38,39
za 152,192,92
zq 36,37
za5 37,52
za 152,216,96
Lf10_atR8:
zc1
s_cbranch_scc1 Lf10_atG8
Lf10_atRb8:
ze 0
zp 156,148,76
zi 88,8,41472
zi 90,8,41488
zi 92,8,41536
zi 94,8,41552
za 156,172,80
zi 96,8,41600
zi 98,8,41616
zca 40,44
zcb 39
za 156,196,84
za6 10,41
z8 16,38,7
z8 19,36,7
zcc
zp 160,152,76
zu 21
zau 13,37,10
zcd
zce
zx 36,32
za 160,176,80
zr 37,32
zf3 38,48
ze2 39,33
z2 38
za 160,200,84
z2 39
zg 36,38
zg 37,39
zs 38
zp 164,156,76
zs 39
zs 36
zs 37
zq 38,39
za 164,180,80
zq 36,37
zr 37,36
zav 36,38
zaw 36
za 164,204,84
z3 45,37
z3 44,36
z4 47,37,45
zp 168,160,76
z4 46,36,44
zax 47
z5 36,46
za 168,184,80
z5 37,47
zbg 40,44,49
zay 41,45,50
za 168,208,84
zw 38,36,37
zaz 36,47
za0 37,46
zp 172,164,76
zw 39,46,47
za1 41,45
za2 41,51
za 172,188,80
za3 36,37
zas 37
za4 41,40
za 172,212,84
zq 38,39
zq 36,37
za5 37,52
zp 176,168,76
zcm 40,44
zcn 39
za6 11,41
z8 17,38,7
za 176,192,80
z8 20,36,7
zco
zau 14,37,11
zcp
za 176,216,84
zcq
Lf10_atR9:
zu 14
s_barrier
zdy
s_cbranch_scc1 Lf10_atG9
Lf10_atRb9:
ze 0
zp 180,148,88
zf4 8,0
zp 184,152,88
zdk 76,8
zi 78,8,16
zp 188,156,88
zi 80,8,64
zi 82,8,80
zp 192,160,88
zi 84,8,128
zi 86,8,144
zp 196,164,88
zp 200,168,88
zb 148,1,12288
zb 150,1,13824
za 180,172,92
zb 152,2,12288
zb 154,2,13824
za 184,176,92
zb 156,1,12352
zb 158,1,13888
za 188,180,92
zb 160,2,12352
zb 162,2,13888
za 192,184,92
zb 164,1,12416
zb 166,1,13952
za 196,188,92
zb 168,2,12416
zb 170,2,13952
za 200,192,92
zb 172,1,30720
zb 174,1,32256
za 180,196,96
zb 176,2,30720
zb 178,2,32256
za 184,200,96
zb 180,1,30784
zb 182,1,32320
za 188,204,96
zb 184,2,30784
zb 186,2,32320
za 192,208,96
zb 188,1,30848
zb 190,1,32384
za 196,212,96
zb 192,2,30848
zb 194,2,32384
za 200,216,96
zfz
s_cbranch_scc1 Lf10_as1R0
zf0
s_cbranch_scc1 Lf10_as2R0
zde
s_cbranch_scc1 Lf10_as3R0
Lf10_as0R0:
zc1
s_cbranch_scc1 Lf10_as0G0
Lf10_as0Rb0:
ze 15
zf 220,148,76
zb 204,1,49216
zb 206,1,50752
zb 208,2,49216
zf 224,152,76
zb 210,2,50752
zb 212,1,49280
zb 214,1,50816
za 0,156,76
zb 216,2,49280
zb 218,2,50816
zb 196,1,49152
za 4,160,76
ze 15
zb 198,1,50688
zb 200,2,49152
zb 202,2,50688
za 8,164,76
zi 88,8,4608
zi 90,8,4624
zi 92,8,4672
za 12,168,76
ze 15
zi 94,8,4688
zi 76,8,4736
zi 78,8,4752
zf 220,188,80
zbr 0x12000
zbb 1
zbb 2
zf 224,192,80
zb2 54
zb3 54
zbz 25,54
za 0,172,80
zbc 0x5800
zbw
zbd
zbe
za 4,176,80
ze 6
s_barrier
z6 0x3000
zag 0x3000
z0 42
za 8,180,80
zn 43,1024
zn 53,2048
za 12,184,80
zn 42,3072
z6 0x4000
zag 0x4000
z0 43
zf 220,204,84
zn 53,1024
zal 28,54
zf 224,208,84
zbc 0x9800
zby
zbd
zbe
za 0,212,84
zal 29,54
zb5
za 4,216,84
zb6 0x1f800
zal 30,54
zb7 54
zbv 26,4
za 8,196,84
zbk 26,54
zb8
za 12,200,84
zb9 26
Lf10_as0R1:
ze6
s_cbranch_scc1 Lf10_as0G1
Lf10_as0Rb1:
ze 0
zf 228,148,88
zi 84,8,9216
zi 86,8,9232
zf 232,152,88
zi 96,8,9280
zi 98,8,9296
za 16,156,88
za 20,160,88
za 24,164,88
za 28,168,88
zi 88,8,9344
zi 90,8,9360
zf 228,188,92
zf 232,192,92
za 16,172,92
za 20,176,92
za 24,180,92
za 28,184,92
zf 228,204,76
zf 232,208,76
za 16,212,76
za 20,216,76
za 24,196,76
za 28,200,76
Lf10_as0R2:
zcf
s_cbranch_scc1 Lf10_as0G2
Lf10_as0Rb2:
ze 0
zf 236,148,84
zbn
zbo
zbq 8,0
zf 240,152,84
zbp
zdk 76,8
zi 78,8,16
za 32,156,84
zi 80,8,64
zi 82,8,80
za 36,160,84
za 40,164,84
za 44,168,84
zu 12
zi 84,8,128
zi 86,8,144
zo 148,1
zf 236,188,96
zb 150,1,1536
zo 152,2
zb 154,2,1536
zf 240,192,96
zb 156,1,64
zb 158,1,1600
za 32,172,96
zb 160,2,64
zb 162,2,1600
za 36,176,96
zb 164,1,128
zb 166,1,1664
za 40,180,96
zb 168,2,128
zb 170,2,1664
za 44,184,96
zu 6
zb 172,1,6144
zb 174,1,7680
zf 236,204,88
zb 176,2,6144
zb 178,2,7680
zf 240,208,88
zb 180,1,6208
zb 182,1,7744
za 32,212,88
zb 184,2,6208
zb 186,2,7744
za 36,216,88
zb 188,1,6272
zb 190,1,7808
za 40,196,88
zb 192,2,6272
zb 194,2,7808
za 44,200,88
s_branch Lf10_amR0
Lf10_as1R0:
zc1
s_cbranch_scc1 Lf10_as1G0
Lf10_as1Rb0:
ze 15
zf 244,156,76
zb 212,1,49280
zb 214,1,50816
zb 216,2,49280
zf 248,160,76
ze 15
zb 218,2,50816
zb 196,1,49152
zb 198,1,50688
za 48,164,76
zb 200,2,49152
zb 202,2,50688
zb 204,1,49216
za 52,168,76
zb 206,1,50752
zb 208,2,49216
zb 210,2,50752
za 56,148,76
zi 88,8,4608
zi 90,8,4624
zi 92,8,4672
za 60,152,76
ze 15
zi 94,8,4688
zi 76,8,4736
zi 78,8,4752
zf 244,172,80
zbr 0x12000
zbb 1
zbb 2
zf 248,176,80
zb2 54
zb3 54
zbz 25,54
za 48,180,80
zbc 0x5800
zbw
zbd
zbe
za 52,184,80
ze 6
s_barrier
z6 0x3000
zag 0x3000
z0 42
za 56,188,80
zn 43,1024
zn 53,2048
za 60,192,80
zn 42,3072
z6 0x4000
zag 0x4000
z0 43
zf 244,212,84
zn 53,1024
zal 28,54
zf 248,216,84
zbc 0x9800
zby
zbd
zbe
za 48,196,84
zal 29,54
zb5
za 52,200,84
zb6 0x1f800
zal 30,54
zb7 54
zbv 26,4
za 56,204,84
zbk 26,54
zb8
za 60,208,84
zb9 26
Lf10_as1R1:
ze6
s_cbranch_scc1 Lf10_as1G1
Lf10_as1Rb1:
ze 0
zf 252,156,88
zi 84,8,9216
zi 86,8,9232
za 64,160,88
zi 96,8,9280
zi 98,8,9296
za 68,164,88
za 72,168,88
za 76,148,88
za 80,152,88
zi 88,8,9344
zi 90,8,9360
zf 252,172,92
za 64,176,92
za 68,180,92
za 72,184,92
za 76,188,92
za 80,192,92
zf 252,212,76
za 64,216,76
za 68,196,76
za 72,200,76
z7 76,204
za 80,208,76
Lf10_as1R2:
zcf
s_cbranch_scc1 Lf10_as1G2
Lf10_as1Rb2:
ze 0
z7 84,156
zbn
zbo
zbq 8,0
za 88,160,84
zbp
zdk 76,8
zi 78,8,16
za 92,164,84
zi 80,8,64
zi 82,8,80
za 96,168,84
za 100,148,84
za 104,152,84
zu 12
zi 84,8,128
zi 86,8,144
zo 148,1
za 84,172,96
zb 150,1,1536
zo 152,2
zb 154,2,1536
za 88,176,96
zb 156,1,64
zb 158,1,1600
za 92,180,96
zb 160,2,64
zb 162,2,1600
z7 96,184
zb 164,1,128
zb 166,1,1664
za 100,188,96
zb 168,2,128
zb 170,2,1664
za 104,192,96
zu 6
zb 172,1,6144
zb 174,1,7680
za 84,212,88
zb 176,2,6144
zb 178,2,7680
z7 88,216
zb 180,1,6208
zb 182,1,7744
za 92,196,88
zb 184,2,6208
zb 186,2,7744
za 96,200,88
zb 188,1,6272
zb 190,1,7808
za 100,204,88
zb 192,2,6272
zb 194,2,7808
za 104,208,88
s_branch Lf10_amR0
Lf10_as2R0:
zc1
s_cbranch_scc1 Lf10_as2G0
Lf10_as2Rb0:
ze 14
za 108,164,76
ze 12
zb 196,1,49152
zb 198,1,50688
zb 200,2,49152
za 112,168,76
zb 202,2,50688
zb 204,1,49216
zb 206,1,50752
za 116,148,76
zb 208,2,49216
zb 210,2,50752
zb 212,1,49280
za 120,152,76
zb 214,1,50816
zb 216,2,49280
zb 218,2,50816
za 124,156,76
zi 88,8,4608
zi 90,8,4624
zi 92,8,4672
za 128,160,76
ze 15
zi 94,8,4688
zi 96,8,4736
zi 98,8,4752
za 108,180,80
zbr 0x12000
zbb 1
zbb 2
za 112,184,80
zb2 54
zb3 54
zbz 25,54
za 116,188,80
zbc 0x5800
zbw
zbd
zbe
za 120,192,80
ze 6
s_barrier
z6 0x3000
zag 0x3000
z0 42
za 124,172,80
zn 43,1024
zn 53,2048
za 128,176,80
zn 42,3072
z6 0x4000
zag 0x4000
z0 43
za 108,196,84
zn 53,1024
zal 28,54
za 112,200,84
zbc 0x9800
zby
zbd
zbe
za 116,204,84
zal 29,54
zb5
za 120,208,84
zb6 0x1f800
zal 30,54
zb7 54
zbv 26,4
za 124,212,84
zbk 26,54
zb8
za 128,216,84
zb9 26
Lf10_as2R1:
zcf
s_cbranch_scc1 Lf10_as2G1
Lf10_as2Rb1:
ze 0
za 132,164,88
zbn
zbo
zbq 8,0
za 136,168,88
zbp
zdk 76,8
zi 78,8,16
za 140,148,88
zi 80,8,64
zi 82,8,80
za 144,152,88
zi 84,8,128
zi 86,8,144
za 148,156,88
za 152,160,88
zu 12
zo 148,1
zb 150,1,1536
za 132,180,92
zo 152,2
zb 154,2,1536
za 136,184,92
zb 156,1,64
zb 158,1,1600
za 140,188,92
zb 160,2,64
zb 162,2,1600
za 144,192,92
zb 164,1,128
zb 166,1,1664
za 148,172,92
zb 168,2,128
zb 170,2,1664
za 152,176,92
zu 6
zb 172,1,6144
zb 174,1,7680
za 132,196,96
zb 176,2,6144
zb 178,2,7680
za 136,200,96
zb 180,1,6208
zb 182,1,7744
za 140,204,96
zb 184,2,6208
zb 186,2,7744
za 144,208,96
zb 188,1,6272
zb 190,1,7808
za 148,212,96
zb 192,2,6272
zb 194,2,7808
za 152,216,96
s_branch Lf10_amR0
Lf10_as3R0:
zc1
s_cbranch_scc1 Lf10_as3G0
Lf10_as3Rb0:
ze 15
za 156,148,76
zb 204,1,49216
zb 206,1,50752
za 160,152,76
zb 208,2,49216
zb 210,2,50752
za 164,156,76
zb 212,1,49280
zb 214,1,50816
za 168,160,76
ze 15
zb 216,2,49280
zb 218,2,50816
za 172,164,76
zb 196,1,49152
zb 198,1,50688
za 176,168,76
ze 12
zb 200,2,49152
zb 202,2,50688
za 156,188,80
ze 12
zi 88,8,4608
zi 90,8,4624
za 160,192,80
zi 92,8,4672
zi 94,8,4688
za 164,172,80
zi 96,8,4736
zi 98,8,4752
za 168,176,80
ze 6
s_barrier
zbr 0x12000
zbb 1
zbb 2
za 172,180,80
zb2 54
zb3 54
za 176,184,80
zbz 25,54
zbc 0x5800
zbw
zbd
za 156,204,84
zbe
zal 28,54
zbc 0x9800
za 160,208,84
zby
zbd
zbe
za 164,212,84
zal 29,54
zb5
za 168,216,84
zb6 0x1f800
zal 30,54
zb7 54
zbv 26,4
za 172,196,84
zbk 26,54
zb8
za 176,200,84
zb9 26
Lf10_as3R1:
zcf
s_cbranch_scc1 Lf10_as3G1
Lf10_as3Rb1:
ze 0
za 180,148,88
zbn
zbo
zbq 8,0
za 184,152,88
zbp
zdk 76,8
zi 78,8,16
za 188,156,88
zi 80,8,64
zi 82,8,80
za 192,160,88
zi 84,8,128
zi 86,8,144
za 196,164,88
za 200,168,88
zu 6
zo 148,1
zb 150,1,1536
za 180,188,92
zo 152,2
zb 154,2,1536
za 184,192,92
zb 156,1,64
zb 158,1,1600
za 188,172,92
zb 160,2,64
zb 162,2,1600
za 192,176,92
zb 164,1,128
zb 166,1,1664
za 196,180,92
zb 168,2,128
zb 170,2,1664
za 200,184,92
zu 0
zb 172,1,6144
zb 174,1,7680
za 180,204,96
zb 176,2,6144
zb 178,2,7680
za 184,208,96
zb 180,1,6208
zb 182,1,7744
za 188,212,96
zb 184,2,6208
zb 186,2,7744
za 192,216,96
zb 188,1,6272
zb 190,1,7808
zdm 196,96
zb 192,2,6272
zb 194,2,7808
zdm 200,96
s_branch Lf10_amR0
.p2align 6
Lf10_amR0:
zda
s_cbranch_scc1 Lf10_amG0
Lf10_amRb0:
ze 15
zf 220,148,76
ze3
zu 0
zb 196,1,12288
zb 198,1,13824
zf 224,152,76
zed
zb 200,2,12288
zb 202,2,13824
za 0,156,76
zee 0x4800
zb 204,1,12352
zb 206,1,13888
za 4,160,76
zef
zb 208,2,12352
zb 210,2,13888
ze 15
za 8,164,76
zeg
zb 212,1,12416
zb 214,1,13952
za 12,168,76
zeh 0x1200
zb 216,2,12416
zb 218,2,13952
zf 220,172,80
zei
zi 88,8,4608
zi 90,8,4624
zf 224,176,80
zej 0xd0
zi 92,8,4672
zi 94,8,4688
ze 15
za 0,180,80
zek 0x12d0
zi 96,8,4736
zi 98,8,4752
za 4,184,80
zel
zx 36,69
zr 37,69
za 8,188,80
zem
zd 69,70
zd 70,71
za 12,192,80
zen
zeo
zd 71,72
ze 10
zf 220,196,84
zf 224,200,84
za 0,204,84
za 4,208,84
ze 4
za 8,212,84
za 12,216,84
Lf10_amR1:
zdb
s_cbranch_scc1 Lf10_amG1
Lf10_amRb1:
zf 228,148,88
ze 0
zi 76,8,9216
zi 78,8,9232
zf 228,172,92
zi 80,8,9280
zi 82,8,9296
zf 228,196,96
zi 84,8,9344
zi 86,8,9360
zf 232,152,88
zcg
zcu
z0 42
zf 232,176,92
zn 43,1024
zf 232,200,96
zd 72,73
zcl 38,48
za 16,156,88
zbs 39,33
z2 38
za 16,180,92
z2 39
zg 36,38
za 16,204,96
zg 37,39
zs 38
za 20,160,88
zs 39
zs 36
za 20,184,92
zs 37
zq 38,39
za 20,208,96
zq 36,37
zr 37,36
za 24,164,88
zav 36,38
zaw 36
za 24,188,92
z3 45,37
z3 44,36
za 24,212,96
z4 47,37,45
za 28,168,88
za 28,192,92
za 28,216,96
Lf10_amR2:
zdc
s_cbranch_scc1 Lf10_amG2
Lf10_amRb2:
ze 0
zf 236,148,76
zi 88,8,13824
zi 90,8,13840
zf 236,172,80
zi 92,8,13888
zi 94,8,13904
zf 236,196,84
zi 96,8,13952
zi 98,8,13968
zf 240,152,76
zn 53,2048
zf 240,176,80
zn 42,3072
zf 240,200,84
z6 0x1000
zag 0x1000
z0 43
za 32,156,76
z4 46,36,44
zax 47
za 32,180,80
z5 36,46
z5 37,47
za 32,204,84
zbg 40,44,49
zay 41,45,50
za 36,160,76
zw 38,36,37
zaz 36,47
za 36,184,80
za0 37,46
zw 39,46,47
za 36,208,84
za1 41,45
za2 41,51
za 40,164,76
za3 36,37
zas 37
za 40,188,80
za4 41,40
zq 38,39
za 40,212,84
za 44,168,76
za 44,192,80
za 44,216,84
Lf10_amR3:
zc5
s_cbranch_scc1 Lf10_amG3
Lf10_amRb3:
ze 0
zf 244,148,88
zi 76,8,18432
zi 78,8,18448
zf 244,172,92
zi 80,8,18496
zi 82,8,18512
zf 244,196,96
zi 84,8,18560
zi 86,8,18576
zf 248,152,88
zn 53,1024
zf 248,176,92
zn 42,2048
zf 248,200,96
zq 36,37
za5 37,52
za 48,156,88
zcm 40,44
zcn 39
za 48,180,92
za6 11,41
z8 17,38,7
za 48,204,96
z8 20,36,7
zco
za 52,160,88
zau 14,37,11
zcp
za 52,184,92
zcq
zx 36,58
zr 37,58
za 52,208,96
zd 58,59
zd 59,60
za 56,164,88
zd 60,61
zdx 38,48
za 56,188,92
zcj 39,33
z2 38
za 56,212,96
za 60,168,88
za 60,192,92
za 60,216,96
Lf10_amR4:
zc0
s_cbranch_scc1 Lf10_amG4
Lf10_amRb4:
ze 0
zf 252,148,76
zi 88,8,23040
zi 90,8,23056
zf 252,172,80
zi 92,8,23104
zi 94,8,23120
zf 252,196,84
zi 96,8,23168
zi 98,8,23184
za 64,152,76
zn 43,3072
za 64,176,80
z6 0x2000
zag 0x2000
z0 53
za 64,200,84
zn 42,1024
za 68,156,76
z2 39
zg 36,38
za 68,180,80
zg 37,39
zs 38
za 68,204,84
zs 39
zs 36
za 72,160,76
zs 37
zq 38,39
za 72,184,80
zq 36,37
zr 37,36
za 72,208,84
zav 36,38
zaw 36
z7 76,164
z3 45,37
z3 44,36
za 76,188,80
z4 47,37,45
z4 46,36,44
za 76,212,84
za 80,168,76
z7 80,192
za 80,216,84
Lf10_amR5:
zd4
s_cbranch_scc1 Lf10_amG5
Lf10_amRb5:
ze 0
za 84,148,88
zi 76,8,27648
zi 78,8,27664
za 84,172,92
zi 80,8,27712
zi 82,8,27728
za 84,196,96
zi 84,8,27776
zi 86,8,27792
z7 88,152
zn 43,2048
za 88,176,92
zn 53,3072
za 88,200,96
zax 47
z5 36,46
za 92,156,88
z5 37,47
zbg 40,44,49
z7 92,180
zay 41,45,50
zw 38,36,37
za 92,204,96
zaz 36,47
za0 37,46
za 96,160,88
zw 39,46,47
za1 41,45
za 96,184,92
za2 41,51
za3 36,37
z7 96,208
zas 37
za4 41,40
za 100,164,88
zq 38,39
zq 36,37
za 100,188,92
za5 37,52
zdf 40,44
za 100,212,96
zdg 39
za 104,168,88
za 104,192,92
za 104,216,96
Lf10_amR6:
zd5
s_cbranch_scc1 Lf10_amG6
Lf10_amRb6:
ze 0
za 108,148,76
zi 88,8,32256
zi 90,8,32272
za 108,172,80
zi 92,8,32320
zi 94,8,32336
za 108,196,84
zi 96,8,32384
zi 98,8,32400
za 112,152,76
z6 0x3000
zag 0x3000
z0 42
za 112,176,80
zn 43,1024
za 112,200,84
zn 53,2048
za 116,156,76
za6 9,41
z8 15,38,7
za 116,180,80
z8 18,36,7
zdh
za 116,204,84
zau 12,37,9
zdi
za 120,160,76
zdj
zx 36,64
zr 37,64
za 120,184,80
zd 64,65
zd 65,66
za 120,208,84
zd 66,67
zfl 38,48
za 124,164,76
zcj 39,33
z2 38
za 124,188,80
za 124,212,84
za 128,168,76
za 128,192,80
za 128,216,84
Lf10_amR7:
zdy
s_cbranch_scc1 Lf10_amG7
Lf10_amRb7:
ze 0
za 132,148,88
zi 76,8,36864
zi 78,8,36880
za 132,172,92
zi 80,8,36928
zi 82,8,36944
za 132,196,96
zi 84,8,36992
zi 86,8,37008
za 136,152,88
zn 42,3072
za 136,176,92
z6 0x4000
zag 0x4000
z0 43
za 136,200,96
zn 53,1024
za 140,156,88
z2 39
zg 36,38
za 140,180,92
zg 37,39
zs 38
za 140,204,96
zs 39
zs 36
za 144,160,88
zs 37
zq 38,39
za 144,184,92
zq 36,37
zr 37,36
za 144,208,96
zav 36,38
zaw 36
za 148,164,88
z3 45,37
z3 44,36
za 148,188,92
z4 47,37,45
z4 46,36,44
za 148,212,96
za 152,168,88
za 152,192,92
za 152,216,96
Lf10_amR8:
zc1
s_cbranch_scc1 Lf10_amG8
Lf10_amRb8:
ze 0
za 156,148,76
zi 88,8,41472
zi 90,8,41488
za 156,172,80
zi 92,8,41536
zi 94,8,41552
za 156,196,84
zi 96,8,41600
zi 98,8,41616
za 160,152,76
zax 47
z5 36,46
za 160,176,80
z5 37,47
zbg 40,44,49
za 160,200,84
zay 41,45,50
zw 38,36,37
za 164,156,76
zaz 36,47
za0 37,46
za 164,180,80
zw 39,46,47
za1 41,45
za 164,204,84
za2 41,51
za3 36,37
za 168,160,76
zas 37
za4 41,40
za 168,184,80
zq 38,39
zq 36,37
za 168,208,84
za5 37,52
zca 40,44
za 172,164,76
zcb 39
za6 10,41
za 172,188,80
z8 16,38,7
z8 19,36,7
za 172,212,84
zcc
zau 13,37,10
zcd
za 176,168,76
zce
za 176,192,80
za 176,216,84
Lf10_amR9:
zcf
s_cbranch_scc1 Lf10_amG9
Lf10_amRb9:
ze 0
za 180,148,88
zbn
zbo
zbq 8,0
za 184,152,88
zbp
zdk 76,8
zi 78,8,16
za 188,156,88
zf5
zi 80,8,64
zi 82,8,80
za 192,160,88
zi 84,8,128
zi 86,8,144
za 196,164,88
za 200,168,88
zu 12
zo 148,1
zb 150,1,1536
za 180,172,92
zo 152,2
zb 154,2,1536
za 184,176,92
zb 156,1,64
zb 158,1,1600
za 188,180,92
zb 160,2,64
zb 162,2,1600
za 192,184,92
zb 164,1,128
zb 166,1,1664
za 196,188,92
zb 168,2,128
zb 170,2,1664
za 200,192,92
zu 6
zb 172,1,6144
zb 174,1,7680
za 180,196,96
zb 176,2,6144
zb 178,2,7680
za 184,200,96
zb 180,1,6208
zb 182,1,7744
za 188,204,96
zb 184,2,6208
zb 186,2,7744
za 192,208,96
zb 188,1,6272
zb 190,1,7808
za 196,212,96
zb 192,2,6272
zb 194,2,7808
za 200,216,96
zgx
s_cbranch_scc1 Lf10_amR0
zde
s_cbranch_scc1 Lf10_ayR0
Lf10_azR0:
zda
s_cbranch_scc1 Lf10_azG0
Lf10_azRb0:
zi 88,8,4608
zi 90,8,4624
zi 92,8,4672
zi 94,8,4688
ze 15
za 0,156,76
zu 0
zi 96,8,4736
zi 98,8,4752
zb 204,1,12352
zb 206,1,13888
za 4,160,76
zb 208,2,12352
zb 210,2,13888
zb 212,1,12416
zb 214,1,13952
za 8,164,76
zb 216,2,12416
zb 218,2,13952
zb 196,1,12288
zb 198,1,13824
za 12,168,76
zb 200,2,12288
zb 202,2,13824
zx 36,69
zr 37,69
zf 220,148,76
zcl 38,48
zbs 39,33
z2 38
z2 39
zf 224,152,76
ze 15
zg 36,38
zg 37,39
zs 38
zs 39
za 0,180,80
zs 36
zs 37
zq 38,39
zq 36,37
za 4,184,80
zr 37,36
zav 36,38
zaw 36
z3 45,37
za 8,188,80
z3 44,36
z4 47,37,45
z4 46,36,44
zax 47
za 12,192,80
z5 36,46
z5 37,47
zbg 40,44,49
zay 41,45,50
zf 220,172,80
zw 38,36,37
zaz 36,47
za0 37,46
zw 39,46,47
zf 224,176,80
ze 0
za1 41,45
za2 41,51
za3 36,37
zas 37
za 0,204,84
za4 41,40
zq 38,39
zq 36,37
za5 37,52
za 4,208,84
zcm 40,44
zcn 39
za6 11,41
z8 17,38,7
za 8,212,84
zk 0,25,2048
za 12,216,84
zv
zk 4,25,3072
zf 220,196,84
z8 20,36,7
zco
zau 14,37,11
zcp
zf 224,200,84
zcq
Lf10_azR1:
zdb
s_cbranch_scc1 Lf10_azG1
Lf10_azRb1:
zi 76,8,9216
zi 78,8,9232
zi 80,8,9280
zi 82,8,9296
za 16,156,88
zfo 0xffff0000
zi 84,8,9344
zi 86,8,9360
za 16,180,92
zf6 0xffff0000
zk 8,25,4096
za 16,204,96
zk 12,25,5120
za 20,160,88
za 20,184,92
za 20,208,96
zbl
zk 16,25,8192
za 24,164,88
ze 1
s_barrier
za7 32,28
za 24,188,92
za7 36,29
zk 20,25,9216
za 24,212,96
za7 40,30
zl 44,28,1024
za 28,168,88
zl 48,29,1024
zl 52,30,1024
za 28,192,92
za 28,216,96
zv
zk 24,25,10240
zf 228,148,88
zf 228,172,92
zf 228,196,96
zb0
zk 28,25,11264
zf 232,152,88
zf 232,176,92
zf 232,200,96
Lf10_azR2:
zdc
s_cbranch_scc1 Lf10_azG2
Lf10_azRb2:
zi 88,8,13824
zi 90,8,13840
zi 92,8,13888
zi 94,8,13904
za 32,156,76
ze 9
zi 96,8,13952
zi 98,8,13968
zm 36,32
zg 40,220
za 32,180,80
zm 37,33
zg 41,221
zm 38,34
zg 42,222
za 32,204,84
zm 39,35
zg 43,223
zg 36,40
zg 37,41
za 36,160,76
zg 38,42
zg 39,43
zc 40,36,37
zc 41,38,39
za 36,184,80
zk 32,25,14336
za 36,208,84
ze 7
zm 48,44
zg 52,224
zm 49,45
zg 53,225
za 40,164,76
s_barrier
zl 32,28,6144
zl 36,29,6144
zm 50,46
za 40,188,80
zk 36,25,15360
za 40,212,84
zg 54,226
zm 51,47
zg 55,227
zg 48,52
za 44,168,76
zl 44,28,7168
zg 49,53
zg 50,54
zg 51,55
za 44,192,80
zk 40,25,16384
za 44,216,84
zc 52,48,49
zc 53,50,51
zah 42,52,40
zf 236,148,76
zl 48,29,7168
zah 43,53,41
zai 40,52
zf 236,172,80
zk 44,25,17408
zf 236,196,84
zai 41,53
zf 240,152,76
zfn
zbf 40,26
zl 52,30,7168
zf 240,176,80
zl 40,30,6144
zf 240,200,84
Lf10_azR3:
zc5
s_cbranch_scc1 Lf10_azG3
Lf10_azRb3:
zi 76,8,18432
zi 78,8,18448
zi 80,8,18496
zi 82,8,18512
ze 10
za 48,156,88
zi 84,8,18560
zi 86,8,18576
zm 36,32
ze 6
zg 40,228
za 48,180,92
zm 37,33
zg 41,229
zm 38,34
zg 42,230
za 48,204,96
zm 39,35
zg 43,231
zg 36,40
zg 37,41
za 52,160,88
zg 38,42
zg 39,43
zc 40,36,37
zc 41,38,39
za 52,184,92
zk 48,25,2048
za 52,208,96
zm 48,44
zg 52,232
zm 49,45
zg 53,233
za 56,164,88
s_barrier
zl 32,28,12288
zl 36,29,12288
zm 50,46
za 56,188,92
zk 52,25,3072
za 56,212,96
zg 54,234
zm 51,47
zg 55,235
zg 48,52
za 60,168,88
zl 44,28,13312
zg 49,53
zg 50,54
zg 51,55
za 60,192,92
zk 56,25,4096
za 60,216,96
zc 52,48,49
zc 53,50,51
zah 42,52,40
zf 244,148,88
zl 48,29,13312
zah 43,53,41
zai 40,52
zf 244,172,92
zk 60,25,5120
zf 244,196,96
zai 41,53
zf 248,152,88
zbh 0xa800
zbf 40,26
zl 52,30,13312
zf 248,176,92
zl 40,30,12288
zf 248,200,96
Lf10_azR4:
zc0
s_cbranch_scc1 Lf10_azG4
Lf10_azRb4:
zi 88,8,23040
zi 90,8,23056
zi 92,8,23104
zi 94,8,23120
ze 10
za 68,156,76
zi 96,8,23168
zi 98,8,23184
zm 36,32
ze 6
zg 40,236
za 68,180,80
zm 37,33
zg 41,237
zm 38,34
zg 42,238
za 68,204,84
zm 39,35
zg 43,239
zg 36,40
zg 37,41
za 72,160,76
zg 38,42
zg 39,43
zc 40,36,37
zc 41,38,39
za 72,184,80
zk 68,25,8192
za 72,208,84
zm 48,44
zg 52,240
zm 49,45
zg 53,241
z7 76,164
s_barrier
za7 32,28
za7 36,29
zm 50,46
za 76,188,80
zk 72,25,9216
za 76,212,84
zg 54,242
zm 51,47
zg 55,243
zg 48,52
za 80,168,76
zl 44,28,1024
zg 49,53
zg 50,54
zg 51,55
z7 80,192
zk 76,25,10240
za 80,216,84
zc 52,48,49
zc 53,50,51
zah 42,52,40
zf 252,148,76
zl 48,29,1024
zah 43,53,41
zai 40,52
zf 252,172,80
zk 80,25,11264
zf 252,196,84
zai 41,53
za 64,152,76
zbh 0x15000
zbf 40,26
zl 52,30,1024
za 64,176,80
za7 40,30
za 64,200,84
Lf10_azR5:
zd4
s_cbranch_scc1 Lf10_azG5
Lf10_azRb5:
zi 76,8,27648
zi 78,8,27664
zi 80,8,27712
zi 82,8,27728
ze 10
za 92,156,88
zi 84,8,27776
zi 86,8,27792
zm 36,32
ze 6
zg 40,244
z7 92,180
zm 37,33
zg 41,245
zm 38,34
zg 42,246
za 92,204,96
zm 39,35
zg 43,247
zg 36,40
zg 37,41
za 96,160,88
zg 38,42
zg 39,43
zc 40,36,37
zc 41,38,39
za 96,184,92
zk 92,25,14336
z7 96,208
zm 48,44
zg 52,248
zm 49,45
zg 53,249
za 100,164,88
s_barrier
zl 32,28,6144
zl 36,29,6144
zm 50,46
za 100,188,92
zk 96,25,15360
za 100,212,96
zg 54,250
zm 51,47
zg 55,251
zg 48,52
za 104,168,88
zl 44,28,7168
zg 49,53
zg 50,54
zg 51,55
za 104,192,92
zk 100,25,16384
za 104,216,96
zc 52,48,49
zc 53,50,51
zah 42,52,40
za 84,148,88
zl 48,29,7168
zah 43,53,41
zai 40,52
za 84,172,92
zk 104,25,17408
za 84,196,96
zai 41,53
z7 88,152
zbh 0x1f800
zbf 40,26
zl 52,30,7168
za 88,176,92
zl 40,30,6144
za 88,200,96
Lf10_azR6:
zd5
s_cbranch_scc1 Lf10_azG6
Lf10_azRb6:
zi 88,8,32256
zi 90,8,32272
zi 92,8,32320
zi 94,8,32336
ze 10
za 116,156,76
zi 96,8,32384
zi 98,8,32400
zm 36,32
ze 6
zg 40,252
za 116,180,80
zm 37,33
zg 41,253
zm 38,34
zg 42,254
za 116,204,84
zm 39,35
zg 43,255
zg 36,40
zg 37,41
za 120,160,76
zg 38,42
zg 39,43
zc 40,36,37
zc 41,38,39
za 120,184,80
zk 116,25,2048
za 120,208,84
zm 48,44
z9 44,64
zg 52,44
zm 49,45
za 124,164,76
s_barrier
zl 32,28,12288
zl 36,29,12288
z9 45,65
za 124,188,80
zk 120,25,3072
za 124,212,84
zg 53,45
zm 50,46
z9 46,66
zg 54,46
za 128,168,76
zm 51,47
z9 47,67
zg 55,47
zg 48,52
za 128,192,80
zk 124,25,4096
za 128,216,84
zl 44,28,13312
zg 49,53
zg 50,54
zg 51,55
za 108,148,76
zc 52,48,49
zc 53,50,51
zah 42,52,40
zah 43,53,41
za 108,172,80
zk 128,25,5120
za 108,196,84
zl 48,29,13312
zai 40,52
zai 41,53
za 112,152,76
zbh 0x2a000
zbf 40,26
zl 52,30,13312
za 112,176,80
zl 40,30,12288
za 112,200,84
Lf10_azR7:
zdy
s_cbranch_scc1 Lf10_azG7
Lf10_azRb7:
zi 76,8,36864
zi 78,8,36880
zi 80,8,36928
zi 82,8,36944
ze 10
za 140,156,88
zi 84,8,36992
zi 86,8,37008
zm 36,32
z9 32,84
ze 6
zg 40,32
za 140,180,92
zm 37,33
z9 33,85
zg 41,33
zm 38,34
za 140,204,96
z9 34,86
zg 42,34
zm 39,35
z9 35,87
za 144,160,88
zg 43,35
zg 36,40
zg 37,41
zg 38,42
za 144,184,92
zk 140,25,8192
za 144,208,96
zg 39,43
zc 40,36,37
zc 41,38,39
zm 48,44
za 148,164,88
s_barrier
za7 32,28
za7 36,29
z9 44,88
za 148,188,92
zk 144,25,9216
za 148,212,96
zg 52,44
zm 49,45
z9 45,89
zg 53,45
za 152,168,88
zm 50,46
z9 46,90
zg 54,46
zm 51,47
za 152,192,92
zk 148,25,10240
za 152,216,96
z9 47,91
zg 55,47
zg 48,52
zg 49,53
za 132,148,88
zl 44,28,1024
zg 50,54
zg 51,55
zc 52,48,49
za 132,172,92
zk 152,25,11264
za 132,196,96
zc 53,50,51
zah 42,52,40
zah 43,53,41
zai 40,52
za 136,152,88
zl 48,29,1024
zai 41,53
za 136,176,92
zbh 0x34800
zbf 40,26
zl 52,30,1024
za7 40,30
za 136,200,96
Lf10_azR8:
zc1
s_cbranch_scc1 Lf10_azG8
Lf10_azRb8:
zi 88,8,41472
zi 90,8,41488
zi 92,8,41536
zi 94,8,41552
ze 10
za 164,156,76
zi 96,8,41600
zi 98,8,41616
zm 36,32
z9 32,108
ze 6
zg 40,32
za 164,180,80
zm 37,33
z9 33,109
zg 41,33
zm 38,34
za 164,204,84
z9 34,110
zg 42,34
zm 39,35
z9 35,111
za 168,160,76
zg 43,35
zg 36,40
zg 37,41
zg 38,42
za 168,184,80
zk 164,25,14336
za 168,208,84
zg 39,43
zc 40,36,37
zc 41,38,39
zm 48,44
za 172,164,76
s_barrier
zl 32,28,6144
zl 36,29,6144
z9 44,112
za 172,188,80
zk 168,25,15360
za 172,212,84
zg 52,44
zm 49,45
z9 45,113
zg 53,45
za 176,168,76
zm 50,46
z9 46,114
zg 54,46
zm 51,47
za 176,192,80
zk 172,25,16384
za 176,216,84
z9 47,115
zg 55,47
zg 48,52
zg 49,53
za 156,148,76
zl 44,28,7168
zg 50,54
zg 51,55
zc 52,48,49
za 156,172,80
zk 176,25,17408
za 156,196,84
zc 53,50,51
zah 42,52,40
zah 43,53,41
zai 40,52
za 160,152,76
zl 48,29,7168
zai 41,53
za 160,176,80
zbh 0x3f000
zbf 40,26
zl 52,30,7168
zl 40,30,6144
za 160,200,84
Lf10_azR9:
Lf10_azH9:
ze 6
zm 36,32
z9 32,132
ze 0
zg 40,32
zm 37,33
za 188,156,88
z9 33,133
zg 41,33
zm 38,34
z9 34,134
za 188,180,92
zg 42,34
zm 39,35
z9 35,135
zg 43,35
za 188,204,96
zg 36,40
zg 37,41
zg 38,42
zg 39,43
za 192,160,88
zc 40,36,37
zc 41,38,39
zm 48,44
z9 44,136
za 192,184,92
zk 188,25,2048
za 192,208,96
zg 52,44
zm 49,45
z9 45,137
zg 53,45
za 196,164,88
s_barrier
zl 32,28,12288
zl 36,29,12288
zm 50,46
za 196,188,92
zk 192,25,3072
za 196,212,96
z9 46,138
zg 54,46
zm 51,47
z9 47,139
za 200,168,88
zg 55,47
zg 48,52
zg 49,53
zg 50,54
za 200,192,92
zk 196,25,4096
za 200,216,96
zl 44,28,13312
zg 51,55
zc 52,48,49
zc 53,50,51
za 180,148,88
zl 48,29,13312
zah 42,52,40
zah 43,53,41
za 180,172,92
zk 200,25,5120
za 180,196,96
zai 40,52
zai 41,53
za 184,152,88
zbh 0x49800
zbf 40,26
zl 52,30,13312
za 184,176,92
zl 40,30,12288
za 184,200,96
ze 2
s_barrier
zm 36,32
z9 32,156
ze 0
zg 40,32
zm 37,33
z9 33,157
zg 41,33
zm 38,34
z9 34,158
zg 42,34
zm 39,35
z9 35,159
zg 43,35
zg 36,40
zg 37,41
zg 38,42
zg 39,43
zc 40,36,37
zc 41,38,39
zm 48,44
z9 44,160
zg 52,44
zm 49,45
z9 45,161
zg 53,45
zm 50,46
z9 46,162
zg 54,46
zm 51,47
z9 47,163
zg 55,47
zg 48,52
zg 49,53
zg 50,54
zg 51,55
zc 52,48,49
zc 53,50,51
zah 42,52,40
zah 43,53,41
zai 40,52
zai 41,53
za7 32,28
za7 36,29
zl 44,28,1024
zl 48,29,1024
zl 52,30,1024
zbh 0x54000
zbf 40,26
zv
za7 40,30
ze 4
zm 36,32
z9 32,180
zm 37,33
z9 33,181
zm 38,34
z9 34,182
zm 39,35
z9 35,183
ze 0
zg 40,32
zg 41,33
zg 42,34
zg 43,35
zg 36,40
zg 37,41
zg 38,42
zg 39,43
zc 40,36,37
zc 41,38,39
zm 48,44
z9 44,184
zg 52,44
zm 49,45
z9 45,185
zg 53,45
zm 50,46
z9 46,186
zg 54,46
zm 51,47
z9 47,187
zg 55,47
zg 48,52
zg 49,53
zg 50,54
zg 51,55
zc 52,48,49
zc 53,50,51
zah 42,52,40
zah 43,53,41
zai 40,52
zai 41,53
zbh 0x5e800
zbf 40,26
s_endpgm
Lf10_ayR0:
zda
s_cbranch_scc1 Lf10_ayG0
Lf10_ayRb0:
zi 88,8,4608
zi 90,8,4624
zi 92,8,4672
zi 94,8,4688
ze 15
za 0,156,76
zu 0
zi 96,8,4736
zi 98,8,4752
zb 204,1,12352
zb 206,1,13888
za 4,160,76
zb 208,2,12352
zb 210,2,13888
zb 212,1,12416
zb 214,1,13952
za 8,164,76
zb 216,2,12416
zb 218,2,13952
zb 196,1,12288
zb 198,1,13824
za 12,168,76
zb 200,2,12288
zb 202,2,13824
zx 36,69
zr 37,69
zf 220,148,76
zcl 38,48
zbs 39,33
z2 38
z2 39
zf 224,152,76
ze 15
zg 36,38
zg 37,39
zs 38
zs 39
za 0,180,80
zs 36
zs 37
zq 38,39
zq 36,37
za 4,184,80
zr 37,36
zav 36,38
zaw 36
z3 45,37
za 8,188,80
z3 44,36
z4 47,37,45
z4 46,36,44
zax 47
za 12,192,80
z5 36,46
z5 37,47
zbg 40,44,49
zay 41,45,50
zf 220,172,80
zw 38,36,37
zaz 36,47
za0 37,46
zw 39,46,47
zf 224,176,80
ze 0
za1 41,45
za2 41,51
za3 36,37
zas 37
za 0,204,84
za4 41,40
zq 38,39
zq 36,37
za5 37,52
za 4,208,84
zcm 40,44
zcn 39
za6 11,41
z8 17,38,7
za 8,212,84
zk 0,25,2048
za 12,216,84
zv
zk 4,25,3072
zf 220,196,84
z8 20,36,7
zco
zau 14,37,11
zcp
zf 224,200,84
zcq
Lf10_ayR1:
zdb
s_cbranch_scc1 Lf10_ayG1
Lf10_ayRb1:
zi 76,8,9216
zi 78,8,9232
zi 80,8,9280
zi 82,8,9296
za 16,156,88
zi 84,8,9344
zi 86,8,9360
za 16,180,92
zk 8,25,4096
za 16,204,96
zk 12,25,5120
za 20,160,88
zdl 220,25
za 20,184,92
zat 224,25,1024
za 20,208,96
zam
zk 16,25,8192
za 24,164,88
za 24,188,92
za 24,212,96
ze 1
s_barrier
zk 20,25,9216
za 28,168,88
za 28,192,92
za 28,216,96
zam
zk 24,25,10240
zf 228,148,88
zf 228,172,92
zf 228,196,96
zam
zk 28,25,11264
zf 232,152,88
zf 232,176,92
zf 232,200,96
zam
zat 228,25,6144
Lf10_ayR2:
zdc
s_cbranch_scc1 Lf10_ayG2
Lf10_ayRb2:
zi 88,8,13824
zi 90,8,13840
zi 92,8,13888
zi 94,8,13904
za 32,156,76
zi 96,8,13952
zi 98,8,13968
za 32,180,80
zat 232,25,7168
za 32,204,84
za 36,160,76
za 36,184,80
za 36,208,84
za 40,164,76
ze 0
s_barrier
zam
zk 32,25,14336
za 40,188,80
zv
zk 36,25,15360
za 40,212,84
za 44,168,76
za 44,192,80
za 44,216,84
zf 236,148,76
zbl
zk 40,25,16384
zf 236,172,80
zv
zk 44,25,17408
zf 236,196,84
zf 240,152,76
zf 240,176,80
zf 240,200,84
zcr
zat 236,25,12288
Lf10_ayR3:
zc5
s_cbranch_scc1 Lf10_ayG3
Lf10_ayRb3:
zi 76,8,18432
zi 78,8,18448
zi 80,8,18496
zi 82,8,18512
za 48,156,88
zi 84,8,18560
zi 86,8,18576
za 48,180,92
zat 240,25,13312
za 48,204,96
za 52,160,88
za 52,184,92
za 52,208,96
za 56,164,88
ze 0
s_barrier
zam
zk 48,25,2048
za 56,188,92
zv
zk 52,25,3072
za 56,212,96
za 60,168,88
za 60,192,92
za 60,216,96
zf 244,148,88
zbl
zk 56,25,4096
zf 244,172,92
zv
zk 60,25,5120
zf 244,196,96
zf 248,152,88
zf 248,176,92
zf 248,200,96
zcr
zdl 244,25
Lf10_ayR4:
zc0
s_cbranch_scc1 Lf10_ayG4
Lf10_ayRb4:
zi 88,8,23040
zi 90,8,23056
zi 92,8,23104
zi 94,8,23120
za 68,156,76
zi 96,8,23168
zi 98,8,23184
za 68,180,80
zat 248,25,1024
za 68,204,84
za 72,160,76
za 72,184,80
za 72,208,84
z7 76,164
ze 0
s_barrier
zam
zk 68,25,8192
za 76,188,80
zv
zk 72,25,9216
za 76,212,84
za 80,168,76
z7 80,192
za 80,216,84
zf 252,148,76
zbl
zk 76,25,10240
zf 252,172,80
zv
zk 80,25,11264
zf 252,196,84
za 64,152,76
za 64,176,80
za 64,200,84
zcr
zat 252,25,6144
Lf10_ayR5:
zd4
s_cbranch_scc1 Lf10_ayG5
Lf10_ayRb5:
zi 76,8,27648
zi 78,8,27664
zi 80,8,27712
zi 82,8,27728
za 92,156,88
zi 84,8,27776
zi 86,8,27792
z7 92,180
zk 64,25,7168
za 92,204,96
za 96,160,88
za 96,184,92
z7 96,208
za 100,164,88
ze 0
s_barrier
zam
zk 92,25,14336
za 100,188,92
zv
zk 96,25,15360
za 100,212,96
za 104,168,88
za 104,192,92
za 104,216,96
za 84,148,88
zbl
zk 100,25,16384
za 84,172,92
zv
zk 104,25,17408
za 84,196,96
z7 88,152
za 88,176,92
za 88,200,96
zcr
zk 84,25,12288
Lf10_ayR6:
zd5
s_cbranch_scc1 Lf10_ayG6
Lf10_ayRb6:
zi 88,8,32256
zi 90,8,32272
zi 92,8,32320
zi 94,8,32336
za 116,156,76
zi 96,8,32384
zi 98,8,32400
za 116,180,80
zk 88,25,13312
za 116,204,84
za 120,160,76
za 120,184,80
za 120,208,84
za 124,164,76
ze 0
s_barrier
zam
zk 116,25,2048
za 124,188,80
zv
zk 120,25,3072
za 124,212,84
za 128,168,76
za 128,192,80
za 128,216,84
za 108,148,76
zbl
zk 124,25,4096
za 108,172,80
zv
zk 128,25,5120
za 108,196,84
za 112,152,76
za 112,176,80
za 112,200,84
zcr
zfr 108,25
Lf10_ayR7:
zdy
s_cbranch_scc1 Lf10_ayG7
Lf10_ayRb7:
zi 76,8,36864
zi 78,8,36880
zi 80,8,36928
zi 82,8,36944
za 140,156,88
zi 84,8,36992
zi 86,8,37008
za 140,180,92
zk 112,25,1024
za 140,204,96
za 144,160,88
za 144,184,92
za 144,208,96
za 148,164,88
ze 0
s_barrier
zam
zk 140,25,8192
za 148,188,92
zv
zk 144,25,9216
za 148,212,96
za 152,168,88
za 152,192,92
za 152,216,96
za 132,148,88
zbl
zk 148,25,10240
za 132,172,92
zv
zk 152,25,11264
za 132,196,96
za 136,152,88
za 136,176,92
za 136,200,96
zcr
zk 132,25,6144
Lf10_ayR8:
zc1
s_cbranch_scc1 Lf10_ayG8
Lf10_ayRb8:
zi 88,8,41472
zi 90,8,41488
zi 92,8,41536
zi 94,8,41552
za 164,156,76
zi 96,8,41600
zi 98,8,41616
za 164,180,80
zk 136,25,7168
za 164,204,84
za 168,160,76
za 168,184,80
za 168,208,84
za 172,164,76
ze 0
s_barrier
zam
zk 164,25,14336
za 172,188,80
zv
zk 168,25,15360
za 172,212,84
za 176,168,76
za 176,192,80
za 176,216,84
za 156,148,76
zbl
zk 172,25,16384
za 156,172,80
zv
zk 176,25,17408
za 156,196,84
za 160,152,76
za 160,176,80
za 160,200,84
zcr
zk 156,25,12288
Lf10_ayR9:
Lf10_ayH9:
za 188,156,88
za 188,180,92
za 188,204,96
zcr
zk 160,25,13312
za 192,160,88
za 192,184,92
za 192,208,96
zk 188,25,2048
za 196,164,88
ze 1
s_barrier
za 196,188,92
za 196,212,96
zam
zk 192,25,3072
za 200,168,88
za 200,192,92
za 200,216,96
zam
zk 196,25,4096
za 180,148,88
za 180,172,92
za 180,196,96
zam
zk 200,25,5120
za 184,152,88
za 184,176,92
za 184,200,96
zam
zfr 180,25
zcr
zk 184,25,1024
ze 0
s_barrier
s_endpgm
Lf10_amH0:
Lf10_amG0:
zd6
s_cbranch_scc1 Lf10_amS0
zda
s_cbranch_scc0 Lf10_amRb0
ze 15
zf 220,148,76
ze3
zac 21,9,6
zac 22,12,6
zad 140,15,3
zf 224,152,76
zed
zo 100,21
zo 102,22
za 0,156,76
zee 0x4800
zb 104,21,16
zb 106,22,16
za 4,160,76
zef
zb 108,21,64
zb 110,22,64
ze 13
za 8,164,76
zeg
zb 112,21,80
zb 114,22,80
za 12,168,76
zeh 0x1200
zb 116,21,128
zb 118,22,128
zf 220,172,80
zei
zb 120,21,144
zb 122,22,144
zf 224,176,80
zej 0xd0
zad 141,15,5
zad 142,18,3
ze 12
za 0,180,80
zek 0x12d0
zu 0
zb 196,1,12288
zad 143,18,5
za 4,184,80
ze 11
zb 198,1,13824
zb 200,2,12288
zh 124,100,140
ze 11
zb 202,2,13824
zb 204,1,12352
zh 128,104,140
ze 11
zb 206,1,13888
zb 208,2,12352
zh 132,108,140
ze 11
zb 210,2,13888
zc 88,124,125
zh 136,112,140
zel
zc 89,126,127
zc 90,128,129
za 8,188,80
zem
zc 91,130,131
zc 92,132,133
ze 8
zh 124,116,140
zc 93,134,135
zc 94,136,137
zh 128,120,140
zen
zb 212,1,12416
zc 95,138,139
za 12,192,80
ze 7
zb 214,1,13952
zc 96,124,125
zf 220,196,84
ze 6
zc 97,126,127
zc 98,128,129
zf 224,200,84
ze 4
zb 216,2,12416
zc 99,130,131
za 0,204,84
ze 3
zb 218,2,13952
zx 36,69
za 4,208,84
zr 37,69
zd 69,70
zd 70,71
zd 71,72
zeo
ze 2
za 8,212,84
ze 0
za 12,216,84
Lf10_amH1:
Lf10_amG1:
zd7
s_cbranch_scc1 Lf10_amS1
zdb
s_cbranch_scc0 Lf10_amRb1
zf 228,148,88
ze 0
zaj 21,9,6
zaj 22,12,6
zak 140,15,3
zf 228,172,92
zo 100,21
zo 102,22
zb 104,21,16
zf 228,196,96
zb 106,22,16
zb 108,21,64
zb 110,22,64
zf 232,152,88
zb 112,21,80
zb 114,22,80
zb 116,21,128
zf 232,176,92
zb 118,22,128
zb 120,21,144
zb 122,22,144
zf 232,200,96
zak 141,15,5
zak 142,18,3
zak 143,18,5
za 16,156,88
zcg
zcu
z0 42
za 16,180,92
ze 10
zn 43,1024
zd 72,73
zh 124,100,140
ze 8
zcl 38,48
zbs 39,33
zh 128,104,140
ze 6
z2 38
z2 39
zh 132,108,140
ze 4
zg 36,38
zc 76,124,125
zh 136,112,140
zc 77,126,127
zc 78,128,129
za 16,204,96
ze 0
zc 79,130,131
zc 80,132,133
zh 124,116,140
zc 81,134,135
zc 82,136,137
zh 128,120,140
zc 83,138,139
zg 37,39
za 20,160,88
zs 38
zv
zc 84,124,125
za 20,184,92
zc 85,126,127
zc 86,128,129
za 20,208,96
zc 87,130,131
zs 39
za 24,164,88
zs 36
zs 37
za 24,188,92
zq 38,39
zq 36,37
za 24,212,96
zr 37,36
zav 36,38
za 28,168,88
zaw 36
z3 45,37
za 28,192,92
z3 44,36
z4 47,37,45
za 28,216,96
Lf10_amH2:
Lf10_amG2:
zd8
s_cbranch_scc1 Lf10_amS2
zdc
s_cbranch_scc0 Lf10_amRb2
ze 0
zf 236,148,76
zaq 21,9,6
zaq 22,12,6
zar 140,15,3
zf 236,172,80
zo 100,21
zo 102,22
zb 104,21,16
zf 236,196,84
zb 106,22,16
zb 108,21,64
zb 110,22,64
zf 240,152,76
zb 112,21,80
zb 114,22,80
zb 116,21,128
zf 240,176,80
zb 118,22,128
zb 120,21,144
zb 122,22,144
zf 240,200,84
zar 141,15,5
zar 142,18,3
zar 143,18,5
za 32,156,76
zn 53,2048
zn 42,3072
za 32,180,80
z6 0x1000
zag 0x1000
z0 43
ze 10
zh 124,100,140
ze 8
z4 46,36,44
zax 47
zh 128,104,140
ze 6
z5 36,46
z5 37,47
zh 132,108,140
ze 3
zbg 40,44,49
zc 88,124,125
zh 136,112,140
zc 89,126,127
zc 90,128,129
za 32,204,84
ze 0
zc 91,130,131
zc 92,132,133
zh 124,116,140
zc 93,134,135
zc 94,136,137
zh 128,120,140
zc 95,138,139
zay 41,45,50
za 36,160,76
zw 38,36,37
zv
zc 96,124,125
za 36,184,80
zc 97,126,127
zc 98,128,129
za 36,208,84
zc 99,130,131
zaz 36,47
za 40,164,76
za0 37,46
zw 39,46,47
za 40,188,80
za1 41,45
za2 41,51
za 40,212,84
za3 36,37
zas 37
za 44,168,76
za4 41,40
zq 38,39
za 44,192,80
za 44,216,84
Lf10_amH3:
Lf10_amG3:
zdt
s_cbranch_scc1 Lf10_amS3
zc5
s_cbranch_scc0 Lf10_amRb3
ze 0
zf 244,148,88
zaa 21,10,6
zaa 22,13,6
zab 140,16,3
zf 244,172,92
zo 100,21
zo 102,22
zb 104,21,16
zf 244,196,96
zb 106,22,16
zb 108,21,64
zb 110,22,64
zf 248,152,88
zb 112,21,80
zb 114,22,80
zb 116,21,128
zf 248,176,92
zb 118,22,128
zb 120,21,144
zf 248,200,96
zb 122,22,144
zab 141,16,5
za 48,156,88
zab 142,19,3
zab 143,19,5
za 48,180,92
zn 53,1024
za 48,204,96
ze 10
zn 42,2048
zh 124,100,140
ze 8
zq 36,37
za5 37,52
zh 128,104,140
ze 6
zcm 40,44
zcn 39
zh 132,108,140
ze 4
za6 11,41
zc 76,124,125
zh 136,112,140
zc 77,126,127
zc 78,128,129
za 52,160,88
ze 1
zc 79,130,131
zc 80,132,133
zh 124,116,140
ze 0
zc 81,134,135
zc 82,136,137
zh 128,120,140
zc 83,138,139
z8 17,38,7
za 52,184,92
z8 20,36,7
zc 84,124,125
za 52,208,96
zco
zc 85,126,127
zc 86,128,129
za 56,164,88
zc 87,130,131
zau 14,37,11
za 56,188,92
zcp
zcq
zx 36,58
za 56,212,96
zr 37,58
zd 58,59
zd 59,60
za 60,168,88
zd 60,61
zdx 38,48
za 60,192,92
zcj 39,33
z2 38
za 60,216,96
Lf10_amH4:
Lf10_amG4:
zc2
s_cbranch_scc1 Lf10_amS4
zc0
s_cbranch_scc0 Lf10_amRb4
ze 0
zf 252,148,76
zac 21,10,6
zac 22,13,6
zad 140,16,3
zf 252,172,80
zo 100,21
zo 102,22
zb 104,21,16
zf 252,196,84
zb 106,22,16
zb 108,21,64
zb 110,22,64
za 64,152,76
zb 112,21,80
zb 114,22,80
zb 116,21,128
za 64,176,80
zb 118,22,128
zb 120,21,144
zb 122,22,144
za 64,200,84
zad 141,16,5
zad 142,19,3
zad 143,19,5
za 68,156,76
zn 43,3072
z6 0x2000
zag 0x2000
z0 53
za 68,180,80
ze 10
zn 42,1024
zh 124,100,140
ze 8
z2 39
zg 36,38
zh 128,104,140
ze 6
zg 37,39
zs 38
zh 132,108,140
ze 3
zs 39
zc 88,124,125
zh 136,112,140
zc 89,126,127
zc 90,128,129
za 68,204,84
ze 0
zc 91,130,131
zc 92,132,133
zh 124,116,140
zc 93,134,135
zc 94,136,137
zh 128,120,140
zc 95,138,139
zs 36
za 72,160,76
zs 37
zv
zc 96,124,125
za 72,184,80
zc 97,126,127
zc 98,128,129
za 72,208,84
zc 99,130,131
zq 38,39
z7 76,164
zq 36,37
zr 37,36
za 76,188,80
zav 36,38
zaw 36
za 76,212,84
z3 45,37
z3 44,36
za 80,168,76
z4 47,37,45
z4 46,36,44
z7 80,192
za 80,216,84
Lf10_amH5:
Lf10_amG5:
zey
s_cbranch_scc1 Lf10_amS5
zd4
s_cbranch_scc0 Lf10_amRb5
ze 0
za 84,148,88
zaj 21,10,6
zaj 22,13,6
zak 140,16,3
za 84,172,92
zo 100,21
zo 102,22
zb 104,21,16
za 84,196,96
zb 106,22,16
zb 108,21,64
zb 110,22,64
z7 88,152
zb 112,21,80
zb 114,22,80
zb 116,21,128
za 88,176,92
zb 118,22,128
zb 120,21,144
zb 122,22,144
za 88,200,96
zak 141,16,5
zak 142,19,3
zak 143,19,5
za 92,156,88
zn 43,2048
zn 53,3072
z7 92,180
ze 10
zax 47
z5 36,46
zh 124,100,140
ze 8
z5 37,47
zbg 40,44,49
zh 128,104,140
ze 6
zay 41,45,50
zw 38,36,37
zh 132,108,140
ze 4
zaz 36,47
zc 76,124,125
zh 136,112,140
zc 77,126,127
zc 78,128,129
za 92,204,96
ze 0
zc 79,130,131
zc 80,132,133
zh 124,116,140
zc 81,134,135
zc 82,136,137
zh 128,120,140
zc 83,138,139
za0 37,46
za 96,160,88
zw 39,46,47
zv
zc 84,124,125
za 96,184,92
zc 85,126,127
zc 86,128,129
z7 96,208
zc 87,130,131
za1 41,45
za 100,164,88
za2 41,51
za3 36,37
za 100,188,92
zas 37
za4 41,40
za 100,212,96
zq 38,39
zq 36,37
za 104,168,88
za5 37,52
zdf 40,44
za 104,192,92
zdg 39
za 104,216,96
Lf10_amH6:
Lf10_amG6:
zez
s_cbranch_scc1 Lf10_amS6
zd5
s_cbranch_scc0 Lf10_amRb6
ze 0
za 108,148,76
zaq 21,10,6
zaq 22,13,6
zar 140,16,3
za 108,172,80
zo 100,21
zo 102,22
zb 104,21,16
za 108,196,84
zb 106,22,16
zb 108,21,64
zb 110,22,64
za 112,152,76
zb 112,21,80
zb 114,22,80
za 112,176,80
zb 116,21,128
zb 118,22,128
za 112,200,84
zb 120,21,144
zb 122,22,144
za 116,156,76
zar 141,16,5
zar 142,19,3
za 116,180,80
z6 0x3000
zag 0x3000
z0 42
zar 143,19,5
za 116,204,84
ze 10
zn 43,1024
zh 124,100,140
ze 8
zn 53,2048
zh 128,104,140
ze 6
za6 9,41
z8 15,38,7
zh 132,108,140
ze 4
z8 18,36,7
zc 88,124,125
zh 136,112,140
zdh
zc 89,126,127
zc 90,128,129
za 120,160,76
ze 0
zc 91,130,131
zc 92,132,133
zh 124,116,140
zc 93,134,135
zc 94,136,137
zh 128,120,140
zc 95,138,139
zau 12,37,9
za 120,184,80
zdi
zdj
zc 96,124,125
za 120,208,84
zc 97,126,127
zc 98,128,129
za 124,164,76
zc 99,130,131
zx 36,64
za 124,188,80
zr 37,64
zd 64,65
za 124,212,84
zd 65,66
zd 66,67
za 128,168,76
zfl 38,48
zcj 39,33
za 128,192,80
z2 38
za 128,216,84
Lf10_amH7:
Lf10_amG7:
zf7
s_cbranch_scc1 Lf10_amS7
zdy
s_cbranch_scc0 Lf10_amRb7
ze 0
za 132,148,88
zaa 21,11,6
zaa 22,14,6
zab 140,17,3
za 132,172,92
zo 100,21
zo 102,22
zb 104,21,16
za 132,196,96
zb 106,22,16
zb 108,21,64
zb 110,22,64
za 136,152,88
zb 112,21,80
zb 114,22,80
zb 116,21,128
za 136,176,92
zb 118,22,128
zb 120,21,144
zb 122,22,144
za 136,200,96
zab 141,17,5
zab 142,20,3
zab 143,20,5
za 140,156,88
zn 42,3072
z6 0x4000
zag 0x4000
z0 43
za 140,180,92
ze 10
zn 53,1024
zh 124,100,140
ze 8
z2 39
zg 36,38
zh 128,104,140
ze 6
zg 37,39
zs 38
zh 132,108,140
ze 3
zs 39
zc 76,124,125
zh 136,112,140
zc 77,126,127
zc 78,128,129
za 140,204,96
ze 0
zc 79,130,131
zc 80,132,133
zh 124,116,140
zc 81,134,135
zc 82,136,137
zh 128,120,140
zc 83,138,139
zs 36
za 144,160,88
zs 37
zv
zc 84,124,125
za 144,184,92
zc 85,126,127
zc 86,128,129
za 144,208,96
zc 87,130,131
zq 38,39
za 148,164,88
zq 36,37
zr 37,36
za 148,188,92
zav 36,38
zaw 36
za 148,212,96
z3 45,37
z3 44,36
za 152,168,88
z4 47,37,45
z4 46,36,44
za 152,192,92
za 152,216,96
Lf10_amH8:
Lf10_amG8:
ze7
s_cbranch_scc1 Lf10_amS8
zc1
s_cbranch_scc0 Lf10_amRb8
ze 0
za 156,148,76
zac 21,11,6
zac 22,14,6
zad 140,17,3
za 156,172,80
zo 100,21
zo 102,22
zb 104,21,16
za 156,196,84
zb 106,22,16
zb 108,21,64
zb 110,22,64
za 160,152,76
zb 112,21,80
zb 114,22,80
zb 116,21,128
za 160,176,80
zb 118,22,128
zb 120,21,144
zb 122,22,144
za 160,200,84
zad 141,17,5
zad 142,20,3
zad 143,20,5
za 164,156,76
zax 47
z5 36,46
z5 37,47
za 164,180,80
zbg 40,44,49
zay 41,45,50
za 164,204,84
ze 10
zw 38,36,37
zaz 36,47
zh 124,100,140
ze 8
za0 37,46
zw 39,46,47
zh 128,104,140
ze 6
za1 41,45
za2 41,51
zh 132,108,140
ze 4
za3 36,37
zc 88,124,125
zh 136,112,140
zc 89,126,127
zc 90,128,129
za 168,160,76
ze 0
zc 91,130,131
zc 92,132,133
zh 124,116,140
zc 93,134,135
zc 94,136,137
zh 128,120,140
zc 95,138,139
zas 37
za 168,184,80
za4 41,40
zv
zc 96,124,125
za 168,208,84
zc 97,126,127
zc 98,128,129
za 172,164,76
zc 99,130,131
zq 38,39
za 172,188,80
zq 36,37
za5 37,52
za 172,212,84
zca 40,44
zcb 39
za 176,168,76
za6 10,41
z8 16,38,7
z8 19,36,7
za 176,192,80
zcc
zau 13,37,10
zcd
zce
za 176,216,84
Lf10_amH9:
Lf10_amG9:
zct
s_cbranch_scc1 Lf10_amS9
zcf
s_cbranch_scc0 Lf10_amRb9
ze 0
za 180,148,88
zbn
zbq 8,0
zaa 21,9,6
zaa 22,12,6
za 184,152,88
zbo
zo 100,21
zo 102,22
zb 104,21,16
za 188,156,88
zbp
zb 106,22,16
zb 108,21,64
zb 110,22,64
za 192,160,88
zf5
zb 112,21,80
zb 114,22,80
zb 116,21,128
za 196,164,88
zb 118,22,128
zb 120,21,144
zb 122,22,144
za 200,168,88
zab 140,15,3
zab 141,15,5
zab 142,18,3
za 180,172,92
zu 12
zo 148,1
zb 150,1,1536
zab 143,18,5
za 184,176,92
ze 12
zo 152,2
zb 154,2,1536
zb 156,1,64
zh 124,100,140
ze 13
zb 158,1,1600
zb 160,2,64
zb 162,2,1600
zh 128,104,140
ze 14
zb 164,1,128
zb 166,1,1664
zh 132,108,140
ze 14
zc 76,124,125
zc 77,126,127
zh 136,112,140
zb 168,2,128
zc 78,128,129
za 188,180,92
ze 11
zc 79,130,131
zc 80,132,133
zh 124,116,140
zc 81,134,135
zc 82,136,137
zh 128,120,140
zb 170,2,1664
zc 83,138,139
za 192,184,92
za 196,188,92
zv
zc 84,124,125
zc 85,126,127
za 200,192,92
zu 6
zb 172,1,6144
zc 86,128,129
zc 87,130,131
za 180,196,96
zb 174,1,7680
zb 176,2,6144
zb 178,2,7680
za 184,200,96
zb 180,1,6208
zb 182,1,7744
za 188,204,96
zb 184,2,6208
zb 186,2,7744
za 192,208,96
zb 188,1,6272
zb 190,1,7808
za 196,212,96
zb 192,2,6272
zb 194,2,7808
za 200,216,96
Lf10_amE2:
zgx
s_cbranch_scc1 Lf10_amH0
zde
s_cbranch_scc1 Lf10_ayH0
s_branch Lf10_azH0
Lf10_azH0:
Lf10_azG0:
zd6
s_cbranch_scc1 Lf10_azS0
zda
s_cbranch_scc0 Lf10_azRb0
ze 15
za 0,156,76
zac 21,9,6
zac 22,12,6
zad 140,15,3
zad 141,15,5
zad 142,18,3
za 4,160,76
ze 12
zo 100,21
zo 102,22
zb 104,21,16
zb 106,22,16
zb 108,21,64
za 8,164,76
zb 110,22,64
zb 112,21,80
zb 114,22,80
zb 116,21,128
za 12,168,76
zb 118,22,128
zb 120,21,144
zb 122,22,144
zad 143,18,5
zf 220,148,76
zu 0
zb 204,1,12352
zb 206,1,13888
zb 208,2,12352
zb 210,2,13888
zf 224,152,76
ze 15
zb 212,1,12416
zb 214,1,13952
zb 216,2,12416
zb 218,2,13952
za 0,180,80
ze 15
zb 196,1,12288
zb 198,1,13824
zb 200,2,12288
zb 202,2,13824
zh 124,100,140
zx 36,69
zr 37,69
zcl 38,48
zbs 39,33
zh 128,104,140
ze 15
z2 38
z2 39
zg 36,38
zc 88,124,125
zh 132,108,140
zc 89,126,127
zg 37,39
zs 38
zc 90,128,129
zh 136,112,140
ze 11
zc 91,130,131
zs 39
zs 36
zc 92,132,133
zh 124,116,140
zc 93,134,135
zs 37
zc 94,136,137
zc 95,138,139
zh 128,120,140
zq 38,39
zq 36,37
zr 37,36
zc 96,124,125
za 4,184,80
zc 97,126,127
zav 36,38
zaw 36
zc 98,128,129
za 8,188,80
zc 99,130,131
z3 45,37
z3 44,36
z4 47,37,45
za 12,192,80
z4 46,36,44
zax 47
z5 36,46
z5 37,47
zf 220,172,80
zbg 40,44,49
zay 41,45,50
zw 38,36,37
zaz 36,47
zf 224,176,80
ze 0
za0 37,46
zw 39,46,47
za1 41,45
za2 41,51
za 0,204,84
za3 36,37
zas 37
za4 41,40
zq 38,39
za 4,208,84
zq 36,37
za5 37,52
zcm 40,44
zcn 39
za 8,212,84
zk 0,25,2048
za 12,216,84
zv
zk 4,25,3072
za6 11,41
zf 220,196,84
z8 17,38,7
z8 20,36,7
zco
zau 14,37,11
zcp
zf 224,200,84
zcq
Lf10_azH1:
Lf10_azG1:
zd7
s_cbranch_scc1 Lf10_azS1
zdb
s_cbranch_scc0 Lf10_azRb1
za 16,156,88
zfo 0xffff0000
zaj 21,9,6
zaj 22,12,6
zak 140,15,3
za 16,180,92
zf6 0xffff0000
zo 100,21
zo 102,22
zb 104,21,16
za 16,204,96
zb 106,22,16
zb 108,21,64
zb 110,22,64
za 20,160,88
zb 112,21,80
zb 114,22,80
zb 116,21,128
za 20,184,92
zb 118,22,128
zb 120,21,144
zb 122,22,144
za 20,208,96
zak 141,15,5
zak 142,18,3
zak 143,18,5
za 24,164,88
zk 8,25,4096
za 24,188,92
ze 11
zk 12,25,5120
zh 124,100,140
ze 10
zk 16,25,8192
zh 128,104,140
ze 9
zk 20,25,9216
zh 132,108,140
ze 2
s_barrier
za7 32,28
za7 36,29
zh 136,112,140
za7 40,30
zl 44,28,1024
za 24,212,96
zl 48,29,1024
zl 52,30,1024
za 28,168,88
zc 76,124,125
zc 77,126,127
za 28,192,92
zc 78,128,129
zc 79,130,131
zh 124,116,140
zk 24,25,10240
zh 128,120,140
zc 80,132,133
zc 81,134,135
za 28,216,96
zc 82,136,137
zc 83,138,139
zf 228,148,88
zc 84,124,125
zc 85,126,127
zf 228,172,92
zc 86,128,129
zc 87,130,131
zf 228,196,96
zk 28,25,11264
zf 232,152,88
zf 232,176,92
zf 232,200,96
Lf10_azH2:
Lf10_azG2:
zd8
s_cbranch_scc1 Lf10_azS2
zdc
s_cbranch_scc0 Lf10_azRb2
za 32,156,76
zaq 21,9,6
zaq 22,12,6
zar 140,15,3
zar 141,15,5
za 32,180,80
zo 100,21
zo 102,22
zb 104,21,16
zb 106,22,16
za 32,204,84
zb 108,21,64
zb 110,22,64
zb 112,21,80
zb 114,22,80
za 36,160,76
zb 116,21,128
zb 118,22,128
zb 120,21,144
zb 122,22,144
za 36,184,80
zk 32,25,14336
zar 142,18,3
zar 143,18,5
za 36,208,84
ze 13
zm 36,32
zg 40,220
zm 37,33
zg 41,221
za 40,164,76
s_barrier
zm 38,34
zg 42,222
zm 39,35
ze 11
zh 124,100,140
ze 9
zk 36,25,15360
zh 128,104,140
ze 8
zl 32,28,6144
zg 43,223
zg 36,40
zg 37,41
zh 132,108,140
ze 7
zg 38,42
zg 39,43
zc 40,36,37
zc 41,38,39
zh 136,112,140
zl 36,29,6144
zc 88,124,125
zc 89,126,127
zc 90,128,129
za 40,188,80
ze 4
zc 91,130,131
zc 92,132,133
zc 93,134,135
zc 94,136,137
zh 124,116,140
zc 95,138,139
zm 48,44
zg 52,224
zm 49,45
zh 128,120,140
zg 53,225
zm 50,46
zg 54,226
zc 96,124,125
za 40,212,84
zc 97,126,127
zm 51,47
zg 55,227
zc 98,128,129
za 44,168,76
zl 44,28,7168
zc 99,130,131
zg 48,52
zg 49,53
za 44,192,80
zk 40,25,16384
za 44,216,84
zg 50,54
zg 51,55
zc 52,48,49
zc 53,50,51
zf 236,148,76
zl 48,29,7168
zah 42,52,40
zah 43,53,41
zf 236,172,80
zk 44,25,17408
zf 236,196,84
zai 40,52
zai 41,53
zf 240,152,76
zfn
zbf 40,26
zl 52,30,7168
zf 240,176,80
zl 40,30,6144
zf 240,200,84
Lf10_azH3:
Lf10_azG3:
zdt
s_cbranch_scc1 Lf10_azS3
zc5
s_cbranch_scc0 Lf10_azRb3
ze 6
za 48,156,88
zaa 21,10,6
zaa 22,13,6
zab 140,16,3
zab 141,16,5
za 48,180,92
zo 100,21
zo 102,22
zb 104,21,16
zb 106,22,16
za 48,204,96
zb 108,21,64
zb 110,22,64
zb 112,21,80
zb 114,22,80
za 52,160,88
zb 116,21,128
zb 118,22,128
zb 120,21,144
zb 122,22,144
za 52,184,92
zk 48,25,2048
zab 142,19,3
zab 143,19,5
za 52,208,96
ze 13
zm 36,32
zg 40,228
zm 37,33
zg 41,229
za 56,164,88
s_barrier
zm 38,34
zg 42,230
zm 39,35
ze 11
zh 124,100,140
ze 9
zk 52,25,3072
zh 128,104,140
ze 8
zl 32,28,12288
zg 43,231
zg 36,40
zg 37,41
zh 132,108,140
ze 7
zg 38,42
zg 39,43
zc 40,36,37
zc 41,38,39
zh 136,112,140
zl 36,29,12288
zc 76,124,125
zc 77,126,127
zc 78,128,129
za 56,188,92
ze 4
zc 79,130,131
zc 80,132,133
zc 81,134,135
zc 82,136,137
zh 124,116,140
zc 83,138,139
zm 48,44
zg 52,232
zm 49,45
zh 128,120,140
zg 53,233
zm 50,46
zg 54,234
zc 84,124,125
za 56,212,96
zc 85,126,127
zm 51,47
zg 55,235
zc 86,128,129
za 60,168,88
zl 44,28,13312
zc 87,130,131
zg 48,52
zg 49,53
za 60,192,92
zk 56,25,4096
za 60,216,96
zg 50,54
zg 51,55
zc 52,48,49
zc 53,50,51
zf 244,148,88
zl 48,29,13312
zah 42,52,40
zah 43,53,41
zf 244,172,92
zk 60,25,5120
zf 244,196,96
zai 40,52
zai 41,53
zf 248,152,88
zbh 0xa800
zbf 40,26
zl 52,30,13312
zf 248,176,92
zl 40,30,12288
zf 248,200,96
Lf10_azH4:
Lf10_azG4:
zc2
s_cbranch_scc1 Lf10_azS4
zc0
s_cbranch_scc0 Lf10_azRb4
ze 6
za 68,156,76
zac 21,10,6
zac 22,13,6
zad 140,16,3
zad 141,16,5
za 68,180,80
zo 100,21
zo 102,22
zb 104,21,16
zb 106,22,16
za 68,204,84
zb 108,21,64
zb 110,22,64
zb 112,21,80
zb 114,22,80
za 72,160,76
zb 116,21,128
zb 118,22,128
zb 120,21,144
zb 122,22,144
za 72,184,80
zk 68,25,8192
zad 142,19,3
zad 143,19,5
za 72,208,84
ze 13
zm 36,32
zg 40,236
zm 37,33
zg 41,237
z7 76,164
s_barrier
zm 38,34
zg 42,238
zm 39,35
ze 11
zh 124,100,140
ze 9
zk 72,25,9216
zh 128,104,140
ze 8
za7 32,28
zg 43,239
zg 36,40
zg 37,41
zh 132,108,140
ze 7
zg 38,42
zg 39,43
zc 40,36,37
zc 41,38,39
zh 136,112,140
za7 36,29
zc 88,124,125
zc 89,126,127
zc 90,128,129
za 76,188,80
ze 4
zc 91,130,131
zc 92,132,133
zc 93,134,135
zc 94,136,137
zh 124,116,140
zc 95,138,139
zm 48,44
zg 52,240
zm 49,45
zh 128,120,140
zg 53,241
zm 50,46
zg 54,242
zc 96,124,125
za 76,212,84
zc 97,126,127
zm 51,47
zg 55,243
zc 98,128,129
za 80,168,76
zl 44,28,1024
zc 99,130,131
zg 48,52
zg 49,53
z7 80,192
zk 76,25,10240
za 80,216,84
zg 50,54
zg 51,55
zc 52,48,49
zc 53,50,51
zf 252,148,76
zl 48,29,1024
zah 42,52,40
zah 43,53,41
zf 252,172,80
zk 80,25,11264
zf 252,196,84
zai 40,52
zai 41,53
za 64,152,76
zbh 0x15000
zbf 40,26
zl 52,30,1024
za 64,176,80
za7 40,30
za 64,200,84
Lf10_azH5:
Lf10_azG5:
zey
s_cbranch_scc1 Lf10_azS5
zd4
s_cbranch_scc0 Lf10_azRb5
ze 6
za 92,156,88
zaj 21,10,6
zaj 22,13,6
zak 140,16,3
zak 141,16,5
z7 92,180
zo 100,21
zo 102,22
zb 104,21,16
zb 106,22,16
za 92,204,96
zb 108,21,64
zb 110,22,64
zb 112,21,80
zb 114,22,80
za 96,160,88
zb 116,21,128
zb 118,22,128
zb 120,21,144
zb 122,22,144
za 96,184,92
zk 92,25,14336
zak 142,19,3
zak 143,19,5
z7 96,208
ze 13
zm 36,32
zg 40,244
zm 37,33
zg 41,245
za 100,164,88
s_barrier
zm 38,34
zg 42,246
zm 39,35
ze 11
zh 124,100,140
ze 9
zk 96,25,15360
zh 128,104,140
ze 8
zl 32,28,6144
zg 43,247
zg 36,40
zg 37,41
zh 132,108,140
ze 7
zg 38,42
zg 39,43
zc 40,36,37
zc 41,38,39
zh 136,112,140
zl 36,29,6144
zc 76,124,125
zc 77,126,127
zc 78,128,129
za 100,188,92
ze 4
zc 79,130,131
zc 80,132,133
zc 81,134,135
zc 82,136,137
zh 124,116,140
zc 83,138,139
zm 48,44
zg 52,248
zm 49,45
zh 128,120,140
zg 53,249
zm 50,46
zg 54,250
zc 84,124,125
za 100,212,96
zc 85,126,127
zm 51,47
zg 55,251
zc 86,128,129
za 104,168,88
zl 44,28,7168
zc 87,130,131
zg 48,52
zg 49,53
za 104,192,92
zk 100,25,16384
za 104,216,96
zg 50,54
zg 51,55
zc 52,48,49
zc 53,50,51
za 84,148,88
zl 48,29,7168
zah 42,52,40
zah 43,53,41
za 84,172,92
zk 104,25,17408
za 84,196,96
zai 40,52
zai 41,53
z7 88,152
zbh 0x1f800
zbf 40,26
zl 52,30,7168
za 88,176,92
zl 40,30,6144
za 88,200,96
Lf10_azH6:
Lf10_azG6:
zez
s_cbranch_scc1 Lf10_azS6
zd5
s_cbranch_scc0 Lf10_azRb6
ze 6
za 116,156,76
zaq 21,10,6
zaq 22,13,6
zar 140,16,3
zar 141,16,5
zar 142,19,3
za 116,180,80
zo 100,21
zo 102,22
zb 104,21,16
zb 106,22,16
za 116,204,84
zb 108,21,64
zb 110,22,64
zb 112,21,80
zb 114,22,80
za 120,160,76
zb 116,21,128
zb 118,22,128
zb 120,21,144
zb 122,22,144
za 120,184,80
zk 116,25,2048
zar 143,19,5
za 120,208,84
ze 13
zm 36,32
zg 40,252
zm 37,33
zg 41,253
za 124,164,76
s_barrier
zm 38,34
zg 42,254
zm 39,35
ze 11
zh 124,100,140
ze 9
zk 120,25,3072
zh 128,104,140
ze 8
zl 32,28,12288
zg 43,255
zg 36,40
zg 37,41
zh 132,108,140
ze 7
zg 38,42
zg 39,43
zc 40,36,37
zc 41,38,39
zh 136,112,140
zl 36,29,12288
zc 88,124,125
zc 89,126,127
zc 90,128,129
za 124,188,80
ze 4
zc 91,130,131
zc 92,132,133
zc 93,134,135
zc 94,136,137
zh 124,116,140
zc 95,138,139
zm 48,44
z9 44,64
zg 52,44
zh 128,120,140
zm 49,45
z9 45,65
zg 53,45
zc 96,124,125
za 124,212,84
zc 97,126,127
zm 50,46
z9 46,66
zc 98,128,129
za 128,168,76
zc 99,130,131
zg 54,46
zm 51,47
z9 47,67
za 128,192,80
zk 124,25,4096
za 128,216,84
zg 55,47
zg 48,52
zg 49,53
zg 50,54
za 108,148,76
zl 44,28,13312
zg 51,55
zc 52,48,49
zc 53,50,51
za 108,172,80
zk 128,25,5120
za 108,196,84
zl 48,29,13312
zah 42,52,40
zah 43,53,41
zai 40,52
za 112,152,76
zai 41,53
za 112,176,80
zbh 0x2a000
zbf 40,26
zl 52,30,13312
zl 40,30,12288
za 112,200,84
Lf10_azH7:
Lf10_azG7:
zf7
s_cbranch_scc1 Lf10_azS7
zdy
s_cbranch_scc0 Lf10_azRb7
ze 6
za 140,156,88
zaa 21,11,6
zaa 22,14,6
zab 140,17,3
zab 141,17,5
zab 142,20,3
za 140,180,92
zo 100,21
zo 102,22
zb 104,21,16
zb 106,22,16
zb 108,21,64
za 140,204,96
zb 110,22,64
zb 112,21,80
zb 114,22,80
zb 116,21,128
zb 118,22,128
za 144,160,88
zb 120,21,144
zb 122,22,144
zk 140,25,8192
zab 143,20,5
za 144,184,92
ze 13
zm 36,32
z9 32,84
zg 40,32
zm 37,33
za 144,208,96
ze 11
z9 33,85
zg 41,33
zm 38,34
z9 34,86
zh 124,100,140
ze 9
zv
zk 144,25,9216
zg 42,34
zm 39,35
z9 35,87
zh 128,104,140
ze 8
zg 43,35
zg 36,40
zg 37,41
zg 38,42
zh 132,108,140
ze 5
zg 39,43
zc 40,36,37
zc 41,38,39
zc 76,124,125
zh 136,112,140
ze 2
zc 77,126,127
zc 78,128,129
zc 79,130,131
zc 80,132,133
zh 124,116,140
zc 81,134,135
zm 48,44
z9 44,88
zc 82,136,137
zh 128,120,140
zc 83,138,139
zg 52,44
zm 49,45
zc 84,124,125
za 148,164,88
s_barrier
za7 32,28
za7 36,29
zc 85,126,127
za 148,188,92
zc 86,128,129
zc 87,130,131
z9 45,89
zg 53,45
za 148,212,96
zm 50,46
z9 46,90
zg 54,46
zm 51,47
za 152,168,88
z9 47,91
zg 55,47
zg 48,52
zg 49,53
za 152,192,92
zk 148,25,10240
za 152,216,96
zl 44,28,1024
zg 50,54
zg 51,55
zc 52,48,49
za 132,148,88
zc 53,50,51
zah 42,52,40
zah 43,53,41
zai 40,52
za 132,172,92
zk 152,25,11264
za 132,196,96
zl 48,29,1024
zai 41,53
za 136,152,88
zbh 0x34800
zbf 40,26
zl 52,30,1024
za 136,176,92
za7 40,30
za 136,200,96
Lf10_azH8:
Lf10_azG8:
ze7
s_cbranch_scc1 Lf10_azS8
zc1
s_cbranch_scc0 Lf10_azRb8
ze 6
za 164,156,76
zac 21,11,6
zac 22,14,6
zad 140,17,3
zad 141,17,5
zad 142,20,3
za 164,180,80
zo 100,21
zo 102,22
zb 104,21,16
zb 106,22,16
zb 108,21,64
za 164,204,84
zb 110,22,64
zb 112,21,80
zb 114,22,80
zb 116,21,128
zb 118,22,128
za 168,160,76
zb 120,21,144
zb 122,22,144
zk 164,25,14336
zad 143,20,5
za 168,184,80
ze 13
zm 36,32
z9 32,108
zg 40,32
zm 37,33
za 168,208,84
ze 11
z9 33,109
zg 41,33
zm 38,34
z9 34,110
zh 124,100,140
ze 9
zv
zk 168,25,15360
zg 42,34
zm 39,35
z9 35,111
zh 128,104,140
ze 8
zg 43,35
zg 36,40
zg 37,41
zg 38,42
zh 132,108,140
ze 5
zg 39,43
zc 40,36,37
zc 41,38,39
zc 88,124,125
zh 136,112,140
ze 2
zc 89,126,127
zc 90,128,129
zc 91,130,131
zc 92,132,133
zh 124,116,140
zc 93,134,135
zm 48,44
z9 44,112
zc 94,136,137
zh 128,120,140
zc 95,138,139
zg 52,44
zm 49,45
zc 96,124,125
za 172,164,76
s_barrier
zl 32,28,6144
zl 36,29,6144
zc 97,126,127
za 172,188,80
zc 98,128,129
zc 99,130,131
z9 45,113
zg 53,45
za 172,212,84
zm 50,46
z9 46,114
zg 54,46
zm 51,47
za 176,168,76
z9 47,115
zg 55,47
zg 48,52
zg 49,53
za 176,192,80
zk 172,25,16384
za 176,216,84
zl 44,28,7168
zg 50,54
zg 51,55
zc 52,48,49
za 156,148,76
zc 53,50,51
zah 42,52,40
zah 43,53,41
zai 40,52
za 156,172,80
zk 176,25,17408
za 156,196,84
zl 48,29,7168
zai 41,53
za 160,152,76
zbh 0x3f000
zbf 40,26
zl 52,30,7168
za 160,176,80
zl 40,30,6144
za 160,200,84
s_branch Lf10_azR9
Lf10_azE2:
Lf10_ayH0:
Lf10_ayG0:
zd6
s_cbranch_scc1 Lf10_ayS0
zda
s_cbranch_scc0 Lf10_ayRb0
ze 15
za 0,156,76
zac 21,9,6
zac 22,12,6
zad 140,15,3
zad 141,15,5
zad 142,18,3
za 4,160,76
ze 12
zo 100,21
zo 102,22
zb 104,21,16
zb 106,22,16
zb 108,21,64
za 8,164,76
zb 110,22,64
zb 112,21,80
zb 114,22,80
zb 116,21,128
za 12,168,76
zb 118,22,128
zb 120,21,144
zb 122,22,144
zad 143,18,5
zf 220,148,76
zu 0
zb 204,1,12352
zb 206,1,13888
zb 208,2,12352
zb 210,2,13888
zf 224,152,76
ze 15
zb 212,1,12416
zb 214,1,13952
zb 216,2,12416
zb 218,2,13952
za 0,180,80
ze 15
zb 196,1,12288
zb 198,1,13824
zb 200,2,12288
zb 202,2,13824
zh 124,100,140
zx 36,69
zr 37,69
zcl 38,48
zbs 39,33
zh 128,104,140
ze 15
z2 38
z2 39
zg 36,38
zc 88,124,125
zh 132,108,140
zc 89,126,127
zg 37,39
zs 38
zc 90,128,129
zh 136,112,140
ze 11
zc 91,130,131
zs 39
zs 36
zc 92,132,133
zh 124,116,140
zc 93,134,135
zs 37
zc 94,136,137
zc 95,138,139
zh 128,120,140
zq 38,39
zq 36,37
zr 37,36
zc 96,124,125
za 4,184,80
zc 97,126,127
zav 36,38
zaw 36
zc 98,128,129
za 8,188,80
zc 99,130,131
z3 45,37
z3 44,36
z4 47,37,45
za 12,192,80
z4 46,36,44
zax 47
z5 36,46
z5 37,47
zf 220,172,80
zbg 40,44,49
zay 41,45,50
zw 38,36,37
zaz 36,47
zf 224,176,80
ze 0
za0 37,46
zw 39,46,47
za1 41,45
za2 41,51
za 0,204,84
za3 36,37
zas 37
za4 41,40
zq 38,39
za 4,208,84
zq 36,37
za5 37,52
zcm 40,44
zcn 39
za 8,212,84
zk 0,25,2048
za 12,216,84
zv
zk 4,25,3072
za6 11,41
zf 220,196,84
z8 17,38,7
z8 20,36,7
zco
zau 14,37,11
zcp
zf 224,200,84
zcq
Lf10_ayH1:
Lf10_ayG1:
zd7
s_cbranch_scc1 Lf10_ayS1
zdb
s_cbranch_scc0 Lf10_ayRb1
za 16,156,88
zaj 21,9,6
zaj 22,12,6
zak 140,15,3
za 16,180,92
zo 100,21
zo 102,22
zb 104,21,16
za 16,204,96
zb 106,22,16
zb 108,21,64
zb 110,22,64
za 20,160,88
zb 112,21,80
zb 114,22,80
zb 116,21,128
za 20,184,92
zb 118,22,128
zb 120,21,144
zb 122,22,144
za 20,208,96
zak 141,15,5
zak 142,18,3
zak 143,18,5
za 24,164,88
zk 8,25,4096
za 24,188,92
ze 11
zk 12,25,5120
zh 124,100,140
ze 10
zdl 220,25
zh 128,104,140
ze 9
zat 224,25,1024
zh 132,108,140
ze 8
zk 16,25,8192
zh 136,112,140
zk 20,25,9216
za 24,212,96
ze 2
s_barrier
zc 76,124,125
zc 77,126,127
za 28,168,88
zc 78,128,129
zc 79,130,131
zc 80,132,133
zh 124,116,140
zk 24,25,10240
zc 81,134,135
zh 128,120,140
zc 82,136,137
zc 83,138,139
za 28,192,92
zam
zc 84,124,125
zc 85,126,127
za 28,216,96
zf 228,148,88
zc 86,128,129
zc 87,130,131
zf 228,172,92
zf 228,196,96
zf 232,152,88
zam
zk 28,25,11264
zf 232,176,92
zb0
zat 228,25,6144
zf 232,200,96
Lf10_ayH2:
Lf10_ayG2:
zd8
s_cbranch_scc1 Lf10_ayS2
zdc
s_cbranch_scc0 Lf10_ayRb2
za 32,156,76
zaq 21,9,6
zaq 22,12,6
zar 140,15,3
za 32,180,80
zo 100,21
zo 102,22
zb 104,21,16
za 32,204,84
zb 106,22,16
zb 108,21,64
zb 110,22,64
za 36,160,76
zb 112,21,80
zb 114,22,80
zb 116,21,128
za 36,184,80
zb 118,22,128
zb 120,21,144
zb 122,22,144
za 36,208,84
zar 141,15,5
zar 142,18,3
zar 143,18,5
za 40,164,76
zat 232,25,7168
za 40,188,80
ze 11
zk 32,25,14336
zh 124,100,140
ze 10
zk 36,25,15360
zh 128,104,140
ze 2
s_barrier
zh 132,108,140
zh 136,112,140
zv
zc 88,124,125
zc 89,126,127
za 40,212,84
za 44,168,76
zc 90,128,129
zc 91,130,131
zc 92,132,133
zh 124,116,140
zb0
zk 40,25,16384
zc 93,134,135
zh 128,120,140
zc 94,136,137
zc 95,138,139
za 44,192,80
zc 96,124,125
zc 97,126,127
za 44,216,84
zf 236,148,76
zv
zc 98,128,129
zc 99,130,131
zf 236,172,80
zf 236,196,84
zf 240,152,76
zv
zk 44,25,17408
zf 240,176,80
zbl
zat 236,25,12288
zf 240,200,84
Lf10_ayH3:
Lf10_ayG3:
zdt
s_cbranch_scc1 Lf10_ayS3
zc5
s_cbranch_scc0 Lf10_ayRb3
za 48,156,88
zaa 21,10,6
zaa 22,13,6
zab 140,16,3
za 48,180,92
zo 100,21
zo 102,22
zb 104,21,16
za 48,204,96
zb 106,22,16
zb 108,21,64
zb 110,22,64
za 52,160,88
zb 112,21,80
zb 114,22,80
zb 116,21,128
za 52,184,92
zb 118,22,128
zb 120,21,144
zb 122,22,144
za 52,208,96
zab 141,16,5
zab 142,19,3
zab 143,19,5
za 56,164,88
zat 240,25,13312
za 56,188,92
ze 11
zk 48,25,2048
zh 124,100,140
ze 10
zk 52,25,3072
zh 128,104,140
ze 2
s_barrier
zh 132,108,140
zh 136,112,140
zv
zc 76,124,125
zc 77,126,127
za 56,212,96
za 60,168,88
zc 78,128,129
zc 79,130,131
zc 80,132,133
zh 124,116,140
zb0
zk 56,25,4096
zc 81,134,135
zh 128,120,140
zc 82,136,137
zc 83,138,139
za 60,192,92
zc 84,124,125
zc 85,126,127
za 60,216,96
zf 244,148,88
zv
zc 86,128,129
zc 87,130,131
zf 244,172,92
zf 244,196,96
zf 248,152,88
zv
zk 60,25,5120
zf 248,176,92
zbl
zdl 244,25
zf 248,200,96
Lf10_ayH4:
Lf10_ayG4:
zc2
s_cbranch_scc1 Lf10_ayS4
zc0
s_cbranch_scc0 Lf10_ayRb4
za 68,156,76
zac 21,10,6
zac 22,13,6
zad 140,16,3
za 68,180,80
zo 100,21
zo 102,22
zb 104,21,16
za 68,204,84
zb 106,22,16
zb 108,21,64
zb 110,22,64
za 72,160,76
zb 112,21,80
zb 114,22,80
zb 116,21,128
za 72,184,80
zb 118,22,128
zb 120,21,144
zb 122,22,144
za 72,208,84
zad 141,16,5
zad 142,19,3
zad 143,19,5
z7 76,164
zat 248,25,1024
za 76,188,80
ze 11
zk 68,25,8192
zh 124,100,140
ze 10
zk 72,25,9216
zh 128,104,140
ze 2
s_barrier
zh 132,108,140
zh 136,112,140
zv
zc 88,124,125
zc 89,126,127
za 76,212,84
za 80,168,76
zc 90,128,129
zc 91,130,131
zc 92,132,133
zh 124,116,140
zb0
zk 76,25,10240
zc 93,134,135
zh 128,120,140
zc 94,136,137
zc 95,138,139
z7 80,192
zc 96,124,125
zc 97,126,127
za 80,216,84
zf 252,148,76
zv
zc 98,128,129
zc 99,130,131
zf 252,172,80
zf 252,196,84
za 64,152,76
zv
zk 80,25,11264
za 64,176,80
zbl
zat 252,25,6144
za 64,200,84
Lf10_ayH5:
Lf10_ayG5:
zey
s_cbranch_scc1 Lf10_ayS5
zd4
s_cbranch_scc0 Lf10_ayRb5
za 92,156,88
zaj 21,10,6
zaj 22,13,6
zak 140,16,3
z7 92,180
zo 100,21
zo 102,22
zb 104,21,16
za 92,204,96
zb 106,22,16
zb 108,21,64
zb 110,22,64
za 96,160,88
zb 112,21,80
zb 114,22,80
zb 116,21,128
za 96,184,92
zb 118,22,128
zb 120,21,144
zb 122,22,144
z7 96,208
zak 141,16,5
zak 142,19,3
zak 143,19,5
za 100,164,88
zk 64,25,7168
za 100,188,92
ze 11
zk 92,25,14336
zh 124,100,140
ze 10
zk 96,25,15360
zh 128,104,140
ze 2
s_barrier
zh 132,108,140
zh 136,112,140
zv
zc 76,124,125
zc 77,126,127
za 100,212,96
za 104,168,88
zc 78,128,129
zc 79,130,131
zc 80,132,133
zh 124,116,140
zb0
zk 100,25,16384
zc 81,134,135
zh 128,120,140
zc 82,136,137
zc 83,138,139
za 104,192,92
zc 84,124,125
zc 85,126,127
za 104,216,96
za 84,148,88
zv
zc 86,128,129
zc 87,130,131
za 84,172,92
za 84,196,96
z7 88,152
zv
zk 104,25,17408
za 88,176,92
zbl
zk 84,25,12288
za 88,200,96
Lf10_ayH6:
Lf10_ayG6:
zez
s_cbranch_scc1 Lf10_ayS6
zd5
s_cbranch_scc0 Lf10_ayRb6
za 116,156,76
zaq 21,10,6
zaq 22,13,6
zar 140,16,3
za 116,180,80
zo 100,21
zo 102,22
zb 104,21,16
za 116,204,84
zb 106,22,16
zb 108,21,64
zb 110,22,64
za 120,160,76
zb 112,21,80
zb 114,22,80
zb 116,21,128
za 120,184,80
zb 118,22,128
zb 120,21,144
zb 122,22,144
za 120,208,84
zar 141,16,5
zar 142,19,3
zar 143,19,5
za 124,164,76
zk 88,25,13312
za 124,188,80
ze 11
zk 116,25,2048
zh 124,100,140
ze 10
zk 120,25,3072
zh 128,104,140
ze 2
s_barrier
zh 132,108,140
zh 136,112,140
zv
zc 88,124,125
zc 89,126,127
za 124,212,84
za 128,168,76
zc 90,128,129
zc 91,130,131
zc 92,132,133
zh 124,116,140
zb0
zk 124,25,4096
zc 93,134,135
zh 128,120,140
zc 94,136,137
zc 95,138,139
za 128,192,80
zc 96,124,125
zc 97,126,127
za 128,216,84
za 108,148,76
zv
zc 98,128,129
zc 99,130,131
za 108,172,80
za 108,196,84
za 112,152,76
zv
zk 128,25,5120
za 112,176,80
zbl
zfr 108,25
za 112,200,84
Lf10_ayH7:
Lf10_ayG7:
zf7
s_cbranch_scc1 Lf10_ayS7
zdy
s_cbranch_scc0 Lf10_ayRb7
za 140,156,88
zaa 21,11,6
zaa 22,14,6
zab 140,17,3
za 140,180,92
zo 100,21
zo 102,22
zb 104,21,16
za 140,204,96
zb 106,22,16
zb 108,21,64
zb 110,22,64
za 144,160,88
zb 112,21,80
zb 114,22,80
zb 116,21,128
za 144,184,92
zb 118,22,128
zb 120,21,144
zb 122,22,144
za 144,208,96
zab 141,17,5
zab 142,20,3
zab 143,20,5
za 148,164,88
zk 112,25,1024
za 148,188,92
ze 11
zk 140,25,8192
zh 124,100,140
ze 10
zk 144,25,9216
zh 128,104,140
ze 2
s_barrier
zh 132,108,140
zh 136,112,140
zv
zc 76,124,125
zc 77,126,127
za 148,212,96
za 152,168,88
zc 78,128,129
zc 79,130,131
zc 80,132,133
zh 124,116,140
zb0
zk 148,25,10240
zc 81,134,135
zh 128,120,140
zc 82,136,137
zc 83,138,139
za 152,192,92
zc 84,124,125
zc 85,126,127
za 152,216,96
za 132,148,88
zv
zc 86,128,129
zc 87,130,131
za 132,172,92
za 132,196,96
za 136,152,88
zv
zk 152,25,11264
za 136,176,92
zbl
zk 132,25,6144
za 136,200,96
Lf10_ayH8:
Lf10_ayG8:
ze7
s_cbranch_scc1 Lf10_ayS8
zc1
s_cbranch_scc0 Lf10_ayRb8
za 164,156,76
zac 21,11,6
zac 22,14,6
zad 140,17,3
za 164,180,80
zo 100,21
zo 102,22
zb 104,21,16
za 164,204,84
zb 106,22,16
zb 108,21,64
zb 110,22,64
za 168,160,76
zb 112,21,80
zb 114,22,80
zb 116,21,128
za 168,184,80
zb 118,22,128
zb 120,21,144
zb 122,22,144
za 168,208,84
zad 141,17,5
zad 142,20,3
zad 143,20,5
za 172,164,76
zk 136,25,7168
za 172,188,80
ze 11
zk 164,25,14336
zh 124,100,140
ze 10
zk 168,25,15360
zh 128,104,140
ze 2
s_barrier
zh 132,108,140
zh 136,112,140
zv
zc 88,124,125
zc 89,126,127
za 172,212,84
za 176,168,76
zc 90,128,129
zc 91,130,131
zc 92,132,133
zh 124,116,140
zb0
zk 172,25,16384
zc 93,134,135
zh 128,120,140
zc 94,136,137
zc 95,138,139
za 176,192,80
zc 96,124,125
zc 97,126,127
za 176,216,84
za 156,148,76
zv
zc 98,128,129
zc 99,130,131
za 156,172,80
za 156,196,84
za 160,152,76
zv
zk 176,25,17408
za 160,176,80
zbl
zk 156,25,12288
za 160,200,84
s_branch Lf10_ayR9
Lf10_ayE2:
Lf10_aqH0:
zu 19
s_barrier
Lf10_aqG0:
zct
s_cbranch_scc1 Lf10_aqS0
zcf
s_cbranch_scc0 Lf10_aqRb0
zaa 21,9,6
zaa 22,12,6
zab 140,15,3
zab 141,15,5
zab 142,18,3
zab 143,18,5
zo 100,21
zo 102,22
zb 104,21,16
zb 106,22,16
zb 108,21,64
zb 110,22,64
zb 112,21,80
zb 114,22,80
zb 116,21,128
zb 118,22,128
zb 120,21,144
zb 122,22,144
zu 13
zo 148,1
zb 150,1,1536
zo 152,2
zb 154,2,1536
zb 156,1,64
zb 158,1,1600
zb 160,2,64
zb 162,2,1600
zb 164,1,128
zb 166,1,1664
zb 168,2,128
zb 170,2,1664
zu 7
zb 172,1,6144
zb 174,1,7680
zb 176,2,6144
zb 178,2,7680
zb 180,1,6208
zb 182,1,7744
zb 184,2,6208
zb 186,2,7744
zb 188,1,6272
ze 15
zh 124,100,140
zb 190,1,7808
zb 192,2,6272
zb 194,2,7808
zh 128,104,140
zh 132,108,140
zh 136,112,140
zam
zc 76,124,125
zc 77,126,127
zam
zc 78,128,129
zc 79,130,131
zh 124,116,140
zc 80,132,133
zc 81,134,135
zc 82,136,137
zc 83,138,139
zh 128,120,140
zb0
zc 84,124,125
zc 85,126,127
zb0
zc 86,128,129
zc 87,130,131
Lf10_aqE2:
s_branch Lf10_atH0
Lf10_atH0:
Lf10_atG0:
zd6
s_cbranch_scc1 Lf10_atS0
zda
s_cbranch_scc0 Lf10_atRb0
ze 15
zh 220,148,76
zac 21,9,6
zac 22,12,6
zad 140,15,3
zh 224,152,76
zo 100,21
zo 102,22
zb 104,21,16
zp 0,156,76
zb 106,22,16
zb 108,21,64
zb 110,22,64
zp 4,160,76
ze 15
zb 112,21,80
zb 114,22,80
zb 116,21,128
zp 8,164,76
zb 118,22,128
zb 120,21,144
zb 122,22,144
zp 12,168,76
zad 141,15,5
zad 142,18,3
zad 143,18,5
zf 220,172,80
zu 1
zb 196,1,12288
zb 198,1,13824
zb 200,2,12288
ze 15
zf 224,176,80
ze 13
zb 202,2,13824
zb 204,1,12352
zb 206,1,13888
zh 124,100,140
ze 14
zb 208,2,12352
zb 210,2,13888
zb 212,1,12416
zh 128,104,140
ze 15
zb 214,1,13952
zb 216,2,12416
zb 218,2,13952
zh 132,108,140
zf1
zcv
zcw 0xdf
zbt 0xa800
zdd 0x9000
zc 88,124,125
zc 89,126,127
ze 12
zh 136,112,140
zc 90,128,129
zc 91,130,131
zh 124,116,140
zc 92,132,133
zc 93,134,135
zh 128,120,140
zam
zc 94,136,137
zc 95,138,139
za 0,180,80
zcx
zv
zae 25
za 4,184,80
zc 96,124,125
zc 97,126,127
za 8,188,80
zc 98,128,129
zc 99,130,131
za 12,192,80
zan 0x400
zv
zae 26
ze 0
zf 220,196,84
zan 0x800
zv
zae 27
zf 224,200,84
zan 0xc00
zv
zae 28
za 0,204,84
zcy 0x3fffffff
zan 0x1000
zv
zae 29
zcz
za 4,208,84
za 8,212,84
za 12,216,84
Lf10_atH1:
Lf10_atG1:
zd7
s_cbranch_scc1 Lf10_atS1
zdb
s_cbranch_scc0 Lf10_atRb1
ze 0
zh 228,148,88
zaj 21,9,6
zaj 22,12,6
zak 140,15,3
zf 228,172,92
zo 100,21
zo 102,22
zb 104,21,16
zf 228,196,96
zb 106,22,16
zb 108,21,64
zb 110,22,64
zh 232,152,88
zb 112,21,80
zb 114,22,80
zb 116,21,128
zf 232,176,92
zb 118,22,128
zb 120,21,144
zb 122,22,144
zf 232,200,96
zak 141,15,5
zak 142,18,3
zak 143,18,5
zp 16,156,88
zgj
zcv
zcw 0xdf
zbt 0xa800
zdd 0xd800
za 16,180,92
zcx
zv
zae 25
zan 0x400
zv
zae 26
ze 9
zh 124,100,140
zan 0x800
zv
zae 27
zan 0xc00
zv
zae 28
ze 1
zh 128,104,140
zcy 0x3fffffff
zan 0x1000
zv
zae 29
zcz
zh 132,108,140
zc 76,124,125
zc 77,126,127
zh 136,112,140
zc 78,128,129
zc 79,130,131
zh 124,116,140
ze 0
zv
zc 80,132,133
zc 81,134,135
zh 128,120,140
zc 82,136,137
zc 83,138,139
za 16,204,96
zc8 0x2bc00
zfi 68,35
zc 84,124,125
zp 20,160,88
zc 85,126,127
zc 86,128,129
za 20,184,92
zu 11
zc 87,130,131
zx 36,62
za 20,208,96
zr 37,62
zci 38,48
zp 24,164,88
zbs 39,33
z2 38
za 24,188,92
z2 39
zg 36,38
za 24,212,96
zg 37,39
zs 38
zp 28,168,88
zs 39
zs 36
za 28,192,92
zbr 0x12000
zdw 1
zdw 2
za 28,216,96
Lf10_atH2:
zu 6
s_barrier
Lf10_atG2:
zd8
s_cbranch_scc1 Lf10_atS2
zdc
s_cbranch_scc0 Lf10_atRb2
ze 0
zh 236,148,76
zaq 21,9,6
zaq 22,12,6
zar 140,15,3
zar 141,15,5
zf 236,172,80
zo 100,21
zo 102,22
zb 104,21,16
zb 106,22,16
zf 236,196,84
zb 108,21,64
zb 110,22,64
zb 112,21,80
zb 114,22,80
zh 240,152,76
zb 116,21,128
zb 118,22,128
zb 120,21,144
zb 122,22,144
zf 240,176,80
zf2 32,35
z6 0x3000
zc7 0x3000
z0 42
zar 142,18,3
zar 143,18,5
zf 240,200,84
zn 43,1024
zn 53,2048
zp 32,156,76
ze 10
zs 37
zq 38,39
zq 36,37
zh 124,100,140
ze 8
zr 37,36
zav 36,38
zaw 36
zh 128,104,140
ze 4
z3 45,37
z3 44,36
z4 47,37,45
zh 132,108,140
zc 88,124,125
zc 89,126,127
z4 46,36,44
zh 136,112,140
ze 0
zc 90,128,129
zc 91,130,131
zci 38,48
zh 124,116,140
zc 92,132,133
zc 93,134,135
z2 38
zh 128,120,140
zc 94,136,137
zc 95,138,139
zd1 39,49
za 32,180,80
zc 96,124,125
zc 97,126,127
zd2 38,39
za 32,204,84
zc 98,128,129
zc 99,130,131
zax 47
zp 36,160,76
z5 36,46
z5 37,47
zd3 40,44,49,38
za 36,184,80
zay 41,45,50
zw 38,36,37
zaz 36,47
za 36,208,84
za0 37,46
zw 39,46,47
za1 41,45
zp 40,164,76
za2 41,51
za3 36,37
zas 37
za 40,188,80
za4 41,40
zq 38,39
zq 36,37
za 40,212,84
za5 37,52
zca 40,44
zcb 39
zp 44,168,76
za6 10,41
z8 16,38,7
z8 19,36,7
za 44,192,80
zcc
zau 13,37,10
zcd
zce
za 44,216,84
Lf10_atH3:
Lf10_atG3:
zdt
s_cbranch_scc1 Lf10_atS3
zc5
s_cbranch_scc0 Lf10_atRb3
ze 0
zh 244,148,88
zaa 21,10,6
zaa 22,13,6
zab 140,16,3
zf 244,172,92
zo 100,21
zo 102,22
zb 104,21,16
zf 244,196,96
zb 106,22,16
zb 108,21,64
zb 110,22,64
zh 248,152,88
zb 112,21,80
zb 114,22,80
zb 116,21,128
zf 248,176,92
zb 118,22,128
zb 120,21,144
zb 122,22,144
zf 248,200,96
zab 141,16,5
zab 142,19,3
zab 143,19,5
zp 48,156,88
ze5
zc6 60,35,16
z6 0x3000
zc7 0x3000
zn 42,3072
za 48,180,92
z6 0x4000
zc7 0x4000
z0 43
ze 10
zh 124,100,140
zu 7
zn 53,1024
zx 36,68
ze 6
zh 128,104,140
zr 37,68
zcl 38,48
zh 132,108,140
ze 2
zc 76,124,125
zc 77,126,127
zh 136,112,140
zbs 39,33
zc 78,128,129
za 48,204,96
zc 79,130,131
zc 80,132,133
zh 124,116,140
ze 0
zc 81,134,135
zc 82,136,137
zh 128,120,140
zc 83,138,139
z2 38
zp 52,160,88
z2 39
zc 84,124,125
za 52,184,92
zc 85,126,127
zv
zc 86,128,129
za 52,208,96
zc 87,130,131
zg 36,38
zp 56,164,88
zg 37,39
zs 38
za 56,188,92
zs 39
zs 36
za 56,212,96
zs 37
zq 38,39
zp 60,168,88
zq 36,37
zr 37,36
za 60,192,92
zav 36,38
zaw 36
za 60,216,96
Lf10_atH4:
Lf10_atG4:
zc2
s_cbranch_scc1 Lf10_atS4
zc0
s_cbranch_scc0 Lf10_atRb4
ze 0
zh 252,148,76
zac 21,10,6
zac 22,13,6
zad 140,16,3
zf 252,172,80
zo 100,21
zo 102,22
zb 104,21,16
zf 252,196,84
zb 106,22,16
zb 108,21,64
zb 110,22,64
zp 64,152,76
zb 112,21,80
zb 114,22,80
zb 116,21,128
za 64,176,80
zb 118,22,128
zb 120,21,144
zb 122,22,144
za 64,200,84
zad 141,16,5
zad 142,19,3
zad 143,19,5
zp 68,156,76
zc8 0x15e00
zc6 66,35,16
zcg
zcu
z0 42
za 68,180,80
ze 10
zn 43,1024
zn 53,2048
zh 124,100,140
ze 8
z3 45,37
z3 44,36
z4 47,37,45
zh 128,104,140
ze 5
z4 46,36,44
zcl 38,48
z2 38
zh 132,108,140
ze 1
zc 88,124,125
zc 89,126,127
zd1 39,49
zh 136,112,140
zc 90,128,129
zc 91,130,131
zd2 38,39
zh 124,116,140
ze 0
zc 92,132,133
zc 93,134,135
zax 47
zh 128,120,140
zc 94,136,137
zc 95,138,139
z5 36,46
za 68,204,84
zc 96,124,125
zc 97,126,127
z5 37,47
zp 72,160,76
zc 98,128,129
zc 99,130,131
zd3 40,44,49,38
za 72,184,80
zay 41,45,50
zw 38,36,37
zaz 36,47
za 72,208,84
za0 37,46
zw 39,46,47
za1 41,45
zex 76,164
za2 41,51
za3 36,37
za 76,188,80
zas 37
za4 41,40
za 76,212,84
zq 38,39
zq 36,37
zp 80,168,76
za5 37,52
zcm 40,44
z7 80,192
zcn 39
za6 11,41
za 80,216,84
Lf10_atH5:
Lf10_atG5:
zey
s_cbranch_scc1 Lf10_atS5
zd4
s_cbranch_scc0 Lf10_atRb5
ze 0
zp 84,148,88
zaj 21,10,6
zaj 22,13,6
zak 140,16,3
za 84,172,92
zo 100,21
zo 102,22
zb 104,21,16
za 84,196,96
zb 106,22,16
zb 108,21,64
zb 110,22,64
zex 88,152
zb 112,21,80
zb 114,22,80
zb 116,21,128
za 88,176,92
zb 118,22,128
zb 120,21,144
zb 122,22,144
za 88,200,96
zak 141,16,5
zak 142,19,3
zak 143,19,5
zp 92,156,88
zc8 0x2bc00
zc6 72,35,16
zcg
zcu
zn 42,3072
z7 92,180
z6 0x1000
zag 0x1000
z0 43
ze 10
zh 124,100,140
ze 8
zn 53,1024
z8 17,38,7
zh 128,104,140
ze 5
z8 20,36,7
zco
zau 14,37,11
zh 132,108,140
zcp
zcq
zc 76,124,125
zc 77,126,127
ze 0
zh 136,112,140
zc 78,128,129
zc 79,130,131
zx 36,57
zh 124,116,140
zc 80,132,133
zc 81,134,135
zr 37,57
zh 128,120,140
zc 82,136,137
zc 83,138,139
zdx 38,48
za 92,204,96
zc 84,124,125
zc 85,126,127
zcj 39,33
zp 96,160,88
zc 86,128,129
zc 87,130,131
z2 38
za 96,184,92
z2 39
zg 36,38
zg 37,39
z7 96,208
zs 38
zs 39
zs 36
zp 100,164,88
zs 37
zq 38,39
zq 36,37
za 100,188,92
zr 37,36
zav 36,38
za 100,212,96
zaw 36
z3 45,37
zp 104,168,88
z3 44,36
z4 47,37,45
za 104,192,92
z4 46,36,44
zax 47
za 104,216,96
Lf10_atH6:
s_barrier
Lf10_atG6:
zez
s_cbranch_scc1 Lf10_atS6
zd5
s_cbranch_scc0 Lf10_atRb6
ze 0
zp 108,148,76
zaq 21,10,6
zaq 22,13,6
zar 140,16,3
za 108,172,80
zo 100,21
zo 102,22
zb 104,21,16
za 108,196,84
zb 106,22,16
zb 108,21,64
zb 110,22,64
zp 112,152,76
zb 112,21,80
zb 114,22,80
zb 116,21,128
za 112,176,80
zb 118,22,128
zb 120,21,144
zb 122,22,144
za 112,200,84
zar 141,16,5
zar 142,19,3
zar 143,19,5
zp 116,156,76
zn 42,2048
zn 43,3072
za 116,180,80
z6 0x2000
zag 0x2000
z0 53
ze 10
zh 124,100,140
ze 8
z5 36,46
z5 37,47
zbg 40,44,49
zh 128,104,140
ze 6
zay 41,45,50
zw 38,36,37
zaz 36,47
zh 132,108,140
ze 3
zc 88,124,125
zc 89,126,127
za0 37,46
zh 136,112,140
ze 0
zc 90,128,129
zc 91,130,131
zw 39,46,47
zh 124,116,140
zc 92,132,133
zc 93,134,135
za1 41,45
zh 128,120,140
zc 94,136,137
zc 95,138,139
za2 41,51
za 116,204,84
zc 96,124,125
zc 97,126,127
za3 36,37
zp 120,160,76
zc 98,128,129
zc 99,130,131
zas 37
za 120,184,80
za4 41,40
zq 38,39
zq 36,37
za 120,208,84
za5 37,52
zdf 40,44
zdg 39
zp 124,164,76
za6 9,41
z8 15,38,7
z8 18,36,7
za 124,188,80
zdh
zau 12,37,9
zdi
za 124,212,84
zdj
zx 36,63
zr 37,63
zfl 38,48
zp 128,168,76
zcj 39,33
z2 38
za 128,192,80
z2 39
zg 36,38
za 128,216,84
Lf10_atH7:
Lf10_atG7:
zf7
s_cbranch_scc1 Lf10_atS7
zdy
s_cbranch_scc0 Lf10_atRb7
ze 0
zp 132,148,88
zaa 21,11,6
zaa 22,14,6
zab 140,17,3
za 132,172,92
zo 100,21
zo 102,22
zb 104,21,16
za 132,196,96
zb 106,22,16
zb 108,21,64
zb 110,22,64
zp 136,152,88
zb 112,21,80
zb 114,22,80
zb 116,21,128
za 136,176,92
zb 118,22,128
zb 120,21,144
zb 122,22,144
za 136,200,96
zab 141,17,5
zab 142,20,3
zab 143,20,5
zp 140,156,88
zn 42,1024
zn 43,2048
za 140,180,92
ze 10
zn 53,3072
zg 37,39
zh 124,100,140
ze 8
zs 38
zs 39
zs 36
zh 128,104,140
ze 6
zs 37
zq 38,39
zq 36,37
zh 132,108,140
ze 3
zc 76,124,125
zc 77,126,127
zr 37,36
zh 136,112,140
ze 0
zc 78,128,129
zc 79,130,131
zav 36,38
zh 124,116,140
zc 80,132,133
zc 81,134,135
zaw 36
zh 128,120,140
zc 82,136,137
zc 83,138,139
z3 45,37
za 140,204,96
zc 84,124,125
zc 85,126,127
z3 44,36
zp 144,160,88
zc 86,128,129
zc 87,130,131
z4 47,37,45
za 144,184,92
z4 46,36,44
zax 47
z5 36,46
za 144,208,96
z5 37,47
zbg 40,44,49
zay 41,45,50
zp 148,164,88
zw 38,36,37
zaz 36,47
za0 37,46
za 148,188,92
zw 39,46,47
za1 41,45
za2 41,51
za 148,212,96
za3 36,37
zas 37
zp 152,168,88
za4 41,40
zq 38,39
za 152,192,92
zq 36,37
za5 37,52
za 152,216,96
Lf10_atH8:
Lf10_atG8:
ze7
s_cbranch_scc1 Lf10_atS8
zc1
s_cbranch_scc0 Lf10_atRb8
ze 0
zp 156,148,76
zac 21,11,6
zac 22,14,6
zad 140,17,3
zad 141,17,5
za 156,172,80
zo 100,21
zo 102,22
zb 104,21,16
zb 106,22,16
za 156,196,84
zb 108,21,64
zb 110,22,64
zb 112,21,80
zb 114,22,80
zp 160,152,76
zb 116,21,128
zb 118,22,128
zb 120,21,144
zb 122,22,144
za 160,176,80
zad 142,20,3
zad 143,20,5
zca 40,44
zcb 39
za 160,200,84
za6 10,41
z8 16,38,7
z8 19,36,7
zcc
zp 164,156,76
zu 21
zau 13,37,10
zcd
zce
zx 36,32
ze 10
zh 124,100,140
ze 8
zr 37,32
zf3 38,48
ze2 39,33
z2 38
zh 128,104,140
ze 6
z2 39
zg 36,38
zg 37,39
zc 88,124,125
zh 132,108,140
ze 2
zc 89,126,127
zs 38
zs 39
zc 90,128,129
zh 136,112,140
zc 91,130,131
zs 36
zs 37
zc 92,132,133
zh 124,116,140
ze 0
zc 93,134,135
zq 38,39
zc 94,136,137
zc 95,138,139
zh 128,120,140
zq 36,37
zr 37,36
zav 36,38
zc 96,124,125
za 164,180,80
zc 97,126,127
zaw 36
z3 45,37
zc 98,128,129
za 164,204,84
zc 99,130,131
z3 44,36
z4 47,37,45
zp 168,160,76
z4 46,36,44
zax 47
z5 36,46
za 168,184,80
z5 37,47
zbg 40,44,49
zay 41,45,50
za 168,208,84
zw 38,36,37
zaz 36,47
za0 37,46
zp 172,164,76
zw 39,46,47
za1 41,45
za2 41,51
za 172,188,80
za3 36,37
zas 37
za4 41,40
za 172,212,84
zq 38,39
zq 36,37
za5 37,52
zp 176,168,76
zcm 40,44
zcn 39
za6 11,41
z8 17,38,7
za 176,192,80
z8 20,36,7
zco
zau 14,37,11
zcp
za 176,216,84
zcq
Lf10_atH9:
zu 14
s_barrier
Lf10_atG9:
zf7
s_cbranch_scc1 Lf10_atS9
zdy
s_cbranch_scc0 Lf10_atRb9
ze 0
zp 180,148,88
zf4 8,0
zaa 21,11,6
zaa 22,14,6
zp 184,152,88
zo 100,21
zo 102,22
zb 104,21,16
zp 188,156,88
zb 106,22,16
zb 108,21,64
zb 110,22,64
zp 192,160,88
zb 112,21,80
zb 114,22,80
zb 116,21,128
zp 196,164,88
zb 118,22,128
zb 120,21,144
zb 122,22,144
zp 200,168,88
zab 140,17,3
zab 141,17,5
zab 142,20,3
za 180,172,92
zb 148,1,12288
zb 150,1,13824
zab 143,20,5
za 184,176,92
ze 12
zb 152,2,12288
zb 154,2,13824
zb 156,1,12352
zh 124,100,140
ze 13
zb 158,1,13888
zb 160,2,12352
zb 162,2,13888
zh 128,104,140
ze 14
zb 164,1,12416
zb 166,1,13952
zh 132,108,140
ze 14
zc 76,124,125
zc 77,126,127
zh 136,112,140
zb 168,2,12416
zc 78,128,129
za 188,180,92
ze 11
zc 79,130,131
zc 80,132,133
zh 124,116,140
zc 81,134,135
zc 82,136,137
zh 128,120,140
zb 170,2,13952
zc 83,138,139
za 192,184,92
za 196,188,92
zv
zc 84,124,125
zc 85,126,127
za 200,192,92
zb 172,1,30720
zc 86,128,129
zc 87,130,131
za 180,196,96
zb 174,1,32256
zb 176,2,30720
zb 178,2,32256
za 184,200,96
zb 180,1,30784
zb 182,1,32320
za 188,204,96
zb 184,2,30784
zb 186,2,32320
za 192,208,96
zb 188,1,30848
zb 190,1,32384
za 196,212,96
zb 192,2,30848
zb 194,2,32384
za 200,216,96
Lf10_atE2:
zfz
s_cbranch_scc1 Lf10_as1H0
zf0
s_cbranch_scc1 Lf10_as2H0
zde
s_cbranch_scc1 Lf10_as3H0
s_branch Lf10_as0H0
Lf10_as0H0:
Lf10_as0G0:
ze7
s_cbranch_scc1 Lf10_as0S0
zc1
s_cbranch_scc0 Lf10_as0Rb0
ze 15
zf 220,148,76
zac 21,11,6
zac 22,14,6
zad 140,17,3
zad 141,17,5
zf 224,152,76
zo 100,21
zo 102,22
zb 104,21,16
zb 106,22,16
za 0,156,76
zb 108,21,64
zb 110,22,64
zb 112,21,80
za 4,160,76
ze 15
zb 114,22,80
zb 116,21,128
zb 118,22,128
za 8,164,76
zb 120,21,144
zb 122,22,144
zad 142,20,3
za 12,168,76
ze 14
zb 204,1,49216
zb 206,1,50752
zad 143,20,5
zf 220,188,80
ze 14
zb 208,2,49216
zb 210,2,50752
zb 212,1,49280
zf 224,192,80
ze 15
zb 214,1,50816
zb 216,2,49280
zb 218,2,50816
zh 124,100,140
ze 15
zb 196,1,49152
zb 198,1,50688
zb 200,2,49152
zh 128,104,140
ze 15
zb 202,2,50688
zbr 0x12000
zbb 1
zbb 2
zh 132,108,140
zc 88,124,125
zc 89,126,127
zb2 54
zh 136,112,140
ze 12
zc 90,128,129
zc 91,130,131
zb3 54
zh 124,116,140
zc 92,132,133
zc 93,134,135
zbz 25,54
zh 128,120,140
zbc 0x5800
zbw
zbd
zc 94,136,137
zc 95,138,139
za 0,172,80
zbe
zc 76,124,125
zc 77,126,127
zal 28,54
za 4,176,80
zc 78,128,129
zc 79,130,131
ze 0
s_barrier
za 8,180,80
z6 0x3000
zag 0x3000
z0 42
zn 43,1024
za 12,184,80
zn 53,2048
zn 42,3072
zf 220,204,84
z6 0x4000
zag 0x4000
z0 43
zf 224,208,84
zbc 0x9800
zn 53,1024
zby
zbd
za 0,212,84
zbe
zal 29,54
zb5
zb6 0x1f800
za 4,216,84
zal 30,54
zb7 54
zbv 26,4
za 8,196,84
zbk 26,54
zb8
za 12,200,84
zb9 26
Lf10_as0H1:
Lf10_as0G1:
zgy
s_cbranch_scc1 Lf10_as0S1
ze6
s_cbranch_scc0 Lf10_as0Rb1
ze 0
zf 228,148,88
zaj 21,11,6
zaj 22,14,6
zf 232,152,88
zo 100,21
zo 102,22
za 16,156,88
zb 104,21,16
zb 106,22,16
za 20,160,88
zb 108,21,64
zb 110,22,64
za 24,164,88
zb 112,21,80
zb 114,22,80
za 28,168,88
zb 116,21,128
zb 118,22,128
zf 228,188,92
zb 120,21,144
zb 122,22,144
zf 232,192,92
zak 140,17,3
zak 141,17,5
za 16,172,92
zak 142,20,3
zak 143,20,5
za 20,176,92
za 24,180,92
ze 10
zh 124,100,140
ze 8
zh 128,104,140
ze 6
zh 132,108,140
ze 4
zh 136,112,140
zam
zc 84,124,125
zc 85,126,127
za 28,184,92
ze 2
zc 86,128,129
zc 87,130,131
zh 124,116,140
ze 0
zc 96,132,133
zc 97,134,135
zh 128,120,140
zc 98,136,137
zc 99,138,139
zf 228,204,76
zf 232,208,76
zc 88,124,125
zc 89,126,127
za 16,212,76
zv
zc 90,128,129
zc 91,130,131
za 20,216,76
za 24,196,76
za 28,200,76
Lf10_as0H2:
Lf10_as0G2:
zct
s_cbranch_scc1 Lf10_as0S2
zcf
s_cbranch_scc0 Lf10_as0Rb2
ze 0
zf 236,148,84
zbn
zbq 8,0
zaa 21,9,6
zaa 22,12,6
zf 240,152,84
zbo
zo 100,21
zo 102,22
zb 104,21,16
za 32,156,84
zbp
zb 106,22,16
zb 108,21,64
zb 110,22,64
za 36,160,84
zb 112,21,80
zb 114,22,80
zb 116,21,128
za 40,164,84
zb 118,22,128
zb 120,21,144
zb 122,22,144
za 44,168,84
zab 140,15,3
zab 141,15,5
zab 142,18,3
zf 236,188,96
zu 12
zo 148,1
zb 150,1,1536
zab 143,18,5
zf 240,192,96
ze 12
zo 152,2
zb 154,2,1536
zb 156,1,64
zh 124,100,140
ze 13
zb 158,1,1600
zb 160,2,64
zb 162,2,1600
zh 128,104,140
ze 14
zb 164,1,128
zb 166,1,1664
zh 132,108,140
ze 14
zc 76,124,125
zc 77,126,127
zh 136,112,140
zb 168,2,128
zc 78,128,129
za 32,172,96
ze 11
zc 79,130,131
zc 80,132,133
zh 124,116,140
zc 81,134,135
zc 82,136,137
zh 128,120,140
zb 170,2,1664
zc 83,138,139
za 36,176,96
za 40,180,96
zv
zc 84,124,125
zc 85,126,127
za 44,184,96
zu 6
zb 172,1,6144
zc 86,128,129
zc 87,130,131
zf 236,204,88
zb 174,1,7680
zb 176,2,6144
zb 178,2,7680
zf 240,208,88
zb 180,1,6208
zb 182,1,7744
za 32,212,88
zb 184,2,6208
zb 186,2,7744
za 36,216,88
zb 188,1,6272
zb 190,1,7808
za 40,196,88
zb 192,2,6272
zb 194,2,7808
za 44,200,88
Lf10_as0E2:
s_branch Lf10_amH0
Lf10_as1H0:
Lf10_as1G0:
ze7
s_cbranch_scc1 Lf10_as1S0
zc1
s_cbranch_scc0 Lf10_as1Rb0
ze 15
zf 244,156,76
zac 21,11,6
zac 22,14,6
zad 140,17,3
zad 141,17,5
zf 248,160,76
ze 14
zo 100,21
zo 102,22
zb 104,21,16
zb 106,22,16
za 48,164,76
ze 15
zb 108,21,64
zb 110,22,64
zb 112,21,80
za 52,168,76
zb 114,22,80
zb 116,21,128
zb 118,22,128
za 56,148,76
zb 120,21,144
zb 122,22,144
zad 142,20,3
za 60,152,76
ze 14
zb 212,1,49280
zb 214,1,50816
zad 143,20,5
zf 244,172,80
zb 216,2,49280
zb 218,2,50816
zb 196,1,49152
zf 248,176,80
ze 15
zb 198,1,50688
zb 200,2,49152
zb 202,2,50688
zh 124,100,140
ze 15
zb 204,1,49216
zb 206,1,50752
zb 208,2,49216
zh 128,104,140
ze 15
zb 210,2,50752
zbr 0x12000
zbb 1
zbb 2
zh 132,108,140
zc 88,124,125
zc 89,126,127
zb2 54
zh 136,112,140
ze 12
zc 90,128,129
zc 91,130,131
zb3 54
zh 124,116,140
zc 92,132,133
zc 93,134,135
zbz 25,54
zh 128,120,140
zbc 0x5800
zbw
zbd
zc 94,136,137
zc 95,138,139
za 48,180,80
zbe
zc 76,124,125
zc 77,126,127
zal 28,54
za 52,184,80
zc 78,128,129
zc 79,130,131
ze 0
s_barrier
za 56,188,80
z6 0x3000
zag 0x3000
z0 42
zn 43,1024
za 60,192,80
zn 53,2048
zn 42,3072
zf 244,212,84
z6 0x4000
zag 0x4000
z0 43
zf 248,216,84
zbc 0x9800
zn 53,1024
zby
zbd
za 48,196,84
zbe
zal 29,54
zb5
zb6 0x1f800
za 52,200,84
zal 30,54
zb7 54
zbv 26,4
za 56,204,84
zbk 26,54
zb8
za 60,208,84
zb9 26
Lf10_as1H1:
Lf10_as1G1:
zgy
s_cbranch_scc1 Lf10_as1S1
ze6
s_cbranch_scc0 Lf10_as1Rb1
ze 0
zf 252,156,88
zaj 21,11,6
zaj 22,14,6
za 64,160,88
zo 100,21
zo 102,22
za 68,164,88
zb 104,21,16
zb 106,22,16
za 72,168,88
zb 108,21,64
zb 110,22,64
za 76,148,88
zb 112,21,80
zb 114,22,80
za 80,152,88
zb 116,21,128
zb 118,22,128
zf 252,172,92
zb 120,21,144
zb 122,22,144
za 64,176,92
zak 140,17,3
zak 141,17,5
za 68,180,92
zak 142,20,3
zak 143,20,5
za 72,184,92
za 76,188,92
ze 10
zh 124,100,140
ze 8
zh 128,104,140
ze 6
zh 132,108,140
ze 4
zh 136,112,140
zam
zc 84,124,125
zc 85,126,127
za 80,192,92
ze 2
zc 86,128,129
zc 87,130,131
zh 124,116,140
ze 0
zc 96,132,133
zc 97,134,135
zh 128,120,140
zc 98,136,137
zc 99,138,139
zf 252,212,76
za 64,216,76
zc 88,124,125
zc 89,126,127
za 68,196,76
zv
zc 90,128,129
zc 91,130,131
za 72,200,76
z7 76,204
za 80,208,76
Lf10_as1H2:
Lf10_as1G2:
zct
s_cbranch_scc1 Lf10_as1S2
zcf
s_cbranch_scc0 Lf10_as1Rb2
ze 0
z7 84,156
zbn
zbq 8,0
zaa 21,9,6
zaa 22,12,6
za 88,160,84
zbo
zo 100,21
zo 102,22
zb 104,21,16
za 92,164,84
zbp
zb 106,22,16
zb 108,21,64
zb 110,22,64
za 96,168,84
zb 112,21,80
zb 114,22,80
zb 116,21,128
za 100,148,84
zb 118,22,128
zb 120,21,144
zb 122,22,144
za 104,152,84
zab 140,15,3
zab 141,15,5
zab 142,18,3
za 84,172,96
zu 12
zo 148,1
zb 150,1,1536
zab 143,18,5
za 88,176,96
ze 12
zo 152,2
zb 154,2,1536
zb 156,1,64
zh 124,100,140
ze 13
zb 158,1,1600
zb 160,2,64
zb 162,2,1600
zh 128,104,140
ze 14
zb 164,1,128
zb 166,1,1664
zh 132,108,140
ze 14
zc 76,124,125
zc 77,126,127
zh 136,112,140
zb 168,2,128
zc 78,128,129
za 92,180,96
ze 11
zc 79,130,131
zc 80,132,133
zh 124,116,140
zc 81,134,135
zc 82,136,137
zh 128,120,140
zb 170,2,1664
zc 83,138,139
z7 96,184
za 100,188,96
zv
zc 84,124,125
zc 85,126,127
za 104,192,96
zu 6
zb 172,1,6144
zc 86,128,129
zc 87,130,131
za 84,212,88
zb 174,1,7680
zb 176,2,6144
zb 178,2,7680
z7 88,216
zb 180,1,6208
zb 182,1,7744
za 92,196,88
zb 184,2,6208
zb 186,2,7744
za 96,200,88
zb 188,1,6272
zb 190,1,7808
za 100,204,88
zb 192,2,6272
zb 194,2,7808
za 104,208,88
Lf10_as1E2:
s_branch Lf10_amH0
Lf10_as2H0:
Lf10_as2G0:
ze7
s_cbranch_scc1 Lf10_as2S0
zc1
s_cbranch_scc0 Lf10_as2Rb0
ze 14
za 108,164,76
ze 12
zac 21,11,6
zac 22,14,6
zad 140,17,3
zad 141,17,5
za 112,168,76
zo 100,21
zo 102,22
zb 104,21,16
zb 106,22,16
za 116,148,76
zb 108,21,64
zb 110,22,64
zb 112,21,80
za 120,152,76
zb 114,22,80
zb 116,21,128
zb 118,22,128
za 124,156,76
zb 120,21,144
zb 122,22,144
zad 142,20,3
za 128,160,76
ze 14
zb 196,1,49152
zb 198,1,50688
zad 143,20,5
za 108,180,80
zb 200,2,49152
zb 202,2,50688
zb 204,1,49216
za 112,184,80
ze 15
zb 206,1,50752
zb 208,2,49216
zb 210,2,50752
zh 124,100,140
ze 15
zb 212,1,49280
zb 214,1,50816
zb 216,2,49280
zh 128,104,140
ze 15
zb 218,2,50816
zbr 0x12000
zbb 1
zbb 2
zh 132,108,140
zc 88,124,125
zc 89,126,127
zb2 54
zh 136,112,140
ze 12
zc 90,128,129
zc 91,130,131
zb3 54
zh 124,116,140
zc 92,132,133
zc 93,134,135
zbz 25,54
zh 128,120,140
zbc 0x5800
zbw
zbd
zc 94,136,137
zc 95,138,139
za 116,188,80
zbe
zc 96,124,125
zc 97,126,127
zal 28,54
za 120,192,80
zc 98,128,129
zc 99,130,131
ze 0
s_barrier
za 124,172,80
z6 0x3000
zag 0x3000
z0 42
zn 43,1024
za 128,176,80
zn 53,2048
zn 42,3072
za 108,196,84
z6 0x4000
zag 0x4000
z0 43
za 112,200,84
zbc 0x9800
zn 53,1024
zby
zbd
za 116,204,84
zbe
zal 29,54
zb5
zb6 0x1f800
za 120,208,84
zal 30,54
zb7 54
zbv 26,4
za 124,212,84
zbk 26,54
zb8
za 128,216,84
zb9 26
Lf10_as2H1:
Lf10_as2G1:
zct
s_cbranch_scc1 Lf10_as2S1
zcf
s_cbranch_scc0 Lf10_as2Rb1
ze 0
za 132,164,88
zbn
zbq 8,0
zaa 21,9,6
zaa 22,12,6
za 136,168,88
zbo
zo 100,21
zo 102,22
zb 104,21,16
za 140,148,88
zbp
zb 106,22,16
zb 108,21,64
zb 110,22,64
za 144,152,88
zb 112,21,80
zb 114,22,80
zb 116,21,128
za 148,156,88
zb 118,22,128
zb 120,21,144
zb 122,22,144
za 152,160,88
zab 140,15,3
zab 141,15,5
zab 142,18,3
za 132,180,92
zu 12
zo 148,1
zb 150,1,1536
zab 143,18,5
za 136,184,92
ze 12
zo 152,2
zb 154,2,1536
zb 156,1,64
zh 124,100,140
ze 13
zb 158,1,1600
zb 160,2,64
zb 162,2,1600
zh 128,104,140
ze 14
zb 164,1,128
zb 166,1,1664
zh 132,108,140
ze 14
zc 76,124,125
zc 77,126,127
zh 136,112,140
zb 168,2,128
zc 78,128,129
za 140,188,92
ze 11
zc 79,130,131
zc 80,132,133
zh 124,116,140
zc 81,134,135
zc 82,136,137
zh 128,120,140
zb 170,2,1664
zc 83,138,139
za 144,192,92
za 148,172,92
zv
zc 84,124,125
zc 85,126,127
za 152,176,92
zu 6
zb 172,1,6144
zc 86,128,129
zc 87,130,131
za 132,196,96
zb 174,1,7680
zb 176,2,6144
zb 178,2,7680
za 136,200,96
zb 180,1,6208
zb 182,1,7744
za 140,204,96
zb 184,2,6208
zb 186,2,7744
za 144,208,96
zb 188,1,6272
zb 190,1,7808
za 148,212,96
zb 192,2,6272
zb 194,2,7808
za 152,216,96
Lf10_as2E2:
s_branch Lf10_amH0
Lf10_as3H0:
Lf10_as3G0:
ze7
s_cbranch_scc1 Lf10_as3S0
zc1
s_cbranch_scc0 Lf10_as3Rb0
ze 15
za 156,148,76
zac 21,11,6
zac 22,14,6
zad 140,17,3
za 160,152,76
zo 100,21
zo 102,22
zb 104,21,16
za 164,156,76
zb 106,22,16
zb 108,21,64
zb 110,22,64
za 168,160,76
ze 15
zb 112,21,80
zb 114,22,80
zb 116,21,128
za 172,164,76
zb 118,22,128
zb 120,21,144
zb 122,22,144
za 176,168,76
ze 14
zad 141,17,5
zad 142,20,3
zad 143,20,5
za 156,188,80
ze 12
zb 204,1,49216
zb 206,1,50752
zb 208,2,49216
za 160,192,80
ze 13
zb 210,2,50752
zb 212,1,49280
zb 214,1,50816
zh 124,100,140
ze 14
zb 216,2,49280
zb 218,2,50816
zb 196,1,49152
zh 128,104,140
ze 15
zb 198,1,50688
zb 200,2,49152
zb 202,2,50688
zh 132,108,140
ze 15
zc 88,124,125
zc 89,126,127
zbr 0x12000
zbb 1
zbb 2
zh 136,112,140
ze 12
zc 90,128,129
zc 91,130,131
zh 124,116,140
zc 92,132,133
zc 93,134,135
zh 128,120,140
zv
zc 94,136,137
zc 95,138,139
za 164,172,80
zb2 54
zc 96,124,125
za 168,176,80
zc 97,126,127
zc 98,128,129
za 172,180,80
zc 99,130,131
ze 0
s_barrier
zb3 54
za 176,184,80
zbz 25,54
zbc 0x5800
zbw
zbd
za 156,204,84
zbe
zal 28,54
zbc 0x9800
za 160,208,84
zby
zbd
zbe
za 164,212,84
zal 29,54
zb5
za 168,216,84
zb6 0x1f800
zal 30,54
zb7 54
zbv 26,4
za 172,196,84
zbk 26,54
zb8
za 176,200,84
zb9 26
Lf10_as3H1:
Lf10_as3G1:
zct
s_cbranch_scc1 Lf10_as3S1
zcf
s_cbranch_scc0 Lf10_as3Rb1
ze 0
za 180,148,88
zbn
zbq 8,0
zaa 21,9,6
zaa 22,12,6
za 184,152,88
zbo
zo 100,21
zo 102,22
zb 104,21,16
za 188,156,88
zbp
zb 106,22,16
zb 108,21,64
zb 110,22,64
za 192,160,88
zb 112,21,80
zb 114,22,80
zb 116,21,128
za 196,164,88
zb 118,22,128
zb 120,21,144
zb 122,22,144
za 200,168,88
zab 140,15,3
zab 141,15,5
zab 142,18,3
za 180,188,92
zu 6
zo 148,1
zb 150,1,1536
zab 143,18,5
za 184,192,92
ze 12
zo 152,2
zb 154,2,1536
zb 156,1,64
zh 124,100,140
ze 13
zb 158,1,1600
zb 160,2,64
zb 162,2,1600
zh 128,104,140
ze 14
zb 164,1,128
zb 166,1,1664
zh 132,108,140
ze 14
zc 76,124,125
zc 77,126,127
zh 136,112,140
zb 168,2,128
zc 78,128,129
za 188,172,92
ze 11
zc 79,130,131
zc 80,132,133
zh 124,116,140
zc 81,134,135
zc 82,136,137
zh 128,120,140
zb 170,2,1664
zc 83,138,139
za 192,176,92
za 196,180,92
zv
zc 84,124,125
zc 85,126,127
za 200,184,92
zu 0
zb 172,1,6144
zc 86,128,129
zc 87,130,131
za 180,204,96
zb 174,1,7680
zb 176,2,6144
zb 178,2,7680
za 184,208,96
zb 180,1,6208
zb 182,1,7744
za 188,212,96
zb 184,2,6208
zb 186,2,7744
za 192,216,96
zb 188,1,6272
zb 190,1,7808
zdm 196,96
zb 192,2,6272
zb 194,2,7808
zdm 200,96
Lf10_as3E2:
s_branch Lf10_amH0
Lf10_amS0:
ze8
s_cbranch_scc0 Lf10_amY0
ze9
zap 0x5780
zao
s_call_b64 s[88:89], Lf10_far
s_branch Lf10_amXb0
Lf10_amY0:
zac 21,9,6
zac 22,12,6
za9 23,15
za9 24,18
s_call_b64 s[88:89], Lf10_four
Lf10_amXb0:
ze 15
zf 220,148,76
ze3
zd 88,100
zd 89,101
zf 224,152,76
zed
zd 90,102
zd 91,103
za 0,156,76
zee 0x4800
zd 92,104
zd 93,105
za 4,160,76
zef
zd 94,106
zd 95,107
ze 8
za 8,164,76
zeg
zd 96,108
zd 97,109
za 12,168,76
zeh 0x1200
zd 98,110
zd 99,111
zf 220,172,80
zei
zu 0
zb 196,1,12288
zb 198,1,13824
zf 224,176,80
zej 0xd0
zb 200,2,12288
zb 202,2,13824
ze 4
za 0,180,80
zek 0x12d0
zb 204,1,12352
zb 206,1,13888
za 4,184,80
zel
zb 208,2,12352
zb 210,2,13888
za 8,188,80
zem
zb 212,1,12416
zb 214,1,13952
za 12,192,80
zb 216,2,12416
zb 218,2,13952
zx 36,69
zr 37,69
zd 69,70
zd 70,71
zd 71,72
zen
zeo
ze 10
zf 220,196,84
ze 8
zf 224,200,84
ze 6
za 0,204,84
ze 4
za 4,208,84
ze 2
za 8,212,84
ze 0
za 12,216,84
s_branch Lf10_amH1
Lf10_amS1:
zfa
s_cbranch_scc0 Lf10_amY1
zfb
zap 0xaf00
zao
s_call_b64 s[88:89], Lf10_far
s_branch Lf10_amXb1
Lf10_amY1:
zaj 21,9,6
zaj 22,12,6
zbm 23,15
zbm 24,18
s_call_b64 s[88:89], Lf10_four
Lf10_amXb1:
zf 228,148,88
ze 0
zd 76,100
zd 77,101
zd 78,102
zf 228,172,92
zd 79,103
zd 80,104
zd 81,105
zf 228,196,96
zd 82,106
zd 83,107
zf 232,152,88
zd 84,108
zd 85,109
zf 232,176,92
zd 86,110
zd 87,111
zf 232,200,96
zcg
zcu
z0 42
za 16,156,88
zn 43,1024
za 16,180,92
zd 72,73
zcl 38,48
za 16,204,96
zbs 39,33
z2 38
za 20,160,88
z2 39
zg 36,38
za 20,184,92
zg 37,39
zs 38
za 20,208,96
zs 39
zs 36
za 24,164,88
zs 37
zq 38,39
za 24,188,92
zq 36,37
zr 37,36
za 24,212,96
zav 36,38
zaw 36
za 28,168,88
z3 45,37
z3 44,36
za 28,192,92
z4 47,37,45
za 28,216,96
s_branch Lf10_amH2
Lf10_amS2:
zfc
s_cbranch_scc0 Lf10_amY2
zfd
zap 0x10680
zao
s_call_b64 s[88:89], Lf10_far
s_branch Lf10_amXb2
Lf10_amY2:
zaq 21,9,6
zaq 22,12,6
zbu 23,15
zbu 24,18
s_call_b64 s[88:89], Lf10_four
Lf10_amXb2:
ze 0
zf 236,148,76
zd 88,100
zd 89,101
zd 90,102
zf 236,172,80
zd 91,103
zd 92,104
zf 236,196,84
zd 93,105
zd 94,106
zf 240,152,76
zd 95,107
zd 96,108
zf 240,176,80
zd 97,109
zd 98,110
zf 240,200,84
zn 53,2048
zd 99,111
za 32,156,76
zn 42,3072
za 32,180,80
z6 0x1000
zag 0x1000
z0 43
za 32,204,84
z4 46,36,44
zax 47
za 36,160,76
z5 36,46
z5 37,47
za 36,184,80
zbg 40,44,49
zay 41,45,50
za 36,208,84
zw 38,36,37
zaz 36,47
za 40,164,76
za0 37,46
zw 39,46,47
za 40,188,80
za1 41,45
za2 41,51
za 40,212,84
za3 36,37
zas 37
za 44,168,76
za4 41,40
zq 38,39
za 44,192,80
za 44,216,84
s_branch Lf10_amH3
Lf10_amS3:
ze1
s_cbranch_scc0 Lf10_amY3
zfe
zap 0x15e00
zao
s_call_b64 s[88:89], Lf10_far
s_branch Lf10_amXb3
Lf10_amY3:
zaa 21,10,6
zaa 22,13,6
za8 23,16
za8 24,19
s_call_b64 s[88:89], Lf10_four
Lf10_amXb3:
ze 0
zf 244,148,88
zd 76,100
zd 77,101
zf 244,172,92
zd 78,102
zd 79,103
zf 244,196,96
zd 80,104
zd 81,105
zf 248,152,88
zd 82,106
zd 83,107
zf 248,176,92
zd 84,108
zd 85,109
zf 248,200,96
zd 86,110
zd 87,111
za 48,156,88
zn 53,1024
za 48,180,92
zn 42,2048
za 48,204,96
zq 36,37
za5 37,52
za 52,160,88
zcm 40,44
zcn 39
za 52,184,92
za6 11,41
z8 17,38,7
za 52,208,96
z8 20,36,7
zco
za 56,164,88
zau 14,37,11
zcp
za 56,188,92
zcq
zx 36,58
zr 37,58
za 56,212,96
zd 58,59
zd 59,60
za 60,168,88
zd 60,61
zdx 38,48
za 60,192,92
zcj 39,33
z2 38
za 60,216,96
s_branch Lf10_amH4
Lf10_amS4:
ze0
s_cbranch_scc0 Lf10_amY4
zfs
zap 0x1b580
zao
s_call_b64 s[88:89], Lf10_far
s_branch Lf10_amXb4
Lf10_amY4:
zac 21,10,6
zac 22,13,6
za9 23,16
za9 24,19
s_call_b64 s[88:89], Lf10_four
Lf10_amXb4:
ze 0
zf 252,148,76
zd 88,100
zd 89,101
zd 90,102
zf 252,172,80
zd 91,103
zd 92,104
zf 252,196,84
zd 93,105
zd 94,106
za 64,152,76
zd 95,107
zd 96,108
za 64,176,80
zd 97,109
zd 98,110
za 64,200,84
zn 43,3072
zd 99,111
za 68,156,76
z6 0x2000
zag 0x2000
z0 53
za 68,180,80
zn 42,1024
za 68,204,84
z2 39
zg 36,38
za 72,160,76
zg 37,39
zs 38
za 72,184,80
zs 39
zs 36
za 72,208,84
zs 37
zq 38,39
z7 76,164
zq 36,37
zr 37,36
za 76,188,80
zav 36,38
zaw 36
za 76,212,84
z3 45,37
z3 44,36
za 80,168,76
z4 47,37,45
z4 46,36,44
z7 80,192
za 80,216,84
s_branch Lf10_amH5
Lf10_amS5:
zft
s_cbranch_scc0 Lf10_amY5
zfu
zap 0x20d00
zao
s_call_b64 s[88:89], Lf10_far
s_branch Lf10_amXb5
Lf10_amY5:
zaj 21,10,6
zaj 22,13,6
zbm 23,16
zbm 24,19
s_call_b64 s[88:89], Lf10_four
Lf10_amXb5:
ze 0
za 84,148,88
zd 76,100
zd 77,101
zd 78,102
za 84,172,92
zd 79,103
zd 80,104
za 84,196,96
zd 81,105
zd 82,106
z7 88,152
zd 83,107
zd 84,108
za 88,176,92
zd 85,109
zd 86,110
za 88,200,96
zn 43,2048
zd 87,111
za 92,156,88
zn 53,3072
z7 92,180
zax 47
z5 36,46
za 92,204,96
z5 37,47
zbg 40,44,49
za 96,160,88
zay 41,45,50
zw 38,36,37
za 96,184,92
zaz 36,47
za0 37,46
z7 96,208
zw 39,46,47
za1 41,45
za 100,164,88
za2 41,51
za3 36,37
za 100,188,92
zas 37
za4 41,40
za 100,212,96
zq 38,39
zq 36,37
za 104,168,88
za5 37,52
zdf 40,44
za 104,192,92
zdg 39
za 104,216,96
s_branch Lf10_amH6
Lf10_amS6:
zfv
s_cbranch_scc0 Lf10_amY6
zfw
zap 0x26480
zao
s_call_b64 s[88:89], Lf10_far
s_branch Lf10_amXb6
Lf10_amY6:
zaq 21,10,6
zaq 22,13,6
zbu 23,16
zbu 24,19
s_call_b64 s[88:89], Lf10_four
Lf10_amXb6:
ze 0
za 108,148,76
zd 88,100
zd 89,101
za 108,172,80
zd 90,102
zd 91,103
za 108,196,84
zd 92,104
zd 93,105
za 112,152,76
zd 94,106
zd 95,107
za 112,176,80
zd 96,108
zd 97,109
za 112,200,84
zd 98,110
zd 99,111
za 116,156,76
z6 0x3000
zag 0x3000
z0 42
za 116,180,80
zn 43,1024
za 116,204,84
zn 53,2048
za 120,160,76
za6 9,41
z8 15,38,7
za 120,184,80
z8 18,36,7
zdh
za 120,208,84
zau 12,37,9
zdi
za 124,164,76
zdj
zx 36,64
zr 37,64
za 124,188,80
zd 64,65
zd 65,66
za 124,212,84
zd 66,67
zfl 38,48
za 128,168,76
zcj 39,33
z2 38
za 128,192,80
za 128,216,84
s_branch Lf10_amH7
Lf10_amS7:
zf8
s_cbranch_scc0 Lf10_amY7
zgl
zap 0x2bc00
zao
s_call_b64 s[88:89], Lf10_far
s_branch Lf10_amXb7
Lf10_amY7:
zaa 21,11,6
zaa 22,14,6
za8 23,17
za8 24,20
s_call_b64 s[88:89], Lf10_four
Lf10_amXb7:
ze 0
za 132,148,88
zd 76,100
zd 77,101
zd 78,102
za 132,172,92
zd 79,103
zd 80,104
za 132,196,96
zd 81,105
zd 82,106
za 136,152,88
zd 83,107
zd 84,108
za 136,176,92
zd 85,109
zd 86,110
za 136,200,96
zn 42,3072
zd 87,111
za 140,156,88
z6 0x4000
zag 0x4000
z0 43
za 140,180,92
zn 53,1024
za 140,204,96
z2 39
zg 36,38
za 144,160,88
zg 37,39
zs 38
za 144,184,92
zs 39
zs 36
za 144,208,96
zs 37
zq 38,39
za 148,164,88
zq 36,37
zr 37,36
za 148,188,92
zav 36,38
zaw 36
za 148,212,96
z3 45,37
z3 44,36
za 152,168,88
z4 47,37,45
z4 46,36,44
za 152,192,92
za 152,216,96
s_branch Lf10_amH8
Lf10_amS8:
zff
s_cbranch_scc0 Lf10_amY8
zg7
zap 0x31380
zao
s_call_b64 s[88:89], Lf10_far
s_branch Lf10_amXb8
Lf10_amY8:
zac 21,11,6
zac 22,14,6
za9 23,17
za9 24,20
s_call_b64 s[88:89], Lf10_four
Lf10_amXb8:
ze 0
za 156,148,76
zd 88,100
zd 89,101
zd 90,102
za 156,172,80
zd 91,103
zd 92,104
za 156,196,84
zd 93,105
zd 94,106
za 160,152,76
zd 95,107
zd 96,108
za 160,176,80
zd 97,109
zd 98,110
za 160,200,84
zd 99,111
zax 47
za 164,156,76
z5 36,46
z5 37,47
za 164,180,80
zbg 40,44,49
zay 41,45,50
za 164,204,84
zw 38,36,37
zaz 36,47
za 168,160,76
za0 37,46
zw 39,46,47
za 168,184,80
za1 41,45
za2 41,51
za 168,208,84
za3 36,37
zas 37
za 172,164,76
za4 41,40
zq 38,39
za 172,188,80
zq 36,37
za5 37,52
za 172,212,84
zca 40,44
zcb 39
za 176,168,76
za6 10,41
z8 16,38,7
z8 19,36,7
za 176,192,80
zcc
zau 13,37,10
zcd
zce
za 176,216,84
s_branch Lf10_amH9
Lf10_amS9:
zdz
s_cbranch_scc0 Lf10_amY9
zet
zeu
zev
s_call_b64 s[88:89], Lf10_far
s_branch Lf10_amXb9
Lf10_amY9:
zaa 21,9,6
zaa 22,12,6
za8 23,15
za8 24,18
s_call_b64 s[88:89], Lf10_four
Lf10_amXb9:
ze 0
za 180,148,88
zbn
zbq 8,0
zd 76,100
zd 77,101
za 184,152,88
zbo
zd 78,102
zd 79,103
zd 80,104
za 188,156,88
zbp
zd 81,105
zd 82,106
zd 83,107
za 192,160,88
zf5
zd 84,108
zd 85,109
za 196,164,88
zd 86,110
zd 87,111
za 200,168,88
zu 12
zo 148,1
zb 150,1,1536
za 180,172,92
zo 152,2
zb 154,2,1536
za 184,176,92
zb 156,1,64
zb 158,1,1600
za 188,180,92
zb 160,2,64
zb 162,2,1600
za 192,184,92
zb 164,1,128
zb 166,1,1664
za 196,188,92
zb 168,2,128
zb 170,2,1664
za 200,192,92
zu 6
zb 172,1,6144
zb 174,1,7680
za 180,196,96
zb 176,2,6144
zb 178,2,7680
za 184,200,96
zb 180,1,6208
zb 182,1,7744
za 188,204,96
zb 184,2,6208
zb 186,2,7744
za 192,208,96
zb 188,1,6272
zb 190,1,7808
za 196,212,96
zb 192,2,6272
zb 194,2,7808
za 200,216,96
s_branch Lf10_amE2
Lf10_azS0:
ze8
s_cbranch_scc0 Lf10_azY0
ze9
zap 0x5780
zao
s_call_b64 s[88:89], Lf10_far
s_branch Lf10_azXb0
Lf10_azY0:
zac 21,9,6
zac 22,12,6
za9 23,15
za9 24,18
s_call_b64 s[88:89], Lf10_four
Lf10_azXb0:
zd 88,100
zd 89,101
zd 90,102
zd 91,103
ze 15
za 0,156,76
zd 92,104
zd 93,105
zd 94,106
zd 95,107
zd 96,108
za 4,160,76
zu 0
zb 204,1,12352
zb 206,1,13888
zd 97,109
zd 98,110
zd 99,111
ze 10
za 8,164,76
zb 208,2,12352
zb 210,2,13888
zb 212,1,12416
zb 214,1,13952
zb 216,2,12416
za 12,168,76
zb 218,2,13952
zb 196,1,12288
zb 198,1,13824
zb 200,2,12288
zb 202,2,13824
zf 220,148,76
zx 36,69
zr 37,69
zcl 38,48
zbs 39,33
zf 224,152,76
ze 12
z2 38
z2 39
zg 36,38
zg 37,39
za 0,180,80
zs 38
zs 39
zs 36
zs 37
za 4,184,80
zq 38,39
zq 36,37
zr 37,36
zav 36,38
za 8,188,80
zaw 36
z3 45,37
z3 44,36
z4 47,37,45
za 12,192,80
z4 46,36,44
zax 47
z5 36,46
z5 37,47
zf 220,172,80
zbg 40,44,49
zay 41,45,50
zw 38,36,37
zaz 36,47
zf 224,176,80
ze 0
za0 37,46
zw 39,46,47
za1 41,45
za2 41,51
za 0,204,84
za3 36,37
zas 37
za4 41,40
zq 38,39
za 4,208,84
zq 36,37
za5 37,52
zcm 40,44
zcn 39
za 8,212,84
zk 0,25,2048
za 12,216,84
zv
zk 4,25,3072
za6 11,41
zf 220,196,84
z8 17,38,7
z8 20,36,7
zco
zau 14,37,11
zcp
zf 224,200,84
zcq
s_branch Lf10_azH1
Lf10_azS1:
zfa
s_cbranch_scc0 Lf10_azY1
zfb
zap 0xaf00
zao
s_call_b64 s[88:89], Lf10_far
s_branch Lf10_azXb1
Lf10_azY1:
zaj 21,9,6
zaj 22,12,6
zbm 23,15
zbm 24,18
s_call_b64 s[88:89], Lf10_four
Lf10_azXb1:
zd 76,100
zd 77,101
zd 78,102
zd 79,103
za 16,156,88
zfo 0xffff0000
zd 80,104
zd 81,105
zd 82,106
za 16,180,92
zf6 0xffff0000
zd 83,107
zd 84,108
zd 85,109
za 16,204,96
zk 8,25,4096
zd 86,110
zd 87,111
za 20,160,88
zk 12,25,5120
za 20,184,92
zam
zk 16,25,8192
za 20,208,96
za 24,164,88
za 24,188,92
ze 1
s_barrier
za7 32,28
za 24,212,96
za7 36,29
za7 40,30
za 28,168,88
zk 20,25,9216
za 28,192,92
zb0
zk 24,25,10240
za 28,216,96
zl 44,28,1024
zl 48,29,1024
zf 228,148,88
zl 52,30,1024
zf 228,172,92
zf 228,196,96
zf 232,152,88
zv
zk 28,25,11264
zf 232,176,92
zf 232,200,96
s_branch Lf10_azH2
Lf10_azS2:
zfc
s_cbranch_scc0 Lf10_azY2
zfd
zap 0x10680
zao
s_call_b64 s[88:89], Lf10_far
s_branch Lf10_azXb2
Lf10_azY2:
zaq 21,9,6
zaq 22,12,6
zbu 23,15
zbu 24,18
s_call_b64 s[88:89], Lf10_four
Lf10_azXb2:
zd 88,100
zd 89,101
zd 90,102
zd 91,103
za 32,156,76
zd 92,104
zd 93,105
zd 94,106
zd 95,107
za 32,180,80
zd 96,108
zd 97,109
zd 98,110
zd 99,111
za 32,204,84
ze 2
zm 36,32
zg 40,220
zm 37,33
zg 41,221
za 36,160,76
zm 38,34
zg 42,222
zm 39,35
zg 43,223
za 36,184,80
zk 32,25,14336
za 36,208,84
zg 36,40
zg 37,41
zg 38,42
zg 39,43
za 40,164,76
ze 1
s_barrier
zl 32,28,6144
zc 40,36,37
zc 41,38,39
za 40,188,80
zk 36,25,15360
za 40,212,84
zl 36,29,6144
zm 48,44
zg 52,224
zm 49,45
za 44,168,76
zg 53,225
zm 50,46
zg 54,226
zm 51,47
za 44,192,80
zk 40,25,16384
za 44,216,84
zl 44,28,7168
zg 55,227
zg 48,52
zg 49,53
zf 236,148,76
zg 50,54
zg 51,55
zc 52,48,49
zc 53,50,51
zf 236,172,80
zk 44,25,17408
zf 236,196,84
zl 48,29,7168
zah 42,52,40
zah 43,53,41
zai 40,52
zf 240,152,76
zai 41,53
zf 240,176,80
zfn
zbf 40,26
zl 52,30,7168
zl 40,30,6144
zf 240,200,84
s_branch Lf10_azH3
Lf10_azS3:
ze1
s_cbranch_scc0 Lf10_azY3
zfe
zap 0x15e00
zao
s_call_b64 s[88:89], Lf10_far
s_branch Lf10_azXb3
Lf10_azY3:
zaa 21,10,6
zaa 22,13,6
za8 23,16
za8 24,19
s_call_b64 s[88:89], Lf10_four
Lf10_azXb3:
zd 76,100
zd 77,101
zd 78,102
zd 79,103
ze 6
za 48,156,88
zd 80,104
zd 81,105
zd 82,106
zd 83,107
za 48,180,92
zd 84,108
zd 85,109
zd 86,110
zd 87,111
za 48,204,96
zm 36,32
ze 0
zg 40,228
zm 37,33
zg 41,229
za 52,160,88
zm 38,34
zg 42,230
zm 39,35
zg 43,231
za 52,184,92
zk 48,25,2048
za 52,208,96
zg 36,40
zg 37,41
zg 38,42
zg 39,43
za 56,164,88
s_barrier
zl 32,28,12288
zc 40,36,37
zc 41,38,39
za 56,188,92
zk 52,25,3072
za 56,212,96
zl 36,29,12288
zm 48,44
zg 52,232
zm 49,45
za 60,168,88
zg 53,233
zm 50,46
zg 54,234
zm 51,47
za 60,192,92
zk 56,25,4096
za 60,216,96
zl 44,28,13312
zg 55,235
zg 48,52
zg 49,53
zf 244,148,88
zg 50,54
zg 51,55
zc 52,48,49
zc 53,50,51
zf 244,172,92
zk 60,25,5120
zf 244,196,96
zl 48,29,13312
zah 42,52,40
zah 43,53,41
zai 40,52
zf 248,152,88
zai 41,53
zf 248,176,92
zbh 0xa800
zbf 40,26
zl 52,30,13312
zl 40,30,12288
zf 248,200,96
s_branch Lf10_azH4
Lf10_azS4:
ze0
s_cbranch_scc0 Lf10_azY4
zfs
zap 0x1b580
zao
s_call_b64 s[88:89], Lf10_far
s_branch Lf10_azXb4
Lf10_azY4:
zac 21,10,6
zac 22,13,6
za9 23,16
za9 24,19
s_call_b64 s[88:89], Lf10_four
Lf10_azXb4:
zd 88,100
zd 89,101
zd 90,102
zd 91,103
ze 6
za 68,156,76
zd 92,104
zd 93,105
zd 94,106
zd 95,107
za 68,180,80
zd 96,108
zd 97,109
zd 98,110
zd 99,111
za 68,204,84
zm 36,32
ze 0
zg 40,236
zm 37,33
zg 41,237
za 72,160,76
zm 38,34
zg 42,238
zm 39,35
zg 43,239
za 72,184,80
zk 68,25,8192
za 72,208,84
zg 36,40
zg 37,41
zg 38,42
zg 39,43
z7 76,164
s_barrier
za7 32,28
zc 40,36,37
zc 41,38,39
za 76,188,80
zk 72,25,9216
za 76,212,84
za7 36,29
zm 48,44
zg 52,240
zm 49,45
za 80,168,76
zg 53,241
zm 50,46
zg 54,242
zm 51,47
z7 80,192
zk 76,25,10240
za 80,216,84
zl 44,28,1024
zg 55,243
zg 48,52
zg 49,53
zf 252,148,76
zg 50,54
zg 51,55
zc 52,48,49
zc 53,50,51
zf 252,172,80
zk 80,25,11264
zf 252,196,84
zl 48,29,1024
zah 42,52,40
zah 43,53,41
zai 40,52
za 64,152,76
zai 41,53
za 64,176,80
zbh 0x15000
zbf 40,26
zl 52,30,1024
za7 40,30
za 64,200,84
s_branch Lf10_azH5
Lf10_azS5:
zft
s_cbranch_scc0 Lf10_azY5
zfu
zap 0x20d00
zao
s_call_b64 s[88:89], Lf10_far
s_branch Lf10_azXb5
Lf10_azY5:
zaj 21,10,6
zaj 22,13,6
zbm 23,16
zbm 24,19
s_call_b64 s[88:89], Lf10_four
Lf10_azXb5:
zd 76,100
zd 77,101
zd 78,102
zd 79,103
ze 6
za 92,156,88
zd 80,104
zd 81,105
zd 82,106
zd 83,107
z7 92,180
zd 84,108
zd 85,109
zd 86,110
zd 87,111
za 92,204,96
zm 36,32
ze 0
zg 40,244
zm 37,33
zg 41,245
za 96,160,88
zm 38,34
zg 42,246
zm 39,35
zg 43,247
za 96,184,92
zk 92,25,14336
z7 96,208
zg 36,40
zg 37,41
zg 38,42
zg 39,43
za 100,164,88
s_barrier
zl 32,28,6144
zc 40,36,37
zc 41,38,39
za 100,188,92
zk 96,25,15360
za 100,212,96
zl 36,29,6144
zm 48,44
zg 52,248
zm 49,45
za 104,168,88
zg 53,249
zm 50,46
zg 54,250
zm 51,47
za 104,192,92
zk 100,25,16384
za 104,216,96
zl 44,28,7168
zg 55,251
zg 48,52
zg 49,53
za 84,148,88
zg 50,54
zg 51,55
zc 52,48,49
zc 53,50,51
za 84,172,92
zk 104,25,17408
za 84,196,96
zl 48,29,7168
zah 42,52,40
zah 43,53,41
zai 40,52
z7 88,152
zai 41,53
za 88,176,92
zbh 0x1f800
zbf 40,26
zl 52,30,7168
zl 40,30,6144
za 88,200,96
s_branch Lf10_azH6
Lf10_azS6:
zfv
s_cbranch_scc0 Lf10_azY6
zfw
zap 0x26480
zao
s_call_b64 s[88:89], Lf10_far
s_branch Lf10_azXb6
Lf10_azY6:
zaq 21,10,6
zaq 22,13,6
zbu 23,16
zbu 24,19
s_call_b64 s[88:89], Lf10_four
Lf10_azXb6:
zd 88,100
zd 89,101
zd 90,102
zd 91,103
ze 6
za 116,156,76
zd 92,104
zd 93,105
zd 94,106
zd 95,107
zd 96,108
za 116,180,80
zd 97,109
zd 98,110
zd 99,111
zm 36,32
ze 0
zg 40,252
za 116,204,84
zm 37,33
zg 41,253
zm 38,34
zg 42,254
zm 39,35
za 120,160,76
zam
zk 116,25,2048
zg 43,255
zg 36,40
zg 37,41
za 120,184,80
zg 38,42
zg 39,43
zc 40,36,37
zc 41,38,39
za 120,208,84
zm 48,44
z9 44,64
zg 52,44
zm 49,45
za 124,164,76
s_barrier
zl 32,28,12288
zl 36,29,12288
z9 45,65
za 124,188,80
zk 120,25,3072
za 124,212,84
zg 53,45
zm 50,46
z9 46,66
zg 54,46
za 128,168,76
zm 51,47
z9 47,67
zg 55,47
zg 48,52
za 128,192,80
zk 124,25,4096
za 128,216,84
zl 44,28,13312
zg 49,53
zg 50,54
zg 51,55
za 108,148,76
zc 52,48,49
zc 53,50,51
zah 42,52,40
zah 43,53,41
za 108,172,80
zk 128,25,5120
za 108,196,84
zl 48,29,13312
zai 40,52
zai 41,53
za 112,152,76
zbh 0x2a000
zbf 40,26
zl 52,30,13312
za 112,176,80
zl 40,30,12288
za 112,200,84
s_branch Lf10_azH7
Lf10_azS7:
zf8
s_cbranch_scc0 Lf10_azY7
zgl
zap 0x2bc00
zao
s_call_b64 s[88:89], Lf10_far
s_branch Lf10_azXb7
Lf10_azY7:
zaa 21,11,6
zaa 22,14,6
za8 23,17
za8 24,20
s_call_b64 s[88:89], Lf10_four
Lf10_azXb7:
zd 76,100
zd 77,101
zd 78,102
zd 79,103
ze 6
za 140,156,88
zd 80,104
zd 81,105
zd 82,106
zd 83,107
zd 84,108
za 140,180,92
zd 85,109
zd 86,110
zd 87,111
zm 36,32
z9 32,84
za 140,204,96
ze 0
zg 40,32
zm 37,33
z9 33,85
zg 41,33
zm 38,34
za 144,160,88
zv
zk 140,25,8192
z9 34,86
zg 42,34
zm 39,35
za 144,184,92
z9 35,87
zg 43,35
zg 36,40
zg 37,41
zg 38,42
za 144,208,96
zg 39,43
zc 40,36,37
zc 41,38,39
zm 48,44
za 148,164,88
s_barrier
za7 32,28
za7 36,29
z9 44,88
za 148,188,92
zk 144,25,9216
za 148,212,96
zg 52,44
zm 49,45
z9 45,89
zg 53,45
za 152,168,88
zm 50,46
z9 46,90
zg 54,46
zm 51,47
za 152,192,92
zk 148,25,10240
za 152,216,96
z9 47,91
zg 55,47
zg 48,52
zg 49,53
za 132,148,88
zl 44,28,1024
zg 50,54
zg 51,55
zc 52,48,49
za 132,172,92
zk 152,25,11264
za 132,196,96
zc 53,50,51
zah 42,52,40
zah 43,53,41
zai 40,52
za 136,152,88
zl 48,29,1024
zai 41,53
za 136,176,92
zbh 0x34800
zbf 40,26
zl 52,30,1024
za7 40,30
za 136,200,96
s_branch Lf10_azH8
Lf10_azS8:
zff
s_cbranch_scc0 Lf10_azY8
zg7
zap 0x31380
zao
s_call_b64 s[88:89], Lf10_far
s_branch Lf10_azXb8
Lf10_azY8:
zac 21,11,6
zac 22,14,6
za9 23,17
za9 24,20
s_call_b64 s[88:89], Lf10_four
Lf10_azXb8:
zd 88,100
zd 89,101
zd 90,102
zd 91,103
ze 6
za 164,156,76
zd 92,104
zd 93,105
zd 94,106
zd 95,107
zd 96,108
za 164,180,80
zd 97,109
zd 98,110
zd 99,111
zm 36,32
z9 32,108
za 164,204,84
ze 0
zg 40,32
zm 37,33
z9 33,109
zg 41,33
zm 38,34
za 168,160,76
zv
zk 164,25,14336
z9 34,110
zg 42,34
zm 39,35
za 168,184,80
z9 35,111
zg 43,35
zg 36,40
zg 37,41
zg 38,42
za 168,208,84
zg 39,43
zc 40,36,37
zc 41,38,39
zm 48,44
za 172,164,76
s_barrier
zl 32,28,6144
zl 36,29,6144
z9 44,112
za 172,188,80
zk 168,25,15360
za 172,212,84
zg 52,44
zm 49,45
z9 45,113
zg 53,45
za 176,168,76
zm 50,46
z9 46,114
zg 54,46
zm 51,47
za 176,192,80
zk 172,25,16384
za 176,216,84
z9 47,115
zg 55,47
zg 48,52
zg 49,53
za 156,148,76
zl 44,28,7168
zg 50,54
zg 51,55
zc 52,48,49
za 156,172,80
zk 176,25,17408
za 156,196,84
zc 53,50,51
zah 42,52,40
zah 43,53,41
zai 40,52
za 160,152,76
zl 48,29,7168
zai 41,53
za 160,176,80
zbh 0x3f000
zbf 40,26
zl 52,30,7168
zl 40,30,6144
za 160,200,84
s_branch Lf10_azH9
Lf10_ayS0:
ze8
s_cbranch_scc0 Lf10_ayY0
ze9
zap 0x5780
zao
s_call_b64 s[88:89], Lf10_far
s_branch Lf10_ayXb0
Lf10_ayY0:
zac 21,9,6
zac 22,12,6
za9 23,15
za9 24,18
s_call_b64 s[88:89], Lf10_four
Lf10_ayXb0:
zd 88,100
zd 89,101
zd 90,102
zd 91,103
ze 15
za 0,156,76
zd 92,104
zd 93,105
zd 94,106
zd 95,107
zd 96,108
za 4,160,76
zu 0
zb 204,1,12352
zb 206,1,13888
zd 97,109
zd 98,110
zd 99,111
ze 10
za 8,164,76
zb 208,2,12352
zb 210,2,13888
zb 212,1,12416
zb 214,1,13952
zb 216,2,12416
za 12,168,76
zb 218,2,13952
zb 196,1,12288
zb 198,1,13824
zb 200,2,12288
zb 202,2,13824
zf 220,148,76
zx 36,69
zr 37,69
zcl 38,48
zbs 39,33
zf 224,152,76
ze 12
z2 38
z2 39
zg 36,38
zg 37,39
za 0,180,80
zs 38
zs 39
zs 36
zs 37
za 4,184,80
zq 38,39
zq 36,37
zr 37,36
zav 36,38
za 8,188,80
zaw 36
z3 45,37
z3 44,36
z4 47,37,45
za 12,192,80
z4 46,36,44
zax 47
z5 36,46
z5 37,47
zf 220,172,80
zbg 40,44,49
zay 41,45,50
zw 38,36,37
zaz 36,47
zf 224,176,80
ze 0
za0 37,46
zw 39,46,47
za1 41,45
za2 41,51
za 0,204,84
za3 36,37
zas 37
za4 41,40
zq 38,39
za 4,208,84
zq 36,37
za5 37,52
zcm 40,44
zcn 39
za 8,212,84
zk 0,25,2048
za 12,216,84
zv
zk 4,25,3072
za6 11,41
zf 220,196,84
z8 17,38,7
z8 20,36,7
zco
zau 14,37,11
zcp
zf 224,200,84
zcq
s_branch Lf10_ayH1
Lf10_ayS1:
zfa
s_cbranch_scc0 Lf10_ayY1
zfb
zap 0xaf00
zao
s_call_b64 s[88:89], Lf10_far
s_branch Lf10_ayXb1
Lf10_ayY1:
zaj 21,9,6
zaj 22,12,6
zbm 23,15
zbm 24,18
s_call_b64 s[88:89], Lf10_four
Lf10_ayXb1:
zd 76,100
zd 77,101
zd 78,102
zd 79,103
za 16,156,88
zd 80,104
zd 81,105
zd 82,106
za 16,180,92
zd 83,107
zd 84,108
zd 85,109
za 16,204,96
zk 8,25,4096
zd 86,110
zd 87,111
za 20,160,88
zk 12,25,5120
za 20,184,92
zdl 220,25
za 20,208,96
zat 224,25,1024
za 24,164,88
zk 16,25,8192
za 24,188,92
zbl
zk 20,25,9216
za 24,212,96
ze 2
s_barrier
za 28,168,88
za 28,192,92
za 28,216,96
zf 228,148,88
zam
zk 24,25,10240
zf 228,172,92
zb0
zk 28,25,11264
zf 228,196,96
zf 232,152,88
zf 232,176,92
zf 232,200,96
zcr
zat 228,25,6144
s_branch Lf10_ayH2
Lf10_ayS2:
zfc
s_cbranch_scc0 Lf10_ayY2
zfd
zap 0x10680
zao
s_call_b64 s[88:89], Lf10_far
s_branch Lf10_ayXb2
Lf10_ayY2:
zaq 21,9,6
zaq 22,12,6
zbu 23,15
zbu 24,18
s_call_b64 s[88:89], Lf10_four
Lf10_ayXb2:
zd 88,100
zd 89,101
zd 90,102
zd 91,103
za 32,156,76
zd 92,104
zd 93,105
za 32,180,80
zd 94,106
zd 95,107
za 32,204,84
zd 96,108
zd 97,109
za 36,160,76
zd 98,110
zd 99,111
za 36,184,80
zat 232,25,7168
za 36,208,84
zk 32,25,14336
za 40,164,76
za 40,188,80
za 40,212,84
ze 1
s_barrier
zam
zk 36,25,15360
za 44,168,76
za 44,192,80
za 44,216,84
zk 40,25,16384
zf 236,148,76
zf 236,172,80
zf 236,196,84
zbl
zk 44,25,17408
zf 240,152,76
zf 240,176,80
zf 240,200,84
zat 236,25,12288
s_branch Lf10_ayH3
Lf10_ayS3:
ze1
s_cbranch_scc0 Lf10_ayY3
zfe
zap 0x15e00
zao
s_call_b64 s[88:89], Lf10_far
s_branch Lf10_ayXb3
Lf10_ayY3:
zaa 21,10,6
zaa 22,13,6
za8 23,16
za8 24,19
s_call_b64 s[88:89], Lf10_four
Lf10_ayXb3:
zd 76,100
zd 77,101
zd 78,102
zd 79,103
za 48,156,88
zd 80,104
zd 81,105
za 48,180,92
zd 82,106
zd 83,107
za 48,204,96
zd 84,108
zd 85,109
za 52,160,88
zd 86,110
zd 87,111
za 52,184,92
zat 240,25,13312
za 52,208,96
zk 48,25,2048
za 56,164,88
za 56,188,92
za 56,212,96
ze 1
s_barrier
zam
zk 52,25,3072
za 60,168,88
za 60,192,92
za 60,216,96
zk 56,25,4096
zf 244,148,88
zf 244,172,92
zf 244,196,96
zbl
zk 60,25,5120
zf 248,152,88
zf 248,176,92
zf 248,200,96
zdl 244,25
s_branch Lf10_ayH4
Lf10_ayS4:
ze0
s_cbranch_scc0 Lf10_ayY4
zfs
zap 0x1b580
zao
s_call_b64 s[88:89], Lf10_far
s_branch Lf10_ayXb4
Lf10_ayY4:
zac 21,10,6
zac 22,13,6
za9 23,16
za9 24,19
s_call_b64 s[88:89], Lf10_four
Lf10_ayXb4:
zd 88,100
zd 89,101
zd 90,102
zd 91,103
za 68,156,76
zd 92,104
zd 93,105
za 68,180,80
zd 94,106
zd 95,107
za 68,204,84
zd 96,108
zd 97,109
za 72,160,76
zd 98,110
zd 99,111
za 72,184,80
zat 248,25,1024
za 72,208,84
zk 68,25,8192
z7 76,164
za 76,188,80
za 76,212,84
ze 1
s_barrier
zam
zk 72,25,9216
za 80,168,76
z7 80,192
za 80,216,84
zk 76,25,10240
zf 252,148,76
zf 252,172,80
zf 252,196,84
zbl
zk 80,25,11264
za 64,152,76
za 64,176,80
za 64,200,84
zat 252,25,6144
s_branch Lf10_ayH5
Lf10_ayS5:
zft
s_cbranch_scc0 Lf10_ayY5
zfu
zap 0x20d00
zao
s_call_b64 s[88:89], Lf10_far
s_branch Lf10_ayXb5
Lf10_ayY5:
zaj 21,10,6
zaj 22,13,6
zbm 23,16
zbm 24,19
s_call_b64 s[88:89], Lf10_four
Lf10_ayXb5:
zd 76,100
zd 77,101
zd 78,102
zd 79,103
za 92,156,88
zd 80,104
zd 81,105
z7 92,180
zd 82,106
zd 83,107
za 92,204,96
zd 84,108
zd 85,109
za 96,160,88
zd 86,110
zd 87,111
za 96,184,92
zk 64,25,7168
z7 96,208
zk 92,25,14336
za 100,164,88
za 100,188,92
za 100,212,96
ze 1
s_barrier
zam
zk 96,25,15360
za 104,168,88
za 104,192,92
za 104,216,96
zk 100,25,16384
za 84,148,88
za 84,172,92
za 84,196,96
zbl
zk 104,25,17408
z7 88,152
za 88,176,92
za 88,200,96
zk 84,25,12288
s_branch Lf10_ayH6
Lf10_ayS6:
zfv
s_cbranch_scc0 Lf10_ayY6
zfw
zap 0x26480
zao
s_call_b64 s[88:89], Lf10_far
s_branch Lf10_ayXb6
Lf10_ayY6:
zaq 21,10,6
zaq 22,13,6
zbu 23,16
zbu 24,19
s_call_b64 s[88:89], Lf10_four
Lf10_ayXb6:
zd 88,100
zd 89,101
zd 90,102
zd 91,103
za 116,156,76
zd 92,104
zd 93,105
za 116,180,80
zd 94,106
zd 95,107
za 116,204,84
zd 96,108
zd 97,109
za 120,160,76
zd 98,110
zd 99,111
za 120,184,80
zk 88,25,13312
za 120,208,84
zk 116,25,2048
za 124,164,76
za 124,188,80
za 124,212,84
ze 1
s_barrier
zam
zk 120,25,3072
za 128,168,76
za 128,192,80
za 128,216,84
zk 124,25,4096
za 108,148,76
za 108,172,80
za 108,196,84
zbl
zk 128,25,5120
za 112,152,76
za 112,176,80
za 112,200,84
zfr 108,25
s_branch Lf10_ayH7
Lf10_ayS7:
zf8
s_cbranch_scc0 Lf10_ayY7
zgl
zap 0x2bc00
zao
s_call_b64 s[88:89], Lf10_far
s_branch Lf10_ayXb7
Lf10_ayY7:
zaa 21,11,6
zaa 22,14,6
za8 23,17
za8 24,20
s_call_b64 s[88:89], Lf10_four
Lf10_ayXb7:
zd 76,100
zd 77,101
zd 78,102
zd 79,103
za 140,156,88
zd 80,104
zd 81,105
za 140,180,92
zd 82,106
zd 83,107
za 140,204,96
zd 84,108
zd 85,109
za 144,160,88
zd 86,110
zd 87,111
za 144,184,92
zk 112,25,1024
za 144,208,96
zk 140,25,8192
za 148,164,88
za 148,188,92
za 148,212,96
ze 1
s_barrier
zam
zk 144,25,9216
za 152,168,88
za 152,192,92
za 152,216,96
zk 148,25,10240
za 132,148,88
za 132,172,92
za 132,196,96
zbl
zk 152,25,11264
za 136,152,88
za 136,176,92
za 136,200,96
zk 132,25,6144
s_branch Lf10_ayH8
Lf10_ayS8:
zff
s_cbranch_scc0 Lf10_ayY8
zg7
zap 0x31380
zao
s_call_b64 s[88:89], Lf10_far
s_branch Lf10_ayXb8
Lf10_ayY8:
zac 21,11,6
zac 22,14,6
za9 23,17
za9 24,20
s_call_b64 s[88:89], Lf10_four
Lf10_ayXb8:
zd 88,100
zd 89,101
zd 90,102
zd 91,103
za 164,156,76
zd 92,104
zd 93,105
za 164,180,80
zd 94,106
zd 95,107
za 164,204,84
zd 96,108
zd 97,109
za 168,160,76
zd 98,110
zd 99,111
za 168,184,80
zk 136,25,7168
za 168,208,84
zk 164,25,14336
za 172,164,76
za 172,188,80
za 172,212,84
ze 1
s_barrier
zam
zk 168,25,15360
za 176,168,76
za 176,192,80
za 176,216,84
zk 172,25,16384
za 156,148,76
za 156,172,80
za 156,196,84
zbl
zk 176,25,17408
za 160,152,76
za 160,176,80
za 160,200,84
zk 156,25,12288
s_branch Lf10_ayH9
Lf10_aqS0:
zdz
s_cbranch_scc0 Lf10_aqY0
s_add_u32 s90, s64, 0
s_add_u32 s91, s66, 0
zao
s_call_b64 s[88:89], Lf10_far
s_branch Lf10_aqXb0
Lf10_aqY0:
zaa 21,9,6
zaa 22,12,6
za8 23,15
za8 24,18
s_call_b64 s[88:89], Lf10_four
Lf10_aqXb0:
zd 76,100
zd 77,101
zd 78,102
zd 79,103
zd 80,104
zd 81,105
zd 82,106
zd 83,107
zd 84,108
zd 85,109
zd 86,110
zd 87,111
zu 13
zo 148,1
zb 150,1,1536
zo 152,2
zb 154,2,1536
zb 156,1,64
zb 158,1,1600
zb 160,2,64
zb 162,2,1600
zb 164,1,128
zb 166,1,1664
zb 168,2,128
zb 170,2,1664
zu 7
zb 172,1,6144
zb 174,1,7680
zb 176,2,6144
zb 178,2,7680
zb 180,1,6208
zb 182,1,7744
zb 184,2,6208
zb 186,2,7744
zb 188,1,6272
zb 190,1,7808
zb 192,2,6272
zb 194,2,7808
s_branch Lf10_aqE2
Lf10_atS0:
ze8
s_cbranch_scc0 Lf10_atY0
ze9
zap 0x5780
zao
s_call_b64 s[88:89], Lf10_far
s_branch Lf10_atXb0
Lf10_atY0:
zac 21,9,6
zac 22,12,6
za9 23,15
za9 24,18
s_call_b64 s[88:89], Lf10_four
Lf10_atXb0:
ze 15
zh 220,148,76
zd 88,100
zd 89,101
zd 90,102
zh 224,152,76
zd 91,103
zd 92,104
zd 93,105
zp 0,156,76
zd 94,106
zd 95,107
zd 96,108
zp 4,160,76
ze 14
zd 97,109
zd 98,110
zd 99,111
zp 8,164,76
zu 1
zb 196,1,12288
zb 198,1,13824
zb 200,2,12288
ze 13
zp 12,168,76
zb 202,2,13824
zb 204,1,12352
zb 206,1,13888
zf 220,172,80
ze 8
zb 208,2,12352
zb 210,2,13888
zf 224,176,80
zb 212,1,12416
zb 214,1,13952
za 0,180,80
zb 216,2,12416
zb 218,2,13952
za 4,184,80
zf1
zcv
zcw 0xdf
zbt 0xa800
zdd 0x9000
za 8,188,80
zcx
zv
zae 25
ze 12
za 12,192,80
zan 0x400
zv
zae 26
ze 9
zf 220,196,84
zan 0x800
zv
zae 27
ze 4
zf 224,200,84
zan 0xc00
zv
zae 28
za 0,204,84
zcy 0x3fffffff
zan 0x1000
zv
zae 29
zcz
za 4,208,84
ze 0
za 8,212,84
za 12,216,84
s_branch Lf10_atH1
Lf10_atS1:
zfa
s_cbranch_scc0 Lf10_atY1
zfb
zap 0xaf00
zao
s_call_b64 s[88:89], Lf10_far
s_branch Lf10_atXb1
Lf10_atY1:
zaj 21,9,6
zaj 22,12,6
zbm 23,15
zbm 24,18
s_call_b64 s[88:89], Lf10_four
Lf10_atXb1:
ze 0
zh 228,148,88
zd 76,100
zd 77,101
zd 78,102
zf 228,172,92
zd 79,103
zd 80,104
zd 81,105
zf 228,196,96
zd 82,106
zd 83,107
zd 84,108
zh 232,152,88
zd 85,109
zd 86,110
zd 87,111
zf 232,176,92
zgj
zcv
zcw 0xdf
zbt 0xa800
zdd 0xd800
zf 232,200,96
zcx
zv
zae 25
zan 0x400
zv
zae 26
zp 16,156,88
zan 0x800
zv
zae 27
za 16,180,92
zan 0xc00
zv
zae 28
za 16,204,96
zcy 0x3fffffff
zan 0x1000
zv
zae 29
zcz
zp 20,160,88
zc8 0x2bc00
zfi 68,35
zu 11
zx 36,62
za 20,184,92
zr 37,62
zci 38,48
za 20,208,96
zbs 39,33
z2 38
zp 24,164,88
z2 39
zg 36,38
za 24,188,92
zg 37,39
zs 38
za 24,212,96
zs 39
zs 36
zp 28,168,88
zbr 0x12000
zdw 1
zdw 2
za 28,192,92
za 28,216,96
s_branch Lf10_atH2
Lf10_atS2:
zfc
s_cbranch_scc0 Lf10_atY2
zfd
zap 0x10680
zao
s_call_b64 s[88:89], Lf10_far
s_branch Lf10_atXb2
Lf10_atY2:
zaq 21,9,6
zaq 22,12,6
zbu 23,15
zbu 24,18
s_call_b64 s[88:89], Lf10_four
Lf10_atXb2:
ze 0
zh 236,148,76
zd 88,100
zd 89,101
zd 90,102
zd 91,103
zf 236,172,80
zd 92,104
zd 93,105
zd 94,106
zd 95,107
zf 236,196,84
zd 96,108
zd 97,109
zd 98,110
zd 99,111
zh 240,152,76
zf2 32,35
z6 0x3000
zc7 0x3000
z0 42
zf 240,176,80
zn 43,1024
zn 53,2048
zf 240,200,84
zs 37
zq 38,39
zq 36,37
zr 37,36
zp 32,156,76
zav 36,38
zaw 36
z3 45,37
za 32,180,80
z3 44,36
z4 47,37,45
z4 46,36,44
za 32,204,84
zci 38,48
z2 38
zd1 39,49
zp 36,160,76
zd2 38,39
zax 47
z5 36,46
za 36,184,80
z5 37,47
zd3 40,44,49,38
zay 41,45,50
za 36,208,84
zw 38,36,37
zaz 36,47
za0 37,46
zp 40,164,76
zw 39,46,47
za1 41,45
za2 41,51
za 40,188,80
za3 36,37
zas 37
za4 41,40
za 40,212,84
zq 38,39
zq 36,37
za5 37,52
zp 44,168,76
zca 40,44
zcb 39
za6 10,41
z8 16,38,7
za 44,192,80
z8 19,36,7
zcc
zau 13,37,10
zcd
za 44,216,84
zce
s_branch Lf10_atH3
Lf10_atS3:
ze1
s_cbranch_scc0 Lf10_atY3
zfe
zap 0x15e00
zao
s_call_b64 s[88:89], Lf10_far
s_branch Lf10_atXb3
Lf10_atY3:
zaa 21,10,6
zaa 22,13,6
za8 23,16
za8 24,19
s_call_b64 s[88:89], Lf10_four
Lf10_atXb3:
ze 0
zh 244,148,88
zd 76,100
zd 77,101
zd 78,102
zf 244,172,92
zd 79,103
zd 80,104
zd 81,105
zf 244,196,96
zd 82,106
zd 83,107
zd 84,108
zh 248,152,88
zd 85,109
zd 86,110
zd 87,111
zf 248,176,92
ze5
zc6 60,35,16
z6 0x3000
zc7 0x3000
zn 42,3072
zf 248,200,96
z6 0x4000
zc7 0x4000
z0 43
zp 48,156,88
zn 53,1024
za 48,180,92
zu 8
zx 36,68
zr 37,68
za 48,204,96
zcl 38,48
zbs 39,33
zp 52,160,88
z2 38
z2 39
za 52,184,92
zg 36,38
zg 37,39
za 52,208,96
zs 38
zs 39
zp 56,164,88
zs 36
zs 37
za 56,188,92
zq 38,39
zq 36,37
za 56,212,96
zr 37,36
zav 36,38
zp 60,168,88
zaw 36
za 60,192,92
za 60,216,96
s_branch Lf10_atH4
Lf10_atS4:
ze0
s_cbranch_scc0 Lf10_atY4
zfs
zap 0x1b580
zao
s_call_b64 s[88:89], Lf10_far
s_branch Lf10_atXb4
Lf10_atY4:
zac 21,10,6
zac 22,13,6
za9 23,16
za9 24,19
s_call_b64 s[88:89], Lf10_four
Lf10_atXb4:
ze 0
zh 252,148,76
zd 88,100
zd 89,101
zd 90,102
zf 252,172,80
zd 91,103
zd 92,104
zd 93,105
zf 252,196,84
zd 94,106
zd 95,107
zd 96,108
zp 64,152,76
zd 97,109
zd 98,110
zd 99,111
za 64,176,80
zc8 0x15e00
zc6 66,35,16
zcg
zcu
z0 42
za 64,200,84
zn 43,1024
zn 53,2048
zp 68,156,76
z3 45,37
z3 44,36
z4 47,37,45
za 68,180,80
z4 46,36,44
zcl 38,48
z2 38
za 68,204,84
zd1 39,49
zd2 38,39
zax 47
zp 72,160,76
z5 36,46
z5 37,47
zd3 40,44,49,38
za 72,184,80
zay 41,45,50
zw 38,36,37
zaz 36,47
za 72,208,84
za0 37,46
zw 39,46,47
za1 41,45
zex 76,164
za2 41,51
za3 36,37
za 76,188,80
zas 37
za4 41,40
za 76,212,84
zq 38,39
zq 36,37
zp 80,168,76
za5 37,52
zcm 40,44
z7 80,192
zcn 39
za6 11,41
za 80,216,84
s_branch Lf10_atH5
Lf10_atS5:
zft
s_cbranch_scc0 Lf10_atY5
zfu
zap 0x20d00
zao
s_call_b64 s[88:89], Lf10_far
s_branch Lf10_atXb5
Lf10_atY5:
zaj 21,10,6
zaj 22,13,6
zbm 23,16
zbm 24,19
s_call_b64 s[88:89], Lf10_four
Lf10_atXb5:
ze 0
zp 84,148,88
zd 76,100
zd 77,101
zd 78,102
za 84,172,92
zd 79,103
zd 80,104
zd 81,105
za 84,196,96
zd 82,106
zd 83,107
zd 84,108
zex 88,152
zd 85,109
zd 86,110
zd 87,111
za 88,176,92
zc8 0x2bc00
zc6 72,35,16
zcg
zcu
zn 42,3072
za 88,200,96
z6 0x1000
zag 0x1000
z0 43
zp 92,156,88
zn 53,1024
z8 17,38,7
z7 92,180
z8 20,36,7
zco
zau 14,37,11
za 92,204,96
zcp
zcq
zx 36,57
zr 37,57
zp 96,160,88
zdx 38,48
zcj 39,33
z2 38
za 96,184,92
z2 39
zg 36,38
zg 37,39
z7 96,208
zs 38
zs 39
zs 36
zp 100,164,88
zs 37
zq 38,39
zq 36,37
za 100,188,92
zr 37,36
zav 36,38
za 100,212,96
zaw 36
z3 45,37
zp 104,168,88
z3 44,36
z4 47,37,45
za 104,192,92
z4 46,36,44
zax 47
za 104,216,96
s_branch Lf10_atH6
Lf10_atS6:
zfv
s_cbranch_scc0 Lf10_atY6
zfw
zap 0x26480
zao
s_call_b64 s[88:89], Lf10_far
s_branch Lf10_atXb6
Lf10_atY6:
zaq 21,10,6
zaq 22,13,6
zbu 23,16
zbu 24,19
s_call_b64 s[88:89], Lf10_four
Lf10_atXb6:
ze 0
zp 108,148,76
zd 88,100
zd 89,101
zd 90,102
za 108,172,80
zd 91,103
zd 92,104
zd 93,105
za 108,196,84
zd 94,106
zd 95,107
zd 96,108
zp 112,152,76
zd 97,109
zd 98,110
zd 99,111
za 112,176,80
zn 42,2048
zn 43,3072
za 112,200,84
z6 0x2000
zag 0x2000
z0 53
zp 116,156,76
z5 36,46
z5 37,47
zbg 40,44,49
za 116,180,80
zay 41,45,50
zw 38,36,37
zaz 36,47
za 116,204,84
za0 37,46
zw 39,46,47
za1 41,45
zp 120,160,76
za2 41,51
za3 36,37
zas 37
za 120,184,80
za4 41,40
zq 38,39
zq 36,37
za 120,208,84
za5 37,52
zdf 40,44
zdg 39
zp 124,164,76
za6 9,41
z8 15,38,7
z8 18,36,7
za 124,188,80
zdh
zau 12,37,9
zdi
za 124,212,84
zdj
zx 36,63
zr 37,63
zfl 38,48
zp 128,168,76
zcj 39,33
z2 38
za 128,192,80
z2 39
zg 36,38
za 128,216,84
s_branch Lf10_atH7
Lf10_atS7:
zf8
s_cbranch_scc0 Lf10_atY7
zgl
zap 0x2bc00
zao
s_call_b64 s[88:89], Lf10_far
s_branch Lf10_atXb7
Lf10_atY7:
zaa 21,11,6
zaa 22,14,6
za8 23,17
za8 24,20
s_call_b64 s[88:89], Lf10_four
Lf10_atXb7:
ze 0
zp 132,148,88
zd 76,100
zd 77,101
zd 78,102
za 132,172,92
zd 79,103
zd 80,104
zd 81,105
za 132,196,96
zd 82,106
zd 83,107
zd 84,108
zp 136,152,88
zd 85,109
zd 86,110
zd 87,111
za 136,176,92
zn 42,1024
zn 43,2048
za 136,200,96
zn 53,3072
zg 37,39
zp 140,156,88
zs 38
zs 39
zs 36
za 140,180,92
zs 37
zq 38,39
zq 36,37
za 140,204,96
zr 37,36
zav 36,38
zaw 36
zp 144,160,88
z3 45,37
z3 44,36
z4 47,37,45
za 144,184,92
z4 46,36,44
zax 47
z5 36,46
za 144,208,96
z5 37,47
zbg 40,44,49
zay 41,45,50
zp 148,164,88
zw 38,36,37
zaz 36,47
za0 37,46
za 148,188,92
zw 39,46,47
za1 41,45
za2 41,51
za 148,212,96
za3 36,37
zas 37
zp 152,168,88
za4 41,40
zq 38,39
za 152,192,92
zq 36,37
za5 37,52
za 152,216,96
s_branch Lf10_atH8
Lf10_atS8:
zff
s_cbranch_scc0 Lf10_atY8
zg7
zap 0x31380
zao
s_call_b64 s[88:89], Lf10_far
s_branch Lf10_atXb8
Lf10_atY8:
zac 21,11,6
zac 22,14,6
za9 23,17
za9 24,20
s_call_b64 s[88:89], Lf10_four
Lf10_atXb8:
ze 0
zp 156,148,76
zd 88,100
zd 89,101
zd 90,102
zd 91,103
za 156,172,80
zd 92,104
zd 93,105
zd 94,106
zd 95,107
za 156,196,84
zd 96,108
zd 97,109
zd 98,110
zd 99,111
zp 160,152,76
zca 40,44
zcb 39
za6 10,41
z8 16,38,7
za 160,176,80
z8 19,36,7
zcc
zau 13,37,10
zcd
za 160,200,84
zce
zu 21
zx 36,32
zr 37,32
zf3 38,48
ze2 39,33
zp 164,156,76
z2 38
z2 39
zg 36,38
zg 37,39
za 164,180,80
zs 38
zs 39
zs 36
zs 37
za 164,204,84
zq 38,39
zq 36,37
zr 37,36
zav 36,38
zp 168,160,76
zaw 36
z3 45,37
z3 44,36
z4 47,37,45
za 168,184,80
z4 46,36,44
zax 47
z5 36,46
z5 37,47
za 168,208,84
zbg 40,44,49
zay 41,45,50
zw 38,36,37
zaz 36,47
zp 172,164,76
za0 37,46
zw 39,46,47
za1 41,45
za2 41,51
za 172,188,80
za3 36,37
zas 37
za4 41,40
za 172,212,84
zq 38,39
zq 36,37
za5 37,52
zp 176,168,76
zcm 40,44
zcn 39
za6 11,41
z8 17,38,7
za 176,192,80
z8 20,36,7
zco
zau 14,37,11
zcp
za 176,216,84
zcq
s_branch Lf10_atH9
Lf10_atS9:
zf8
s_cbranch_scc0 Lf10_atY9
s_add_u32 s90, s78, 0
s_add_u32 s91, s79, 0
zdu
s_call_b64 s[88:89], Lf10_far
s_branch Lf10_atXb9
Lf10_atY9:
zaa 21,11,6
zaa 22,14,6
za8 23,17
za8 24,20
s_call_b64 s[88:89], Lf10_four
Lf10_atXb9:
ze 0
zp 180,148,88
zf4 8,0
zd 76,100
zd 77,101
zp 184,152,88
zd 78,102
zd 79,103
zd 80,104
zp 188,156,88
zd 81,105
zd 82,106
zd 83,107
zp 192,160,88
zd 84,108
zd 85,109
zp 196,164,88
zd 86,110
zd 87,111
zp 200,168,88
zb 148,1,12288
zb 150,1,13824
za 180,172,92
zb 152,2,12288
zb 154,2,13824
za 184,176,92
zb 156,1,12352
zb 158,1,13888
za 188,180,92
zb 160,2,12352
zb 162,2,13888
za 192,184,92
zb 164,1,12416
zb 166,1,13952
za 196,188,92
zb 168,2,12416
zb 170,2,13952
za 200,192,92
zb 172,1,30720
zb 174,1,32256
za 180,196,96
zb 176,2,30720
zb 178,2,32256
za 184,200,96
zb 180,1,30784
zb 182,1,32320
za 188,204,96
zb 184,2,30784
zb 186,2,32320
za 192,208,96
zb 188,1,30848
zb 190,1,32384
za 196,212,96
zb 192,2,30848
zb 194,2,32384
za 200,216,96
s_branch Lf10_atE2
Lf10_as0S0:
zff
s_cbranch_scc0 Lf10_as0Y0
zfg
zec 0x5780
zdu
s_call_b64 s[88:89], Lf10_far
s_branch Lf10_as0Xb0
Lf10_as0Y0:
zac 21,11,6
zac 22,14,6
za9 23,17
za9 24,20
s_call_b64 s[88:89], Lf10_four
Lf10_as0Xb0:
ze 15
zf 220,148,76
zd 88,100
zd 89,101
zd 90,102
zd 91,103
zf 224,152,76
zd 92,104
zd 93,105
zd 94,106
zd 95,107
za 0,156,76
zb 204,1,49216
zb 206,1,50752
zb 208,2,49216
za 4,160,76
ze 11
zb 210,2,50752
zb 212,1,49280
zb 214,1,50816
za 8,164,76
zb 216,2,49280
zb 218,2,50816
zb 196,1,49152
za 12,168,76
ze 11
zd 76,108
zd 77,109
zd 78,110
zf 220,188,80
ze 9
zb 198,1,50688
zb 200,2,49152
zb 202,2,50688
zd 79,111
zf 224,192,80
zbr 0x12000
zbb 1
zbb 2
zb2 54
za 0,172,80
zb3 54
zbz 25,54
zbc 0x5800
zbw
zbd
za 4,176,80
ze 0
s_barrier
z6 0x3000
zag 0x3000
z0 42
za 8,180,80
zbe
zn 43,1024
zn 53,2048
za 12,184,80
zn 42,3072
z6 0x4000
zag 0x4000
z0 43
zf 220,204,84
zn 53,1024
zal 28,54
zf 224,208,84
zbc 0x9800
zby
zbd
zbe
za 0,212,84
zal 29,54
zb5
za 4,216,84
zb6 0x1f800
zal 30,54
zb7 54
zbv 26,4
za 8,196,84
zbk 26,54
zb8
za 12,200,84
zb9 26
s_branch Lf10_as0H1
Lf10_as0S1:
zgz
s_cbranch_scc0 Lf10_as0Y1
zic
zec 0xaf00
zdu
s_call_b64 s[88:89], Lf10_far
s_branch Lf10_as0Xb1
Lf10_as0Y1:
zaj 21,11,6
zaj 22,14,6
zbm 23,17
zbm 24,20
s_call_b64 s[88:89], Lf10_four
Lf10_as0Xb1:
ze 0
zf 228,148,88
zd 84,100
zd 85,101
zf 232,152,88
zd 86,102
zd 87,103
za 16,156,88
zd 96,104
zd 97,105
za 20,160,88
zd 98,106
zd 99,107
za 24,164,88
za 28,168,88
zd 88,108
zd 89,109
zf 228,188,92
zd 90,110
zd 91,111
zf 232,192,92
za 16,172,92
za 20,176,92
za 24,180,92
za 28,184,92
zf 228,204,76
zf 232,208,76
za 16,212,76
za 20,216,76
za 24,196,76
za 28,200,76
s_branch Lf10_as0H2
Lf10_as0S2:
zdz
s_cbranch_scc0 Lf10_as0Y2
zet
zeu
zev
s_call_b64 s[88:89], Lf10_far
s_branch Lf10_as0Xb2
Lf10_as0Y2:
zaa 21,9,6
zaa 22,12,6
za8 23,15
za8 24,18
s_call_b64 s[88:89], Lf10_four
Lf10_as0Xb2:
ze 0
zf 236,148,84
zbn
zbq 8,0
zd 76,100
zd 77,101
zf 240,152,84
zbo
zd 78,102
zd 79,103
zd 80,104
za 32,156,84
zbp
zd 81,105
zd 82,106
zd 83,107
za 36,160,84
za 40,164,84
za 44,168,84
zd 84,108
zd 85,109
zd 86,110
zf 236,188,96
zu 12
zo 148,1
zb 150,1,1536
zd 87,111
zf 240,192,96
zo 152,2
zb 154,2,1536
zb 156,1,64
za 32,172,96
zb 158,1,1600
zb 160,2,64
zb 162,2,1600
za 36,176,96
zb 164,1,128
zb 166,1,1664
za 40,180,96
zb 168,2,128
zb 170,2,1664
za 44,184,96
zu 6
zb 172,1,6144
zb 174,1,7680
zf 236,204,88
zb 176,2,6144
zb 178,2,7680
zf 240,208,88
zb 180,1,6208
zb 182,1,7744
za 32,212,88
zb 184,2,6208
zb 186,2,7744
za 36,216,88
zb 188,1,6272
zb 190,1,7808
za 40,196,88
zb 192,2,6272
zb 194,2,7808
za 44,200,88
s_branch Lf10_as0E2
Lf10_as1S0:
zff
s_cbranch_scc0 Lf10_as1Y0
zfg
zec 0x5780
zdu
s_call_b64 s[88:89], Lf10_far
s_branch Lf10_as1Xb0
Lf10_as1Y0:
zac 21,11,6
zac 22,14,6
za9 23,17
za9 24,20
s_call_b64 s[88:89], Lf10_four
Lf10_as1Xb0:
ze 15
zf 244,156,76
zd 88,100
zd 89,101
zd 90,102
zd 91,103
zf 248,160,76
ze 14
zd 92,104
zd 93,105
zd 94,106
zd 95,107
za 48,164,76
ze 11
zb 212,1,49280
zb 214,1,50816
zb 216,2,49280
za 52,168,76
zb 218,2,50816
zb 196,1,49152
zb 198,1,50688
za 56,148,76
zb 200,2,49152
zb 202,2,50688
zb 204,1,49216
za 60,152,76
ze 11
zd 76,108
zd 77,109
zd 78,110
zf 244,172,80
zb 206,1,50752
zb 208,2,49216
zb 210,2,50752
zd 79,111
zf 248,176,80
zbr 0x12000
zbb 1
zbb 2
zb2 54
za 48,180,80
zb3 54
zbz 25,54
zbc 0x5800
zbw
zbd
za 52,184,80
ze 0
s_barrier
z6 0x3000
zag 0x3000
z0 42
za 56,188,80
zbe
zn 43,1024
zn 53,2048
za 60,192,80
zn 42,3072
z6 0x4000
zag 0x4000
z0 43
zf 244,212,84
zn 53,1024
zal 28,54
zf 248,216,84
zbc 0x9800
zby
zbd
zbe
za 48,196,84
zal 29,54
zb5
za 52,200,84
zb6 0x1f800
zal 30,54
zb7 54
zbv 26,4
za 56,204,84
zbk 26,54
zb8
za 60,208,84
zb9 26
s_branch Lf10_as1H1
Lf10_as1S1:
zgz
s_cbranch_scc0 Lf10_as1Y1
zic
zec 0xaf00
zdu
s_call_b64 s[88:89], Lf10_far
s_branch Lf10_as1Xb1
Lf10_as1Y1:
zaj 21,11,6
zaj 22,14,6
zbm 23,17
zbm 24,20
s_call_b64 s[88:89], Lf10_four
Lf10_as1Xb1:
ze 0
zf 252,156,88
zd 84,100
zd 85,101
za 64,160,88
zd 86,102
zd 87,103
za 68,164,88
zd 96,104
zd 97,105
za 72,168,88
zd 98,106
zd 99,107
za 76,148,88
za 80,152,88
zd 88,108
zd 89,109
zf 252,172,92
zd 90,110
zd 91,111
za 64,176,92
za 68,180,92
za 72,184,92
za 76,188,92
za 80,192,92
zf 252,212,76
za 64,216,76
za 68,196,76
za 72,200,76
z7 76,204
za 80,208,76
s_branch Lf10_as1H2
Lf10_as1S2:
zdz
s_cbranch_scc0 Lf10_as1Y2
zet
zeu
zev
s_call_b64 s[88:89], Lf10_far
s_branch Lf10_as1Xb2
Lf10_as1Y2:
zaa 21,9,6
zaa 22,12,6
za8 23,15
za8 24,18
s_call_b64 s[88:89], Lf10_four
Lf10_as1Xb2:
ze 0
z7 84,156
zbn
zbq 8,0
zd 76,100
zd 77,101
za 88,160,84
zbo
zd 78,102
zd 79,103
zd 80,104
za 92,164,84
zbp
zd 81,105
zd 82,106
zd 83,107
za 96,168,84
za 100,148,84
za 104,152,84
zd 84,108
zd 85,109
zd 86,110
za 84,172,96
zu 12
zo 148,1
zb 150,1,1536
zd 87,111
za 88,176,96
zo 152,2
zb 154,2,1536
zb 156,1,64
za 92,180,96
zb 158,1,1600
zb 160,2,64
zb 162,2,1600
z7 96,184
zb 164,1,128
zb 166,1,1664
za 100,188,96
zb 168,2,128
zb 170,2,1664
za 104,192,96
zu 6
zb 172,1,6144
zb 174,1,7680
za 84,212,88
zb 176,2,6144
zb 178,2,7680
z7 88,216
zb 180,1,6208
zb 182,1,7744
za 92,196,88
zb 184,2,6208
zb 186,2,7744
za 96,200,88
zb 188,1,6272
zb 190,1,7808
za 100,204,88
zb 192,2,6272
zb 194,2,7808
za 104,208,88
s_branch Lf10_as1E2
Lf10_as2S0:
zff
s_cbranch_scc0 Lf10_as2Y0
zfg
zec 0x5780
zdu
s_call_b64 s[88:89], Lf10_far
s_branch Lf10_as2Xb0
Lf10_as2Y0:
zac 21,11,6
zac 22,14,6
za9 23,17
za9 24,20
s_call_b64 s[88:89], Lf10_four
Lf10_as2Xb0:
ze 14
za 108,164,76
ze 12
zd 88,100
zd 89,101
zd 90,102
zd 91,103
za 112,168,76
zd 92,104
zd 93,105
zd 94,106
zd 95,107
za 116,148,76
zd 96,108
zd 97,109
zd 98,110
za 120,152,76
zb 196,1,49152
zb 198,1,50688
zd 99,111
za 124,156,76
zb 200,2,49152
zb 202,2,50688
zb 204,1,49216
za 128,160,76
ze 7
zb 206,1,50752
zb 208,2,49216
zb 210,2,50752
za 108,180,80
zb 212,1,49280
zb 214,1,50816
zb 216,2,49280
zb 218,2,50816
za 112,184,80
zbr 0x12000
zbb 1
zbb 2
zb2 54
za 116,188,80
ze 12
zb3 54
zbz 25,54
zbc 0x5800
zbw
zbd
za 120,192,80
ze 0
s_barrier
z6 0x3000
zag 0x3000
z0 42
za 124,172,80
zbe
zn 43,1024
zn 53,2048
za 128,176,80
zn 42,3072
z6 0x4000
zag 0x4000
z0 43
za 108,196,84
zn 53,1024
zal 28,54
za 112,200,84
zbc 0x9800
zby
zbd
zbe
za 116,204,84
zal 29,54
zb5
za 120,208,84
zb6 0x1f800
zal 30,54
zb7 54
zbv 26,4
za 124,212,84
zbk 26,54
zb8
za 128,216,84
zb9 26
s_branch Lf10_as2H1
Lf10_as2S1:
zdz
s_cbranch_scc0 Lf10_as2Y1
zet
zeu
zev
s_call_b64 s[88:89], Lf10_far
s_branch Lf10_as2Xb1
Lf10_as2Y1:
zaa 21,9,6
zaa 22,12,6
za8 23,15
za8 24,18
s_call_b64 s[88:89], Lf10_four
Lf10_as2Xb1:
ze 0
za 132,164,88
zbn
zbq 8,0
zd 76,100
zd 77,101
za 136,168,88
zbo
zd 78,102
zd 79,103
zd 80,104
za 140,148,88
zbp
zd 81,105
zd 82,106
zd 83,107
za 144,152,88
zd 84,108
zd 85,109
za 148,156,88
zd 86,110
zd 87,111
za 152,160,88
zu 12
zo 148,1
zb 150,1,1536
za 132,180,92
zo 152,2
zb 154,2,1536
za 136,184,92
zb 156,1,64
zb 158,1,1600
za 140,188,92
zb 160,2,64
zb 162,2,1600
za 144,192,92
zb 164,1,128
zb 166,1,1664
za 148,172,92
zb 168,2,128
zb 170,2,1664
za 152,176,92
zu 6
zb 172,1,6144
zb 174,1,7680
za 132,196,96
zb 176,2,6144
zb 178,2,7680
za 136,200,96
zb 180,1,6208
zb 182,1,7744
za 140,204,96
zb 184,2,6208
zb 186,2,7744
za 144,208,96
zb 188,1,6272
zb 190,1,7808
za 148,212,96
zb 192,2,6272
zb 194,2,7808
za 152,216,96
s_branch Lf10_as2E2
Lf10_as3S0:
zff
s_cbranch_scc0 Lf10_as3Y0
zfg
zec 0x5780
zdu
s_call_b64 s[88:89], Lf10_far
s_branch Lf10_as3Xb0
Lf10_as3Y0:
zac 21,11,6
zac 22,14,6
za9 23,17
za9 24,20
s_call_b64 s[88:89], Lf10_four
Lf10_as3Xb0:
ze 15
za 156,148,76
zd 88,100
zd 89,101
zd 90,102
za 160,152,76
zd 91,103
zd 92,104
zd 93,105
za 164,156,76
zd 94,106
zd 95,107
zd 96,108
za 168,160,76
ze 9
zd 97,109
zd 98,110
zd 99,111
za 172,164,76
zb 204,1,49216
zb 206,1,50752
zb 208,2,49216
za 176,168,76
ze 5
zb 210,2,50752
zb 212,1,49280
za 156,188,80
ze 5
zb 214,1,50816
zb 216,2,49280
za 160,192,80
zb 218,2,50816
zb 196,1,49152
za 164,172,80
zb 198,1,50688
zb 200,2,49152
zb 202,2,50688
za 168,176,80
ze 0
s_barrier
zbr 0x12000
zbb 1
zbb 2
za 172,180,80
zb2 54
zb3 54
za 176,184,80
zbz 25,54
zbc 0x5800
zbw
zbd
za 156,204,84
zbe
zal 28,54
zbc 0x9800
za 160,208,84
zby
zbd
zbe
za 164,212,84
zal 29,54
zb5
za 168,216,84
zb6 0x1f800
zal 30,54
zb7 54
zbv 26,4
za 172,196,84
zbk 26,54
zb8
za 176,200,84
zb9 26
s_branch Lf10_as3H1
Lf10_as3S1:
zdz
s_cbranch_scc0 Lf10_as3Y1
zet
zeu
zev
s_call_b64 s[88:89], Lf10_far
s_branch Lf10_as3Xb1
Lf10_as3Y1:
zaa 21,9,6
zaa 22,12,6
za8 23,15
za8 24,18
s_call_b64 s[88:89], Lf10_four
Lf10_as3Xb1:
ze 0
za 180,148,88
zbn
zbq 8,0
zd 76,100
zd 77,101
za 184,152,88
zbo
zd 78,102
zd 79,103
zd 80,104
za 188,156,88
zbp
zd 81,105
zd 82,106
zd 83,107
za 192,160,88
zd 84,108
zd 85,109
za 196,164,88
zd 86,110
zd 87,111
za 200,168,88
zu 6
zo 148,1
zb 150,1,1536
za 180,188,92
zo 152,2
zb 154,2,1536
za 184,192,92
zb 156,1,64
zb 158,1,1600
za 188,172,92
zb 160,2,64
zb 162,2,1600
za 192,176,92
zb 164,1,128
zb 166,1,1664
za 196,180,92
zb 168,2,128
zb 170,2,1664
za 200,184,92
zu 0
zb 172,1,6144
zb 174,1,7680
za 180,204,96
zb 176,2,6144
zb 178,2,7680
za 184,208,96
zb 180,1,6208
zb 182,1,7744
za 188,212,96
zb 184,2,6208
zb 186,2,7744
za 192,216,96
zb 188,1,6272
zb 190,1,7808
zdm 196,96
zb 192,2,6272
zb 194,2,7808
zdm 200,96
s_branch Lf10_as3E2
Lf10_four:
ze 0
zo 104,21
zo 106,22
zb 108,21,16
zb 110,22,16
zb 100,21,4608
zb 102,21,4816
zb 112,21,4624
zb 114,21,4832
zb 116,21,64
zb 118,22,64
zb 120,21,80
zb 122,22,80
zc3 140,23,3
zc3 141,23,5
zc3 142,24,3
zc3 143,24,5
zg0 23
zg0 24
zc3 144,24,3
zc3 145,24,5
zc3 146,23,3
ze 10
zh 124,104,140
zb 104,21,4672
zb 106,21,4880
ze 10
zh 128,108,140
zb 108,21,4688
zb 110,21,4896
ze 6
zh 132,116,140
zb 116,21,144
zb 118,22,144
ze 6
zh 136,120,140
zb 120,21,4736
zb 122,21,4944
zc3 147,23,5
zam
zf 124,100,144
zf 128,112,144
zb 112,21,128
zb 114,22,128
ze 8
zf 132,104,144
ze 6
zf 136,108,144
zb 108,21,4752
zb 110,21,4960
zc 100,124,125
zc 101,126,127
zc 102,128,129
zc 103,130,131
ze 6
zh 128,116,140
zc 104,132,133
zc 105,134,135
zc 106,136,137
zc 107,138,139
ze 2
zh 124,112,140
zf 124,120,144
ze 0
zf 128,108,144
s_nop 5
zc 108,124,125
zc 109,126,127
zc 110,128,129
zc 111,130,131
zgb
Lf10_far:
ze 0
zh6 110,4
zh7 100,110
zh8
v_mul_u32_u24 v107, 52, v4
v_sub_u32 v107, v0, v107
zh9
zgr 104,4
zia 103
zib 104
z2 104
zu 0
zx 101,100
zr 102,100
zg 101,103
zg 102,104
zs 101
zs 102
zc 100,101,102
zx 101,100
zr 102,100
z3 103,101
z3 104,102
z4 105,101,103
z4 106,102,104
z5 101,105
z5 102,106
zw 144,101,102
zw 145,101,106
zw 146,105,102
zw 147,105,106
zgf 103
zgf 104
zgg 108,103
zgg 109,104
zgh 108
zgh 109
zgi 103
zgi 108
zck 104
zck 109
ze 0
zew 140,103,104,107
zew 141,103,109,107
zew 142,108,104,107
zew 143,108,109,107
zfh 124,140
zbi 126,140,16
zbi 128,140,64
zbi 130,140,80
zbi 132,140,128
zbi 134,140,144
zu 5
zx 140,124
zw 100,144,140
zr 140,124
zw 101,144,140
zx 140,125
zw 102,144,140
zr 140,125
zw 103,144,140
zu 4
zx 140,126
zw 104,144,140
zr 140,126
zw 105,144,140
zx 140,127
zw 106,144,140
zr 140,127
zw 107,144,140
zu 3
zx 140,128
zw 108,144,140
zr 140,128
zw 109,144,140
zx 140,129
zw 110,144,140
zr 140,129
zw 111,144,140
zu 2
zx 140,130
zw 112,144,140
zr 140,130
zw 113,144,140
zx 140,131
zw 114,144,140
zr 140,131
zw 115,144,140
zu 1
zx 140,132
zw 116,144,140
zr 140,132
zw 117,144,140
zx 140,133
zw 118,144,140
zr 140,133
zw 119,144,140
zu 0
zx 140,134
zw 120,144,140
zr 140,134
zw 121,144,140
zx 140,135
zw 122,144,140
zr 140,135
zw 123,144,140
zfh 124,141
zbi 126,141,16
zbi 128,141,64
zbi 130,141,80
zbi 132,141,128
zbi 134,141,144
zu 5
zx 141,124
zy 100,145,141
zr 141,124
zy 101,145,141
zx 141,125
zy 102,145,141
zr 141,125
zy 103,145,141
zu 4
zx 141,126
zy 104,145,141
zr 141,126
zy 105,145,141
zx 141,127
zy 106,145,141
zr 141,127
zy 107,145,141
zu 3
zx 141,128
zy 108,145,141
zr 141,128
zy 109,145,141
zx 141,129
zy 110,145,141
zr 141,129
zy 111,145,141
zu 2
zx 141,130
zy 112,145,141
zr 141,130
zy 113,145,141
zx 141,131
zy 114,145,141
zr 141,131
zy 115,145,141
zu 1
zx 141,132
zy 116,145,141
zr 141,132
zy 117,145,141
zx 141,133
zy 118,145,141
zr 141,133
zy 119,145,141
zu 0
zx 141,134
zy 120,145,141
zr 141,134
zy 121,145,141
zx 141,135
zy 122,145,141
zr 141,135
zy 123,145,141
zfh 124,142
zbi 126,142,16
zbi 128,142,64
zbi 130,142,80
zbi 132,142,128
zbi 134,142,144
zu 5
zx 142,124
zy 100,146,142
zr 142,124
zy 101,146,142
zx 142,125
zy 102,146,142
zr 142,125
zy 103,146,142
zu 4
zx 142,126
zy 104,146,142
zr 142,126
zy 105,146,142
zx 142,127
zy 106,146,142
zr 142,127
zy 107,146,142
zu 3
zx 142,128
zy 108,146,142
zr 142,128
zy 109,146,142
zx 142,129
zy 110,146,142
zr 142,129
zy 111,146,142
zu 2
zx 142,130
zy 112,146,142
zr 142,130
zy 113,146,142
zx 142,131
zy 114,146,142
zr 142,131
zy 115,146,142
zu 1
zx 142,132
zy 116,146,142
zr 142,132
zy 117,146,142
zx 142,133
zy 118,146,142
zr 142,133
zy 119,146,142
zu 0
zx 142,134
zy 120,146,142
zr 142,134
zy 121,146,142
zx 142,135
zy 122,146,142
zr 142,135
zy 123,146,142
zfh 124,143
zbi 126,143,16
zbi 128,143,64
zbi 130,143,80
zbi 132,143,128
zbi 134,143,144
zu 5
zx 143,124
zy 100,147,143
zr 143,124
zy 101,147,143
zx 143,125
zy 102,147,143
zr 143,125
zy 103,147,143
zu 4
zx 143,126
zy 104,147,143
zr 143,126
zy 105,147,143
zx 143,127
zy 106,147,143
zr 143,127
zy 107,147,143
zu 3
zx 143,128
zy 108,147,143
zr 143,128
zy 109,147,143
zx 143,129
zy 110,147,143
zr 143,129
zy 111,147,143
zu 2
zx 143,130
zy 112,147,143
zr 143,130
zy 113,147,143
zx 143,131
zy 114,147,143
zr 143,131
zy 115,147,143
zu 1
zx 143,132
zy 116,147,143
zr 143,132
zy 117,147,143
zx 143,133
zy 118,147,143
zr 143,133
zy 119,147,143
zu 0
zx 143,134
zy 120,147,143
zr 143,134
zy 121,147,143
zx 143,135
zy 122,147,143
zr 143,135
zy 123,147,143
zq 100,101
zc 101,102,103
zc 102,104,105
zc 103,106,107
zc 104,108,109
zc 105,110,111
zc 106,112,113
zc 107,114,115
zc 108,116,117
zc 109,118,119
zc 110,120,121
zc 111,122,123
zgb
Lf9_start:
zhf 124,0
zhr 0x4800
s_add_u32 s73, s73, 0x11000
s_mul_i32 s81, s21, 0xe0
s_add_u32 s81, s81, s22
s_mul_i32 s93, s81, 0xc0
s_mul_i32 s77, s81, 0x64
zhb 125,124
zhc 126,124
zgd 128,124
v_and_b32 v130, 12, v124
zgu 127,130,126
v_add_u32 v48, s21, v128
v_add_u32 v33, s22, v127
zh4 129,128
zh5 130,127
zgu 35,129,130
s_mul_i32 s25, s20, 13
s_lshr_b32 s25, s25, 1
zed
zee 0x4800
zef
zeg
zeh 0x1200
zei
zej 0xd0
zek 0x12d0
zel
zem
zen
zeo
zbn
zbo
zbp
zhg 0x930000
zhh 0x20000
zhi 0x20000
zha 0x70880
zhj 0x20000
zhk 0x20000
zhw
zhz 0x1200
s_sub_u32 s85, s21, 3
s_add_u32 s85, s85, s20
s_add_u32 s97, s85, 0
zcv
zcw 0xdf
zbt 0xa800
s_add_u32 s42, s35, 0
ze2 129,124
zep 130,129
zd9 130
zeq 25,130
zd0 129,25
zer 129
zea 130
zes 130
zeb 130
zck 130
zbk 130,129
zc9 129,0x40000000
zcs 25,130,129
ze 0
zhl 0xffff
zhp 0xffff
zcx
zv
zae 25
ze5
zfi 56,35
zhs 129,124
zep 130,129
zd9 130
zeq 26,130
zd0 129,26
zer 129
zea 130
zes 130
zeb 130
zck 130
zbk 130,129
zc9 129,0x40000000
zcs 26,130,129
zan 0x400
zv
zae 26
zht 129,124
zep 130,129
zd9 130
zeq 27,130
zd0 129,27
zer 129
zea 130
zes 130
zeb 130
zck 130
zbk 130,129
zc9 129,0x40000000
zcs 27,130,129
zan 0x800
zv
zae 27
v_add_u32 v129, 0xc0, v124
zep 130,129
zd9 130
zeq 28,130
zd0 129,28
zer 129
zea 130
zes 130
zeb 130
zck 130
zbk 130,129
zc9 129,0x40000000
zcs 28,130,129
zan 0xc00
zv
zae 28
v_add_u32 v129, 0x100, v124
zep 130,129
zd9 130
zeq 29,130
zd0 129,29
zer 129
zea 130
zes 130
zeb 130
zck 130
zbk 130,129
zc9 129,0x40000000
zcs 29,130,129
zcy 0x3fffffff
zan 0x1000
zv
zae 29
zcz
s_add_u32 s97, s85, 4
zcv
zcw 0xdf
zbt 0xa800
zdd 0x4800
zcx
zv
zae 25
zan 0x400
zv
zae 26
zan 0x800
zv
zae 27
zan 0xc00
zv
zae 28
zcy 0x3fffffff
zan 0x1000
zv
zae 29
zcz
zhm 0x80
zhn
zho 0xffff
zhq 0xffff
zde
s_cselect_b32 s82, 0, s20
s_lshl_b32 s83, s82, 6
s_add_u32 s83, s83, 0x80
s_mul_i32 s82, s82, 5
s_lshr_b32 s82, 0x5880, s82
zh0 129,124
v_lshl_add_u32 v130, v124, 4, s83
v_lshl_add_u32 v129, v129, 4, s83
zgr 127,124
v_mul_u32_u24 v128, 0x56, v127
v_lshrrev_b32 v128, 8, v128
v_mad_i32_i24 v127, v128, -3, v127
v_cmp_le_u32 vcc, 48, v124
zam
zcs 42,130,129
v_cmp_gt_u32 vcc, 32, v124
zam
zcs 43,130,129
v_cmp_le_u32 vcc, 16, v124
zam
zcs 53,130,129
s_mov_b32 s84, 0xffffff40
zfx 128,127
zfy 42,128
zgv
zfx 128,127
zfy 43,128
zgv
zfx 128,127
zfy 53,128
zcg
zcu
z0 42
zn 43,1024
zn 53,2048
zn 42,3072
z6 0x1000
zag 0x1000
z0 43
zn 53,1024
zn 42,2048
zn 43,3072
z6 0x2000
zag 0x2000
z0 53
zn 42,1024
zn 43,2048
zn 53,3072
z6 0x3000
zag 0x3000
z0 42
zn 43,1024
zn 53,2048
zn 42,3072
z6 0x4000
zag 0x4000
z0 43
zn 53,1024
zc8 0x15e00
zfi 62,35
zhd 127,124
zgd 128,124
zfk 131,126
zg3 4,125
zh1 0x435f0000
zgc 130,126
zgp 0,131
zgn 0,130
v_mul_u32_u24 v129, 0xd0, v125
v_add_u32 v0, v129, v0
zf9 129,130
zg2 129,131
zhe 129,127
zck 129
zgq 130,128,131
zbk 129,130
v_add_u32 v129, s73, v129
zfk 130,128
zh2 1,130,129
zh3 2,1
s_mov_b32 s3, 0
zfz
s_cselect_b32 s3, 3, s3
zf0
s_cselect_b32 s3, 5, s3
zde
s_cselect_b32 s3, 7, s3
s_mov_b32 s78, s3
s_mul_i32 s79, s3, 0x5780
s_add_u32 s79, s79, s77
s_add_u32 s79, s79, 48
s_mul_i32 s94, s3, 0x1200
s_add_u32 s94, s94, 0x3870
zbq 8,0
ze3
zed
zee 0x4800
zef
zeg
zeh 0x1200
zei
zej 0xd0
zek 0x12d0
zel
zem
zen
zeo
s_mov_b32 s80, 0
s_mul_i32 s58, s20, 0x1800
s_add_u32 s58, s58, 0x33000
zde
s_cselect_b32 s58, s71, s58
zgp 6,130
zgc 130,128
zgn 6,130
zfk 130,127
zf9 7,130
zc9 129,0xffff
v_lshlrev_b32 v129, v7, v129
v_cmp_eq_u32 vcc, v128, v126
zam
zas 129
v_cmp_gt_u32 vcc, 2, v127
zam
v_cndmask_b32 v3, 0, v129, vcc
zgq 5,3,129
s_sub_u32 s82, s21, 3
s_sub_u32 s83, s22, 3
v_cvt_f32_i32 v49, s82
v_cvt_f32_i32 v50, s83
v_add_f32 v129, 0x41500000, v49
v_add_f32 v130, 0x41a00000, v50
v_mul_f32 v51, 0xc3500000, v50
v_fmamk_f32 v51, v49, 0xc5900000, v51
v_readfirstlane_b32 s75, v129
v_readfirstlane_b32 s76, v130
zc9 52,0x120
s_mov_b32 s26, 0x11111111
s_mov_b32 s27, 0x11111111
s_mov_b32 s28, 0x22222222
s_mov_b32 s29, 0x22222222
s_mov_b32 s30, 0x44444444
s_mov_b32 s31, 0x44444444
s_mov_b32 s32, 0x88888888
s_mov_b32 s33, 0x88888888
zu 28
zx 36,56
zr 37,56
zgw 38,48
zbs 39,33
z2 38
z2 39
zg 36,38
zg 37,39
zs 38
zs 39
zs 36
zs 37
zq 38,39
zq 36,37
zr 37,36
zav 36,38
zaw 36
z3 45,37
z3 44,36
z4 47,37,45
z4 46,36,44
zgw 38,48
z2 38
zd1 39,49
zd2 38,39
zax 47
z5 36,46
z5 37,47
zd3 40,44,49,38
zay 41,45,50
zw 38,36,37
zaz 36,47
za0 37,46
zw 39,46,47
za1 41,45
za2 41,51
za3 36,37
zas 37
za4 41,40
zq 38,39
zq 36,37
za5 37,52
zdf 40,44
zdg 39
za6 9,41
z8 15,38,7
z8 18,36,7
zdh
zau 12,37,9
zdi
zdj
Lf9_aqR0:
zu 19
s_barrier
zcf
s_cbranch_scc1 Lf9_aqG0
Lf9_aqRb0:
zdk 76,8
zi 78,8,16
zi 80,8,64
zi 82,8,80
zi 84,8,128
zi 86,8,144
zu 13
zo 148,1
zb 150,1,1536
zo 152,2
zb 154,2,1536
zb 156,1,64
zb 158,1,1600
zb 160,2,64
zb 162,2,1600
zb 164,1,128
zb 166,1,1664
zb 168,2,128
zb 170,2,1664
zu 7
zb 172,1,6144
zb 174,1,7680
zb 176,2,6144
zb 178,2,7680
zb 180,1,6208
zb 182,1,7744
zb 184,2,6208
zb 186,2,7744
zb 188,1,6272
zb 190,1,7808
zb 192,2,6272
zb 194,2,7808
Lf9_atR0:
zda
s_cbranch_scc1 Lf9_atG0
Lf9_atRb0:
ze 15
zh 220,148,76
zu 1
zb 196,1,12288
zb 198,1,13824
zh 224,152,76
zb 200,2,12288
zb 202,2,13824
zp 0,156,76
zb 204,1,12352
zb 206,1,13888
zp 4,160,76
ze 15
zb 208,2,12352
zb 210,2,13888
zp 8,164,76
zb 212,1,12416
zb 214,1,13952
zp 12,168,76
zb 216,2,12416
zb 218,2,13952
zf 220,172,80
ze 15
zi 88,8,4608
zi 90,8,4624
zf 224,176,80
zi 92,8,4672
zi 94,8,4688
za 0,180,80
zi 96,8,4736
zi 98,8,4752
za 4,184,80
zf1
zcv
zcw 0xdf
zbt 0xa800
zdd 0x9000
ze 15
za 8,188,80
zcx
zv
zae 25
za 12,192,80
zan 0x400
zv
zae 26
zf 220,196,84
zan 0x800
zv
zae 27
ze 5
zf 224,200,84
zan 0xc00
zv
zae 28
za 0,204,84
zcy 0x3fffffff
zan 0x1000
zv
zae 29
zcz
za 4,208,84
za 8,212,84
za 12,216,84
Lf9_atR1:
zdb
s_cbranch_scc1 Lf9_atG1
Lf9_atRb1:
ze 0
zh 228,148,88
zi 76,8,9216
zi 78,8,9232
zi 80,8,9280
zf 228,172,92
zi 82,8,9296
zi 84,8,9344
zi 86,8,9360
zf 228,196,96
zgj
zcv
zcw 0xdf
zbt 0xa800
zdd 0xd800
zh 232,152,88
zid
zgk
s_cselect_b32 s42, 0x23000, s42
zcx
zv
zae 25
zf 232,176,92
zan 0x400
zv
zae 26
zan 0x800
zv
zae 27
zf 232,200,96
zan 0xc00
zv
zae 28
zcy 0x3fffffff
zan 0x1000
zv
zae 29
zcz
zp 16,156,88
zc8 0x2bc00
zfi 68,35
zu 11
zx 36,62
zr 37,62
za 16,180,92
zci 38,48
zbs 39,33
za 16,204,96
z2 38
z2 39
zp 20,160,88
zg 36,38
zg 37,39
za 20,184,92
zs 38
zs 39
za 20,208,96
zs 36
zs 37
zp 24,164,88
zq 38,39
zq 36,37
za 24,188,92
zr 37,36
zav 36,38
za 24,212,96
zaw 36
z3 45,37
zp 28,168,88
z3 44,36
z4 47,37,45
za 28,192,92
zbr 0x11000
zdw 1
zdw 2
za 28,216,96
Lf9_atR2:
zu 6
s_barrier
zdc
s_cbranch_scc1 Lf9_atG2
Lf9_atRb2:
ze 0
zh 236,148,76
zi 88,8,13824
zi 90,8,13840
zi 92,8,13888
zf 236,172,80
zi 94,8,13904
zi 96,8,13952
zi 98,8,13968
zf 236,196,84
zf2 32,35
z6 0x3000
zc7 0x3000
z0 42
zh 240,152,76
zn 43,1024
zn 53,2048
zf 240,176,80
z4 46,36,44
zci 38,48
z2 38
zf 240,200,84
zd1 39,49
zd2 38,39
zax 47
zp 32,156,76
z5 36,46
z5 37,47
za 32,180,80
zd3 40,44,49,38
zay 41,45,50
za 32,204,84
zw 38,36,37
zaz 36,47
zp 36,160,76
za0 37,46
zw 39,46,47
za 36,184,80
za1 41,45
za2 41,51
za 36,208,84
za3 36,37
zas 37
zp 40,164,76
za4 41,40
zq 38,39
za 40,188,80
zq 36,37
za5 37,52
za 40,212,84
zca 40,44
zcb 39
zp 44,168,76
za6 10,41
z8 16,38,7
z8 19,36,7
za 44,192,80
zcc
zau 13,37,10
zcd
zce
za 44,216,84
Lf9_atR3:
zc5
s_cbranch_scc1 Lf9_atG3
Lf9_atRb3:
ze 0
zh 244,148,88
zi 76,8,18432
zi 78,8,18448
zi 80,8,18496
zf 244,172,92
zi 82,8,18512
zi 84,8,18560
zi 86,8,18576
zf 244,196,96
ze5
zc6 60,35,16
z6 0x3000
zc7 0x3000
zn 42,3072
zh 248,152,88
z6 0x4000
zc7 0x4000
z0 43
zf 248,176,92
zn 53,1024
zcg
zcu
z0 42
zf 248,200,96
zu 9
zx 36,68
zr 37,68
zcl 38,48
zp 48,156,88
zbs 39,33
z2 38
z2 39
za 48,180,92
zg 36,38
zg 37,39
zs 38
za 48,204,96
zs 39
zs 36
zs 37
zp 52,160,88
zq 38,39
zq 36,37
zr 37,36
za 52,184,92
zav 36,38
zaw 36
z3 45,37
za 52,208,96
z3 44,36
z4 47,37,45
z4 46,36,44
zp 56,164,88
zcl 38,48
z2 38
za 56,188,92
zd1 39,49
zd2 38,39
za 56,212,96
zax 47
z5 36,46
zp 60,168,88
z5 37,47
zd3 40,44,49,38
za 60,192,92
zay 41,45,50
zw 38,36,37
za 60,216,96
Lf9_atR4:
zc0
s_cbranch_scc1 Lf9_atG4
Lf9_atRb4:
ze 0
zh 252,148,76
zi 88,8,23040
zi 90,8,23056
zi 92,8,23104
zf 252,172,80
zi 94,8,23120
zi 96,8,23168
zi 98,8,23184
zf 252,196,84
zc8 0x15e00
zc6 66,35,16
zcg
zcu
zn 43,1024
zp 64,152,76
zn 53,2048
zn 42,3072
za 64,176,80
zaz 36,47
za0 37,46
zw 39,46,47
za 64,200,84
za1 41,45
za2 41,51
za3 36,37
zp 68,156,76
zas 37
za4 41,40
za 68,180,80
zq 38,39
zq 36,37
za 68,204,84
za5 37,52
zcm 40,44
zp 72,160,76
zcn 39
za6 11,41
za 72,184,80
z8 17,38,7
z8 20,36,7
za 72,208,84
zco
zau 14,37,11
zcp
zex 76,164
zcq
zx 36,57
zr 37,57
zdx 38,48
za 76,188,80
zcj 39,33
z2 38
za 76,212,84
z2 39
zg 36,38
zp 80,168,76
zg 37,39
zs 38
z7 80,192
zs 39
zs 36
za 80,216,84
Lf9_atR5:
zd4
s_cbranch_scc1 Lf9_atG5
Lf9_atRb5:
ze 0
zp 84,148,88
zi 76,8,27648
zi 78,8,27664
zi 80,8,27712
za 84,172,92
zi 82,8,27728
zi 84,8,27776
zi 86,8,27792
za 84,196,96
zc8 0x2bc00
zc6 72,35,16
z6 0x1000
zag 0x1000
z0 43
zex 88,152
zn 53,1024
zn 42,2048
za 88,176,92
zn 43,3072
zs 37
za 88,200,96
zq 38,39
zq 36,37
zr 37,36
zp 92,156,88
zav 36,38
zaw 36
z3 45,37
z7 92,180
z3 44,36
z4 47,37,45
z4 46,36,44
za 92,204,96
zax 47
z5 36,46
z5 37,47
zp 96,160,88
zbg 40,44,49
zay 41,45,50
zw 38,36,37
za 96,184,92
zaz 36,47
za0 37,46
zw 39,46,47
z7 96,208
za1 41,45
za2 41,51
zp 100,164,88
za3 36,37
zas 37
za 100,188,92
za4 41,40
zq 38,39
za 100,212,96
zq 36,37
za5 37,52
zp 104,168,88
zdf 40,44
zdg 39
za 104,192,92
za6 9,41
z8 15,38,7
za 104,216,96
Lf9_atR6:
s_barrier
zd5
s_cbranch_scc1 Lf9_atG6
Lf9_atRb6:
ze 0
zp 108,148,76
zi 88,8,32256
zi 90,8,32272
zi 92,8,32320
zp 112,152,76
z6 0x2000
zag 0x2000
z0 53
zi 94,8,32336
zp 116,156,76
zn 42,1024
zn 43,2048
zp 120,160,76
zn 53,3072
z8 18,36,7
zp 124,164,76
zdh
zau 12,37,9
zdi
zdj
zp 128,168,76
zi 76,8,32384
zi 78,8,32400
zx 36,63
za 108,172,80
zr 37,63
zfl 38,48
zcj 39,33
za 112,176,80
z2 38
z2 39
zg 36,38
za 116,180,80
zg 37,39
zs 38
zs 39
za 120,184,80
zs 36
zs 37
zq 38,39
za 124,188,80
zq 36,37
zr 37,36
zav 36,38
za 128,192,80
zaw 36
z3 45,37
z3 44,36
za 108,196,84
z4 47,37,45
z4 46,36,44
za 112,200,84
zax 47
z5 36,46
za 116,204,84
z5 37,47
zbg 40,44,49
za 120,208,84
zay 41,45,50
zw 38,36,37
za 124,212,84
zaz 36,47
za0 37,46
za 128,216,84
Lf9_atR7:
zdy
s_cbranch_scc1 Lf9_atG7
Lf9_atRb7:
ze 0
zp 132,148,88
zi 84,8,36864
zi 86,8,36880
zi 96,8,36928
zi 98,8,36944
zp 136,152,88
zw 39,46,47
za1 41,45
za2 41,51
za3 36,37
zp 140,156,88
zas 37
za4 41,40
zq 38,39
zq 36,37
zp 144,160,88
za5 37,52
zca 40,44
zcb 39
za6 10,41
zp 148,164,88
z8 16,38,7
z8 19,36,7
zcc
zau 13,37,10
zp 152,168,88
zcd
zi 88,8,36992
zi 90,8,37008
zce
zu 21
zx 36,32
za 132,172,92
zr 37,32
zf3 38,48
ze2 39,33
z2 38
za 136,176,92
z2 39
zg 36,38
zg 37,39
zs 38
za 140,180,92
zs 39
zs 36
zs 37
zq 38,39
za 144,184,92
zq 36,37
zr 37,36
zav 36,38
zaw 36
za 148,188,92
z3 45,37
z3 44,36
z4 47,37,45
z4 46,36,44
za 152,192,92
zax 47
z5 36,46
z5 37,47
zbg 40,44,49
za 132,196,76
zay 41,45,50
zw 38,36,37
zaz 36,47
za0 37,46
za 136,200,76
zw 39,46,47
za1 41,45
za2 41,51
za3 36,37
za 140,204,76
zas 37
za4 41,40
zq 38,39
zq 36,37
za 144,208,76
za5 37,52
zcm 40,44
zcn 39
za6 11,41
za 148,212,76
z8 17,38,7
z8 20,36,7
zco
zau 14,37,11
zcp
za 152,216,76
zcq
Lf9_atR8:
zu 14
s_barrier
zdy
s_cbranch_scc1 Lf9_atG8
Lf9_atRb8:
ze 0
zp 156,148,84
zf4 8,0
zp 160,152,84
zdk 76,8
zi 78,8,16
zp 164,156,84
zi 80,8,64
zi 82,8,80
zp 168,160,84
zp 172,164,84
zp 176,168,84
zi 84,8,128
zi 86,8,144
zb 148,1,12288
za 156,172,96
zb 150,1,13824
zb 152,2,12288
zb 154,2,13824
za 160,176,96
zb 156,1,12352
zb 158,1,13888
za 164,180,96
zb 160,2,12352
zb 162,2,13888
za 168,184,96
zb 164,1,12416
zb 166,1,13952
za 172,188,96
zb 168,2,12416
zb 170,2,13952
za 176,192,96
zb 172,1,30720
zb 174,1,32256
za 156,196,88
zb 176,2,30720
zb 178,2,32256
za 160,200,88
zb 180,1,30784
zb 182,1,32320
za 164,204,88
zb 184,2,30784
zb 186,2,32320
za 168,208,88
zb 188,1,30848
zb 190,1,32384
za 172,212,88
zb 192,2,30848
zb 194,2,32384
za 176,216,88
zfz
s_cbranch_scc1 Lf9_as1R0
zf0
s_cbranch_scc1 Lf9_as2R0
zde
s_cbranch_scc1 Lf9_as3R0
Lf9_as0R0:
zc1
s_cbranch_scc1 Lf9_as0G0
Lf9_as0Rb0:
ze 15
zf 220,148,76
zb 204,1,49216
zb 206,1,50752
zb 208,2,49216
zf 224,152,76
zb 210,2,50752
zb 212,1,49280
zb 214,1,50816
za 0,156,76
zb 216,2,49280
zb 218,2,50816
zb 196,1,49152
za 4,160,76
ze 15
zb 198,1,50688
zb 200,2,49152
zb 202,2,50688
za 8,164,76
zi 88,8,4608
zi 90,8,4624
zi 92,8,4672
za 12,168,76
ze 15
zi 94,8,4688
zi 76,8,4736
zi 78,8,4752
zf 220,188,80
zbr 0x11000
zbb 1
zbb 2
zf 224,192,80
zb2 54
zb3 54
zbz 25,54
za 0,172,80
zbc 0x5800
zbw
zbd
zbe
za 4,176,80
ze 6
s_barrier
z6 0x3000
zag 0x3000
z0 42
za 8,180,80
zn 43,1024
zn 53,2048
za 12,184,80
zn 42,3072
z6 0x4000
zag 0x4000
z0 43
zf 220,204,84
zn 53,1024
zal 28,54
zf 224,208,84
zbc 0x9800
zby
zbd
zbe
za 0,212,84
zal 29,54
zb5
za 4,216,84
zb6 0x1e800
zal 30,54
zb7 54
zbv 26,4
za 8,196,84
zbk 26,54
zb8
za 12,200,84
zb9 26
Lf9_as0R1:
ze6
s_cbranch_scc1 Lf9_as0G1
Lf9_as0Rb1:
ze 0
zf 228,148,88
zi 84,8,9216
zi 86,8,9232
zf 232,152,88
zi 96,8,9280
zi 98,8,9296
za 16,156,88
za 20,160,88
za 24,164,88
za 28,168,88
zi 88,8,9344
zi 90,8,9360
zf 228,188,92
zf 232,192,92
za 16,172,92
za 20,176,92
za 24,180,92
za 28,184,92
zf 228,204,76
zf 232,208,76
za 16,212,76
za 20,216,76
za 24,196,76
za 28,200,76
Lf9_as0R2:
zcf
s_cbranch_scc1 Lf9_as0G2
Lf9_as0Rb2:
ze 0
zf 236,148,84
zbn
zbo
zbq 8,0
zf 240,152,84
zbp
zdk 76,8
zi 78,8,16
za 32,156,84
zi 80,8,64
zi 82,8,80
za 36,160,84
za 40,164,84
za 44,168,84
zu 12
zi 84,8,128
zi 86,8,144
zo 148,1
zf 236,188,96
zb 150,1,1536
zo 152,2
zb 154,2,1536
zf 240,192,96
zb 156,1,64
zb 158,1,1600
za 32,172,96
zb 160,2,64
zb 162,2,1600
za 36,176,96
zb 164,1,128
zb 166,1,1664
za 40,180,96
zb 168,2,128
zb 170,2,1664
za 44,184,96
zu 6
zb 172,1,6144
zb 174,1,7680
zf 236,204,88
zb 176,2,6144
zb 178,2,7680
zf 240,208,88
zb 180,1,6208
zb 182,1,7744
za 32,212,88
zb 184,2,6208
zb 186,2,7744
za 36,216,88
zb 188,1,6272
zb 190,1,7808
za 40,196,88
zb 192,2,6272
zb 194,2,7808
za 44,200,88
s_branch Lf9_amR0
Lf9_as1R0:
zc1
s_cbranch_scc1 Lf9_as1G0
Lf9_as1Rb0:
ze 15
zf 244,156,76
zb 212,1,49280
zb 214,1,50816
zb 216,2,49280
zf 248,160,76
ze 15
zb 218,2,50816
zb 196,1,49152
zb 198,1,50688
za 48,164,76
zb 200,2,49152
zb 202,2,50688
zb 204,1,49216
za 52,168,76
zb 206,1,50752
zb 208,2,49216
zb 210,2,50752
za 56,148,76
zi 88,8,4608
zi 90,8,4624
zi 92,8,4672
za 60,152,76
ze 15
zi 94,8,4688
zi 96,8,4736
zi 98,8,4752
zf 244,172,80
zbr 0x11000
zbb 1
zbb 2
zf 248,176,80
zb2 54
zb3 54
zbz 25,54
za 48,180,80
zbc 0x5800
zbw
zbd
zbe
za 52,184,80
ze 6
s_barrier
z6 0x3000
zag 0x3000
z0 42
za 56,188,80
zn 43,1024
zn 53,2048
za 60,192,80
zn 42,3072
z6 0x4000
zag 0x4000
z0 43
zf 244,212,84
zn 53,1024
zal 28,54
zf 248,216,84
zbc 0x9800
zby
zbd
zbe
za 48,196,84
zal 29,54
zb5
za 52,200,84
zb6 0x1e800
zal 30,54
zb7 54
zbv 26,4
za 56,204,84
zbk 26,54
zb8
za 60,208,84
zb9 26
Lf9_as1R1:
zcf
s_cbranch_scc1 Lf9_as1G1
Lf9_as1Rb1:
ze 0
zf 252,156,88
zbn
zbo
zbq 8,0
za 64,160,88
zbp
zdk 76,8
zi 78,8,16
za 68,164,88
zi 80,8,64
zi 82,8,80
za 72,168,88
zi 84,8,128
zi 86,8,144
za 76,148,88
za 80,152,88
zu 12
zo 148,1
zb 150,1,1536
zf 252,172,92
zo 152,2
zb 154,2,1536
za 64,176,92
zb 156,1,64
zb 158,1,1600
za 68,180,92
zb 160,2,64
zb 162,2,1600
za 72,184,92
zb 164,1,128
zb 166,1,1664
za 76,188,92
zb 168,2,128
zb 170,2,1664
za 80,192,92
zu 6
zb 172,1,6144
zb 174,1,7680
zf 252,212,96
zb 176,2,6144
zb 178,2,7680
za 64,216,96
zb 180,1,6208
zb 182,1,7744
za 68,196,96
zb 184,2,6208
zb 186,2,7744
za 72,200,96
zb 188,1,6272
zb 190,1,7808
za 76,204,96
zb 192,2,6272
zb 194,2,7808
za 80,208,96
s_branch Lf9_amR0
Lf9_as2R0:
zc1
s_cbranch_scc1 Lf9_as2G0
Lf9_as2Rb0:
ze 14
za 84,164,76
ze 12
zb 196,1,49152
zb 198,1,50688
zb 200,2,49152
za 88,168,76
zb 202,2,50688
zb 204,1,49216
zb 206,1,50752
za 92,148,76
zb 208,2,49216
zb 210,2,50752
zb 212,1,49280
za 96,152,76
zb 214,1,50816
zb 216,2,49280
zb 218,2,50816
za 100,156,76
zi 88,8,4608
zi 90,8,4624
zi 92,8,4672
za 104,160,76
ze 15
zi 94,8,4688
zi 96,8,4736
zi 98,8,4752
za 84,180,80
zbr 0x11000
zbb 1
zbb 2
za 88,184,80
zb2 54
zb3 54
zbz 25,54
za 92,188,80
zbc 0x5800
zbw
zbd
zbe
za 96,192,80
ze 6
s_barrier
z6 0x3000
zag 0x3000
z0 42
za 100,172,80
zn 43,1024
zn 53,2048
za 104,176,80
zn 42,3072
z6 0x4000
zag 0x4000
z0 43
z7 84,196
zn 53,1024
zal 28,54
za 88,200,84
zbc 0x9800
zby
zbd
zbe
za 92,204,84
zal 29,54
zb5
za 96,208,84
zb6 0x1e800
zal 30,54
zb7 54
zbv 26,4
za 100,212,84
zbk 26,54
zb8
za 104,216,84
zb9 26
Lf9_as2R1:
zcf
s_cbranch_scc1 Lf9_as2G1
Lf9_as2Rb1:
ze 0
za 108,164,88
zbn
zbo
zbq 8,0
za 112,168,88
zbp
zdk 76,8
zi 78,8,16
za 116,148,88
zi 80,8,64
zi 82,8,80
za 120,152,88
zi 84,8,128
zi 86,8,144
za 124,156,88
za 128,160,88
zu 12
zo 148,1
zb 150,1,1536
za 108,180,92
zo 152,2
zb 154,2,1536
za 112,184,92
zb 156,1,64
zb 158,1,1600
za 116,188,92
zb 160,2,64
zb 162,2,1600
za 120,192,92
zb 164,1,128
zb 166,1,1664
za 124,172,92
zb 168,2,128
zb 170,2,1664
za 128,176,92
zu 6
zb 172,1,6144
zb 174,1,7680
za 108,196,96
zb 176,2,6144
zb 178,2,7680
za 112,200,96
zb 180,1,6208
zb 182,1,7744
za 116,204,96
zb 184,2,6208
zb 186,2,7744
za 120,208,96
zb 188,1,6272
zb 190,1,7808
za 124,212,96
zb 192,2,6272
zb 194,2,7808
za 128,216,96
s_branch Lf9_amR0
Lf9_as3R0:
zc1
s_cbranch_scc1 Lf9_as3G0
Lf9_as3Rb0:
ze 15
za 132,148,76
zb 204,1,49216
zb 206,1,50752
za 136,152,76
zb 208,2,49216
zb 210,2,50752
za 140,156,76
zb 212,1,49280
zb 214,1,50816
za 144,160,76
ze 15
zb 216,2,49280
zb 218,2,50816
za 148,164,76
zb 196,1,49152
zb 198,1,50688
za 152,168,76
ze 12
zb 200,2,49152
zb 202,2,50688
za 132,188,80
ze 12
zi 88,8,4608
zi 90,8,4624
za 136,192,80
zi 92,8,4672
zi 94,8,4688
za 140,172,80
zi 96,8,4736
zi 98,8,4752
za 144,176,80
ze 6
s_barrier
zbr 0x11000
zbb 1
zbb 2
za 148,180,80
zb2 54
zb3 54
za 152,184,80
zbz 25,54
zbc 0x5800
zbw
zbd
za 132,204,84
zbe
zal 28,54
zbc 0x9800
za 136,208,84
zby
zbd
zbe
za 140,212,84
zal 29,54
zb5
za 144,216,84
zb6 0x1e800
zal 30,54
zb7 54
zbv 26,4
za 148,196,84
zbk 26,54
zb8
za 152,200,84
zb9 26
Lf9_as3R1:
zcf
s_cbranch_scc1 Lf9_as3G1
Lf9_as3Rb1:
ze 0
za 156,148,88
zbn
zbo
zbq 8,0
za 160,152,88
zbp
zdk 76,8
zi 78,8,16
za 164,156,88
zi 80,8,64
zi 82,8,80
za 168,160,88
zi 84,8,128
zi 86,8,144
za 172,164,88
za 176,168,88
zu 6
zo 148,1
zb 150,1,1536
za 156,188,92
zo 152,2
zb 154,2,1536
za 160,192,92
zb 156,1,64
zb 158,1,1600
za 164,172,92
zb 160,2,64
zb 162,2,1600
za 168,176,92
zb 164,1,128
zb 166,1,1664
za 172,180,92
zb 168,2,128
zb 170,2,1664
za 176,184,92
zu 0
zb 172,1,6144
zb 174,1,7680
za 156,204,96
zb 176,2,6144
zb 178,2,7680
za 160,208,96
zb 180,1,6208
zb 182,1,7744
za 164,212,96
zb 184,2,6208
zb 186,2,7744
za 168,216,96
zb 188,1,6272
zb 190,1,7808
za 172,196,96
zb 192,2,6272
zb 194,2,7808
za 176,200,96
s_branch Lf9_amR0
.p2align 6
Lf9_amR0:
zda
s_cbranch_scc1 Lf9_amG0
Lf9_amRb0:
ze 15
zf 220,148,76
ze3
zu 0
zb 196,1,12288
zb 198,1,13824
zf 224,152,76
zed
zb 200,2,12288
zb 202,2,13824
za 0,156,76
zee 0x4800
zb 204,1,12352
zb 206,1,13888
za 4,160,76
zef
zb 208,2,12352
zb 210,2,13888
ze 15
za 8,164,76
zeg
zb 212,1,12416
zb 214,1,13952
za 12,168,76
zeh 0x1200
zb 216,2,12416
zb 218,2,13952
zf 220,172,80
zei
zi 88,8,4608
zi 90,8,4624
zf 224,176,80
zej 0xd0
zi 92,8,4672
zi 94,8,4688
ze 15
za 0,180,80
zek 0x12d0
zi 96,8,4736
zi 98,8,4752
za 4,184,80
zel
zx 36,69
zr 37,69
za 8,188,80
zem
zd 69,70
zd 70,71
za 12,192,80
ze 10
zd 71,72
zd 72,73
zf 220,196,84
zen
zcl 38,48
zbs 39,33
zf 224,200,84
zeo
za 0,204,84
za 4,208,84
ze 4
za 8,212,84
za 12,216,84
Lf9_amR1:
zdb
s_cbranch_scc1 Lf9_amG1
Lf9_amRb1:
zf 228,148,88
ze 0
zi 76,8,9216
zi 78,8,9232
zf 228,172,92
zi 80,8,9280
zi 82,8,9296
zf 228,196,96
zi 84,8,9344
zi 86,8,9360
zf 232,152,88
zcg
zcu
z0 42
zf 232,176,92
zn 43,1024
zf 232,200,96
zn 53,2048
za 16,156,88
z2 38
z2 39
za 16,180,92
zg 36,38
zg 37,39
za 16,204,96
zs 38
zs 39
za 20,160,88
zs 36
zs 37
za 20,184,92
zq 38,39
zq 36,37
za 20,208,96
zr 37,36
zav 36,38
za 24,164,88
zaw 36
z3 45,37
za 24,188,92
z3 44,36
z4 47,37,45
za 24,212,96
z4 46,36,44
zax 47
za 28,168,88
z5 36,46
za 28,192,92
za 28,216,96
Lf9_amR2:
zdc
s_cbranch_scc1 Lf9_amG2
Lf9_amRb2:
ze 0
zf 236,148,76
zi 88,8,13824
zi 90,8,13840
zf 236,172,80
zi 92,8,13888
zi 94,8,13904
zf 236,196,84
zi 96,8,13952
zi 98,8,13968
zf 240,152,76
zn 42,3072
zf 240,176,80
z6 0x1000
zag 0x1000
z0 43
zf 240,200,84
zn 53,1024
za 32,156,76
z5 37,47
zbg 40,44,49
za 32,180,80
zay 41,45,50
zw 38,36,37
za 32,204,84
zaz 36,47
za0 37,46
za 36,160,76
zw 39,46,47
za1 41,45
za 36,184,80
za2 41,51
za3 36,37
za 36,208,84
zas 37
za4 41,40
za 40,164,76
zq 38,39
zq 36,37
za 40,188,80
za5 37,52
zcm 40,44
za 40,212,84
zcn 39
za6 11,41
za 44,168,76
z8 17,38,7
za 44,192,80
za 44,216,84
Lf9_amR3:
zc5
s_cbranch_scc1 Lf9_amG3
Lf9_amRb3:
ze 0
zf 244,148,88
zi 76,8,18432
zi 78,8,18448
zf 244,172,92
zi 80,8,18496
zi 82,8,18512
zf 244,196,96
zi 84,8,18560
zi 86,8,18576
zf 248,152,88
zn 42,2048
zf 248,176,92
zn 43,3072
zf 248,200,96
z6 0x2000
zag 0x2000
z0 53
za 48,156,88
z8 20,36,7
zco
za 48,180,92
zau 14,37,11
zcp
za 48,204,96
zcq
zx 36,58
zr 37,58
za 52,160,88
zd 58,59
zd 59,60
za 52,184,92
zd 60,61
zdx 38,48
za 52,208,96
zcj 39,33
z2 38
za 56,164,88
z2 39
zg 36,38
za 56,188,92
zg 37,39
zs 38
za 56,212,96
zs 39
zs 36
za 60,168,88
za 60,192,92
za 60,216,96
Lf9_amR4:
zc0
s_cbranch_scc1 Lf9_amG4
Lf9_amRb4:
ze 0
zf 252,148,76
zi 88,8,23040
zi 90,8,23056
zf 252,172,80
zi 92,8,23104
zi 94,8,23120
zf 252,196,84
zi 96,8,23168
zi 98,8,23184
za 64,152,76
zn 42,1024
za 64,176,80
zn 43,2048
za 64,200,84
zn 53,3072
za 68,156,76
zs 37
zq 38,39
za 68,180,80
zq 36,37
zr 37,36
za 68,204,84
zav 36,38
zaw 36
za 72,160,76
z3 45,37
z3 44,36
za 72,184,80
z4 47,37,45
z4 46,36,44
za 72,208,84
zax 47
z5 36,46
z7 76,164
z5 37,47
zbg 40,44,49
za 76,188,80
zay 41,45,50
zw 38,36,37
za 76,212,84
zaz 36,47
za0 37,46
za 80,168,76
zw 39,46,47
z7 80,192
za 80,216,84
Lf9_amR5:
zd4
s_cbranch_scc1 Lf9_amG5
Lf9_amRb5:
ze 0
za 84,148,88
zi 76,8,27648
zi 78,8,27664
za 84,172,92
zi 80,8,27712
zi 82,8,27728
za 84,196,96
zi 84,8,27776
zi 86,8,27792
z7 88,152
z6 0x3000
zag 0x3000
z0 42
za 88,176,92
zn 43,1024
za 88,200,96
zn 53,2048
za 92,156,88
za1 41,45
za2 41,51
z7 92,180
za3 36,37
zas 37
za 92,204,96
za4 41,40
zq 38,39
za 96,160,88
zq 36,37
za5 37,52
za 96,184,92
zdf 40,44
zdg 39
z7 96,208
za6 9,41
z8 15,38,7
za 100,164,88
z8 18,36,7
zdh
za 100,188,92
zau 12,37,9
zdi
za 100,212,96
zdj
zx 36,64
za 104,168,88
za 104,192,92
za 104,216,96
Lf9_amR6:
zd5
s_cbranch_scc1 Lf9_amG6
Lf9_amRb6:
ze 0
za 108,148,76
zi 88,8,32256
zi 90,8,32272
za 112,152,76
zi 92,8,32320
zi 94,8,32336
za 116,156,76
zn 42,3072
za 120,160,76
z6 0x4000
zag 0x4000
z0 43
za 124,164,76
zn 53,1024
za 128,168,76
zi 76,8,32384
zi 78,8,32400
za 108,172,80
zr 37,64
zd 64,65
za 112,176,80
zd 65,66
zd 66,67
za 116,180,80
zfl 38,48
zcj 39,33
za 120,184,80
z2 38
z2 39
za 124,188,80
zg 36,38
zg 37,39
za 128,192,80
zs 38
zs 39
za 108,196,84
zs 36
zs 37
za 112,200,84
zq 38,39
zq 36,37
za 116,204,84
zr 37,36
zav 36,38
za 120,208,84
zaw 36
za 124,212,84
za 128,216,84
Lf9_amR7:
zdy
s_cbranch_scc1 Lf9_amG7
Lf9_amRb7:
ze 0
za 132,148,88
zi 84,8,36864
zi 86,8,36880
za 136,152,88
zi 96,8,36928
zi 98,8,36944
za 140,156,88
z3 45,37
z3 44,36
za 144,160,88
z4 47,37,45
z4 46,36,44
za 148,164,88
zax 47
z5 36,46
za 152,168,88
zi 88,8,36992
zi 90,8,37008
za 132,172,92
z5 37,47
zbg 40,44,49
za 136,176,92
zay 41,45,50
zw 38,36,37
za 140,180,92
zaz 36,47
za0 37,46
za 144,184,92
zw 39,46,47
za1 41,45
za 148,188,92
za2 41,51
za3 36,37
za 152,192,92
zas 37
za4 41,40
za 132,196,76
zq 38,39
zq 36,37
za 136,200,76
za5 37,52
zca 40,44
za 140,204,76
zcb 39
za6 10,41
za 144,208,76
z8 16,38,7
z8 19,36,7
za 148,212,76
zcc
zau 13,37,10
zcd
zce
za 152,216,76
Lf9_amR8:
zcf
s_cbranch_scc1 Lf9_amG8
Lf9_amRb8:
ze 0
za 156,148,84
zbn
zbo
zbq 8,0
za 160,152,84
zbp
zdk 76,8
zi 78,8,16
za 164,156,84
zf5
zi 80,8,64
zi 82,8,80
za 168,160,84
za 172,164,84
za 176,168,84
zu 12
zi 84,8,128
zi 86,8,144
zo 148,1
za 156,172,96
zb 150,1,1536
zo 152,2
zb 154,2,1536
za 160,176,96
zb 156,1,64
zb 158,1,1600
za 164,180,96
zb 160,2,64
zb 162,2,1600
za 168,184,96
zb 164,1,128
zb 166,1,1664
za 172,188,96
zb 168,2,128
zb 170,2,1664
za 176,192,96
zu 6
zb 172,1,6144
zb 174,1,7680
za 156,196,88
zb 176,2,6144
zb 178,2,7680
za 160,200,88
zb 180,1,6208
zb 182,1,7744
za 164,204,88
zb 184,2,6208
zb 186,2,7744
za 168,208,88
zb 188,1,6272
zb 190,1,7808
za 172,212,88
zb 192,2,6272
zb 194,2,7808
za 176,216,88
zgx
s_cbranch_scc1 Lf9_amR0
zde
s_cbranch_scc1 Lf9_ayR0
Lf9_azR0:
zda
s_cbranch_scc1 Lf9_azG0
Lf9_azRb0:
zi 88,8,4608
zi 90,8,4624
zi 92,8,4672
zi 94,8,4688
ze 15
za 0,156,76
zu 0
zi 96,8,4736
zi 98,8,4752
zb 204,1,12352
zb 206,1,13888
za 4,160,76
zb 208,2,12352
zb 210,2,13888
zb 212,1,12416
zb 214,1,13952
za 8,164,76
zb 216,2,12416
zb 218,2,13952
zb 196,1,12288
zb 198,1,13824
za 12,168,76
zb 200,2,12288
zb 202,2,13824
zx 36,69
zr 37,69
zf 220,148,76
zcl 38,48
zbs 39,33
z2 38
z2 39
zf 224,152,76
ze 15
zg 36,38
zg 37,39
zs 38
zs 39
za 0,180,80
zs 36
zs 37
zq 38,39
zq 36,37
za 4,184,80
zr 37,36
zav 36,38
zaw 36
z3 45,37
za 8,188,80
z3 44,36
z4 47,37,45
z4 46,36,44
zax 47
za 12,192,80
z5 36,46
z5 37,47
zbg 40,44,49
zay 41,45,50
zf 220,172,80
zw 38,36,37
zaz 36,47
za0 37,46
zw 39,46,47
zf 224,176,80
ze 0
za1 41,45
za2 41,51
za3 36,37
zas 37
za 0,204,84
za4 41,40
zq 38,39
zq 36,37
za5 37,52
za 4,208,84
zcm 40,44
zcn 39
za6 11,41
z8 17,38,7
za 8,212,84
zk 0,25,2048
za 12,216,84
zv
zk 4,25,3072
zf 220,196,84
z8 20,36,7
zco
zau 14,37,11
zcp
zf 224,200,84
zcq
Lf9_azR1:
zdb
s_cbranch_scc1 Lf9_azG1
Lf9_azRb1:
zi 76,8,9216
zi 78,8,9232
zi 80,8,9280
zi 82,8,9296
za 16,156,88
zfo 0xffff0000
zi 84,8,9344
zi 86,8,9360
za 16,180,92
zf6 0xffff0000
zk 8,25,4096
za 16,204,96
zk 12,25,5120
za 20,160,88
za 20,184,92
za 20,208,96
zbl
zk 16,25,8192
za 24,164,88
ze 1
s_barrier
za7 32,28
za 24,188,92
za7 36,29
zk 20,25,9216
za 24,212,96
za7 40,30
zl 44,28,1024
za 28,168,88
zl 48,29,1024
zl 52,30,1024
za 28,192,92
za 28,216,96
zv
zk 24,25,10240
zf 228,148,88
zf 228,172,92
zf 228,196,96
zb0
zk 28,25,11264
zf 232,152,88
zf 232,176,92
zf 232,200,96
Lf9_azR2:
zdc
s_cbranch_scc1 Lf9_azG2
Lf9_azRb2:
zi 88,8,13824
zi 90,8,13840
zi 92,8,13888
zi 94,8,13904
za 32,156,76
ze 9
zi 96,8,13952
zi 98,8,13968
zm 36,32
zg 40,220
za 32,180,80
zm 37,33
zg 41,221
zm 38,34
zg 42,222
za 32,204,84
zm 39,35
zg 43,223
zg 36,40
zg 37,41
za 36,160,76
zg 38,42
zg 39,43
zc 40,36,37
zc 41,38,39
za 36,184,80
zk 32,25,14336
za 36,208,84
ze 7
zm 48,44
zg 52,224
zm 49,45
zg 53,225
za 40,164,76
s_barrier
zl 32,28,6144
zl 36,29,6144
zm 50,46
za 40,188,80
zk 36,25,15360
za 40,212,84
zg 54,226
zm 51,47
zg 55,227
zg 48,52
za 44,168,76
zl 44,28,7168
zg 49,53
zg 50,54
zg 51,55
za 44,192,80
zk 40,25,16384
za 44,216,84
zc 52,48,49
zc 53,50,51
zah 42,52,40
zf 236,148,76
zl 48,29,7168
zah 43,53,41
zai 40,52
zf 236,172,80
zk 44,25,17408
zf 236,196,84
zai 41,53
zf 240,152,76
zfn
zbf 40,26
zl 52,30,7168
zf 240,176,80
zl 40,30,6144
zf 240,200,84
Lf9_azR3:
zc5
s_cbranch_scc1 Lf9_azG3
Lf9_azRb3:
zi 76,8,18432
zi 78,8,18448
zi 80,8,18496
zi 82,8,18512
ze 10
za 48,156,88
zi 84,8,18560
zi 86,8,18576
zm 36,32
ze 6
zg 40,228
za 48,180,92
zm 37,33
zg 41,229
zm 38,34
zg 42,230
za 48,204,96
zm 39,35
zg 43,231
zg 36,40
zg 37,41
za 52,160,88
zg 38,42
zg 39,43
zc 40,36,37
zc 41,38,39
za 52,184,92
zk 48,25,2048
za 52,208,96
zm 48,44
zg 52,232
zm 49,45
zg 53,233
za 56,164,88
s_barrier
zl 32,28,12288
zl 36,29,12288
zm 50,46
za 56,188,92
zk 52,25,3072
za 56,212,96
zg 54,234
zm 51,47
zg 55,235
zg 48,52
za 60,168,88
zl 44,28,13312
zg 49,53
zg 50,54
zg 51,55
za 60,192,92
zk 56,25,4096
za 60,216,96
zc 52,48,49
zc 53,50,51
zah 42,52,40
zf 244,148,88
zl 48,29,13312
zah 43,53,41
zai 40,52
zf 244,172,92
zk 60,25,5120
zf 244,196,96
zai 41,53
zf 248,152,88
zbh 0xa800
zbf 40,26
zl 52,30,13312
zf 248,176,92
zl 40,30,12288
zf 248,200,96
Lf9_azR4:
zc0
s_cbranch_scc1 Lf9_azG4
Lf9_azRb4:
zi 88,8,23040
zi 90,8,23056
zi 92,8,23104
zi 94,8,23120
ze 10
za 68,156,76
zi 96,8,23168
zi 98,8,23184
zm 36,32
ze 6
zg 40,236
za 68,180,80
zm 37,33
zg 41,237
zm 38,34
zg 42,238
za 68,204,84
zm 39,35
zg 43,239
zg 36,40
zg 37,41
za 72,160,76
zg 38,42
zg 39,43
zc 40,36,37
zc 41,38,39
za 72,184,80
zk 68,25,8192
za 72,208,84
zm 48,44
zg 52,240
zm 49,45
zg 53,241
z7 76,164
s_barrier
za7 32,28
za7 36,29
zm 50,46
za 76,188,80
zk 72,25,9216
za 76,212,84
zg 54,242
zm 51,47
zg 55,243
zg 48,52
za 80,168,76
zl 44,28,1024
zg 49,53
zg 50,54
zg 51,55
z7 80,192
zk 76,25,10240
za 80,216,84
zc 52,48,49
zc 53,50,51
zah 42,52,40
zf 252,148,76
zl 48,29,1024
zah 43,53,41
zai 40,52
zf 252,172,80
zk 80,25,11264
zf 252,196,84
zai 41,53
za 64,152,76
zbh 0x15000
zbf 40,26
zl 52,30,1024
za 64,176,80
za7 40,30
za 64,200,84
Lf9_azR5:
zd4
s_cbranch_scc1 Lf9_azG5
Lf9_azRb5:
zi 76,8,27648
zi 78,8,27664
zi 80,8,27712
zi 82,8,27728
ze 10
za 92,156,88
zi 84,8,27776
zi 86,8,27792
zm 36,32
ze 6
zg 40,244
z7 92,180
zm 37,33
zg 41,245
zm 38,34
zg 42,246
za 92,204,96
zm 39,35
zg 43,247
zg 36,40
zg 37,41
za 96,160,88
zg 38,42
zg 39,43
zc 40,36,37
zc 41,38,39
za 96,184,92
zk 92,25,14336
z7 96,208
zm 48,44
zg 52,248
zm 49,45
zg 53,249
za 100,164,88
s_barrier
zl 32,28,6144
zl 36,29,6144
zm 50,46
za 100,188,92
zk 96,25,15360
za 100,212,96
zg 54,250
zm 51,47
zg 55,251
zg 48,52
za 104,168,88
zl 44,28,7168
zg 49,53
zg 50,54
zg 51,55
za 104,192,92
zk 100,25,16384
za 104,216,96
zc 52,48,49
zc 53,50,51
zah 42,52,40
za 84,148,88
zl 48,29,7168
zah 43,53,41
zai 40,52
za 84,172,92
zk 104,25,17408
za 84,196,96
zai 41,53
z7 88,152
zbh 0x1f800
zbf 40,26
zl 52,30,7168
za 88,176,92
zl 40,30,6144
za 88,200,96
Lf9_azR6:
zd5
s_cbranch_scc1 Lf9_azG6
Lf9_azRb6:
zi 88,8,32256
zi 90,8,32272
zi 92,8,32320
zi 94,8,32336
ze 10
za 116,156,76
zi 96,8,32384
zi 98,8,32400
zm 36,32
ze 6
zg 40,252
za 116,180,80
zm 37,33
zg 41,253
zm 38,34
zg 42,254
za 116,204,84
zm 39,35
zg 43,255
zg 36,40
zg 37,41
za 120,160,76
zg 38,42
zg 39,43
zc 40,36,37
zc 41,38,39
za 120,184,80
zk 116,25,2048
za 120,208,84
zm 48,44
z9 44,64
zg 52,44
zm 49,45
za 124,164,76
s_barrier
zl 32,28,12288
zl 36,29,12288
z9 45,65
za 124,188,80
zk 120,25,3072
za 124,212,84
zg 53,45
zm 50,46
z9 46,66
zg 54,46
za 128,168,76
zm 51,47
z9 47,67
zg 55,47
zg 48,52
za 128,192,80
zk 124,25,4096
za 128,216,84
zl 44,28,13312
zg 49,53
zg 50,54
zg 51,55
za 108,148,76
zc 52,48,49
zc 53,50,51
zah 42,52,40
zah 43,53,41
za 108,172,80
zk 128,25,5120
za 108,196,84
zl 48,29,13312
zai 40,52
zai 41,53
za 112,152,76
zbh 0x2a000
zbf 40,26
zl 52,30,13312
za 112,176,80
zl 40,30,12288
za 112,200,84
Lf9_azR7:
zdy
s_cbranch_scc1 Lf9_azG7
Lf9_azRb7:
zi 76,8,36864
zi 78,8,36880
zi 80,8,36928
zi 82,8,36944
ze 10
za 140,156,88
zi 84,8,36992
zi 86,8,37008
zm 36,32
z9 32,84
ze 6
zg 40,32
za 140,180,92
zm 37,33
z9 33,85
zg 41,33
zm 38,34
za 140,204,96
z9 34,86
zg 42,34
zm 39,35
z9 35,87
za 144,160,88
zg 43,35
zg 36,40
zg 37,41
zg 38,42
za 144,184,92
zk 140,25,8192
za 144,208,96
zg 39,43
zc 40,36,37
zc 41,38,39
zm 48,44
za 148,164,88
s_barrier
za7 32,28
za7 36,29
z9 44,88
za 148,188,92
zk 144,25,9216
za 148,212,96
zg 52,44
zm 49,45
z9 45,89
zg 53,45
za 152,168,88
zm 50,46
z9 46,90
zg 54,46
zm 51,47
za 152,192,92
zk 148,25,10240
za 152,216,96
z9 47,91
zg 55,47
zg 48,52
zg 49,53
za 132,148,88
zl 44,28,1024
zg 50,54
zg 51,55
zc 52,48,49
za 132,172,92
zk 152,25,11264
za 132,196,96
zc 53,50,51
zah 42,52,40
zah 43,53,41
zai 40,52
za 136,152,88
zl 48,29,1024
zai 41,53
za 136,176,92
zbh 0x34800
zbf 40,26
zl 52,30,1024
za7 40,30
za 136,200,96
Lf9_azR8:
Lf9_azH8:
ze 6
zm 36,32
z9 32,108
ze 0
zg 40,32
zm 37,33
za 164,156,76
z9 33,109
zg 41,33
zm 38,34
z9 34,110
za 164,180,80
zg 42,34
zm 39,35
z9 35,111
zg 43,35
za 164,204,84
zg 36,40
zg 37,41
zg 38,42
zg 39,43
za 168,160,76
zc 40,36,37
zc 41,38,39
zm 48,44
z9 44,112
za 168,184,80
zk 164,25,14336
za 168,208,84
zg 52,44
zm 49,45
z9 45,113
zg 53,45
za 172,164,76
s_barrier
zl 32,28,6144
zl 36,29,6144
zm 50,46
za 172,188,80
zk 168,25,15360
za 172,212,84
z9 46,114
zg 54,46
zm 51,47
z9 47,115
za 176,168,76
zg 55,47
zg 48,52
zg 49,53
zg 50,54
za 176,192,80
zk 172,25,16384
za 176,216,84
zl 44,28,7168
zg 51,55
zc 52,48,49
zc 53,50,51
za 156,148,76
zl 48,29,7168
zah 42,52,40
zah 43,53,41
za 156,172,80
zk 176,25,17408
za 156,196,84
zai 40,52
zai 41,53
za 160,152,76
zbh 0x3f000
zbf 40,26
zl 52,30,7168
za 160,176,80
zl 40,30,6144
za 160,200,84
ze 2
s_barrier
zm 36,32
z9 32,132
ze 0
zg 40,32
zm 37,33
z9 33,133
zg 41,33
zm 38,34
z9 34,134
zg 42,34
zm 39,35
z9 35,135
zg 43,35
zg 36,40
zg 37,41
zg 38,42
zg 39,43
zc 40,36,37
zc 41,38,39
zm 48,44
z9 44,136
zg 52,44
zm 49,45
z9 45,137
zg 53,45
zm 50,46
z9 46,138
zg 54,46
zm 51,47
z9 47,139
zg 55,47
zg 48,52
zg 49,53
zg 50,54
zg 51,55
zc 52,48,49
zc 53,50,51
zah 42,52,40
zah 43,53,41
zai 40,52
zai 41,53
zl 32,28,12288
zl 36,29,12288
zl 44,28,13312
zl 48,29,13312
zl 52,30,13312
zbh 0x49800
zbf 40,26
zv
zl 40,30,12288
ze 4
zm 36,32
z9 32,156
zm 37,33
z9 33,157
zm 38,34
z9 34,158
zm 39,35
z9 35,159
ze 0
zg 40,32
zg 41,33
zg 42,34
zg 43,35
zg 36,40
zg 37,41
zg 38,42
zg 39,43
zc 40,36,37
zc 41,38,39
zm 48,44
z9 44,160
zg 52,44
zm 49,45
z9 45,161
zg 53,45
zm 50,46
z9 46,162
zg 54,46
zm 51,47
z9 47,163
zg 55,47
zg 48,52
zg 49,53
zg 50,54
zg 51,55
zc 52,48,49
zc 53,50,51
zah 42,52,40
zah 43,53,41
zai 40,52
zai 41,53
zbh 0x54000
zbf 40,26
s_endpgm
Lf9_ayR0:
zda
s_cbranch_scc1 Lf9_ayG0
Lf9_ayRb0:
zi 88,8,4608
zi 90,8,4624
zi 92,8,4672
zi 94,8,4688
ze 15
za 0,156,76
zu 0
zi 96,8,4736
zi 98,8,4752
zb 204,1,12352
zb 206,1,13888
za 4,160,76
zb 208,2,12352
zb 210,2,13888
zb 212,1,12416
zb 214,1,13952
za 8,164,76
zb 216,2,12416
zb 218,2,13952
zb 196,1,12288
zb 198,1,13824
za 12,168,76
zb 200,2,12288
zb 202,2,13824
zx 36,69
zr 37,69
zf 220,148,76
zcl 38,48
zbs 39,33
z2 38
z2 39
zf 224,152,76
ze 15
zg 36,38
zg 37,39
zs 38
zs 39
za 0,180,80
zs 36
zs 37
zq 38,39
zq 36,37
za 4,184,80
zr 37,36
zav 36,38
zaw 36
z3 45,37
za 8,188,80
z3 44,36
z4 47,37,45
z4 46,36,44
zax 47
za 12,192,80
z5 36,46
z5 37,47
zbg 40,44,49
zay 41,45,50
zf 220,172,80
zw 38,36,37
zaz 36,47
za0 37,46
zw 39,46,47
zf 224,176,80
ze 0
za1 41,45
za2 41,51
za3 36,37
zas 37
za 0,204,84
za4 41,40
zq 38,39
zq 36,37
za5 37,52
za 4,208,84
zcm 40,44
zcn 39
za6 11,41
z8 17,38,7
za 8,212,84
zk 0,25,2048
za 12,216,84
zv
zk 4,25,3072
zf 220,196,84
z8 20,36,7
zco
zau 14,37,11
zcp
zf 224,200,84
zcq
Lf9_ayR1:
zdb
s_cbranch_scc1 Lf9_ayG1
Lf9_ayRb1:
zi 76,8,9216
zi 78,8,9232
zi 80,8,9280
zi 82,8,9296
za 16,156,88
zi 84,8,9344
zi 86,8,9360
za 16,180,92
zk 8,25,4096
za 16,204,96
zk 12,25,5120
za 20,160,88
zdl 220,25
za 20,184,92
zat 224,25,1024
za 20,208,96
zam
zk 16,25,8192
za 24,164,88
za 24,188,92
za 24,212,96
ze 1
s_barrier
zk 20,25,9216
za 28,168,88
za 28,192,92
za 28,216,96
zam
zk 24,25,10240
zf 228,148,88
zf 228,172,92
zf 228,196,96
zam
zk 28,25,11264
zf 232,152,88
zf 232,176,92
zf 232,200,96
zam
zat 228,25,6144
Lf9_ayR2:
zdc
s_cbranch_scc1 Lf9_ayG2
Lf9_ayRb2:
zi 88,8,13824
zi 90,8,13840
zi 92,8,13888
zi 94,8,13904
za 32,156,76
zi 96,8,13952
zi 98,8,13968
za 32,180,80
zat 232,25,7168
za 32,204,84
za 36,160,76
za 36,184,80
za 36,208,84
za 40,164,76
ze 0
s_barrier
zam
zk 32,25,14336
za 40,188,80
zv
zk 36,25,15360
za 40,212,84
za 44,168,76
za 44,192,80
za 44,216,84
zf 236,148,76
zbl
zk 40,25,16384
zf 236,172,80
zv
zk 44,25,17408
zf 236,196,84
zf 240,152,76
zf 240,176,80
zf 240,200,84
zcr
zat 236,25,12288
Lf9_ayR3:
zc5
s_cbranch_scc1 Lf9_ayG3
Lf9_ayRb3:
zi 76,8,18432
zi 78,8,18448
zi 80,8,18496
zi 82,8,18512
za 48,156,88
zi 84,8,18560
zi 86,8,18576
za 48,180,92
zat 240,25,13312
za 48,204,96
za 52,160,88
za 52,184,92
za 52,208,96
za 56,164,88
ze 0
s_barrier
zam
zk 48,25,2048
za 56,188,92
zv
zk 52,25,3072
za 56,212,96
za 60,168,88
za 60,192,92
za 60,216,96
zf 244,148,88
zbl
zk 56,25,4096
zf 244,172,92
zv
zk 60,25,5120
zf 244,196,96
zf 248,152,88
zf 248,176,92
zf 248,200,96
zcr
zdl 244,25
Lf9_ayR4:
zc0
s_cbranch_scc1 Lf9_ayG4
Lf9_ayRb4:
zi 88,8,23040
zi 90,8,23056
zi 92,8,23104
zi 94,8,23120
za 68,156,76
zi 96,8,23168
zi 98,8,23184
za 68,180,80
zat 248,25,1024
za 68,204,84
za 72,160,76
za 72,184,80
za 72,208,84
z7 76,164
ze 0
s_barrier
zam
zk 68,25,8192
za 76,188,80
zv
zk 72,25,9216
za 76,212,84
za 80,168,76
z7 80,192
za 80,216,84
zf 252,148,76
zbl
zk 76,25,10240
zf 252,172,80
zv
zk 80,25,11264
zf 252,196,84
za 64,152,76
za 64,176,80
za 64,200,84
zcr
zat 252,25,6144
Lf9_ayR5:
zd4
s_cbranch_scc1 Lf9_ayG5
Lf9_ayRb5:
zi 76,8,27648
zi 78,8,27664
zi 80,8,27712
zi 82,8,27728
za 92,156,88
zi 84,8,27776
zi 86,8,27792
z7 92,180
zk 64,25,7168
za 92,204,96
za 96,160,88
za 96,184,92
z7 96,208
za 100,164,88
ze 0
s_barrier
zam
zk 92,25,14336
za 100,188,92
zv
zk 96,25,15360
za 100,212,96
za 104,168,88
za 104,192,92
za 104,216,96
za 84,148,88
zbl
zk 100,25,16384
za 84,172,92
zv
zk 104,25,17408
za 84,196,96
z7 88,152
za 88,176,92
za 88,200,96
zcr
zk 84,25,12288
Lf9_ayR6:
zd5
s_cbranch_scc1 Lf9_ayG6
Lf9_ayRb6:
zi 88,8,32256
zi 90,8,32272
zi 92,8,32320
zi 94,8,32336
za 116,156,76
zi 96,8,32384
zi 98,8,32400
za 116,180,80
zk 88,25,13312
za 116,204,84
za 120,160,76
za 120,184,80
za 120,208,84
za 124,164,76
ze 0
s_barrier
zam
zk 116,25,2048
za 124,188,80
zv
zk 120,25,3072
za 124,212,84
za 128,168,76
za 128,192,80
za 128,216,84
za 108,148,76
zbl
zk 124,25,4096
za 108,172,80
zv
zk 128,25,5120
za 108,196,84
za 112,152,76
za 112,176,80
za 112,200,84
zcr
zfr 108,25
Lf9_ayR7:
zdy
s_cbranch_scc1 Lf9_ayG7
Lf9_ayRb7:
zi 76,8,36864
zi 78,8,36880
zi 80,8,36928
zi 82,8,36944
za 140,156,88
zi 84,8,36992
zi 86,8,37008
za 140,180,92
zk 112,25,1024
za 140,204,96
za 144,160,88
za 144,184,92
za 144,208,96
za 148,164,88
ze 0
s_barrier
zam
zk 140,25,8192
za 148,188,92
zv
zk 144,25,9216
za 148,212,96
za 152,168,88
za 152,192,92
za 152,216,96
za 132,148,88
zbl
zk 148,25,10240
za 132,172,92
zv
zk 152,25,11264
za 132,196,96
za 136,152,88
za 136,176,92
za 136,200,96
zcr
zk 132,25,6144
Lf9_ayR8:
Lf9_ayH8:
za 164,156,76
za 164,180,80
za 164,204,84
zcr
zk 136,25,7168
za 168,160,76
za 168,184,80
za 168,208,84
zk 164,25,14336
za 172,164,76
ze 1
s_barrier
za 172,188,80
za 172,212,84
zam
zk 168,25,15360
za 176,168,76
za 176,192,80
za 176,216,84
zam
zk 172,25,16384
za 156,148,76
za 156,172,80
za 156,196,84
zam
zk 176,25,17408
za 160,152,76
za 160,176,80
za 160,200,84
zam
zk 156,25,12288
zcr
zk 160,25,13312
ze 0
s_barrier
s_endpgm
Lf9_amH0:
Lf9_amG0:
zd6
s_cbranch_scc1 Lf9_amS0
zda
s_cbranch_scc0 Lf9_amRb0
ze 15
zf 220,148,76
ze3
zac 21,9,6
zac 22,12,6
zad 140,15,3
zf 224,152,76
zed
zo 100,21
zo 102,22
zb 104,21,16
za 0,156,76
zee 0x4800
zb 106,22,16
zb 108,21,64
zb 110,22,64
za 4,160,76
zef
zb 112,21,80
zb 114,22,80
zb 116,21,128
ze 15
za 8,164,76
zeg
zb 118,22,128
zb 120,21,144
za 12,168,76
zeh 0x1200
zb 122,22,144
zad 141,15,5
zf 220,172,80
zei
zad 142,18,3
zad 143,18,5
zf 224,176,80
zej 0xd0
zu 0
zb 196,1,12288
zb 198,1,13824
za 0,180,80
ze 12
zb 200,2,12288
zb 202,2,13824
zh 124,100,140
ze 12
zb 204,1,12352
zb 206,1,13888
zh 128,104,140
ze 12
zb 208,2,12352
zb 210,2,13888
zh 132,108,140
ze 11
zb 212,1,12416
zc 88,124,125
zh 136,112,140
zek 0x12d0
zc 89,126,127
zc 90,128,129
za 4,184,80
zel
zc 91,130,131
zc 92,132,133
ze 9
zh 124,116,140
zc 93,134,135
zc 94,136,137
zh 128,120,140
zem
zb 214,1,13952
zc 95,138,139
za 8,188,80
zen
zb 216,2,12416
zc 96,124,125
za 12,192,80
ze 6
zc 97,126,127
zc 98,128,129
zf 220,196,84
zeo
zb 218,2,13952
zc 99,130,131
zf 224,200,84
ze 3
zx 36,69
zr 37,69
za 0,204,84
zd 69,70
zd 70,71
za 4,208,84
ze 2
zd 71,72
zd 72,73
zcl 38,48
zbs 39,33
za 8,212,84
ze 0
za 12,216,84
Lf9_amH1:
Lf9_amG1:
zd7
s_cbranch_scc1 Lf9_amS1
zdb
s_cbranch_scc0 Lf9_amRb1
zf 228,148,88
ze 0
zaj 21,9,6
zaj 22,12,6
zak 140,15,3
zf 228,172,92
zo 100,21
zo 102,22
zb 104,21,16
zf 228,196,96
zb 106,22,16
zb 108,21,64
zb 110,22,64
zf 232,152,88
zb 112,21,80
zb 114,22,80
zb 116,21,128
zf 232,176,92
zb 118,22,128
zb 120,21,144
zb 122,22,144
zf 232,200,96
zak 141,15,5
zak 142,18,3
zak 143,18,5
za 16,156,88
zcg
zcu
z0 42
za 16,180,92
ze 10
zn 43,1024
zn 53,2048
zh 124,100,140
ze 8
z2 38
z2 39
zg 36,38
zh 128,104,140
ze 6
zg 37,39
zs 38
zh 132,108,140
ze 3
zc 76,124,125
zc 77,126,127
zh 136,112,140
zs 39
zc 78,128,129
za 16,204,96
ze 0
zc 79,130,131
zc 80,132,133
zh 124,116,140
zc 81,134,135
zc 82,136,137
zh 128,120,140
zc 83,138,139
zs 36
za 20,160,88
zs 37
zv
zc 84,124,125
za 20,184,92
zc 85,126,127
zc 86,128,129
za 20,208,96
zc 87,130,131
zq 38,39
za 24,164,88
zq 36,37
zr 37,36
za 24,188,92
zav 36,38
zaw 36
za 24,212,96
z3 45,37
z3 44,36
za 28,168,88
z4 47,37,45
z4 46,36,44
za 28,192,92
zax 47
z5 36,46
za 28,216,96
Lf9_amH2:
Lf9_amG2:
zd8
s_cbranch_scc1 Lf9_amS2
zdc
s_cbranch_scc0 Lf9_amRb2
ze 0
zf 236,148,76
zaq 21,9,6
zaq 22,12,6
zar 140,15,3
zf 236,172,80
zo 100,21
zo 102,22
zb 104,21,16
zf 236,196,84
zb 106,22,16
zb 108,21,64
zb 110,22,64
zf 240,152,76
zb 112,21,80
zb 114,22,80
zb 116,21,128
zf 240,176,80
zb 118,22,128
zb 120,21,144
zb 122,22,144
zf 240,200,84
zar 141,15,5
zar 142,18,3
zar 143,18,5
za 32,156,76
zn 42,3072
z6 0x1000
zag 0x1000
z0 43
za 32,180,80
ze 10
zn 53,1024
z5 37,47
zh 124,100,140
ze 8
zbg 40,44,49
zay 41,45,50
zh 128,104,140
ze 6
zw 38,36,37
zaz 36,47
zh 132,108,140
ze 3
za0 37,46
zc 88,124,125
zh 136,112,140
zc 89,126,127
zc 90,128,129
za 32,204,84
ze 0
zc 91,130,131
zc 92,132,133
zh 124,116,140
zc 93,134,135
zc 94,136,137
zh 128,120,140
zc 95,138,139
zw 39,46,47
za 36,160,76
za1 41,45
zv
zc 96,124,125
za 36,184,80
zc 97,126,127
zc 98,128,129
za 36,208,84
zc 99,130,131
za2 41,51
za 40,164,76
za3 36,37
zas 37
za 40,188,80
za4 41,40
zq 38,39
za 40,212,84
zq 36,37
za5 37,52
za 44,168,76
zcm 40,44
zcn 39
za 44,192,80
za6 11,41
z8 17,38,7
za 44,216,84
Lf9_amH3:
Lf9_amG3:
zdt
s_cbranch_scc1 Lf9_amS3
zc5
s_cbranch_scc0 Lf9_amRb3
ze 0
zf 244,148,88
zaa 21,10,6
zaa 22,13,6
zab 140,16,3
zf 244,172,92
zo 100,21
zo 102,22
zb 104,21,16
zf 244,196,96
zb 106,22,16
zb 108,21,64
zb 110,22,64
zf 248,152,88
zb 112,21,80
zb 114,22,80
zb 116,21,128
zf 248,176,92
zb 118,22,128
zb 120,21,144
zb 122,22,144
zf 248,200,96
zab 141,16,5
zab 142,19,3
zab 143,19,5
za 48,156,88
zn 42,2048
zn 43,3072
za 48,180,92
z6 0x2000
zag 0x2000
z0 53
ze 10
zh 124,100,140
ze 8
z8 20,36,7
zco
zh 128,104,140
ze 6
zau 14,37,11
zcp
zh 132,108,140
zcq
zx 36,58
zc 76,124,125
ze 2
zh 136,112,140
zc 77,126,127
zc 78,128,129
za 48,204,96
zc 79,130,131
zc 80,132,133
zh 124,116,140
ze 0
zc 81,134,135
zc 82,136,137
zh 128,120,140
zc 83,138,139
zr 37,58
za 52,160,88
zd 58,59
zc 84,124,125
za 52,184,92
zc 85,126,127
zv
zc 86,128,129
za 52,208,96
zc 87,130,131
zd 59,60
za 56,164,88
zd 60,61
zdx 38,48
za 56,188,92
zcj 39,33
z2 38
za 56,212,96
z2 39
zg 36,38
za 60,168,88
zg 37,39
zs 38
za 60,192,92
zs 39
zs 36
za 60,216,96
Lf9_amH4:
Lf9_amG4:
zc2
s_cbranch_scc1 Lf9_amS4
zc0
s_cbranch_scc0 Lf9_amRb4
ze 0
zf 252,148,76
zac 21,10,6
zac 22,13,6
zad 140,16,3
zf 252,172,80
zo 100,21
zo 102,22
zb 104,21,16
zf 252,196,84
zb 106,22,16
zb 108,21,64
zb 110,22,64
za 64,152,76
zb 112,21,80
zb 114,22,80
zb 116,21,128
za 64,176,80
zb 118,22,128
zb 120,21,144
zb 122,22,144
za 64,200,84
zad 141,16,5
zad 142,19,3
zad 143,19,5
za 68,156,76
zn 42,1024
zn 43,2048
za 68,180,80
ze 10
zn 53,3072
zs 37
zh 124,100,140
ze 8
zq 38,39
zq 36,37
zh 128,104,140
ze 6
zr 37,36
zav 36,38
zh 132,108,140
ze 4
zaw 36
zc 88,124,125
zh 136,112,140
zc 89,126,127
zc 90,128,129
za 68,204,84
ze 0
zc 91,130,131
zc 92,132,133
zh 124,116,140
zc 93,134,135
zc 94,136,137
zh 128,120,140
zc 95,138,139
z3 45,37
za 72,160,76
z3 44,36
zv
zc 96,124,125
za 72,184,80
zc 97,126,127
zc 98,128,129
za 72,208,84
zc 99,130,131
z4 47,37,45
z7 76,164
z4 46,36,44
zax 47
za 76,188,80
z5 36,46
z5 37,47
za 76,212,84
zbg 40,44,49
zay 41,45,50
za 80,168,76
zw 38,36,37
zaz 36,47
z7 80,192
za0 37,46
zw 39,46,47
za 80,216,84
Lf9_amH5:
Lf9_amG5:
zey
s_cbranch_scc1 Lf9_amS5
zd4
s_cbranch_scc0 Lf9_amRb5
ze 0
za 84,148,88
zaj 21,10,6
zaj 22,13,6
zak 140,16,3
za 84,172,92
zo 100,21
zo 102,22
zb 104,21,16
za 84,196,96
zb 106,22,16
zb 108,21,64
zb 110,22,64
z7 88,152
zb 112,21,80
zb 114,22,80
zb 116,21,128
za 88,176,92
zb 118,22,128
zb 120,21,144
zb 122,22,144
za 88,200,96
zak 141,16,5
zak 142,19,3
zak 143,19,5
za 92,156,88
z6 0x3000
zag 0x3000
z0 42
z7 92,180
zn 43,1024
za 92,204,96
ze 10
zn 53,2048
zh 124,100,140
ze 8
za1 41,45
za2 41,51
zh 128,104,140
ze 6
za3 36,37
zas 37
zh 132,108,140
ze 3
za4 41,40
zc 76,124,125
zh 136,112,140
zc 77,126,127
zc 78,128,129
za 96,160,88
ze 0
zc 79,130,131
zc 80,132,133
zh 124,116,140
zc 81,134,135
zc 82,136,137
zh 128,120,140
zc 83,138,139
zq 38,39
za 96,184,92
zq 36,37
zv
zc 84,124,125
z7 96,208
zc 85,126,127
zc 86,128,129
za 100,164,88
zc 87,130,131
za5 37,52
za 100,188,92
zdf 40,44
zdg 39
za 100,212,96
za6 9,41
z8 15,38,7
za 104,168,88
z8 18,36,7
zdh
za 104,192,92
zau 12,37,9
zdi
zdj
za 104,216,96
zx 36,64
Lf9_amH6:
Lf9_amG6:
zez
s_cbranch_scc1 Lf9_amS6
zd5
s_cbranch_scc0 Lf9_amRb6
ze 0
za 108,148,76
zaq 21,10,6
zaq 22,13,6
zar 140,16,3
za 112,152,76
zo 100,21
zo 102,22
zb 104,21,16
za 116,156,76
zb 106,22,16
zb 108,21,64
zb 110,22,64
za 120,160,76
zb 112,21,80
zb 114,22,80
zb 116,21,128
za 124,164,76
zb 118,22,128
zb 120,21,144
zb 122,22,144
za 128,168,76
zar 141,16,5
zar 142,19,3
zar 143,19,5
za 108,172,80
zn 42,3072
z6 0x4000
zag 0x4000
z0 43
za 112,176,80
ze 10
zn 53,1024
zr 37,64
zh 124,100,140
ze 8
zd 64,65
zd 65,66
zh 128,104,140
ze 6
zd 66,67
zfl 38,48
zh 132,108,140
ze 3
zcj 39,33
zc 88,124,125
zh 136,112,140
zc 89,126,127
zc 90,128,129
za 116,180,80
ze 0
zc 91,130,131
zc 92,132,133
zh 124,116,140
zc 93,134,135
zc 94,136,137
zh 128,120,140
zc 95,138,139
z2 38
za 120,184,80
z2 39
zv
zc 76,124,125
za 124,188,80
zc 77,126,127
zc 78,128,129
za 128,192,80
zc 79,130,131
zg 36,38
za 108,196,84
zg 37,39
zs 38
za 112,200,84
zs 39
zs 36
za 116,204,84
zs 37
zq 38,39
za 120,208,84
zq 36,37
zr 37,36
za 124,212,84
zav 36,38
zaw 36
za 128,216,84
Lf9_amH7:
Lf9_amG7:
zf7
s_cbranch_scc1 Lf9_amS7
zdy
s_cbranch_scc0 Lf9_amRb7
ze 0
za 132,148,88
zaa 21,11,6
zaa 22,14,6
zab 140,17,3
za 136,152,88
zo 100,21
zo 102,22
zb 104,21,16
za 140,156,88
zb 106,22,16
zb 108,21,64
zb 110,22,64
za 144,160,88
zb 112,21,80
zb 114,22,80
zb 116,21,128
za 148,164,88
zb 118,22,128
zb 120,21,144
zb 122,22,144
za 152,168,88
zab 141,17,5
zab 142,20,3
zab 143,20,5
za 132,172,92
z3 45,37
z3 44,36
z4 47,37,45
za 136,176,92
ze 10
z4 46,36,44
zax 47
z5 36,46
zh 124,100,140
ze 8
z5 37,47
zbg 40,44,49
zay 41,45,50
zh 128,104,140
ze 6
zw 38,36,37
zaz 36,47
za0 37,46
zh 132,108,140
ze 4
zc 84,124,125
zc 85,126,127
zw 39,46,47
zh 136,112,140
ze 2
zc 86,128,129
zc 87,130,131
zh 124,116,140
ze 0
zc 96,132,133
zc 97,134,135
zh 128,120,140
zc 98,136,137
zc 99,138,139
za 140,180,92
za1 41,45
zc 88,124,125
za 144,184,92
zc 89,126,127
zv
zc 90,128,129
za 148,188,92
zc 91,130,131
za2 41,51
za 152,192,92
za3 36,37
zas 37
za 132,196,76
za4 41,40
zq 38,39
za 136,200,76
zq 36,37
za5 37,52
za 140,204,76
zca 40,44
zcb 39
za 144,208,76
za6 10,41
z8 16,38,7
z8 19,36,7
za 148,212,76
zcc
zau 13,37,10
zcd
zce
za 152,216,76
Lf9_amH8:
Lf9_amG8:
zct
s_cbranch_scc1 Lf9_amS8
zcf
s_cbranch_scc0 Lf9_amRb8
ze 0
za 156,148,84
zbn
zbq 8,0
zaa 21,9,6
zaa 22,12,6
za 160,152,84
zbo
zo 100,21
zo 102,22
zb 104,21,16
za 164,156,84
zbp
zb 106,22,16
zb 108,21,64
zb 110,22,64
za 168,160,84
zf5
zb 112,21,80
zb 114,22,80
zb 116,21,128
za 172,164,84
zb 118,22,128
zb 120,21,144
zb 122,22,144
za 176,168,84
zab 140,15,3
zab 141,15,5
zab 142,18,3
za 156,172,96
zu 12
zo 148,1
zb 150,1,1536
zab 143,18,5
za 160,176,96
ze 12
zo 152,2
zb 154,2,1536
zb 156,1,64
zh 124,100,140
ze 13
zb 158,1,1600
zb 160,2,64
zb 162,2,1600
zh 128,104,140
ze 14
zb 164,1,128
zb 166,1,1664
zh 132,108,140
ze 14
zc 76,124,125
zc 77,126,127
zh 136,112,140
zb 168,2,128
zc 78,128,129
za 164,180,96
ze 11
zc 79,130,131
zc 80,132,133
zh 124,116,140
zc 81,134,135
zc 82,136,137
zh 128,120,140
zb 170,2,1664
zc 83,138,139
za 168,184,96
za 172,188,96
zv
zc 84,124,125
zc 85,126,127
za 176,192,96
zu 6
zb 172,1,6144
zc 86,128,129
zc 87,130,131
za 156,196,88
zb 174,1,7680
zb 176,2,6144
zb 178,2,7680
za 160,200,88
zb 180,1,6208
zb 182,1,7744
za 164,204,88
zb 184,2,6208
zb 186,2,7744
za 168,208,88
zb 188,1,6272
zb 190,1,7808
za 172,212,88
zb 192,2,6272
zb 194,2,7808
za 176,216,88
Lf9_amE2:
zgx
s_cbranch_scc1 Lf9_amH0
zde
s_cbranch_scc1 Lf9_ayH0
s_branch Lf9_azH0
Lf9_azH0:
Lf9_azG0:
zd6
s_cbranch_scc1 Lf9_azS0
zda
s_cbranch_scc0 Lf9_azRb0
ze 15
za 0,156,76
zac 21,9,6
zac 22,12,6
zad 140,15,3
zad 141,15,5
zad 142,18,3
za 4,160,76
ze 12
zo 100,21
zo 102,22
zb 104,21,16
zb 106,22,16
zb 108,21,64
za 8,164,76
zb 110,22,64
zb 112,21,80
zb 114,22,80
zb 116,21,128
za 12,168,76
zb 118,22,128
zb 120,21,144
zb 122,22,144
zad 143,18,5
zf 220,148,76
zu 0
zb 204,1,12352
zb 206,1,13888
zb 208,2,12352
zb 210,2,13888
zf 224,152,76
ze 15
zb 212,1,12416
zb 214,1,13952
zb 216,2,12416
zb 218,2,13952
za 0,180,80
ze 15
zb 196,1,12288
zb 198,1,13824
zb 200,2,12288
zb 202,2,13824
zh 124,100,140
zx 36,69
zr 37,69
zcl 38,48
zbs 39,33
zh 128,104,140
ze 15
z2 38
z2 39
zg 36,38
zc 88,124,125
zh 132,108,140
zc 89,126,127
zg 37,39
zs 38
zc 90,128,129
zh 136,112,140
ze 11
zc 91,130,131
zs 39
zs 36
zc 92,132,133
zh 124,116,140
zc 93,134,135
zs 37
zc 94,136,137
zc 95,138,139
zh 128,120,140
zq 38,39
zq 36,37
zr 37,36
zc 96,124,125
za 4,184,80
zc 97,126,127
zav 36,38
zaw 36
zc 98,128,129
za 8,188,80
zc 99,130,131
z3 45,37
z3 44,36
z4 47,37,45
za 12,192,80
z4 46,36,44
zax 47
z5 36,46
z5 37,47
zf 220,172,80
zbg 40,44,49
zay 41,45,50
zw 38,36,37
zaz 36,47
zf 224,176,80
ze 0
za0 37,46
zw 39,46,47
za1 41,45
za2 41,51
za 0,204,84
za3 36,37
zas 37
za4 41,40
zq 38,39
za 4,208,84
zq 36,37
za5 37,52
zcm 40,44
zcn 39
za 8,212,84
zk 0,25,2048
za 12,216,84
zv
zk 4,25,3072
za6 11,41
zf 220,196,84
z8 17,38,7
z8 20,36,7
zco
zau 14,37,11
zcp
zf 224,200,84
zcq
Lf9_azH1:
Lf9_azG1:
zd7
s_cbranch_scc1 Lf9_azS1
zdb
s_cbranch_scc0 Lf9_azRb1
za 16,156,88
zfo 0xffff0000
zaj 21,9,6
zaj 22,12,6
zak 140,15,3
za 16,180,92
zf6 0xffff0000
zo 100,21
zo 102,22
zb 104,21,16
za 16,204,96
zb 106,22,16
zb 108,21,64
zb 110,22,64
za 20,160,88
zb 112,21,80
zb 114,22,80
zb 116,21,128
za 20,184,92
zb 118,22,128
zb 120,21,144
zb 122,22,144
za 20,208,96
zak 141,15,5
zak 142,18,3
zak 143,18,5
za 24,164,88
zk 8,25,4096
za 24,188,92
ze 11
zk 12,25,5120
zh 124,100,140
ze 10
zk 16,25,8192
zh 128,104,140
ze 9
zk 20,25,9216
zh 132,108,140
ze 2
s_barrier
za7 32,28
za7 36,29
zh 136,112,140
za7 40,30
zl 44,28,1024
za 24,212,96
zl 48,29,1024
zl 52,30,1024
za 28,168,88
zc 76,124,125
zc 77,126,127
za 28,192,92
zc 78,128,129
zc 79,130,131
zh 124,116,140
zk 24,25,10240
zh 128,120,140
zc 80,132,133
zc 81,134,135
za 28,216,96
zc 82,136,137
zc 83,138,139
zf 228,148,88
zc 84,124,125
zc 85,126,127
zf 228,172,92
zc 86,128,129
zc 87,130,131
zf 228,196,96
zk 28,25,11264
zf 232,152,88
zf 232,176,92
zf 232,200,96
Lf9_azH2:
Lf9_azG2:
zd8
s_cbranch_scc1 Lf9_azS2
zdc
s_cbranch_scc0 Lf9_azRb2
za 32,156,76
zaq 21,9,6
zaq 22,12,6
zar 140,15,3
zar 141,15,5
za 32,180,80
zo 100,21
zo 102,22
zb 104,21,16
zb 106,22,16
za 32,204,84
zb 108,21,64
zb 110,22,64
zb 112,21,80
zb 114,22,80
za 36,160,76
zb 116,21,128
zb 118,22,128
zb 120,21,144
zb 122,22,144
za 36,184,80
zk 32,25,14336
zar 142,18,3
zar 143,18,5
za 36,208,84
ze 13
zm 36,32
zg 40,220
zm 37,33
zg 41,221
za 40,164,76
s_barrier
zm 38,34
zg 42,222
zm 39,35
ze 11
zh 124,100,140
ze 9
zk 36,25,15360
zh 128,104,140
ze 8
zl 32,28,6144
zg 43,223
zg 36,40
zg 37,41
zh 132,108,140
ze 7
zg 38,42
zg 39,43
zc 40,36,37
zc 41,38,39
zh 136,112,140
zl 36,29,6144
zc 88,124,125
zc 89,126,127
zc 90,128,129
za 40,188,80
ze 4
zc 91,130,131
zc 92,132,133
zc 93,134,135
zc 94,136,137
zh 124,116,140
zc 95,138,139
zm 48,44
zg 52,224
zm 49,45
zh 128,120,140
zg 53,225
zm 50,46
zg 54,226
zc 96,124,125
za 40,212,84
zc 97,126,127
zm 51,47
zg 55,227
zc 98,128,129
za 44,168,76
zl 44,28,7168
zc 99,130,131
zg 48,52
zg 49,53
za 44,192,80
zk 40,25,16384
za 44,216,84
zg 50,54
zg 51,55
zc 52,48,49
zc 53,50,51
zf 236,148,76
zl 48,29,7168
zah 42,52,40
zah 43,53,41
zf 236,172,80
zk 44,25,17408
zf 236,196,84
zai 40,52
zai 41,53
zf 240,152,76
zfn
zbf 40,26
zl 52,30,7168
zf 240,176,80
zl 40,30,6144
zf 240,200,84
Lf9_azH3:
Lf9_azG3:
zdt
s_cbranch_scc1 Lf9_azS3
zc5
s_cbranch_scc0 Lf9_azRb3
ze 6
za 48,156,88
zaa 21,10,6
zaa 22,13,6
zab 140,16,3
zab 141,16,5
za 48,180,92
zo 100,21
zo 102,22
zb 104,21,16
zb 106,22,16
za 48,204,96
zb 108,21,64
zb 110,22,64
zb 112,21,80
zb 114,22,80
za 52,160,88
zb 116,21,128
zb 118,22,128
zb 120,21,144
zb 122,22,144
za 52,184,92
zk 48,25,2048
zab 142,19,3
zab 143,19,5
za 52,208,96
ze 13
zm 36,32
zg 40,228
zm 37,33
zg 41,229
za 56,164,88
s_barrier
zm 38,34
zg 42,230
zm 39,35
ze 11
zh 124,100,140
ze 9
zk 52,25,3072
zh 128,104,140
ze 8
zl 32,28,12288
zg 43,231
zg 36,40
zg 37,41
zh 132,108,140
ze 7
zg 38,42
zg 39,43
zc 40,36,37
zc 41,38,39
zh 136,112,140
zl 36,29,12288
zc 76,124,125
zc 77,126,127
zc 78,128,129
za 56,188,92
ze 4
zc 79,130,131
zc 80,132,133
zc 81,134,135
zc 82,136,137
zh 124,116,140
zc 83,138,139
zm 48,44
zg 52,232
zm 49,45
zh 128,120,140
zg 53,233
zm 50,46
zg 54,234
zc 84,124,125
za 56,212,96
zc 85,126,127
zm 51,47
zg 55,235
zc 86,128,129
za 60,168,88
zl 44,28,13312
zc 87,130,131
zg 48,52
zg 49,53
za 60,192,92
zk 56,25,4096
za 60,216,96
zg 50,54
zg 51,55
zc 52,48,49
zc 53,50,51
zf 244,148,88
zl 48,29,13312
zah 42,52,40
zah 43,53,41
zf 244,172,92
zk 60,25,5120
zf 244,196,96
zai 40,52
zai 41,53
zf 248,152,88
zbh 0xa800
zbf 40,26
zl 52,30,13312
zf 248,176,92
zl 40,30,12288
zf 248,200,96
Lf9_azH4:
Lf9_azG4:
zc2
s_cbranch_scc1 Lf9_azS4
zc0
s_cbranch_scc0 Lf9_azRb4
ze 6
za 68,156,76
zac 21,10,6
zac 22,13,6
zad 140,16,3
zad 141,16,5
za 68,180,80
zo 100,21
zo 102,22
zb 104,21,16
zb 106,22,16
za 68,204,84
zb 108,21,64
zb 110,22,64
zb 112,21,80
zb 114,22,80
za 72,160,76
zb 116,21,128
zb 118,22,128
zb 120,21,144
zb 122,22,144
za 72,184,80
zk 68,25,8192
zad 142,19,3
zad 143,19,5
za 72,208,84
ze 13
zm 36,32
zg 40,236
zm 37,33
zg 41,237
z7 76,164
s_barrier
zm 38,34
zg 42,238
zm 39,35
ze 11
zh 124,100,140
ze 9
zk 72,25,9216
zh 128,104,140
ze 8
za7 32,28
zg 43,239
zg 36,40
zg 37,41
zh 132,108,140
ze 7
zg 38,42
zg 39,43
zc 40,36,37
zc 41,38,39
zh 136,112,140
za7 36,29
zc 88,124,125
zc 89,126,127
zc 90,128,129
za 76,188,80
ze 4
zc 91,130,131
zc 92,132,133
zc 93,134,135
zc 94,136,137
zh 124,116,140
zc 95,138,139
zm 48,44
zg 52,240
zm 49,45
zh 128,120,140
zg 53,241
zm 50,46
zg 54,242
zc 96,124,125
za 76,212,84
zc 97,126,127
zm 51,47
zg 55,243
zc 98,128,129
za 80,168,76
zl 44,28,1024
zc 99,130,131
zg 48,52
zg 49,53
z7 80,192
zk 76,25,10240
za 80,216,84
zg 50,54
zg 51,55
zc 52,48,49
zc 53,50,51
zf 252,148,76
zl 48,29,1024
zah 42,52,40
zah 43,53,41
zf 252,172,80
zk 80,25,11264
zf 252,196,84
zai 40,52
zai 41,53
za 64,152,76
zbh 0x15000
zbf 40,26
zl 52,30,1024
za 64,176,80
za7 40,30
za 64,200,84
Lf9_azH5:
Lf9_azG5:
zey
s_cbranch_scc1 Lf9_azS5
zd4
s_cbranch_scc0 Lf9_azRb5
ze 6
za 92,156,88
zaj 21,10,6
zaj 22,13,6
zak 140,16,3
zak 141,16,5
z7 92,180
zo 100,21
zo 102,22
zb 104,21,16
zb 106,22,16
za 92,204,96
zb 108,21,64
zb 110,22,64
zb 112,21,80
zb 114,22,80
za 96,160,88
zb 116,21,128
zb 118,22,128
zb 120,21,144
zb 122,22,144
za 96,184,92
zk 92,25,14336
zak 142,19,3
zak 143,19,5
z7 96,208
ze 13
zm 36,32
zg 40,244
zm 37,33
zg 41,245
za 100,164,88
s_barrier
zm 38,34
zg 42,246
zm 39,35
ze 11
zh 124,100,140
ze 9
zk 96,25,15360
zh 128,104,140
ze 8
zl 32,28,6144
zg 43,247
zg 36,40
zg 37,41
zh 132,108,140
ze 7
zg 38,42
zg 39,43
zc 40,36,37
zc 41,38,39
zh 136,112,140
zl 36,29,6144
zc 76,124,125
zc 77,126,127
zc 78,128,129
za 100,188,92
ze 4
zc 79,130,131
zc 80,132,133
zc 81,134,135
zc 82,136,137
zh 124,116,140
zc 83,138,139
zm 48,44
zg 52,248
zm 49,45
zh 128,120,140
zg 53,249
zm 50,46
zg 54,250
zc 84,124,125
za 100,212,96
zc 85,126,127
zm 51,47
zg 55,251
zc 86,128,129
za 104,168,88
zl 44,28,7168
zc 87,130,131
zg 48,52
zg 49,53
za 104,192,92
zk 100,25,16384
za 104,216,96
zg 50,54
zg 51,55
zc 52,48,49
zc 53,50,51
za 84,148,88
zl 48,29,7168
zah 42,52,40
zah 43,53,41
za 84,172,92
zk 104,25,17408
za 84,196,96
zai 40,52
zai 41,53
z7 88,152
zbh 0x1f800
zbf 40,26
zl 52,30,7168
za 88,176,92
zl 40,30,6144
za 88,200,96
Lf9_azH6:
Lf9_azG6:
zez
s_cbranch_scc1 Lf9_azS6
zd5
s_cbranch_scc0 Lf9_azRb6
ze 6
za 116,156,76
zaq 21,10,6
zaq 22,13,6
zar 140,16,3
zar 141,16,5
zar 142,19,3
za 116,180,80
zo 100,21
zo 102,22
zb 104,21,16
zb 106,22,16
za 116,204,84
zb 108,21,64
zb 110,22,64
zb 112,21,80
zb 114,22,80
za 120,160,76
zb 116,21,128
zb 118,22,128
zb 120,21,144
zb 122,22,144
za 120,184,80
zk 116,25,2048
zar 143,19,5
za 120,208,84
ze 13
zm 36,32
zg 40,252
zm 37,33
zg 41,253
za 124,164,76
s_barrier
zm 38,34
zg 42,254
zm 39,35
ze 11
zh 124,100,140
ze 9
zk 120,25,3072
zh 128,104,140
ze 8
zl 32,28,12288
zg 43,255
zg 36,40
zg 37,41
zh 132,108,140
ze 7
zg 38,42
zg 39,43
zc 40,36,37
zc 41,38,39
zh 136,112,140
zl 36,29,12288
zc 88,124,125
zc 89,126,127
zc 90,128,129
za 124,188,80
ze 4
zc 91,130,131
zc 92,132,133
zc 93,134,135
zc 94,136,137
zh 124,116,140
zc 95,138,139
zm 48,44
z9 44,64
zg 52,44
zh 128,120,140
zm 49,45
z9 45,65
zg 53,45
zc 96,124,125
za 124,212,84
zc 97,126,127
zm 50,46
z9 46,66
zc 98,128,129
za 128,168,76
zc 99,130,131
zg 54,46
zm 51,47
z9 47,67
za 128,192,80
zk 124,25,4096
za 128,216,84
zg 55,47
zg 48,52
zg 49,53
zg 50,54
za 108,148,76
zl 44,28,13312
zg 51,55
zc 52,48,49
zc 53,50,51
za 108,172,80
zk 128,25,5120
za 108,196,84
zl 48,29,13312
zah 42,52,40
zah 43,53,41
zai 40,52
za 112,152,76
zai 41,53
za 112,176,80
zbh 0x2a000
zbf 40,26
zl 52,30,13312
zl 40,30,12288
za 112,200,84
Lf9_azH7:
Lf9_azG7:
zf7
s_cbranch_scc1 Lf9_azS7
zdy
s_cbranch_scc0 Lf9_azRb7
ze 6
za 140,156,88
zaa 21,11,6
zaa 22,14,6
zab 140,17,3
zab 141,17,5
zab 142,20,3
za 140,180,92
zo 100,21
zo 102,22
zb 104,21,16
zb 106,22,16
zb 108,21,64
za 140,204,96
zb 110,22,64
zb 112,21,80
zb 114,22,80
zb 116,21,128
zb 118,22,128
za 144,160,88
zb 120,21,144
zb 122,22,144
zk 140,25,8192
zab 143,20,5
za 144,184,92
ze 13
zm 36,32
z9 32,84
zg 40,32
zm 37,33
za 144,208,96
ze 11
z9 33,85
zg 41,33
zm 38,34
z9 34,86
zh 124,100,140
ze 9
zv
zk 144,25,9216
zg 42,34
zm 39,35
z9 35,87
zh 128,104,140
ze 8
zg 43,35
zg 36,40
zg 37,41
zg 38,42
zh 132,108,140
ze 5
zg 39,43
zc 40,36,37
zc 41,38,39
zc 76,124,125
zh 136,112,140
ze 2
zc 77,126,127
zc 78,128,129
zc 79,130,131
zc 80,132,133
zh 124,116,140
zc 81,134,135
zm 48,44
z9 44,88
zc 82,136,137
zh 128,120,140
zc 83,138,139
zg 52,44
zm 49,45
zc 84,124,125
za 148,164,88
s_barrier
za7 32,28
za7 36,29
zc 85,126,127
za 148,188,92
zc 86,128,129
zc 87,130,131
z9 45,89
zg 53,45
za 148,212,96
zm 50,46
z9 46,90
zg 54,46
zm 51,47
za 152,168,88
z9 47,91
zg 55,47
zg 48,52
zg 49,53
za 152,192,92
zk 148,25,10240
za 152,216,96
zl 44,28,1024
zg 50,54
zg 51,55
zc 52,48,49
za 132,148,88
zc 53,50,51
zah 42,52,40
zah 43,53,41
zai 40,52
za 132,172,92
zk 152,25,11264
za 132,196,96
zl 48,29,1024
zai 41,53
za 136,152,88
zbh 0x34800
zbf 40,26
zl 52,30,1024
za 136,176,92
za7 40,30
za 136,200,96
s_branch Lf9_azR8
Lf9_azE2:
Lf9_ayH0:
Lf9_ayG0:
zd6
s_cbranch_scc1 Lf9_ayS0
zda
s_cbranch_scc0 Lf9_ayRb0
ze 15
za 0,156,76
zac 21,9,6
zac 22,12,6
zad 140,15,3
zad 141,15,5
zad 142,18,3
za 4,160,76
ze 12
zo 100,21
zo 102,22
zb 104,21,16
zb 106,22,16
zb 108,21,64
za 8,164,76
zb 110,22,64
zb 112,21,80
zb 114,22,80
zb 116,21,128
za 12,168,76
zb 118,22,128
zb 120,21,144
zb 122,22,144
zad 143,18,5
zf 220,148,76
zu 0
zb 204,1,12352
zb 206,1,13888
zb 208,2,12352
zb 210,2,13888
zf 224,152,76
ze 15
zb 212,1,12416
zb 214,1,13952
zb 216,2,12416
zb 218,2,13952
za 0,180,80
ze 15
zb 196,1,12288
zb 198,1,13824
zb 200,2,12288
zb 202,2,13824
zh 124,100,140
zx 36,69
zr 37,69
zcl 38,48
zbs 39,33
zh 128,104,140
ze 15
z2 38
z2 39
zg 36,38
zc 88,124,125
zh 132,108,140
zc 89,126,127
zg 37,39
zs 38
zc 90,128,129
zh 136,112,140
ze 11
zc 91,130,131
zs 39
zs 36
zc 92,132,133
zh 124,116,140
zc 93,134,135
zs 37
zc 94,136,137
zc 95,138,139
zh 128,120,140
zq 38,39
zq 36,37
zr 37,36
zc 96,124,125
za 4,184,80
zc 97,126,127
zav 36,38
zaw 36
zc 98,128,129
za 8,188,80
zc 99,130,131
z3 45,37
z3 44,36
z4 47,37,45
za 12,192,80
z4 46,36,44
zax 47
z5 36,46
z5 37,47
zf 220,172,80
zbg 40,44,49
zay 41,45,50
zw 38,36,37
zaz 36,47
zf 224,176,80
ze 0
za0 37,46
zw 39,46,47
za1 41,45
za2 41,51
za 0,204,84
za3 36,37
zas 37
za4 41,40
zq 38,39
za 4,208,84
zq 36,37
za5 37,52
zcm 40,44
zcn 39
za 8,212,84
zk 0,25,2048
za 12,216,84
zv
zk 4,25,3072
za6 11,41
zf 220,196,84
z8 17,38,7
z8 20,36,7
zco
zau 14,37,11
zcp
zf 224,200,84
zcq
Lf9_ayH1:
Lf9_ayG1:
zd7
s_cbranch_scc1 Lf9_ayS1
zdb
s_cbranch_scc0 Lf9_ayRb1
za 16,156,88
zaj 21,9,6
zaj 22,12,6
zak 140,15,3
za 16,180,92
zo 100,21
zo 102,22
zb 104,21,16
za 16,204,96
zb 106,22,16
zb 108,21,64
zb 110,22,64
za 20,160,88
zb 112,21,80
zb 114,22,80
zb 116,21,128
za 20,184,92
zb 118,22,128
zb 120,21,144
zb 122,22,144
za 20,208,96
zak 141,15,5
zak 142,18,3
zak 143,18,5
za 24,164,88
zk 8,25,4096
za 24,188,92
ze 11
zk 12,25,5120
zh 124,100,140
ze 10
zdl 220,25
zh 128,104,140
ze 9
zat 224,25,1024
zh 132,108,140
ze 8
zk 16,25,8192
zh 136,112,140
zk 20,25,9216
za 24,212,96
ze 2
s_barrier
zc 76,124,125
zc 77,126,127
za 28,168,88
zc 78,128,129
zc 79,130,131
zc 80,132,133
zh 124,116,140
zk 24,25,10240
zc 81,134,135
zh 128,120,140
zc 82,136,137
zc 83,138,139
za 28,192,92
zam
zc 84,124,125
zc 85,126,127
za 28,216,96
zf 228,148,88
zc 86,128,129
zc 87,130,131
zf 228,172,92
zf 228,196,96
zf 232,152,88
zam
zk 28,25,11264
zf 232,176,92
zb0
zat 228,25,6144
zf 232,200,96
Lf9_ayH2:
Lf9_ayG2:
zd8
s_cbranch_scc1 Lf9_ayS2
zdc
s_cbranch_scc0 Lf9_ayRb2
za 32,156,76
zaq 21,9,6
zaq 22,12,6
zar 140,15,3
za 32,180,80
zo 100,21
zo 102,22
zb 104,21,16
za 32,204,84
zb 106,22,16
zb 108,21,64
zb 110,22,64
za 36,160,76
zb 112,21,80
zb 114,22,80
zb 116,21,128
za 36,184,80
zb 118,22,128
zb 120,21,144
zb 122,22,144
za 36,208,84
zar 141,15,5
zar 142,18,3
zar 143,18,5
za 40,164,76
zat 232,25,7168
za 40,188,80
ze 11
zk 32,25,14336
zh 124,100,140
ze 10
zk 36,25,15360
zh 128,104,140
ze 2
s_barrier
zh 132,108,140
zh 136,112,140
zv
zc 88,124,125
zc 89,126,127
za 40,212,84
za 44,168,76
zc 90,128,129
zc 91,130,131
zc 92,132,133
zh 124,116,140
zb0
zk 40,25,16384
zc 93,134,135
zh 128,120,140
zc 94,136,137
zc 95,138,139
za 44,192,80
zc 96,124,125
zc 97,126,127
za 44,216,84
zf 236,148,76
zv
zc 98,128,129
zc 99,130,131
zf 236,172,80
zf 236,196,84
zf 240,152,76
zv
zk 44,25,17408
zf 240,176,80
zbl
zat 236,25,12288
zf 240,200,84
Lf9_ayH3:
Lf9_ayG3:
zdt
s_cbranch_scc1 Lf9_ayS3
zc5
s_cbranch_scc0 Lf9_ayRb3
za 48,156,88
zaa 21,10,6
zaa 22,13,6
zab 140,16,3
za 48,180,92
zo 100,21
zo 102,22
zb 104,21,16
za 48,204,96
zb 106,22,16
zb 108,21,64
zb 110,22,64
za 52,160,88
zb 112,21,80
zb 114,22,80
zb 116,21,128
za 52,184,92
zb 118,22,128
zb 120,21,144
zb 122,22,144
za 52,208,96
zab 141,16,5
zab 142,19,3
zab 143,19,5
za 56,164,88
zat 240,25,13312
za 56,188,92
ze 11
zk 48,25,2048
zh 124,100,140
ze 10
zk 52,25,3072
zh 128,104,140
ze 2
s_barrier
zh 132,108,140
zh 136,112,140
zv
zc 76,124,125
zc 77,126,127
za 56,212,96
za 60,168,88
zc 78,128,129
zc 79,130,131
zc 80,132,133
zh 124,116,140
zb0
zk 56,25,4096
zc 81,134,135
zh 128,120,140
zc 82,136,137
zc 83,138,139
za 60,192,92
zc 84,124,125
zc 85,126,127
za 60,216,96
zf 244,148,88
zv
zc 86,128,129
zc 87,130,131
zf 244,172,92
zf 244,196,96
zf 248,152,88
zv
zk 60,25,5120
zf 248,176,92
zbl
zdl 244,25
zf 248,200,96
Lf9_ayH4:
Lf9_ayG4:
zc2
s_cbranch_scc1 Lf9_ayS4
zc0
s_cbranch_scc0 Lf9_ayRb4
za 68,156,76
zac 21,10,6
zac 22,13,6
zad 140,16,3
za 68,180,80
zo 100,21
zo 102,22
zb 104,21,16
za 68,204,84
zb 106,22,16
zb 108,21,64
zb 110,22,64
za 72,160,76
zb 112,21,80
zb 114,22,80
zb 116,21,128
za 72,184,80
zb 118,22,128
zb 120,21,144
zb 122,22,144
za 72,208,84
zad 141,16,5
zad 142,19,3
zad 143,19,5
z7 76,164
zat 248,25,1024
za 76,188,80
ze 11
zk 68,25,8192
zh 124,100,140
ze 10
zk 72,25,9216
zh 128,104,140
ze 2
s_barrier
zh 132,108,140
zh 136,112,140
zv
zc 88,124,125
zc 89,126,127
za 76,212,84
za 80,168,76
zc 90,128,129
zc 91,130,131
zc 92,132,133
zh 124,116,140
zb0
zk 76,25,10240
zc 93,134,135
zh 128,120,140
zc 94,136,137
zc 95,138,139
z7 80,192
zc 96,124,125
zc 97,126,127
za 80,216,84
zf 252,148,76
zv
zc 98,128,129
zc 99,130,131
zf 252,172,80
zf 252,196,84
za 64,152,76
zv
zk 80,25,11264
za 64,176,80
zbl
zat 252,25,6144
za 64,200,84
Lf9_ayH5:
Lf9_ayG5:
zey
s_cbranch_scc1 Lf9_ayS5
zd4
s_cbranch_scc0 Lf9_ayRb5
za 92,156,88
zaj 21,10,6
zaj 22,13,6
zak 140,16,3
z7 92,180
zo 100,21
zo 102,22
zb 104,21,16
za 92,204,96
zb 106,22,16
zb 108,21,64
zb 110,22,64
za 96,160,88
zb 112,21,80
zb 114,22,80
zb 116,21,128
za 96,184,92
zb 118,22,128
zb 120,21,144
zb 122,22,144
z7 96,208
zak 141,16,5
zak 142,19,3
zak 143,19,5
za 100,164,88
zk 64,25,7168
za 100,188,92
ze 11
zk 92,25,14336
zh 124,100,140
ze 10
zk 96,25,15360
zh 128,104,140
ze 2
s_barrier
zh 132,108,140
zh 136,112,140
zv
zc 76,124,125
zc 77,126,127
za 100,212,96
za 104,168,88
zc 78,128,129
zc 79,130,131
zc 80,132,133
zh 124,116,140
zb0
zk 100,25,16384
zc 81,134,135
zh 128,120,140
zc 82,136,137
zc 83,138,139
za 104,192,92
zc 84,124,125
zc 85,126,127
za 104,216,96
za 84,148,88
zv
zc 86,128,129
zc 87,130,131
za 84,172,92
za 84,196,96
z7 88,152
zv
zk 104,25,17408
za 88,176,92
zbl
zk 84,25,12288
za 88,200,96
Lf9_ayH6:
Lf9_ayG6:
zez
s_cbranch_scc1 Lf9_ayS6
zd5
s_cbranch_scc0 Lf9_ayRb6
za 116,156,76
zaq 21,10,6
zaq 22,13,6
zar 140,16,3
za 116,180,80
zo 100,21
zo 102,22
zb 104,21,16
za 116,204,84
zb 106,22,16
zb 108,21,64
zb 110,22,64
za 120,160,76
zb 112,21,80
zb 114,22,80
zb 116,21,128
za 120,184,80
zb 118,22,128
zb 120,21,144
zb 122,22,144
za 120,208,84
zar 141,16,5
zar 142,19,3
zar 143,19,5
za 124,164,76
zk 88,25,13312
za 124,188,80
ze 11
zk 116,25,2048
zh 124,100,140
ze 10
zk 120,25,3072
zh 128,104,140
ze 2
s_barrier
zh 132,108,140
zh 136,112,140
zv
zc 88,124,125
zc 89,126,127
za 124,212,84
za 128,168,76
zc 90,128,129
zc 91,130,131
zc 92,132,133
zh 124,116,140
zb0
zk 124,25,4096
zc 93,134,135
zh 128,120,140
zc 94,136,137
zc 95,138,139
za 128,192,80
zc 96,124,125
zc 97,126,127
za 128,216,84
za 108,148,76
zv
zc 98,128,129
zc 99,130,131
za 108,172,80
za 108,196,84
za 112,152,76
zv
zk 128,25,5120
za 112,176,80
zbl
zfr 108,25
za 112,200,84
Lf9_ayH7:
Lf9_ayG7:
zf7
s_cbranch_scc1 Lf9_ayS7
zdy
s_cbranch_scc0 Lf9_ayRb7
za 140,156,88
zaa 21,11,6
zaa 22,14,6
zab 140,17,3
za 140,180,92
zo 100,21
zo 102,22
zb 104,21,16
za 140,204,96
zb 106,22,16
zb 108,21,64
zb 110,22,64
za 144,160,88
zb 112,21,80
zb 114,22,80
zb 116,21,128
za 144,184,92
zb 118,22,128
zb 120,21,144
zb 122,22,144
za 144,208,96
zab 141,17,5
zab 142,20,3
zab 143,20,5
za 148,164,88
zk 112,25,1024
za 148,188,92
ze 11
zk 140,25,8192
zh 124,100,140
ze 10
zk 144,25,9216
zh 128,104,140
ze 2
s_barrier
zh 132,108,140
zh 136,112,140
zv
zc 76,124,125
zc 77,126,127
za 148,212,96
za 152,168,88
zc 78,128,129
zc 79,130,131
zc 80,132,133
zh 124,116,140
zb0
zk 148,25,10240
zc 81,134,135
zh 128,120,140
zc 82,136,137
zc 83,138,139
za 152,192,92
zc 84,124,125
zc 85,126,127
za 152,216,96
za 132,148,88
zv
zc 86,128,129
zc 87,130,131
za 132,172,92
za 132,196,96
za 136,152,88
zv
zk 152,25,11264
za 136,176,92
zbl
zk 132,25,6144
za 136,200,96
s_branch Lf9_ayR8
Lf9_ayE2:
Lf9_aqH0:
zu 19
s_barrier
Lf9_aqG0:
zct
s_cbranch_scc1 Lf9_aqS0
zcf
s_cbranch_scc0 Lf9_aqRb0
zaa 21,9,6
zaa 22,12,6
zab 140,15,3
zab 141,15,5
zab 142,18,3
zab 143,18,5
zo 100,21
zo 102,22
zb 104,21,16
zb 106,22,16
zb 108,21,64
zb 110,22,64
zb 112,21,80
zb 114,22,80
zb 116,21,128
zb 118,22,128
zb 120,21,144
zb 122,22,144
zu 13
zo 148,1
zb 150,1,1536
zo 152,2
zb 154,2,1536
zb 156,1,64
zb 158,1,1600
zb 160,2,64
zb 162,2,1600
zb 164,1,128
zb 166,1,1664
zb 168,2,128
zb 170,2,1664
zu 7
zb 172,1,6144
zb 174,1,7680
zb 176,2,6144
zb 178,2,7680
zb 180,1,6208
zb 182,1,7744
zb 184,2,6208
zb 186,2,7744
zb 188,1,6272
ze 15
zh 124,100,140
zb 190,1,7808
zb 192,2,6272
zb 194,2,7808
zh 128,104,140
zh 132,108,140
zh 136,112,140
zam
zc 76,124,125
zc 77,126,127
zam
zc 78,128,129
zc 79,130,131
zh 124,116,140
zc 80,132,133
zc 81,134,135
zc 82,136,137
zc 83,138,139
zh 128,120,140
zb0
zc 84,124,125
zc 85,126,127
zb0
zc 86,128,129
zc 87,130,131
Lf9_aqE2:
s_branch Lf9_atH0
Lf9_atH0:
Lf9_atG0:
zd6
s_cbranch_scc1 Lf9_atS0
zda
s_cbranch_scc0 Lf9_atRb0
ze 15
zh 220,148,76
zac 21,9,6
zac 22,12,6
zad 140,15,3
zh 224,152,76
zo 100,21
zo 102,22
zb 104,21,16
zp 0,156,76
zb 106,22,16
zb 108,21,64
zb 110,22,64
zp 4,160,76
ze 15
zb 112,21,80
zb 114,22,80
zb 116,21,128
zp 8,164,76
zb 118,22,128
zb 120,21,144
zb 122,22,144
zp 12,168,76
zad 141,15,5
zad 142,18,3
zad 143,18,5
zf 220,172,80
zu 1
zb 196,1,12288
zb 198,1,13824
zb 200,2,12288
ze 15
zf 224,176,80
ze 13
zb 202,2,13824
zb 204,1,12352
zb 206,1,13888
zh 124,100,140
ze 14
zb 208,2,12352
zb 210,2,13888
zb 212,1,12416
zh 128,104,140
ze 15
zb 214,1,13952
zb 216,2,12416
zb 218,2,13952
zh 132,108,140
zf1
zcv
zcw 0xdf
zbt 0xa800
zdd 0x9000
zc 88,124,125
zc 89,126,127
ze 12
zh 136,112,140
zc 90,128,129
zc 91,130,131
zh 124,116,140
zc 92,132,133
zc 93,134,135
zh 128,120,140
zam
zc 94,136,137
zc 95,138,139
za 0,180,80
zcx
zv
zae 25
za 4,184,80
zc 96,124,125
zc 97,126,127
za 8,188,80
zc 98,128,129
zc 99,130,131
za 12,192,80
zan 0x400
zv
zae 26
ze 0
zf 220,196,84
zan 0x800
zv
zae 27
zf 224,200,84
zan 0xc00
zv
zae 28
za 0,204,84
zcy 0x3fffffff
zan 0x1000
zv
zae 29
zcz
za 4,208,84
za 8,212,84
za 12,216,84
Lf9_atH1:
Lf9_atG1:
zd7
s_cbranch_scc1 Lf9_atS1
zdb
s_cbranch_scc0 Lf9_atRb1
ze 0
zh 228,148,88
zaj 21,9,6
zaj 22,12,6
zak 140,15,3
zak 141,15,5
zf 228,172,92
zo 100,21
zo 102,22
zb 104,21,16
zb 106,22,16
zf 228,196,96
zb 108,21,64
zb 110,22,64
zb 112,21,80
zh 232,152,88
zb 114,22,80
zb 116,21,128
zb 118,22,128
zf 232,176,92
zb 120,21,144
zb 122,22,144
zak 142,18,3
zf 232,200,96
zgj
zcv
zcw 0xdf
zbt 0xa800
zdd 0xd800
zak 143,18,5
zp 16,156,88
zid
zgk
s_cselect_b32 s42, 0x23000, s42
zcx
zv
zae 25
ze 10
zh 124,100,140
zan 0x400
zv
zae 26
zan 0x800
zv
zae 27
ze 4
zh 128,104,140
zan 0xc00
zv
zae 28
zc 76,124,125
zh 132,108,140
zcy 0x3fffffff
zan 0x1000
zv
zae 29
zcz
zc 77,126,127
zh 136,112,140
ze 0
zc 78,128,129
zc 79,130,131
zc 80,132,133
zh 124,116,140
zc8 0x2bc00
zfi 68,35
zc 81,134,135
zu 11
zx 36,62
zh 128,120,140
zc 82,136,137
zc 83,138,139
zr 37,62
za 16,180,92
zc 84,124,125
zc 85,126,127
zci 38,48
za 16,204,96
zc 86,128,129
zc 87,130,131
zbs 39,33
zp 20,160,88
z2 38
z2 39
zg 36,38
za 20,184,92
zg 37,39
zs 38
zs 39
za 20,208,96
zs 36
zs 37
zp 24,164,88
zq 38,39
zq 36,37
za 24,188,92
zr 37,36
zav 36,38
za 24,212,96
zaw 36
z3 45,37
zp 28,168,88
z3 44,36
z4 47,37,45
za 28,192,92
zbr 0x11000
zdw 1
zdw 2
za 28,216,96
Lf9_atH2:
zu 6
s_barrier
Lf9_atG2:
zd8
s_cbranch_scc1 Lf9_atS2
zdc
s_cbranch_scc0 Lf9_atRb2
ze 0
zh 236,148,76
zaq 21,9,6
zaq 22,12,6
zar 140,15,3
zf 236,172,80
zo 100,21
zo 102,22
zb 104,21,16
zf 236,196,84
zb 106,22,16
zb 108,21,64
zb 110,22,64
zh 240,152,76
zb 112,21,80
zb 114,22,80
zb 116,21,128
zf 240,176,80
zb 118,22,128
zb 120,21,144
zb 122,22,144
zf 240,200,84
zar 141,15,5
zar 142,18,3
zar 143,18,5
zp 32,156,76
zf2 32,35
z6 0x3000
zc7 0x3000
z0 42
za 32,180,80
ze 10
zn 43,1024
zn 53,2048
zh 124,100,140
ze 8
z4 46,36,44
zci 38,48
z2 38
zh 128,104,140
ze 6
zd1 39,49
zd2 38,39
zax 47
zh 132,108,140
ze 2
zc 88,124,125
zc 89,126,127
z5 36,46
zh 136,112,140
zc 90,128,129
zc 91,130,131
z5 37,47
zh 124,116,140
ze 0
zc 92,132,133
zc 93,134,135
zd3 40,44,49,38
zh 128,120,140
zc 94,136,137
zc 95,138,139
zay 41,45,50
za 32,204,84
zc 96,124,125
zc 97,126,127
zw 38,36,37
zp 36,160,76
zc 98,128,129
zc 99,130,131
zaz 36,47
za 36,184,80
za0 37,46
zw 39,46,47
za1 41,45
za 36,208,84
za2 41,51
za3 36,37
zas 37
zp 40,164,76
za4 41,40
zq 38,39
za 40,188,80
zq 36,37
za5 37,52
za 40,212,84
zca 40,44
zcb 39
zp 44,168,76
za6 10,41
z8 16,38,7
z8 19,36,7
za 44,192,80
zcc
zau 13,37,10
zcd
zce
za 44,216,84
Lf9_atH3:
Lf9_atG3:
zdt
s_cbranch_scc1 Lf9_atS3
zc5
s_cbranch_scc0 Lf9_atRb3
ze 0
zh 244,148,88
zaa 21,10,6
zaa 22,13,6
zab 140,16,3
zab 141,16,5
zf 244,172,92
zo 100,21
zo 102,22
zb 104,21,16
zb 106,22,16
zf 244,196,96
zb 108,21,64
zb 110,22,64
zb 112,21,80
zb 114,22,80
zh 248,152,88
zb 116,21,128
zb 118,22,128
zb 120,21,144
zb 122,22,144
zf 248,176,92
ze5
zc6 60,35,16
zab 142,19,3
zab 143,19,5
zf 248,200,96
z6 0x3000
zc7 0x3000
zn 42,3072
zp 48,156,88
z6 0x4000
zc7 0x4000
z0 43
za 48,180,92
ze 10
zn 53,1024
zcg
zcu
z0 42
zh 124,100,140
zu 9
zx 36,68
zr 37,68
zcl 38,48
ze 1
zh 128,104,140
zbs 39,33
z2 38
z2 39
zh 132,108,140
zc 76,124,125
zc 77,126,127
zg 36,38
zh 136,112,140
zc 78,128,129
zc 79,130,131
zg 37,39
zh 124,116,140
ze 0
zc 80,132,133
zc 81,134,135
zs 38
zh 128,120,140
zc 82,136,137
zc 83,138,139
zs 39
za 48,204,96
zc 84,124,125
zc 85,126,127
zs 36
zp 52,160,88
zc 86,128,129
zc 87,130,131
zs 37
za 52,184,92
zq 38,39
zq 36,37
zr 37,36
za 52,208,96
zav 36,38
zaw 36
z3 45,37
zp 56,164,88
z3 44,36
z4 47,37,45
z4 46,36,44
za 56,188,92
zcl 38,48
z2 38
zd1 39,49
za 56,212,96
zd2 38,39
zax 47
z5 36,46
zp 60,168,88
z5 37,47
zd3 40,44,49,38
za 60,192,92
zay 41,45,50
zw 38,36,37
za 60,216,96
Lf9_atH4:
Lf9_atG4:
zc2
s_cbranch_scc1 Lf9_atS4
zc0
s_cbranch_scc0 Lf9_atRb4
ze 0
zh 252,148,76
zac 21,10,6
zac 22,13,6
zad 140,16,3
zf 252,172,80
zo 100,21
zo 102,22
zb 104,21,16
zf 252,196,84
zb 106,22,16
zb 108,21,64
zb 110,22,64
zp 64,152,76
zb 112,21,80
zb 114,22,80
zb 116,21,128
za 64,176,80
zb 118,22,128
zb 120,21,144
zb 122,22,144
za 64,200,84
zad 141,16,5
zad 142,19,3
zad 143,19,5
zp 68,156,76
zc8 0x15e00
zc6 66,35,16
zcg
zcu
zn 43,1024
za 68,180,80
ze 10
zn 53,2048
zn 42,3072
zh 124,100,140
ze 8
zaz 36,47
za0 37,46
zw 39,46,47
zh 128,104,140
ze 5
za1 41,45
za2 41,51
za3 36,37
zh 132,108,140
ze 1
zc 88,124,125
zc 89,126,127
zas 37
zh 136,112,140
zc 90,128,129
zc 91,130,131
za4 41,40
zh 124,116,140
ze 0
zc 92,132,133
zc 93,134,135
zq 38,39
zh 128,120,140
zc 94,136,137
zc 95,138,139
zq 36,37
za 68,204,84
zc 96,124,125
zc 97,126,127
za5 37,52
zp 72,160,76
zc 98,128,129
zc 99,130,131
zcm 40,44
za 72,184,80
zcn 39
za6 11,41
z8 17,38,7
za 72,208,84
z8 20,36,7
zco
zau 14,37,11
zex 76,164
zcp
zcq
zx 36,57
zr 37,57
za 76,188,80
zdx 38,48
zcj 39,33
z2 38
za 76,212,84
z2 39
zg 36,38
zp 80,168,76
zg 37,39
zs 38
z7 80,192
zs 39
zs 36
za 80,216,84
Lf9_atH5:
Lf9_atG5:
zey
s_cbranch_scc1 Lf9_atS5
zd4
s_cbranch_scc0 Lf9_atRb5
ze 0
zp 84,148,88
zaj 21,10,6
zaj 22,13,6
zak 140,16,3
zak 141,16,5
za 84,172,92
zo 100,21
zo 102,22
zb 104,21,16
zb 106,22,16
za 84,196,96
zb 108,21,64
zb 110,22,64
zb 112,21,80
zex 88,152
zb 114,22,80
zb 116,21,128
zb 118,22,128
za 88,176,92
zb 120,21,144
zb 122,22,144
zak 142,19,3
za 88,200,96
zc8 0x2bc00
zc6 72,35,16
z6 0x1000
zag 0x1000
z0 43
zak 143,19,5
zp 92,156,88
ze 10
zn 53,1024
zn 42,2048
zh 124,100,140
ze 8
zn 43,3072
zs 37
zh 128,104,140
ze 5
zq 38,39
zq 36,37
zr 37,36
zh 132,108,140
ze 2
zc 76,124,125
zc 77,126,127
zav 36,38
zh 136,112,140
zc 78,128,129
zc 79,130,131
zaw 36
zh 124,116,140
ze 0
zc 80,132,133
zc 81,134,135
z3 45,37
zh 128,120,140
zc 82,136,137
zc 83,138,139
z3 44,36
z7 92,180
zc 84,124,125
zc 85,126,127
z4 47,37,45
za 92,204,96
zc 86,128,129
zc 87,130,131
z4 46,36,44
zp 96,160,88
zax 47
z5 36,46
z5 37,47
za 96,184,92
zbg 40,44,49
zay 41,45,50
zw 38,36,37
z7 96,208
zaz 36,47
za0 37,46
zw 39,46,47
zp 100,164,88
za1 41,45
za2 41,51
za3 36,37
za 100,188,92
zas 37
za4 41,40
zq 38,39
za 100,212,96
zq 36,37
za5 37,52
zp 104,168,88
zdf 40,44
zdg 39
za 104,192,92
za6 9,41
z8 15,38,7
za 104,216,96
Lf9_atH6:
s_barrier
Lf9_atG6:
zez
s_cbranch_scc1 Lf9_atS6
zd5
s_cbranch_scc0 Lf9_atRb6
ze 0
zp 108,148,76
zaq 21,10,6
zaq 22,13,6
zar 140,16,3
zar 141,16,5
zp 112,152,76
zo 100,21
zo 102,22
zb 104,21,16
zp 116,156,76
zb 106,22,16
zb 108,21,64
zb 110,22,64
zp 120,160,76
zb 112,21,80
zb 114,22,80
zb 116,21,128
zp 124,164,76
zb 118,22,128
zb 120,21,144
zb 122,22,144
zp 128,168,76
z6 0x2000
zag 0x2000
z0 53
zar 142,19,3
zar 143,19,5
za 108,172,80
zn 42,1024
zn 43,2048
za 112,176,80
ze 10
zn 53,3072
z8 18,36,7
zh 124,100,140
zdh
zau 12,37,9
zdi
zdj
ze 6
zh 128,104,140
zx 36,63
zr 37,63
zfl 38,48
zh 132,108,140
ze 0
zc 88,124,125
zc 89,126,127
zcj 39,33
zh 136,112,140
zc 90,128,129
zc 91,130,131
z2 38
zh 124,116,140
zc 92,132,133
zc 93,134,135
z2 39
zh 128,120,140
zc 94,136,137
zc 95,138,139
zg 36,38
za 116,180,80
zc 76,124,125
zc 77,126,127
zg 37,39
za 120,184,80
zc 78,128,129
zc 79,130,131
zs 38
za 124,188,80
zs 39
zs 36
zs 37
za 128,192,80
zq 38,39
zq 36,37
zr 37,36
za 108,196,84
zav 36,38
zaw 36
z3 45,37
za 112,200,84
z3 44,36
z4 47,37,45
z4 46,36,44
za 116,204,84
zax 47
z5 36,46
z5 37,47
za 120,208,84
zbg 40,44,49
zay 41,45,50
zw 38,36,37
za 124,212,84
zaz 36,47
za0 37,46
za 128,216,84
Lf9_atH7:
Lf9_atG7:
zf7
s_cbranch_scc1 Lf9_atS7
zdy
s_cbranch_scc0 Lf9_atRb7
ze 0
zp 132,148,88
zaa 21,11,6
zaa 22,14,6
zab 140,17,3
zab 141,17,5
zp 136,152,88
zo 100,21
zo 102,22
zb 104,21,16
zb 106,22,16
zp 140,156,88
zb 108,21,64
zb 110,22,64
zb 112,21,80
zb 114,22,80
zp 144,160,88
zb 116,21,128
zb 118,22,128
zb 120,21,144
zb 122,22,144
zp 148,164,88
zab 142,20,3
zab 143,20,5
zw 39,46,47
za1 41,45
zp 152,168,88
za2 41,51
za3 36,37
zas 37
za4 41,40
za 132,172,92
ze 10
zq 38,39
zq 36,37
za5 37,52
zca 40,44
zh 124,100,140
ze 8
zcb 39
za6 10,41
z8 16,38,7
z8 19,36,7
zh 128,104,140
zcc
zau 13,37,10
zcd
zce
zc 84,124,125
ze 4
zh 132,108,140
zu 21
zc 85,126,127
zx 36,32
zc 86,128,129
zc 87,130,131
zh 136,112,140
ze 0
zr 37,32
zf3 38,48
ze2 39,33
zc 96,132,133
zh 124,116,140
zc 97,134,135
z2 38
z2 39
zc 98,136,137
zh 128,120,140
zc 99,138,139
zg 36,38
zg 37,39
zc 88,124,125
za 136,176,92
zc 89,126,127
zs 38
zs 39
zc 90,128,129
za 140,180,92
zc 91,130,131
zs 36
zs 37
zq 38,39
za 144,184,92
zq 36,37
zr 37,36
zav 36,38
zaw 36
za 148,188,92
z3 45,37
z3 44,36
z4 47,37,45
z4 46,36,44
za 152,192,92
zax 47
z5 36,46
z5 37,47
zbg 40,44,49
za 132,196,76
zay 41,45,50
zw 38,36,37
zaz 36,47
za0 37,46
za 136,200,76
zw 39,46,47
za1 41,45
za2 41,51
za3 36,37
za 140,204,76
zas 37
za4 41,40
zq 38,39
zq 36,37
za 144,208,76
za5 37,52
zcm 40,44
zcn 39
za6 11,41
za 148,212,76
z8 17,38,7
z8 20,36,7
zco
zau 14,37,11
zcp
za 152,216,76
zcq
Lf9_atH8:
zu 14
s_barrier
Lf9_atG8:
zf7
s_cbranch_scc1 Lf9_atS8
zdy
s_cbranch_scc0 Lf9_atRb8
ze 0
zp 156,148,84
zf4 8,0
zaa 21,11,6
zaa 22,14,6
zp 160,152,84
zo 100,21
zo 102,22
zb 104,21,16
zp 164,156,84
zb 106,22,16
zb 108,21,64
zb 110,22,64
zp 168,160,84
zb 112,21,80
zb 114,22,80
zb 116,21,128
zp 172,164,84
zb 118,22,128
zb 120,21,144
zb 122,22,144
zp 176,168,84
zab 140,17,3
zab 141,17,5
zab 142,20,3
za 156,172,96
zb 148,1,12288
zb 150,1,13824
zab 143,20,5
za 160,176,96
ze 12
zb 152,2,12288
zb 154,2,13824
zb 156,1,12352
zh 124,100,140
ze 13
zb 158,1,13888
zb 160,2,12352
zb 162,2,13888
zh 128,104,140
ze 14
zb 164,1,12416
zb 166,1,13952
zh 132,108,140
ze 14
zc 76,124,125
zc 77,126,127
zh 136,112,140
zb 168,2,12416
zc 78,128,129
za 164,180,96
ze 11
zc 79,130,131
zc 80,132,133
zh 124,116,140
zc 81,134,135
zc 82,136,137
zh 128,120,140
zb 170,2,13952
zc 83,138,139
za 168,184,96
za 172,188,96
zv
zc 84,124,125
zc 85,126,127
za 176,192,96
zb 172,1,30720
zc 86,128,129
zc 87,130,131
za 156,196,88
zb 174,1,32256
zb 176,2,30720
zb 178,2,32256
za 160,200,88
zb 180,1,30784
zb 182,1,32320
za 164,204,88
zb 184,2,30784
zb 186,2,32320
za 168,208,88
zb 188,1,30848
zb 190,1,32384
za 172,212,88
zb 192,2,30848
zb 194,2,32384
za 176,216,88
Lf9_atE2:
zfz
s_cbranch_scc1 Lf9_as1H0
zf0
s_cbranch_scc1 Lf9_as2H0
zde
s_cbranch_scc1 Lf9_as3H0
s_branch Lf9_as0H0
Lf9_as0H0:
Lf9_as0G0:
ze7
s_cbranch_scc1 Lf9_as0S0
zc1
s_cbranch_scc0 Lf9_as0Rb0
ze 15
zf 220,148,76
zac 21,11,6
zac 22,14,6
zad 140,17,3
zad 141,17,5
zf 224,152,76
zo 100,21
zo 102,22
zb 104,21,16
zb 106,22,16
za 0,156,76
zb 108,21,64
zb 110,22,64
zb 112,21,80
za 4,160,76
ze 15
zb 114,22,80
zb 116,21,128
zb 118,22,128
za 8,164,76
zb 120,21,144
zb 122,22,144
zad 142,20,3
za 12,168,76
ze 14
zb 204,1,49216
zb 206,1,50752
zad 143,20,5
zf 220,188,80
ze 14
zb 208,2,49216
zb 210,2,50752
zb 212,1,49280
zf 224,192,80
ze 15
zb 214,1,50816
zb 216,2,49280
zb 218,2,50816
zh 124,100,140
ze 15
zb 196,1,49152
zb 198,1,50688
zb 200,2,49152
zh 128,104,140
ze 15
zb 202,2,50688
zbr 0x11000
zbb 1
zbb 2
zh 132,108,140
zc 88,124,125
zc 89,126,127
zb2 54
zh 136,112,140
ze 12
zc 90,128,129
zc 91,130,131
zb3 54
zh 124,116,140
zc 92,132,133
zc 93,134,135
zbz 25,54
zh 128,120,140
zbc 0x5800
zbw
zbd
zc 94,136,137
zc 95,138,139
za 0,172,80
zbe
zc 76,124,125
zc 77,126,127
zal 28,54
za 4,176,80
zc 78,128,129
zc 79,130,131
ze 0
s_barrier
za 8,180,80
z6 0x3000
zag 0x3000
z0 42
zn 43,1024
za 12,184,80
zn 53,2048
zn 42,3072
zf 220,204,84
z6 0x4000
zag 0x4000
z0 43
zf 224,208,84
zbc 0x9800
zn 53,1024
zby
zbd
za 0,212,84
zbe
zal 29,54
zb5
zb6 0x1e800
za 4,216,84
zal 30,54
zb7 54
zbv 26,4
za 8,196,84
zbk 26,54
zb8
za 12,200,84
zb9 26
Lf9_as0H1:
Lf9_as0G1:
zgy
s_cbranch_scc1 Lf9_as0S1
ze6
s_cbranch_scc0 Lf9_as0Rb1
ze 0
zf 228,148,88
zaj 21,11,6
zaj 22,14,6
zf 232,152,88
zo 100,21
zo 102,22
za 16,156,88
zb 104,21,16
zb 106,22,16
za 20,160,88
zb 108,21,64
zb 110,22,64
za 24,164,88
zb 112,21,80
zb 114,22,80
za 28,168,88
zb 116,21,128
zb 118,22,128
zf 228,188,92
zb 120,21,144
zb 122,22,144
zf 232,192,92
zak 140,17,3
zak 141,17,5
za 16,172,92
zak 142,20,3
zak 143,20,5
za 20,176,92
za 24,180,92
ze 10
zh 124,100,140
ze 8
zh 128,104,140
ze 6
zh 132,108,140
ze 4
zh 136,112,140
zam
zc 84,124,125
zc 85,126,127
za 28,184,92
ze 2
zc 86,128,129
zc 87,130,131
zh 124,116,140
ze 0
zc 96,132,133
zc 97,134,135
zh 128,120,140
zc 98,136,137
zc 99,138,139
zf 228,204,76
zf 232,208,76
zc 88,124,125
zc 89,126,127
za 16,212,76
zv
zc 90,128,129
zc 91,130,131
za 20,216,76
za 24,196,76
za 28,200,76
Lf9_as0H2:
Lf9_as0G2:
zct
s_cbranch_scc1 Lf9_as0S2
zcf
s_cbranch_scc0 Lf9_as0Rb2
ze 0
zf 236,148,84
zbn
zbq 8,0
zaa 21,9,6
zaa 22,12,6
zf 240,152,84
zbo
zo 100,21
zo 102,22
zb 104,21,16
za 32,156,84
zbp
zb 106,22,16
zb 108,21,64
zb 110,22,64
za 36,160,84
zb 112,21,80
zb 114,22,80
zb 116,21,128
za 40,164,84
zb 118,22,128
zb 120,21,144
zb 122,22,144
za 44,168,84
zab 140,15,3
zab 141,15,5
zab 142,18,3
zf 236,188,96
zu 12
zo 148,1
zb 150,1,1536
zab 143,18,5
zf 240,192,96
ze 12
zo 152,2
zb 154,2,1536
zb 156,1,64
zh 124,100,140
ze 13
zb 158,1,1600
zb 160,2,64
zb 162,2,1600
zh 128,104,140
ze 14
zb 164,1,128
zb 166,1,1664
zh 132,108,140
ze 14
zc 76,124,125
zc 77,126,127
zh 136,112,140
zb 168,2,128
zc 78,128,129
za 32,172,96
ze 11
zc 79,130,131
zc 80,132,133
zh 124,116,140
zc 81,134,135
zc 82,136,137
zh 128,120,140
zb 170,2,1664
zc 83,138,139
za 36,176,96
za 40,180,96
zv
zc 84,124,125
zc 85,126,127
za 44,184,96
zu 6
zb 172,1,6144
zc 86,128,129
zc 87,130,131
zf 236,204,88
zb 174,1,7680
zb 176,2,6144
zb 178,2,7680
zf 240,208,88
zb 180,1,6208
zb 182,1,7744
za 32,212,88
zb 184,2,6208
zb 186,2,7744
za 36,216,88
zb 188,1,6272
zb 190,1,7808
za 40,196,88
zb 192,2,6272
zb 194,2,7808
za 44,200,88
Lf9_as0E2:
s_branch Lf9_amH0
Lf9_as1H0:
Lf9_as1G0:
ze7
s_cbranch_scc1 Lf9_as1S0
zc1
s_cbranch_scc0 Lf9_as1Rb0
ze 15
zf 244,156,76
zac 21,11,6
zac 22,14,6
zad 140,17,3
zad 141,17,5
zf 248,160,76
ze 14
zo 100,21
zo 102,22
zb 104,21,16
zb 106,22,16
za 48,164,76
ze 15
zb 108,21,64
zb 110,22,64
zb 112,21,80
za 52,168,76
zb 114,22,80
zb 116,21,128
zb 118,22,128
za 56,148,76
zb 120,21,144
zb 122,22,144
zad 142,20,3
za 60,152,76
ze 14
zb 212,1,49280
zb 214,1,50816
zad 143,20,5
zf 244,172,80
zb 216,2,49280
zb 218,2,50816
zb 196,1,49152
zf 248,176,80
ze 15
zb 198,1,50688
zb 200,2,49152
zb 202,2,50688
zh 124,100,140
ze 15
zb 204,1,49216
zb 206,1,50752
zb 208,2,49216
zh 128,104,140
ze 15
zb 210,2,50752
zbr 0x11000
zbb 1
zbb 2
zh 132,108,140
zc 88,124,125
zc 89,126,127
zb2 54
zh 136,112,140
ze 12
zc 90,128,129
zc 91,130,131
zb3 54
zh 124,116,140
zc 92,132,133
zc 93,134,135
zbz 25,54
zh 128,120,140
zbc 0x5800
zbw
zbd
zc 94,136,137
zc 95,138,139
za 48,180,80
zbe
zc 96,124,125
zc 97,126,127
zal 28,54
za 52,184,80
zc 98,128,129
zc 99,130,131
ze 0
s_barrier
za 56,188,80
z6 0x3000
zag 0x3000
z0 42
zn 43,1024
za 60,192,80
zn 53,2048
zn 42,3072
zf 244,212,84
z6 0x4000
zag 0x4000
z0 43
zf 248,216,84
zbc 0x9800
zn 53,1024
zby
zbd
za 48,196,84
zbe
zal 29,54
zb5
zb6 0x1e800
za 52,200,84
zal 30,54
zb7 54
zbv 26,4
za 56,204,84
zbk 26,54
zb8
za 60,208,84
zb9 26
Lf9_as1H1:
Lf9_as1G1:
zct
s_cbranch_scc1 Lf9_as1S1
zcf
s_cbranch_scc0 Lf9_as1Rb1
ze 0
zf 252,156,88
zbn
zbq 8,0
zaa 21,9,6
zaa 22,12,6
za 64,160,88
zbo
zo 100,21
zo 102,22
zb 104,21,16
za 68,164,88
zbp
zb 106,22,16
zb 108,21,64
zb 110,22,64
za 72,168,88
zb 112,21,80
zb 114,22,80
zb 116,21,128
za 76,148,88
zb 118,22,128
zb 120,21,144
zb 122,22,144
za 80,152,88
zab 140,15,3
zab 141,15,5
zab 142,18,3
zf 252,172,92
zu 12
zo 148,1
zb 150,1,1536
zab 143,18,5
za 64,176,92
ze 12
zo 152,2
zb 154,2,1536
zb 156,1,64
zh 124,100,140
ze 13
zb 158,1,1600
zb 160,2,64
zb 162,2,1600
zh 128,104,140
ze 14
zb 164,1,128
zb 166,1,1664
zh 132,108,140
ze 14
zc 76,124,125
zc 77,126,127
zh 136,112,140
zb 168,2,128
zc 78,128,129
za 68,180,92
ze 11
zc 79,130,131
zc 80,132,133
zh 124,116,140
zc 81,134,135
zc 82,136,137
zh 128,120,140
zb 170,2,1664
zc 83,138,139
za 72,184,92
za 76,188,92
zv
zc 84,124,125
zc 85,126,127
za 80,192,92
zu 6
zb 172,1,6144
zc 86,128,129
zc 87,130,131
zf 252,212,96
zb 174,1,7680
zb 176,2,6144
zb 178,2,7680
za 64,216,96
zb 180,1,6208
zb 182,1,7744
za 68,196,96
zb 184,2,6208
zb 186,2,7744
za 72,200,96
zb 188,1,6272
zb 190,1,7808
za 76,204,96
zb 192,2,6272
zb 194,2,7808
za 80,208,96
Lf9_as1E2:
s_branch Lf9_amH0
Lf9_as2H0:
Lf9_as2G0:
ze7
s_cbranch_scc1 Lf9_as2S0
zc1
s_cbranch_scc0 Lf9_as2Rb0
ze 14
za 84,164,76
ze 12
zac 21,11,6
zac 22,14,6
zad 140,17,3
zad 141,17,5
za 88,168,76
zo 100,21
zo 102,22
zb 104,21,16
zb 106,22,16
za 92,148,76
zb 108,21,64
zb 110,22,64
zb 112,21,80
za 96,152,76
zb 114,22,80
zb 116,21,128
zb 118,22,128
za 100,156,76
zb 120,21,144
zb 122,22,144
zad 142,20,3
za 104,160,76
ze 14
zb 196,1,49152
zb 198,1,50688
zad 143,20,5
za 84,180,80
zb 200,2,49152
zb 202,2,50688
zb 204,1,49216
za 88,184,80
ze 15
zb 206,1,50752
zb 208,2,49216
zb 210,2,50752
zh 124,100,140
ze 15
zb 212,1,49280
zb 214,1,50816
zb 216,2,49280
zh 128,104,140
ze 15
zb 218,2,50816
zbr 0x11000
zbb 1
zbb 2
zh 132,108,140
zc 88,124,125
zc 89,126,127
zb2 54
zh 136,112,140
ze 12
zc 90,128,129
zc 91,130,131
zb3 54
zh 124,116,140
zc 92,132,133
zc 93,134,135
zbz 25,54
zh 128,120,140
zbc 0x5800
zbw
zbd
zc 94,136,137
zc 95,138,139
za 92,188,80
zbe
zc 96,124,125
zc 97,126,127
zal 28,54
za 96,192,80
zc 98,128,129
zc 99,130,131
ze 0
s_barrier
za 100,172,80
z6 0x3000
zag 0x3000
z0 42
zn 43,1024
za 104,176,80
zn 53,2048
zn 42,3072
z7 84,196
z6 0x4000
zag 0x4000
z0 43
za 88,200,84
zbc 0x9800
zn 53,1024
zby
zbd
za 92,204,84
zbe
zal 29,54
zb5
zb6 0x1e800
za 96,208,84
zal 30,54
zb7 54
zbv 26,4
za 100,212,84
zbk 26,54
zb8
za 104,216,84
zb9 26
Lf9_as2H1:
Lf9_as2G1:
zct
s_cbranch_scc1 Lf9_as2S1
zcf
s_cbranch_scc0 Lf9_as2Rb1
ze 0
za 108,164,88
zbn
zbq 8,0
zaa 21,9,6
zaa 22,12,6
za 112,168,88
zbo
zo 100,21
zo 102,22
zb 104,21,16
za 116,148,88
zbp
zb 106,22,16
zb 108,21,64
zb 110,22,64
za 120,152,88
zb 112,21,80
zb 114,22,80
zb 116,21,128
za 124,156,88
zb 118,22,128
zb 120,21,144
zb 122,22,144
za 128,160,88
zab 140,15,3
zab 141,15,5
zab 142,18,3
za 108,180,92
zu 12
zo 148,1
zb 150,1,1536
zab 143,18,5
za 112,184,92
ze 12
zo 152,2
zb 154,2,1536
zb 156,1,64
zh 124,100,140
ze 13
zb 158,1,1600
zb 160,2,64
zb 162,2,1600
zh 128,104,140
ze 14
zb 164,1,128
zb 166,1,1664
zh 132,108,140
ze 14
zc 76,124,125
zc 77,126,127
zh 136,112,140
zb 168,2,128
zc 78,128,129
za 116,188,92
ze 11
zc 79,130,131
zc 80,132,133
zh 124,116,140
zc 81,134,135
zc 82,136,137
zh 128,120,140
zb 170,2,1664
zc 83,138,139
za 120,192,92
za 124,172,92
zv
zc 84,124,125
zc 85,126,127
za 128,176,92
zu 6
zb 172,1,6144
zc 86,128,129
zc 87,130,131
za 108,196,96
zb 174,1,7680
zb 176,2,6144
zb 178,2,7680
za 112,200,96
zb 180,1,6208
zb 182,1,7744
za 116,204,96
zb 184,2,6208
zb 186,2,7744
za 120,208,96
zb 188,1,6272
zb 190,1,7808
za 124,212,96
zb 192,2,6272
zb 194,2,7808
za 128,216,96
Lf9_as2E2:
s_branch Lf9_amH0
Lf9_as3H0:
Lf9_as3G0:
ze7
s_cbranch_scc1 Lf9_as3S0
zc1
s_cbranch_scc0 Lf9_as3Rb0
ze 15
za 132,148,76
zac 21,11,6
zac 22,14,6
zad 140,17,3
za 136,152,76
zo 100,21
zo 102,22
zb 104,21,16
za 140,156,76
zb 106,22,16
zb 108,21,64
zb 110,22,64
za 144,160,76
ze 15
zb 112,21,80
zb 114,22,80
zb 116,21,128
za 148,164,76
zb 118,22,128
zb 120,21,144
zb 122,22,144
za 152,168,76
ze 14
zad 141,17,5
zad 142,20,3
zad 143,20,5
za 132,188,80
ze 12
zb 204,1,49216
zb 206,1,50752
zb 208,2,49216
za 136,192,80
ze 13
zb 210,2,50752
zb 212,1,49280
zb 214,1,50816
zh 124,100,140
ze 14
zb 216,2,49280
zb 218,2,50816
zb 196,1,49152
zh 128,104,140
ze 15
zb 198,1,50688
zb 200,2,49152
zb 202,2,50688
zh 132,108,140
ze 15
zc 88,124,125
zc 89,126,127
zbr 0x11000
zbb 1
zbb 2
zh 136,112,140
ze 12
zc 90,128,129
zc 91,130,131
zh 124,116,140
zc 92,132,133
zc 93,134,135
zh 128,120,140
zv
zc 94,136,137
zc 95,138,139
za 140,172,80
zb2 54
zc 96,124,125
za 144,176,80
zc 97,126,127
zc 98,128,129
za 148,180,80
zc 99,130,131
ze 0
s_barrier
zb3 54
za 152,184,80
zbz 25,54
zbc 0x5800
zbw
zbd
za 132,204,84
zbe
zal 28,54
zbc 0x9800
za 136,208,84
zby
zbd
zbe
za 140,212,84
zal 29,54
zb5
za 144,216,84
zb6 0x1e800
zal 30,54
zb7 54
zbv 26,4
za 148,196,84
zbk 26,54
zb8
za 152,200,84
zb9 26
Lf9_as3H1:
Lf9_as3G1:
zct
s_cbranch_scc1 Lf9_as3S1
zcf
s_cbranch_scc0 Lf9_as3Rb1
ze 0
za 156,148,88
zbn
zbq 8,0
zaa 21,9,6
zaa 22,12,6
za 160,152,88
zbo
zo 100,21
zo 102,22
zb 104,21,16
za 164,156,88
zbp
zb 106,22,16
zb 108,21,64
zb 110,22,64
za 168,160,88
zb 112,21,80
zb 114,22,80
zb 116,21,128
za 172,164,88
zb 118,22,128
zb 120,21,144
zb 122,22,144
za 176,168,88
zab 140,15,3
zab 141,15,5
zab 142,18,3
za 156,188,92
zu 6
zo 148,1
zb 150,1,1536
zab 143,18,5
za 160,192,92
ze 12
zo 152,2
zb 154,2,1536
zb 156,1,64
zh 124,100,140
ze 13
zb 158,1,1600
zb 160,2,64
zb 162,2,1600
zh 128,104,140
ze 14
zb 164,1,128
zb 166,1,1664
zh 132,108,140
ze 14
zc 76,124,125
zc 77,126,127
zh 136,112,140
zb 168,2,128
zc 78,128,129
za 164,172,92
ze 11
zc 79,130,131
zc 80,132,133
zh 124,116,140
zc 81,134,135
zc 82,136,137
zh 128,120,140
zb 170,2,1664
zc 83,138,139
za 168,176,92
za 172,180,92
zv
zc 84,124,125
zc 85,126,127
za 176,184,92
zu 0
zb 172,1,6144
zc 86,128,129
zc 87,130,131
za 156,204,96
zb 174,1,7680
zb 176,2,6144
zb 178,2,7680
za 160,208,96
zb 180,1,6208
zb 182,1,7744
za 164,212,96
zb 184,2,6208
zb 186,2,7744
za 168,216,96
zb 188,1,6272
zb 190,1,7808
za 172,196,96
zb 192,2,6272
zb 194,2,7808
za 176,200,96
Lf9_as3E2:
s_branch Lf9_amH0
Lf9_amS0:
ze8
s_cbranch_scc0 Lf9_amY0
ze9
zap 0x5780
zao
s_call_b64 s[88:89], Lf9_far
s_branch Lf9_amXb0
Lf9_amY0:
zac 21,9,6
zac 22,12,6
za9 23,15
za9 24,18
s_call_b64 s[88:89], Lf9_four
Lf9_amXb0:
ze 15
zf 220,148,76
ze3
zd 88,100
zd 89,101
zf 224,152,76
zed
zd 90,102
zd 91,103
za 0,156,76
zee 0x4800
zd 92,104
zd 93,105
za 4,160,76
zef
zd 94,106
zd 95,107
ze 8
za 8,164,76
zeg
zd 96,108
zd 97,109
za 12,168,76
zeh 0x1200
zd 98,110
zd 99,111
zf 220,172,80
zei
zu 0
zb 196,1,12288
zb 198,1,13824
zf 224,176,80
zej 0xd0
zb 200,2,12288
zb 202,2,13824
ze 4
za 0,180,80
zek 0x12d0
zb 204,1,12352
zb 206,1,13888
za 4,184,80
zel
zb 208,2,12352
zb 210,2,13888
za 8,188,80
zem
zb 212,1,12416
zb 214,1,13952
za 12,192,80
zb 216,2,12416
zb 218,2,13952
zx 36,69
zr 37,69
zd 69,70
zd 70,71
zd 71,72
zd 72,73
zcl 38,48
zbs 39,33
zen
zeo
ze 10
zf 220,196,84
ze 8
zf 224,200,84
ze 6
za 0,204,84
ze 4
za 4,208,84
ze 2
za 8,212,84
ze 0
za 12,216,84
s_branch Lf9_amH1
Lf9_amS1:
zfa
s_cbranch_scc0 Lf9_amY1
zfb
zap 0xaf00
zao
s_call_b64 s[88:89], Lf9_far
s_branch Lf9_amXb1
Lf9_amY1:
zaj 21,9,6
zaj 22,12,6
zbm 23,15
zbm 24,18
s_call_b64 s[88:89], Lf9_four
Lf9_amXb1:
zf 228,148,88
ze 0
zd 76,100
zd 77,101
zd 78,102
zf 228,172,92
zd 79,103
zd 80,104
zd 81,105
zf 228,196,96
zd 82,106
zd 83,107
zd 84,108
zf 232,152,88
zd 85,109
zd 86,110
zd 87,111
zf 232,176,92
zcg
zcu
z0 42
zf 232,200,96
zn 43,1024
za 16,156,88
zn 53,2048
za 16,180,92
z2 38
z2 39
za 16,204,96
zg 36,38
zg 37,39
za 20,160,88
zs 38
zs 39
za 20,184,92
zs 36
zs 37
za 20,208,96
zq 38,39
zq 36,37
za 24,164,88
zr 37,36
zav 36,38
za 24,188,92
zaw 36
z3 45,37
za 24,212,96
z3 44,36
z4 47,37,45
za 28,168,88
z4 46,36,44
zax 47
za 28,192,92
z5 36,46
za 28,216,96
s_branch Lf9_amH2
Lf9_amS2:
zfc
s_cbranch_scc0 Lf9_amY2
zfd
zap 0x10680
zao
s_call_b64 s[88:89], Lf9_far
s_branch Lf9_amXb2
Lf9_amY2:
zaq 21,9,6
zaq 22,12,6
zbu 23,15
zbu 24,18
s_call_b64 s[88:89], Lf9_four
Lf9_amXb2:
ze 0
zf 236,148,76
zd 88,100
zd 89,101
zd 90,102
zf 236,172,80
zd 91,103
zd 92,104
zd 93,105
zf 236,196,84
zd 94,106
zd 95,107
zd 96,108
zf 240,152,76
zd 97,109
zd 98,110
zd 99,111
zf 240,176,80
zn 42,3072
zf 240,200,84
z6 0x1000
zag 0x1000
z0 43
za 32,156,76
zn 53,1024
za 32,180,80
z5 37,47
zbg 40,44,49
za 32,204,84
zay 41,45,50
zw 38,36,37
za 36,160,76
zaz 36,47
za0 37,46
za 36,184,80
zw 39,46,47
za1 41,45
za 36,208,84
za2 41,51
za3 36,37
za 40,164,76
zas 37
za4 41,40
za 40,188,80
zq 38,39
zq 36,37
za 40,212,84
za5 37,52
zcm 40,44
za 44,168,76
zcn 39
za6 11,41
za 44,192,80
z8 17,38,7
za 44,216,84
s_branch Lf9_amH3
Lf9_amS3:
ze1
s_cbranch_scc0 Lf9_amY3
zfe
zap 0x15e00
zao
s_call_b64 s[88:89], Lf9_far
s_branch Lf9_amXb3
Lf9_amY3:
zaa 21,10,6
zaa 22,13,6
za8 23,16
za8 24,19
s_call_b64 s[88:89], Lf9_four
Lf9_amXb3:
ze 0
zf 244,148,88
zd 76,100
zd 77,101
zd 78,102
zf 244,172,92
zd 79,103
zd 80,104
zf 244,196,96
zd 81,105
zd 82,106
zf 248,152,88
zd 83,107
zd 84,108
zf 248,176,92
zd 85,109
zd 86,110
zf 248,200,96
zn 42,2048
zd 87,111
za 48,156,88
zn 43,3072
za 48,180,92
z6 0x2000
zag 0x2000
z0 53
za 48,204,96
z8 20,36,7
zco
za 52,160,88
zau 14,37,11
zcp
za 52,184,92
zcq
zx 36,58
zr 37,58
za 52,208,96
zd 58,59
zd 59,60
za 56,164,88
zd 60,61
zdx 38,48
za 56,188,92
zcj 39,33
z2 38
za 56,212,96
z2 39
zg 36,38
za 60,168,88
zg 37,39
zs 38
za 60,192,92
zs 39
zs 36
za 60,216,96
s_branch Lf9_amH4
Lf9_amS4:
ze0
s_cbranch_scc0 Lf9_amY4
zfs
zap 0x1b580
zao
s_call_b64 s[88:89], Lf9_far
s_branch Lf9_amXb4
Lf9_amY4:
zac 21,10,6
zac 22,13,6
za9 23,16
za9 24,19
s_call_b64 s[88:89], Lf9_four
Lf9_amXb4:
ze 0
zf 252,148,76
zd 88,100
zd 89,101
zd 90,102
zf 252,172,80
zd 91,103
zd 92,104
zd 93,105
zf 252,196,84
zd 94,106
zd 95,107
zd 96,108
za 64,152,76
zd 97,109
zd 98,110
za 64,176,80
zn 42,1024
zd 99,111
za 64,200,84
zn 43,2048
za 68,156,76
zn 53,3072
za 68,180,80
zs 37
zq 38,39
za 68,204,84
zq 36,37
zr 37,36
za 72,160,76
zav 36,38
zaw 36
za 72,184,80
z3 45,37
z3 44,36
za 72,208,84
z4 47,37,45
z4 46,36,44
z7 76,164
zax 47
z5 36,46
za 76,188,80
z5 37,47
zbg 40,44,49
za 76,212,84
zay 41,45,50
zw 38,36,37
za 80,168,76
zaz 36,47
za0 37,46
z7 80,192
zw 39,46,47
za 80,216,84
s_branch Lf9_amH5
Lf9_amS5:
zft
s_cbranch_scc0 Lf9_amY5
zfu
zap 0x20d00
zao
s_call_b64 s[88:89], Lf9_far
s_branch Lf9_amXb5
Lf9_amY5:
zaj 21,10,6
zaj 22,13,6
zbm 23,16
zbm 24,19
s_call_b64 s[88:89], Lf9_four
Lf9_amXb5:
ze 0
za 84,148,88
zd 76,100
zd 77,101
za 84,172,92
zd 78,102
zd 79,103
za 84,196,96
zd 80,104
zd 81,105
z7 88,152
zd 82,106
zd 83,107
za 88,176,92
zd 84,108
zd 85,109
za 88,200,96
zd 86,110
zd 87,111
za 92,156,88
z6 0x3000
zag 0x3000
z0 42
z7 92,180
zn 43,1024
za 92,204,96
zn 53,2048
za 96,160,88
za1 41,45
za2 41,51
za 96,184,92
za3 36,37
zas 37
z7 96,208
za4 41,40
zq 38,39
za 100,164,88
zq 36,37
za5 37,52
za 100,188,92
zdf 40,44
zdg 39
za 100,212,96
za6 9,41
z8 15,38,7
za 104,168,88
z8 18,36,7
zdh
za 104,192,92
zau 12,37,9
zdi
zdj
za 104,216,96
zx 36,64
s_branch Lf9_amH6
Lf9_amS6:
zfv
s_cbranch_scc0 Lf9_amY6
zfw
zap 0x26480
zao
s_call_b64 s[88:89], Lf9_far
s_branch Lf9_amXb6
Lf9_amY6:
zaq 21,10,6
zaq 22,13,6
zbu 23,16
zbu 24,19
s_call_b64 s[88:89], Lf9_four
Lf9_amXb6:
ze 0
za 108,148,76
zd 88,100
zd 89,101
zd 90,102
za 112,152,76
zd 91,103
zd 92,104
zd 93,105
za 116,156,76
zn 42,3072
zd 94,106
zd 95,107
za 120,160,76
z6 0x4000
zag 0x4000
z0 43
za 124,164,76
zn 53,1024
za 128,168,76
zd 76,108
zd 77,109
za 108,172,80
zd 78,110
zd 79,111
za 112,176,80
zr 37,64
zd 64,65
za 116,180,80
zd 65,66
zd 66,67
za 120,184,80
zfl 38,48
zcj 39,33
za 124,188,80
z2 38
z2 39
za 128,192,80
zg 36,38
zg 37,39
za 108,196,84
zs 38
zs 39
za 112,200,84
zs 36
zs 37
za 116,204,84
zq 38,39
zq 36,37
za 120,208,84
zr 37,36
zav 36,38
za 124,212,84
zaw 36
za 128,216,84
s_branch Lf9_amH7
Lf9_amS7:
zf8
s_cbranch_scc0 Lf9_amY7
zgl
zap 0x2bc00
zao
s_call_b64 s[88:89], Lf9_far
s_branch Lf9_amXb7
Lf9_amY7:
zaa 21,11,6
zaa 22,14,6
za8 23,17
za8 24,20
s_call_b64 s[88:89], Lf9_four
Lf9_amXb7:
ze 0
za 132,148,88
zd 84,100
zd 85,101
zd 86,102
za 136,152,88
zd 87,103
zd 96,104
zd 97,105
za 140,156,88
zd 98,106
zd 99,107
z3 45,37
za 144,160,88
z3 44,36
z4 47,37,45
z4 46,36,44
za 148,164,88
zax 47
z5 36,46
z5 37,47
za 152,168,88
zd 88,108
zd 89,109
za 132,172,92
zd 90,110
zd 91,111
za 136,176,92
zbg 40,44,49
zay 41,45,50
za 140,180,92
zw 38,36,37
zaz 36,47
za 144,184,92
za0 37,46
zw 39,46,47
za 148,188,92
za1 41,45
za2 41,51
za 152,192,92
za3 36,37
zas 37
za 132,196,76
za4 41,40
zq 38,39
za 136,200,76
zq 36,37
za5 37,52
za 140,204,76
zca 40,44
zcb 39
za 144,208,76
za6 10,41
z8 16,38,7
z8 19,36,7
za 148,212,76
zcc
zau 13,37,10
zcd
zce
za 152,216,76
s_branch Lf9_amH8
Lf9_amS8:
zdz
s_cbranch_scc0 Lf9_amY8
zet
zeu
zev
s_call_b64 s[88:89], Lf9_far
s_branch Lf9_amXb8
Lf9_amY8:
zaa 21,9,6
zaa 22,12,6
za8 23,15
za8 24,18
s_call_b64 s[88:89], Lf9_four
Lf9_amXb8:
ze 0
za 156,148,84
zbn
zbq 8,0
zd 76,100
zd 77,101
za 160,152,84
zbo
zd 78,102
zd 79,103
zd 80,104
za 164,156,84
zbp
zd 81,105
zd 82,106
zd 83,107
za 168,160,84
zf5
za 172,164,84
za 176,168,84
zd 84,108
zd 85,109
zd 86,110
za 156,172,96
zu 12
zo 148,1
zb 150,1,1536
zd 87,111
za 160,176,96
zo 152,2
zb 154,2,1536
zb 156,1,64
za 164,180,96
zb 158,1,1600
zb 160,2,64
zb 162,2,1600
za 168,184,96
zb 164,1,128
zb 166,1,1664
za 172,188,96
zb 168,2,128
zb 170,2,1664
za 176,192,96
zu 6
zb 172,1,6144
zb 174,1,7680
za 156,196,88
zb 176,2,6144
zb 178,2,7680
za 160,200,88
zb 180,1,6208
zb 182,1,7744
za 164,204,88
zb 184,2,6208
zb 186,2,7744
za 168,208,88
zb 188,1,6272
zb 190,1,7808
za 172,212,88
zb 192,2,6272
zb 194,2,7808
za 176,216,88
s_branch Lf9_amE2
Lf9_azS0:
ze8
s_cbranch_scc0 Lf9_azY0
ze9
zap 0x5780
zao
s_call_b64 s[88:89], Lf9_far
s_branch Lf9_azXb0
Lf9_azY0:
zac 21,9,6
zac 22,12,6
za9 23,15
za9 24,18
s_call_b64 s[88:89], Lf9_four
Lf9_azXb0:
zd 88,100
zd 89,101
zd 90,102
zd 91,103
ze 15
za 0,156,76
zd 92,104
zd 93,105
zd 94,106
zd 95,107
zd 96,108
za 4,160,76
zu 0
zb 204,1,12352
zb 206,1,13888
zd 97,109
zd 98,110
zd 99,111
ze 10
za 8,164,76
zb 208,2,12352
zb 210,2,13888
zb 212,1,12416
zb 214,1,13952
zb 216,2,12416
za 12,168,76
zb 218,2,13952
zb 196,1,12288
zb 198,1,13824
zb 200,2,12288
zb 202,2,13824
zf 220,148,76
zx 36,69
zr 37,69
zcl 38,48
zbs 39,33
zf 224,152,76
ze 12
z2 38
z2 39
zg 36,38
zg 37,39
za 0,180,80
zs 38
zs 39
zs 36
zs 37
za 4,184,80
zq 38,39
zq 36,37
zr 37,36
zav 36,38
za 8,188,80
zaw 36
z3 45,37
z3 44,36
z4 47,37,45
za 12,192,80
z4 46,36,44
zax 47
z5 36,46
z5 37,47
zf 220,172,80
zbg 40,44,49
zay 41,45,50
zw 38,36,37
zaz 36,47
zf 224,176,80
ze 0
za0 37,46
zw 39,46,47
za1 41,45
za2 41,51
za 0,204,84
za3 36,37
zas 37
za4 41,40
zq 38,39
za 4,208,84
zq 36,37
za5 37,52
zcm 40,44
zcn 39
za 8,212,84
zk 0,25,2048
za 12,216,84
zv
zk 4,25,3072
za6 11,41
zf 220,196,84
z8 17,38,7
z8 20,36,7
zco
zau 14,37,11
zcp
zf 224,200,84
zcq
s_branch Lf9_azH1
Lf9_azS1:
zfa
s_cbranch_scc0 Lf9_azY1
zfb
zap 0xaf00
zao
s_call_b64 s[88:89], Lf9_far
s_branch Lf9_azXb1
Lf9_azY1:
zaj 21,9,6
zaj 22,12,6
zbm 23,15
zbm 24,18
s_call_b64 s[88:89], Lf9_four
Lf9_azXb1:
zd 76,100
zd 77,101
zd 78,102
zd 79,103
za 16,156,88
zfo 0xffff0000
zd 80,104
zd 81,105
zd 82,106
za 16,180,92
zf6 0xffff0000
zd 83,107
zd 84,108
zd 85,109
za 16,204,96
zk 8,25,4096
zd 86,110
zd 87,111
za 20,160,88
zk 12,25,5120
za 20,184,92
zam
zk 16,25,8192
za 20,208,96
za 24,164,88
za 24,188,92
ze 1
s_barrier
za7 32,28
za 24,212,96
za7 36,29
za7 40,30
za 28,168,88
zk 20,25,9216
za 28,192,92
zb0
zk 24,25,10240
za 28,216,96
zl 44,28,1024
zl 48,29,1024
zf 228,148,88
zl 52,30,1024
zf 228,172,92
zf 228,196,96
zf 232,152,88
zv
zk 28,25,11264
zf 232,176,92
zf 232,200,96
s_branch Lf9_azH2
Lf9_azS2:
zfc
s_cbranch_scc0 Lf9_azY2
zfd
zap 0x10680
zao
s_call_b64 s[88:89], Lf9_far
s_branch Lf9_azXb2
Lf9_azY2:
zaq 21,9,6
zaq 22,12,6
zbu 23,15
zbu 24,18
s_call_b64 s[88:89], Lf9_four
Lf9_azXb2:
zd 88,100
zd 89,101
zd 90,102
zd 91,103
za 32,156,76
zd 92,104
zd 93,105
zd 94,106
zd 95,107
za 32,180,80
zd 96,108
zd 97,109
zd 98,110
zd 99,111
za 32,204,84
ze 2
zm 36,32
zg 40,220
zm 37,33
zg 41,221
za 36,160,76
zm 38,34
zg 42,222
zm 39,35
zg 43,223
za 36,184,80
zk 32,25,14336
za 36,208,84
zg 36,40
zg 37,41
zg 38,42
zg 39,43
za 40,164,76
ze 1
s_barrier
zl 32,28,6144
zc 40,36,37
zc 41,38,39
za 40,188,80
zk 36,25,15360
za 40,212,84
zl 36,29,6144
zm 48,44
zg 52,224
zm 49,45
za 44,168,76
zg 53,225
zm 50,46
zg 54,226
zm 51,47
za 44,192,80
zk 40,25,16384
za 44,216,84
zl 44,28,7168
zg 55,227
zg 48,52
zg 49,53
zf 236,148,76
zg 50,54
zg 51,55
zc 52,48,49
zc 53,50,51
zf 236,172,80
zk 44,25,17408
zf 236,196,84
zl 48,29,7168
zah 42,52,40
zah 43,53,41
zai 40,52
zf 240,152,76
zai 41,53
zf 240,176,80
zfn
zbf 40,26
zl 52,30,7168
zl 40,30,6144
zf 240,200,84
s_branch Lf9_azH3
Lf9_azS3:
ze1
s_cbranch_scc0 Lf9_azY3
zfe
zap 0x15e00
zao
s_call_b64 s[88:89], Lf9_far
s_branch Lf9_azXb3
Lf9_azY3:
zaa 21,10,6
zaa 22,13,6
za8 23,16
za8 24,19
s_call_b64 s[88:89], Lf9_four
Lf9_azXb3:
zd 76,100
zd 77,101
zd 78,102
zd 79,103
ze 6
za 48,156,88
zd 80,104
zd 81,105
zd 82,106
zd 83,107
za 48,180,92
zd 84,108
zd 85,109
zd 86,110
zd 87,111
za 48,204,96
zm 36,32
ze 0
zg 40,228
zm 37,33
zg 41,229
za 52,160,88
zm 38,34
zg 42,230
zm 39,35
zg 43,231
za 52,184,92
zk 48,25,2048
za 52,208,96
zg 36,40
zg 37,41
zg 38,42
zg 39,43
za 56,164,88
s_barrier
zl 32,28,12288
zc 40,36,37
zc 41,38,39
za 56,188,92
zk 52,25,3072
za 56,212,96
zl 36,29,12288
zm 48,44
zg 52,232
zm 49,45
za 60,168,88
zg 53,233
zm 50,46
zg 54,234
zm 51,47
za 60,192,92
zk 56,25,4096
za 60,216,96
zl 44,28,13312
zg 55,235
zg 48,52
zg 49,53
zf 244,148,88
zg 50,54
zg 51,55
zc 52,48,49
zc 53,50,51
zf 244,172,92
zk 60,25,5120
zf 244,196,96
zl 48,29,13312
zah 42,52,40
zah 43,53,41
zai 40,52
zf 248,152,88
zai 41,53
zf 248,176,92
zbh 0xa800
zbf 40,26
zl 52,30,13312
zl 40,30,12288
zf 248,200,96
s_branch Lf9_azH4
Lf9_azS4:
ze0
s_cbranch_scc0 Lf9_azY4
zfs
zap 0x1b580
zao
s_call_b64 s[88:89], Lf9_far
s_branch Lf9_azXb4
Lf9_azY4:
zac 21,10,6
zac 22,13,6
za9 23,16
za9 24,19
s_call_b64 s[88:89], Lf9_four
Lf9_azXb4:
zd 88,100
zd 89,101
zd 90,102
zd 91,103
ze 6
za 68,156,76
zd 92,104
zd 93,105
zd 94,106
zd 95,107
za 68,180,80
zd 96,108
zd 97,109
zd 98,110
zd 99,111
za 68,204,84
zm 36,32
ze 0
zg 40,236
zm 37,33
zg 41,237
za 72,160,76
zm 38,34
zg 42,238
zm 39,35
zg 43,239
za 72,184,80
zk 68,25,8192
za 72,208,84
zg 36,40
zg 37,41
zg 38,42
zg 39,43
z7 76,164
s_barrier
za7 32,28
zc 40,36,37
zc 41,38,39
za 76,188,80
zk 72,25,9216
za 76,212,84
za7 36,29
zm 48,44
zg 52,240
zm 49,45
za 80,168,76
zg 53,241
zm 50,46
zg 54,242
zm 51,47
z7 80,192
zk 76,25,10240
za 80,216,84
zl 44,28,1024
zg 55,243
zg 48,52
zg 49,53
zf 252,148,76
zg 50,54
zg 51,55
zc 52,48,49
zc 53,50,51
zf 252,172,80
zk 80,25,11264
zf 252,196,84
zl 48,29,1024
zah 42,52,40
zah 43,53,41
zai 40,52
za 64,152,76
zai 41,53
za 64,176,80
zbh 0x15000
zbf 40,26
zl 52,30,1024
za7 40,30
za 64,200,84
s_branch Lf9_azH5
Lf9_azS5:
zft
s_cbranch_scc0 Lf9_azY5
zfu
zap 0x20d00
zao
s_call_b64 s[88:89], Lf9_far
s_branch Lf9_azXb5
Lf9_azY5:
zaj 21,10,6
zaj 22,13,6
zbm 23,16
zbm 24,19
s_call_b64 s[88:89], Lf9_four
Lf9_azXb5:
zd 76,100
zd 77,101
zd 78,102
zd 79,103
ze 6
za 92,156,88
zd 80,104
zd 81,105
zd 82,106
zd 83,107
z7 92,180
zd 84,108
zd 85,109
zd 86,110
zd 87,111
za 92,204,96
zm 36,32
ze 0
zg 40,244
zm 37,33
zg 41,245
za 96,160,88
zm 38,34
zg 42,246
zm 39,35
zg 43,247
za 96,184,92
zk 92,25,14336
z7 96,208
zg 36,40
zg 37,41
zg 38,42
zg 39,43
za 100,164,88
s_barrier
zl 32,28,6144
zc 40,36,37
zc 41,38,39
za 100,188,92
zk 96,25,15360
za 100,212,96
zl 36,29,6144
zm 48,44
zg 52,248
zm 49,45
za 104,168,88
zg 53,249
zm 50,46
zg 54,250
zm 51,47
za 104,192,92
zk 100,25,16384
za 104,216,96
zl 44,28,7168
zg 55,251
zg 48,52
zg 49,53
za 84,148,88
zg 50,54
zg 51,55
zc 52,48,49
zc 53,50,51
za 84,172,92
zk 104,25,17408
za 84,196,96
zl 48,29,7168
zah 42,52,40
zah 43,53,41
zai 40,52
z7 88,152
zai 41,53
za 88,176,92
zbh 0x1f800
zbf 40,26
zl 52,30,7168
zl 40,30,6144
za 88,200,96
s_branch Lf9_azH6
Lf9_azS6:
zfv
s_cbranch_scc0 Lf9_azY6
zfw
zap 0x26480
zao
s_call_b64 s[88:89], Lf9_far
s_branch Lf9_azXb6
Lf9_azY6:
zaq 21,10,6
zaq 22,13,6
zbu 23,16
zbu 24,19
s_call_b64 s[88:89], Lf9_four
Lf9_azXb6:
zd 88,100
zd 89,101
zd 90,102
zd 91,103
ze 6
za 116,156,76
zd 92,104
zd 93,105
zd 94,106
zd 95,107
zd 96,108
za 116,180,80
zd 97,109
zd 98,110
zd 99,111
zm 36,32
ze 0
zg 40,252
za 116,204,84
zm 37,33
zg 41,253
zm 38,34
zg 42,254
zm 39,35
za 120,160,76
zam
zk 116,25,2048
zg 43,255
zg 36,40
zg 37,41
za 120,184,80
zg 38,42
zg 39,43
zc 40,36,37
zc 41,38,39
za 120,208,84
zm 48,44
z9 44,64
zg 52,44
zm 49,45
za 124,164,76
s_barrier
zl 32,28,12288
zl 36,29,12288
z9 45,65
za 124,188,80
zk 120,25,3072
za 124,212,84
zg 53,45
zm 50,46
z9 46,66
zg 54,46
za 128,168,76
zm 51,47
z9 47,67
zg 55,47
zg 48,52
za 128,192,80
zk 124,25,4096
za 128,216,84
zl 44,28,13312
zg 49,53
zg 50,54
zg 51,55
za 108,148,76
zc 52,48,49
zc 53,50,51
zah 42,52,40
zah 43,53,41
za 108,172,80
zk 128,25,5120
za 108,196,84
zl 48,29,13312
zai 40,52
zai 41,53
za 112,152,76
zbh 0x2a000
zbf 40,26
zl 52,30,13312
za 112,176,80
zl 40,30,12288
za 112,200,84
s_branch Lf9_azH7
Lf9_azS7:
zf8
s_cbranch_scc0 Lf9_azY7
zgl
zap 0x2bc00
zao
s_call_b64 s[88:89], Lf9_far
s_branch Lf9_azXb7
Lf9_azY7:
zaa 21,11,6
zaa 22,14,6
za8 23,17
za8 24,20
s_call_b64 s[88:89], Lf9_four
Lf9_azXb7:
zd 76,100
zd 77,101
zd 78,102
zd 79,103
ze 6
za 140,156,88
zd 80,104
zd 81,105
zd 82,106
zd 83,107
zd 84,108
za 140,180,92
zd 85,109
zd 86,110
zd 87,111
zm 36,32
z9 32,84
za 140,204,96
ze 0
zg 40,32
zm 37,33
z9 33,85
zg 41,33
zm 38,34
za 144,160,88
zv
zk 140,25,8192
z9 34,86
zg 42,34
zm 39,35
za 144,184,92
z9 35,87
zg 43,35
zg 36,40
zg 37,41
zg 38,42
za 144,208,96
zg 39,43
zc 40,36,37
zc 41,38,39
zm 48,44
za 148,164,88
s_barrier
za7 32,28
za7 36,29
z9 44,88
za 148,188,92
zk 144,25,9216
za 148,212,96
zg 52,44
zm 49,45
z9 45,89
zg 53,45
za 152,168,88
zm 50,46
z9 46,90
zg 54,46
zm 51,47
za 152,192,92
zk 148,25,10240
za 152,216,96
z9 47,91
zg 55,47
zg 48,52
zg 49,53
za 132,148,88
zl 44,28,1024
zg 50,54
zg 51,55
zc 52,48,49
za 132,172,92
zk 152,25,11264
za 132,196,96
zc 53,50,51
zah 42,52,40
zah 43,53,41
zai 40,52
za 136,152,88
zl 48,29,1024
zai 41,53
za 136,176,92
zbh 0x34800
zbf 40,26
zl 52,30,1024
za7 40,30
za 136,200,96
s_branch Lf9_azH8
Lf9_ayS0:
ze8
s_cbranch_scc0 Lf9_ayY0
ze9
zap 0x5780
zao
s_call_b64 s[88:89], Lf9_far
s_branch Lf9_ayXb0
Lf9_ayY0:
zac 21,9,6
zac 22,12,6
za9 23,15
za9 24,18
s_call_b64 s[88:89], Lf9_four
Lf9_ayXb0:
zd 88,100
zd 89,101
zd 90,102
zd 91,103
ze 15
za 0,156,76
zd 92,104
zd 93,105
zd 94,106
zd 95,107
zd 96,108
za 4,160,76
zu 0
zb 204,1,12352
zb 206,1,13888
zd 97,109
zd 98,110
zd 99,111
ze 10
za 8,164,76
zb 208,2,12352
zb 210,2,13888
zb 212,1,12416
zb 214,1,13952
zb 216,2,12416
za 12,168,76
zb 218,2,13952
zb 196,1,12288
zb 198,1,13824
zb 200,2,12288
zb 202,2,13824
zf 220,148,76
zx 36,69
zr 37,69
zcl 38,48
zbs 39,33
zf 224,152,76
ze 12
z2 38
z2 39
zg 36,38
zg 37,39
za 0,180,80
zs 38
zs 39
zs 36
zs 37
za 4,184,80
zq 38,39
zq 36,37
zr 37,36
zav 36,38
za 8,188,80
zaw 36
z3 45,37
z3 44,36
z4 47,37,45
za 12,192,80
z4 46,36,44
zax 47
z5 36,46
z5 37,47
zf 220,172,80
zbg 40,44,49
zay 41,45,50
zw 38,36,37
zaz 36,47
zf 224,176,80
ze 0
za0 37,46
zw 39,46,47
za1 41,45
za2 41,51
za 0,204,84
za3 36,37
zas 37
za4 41,40
zq 38,39
za 4,208,84
zq 36,37
za5 37,52
zcm 40,44
zcn 39
za 8,212,84
zk 0,25,2048
za 12,216,84
zv
zk 4,25,3072
za6 11,41
zf 220,196,84
z8 17,38,7
z8 20,36,7
zco
zau 14,37,11
zcp
zf 224,200,84
zcq
s_branch Lf9_ayH1
Lf9_ayS1:
zfa
s_cbranch_scc0 Lf9_ayY1
zfb
zap 0xaf00
zao
s_call_b64 s[88:89], Lf9_far
s_branch Lf9_ayXb1
Lf9_ayY1:
zaj 21,9,6
zaj 22,12,6
zbm 23,15
zbm 24,18
s_call_b64 s[88:89], Lf9_four
Lf9_ayXb1:
zd 76,100
zd 77,101
zd 78,102
zd 79,103
za 16,156,88
zd 80,104
zd 81,105
zd 82,106
za 16,180,92
zd 83,107
zd 84,108
zd 85,109
za 16,204,96
zk 8,25,4096
zd 86,110
zd 87,111
za 20,160,88
zk 12,25,5120
za 20,184,92
zdl 220,25
za 20,208,96
zat 224,25,1024
za 24,164,88
zk 16,25,8192
za 24,188,92
zbl
zk 20,25,9216
za 24,212,96
ze 2
s_barrier
za 28,168,88
za 28,192,92
za 28,216,96
zf 228,148,88
zam
zk 24,25,10240
zf 228,172,92
zb0
zk 28,25,11264
zf 228,196,96
zf 232,152,88
zf 232,176,92
zf 232,200,96
zcr
zat 228,25,6144
s_branch Lf9_ayH2
Lf9_ayS2:
zfc
s_cbranch_scc0 Lf9_ayY2
zfd
zap 0x10680
zao
s_call_b64 s[88:89], Lf9_far
s_branch Lf9_ayXb2
Lf9_ayY2:
zaq 21,9,6
zaq 22,12,6
zbu 23,15
zbu 24,18
s_call_b64 s[88:89], Lf9_four
Lf9_ayXb2:
zd 88,100
zd 89,101
zd 90,102
zd 91,103
za 32,156,76
zd 92,104
zd 93,105
za 32,180,80
zd 94,106
zd 95,107
za 32,204,84
zd 96,108
zd 97,109
za 36,160,76
zd 98,110
zd 99,111
za 36,184,80
zat 232,25,7168
za 36,208,84
zk 32,25,14336
za 40,164,76
za 40,188,80
za 40,212,84
ze 1
s_barrier
zam
zk 36,25,15360
za 44,168,76
za 44,192,80
za 44,216,84
zk 40,25,16384
zf 236,148,76
zf 236,172,80
zf 236,196,84
zbl
zk 44,25,17408
zf 240,152,76
zf 240,176,80
zf 240,200,84
zat 236,25,12288
s_branch Lf9_ayH3
Lf9_ayS3:
ze1
s_cbranch_scc0 Lf9_ayY3
zfe
zap 0x15e00
zao
s_call_b64 s[88:89], Lf9_far
s_branch Lf9_ayXb3
Lf9_ayY3:
zaa 21,10,6
zaa 22,13,6
za8 23,16
za8 24,19
s_call_b64 s[88:89], Lf9_four
Lf9_ayXb3:
zd 76,100
zd 77,101
zd 78,102
zd 79,103
za 48,156,88
zd 80,104
zd 81,105
za 48,180,92
zd 82,106
zd 83,107
za 48,204,96
zd 84,108
zd 85,109
za 52,160,88
zd 86,110
zd 87,111
za 52,184,92
zat 240,25,13312
za 52,208,96
zk 48,25,2048
za 56,164,88
za 56,188,92
za 56,212,96
ze 1
s_barrier
zam
zk 52,25,3072
za 60,168,88
za 60,192,92
za 60,216,96
zk 56,25,4096
zf 244,148,88
zf 244,172,92
zf 244,196,96
zbl
zk 60,25,5120
zf 248,152,88
zf 248,176,92
zf 248,200,96
zdl 244,25
s_branch Lf9_ayH4
Lf9_ayS4:
ze0
s_cbranch_scc0 Lf9_ayY4
zfs
zap 0x1b580
zao
s_call_b64 s[88:89], Lf9_far
s_branch Lf9_ayXb4
Lf9_ayY4:
zac 21,10,6
zac 22,13,6
za9 23,16
za9 24,19
s_call_b64 s[88:89], Lf9_four
Lf9_ayXb4:
zd 88,100
zd 89,101
zd 90,102
zd 91,103
za 68,156,76
zd 92,104
zd 93,105
za 68,180,80
zd 94,106
zd 95,107
za 68,204,84
zd 96,108
zd 97,109
za 72,160,76
zd 98,110
zd 99,111
za 72,184,80
zat 248,25,1024
za 72,208,84
zk 68,25,8192
z7 76,164
za 76,188,80
za 76,212,84
ze 1
s_barrier
zam
zk 72,25,9216
za 80,168,76
z7 80,192
za 80,216,84
zk 76,25,10240
zf 252,148,76
zf 252,172,80
zf 252,196,84
zbl
zk 80,25,11264
za 64,152,76
za 64,176,80
za 64,200,84
zat 252,25,6144
s_branch Lf9_ayH5
Lf9_ayS5:
zft
s_cbranch_scc0 Lf9_ayY5
zfu
zap 0x20d00
zao
s_call_b64 s[88:89], Lf9_far
s_branch Lf9_ayXb5
Lf9_ayY5:
zaj 21,10,6
zaj 22,13,6
zbm 23,16
zbm 24,19
s_call_b64 s[88:89], Lf9_four
Lf9_ayXb5:
zd 76,100
zd 77,101
zd 78,102
zd 79,103
za 92,156,88
zd 80,104
zd 81,105
z7 92,180
zd 82,106
zd 83,107
za 92,204,96
zd 84,108
zd 85,109
za 96,160,88
zd 86,110
zd 87,111
za 96,184,92
zk 64,25,7168
z7 96,208
zk 92,25,14336
za 100,164,88
za 100,188,92
za 100,212,96
ze 1
s_barrier
zam
zk 96,25,15360
za 104,168,88
za 104,192,92
za 104,216,96
zk 100,25,16384
za 84,148,88
za 84,172,92
za 84,196,96
zbl
zk 104,25,17408
z7 88,152
za 88,176,92
za 88,200,96
zk 84,25,12288
s_branch Lf9_ayH6
Lf9_ayS6:
zfv
s_cbranch_scc0 Lf9_ayY6
zfw
zap 0x26480
zao
s_call_b64 s[88:89], Lf9_far
s_branch Lf9_ayXb6
Lf9_ayY6:
zaq 21,10,6
zaq 22,13,6
zbu 23,16
zbu 24,19
s_call_b64 s[88:89], Lf9_four
Lf9_ayXb6:
zd 88,100
zd 89,101
zd 90,102
zd 91,103
za 116,156,76
zd 92,104
zd 93,105
za 116,180,80
zd 94,106
zd 95,107
za 116,204,84
zd 96,108
zd 97,109
za 120,160,76
zd 98,110
zd 99,111
za 120,184,80
zk 88,25,13312
za 120,208,84
zk 116,25,2048
za 124,164,76
za 124,188,80
za 124,212,84
ze 1
s_barrier
zam
zk 120,25,3072
za 128,168,76
za 128,192,80
za 128,216,84
zk 124,25,4096
za 108,148,76
za 108,172,80
za 108,196,84
zbl
zk 128,25,5120
za 112,152,76
za 112,176,80
za 112,200,84
zfr 108,25
s_branch Lf9_ayH7
Lf9_ayS7:
zf8
s_cbranch_scc0 Lf9_ayY7
zgl
zap 0x2bc00
zao
s_call_b64 s[88:89], Lf9_far
s_branch Lf9_ayXb7
Lf9_ayY7:
zaa 21,11,6
zaa 22,14,6
za8 23,17
za8 24,20
s_call_b64 s[88:89], Lf9_four
Lf9_ayXb7:
zd 76,100
zd 77,101
zd 78,102
zd 79,103
za 140,156,88
zd 80,104
zd 81,105
za 140,180,92
zd 82,106
zd 83,107
za 140,204,96
zd 84,108
zd 85,109
za 144,160,88
zd 86,110
zd 87,111
za 144,184,92
zk 112,25,1024
za 144,208,96
zk 140,25,8192
za 148,164,88
za 148,188,92
za 148,212,96
ze 1
s_barrier
zam
zk 144,25,9216
za 152,168,88
za 152,192,92
za 152,216,96
zk 148,25,10240
za 132,148,88
za 132,172,92
za 132,196,96
zbl
zk 152,25,11264
za 136,152,88
za 136,176,92
za 136,200,96
zk 132,25,6144
s_branch Lf9_ayH8
Lf9_aqS0:
zdz
s_cbranch_scc0 Lf9_aqY0
s_add_u32 s90, s64, 0
s_add_u32 s91, s66, 0
zao
s_call_b64 s[88:89], Lf9_far
s_branch Lf9_aqXb0
Lf9_aqY0:
zaa 21,9,6
zaa 22,12,6
za8 23,15
za8 24,18
s_call_b64 s[88:89], Lf9_four
Lf9_aqXb0:
zd 76,100
zd 77,101
zd 78,102
zd 79,103
zd 80,104
zd 81,105
zd 82,106
zd 83,107
zd 84,108
zd 85,109
zd 86,110
zd 87,111
zu 13
zo 148,1
zb 150,1,1536
zo 152,2
zb 154,2,1536
zb 156,1,64
zb 158,1,1600
zb 160,2,64
zb 162,2,1600
zb 164,1,128
zb 166,1,1664
zb 168,2,128
zb 170,2,1664
zu 7
zb 172,1,6144
zb 174,1,7680
zb 176,2,6144
zb 178,2,7680
zb 180,1,6208
zb 182,1,7744
zb 184,2,6208
zb 186,2,7744
zb 188,1,6272
zb 190,1,7808
zb 192,2,6272
zb 194,2,7808
s_branch Lf9_aqE2
Lf9_atS0:
ze8
s_cbranch_scc0 Lf9_atY0
ze9
zap 0x5780
zao
s_call_b64 s[88:89], Lf9_far
s_branch Lf9_atXb0
Lf9_atY0:
zac 21,9,6
zac 22,12,6
za9 23,15
za9 24,18
s_call_b64 s[88:89], Lf9_four
Lf9_atXb0:
ze 15
zh 220,148,76
zd 88,100
zd 89,101
zd 90,102
zh 224,152,76
zd 91,103
zd 92,104
zd 93,105
zp 0,156,76
zd 94,106
zd 95,107
zd 96,108
zp 4,160,76
ze 14
zd 97,109
zd 98,110
zd 99,111
zp 8,164,76
zu 1
zb 196,1,12288
zb 198,1,13824
zb 200,2,12288
ze 13
zp 12,168,76
zb 202,2,13824
zb 204,1,12352
zb 206,1,13888
zf 220,172,80
ze 8
zb 208,2,12352
zb 210,2,13888
zf 224,176,80
zb 212,1,12416
zb 214,1,13952
za 0,180,80
zb 216,2,12416
zb 218,2,13952
za 4,184,80
zf1
zcv
zcw 0xdf
zbt 0xa800
zdd 0x9000
za 8,188,80
zcx
zv
zae 25
ze 12
za 12,192,80
zan 0x400
zv
zae 26
ze 9
zf 220,196,84
zan 0x800
zv
zae 27
ze 4
zf 224,200,84
zan 0xc00
zv
zae 28
za 0,204,84
zcy 0x3fffffff
zan 0x1000
zv
zae 29
zcz
za 4,208,84
ze 0
za 8,212,84
za 12,216,84
s_branch Lf9_atH1
Lf9_atS1:
zfa
s_cbranch_scc0 Lf9_atY1
zfb
zap 0xaf00
zao
s_call_b64 s[88:89], Lf9_far
s_branch Lf9_atXb1
Lf9_atY1:
zaj 21,9,6
zaj 22,12,6
zbm 23,15
zbm 24,18
s_call_b64 s[88:89], Lf9_four
Lf9_atXb1:
ze 0
zh 228,148,88
zd 76,100
zd 77,101
zd 78,102
zd 79,103
zf 228,172,92
zd 80,104
zd 81,105
zd 82,106
zd 83,107
zf 228,196,96
zd 84,108
zd 85,109
zd 86,110
zh 232,152,88
zgj
zcv
zcw 0xdf
zbt 0xa800
zdd 0xd800
zd 87,111
zf 232,176,92
zid
zgk
s_cselect_b32 s42, 0x23000, s42
zcx
zv
zae 25
zf 232,200,96
zan 0x400
zv
zae 26
zan 0x800
zv
zae 27
zp 16,156,88
zan 0xc00
zv
zae 28
zcy 0x3fffffff
zan 0x1000
zv
zae 29
zcz
za 16,180,92
zc8 0x2bc00
zfi 68,35
zu 11
zx 36,62
zr 37,62
za 16,204,96
zci 38,48
zbs 39,33
z2 38
zp 20,160,88
z2 39
zg 36,38
zg 37,39
za 20,184,92
zs 38
zs 39
za 20,208,96
zs 36
zs 37
zp 24,164,88
zq 38,39
zq 36,37
za 24,188,92
zr 37,36
zav 36,38
za 24,212,96
zaw 36
z3 45,37
zp 28,168,88
z3 44,36
z4 47,37,45
za 28,192,92
zbr 0x11000
zdw 1
zdw 2
za 28,216,96
s_branch Lf9_atH2
Lf9_atS2:
zfc
s_cbranch_scc0 Lf9_atY2
zfd
zap 0x10680
zao
s_call_b64 s[88:89], Lf9_far
s_branch Lf9_atXb2
Lf9_atY2:
zaq 21,9,6
zaq 22,12,6
zbu 23,15
zbu 24,18
s_call_b64 s[88:89], Lf9_four
Lf9_atXb2:
ze 0
zh 236,148,76
zd 88,100
zd 89,101
zd 90,102
zf 236,172,80
zd 91,103
zd 92,104
zd 93,105
zf 236,196,84
zd 94,106
zd 95,107
zd 96,108
zh 240,152,76
zd 97,109
zd 98,110
zd 99,111
zf 240,176,80
zf2 32,35
z6 0x3000
zc7 0x3000
z0 42
zf 240,200,84
zn 43,1024
zn 53,2048
zp 32,156,76
z4 46,36,44
zci 38,48
z2 38
za 32,180,80
zd1 39,49
zd2 38,39
zax 47
za 32,204,84
z5 36,46
z5 37,47
zd3 40,44,49,38
zp 36,160,76
zay 41,45,50
zw 38,36,37
zaz 36,47
za 36,184,80
za0 37,46
zw 39,46,47
za1 41,45
za 36,208,84
za2 41,51
za3 36,37
zas 37
zp 40,164,76
za4 41,40
zq 38,39
za 40,188,80
zq 36,37
za5 37,52
za 40,212,84
zca 40,44
zcb 39
zp 44,168,76
za6 10,41
z8 16,38,7
z8 19,36,7
za 44,192,80
zcc
zau 13,37,10
zcd
zce
za 44,216,84
s_branch Lf9_atH3
Lf9_atS3:
ze1
s_cbranch_scc0 Lf9_atY3
zfe
zap 0x15e00
zao
s_call_b64 s[88:89], Lf9_far
s_branch Lf9_atXb3
Lf9_atY3:
zaa 21,10,6
zaa 22,13,6
za8 23,16
za8 24,19
s_call_b64 s[88:89], Lf9_four
Lf9_atXb3:
ze 0
zh 244,148,88
zd 76,100
zd 77,101
zd 78,102
zd 79,103
zf 244,172,92
zd 80,104
zd 81,105
zd 82,106
zd 83,107
zf 244,196,96
zd 84,108
zd 85,109
zd 86,110
zd 87,111
zh 248,152,88
ze5
zc6 60,35,16
z6 0x3000
zc7 0x3000
zn 42,3072
zf 248,176,92
z6 0x4000
zc7 0x4000
z0 43
zf 248,200,96
zn 53,1024
zcg
zcu
z0 42
zp 48,156,88
zu 9
zx 36,68
zr 37,68
zcl 38,48
za 48,180,92
zbs 39,33
z2 38
z2 39
za 48,204,96
zg 36,38
zg 37,39
zs 38
zp 52,160,88
zs 39
zs 36
zs 37
za 52,184,92
zq 38,39
zq 36,37
zr 37,36
za 52,208,96
zav 36,38
zaw 36
z3 45,37
zp 56,164,88
z3 44,36
z4 47,37,45
z4 46,36,44
za 56,188,92
zcl 38,48
z2 38
zd1 39,49
za 56,212,96
zd2 38,39
zax 47
z5 36,46
zp 60,168,88
z5 37,47
zd3 40,44,49,38
za 60,192,92
zay 41,45,50
zw 38,36,37
za 60,216,96
s_branch Lf9_atH4
Lf9_atS4:
ze0
s_cbranch_scc0 Lf9_atY4
zfs
zap 0x1b580
zao
s_call_b64 s[88:89], Lf9_far
s_branch Lf9_atXb4
Lf9_atY4:
zac 21,10,6
zac 22,13,6
za9 23,16
za9 24,19
s_call_b64 s[88:89], Lf9_four
Lf9_atXb4:
ze 0
zh 252,148,76
zd 88,100
zd 89,101
zd 90,102
zf 252,172,80
zd 91,103
zd 92,104
zd 93,105
zf 252,196,84
zd 94,106
zd 95,107
zd 96,108
zp 64,152,76
zd 97,109
zd 98,110
zd 99,111
za 64,176,80
zc8 0x15e00
zc6 66,35,16
zcg
zcu
zn 43,1024
za 64,200,84
zn 53,2048
zn 42,3072
zp 68,156,76
zaz 36,47
za0 37,46
zw 39,46,47
za 68,180,80
za1 41,45
za2 41,51
za3 36,37
za 68,204,84
zas 37
za4 41,40
zq 38,39
zp 72,160,76
zq 36,37
za5 37,52
zcm 40,44
za 72,184,80
zcn 39
za6 11,41
z8 17,38,7
za 72,208,84
z8 20,36,7
zco
zau 14,37,11
zex 76,164
zcp
zcq
zx 36,57
zr 37,57
za 76,188,80
zdx 38,48
zcj 39,33
z2 38
za 76,212,84
z2 39
zg 36,38
zp 80,168,76
zg 37,39
zs 38
z7 80,192
zs 39
zs 36
za 80,216,84
s_branch Lf9_atH5
Lf9_atS5:
zft
s_cbranch_scc0 Lf9_atY5
zfu
zap 0x20d00
zao
s_call_b64 s[88:89], Lf9_far
s_branch Lf9_atXb5
Lf9_atY5:
zaj 21,10,6
zaj 22,13,6
zbm 23,16
zbm 24,19
s_call_b64 s[88:89], Lf9_four
Lf9_atXb5:
ze 0
zp 84,148,88
zd 76,100
zd 77,101
zd 78,102
zd 79,103
za 84,172,92
zd 80,104
zd 81,105
zd 82,106
zd 83,107
za 84,196,96
zd 84,108
zd 85,109
zd 86,110
zex 88,152
zc8 0x2bc00
zc6 72,35,16
z6 0x1000
zag 0x1000
z0 43
zd 87,111
za 88,176,92
zn 53,1024
zn 42,2048
za 88,200,96
zn 43,3072
zs 37
zp 92,156,88
zq 38,39
zq 36,37
zr 37,36
z7 92,180
zav 36,38
zaw 36
z3 45,37
za 92,204,96
z3 44,36
z4 47,37,45
z4 46,36,44
zp 96,160,88
zax 47
z5 36,46
z5 37,47
za 96,184,92
zbg 40,44,49
zay 41,45,50
zw 38,36,37
z7 96,208
zaz 36,47
za0 37,46
zw 39,46,47
zp 100,164,88
za1 41,45
za2 41,51
za3 36,37
za 100,188,92
zas 37
za4 41,40
zq 38,39
za 100,212,96
zq 36,37
za5 37,52
zp 104,168,88
zdf 40,44
zdg 39
za 104,192,92
za6 9,41
z8 15,38,7
za 104,216,96
s_branch Lf9_atH6
Lf9_atS6:
zfv
s_cbranch_scc0 Lf9_atY6
zfw
zap 0x26480
zao
s_call_b64 s[88:89], Lf9_far
s_branch Lf9_atXb6
Lf9_atY6:
zaq 21,10,6
zaq 22,13,6
zbu 23,16
zbu 24,19
s_call_b64 s[88:89], Lf9_four
Lf9_atXb6:
ze 0
zp 108,148,76
zd 88,100
zd 89,101
zd 90,102
zd 91,103
zp 112,152,76
zd 92,104
zd 93,105
zd 94,106
zp 116,156,76
z6 0x2000
zag 0x2000
z0 53
zd 95,107
zp 120,160,76
zn 42,1024
zn 43,2048
zp 124,164,76
zn 53,3072
z8 18,36,7
zp 128,168,76
zdh
zd 76,108
zd 77,109
zd 78,110
za 108,172,80
zd 79,111
zau 12,37,9
zdi
za 112,176,80
zdj
zx 36,63
zr 37,63
zfl 38,48
za 116,180,80
zcj 39,33
z2 38
z2 39
za 120,184,80
zg 36,38
zg 37,39
zs 38
za 124,188,80
zs 39
zs 36
zs 37
za 128,192,80
zq 38,39
zq 36,37
zr 37,36
za 108,196,84
zav 36,38
zaw 36
z3 45,37
za 112,200,84
z3 44,36
z4 47,37,45
z4 46,36,44
za 116,204,84
zax 47
z5 36,46
z5 37,47
za 120,208,84
zbg 40,44,49
zay 41,45,50
zw 38,36,37
za 124,212,84
zaz 36,47
za0 37,46
za 128,216,84
s_branch Lf9_atH7
Lf9_atS7:
zf8
s_cbranch_scc0 Lf9_atY7
zgl
zap 0x2bc00
zao
s_call_b64 s[88:89], Lf9_far
s_branch Lf9_atXb7
Lf9_atY7:
zaa 21,11,6
zaa 22,14,6
za8 23,17
za8 24,20
s_call_b64 s[88:89], Lf9_four
Lf9_atXb7:
ze 0
zp 132,148,88
zd 84,100
zd 85,101
zd 86,102
zd 87,103
zd 96,104
zp 136,152,88
zd 97,105
zd 98,106
zd 99,107
zw 39,46,47
za1 41,45
zp 140,156,88
za2 41,51
za3 36,37
zas 37
za4 41,40
zq 38,39
zp 144,160,88
zq 36,37
za5 37,52
zca 40,44
zcb 39
zp 148,164,88
za6 10,41
z8 16,38,7
z8 19,36,7
zcc
zp 152,168,88
zd 88,108
zd 89,109
zd 90,110
zd 91,111
zau 13,37,10
za 132,172,92
zcd
zce
zu 21
zx 36,32
zr 37,32
zf3 38,48
za 136,176,92
ze2 39,33
z2 38
z2 39
zg 36,38
zg 37,39
za 140,180,92
zs 38
zs 39
zs 36
zs 37
za 144,184,92
zq 38,39
zq 36,37
zr 37,36
zav 36,38
za 148,188,92
zaw 36
z3 45,37
z3 44,36
z4 47,37,45
za 152,192,92
z4 46,36,44
zax 47
z5 36,46
z5 37,47
za 132,196,76
zbg 40,44,49
zay 41,45,50
zw 38,36,37
zaz 36,47
za 136,200,76
za0 37,46
zw 39,46,47
za1 41,45
za2 41,51
za 140,204,76
za3 36,37
zas 37
za4 41,40
zq 38,39
za 144,208,76
zq 36,37
za5 37,52
zcm 40,44
zcn 39
za6 11,41
za 148,212,76
z8 17,38,7
z8 20,36,7
zco
zau 14,37,11
zcp
za 152,216,76
zcq
s_branch Lf9_atH8
Lf9_atS8:
zf8
s_cbranch_scc0 Lf9_atY8
s_add_u32 s90, s78, 0
s_add_u32 s91, s79, 0
zdu
s_call_b64 s[88:89], Lf9_far
s_branch Lf9_atXb8
Lf9_atY8:
zaa 21,11,6
zaa 22,14,6
za8 23,17
za8 24,20
s_call_b64 s[88:89], Lf9_four
Lf9_atXb8:
ze 0
zp 156,148,84
zf4 8,0
zd 76,100
zd 77,101
zp 160,152,84
zd 78,102
zd 79,103
zd 80,104
zp 164,156,84
zd 81,105
zd 82,106
zd 83,107
zp 168,160,84
zp 172,164,84
zp 176,168,84
zd 84,108
zd 85,109
zd 86,110
za 156,172,96
zb 148,1,12288
zb 150,1,13824
zd 87,111
za 160,176,96
zb 152,2,12288
zb 154,2,13824
zb 156,1,12352
za 164,180,96
zb 158,1,13888
zb 160,2,12352
zb 162,2,13888
za 168,184,96
zb 164,1,12416
zb 166,1,13952
za 172,188,96
zb 168,2,12416
zb 170,2,13952
za 176,192,96
zb 172,1,30720
zb 174,1,32256
za 156,196,88
zb 176,2,30720
zb 178,2,32256
za 160,200,88
zb 180,1,30784
zb 182,1,32320
za 164,204,88
zb 184,2,30784
zb 186,2,32320
za 168,208,88
zb 188,1,30848
zb 190,1,32384
za 172,212,88
zb 192,2,30848
zb 194,2,32384
za 176,216,88
s_branch Lf9_atE2
Lf9_as0S0:
zff
s_cbranch_scc0 Lf9_as0Y0
zfg
zec 0x5780
zdu
s_call_b64 s[88:89], Lf9_far
s_branch Lf9_as0Xb0
Lf9_as0Y0:
zac 21,11,6
zac 22,14,6
za9 23,17
za9 24,20
s_call_b64 s[88:89], Lf9_four
Lf9_as0Xb0:
ze 15
zf 220,148,76
zd 88,100
zd 89,101
zd 90,102
zd 91,103
zf 224,152,76
zd 92,104
zd 93,105
zd 94,106
zd 95,107
za 0,156,76
zb 204,1,49216
zb 206,1,50752
zb 208,2,49216
za 4,160,76
ze 11
zb 210,2,50752
zb 212,1,49280
zb 214,1,50816
za 8,164,76
zb 216,2,49280
zb 218,2,50816
zb 196,1,49152
za 12,168,76
ze 11
zd 76,108
zd 77,109
zd 78,110
zf 220,188,80
ze 9
zb 198,1,50688
zb 200,2,49152
zb 202,2,50688
zd 79,111
zf 224,192,80
zbr 0x11000
zbb 1
zbb 2
zb2 54
za 0,172,80
zb3 54
zbz 25,54
zbc 0x5800
zbw
zbd
za 4,176,80
ze 0
s_barrier
z6 0x3000
zag 0x3000
z0 42
za 8,180,80
zbe
zn 43,1024
zn 53,2048
za 12,184,80
zn 42,3072
z6 0x4000
zag 0x4000
z0 43
zf 220,204,84
zn 53,1024
zal 28,54
zf 224,208,84
zbc 0x9800
zby
zbd
zbe
za 0,212,84
zal 29,54
zb5
za 4,216,84
zb6 0x1e800
zal 30,54
zb7 54
zbv 26,4
za 8,196,84
zbk 26,54
zb8
za 12,200,84
zb9 26
s_branch Lf9_as0H1
Lf9_as0S1:
zgz
s_cbranch_scc0 Lf9_as0Y1
zic
zec 0xaf00
zdu
s_call_b64 s[88:89], Lf9_far
s_branch Lf9_as0Xb1
Lf9_as0Y1:
zaj 21,11,6
zaj 22,14,6
zbm 23,17
zbm 24,20
s_call_b64 s[88:89], Lf9_four
Lf9_as0Xb1:
ze 0
zf 228,148,88
zd 84,100
zd 85,101
zf 232,152,88
zd 86,102
zd 87,103
za 16,156,88
zd 96,104
zd 97,105
za 20,160,88
zd 98,106
zd 99,107
za 24,164,88
za 28,168,88
zd 88,108
zd 89,109
zf 228,188,92
zd 90,110
zd 91,111
zf 232,192,92
za 16,172,92
za 20,176,92
za 24,180,92
za 28,184,92
zf 228,204,76
zf 232,208,76
za 16,212,76
za 20,216,76
za 24,196,76
za 28,200,76
s_branch Lf9_as0H2
Lf9_as0S2:
zdz
s_cbranch_scc0 Lf9_as0Y2
zet
zeu
zev
s_call_b64 s[88:89], Lf9_far
s_branch Lf9_as0Xb2
Lf9_as0Y2:
zaa 21,9,6
zaa 22,12,6
za8 23,15
za8 24,18
s_call_b64 s[88:89], Lf9_four
Lf9_as0Xb2:
ze 0
zf 236,148,84
zbn
zbq 8,0
zd 76,100
zd 77,101
zf 240,152,84
zbo
zd 78,102
zd 79,103
zd 80,104
za 32,156,84
zbp
zd 81,105
zd 82,106
zd 83,107
za 36,160,84
za 40,164,84
za 44,168,84
zd 84,108
zd 85,109
zd 86,110
zf 236,188,96
zu 12
zo 148,1
zb 150,1,1536
zd 87,111
zf 240,192,96
zo 152,2
zb 154,2,1536
zb 156,1,64
za 32,172,96
zb 158,1,1600
zb 160,2,64
zb 162,2,1600
za 36,176,96
zb 164,1,128
zb 166,1,1664
za 40,180,96
zb 168,2,128
zb 170,2,1664
za 44,184,96
zu 6
zb 172,1,6144
zb 174,1,7680
zf 236,204,88
zb 176,2,6144
zb 178,2,7680
zf 240,208,88
zb 180,1,6208
zb 182,1,7744
za 32,212,88
zb 184,2,6208
zb 186,2,7744
za 36,216,88
zb 188,1,6272
zb 190,1,7808
za 40,196,88
zb 192,2,6272
zb 194,2,7808
za 44,200,88
s_branch Lf9_as0E2
Lf9_as1S0:
zff
s_cbranch_scc0 Lf9_as1Y0
zfg
zec 0x5780
zdu
s_call_b64 s[88:89], Lf9_far
s_branch Lf9_as1Xb0
Lf9_as1Y0:
zac 21,11,6
zac 22,14,6
za9 23,17
za9 24,20
s_call_b64 s[88:89], Lf9_four
Lf9_as1Xb0:
ze 15
zf 244,156,76
zd 88,100
zd 89,101
zd 90,102
zd 91,103
zf 248,160,76
ze 14
zd 92,104
zd 93,105
zd 94,106
zd 95,107
za 48,164,76
ze 11
zd 96,108
zd 97,109
zd 98,110
za 52,168,76
zb 212,1,49280
zb 214,1,50816
zd 99,111
za 56,148,76
zb 216,2,49280
zb 218,2,50816
zb 196,1,49152
za 60,152,76
ze 7
zb 198,1,50688
zb 200,2,49152
zb 202,2,50688
zf 244,172,80
zb 204,1,49216
zb 206,1,50752
zb 208,2,49216
zb 210,2,50752
zf 248,176,80
zbr 0x11000
zbb 1
zbb 2
zb2 54
za 48,180,80
zb3 54
zbz 25,54
zbc 0x5800
zbw
zbd
za 52,184,80
ze 0
s_barrier
z6 0x3000
zag 0x3000
z0 42
za 56,188,80
zbe
zn 43,1024
zn 53,2048
za 60,192,80
zn 42,3072
z6 0x4000
zag 0x4000
z0 43
zf 244,212,84
zn 53,1024
zal 28,54
zf 248,216,84
zbc 0x9800
zby
zbd
zbe
za 48,196,84
zal 29,54
zb5
za 52,200,84
zb6 0x1e800
zal 30,54
zb7 54
zbv 26,4
za 56,204,84
zbk 26,54
zb8
za 60,208,84
zb9 26
s_branch Lf9_as1H1
Lf9_as1S1:
zdz
s_cbranch_scc0 Lf9_as1Y1
zet
zeu
zev
s_call_b64 s[88:89], Lf9_far
s_branch Lf9_as1Xb1
Lf9_as1Y1:
zaa 21,9,6
zaa 22,12,6
za8 23,15
za8 24,18
s_call_b64 s[88:89], Lf9_four
Lf9_as1Xb1:
ze 0
zf 252,156,88
zbn
zbq 8,0
zd 76,100
zd 77,101
za 64,160,88
zbo
zd 78,102
zd 79,103
zd 80,104
za 68,164,88
zbp
zd 81,105
zd 82,106
zd 83,107
za 72,168,88
zd 84,108
zd 85,109
za 76,148,88
zd 86,110
zd 87,111
za 80,152,88
zu 12
zo 148,1
zb 150,1,1536
zf 252,172,92
zo 152,2
zb 154,2,1536
za 64,176,92
zb 156,1,64
zb 158,1,1600
za 68,180,92
zb 160,2,64
zb 162,2,1600
za 72,184,92
zb 164,1,128
zb 166,1,1664
za 76,188,92
zb 168,2,128
zb 170,2,1664
za 80,192,92
zu 6
zb 172,1,6144
zb 174,1,7680
zf 252,212,96
zb 176,2,6144
zb 178,2,7680
za 64,216,96
zb 180,1,6208
zb 182,1,7744
za 68,196,96
zb 184,2,6208
zb 186,2,7744
za 72,200,96
zb 188,1,6272
zb 190,1,7808
za 76,204,96
zb 192,2,6272
zb 194,2,7808
za 80,208,96
s_branch Lf9_as1E2
Lf9_as2S0:
zff
s_cbranch_scc0 Lf9_as2Y0
zfg
zec 0x5780
zdu
s_call_b64 s[88:89], Lf9_far
s_branch Lf9_as2Xb0
Lf9_as2Y0:
zac 21,11,6
zac 22,14,6
za9 23,17
za9 24,20
s_call_b64 s[88:89], Lf9_four
Lf9_as2Xb0:
ze 14
za 84,164,76
ze 12
zd 88,100
zd 89,101
zd 90,102
zd 91,103
za 88,168,76
zd 92,104
zd 93,105
zd 94,106
zd 95,107
za 92,148,76
zd 96,108
zd 97,109
zd 98,110
za 96,152,76
zb 196,1,49152
zb 198,1,50688
zd 99,111
za 100,156,76
zb 200,2,49152
zb 202,2,50688
zb 204,1,49216
za 104,160,76
ze 7
zb 206,1,50752
zb 208,2,49216
zb 210,2,50752
za 84,180,80
zb 212,1,49280
zb 214,1,50816
zb 216,2,49280
zb 218,2,50816
za 88,184,80
zbr 0x11000
zbb 1
zbb 2
zb2 54
za 92,188,80
ze 12
zb3 54
zbz 25,54
zbc 0x5800
zbw
zbd
za 96,192,80
ze 0
s_barrier
z6 0x3000
zag 0x3000
z0 42
za 100,172,80
zbe
zn 43,1024
zn 53,2048
za 104,176,80
zn 42,3072
z6 0x4000
zag 0x4000
z0 43
z7 84,196
zn 53,1024
zal 28,54
za 88,200,84
zbc 0x9800
zby
zbd
zbe
za 92,204,84
zal 29,54
zb5
za 96,208,84
zb6 0x1e800
zal 30,54
zb7 54
zbv 26,4
za 100,212,84
zbk 26,54
zb8
za 104,216,84
zb9 26
s_branch Lf9_as2H1
Lf9_as2S1:
zdz
s_cbranch_scc0 Lf9_as2Y1
zet
zeu
zev
s_call_b64 s[88:89], Lf9_far
s_branch Lf9_as2Xb1
Lf9_as2Y1:
zaa 21,9,6
zaa 22,12,6
za8 23,15
za8 24,18
s_call_b64 s[88:89], Lf9_four
Lf9_as2Xb1:
ze 0
za 108,164,88
zbn
zbq 8,0
zd 76,100
zd 77,101
za 112,168,88
zbo
zd 78,102
zd 79,103
zd 80,104
za 116,148,88
zbp
zd 81,105
zd 82,106
zd 83,107
za 120,152,88
zd 84,108
zd 85,109
za 124,156,88
zd 86,110
zd 87,111
za 128,160,88
zu 12
zo 148,1
zb 150,1,1536
za 108,180,92
zo 152,2
zb 154,2,1536
za 112,184,92
zb 156,1,64
zb 158,1,1600
za 116,188,92
zb 160,2,64
zb 162,2,1600
za 120,192,92
zb 164,1,128
zb 166,1,1664
za 124,172,92
zb 168,2,128
zb 170,2,1664
za 128,176,92
zu 6
zb 172,1,6144
zb 174,1,7680
za 108,196,96
zb 176,2,6144
zb 178,2,7680
za 112,200,96
zb 180,1,6208
zb 182,1,7744
za 116,204,96
zb 184,2,6208
zb 186,2,7744
za 120,208,96
zb 188,1,6272
zb 190,1,7808
za 124,212,96
zb 192,2,6272
zb 194,2,7808
za 128,216,96
s_branch Lf9_as2E2
Lf9_as3S0:
zff
s_cbranch_scc0 Lf9_as3Y0
zfg
zec 0x5780
zdu
s_call_b64 s[88:89], Lf9_far
s_branch Lf9_as3Xb0
Lf9_as3Y0:
zac 21,11,6
zac 22,14,6
za9 23,17
za9 24,20
s_call_b64 s[88:89], Lf9_four
Lf9_as3Xb0:
ze 15
za 132,148,76
zd 88,100
zd 89,101
zd 90,102
za 136,152,76
zd 91,103
zd 92,104
zd 93,105
za 140,156,76
zd 94,106
zd 95,107
zd 96,108
za 144,160,76
ze 9
zd 97,109
zd 98,110
zd 99,111
za 148,164,76
zb 204,1,49216
zb 206,1,50752
zb 208,2,49216
za 152,168,76
ze 5
zb 210,2,50752
zb 212,1,49280
za 132,188,80
ze 5
zb 214,1,50816
zb 216,2,49280
za 136,192,80
zb 218,2,50816
zb 196,1,49152
za 140,172,80
zb 198,1,50688
zb 200,2,49152
zb 202,2,50688
za 144,176,80
ze 0
s_barrier
zbr 0x11000
zbb 1
zbb 2
za 148,180,80
zb2 54
zb3 54
za 152,184,80
zbz 25,54
zbc 0x5800
zbw
zbd
za 132,204,84
zbe
zal 28,54
zbc 0x9800
za 136,208,84
zby
zbd
zbe
za 140,212,84
zal 29,54
zb5
za 144,216,84
zb6 0x1e800
zal 30,54
zb7 54
zbv 26,4
za 148,196,84
zbk 26,54
zb8
za 152,200,84
zb9 26
s_branch Lf9_as3H1
Lf9_as3S1:
zdz
s_cbranch_scc0 Lf9_as3Y1
zet
zeu
zev
s_call_b64 s[88:89], Lf9_far
s_branch Lf9_as3Xb1
Lf9_as3Y1:
zaa 21,9,6
zaa 22,12,6
za8 23,15
za8 24,18
s_call_b64 s[88:89], Lf9_four
Lf9_as3Xb1:
ze 0
za 156,148,88
zbn
zbq 8,0
zd 76,100
zd 77,101
za 160,152,88
zbo
zd 78,102
zd 79,103
zd 80,104
za 164,156,88
zbp
zd 81,105
zd 82,106
zd 83,107
za 168,160,88
zd 84,108
zd 85,109
za 172,164,88
zd 86,110
zd 87,111
za 176,168,88
zu 6
zo 148,1
zb 150,1,1536
za 156,188,92
zo 152,2
zb 154,2,1536
za 160,192,92
zb 156,1,64
zb 158,1,1600
za 164,172,92
zb 160,2,64
zb 162,2,1600
za 168,176,92
zb 164,1,128
zb 166,1,1664
za 172,180,92
zb 168,2,128
zb 170,2,1664
za 176,184,92
zu 0
zb 172,1,6144
zb 174,1,7680
za 156,204,96
zb 176,2,6144
zb 178,2,7680
za 160,208,96
zb 180,1,6208
zb 182,1,7744
za 164,212,96
zb 184,2,6208
zb 186,2,7744
za 168,216,96
zb 188,1,6272
zb 190,1,7808
za 172,196,96
zb 192,2,6272
zb 194,2,7808
za 176,200,96
s_branch Lf9_as3E2
Lf9_four:
ze 0
zo 104,21
zo 106,22
zb 108,21,16
zb 110,22,16
zb 100,21,4608
zb 102,21,4816
zb 112,21,4624
zb 114,21,4832
zb 116,21,64
zb 118,22,64
zb 120,21,80
zb 122,22,80
zc3 140,23,3
zc3 141,23,5
zc3 142,24,3
zc3 143,24,5
zg0 23
zg0 24
zc3 144,24,3
zc3 145,24,5
zc3 146,23,3
ze 10
zh 124,104,140
zb 104,21,4672
zb 106,21,4880
ze 10
zh 128,108,140
zb 108,21,4688
zb 110,21,4896
ze 6
zh 132,116,140
zb 116,21,144
zb 118,22,144
ze 6
zh 136,120,140
zb 120,21,4736
zb 122,21,4944
zc3 147,23,5
zam
zf 124,100,144
zf 128,112,144
zb 112,21,128
zb 114,22,128
ze 8
zf 132,104,144
ze 6
zf 136,108,144
zb 108,21,4752
zb 110,21,4960
zc 100,124,125
zc 101,126,127
zc 102,128,129
zc 103,130,131
ze 6
zh 128,116,140
zc 104,132,133
zc 105,134,135
zc 106,136,137
zc 107,138,139
ze 2
zh 124,112,140
zf 124,120,144
ze 0
zf 128,108,144
s_nop 5
zc 108,124,125
zc 109,126,127
zc 110,128,129
zc 111,130,131
zgb
Lf9_far:
ze 0
zh6 110,4
zh7 100,110
zh8
v_mul_u32_u24 v107, 52, v4
v_sub_u32 v107, v0, v107
zh9
zgr 104,4
zia 103
zib 104
z2 104
zu 0
zx 101,100
zr 102,100
zg 101,103
zg 102,104
zs 101
zs 102
zc 100,101,102
zx 101,100
zr 102,100
z3 103,101
z3 104,102
z4 105,101,103
z4 106,102,104
z5 101,105
z5 102,106
zw 144,101,102
zw 145,101,106
zw 146,105,102
zw 147,105,106
zgf 103
zgf 104
zgg 108,103
zgg 109,104
zgh 108
zgh 109
zgi 103
zgi 108
zck 104
zck 109
ze 0
zew 140,103,104,107
zew 141,103,109,107
zew 142,108,104,107
zew 143,108,109,107
zfh 124,140
zbi 126,140,16
zbi 128,140,64
zbi 130,140,80
zbi 132,140,128
zbi 134,140,144
zu 5
zx 140,124
zw 100,144,140
zr 140,124
zw 101,144,140
zx 140,125
zw 102,144,140
zr 140,125
zw 103,144,140
zu 4
zx 140,126
zw 104,144,140
zr 140,126
zw 105,144,140
zx 140,127
zw 106,144,140
zr 140,127
zw 107,144,140
zu 3
zx 140,128
zw 108,144,140
zr 140,128
zw 109,144,140
zx 140,129
zw 110,144,140
zr 140,129
zw 111,144,140
zu 2
zx 140,130
zw 112,144,140
zr 140,130
zw 113,144,140
zx 140,131
zw 114,144,140
zr 140,131
zw 115,144,140
zu 1
zx 140,132
zw 116,144,140
zr 140,132
zw 117,144,140
zx 140,133
zw 118,144,140
zr 140,133
zw 119,144,140
zu 0
zx 140,134
zw 120,144,140
zr 140,134
zw 121,144,140
zx 140,135
zw 122,144,140
zr 140,135
zw 123,144,140
zfh 124,141
zbi 126,141,16
zbi 128,141,64
zbi 130,141,80
zbi 132,141,128
zbi 134,141,144
zu 5
zx 141,124
zy 100,145,141
zr 141,124
zy 101,145,141
zx 141,125
zy 102,145,141
zr 141,125
zy 103,145,141
zu 4
zx 141,126
zy 104,145,141
zr 141,126
zy 105,145,141
zx 141,127
zy 106,145,141
zr 141,127
zy 107,145,141
zu 3
zx 141,128
zy 108,145,141
zr 141,128
zy 109,145,141
zx 141,129
zy 110,145,141
zr 141,129
zy 111,145,141
zu 2
zx 141,130
zy 112,145,141
zr 141,130
zy 113,145,141
zx 141,131
zy 114,145,141
zr 141,131
zy 115,145,141
zu 1
zx 141,132
zy 116,145,141
zr 141,132
zy 117,145,141
zx 141,133
zy 118,145,141
zr 141,133
zy 119,145,141
zu 0
zx 141,134
zy 120,145,141
zr 141,134
zy 121,145,141
zx 141,135
zy 122,145,141
zr 141,135
zy 123,145,141
zfh 124,142
zbi 126,142,16
zbi 128,142,64
zbi 130,142,80
zbi 132,142,128
zbi 134,142,144
zu 5
zx 142,124
zy 100,146,142
zr 142,124
zy 101,146,142
zx 142,125
zy 102,146,142
zr 142,125
zy 103,146,142
zu 4
zx 142,126
zy 104,146,142
zr 142,126
zy 105,146,142
zx 142,127
zy 106,146,142
zr 142,127
zy 107,146,142
zu 3
zx 142,128
zy 108,146,142
zr 142,128
zy 109,146,142
zx 142,129
zy 110,146,142
zr 142,129
zy 111,146,142
zu 2
zx 142,130
zy 112,146,142
zr 142,130
zy 113,146,142
zx 142,131
zy 114,146,142
zr 142,131
zy 115,146,142
zu 1
zx 142,132
zy 116,146,142
zr 142,132
zy 117,146,142
zx 142,133
zy 118,146,142
zr 142,133
zy 119,146,142
zu 0
zx 142,134
zy 120,146,142
zr 142,134
zy 121,146,142
zx 142,135
zy 122,146,142
zr 142,135
zy 123,146,142
zfh 124,143
zbi 126,143,16
zbi 128,143,64
zbi 130,143,80
zbi 132,143,128
zbi 134,143,144
zu 5
zx 143,124
zy 100,147,143
zr 143,124
zy 101,147,143
zx 143,125
zy 102,147,143
zr 143,125
zy 103,147,143
zu 4
zx 143,126
zy 104,147,143
zr 143,126
zy 105,147,143
zx 143,127
zy 106,147,143
zr 143,127
zy 107,147,143
zu 3
zx 143,128
zy 108,147,143
zr 143,128
zy 109,147,143
zx 143,129
zy 110,147,143
zr 143,129
zy 111,147,143
zu 2
zx 143,130
zy 112,147,143
zr 143,130
zy 113,147,143
zx 143,131
zy 114,147,143
zr 143,131
zy 115,147,143
zu 1
zx 143,132
zy 116,147,143
zr 143,132
zy 117,147,143
zx 143,133
zy 118,147,143
zr 143,133
zy 119,147,143
zu 0
zx 143,134
zy 120,147,143
zr 143,134
zy 121,147,143
zx 143,135
zy 122,147,143
zr 143,135
zy 123,147,143
zq 100,101
zc 101,102,103
zc 102,104,105
zc 103,106,107
zc 104,108,109
zc 105,110,111
zc 106,112,113
zc 107,114,115
zc 108,116,117
zc 109,118,119
zc 110,120,121
zc 111,122,123
zgb
Lf8_start:
zhf 112,0
zhr 0x4800
s_add_u32 s73, s73, 0x10000
s_mul_i32 s81, s21, 0xe0
s_add_u32 s81, s81, s22
s_mul_i32 s93, s81, 0xc0
s_mul_i32 s77, s81, 0x64
zhb 113,112
zhc 114,112
zgd 116,112
v_and_b32 v118, 12, v112
zgu 115,118,114
v_add_u32 v44, s21, v116
v_add_u32 v29, s22, v115
zh4 117,116
zh5 118,115
zgu 31,117,118
s_mul_i32 s25, s20, 13
s_lshr_b32 s25, s25, 1
zed
zee 0x4800
zef
zeg
zeh 0x1200
zei
zej 0xd0
zek 0x12d0
zel
zem
zen
zeo
zbn
zbo
zbp
zhg 0x930000
zhh 0x20000
zhi 0x20000
zha 0x70880
zhj 0x20000
zhk 0x20000
zhw
zhz 0x1200
s_sub_u32 s85, s21, 3
s_add_u32 s85, s85, s20
s_add_u32 s97, s85, 0
zcv
zcw 0xdf
zbt 0xa800
s_add_u32 s42, s35, 0
ze2 117,112
zep 118,117
zd9 118
zeq 21,118
zd0 117,21
zer 117
zea 118
zes 118
zeb 118
zck 118
zbk 118,117
zc9 117,0x40000000
zcs 21,118,117
ze 0
zhl 0xffff
zhp 0xffff
zcx
zv
zae 21
ze5
zfi 52,31
zhs 117,112
zep 118,117
zd9 118
zeq 22,118
zd0 117,22
zer 117
zea 118
zes 118
zeb 118
zck 118
zbk 118,117
zc9 117,0x40000000
zcs 22,118,117
zan 0x400
zv
zae 22
zht 117,112
zep 118,117
zd9 118
zeq 23,118
zd0 117,23
zer 117
zea 118
zes 118
zeb 118
zck 118
zbk 118,117
zc9 117,0x40000000
zcs 23,118,117
zan 0x800
zv
zae 23
v_add_u32 v117, 0xc0, v112
zep 118,117
zd9 118
zeq 24,118
zd0 117,24
zer 117
zea 118
zes 118
zeb 118
zck 118
zbk 118,117
zc9 117,0x40000000
zcs 24,118,117
zan 0xc00
zv
zae 24
v_add_u32 v117, 0x100, v112
zep 118,117
zd9 118
zeq 25,118
zd0 117,25
zer 117
zea 118
zes 118
zeb 118
zck 118
zbk 118,117
zc9 117,0x40000000
zcs 25,118,117
zcy 0x3fffffff
zan 0x1000
zv
zae 25
zcz
s_add_u32 s97, s85, 4
zcv
zcw 0xdf
zbt 0xa800
zdd 0x4800
zcx
zv
zae 21
zan 0x400
zv
zae 22
zan 0x800
zv
zae 23
zan 0xc00
zv
zae 24
zcy 0x3fffffff
zan 0x1000
zv
zae 25
zcz
zhm 0x80
zhn
zho 0xffff
zhq 0xffff
zde
s_cselect_b32 s82, 0, s20
s_lshl_b32 s83, s82, 6
s_add_u32 s83, s83, 0x80
s_mul_i32 s82, s82, 5
s_lshr_b32 s82, 0x5880, s82
zh0 117,112
v_lshl_add_u32 v118, v112, 4, s83
v_lshl_add_u32 v117, v117, 4, s83
zgr 115,112
v_mul_u32_u24 v116, 0x56, v115
v_lshrrev_b32 v116, 8, v116
v_mad_i32_i24 v115, v116, -3, v115
v_cmp_le_u32 vcc, 48, v112
zam
zcs 38,118,117
v_cmp_gt_u32 vcc, 32, v112
zam
zcs 39,118,117
v_cmp_le_u32 vcc, 16, v112
zam
zcs 49,118,117
s_mov_b32 s84, 0xffffff40
zfx 116,115
zfy 38,116
zgv
zfx 116,115
zfy 39,116
zgv
zfx 116,115
zfy 49,116
zcg
zcu
z0 38
zn 39,1024
zn 49,2048
zn 38,3072
z6 0x1000
zag 0x1000
z0 39
zn 49,1024
zn 38,2048
zn 39,3072
z6 0x2000
zag 0x2000
z0 49
zn 38,1024
zn 39,2048
zn 49,3072
z6 0x3000
zag 0x3000
z0 38
zn 39,1024
zn 49,2048
zn 38,3072
z6 0x4000
zag 0x4000
z0 39
zn 49,1024
zc8 0x15e00
zfi 58,31
zhd 115,112
zgd 116,112
zfk 119,114
zg3 4,113
zh1 0x435f0000
zgc 118,114
zgp 0,119
zgn 0,118
v_mul_u32_u24 v117, 0xd0, v113
v_add_u32 v0, v117, v0
zf9 117,118
zg2 117,119
zhe 117,115
zck 117
zgq 118,116,119
zbk 117,118
v_add_u32 v117, s73, v117
zfk 118,116
zh2 1,118,117
zh3 2,1
s_mov_b32 s3, 0
zfz
s_cselect_b32 s3, 2, s3
zf0
s_cselect_b32 s3, 4, s3
zde
s_cselect_b32 s3, 6, s3
s_mov_b32 s78, s3
s_mul_i32 s79, s3, 0x5780
s_add_u32 s79, s79, s77
s_add_u32 s79, s79, 48
s_mul_i32 s94, s3, 0x1200
s_add_u32 s94, s94, 0x3870
zbq 8,0
ze3
zed
zee 0x4800
zef
zeg
zeh 0x1200
zei
zej 0xd0
zek 0x12d0
zel
zem
zen
zeo
s_mov_b32 s80, 0
s_mul_i32 s58, s20, 0x1800
s_add_u32 s58, s58, 0x33000
zde
s_cselect_b32 s58, s71, s58
zgp 6,118
zgc 118,116
zgn 6,118
zfk 118,115
zf9 7,118
zc9 117,0xffff
v_lshlrev_b32 v117, v7, v117
v_cmp_eq_u32 vcc, v116, v114
zam
zas 117
v_cmp_gt_u32 vcc, 2, v115
zam
v_cndmask_b32 v3, 0, v117, vcc
zgq 5,3,117
s_sub_u32 s82, s21, 3
s_sub_u32 s83, s22, 3
v_cvt_f32_i32 v45, s82
v_cvt_f32_i32 v46, s83
v_add_f32 v117, 0x41400000, v45
v_add_f32 v118, 0x41a00000, v46
v_mul_f32 v47, 0xc3500000, v46
v_fmamk_f32 v47, v45, 0xc5900000, v47
v_readfirstlane_b32 s75, v117
v_readfirstlane_b32 s76, v118
zc9 48,0x120
s_mov_b32 s26, 0x11111111
s_mov_b32 s27, 0x11111111
s_mov_b32 s28, 0x22222222
s_mov_b32 s29, 0x22222222
s_mov_b32 s30, 0x44444444
s_mov_b32 s31, 0x44444444
s_mov_b32 s32, 0x88888888
s_mov_b32 s33, 0x88888888
zu 28
zx 32,52
zr 33,52
zgw 34,44
zbs 35,29
z2 34
z2 35
zg 32,34
zg 33,35
zs 34
zs 35
zs 32
zs 33
zq 34,35
zq 32,33
zr 33,32
zav 32,34
zaw 32
z3 41,33
z3 40,32
z4 43,33,41
z4 42,32,40
zgw 34,44
z2 34
zd1 35,45
zd2 34,35
zax 43
z5 32,42
z5 33,43
zd3 36,40,45,34
zay 37,41,46
zw 34,32,33
zaz 32,43
za0 33,42
zw 35,42,43
za1 37,41
za2 37,47
za3 32,33
zas 33
za4 37,36
zq 34,35
zq 32,33
za5 33,48
zdf 36,40
zdg 35
za6 9,37
z8 13,34,7
z8 15,32,7
zdh
zau 11,33,9
zdi
zdj
Lf8_aqR0:
zu 19
s_barrier
zcf
s_cbranch_scc1 Lf8_aqG0
Lf8_aqRb0:
zdk 64,8
zi 66,8,16
zi 68,8,64
zi 70,8,80
zi 72,8,128
zi 74,8,144
zu 13
zo 136,1
zb 138,1,1536
zo 140,2
zb 142,2,1536
zb 144,1,64
zb 146,1,1600
zb 148,2,64
zb 150,2,1600
zb 152,1,128
zb 154,1,1664
zb 156,2,128
zb 158,2,1664
zu 7
zb 160,1,6144
zb 162,1,7680
zb 164,2,6144
zb 166,2,7680
zb 168,1,6208
zb 170,1,7744
zb 172,2,6208
zb 174,2,7744
zb 176,1,6272
zb 178,1,7808
zb 180,2,6272
zb 182,2,7808
Lf8_atR0:
zda
s_cbranch_scc1 Lf8_atG0
Lf8_atRb0:
ze 15
zh 208,136,64
zu 1
zb 184,1,12288
zb 186,1,13824
zh 212,140,64
zb 188,2,12288
zb 190,2,13824
zp 0,144,64
zb 192,1,12352
zb 194,1,13888
zp 4,148,64
ze 15
zb 196,2,12352
zb 198,2,13888
zp 8,152,64
zb 200,1,12416
zb 202,1,13952
zp 12,156,64
zb 204,2,12416
zb 206,2,13952
zf 208,160,68
ze 15
zi 76,8,4608
zi 78,8,4624
zf 212,164,68
zi 80,8,4672
zi 82,8,4688
za 0,168,68
zi 84,8,4736
zi 86,8,4752
za 4,172,68
zf1
zcv
zcw 0xdf
zbt 0xa800
zdd 0x9000
ze 15
za 8,176,68
zcx
zv
zae 21
za 12,180,68
zan 0x400
zv
zae 22
zf 208,184,72
zan 0x800
zv
zae 23
ze 5
zf 212,188,72
zan 0xc00
zv
zae 24
za 0,192,72
zcy 0x3fffffff
zan 0x1000
zv
zae 25
zcz
za 4,196,72
za 8,200,72
za 12,204,72
Lf8_atR1:
zdb
s_cbranch_scc1 Lf8_atG1
Lf8_atRb1:
ze 0
zh 216,136,76
zi 64,8,9216
zi 66,8,9232
zf 216,160,80
zi 68,8,9280
zi 70,8,9296
zf 216,184,84
zi 72,8,9344
zi 74,8,9360
zh 220,140,76
zgj
zcv
zcw 0xdf
zbt 0xa800
zdd 0xd800
zf 220,164,80
zbw
zgk
s_cselect_b32 s42, 0x22000, s42
zf 220,188,84
zcx
zv
zae 21
zp 16,144,76
zan 0x400
zv
zae 22
za 16,168,80
zan 0x800
zv
zae 23
za 16,192,84
zan 0xc00
zv
zae 24
zp 20,148,76
zcy 0x3fffffff
zan 0x1000
zv
zae 25
zcz
za 20,172,80
zu 10
zf2 28,31
zx 32,58
za 20,196,84
zr 33,58
zci 34,44
zp 24,152,76
zbs 35,29
z2 34
za 24,176,80
z2 35
zg 32,34
za 24,200,84
zbr 0x10000
zdw 1
zdw 2
zp 28,156,76
za 28,180,80
za 28,204,84
Lf8_atR2:
zu 6
s_barrier
zdc
s_cbranch_scc1 Lf8_atG2
Lf8_atRb2:
ze 0
zh 224,136,64
zi 76,8,13824
zi 78,8,13840
zi 80,8,13888
zi 82,8,13904
zf 224,160,68
ze5
zc6 56,31,16
zi 84,8,13952
zi 86,8,13968
z6 0x3000
zc7 0x3000
z0 38
zf 224,184,72
zn 39,1024
zn 49,2048
zh 228,140,64
zn 38,3072
zg 33,35
zs 34
zf 228,164,68
zs 35
zs 32
zs 33
zf 228,188,72
zq 34,35
zq 32,33
zr 33,32
zp 32,144,64
zav 32,34
zaw 32
z3 41,33
za 32,168,68
z3 40,32
z4 43,33,41
z4 42,32,40
za 32,192,72
zci 34,44
z2 34
zd1 35,45
zp 36,148,64
zd2 34,35
zax 43
z5 32,42
za 36,172,68
z5 33,43
zd3 36,40,45,34
zay 37,41,46
za 36,196,72
zw 34,32,33
zaz 32,43
za0 33,42
zp 40,152,64
zw 35,42,43
za1 37,41
za2 37,47
za 40,176,68
za3 32,33
zas 33
za4 37,36
za 40,200,72
zq 34,35
zq 32,33
za5 33,48
zp 44,156,64
zca 36,40
zcb 35
za6 10,37
z8 14,34,7
za 44,180,68
z8 16,32,7
zcc
zau 12,33,10
zcd
za 44,204,72
zce
Lf8_atR3:
zc5
s_cbranch_scc1 Lf8_atG3
Lf8_atRb3:
ze 0
zh 232,136,76
zi 64,8,18432
zi 66,8,18448
zf 232,160,80
zi 68,8,18496
zi 70,8,18512
zf 232,184,84
zi 72,8,18560
zi 74,8,18576
zh 236,140,76
zc8 0x15e00
zc6 62,31,16
z6 0x4000
zc7 0x4000
z0 39
zf 236,164,80
zn 49,1024
zf 236,188,84
zcg
zcu
z0 38
zp 48,144,76
zn 39,1024
za 48,168,80
zn 49,2048
za 48,192,84
zp 52,148,76
za 52,172,80
za 52,196,84
zp 56,152,76
za 56,176,80
za 56,200,84
zp 60,156,76
za 60,180,80
za 60,204,84
Lf8_atR4:
zc0
s_cbranch_scc1 Lf8_atG4
Lf8_atRb4:
ze 0
zh 240,136,64
zi 76,8,23040
zi 78,8,23056
zi 80,8,23104
zf 240,160,68
zi 82,8,23120
zi 84,8,23168
zf 240,184,72
zi 86,8,23184
zn 38,3072
zh 244,140,64
z6 0x1000
zag 0x1000
z0 39
zf 244,164,68
zn 49,1024
zf 244,188,72
zn 38,2048
zex 64,144
zx 32,53
zr 33,53
za 64,168,68
zdx 34,44
zcj 35,29
za 64,192,72
z2 34
z2 35
zp 68,148,64
zg 32,34
zg 33,35
z7 68,172
zs 34
zs 35
za 68,196,72
zs 32
zs 33
zp 72,152,64
zq 34,35
zq 32,33
za 72,176,68
zr 33,32
zav 32,34
z7 72,200
zaw 32
z3 41,33
zp 76,156,64
z3 40,32
z4 43,33,41
za 76,180,68
za 76,204,72
Lf8_atR5:
zd4
s_cbranch_scc1 Lf8_atG5
Lf8_atRb5:
ze 0
zh 248,136,76
zi 64,8,27648
zi 66,8,27664
zi 68,8,27712
zf 248,160,80
zi 70,8,27728
zi 72,8,27776
zi 74,8,27792
zf 248,184,84
zn 39,3072
z6 0x2000
zag 0x2000
z0 49
zh 252,140,76
zn 38,1024
zn 39,2048
zf 252,164,80
zn 49,3072
zf 252,188,84
z4 42,32,40
zax 43
zp 80,144,76
z5 32,42
z5 33,43
z7 80,168
zbg 36,40,45
zay 37,41,46
za 80,192,84
zw 34,32,33
zaz 32,43
zp 84,148,76
za0 33,42
zw 35,42,43
za 84,172,80
za1 37,41
za2 37,47
z7 84,196
za3 32,33
zas 33
zp 88,152,76
za4 37,36
zq 34,35
za 88,176,80
zq 32,33
za5 33,48
za 88,200,84
zdf 36,40
zdg 35
zp 92,156,76
za6 9,37
z8 13,34,7
za 92,180,80
z8 15,32,7
zdh
za 92,204,84
Lf8_atR6:
zu 21
s_barrier
zd5
s_cbranch_scc1 Lf8_atG6
Lf8_atRb6:
ze 0
zp 96,136,64
zi 76,8,32256
zi 78,8,32272
zi 80,8,32320
za 96,160,68
zi 82,8,32336
zi 84,8,32384
zi 86,8,32400
za 96,184,72
zau 11,33,9
zdi
zdj
zp 100,140,64
zu 20
zx 32,28
zr 33,28
zf3 34,44
ze2 35,29
za 100,164,68
z2 34
z2 35
zg 32,34
zg 33,35
za 100,188,72
zs 34
zs 35
zs 32
zp 104,144,64
zs 33
zq 34,35
zq 32,33
za 104,168,68
zr 33,32
zav 32,34
zaw 32
za 104,192,72
z3 41,33
z3 40,32
z4 43,33,41
zp 108,148,64
z4 42,32,40
zax 43
z5 32,42
za 108,172,68
z5 33,43
zbg 36,40,45
zay 37,41,46
za 108,196,72
zw 34,32,33
zaz 32,43
za0 33,42
zp 112,152,64
zw 35,42,43
za1 37,41
za2 37,47
za 112,176,68
za3 32,33
zas 33
za4 37,36
za 112,200,72
zq 34,35
zq 32,33
za5 33,48
zp 116,156,64
zca 36,40
zcb 35
za6 10,37
z8 14,34,7
za 116,180,68
z8 16,32,7
zcc
zau 12,33,10
zcd
za 116,204,72
zce
Lf8_atR7:
zu 12
s_barrier
zc5
s_cbranch_scc1 Lf8_atG7
Lf8_atRb7:
ze 0
zp 120,136,76
zf4 8,0
zp 124,140,76
zdk 64,8
zi 66,8,16
zp 128,144,76
zi 68,8,64
zi 70,8,80
zp 132,148,76
zi 72,8,128
zi 74,8,144
zp 136,152,76
zp 140,156,76
zb 136,1,12288
zb 138,1,13824
za 120,160,80
zb 140,2,12288
zb 142,2,13824
za 124,164,80
zb 144,1,12352
zb 146,1,13888
za 128,168,80
zb 148,2,12352
zb 150,2,13888
za 132,172,80
zb 152,1,12416
zb 154,1,13952
za 136,176,80
zb 156,2,12416
zb 158,2,13952
za 140,180,80
zb 160,1,30720
zb 162,1,32256
za 120,184,84
zb 164,2,30720
zb 166,2,32256
za 124,188,84
zb 168,1,30784
zb 170,1,32320
za 128,192,84
zb 172,2,30784
zb 174,2,32320
za 132,196,84
zb 176,1,30848
zb 178,1,32384
za 136,200,84
zb 180,2,30848
zb 182,2,32384
za 140,204,84
zfz
s_cbranch_scc1 Lf8_as1R0
zf0
s_cbranch_scc1 Lf8_as2R0
zde
s_cbranch_scc1 Lf8_as3R0
Lf8_as0R0:
zc0
s_cbranch_scc1 Lf8_as0G0
Lf8_as0Rb0:
ze 15
zf 208,136,64
zb 192,1,49216
zb 194,1,50752
zb 196,2,49216
zf 212,140,64
zb 198,2,50752
zb 200,1,49280
zb 202,1,50816
za 0,144,64
zb 204,2,49280
zb 206,2,50816
zb 184,1,49152
za 4,148,64
ze 15
zb 186,1,50688
zb 188,2,49152
zb 190,2,50688
za 8,152,64
zi 76,8,4608
zi 78,8,4624
zi 80,8,4672
za 12,156,64
ze 15
zi 82,8,4688
zi 84,8,4736
zi 86,8,4752
zf 208,176,68
zbr 0x10000
zbb 1
zbb 2
zf 212,180,68
zb2 50
zb3 50
zbz 21,50
za 0,160,68
zbc 0x5800
zbw
zbd
zbe
za 4,164,68
ze 6
s_barrier
z6 0x3000
zag 0x3000
z0 38
za 8,168,68
zn 39,1024
zn 49,2048
za 12,172,68
zn 38,3072
z6 0x4000
zag 0x4000
z0 39
zf 208,192,72
zn 49,1024
zal 24,50
zf 212,196,72
zbc 0x9800
zby
zbd
zbe
za 0,200,72
zal 25,50
zb5
za 4,204,72
zb6 0x1d800
zal 26,50
zb7 50
zbv 22,4
za 8,184,72
zbk 22,50
zb8
za 12,188,72
zb9 22
Lf8_as0R1:
zcf
s_cbranch_scc1 Lf8_as0G1
Lf8_as0Rb1:
ze 0
zf 216,136,76
zbn
zbo
zbq 8,0
zf 220,140,76
zbp
zdk 64,8
zi 66,8,16
za 16,144,76
zi 68,8,64
zi 70,8,80
za 20,148,76
zi 72,8,128
zi 74,8,144
za 24,152,76
za 28,156,76
zu 12
zo 136,1
zb 138,1,1536
zf 216,176,80
zo 140,2
zb 142,2,1536
zf 220,180,80
zb 144,1,64
zb 146,1,1600
za 16,160,80
zb 148,2,64
zb 150,2,1600
za 20,164,80
zb 152,1,128
zb 154,1,1664
za 24,168,80
zb 156,2,128
zb 158,2,1664
za 28,172,80
zu 6
zb 160,1,6144
zb 162,1,7680
zf 216,192,84
zb 164,2,6144
zb 166,2,7680
zf 220,196,84
zb 168,1,6208
zb 170,1,7744
za 16,200,84
zb 172,2,6208
zb 174,2,7744
za 20,204,84
zb 176,1,6272
zb 178,1,7808
za 24,184,84
zb 180,2,6272
zb 182,2,7808
za 28,188,84
s_branch Lf8_amR0
Lf8_as1R0:
zc0
s_cbranch_scc1 Lf8_as1G0
Lf8_as1Rb0:
ze 15
zf 224,144,64
zb 200,1,49280
zb 202,1,50816
zb 204,2,49280
zf 228,148,64
ze 15
zb 206,2,50816
zb 184,1,49152
zb 186,1,50688
za 32,152,64
zb 188,2,49152
zb 190,2,50688
zb 192,1,49216
za 36,156,64
zb 194,1,50752
zb 196,2,49216
zb 198,2,50752
za 40,136,64
zi 76,8,4608
zi 78,8,4624
zi 80,8,4672
za 44,140,64
ze 15
zi 82,8,4688
zi 84,8,4736
zi 86,8,4752
zf 224,160,68
zbr 0x10000
zbb 1
zbb 2
zf 228,164,68
zb2 50
zb3 50
zbz 21,50
za 32,168,68
zbc 0x5800
zbw
zbd
zbe
za 36,172,68
ze 6
s_barrier
z6 0x3000
zag 0x3000
z0 38
za 40,176,68
zn 39,1024
zn 49,2048
za 44,180,68
zn 38,3072
z6 0x4000
zag 0x4000
z0 39
zf 224,200,72
zn 49,1024
zal 24,50
zf 228,204,72
zbc 0x9800
zby
zbd
zbe
za 32,184,72
zal 25,50
zb5
za 36,188,72
zb6 0x1d800
zal 26,50
zb7 50
zbv 22,4
za 40,192,72
zbk 22,50
zb8
za 44,196,72
zb9 22
Lf8_as1R1:
zcf
s_cbranch_scc1 Lf8_as1G1
Lf8_as1Rb1:
ze 0
zf 232,144,76
zbn
zbo
zbq 8,0
zf 236,148,76
zbp
zdk 64,8
zi 66,8,16
za 48,152,76
zi 68,8,64
zi 70,8,80
za 52,156,76
zi 72,8,128
zi 74,8,144
za 56,136,76
za 60,140,76
zu 12
zo 136,1
zb 138,1,1536
zf 232,160,80
zo 140,2
zb 142,2,1536
zf 236,164,80
zb 144,1,64
zb 146,1,1600
za 48,168,80
zb 148,2,64
zb 150,2,1600
za 52,172,80
zb 152,1,128
zb 154,1,1664
za 56,176,80
zb 156,2,128
zb 158,2,1664
za 60,180,80
zu 6
zb 160,1,6144
zb 162,1,7680
zf 232,200,84
zb 164,2,6144
zb 166,2,7680
zf 236,204,84
zb 168,1,6208
zb 170,1,7744
za 48,184,84
zb 172,2,6208
zb 174,2,7744
za 52,188,84
zb 176,1,6272
zb 178,1,7808
za 56,192,84
zb 180,2,6272
zb 182,2,7808
za 60,196,84
s_branch Lf8_amR0
Lf8_as2R0:
zc0
s_cbranch_scc1 Lf8_as2G0
Lf8_as2Rb0:
ze 14
zf 240,152,64
ze 12
zb 184,1,49152
zb 186,1,50688
zb 188,2,49152
zf 244,156,64
zb 190,2,50688
zb 192,1,49216
zb 194,1,50752
z7 64,136
zb 196,2,49216
zb 198,2,50752
zb 200,1,49280
za 68,140,64
zb 202,1,50816
zb 204,2,49280
zb 206,2,50816
za 72,144,64
zi 76,8,4608
zi 78,8,4624
zi 80,8,4672
za 76,148,64
ze 15
zi 82,8,4688
zi 84,8,4736
zi 86,8,4752
zf 240,168,68
zbr 0x10000
zbb 1
zbb 2
zf 244,172,68
zb2 50
zb3 50
zbz 21,50
za 64,176,68
zbc 0x5800
zbw
zbd
zbe
z7 68,180
ze 6
s_barrier
z6 0x3000
zag 0x3000
z0 38
za 72,160,68
zn 39,1024
zn 49,2048
za 76,164,68
zn 38,3072
z6 0x4000
zag 0x4000
z0 39
zf 240,184,72
zn 49,1024
zal 24,50
zf 244,188,72
zbc 0x9800
zby
zbd
zbe
za 64,192,72
zal 25,50
zb5
za 68,196,72
zb6 0x1d800
zal 26,50
zb7 50
zbv 22,4
z7 72,200
zbk 22,50
zb8
za 76,204,72
zb9 22
Lf8_as2R1:
zcf
s_cbranch_scc1 Lf8_as2G1
Lf8_as2Rb1:
ze 0
zf 248,152,76
zbn
zbo
zbq 8,0
zf 252,156,76
zbp
zdk 64,8
zi 66,8,16
za 80,136,76
zi 68,8,64
zi 70,8,80
za 84,140,76
zi 72,8,128
zi 74,8,144
za 88,144,76
za 92,148,76
zu 12
zo 136,1
zb 138,1,1536
zf 248,168,80
zo 140,2
zb 142,2,1536
zf 252,172,80
zb 144,1,64
zb 146,1,1600
z7 80,176
zb 148,2,64
zb 150,2,1600
za 84,180,80
zb 152,1,128
zb 154,1,1664
za 88,160,80
zb 156,2,128
zb 158,2,1664
za 92,164,80
zu 6
zb 160,1,6144
zb 162,1,7680
zf 248,184,84
zb 164,2,6144
zb 166,2,7680
zf 252,188,84
zb 168,1,6208
zb 170,1,7744
za 80,192,84
zb 172,2,6208
zb 174,2,7744
z7 84,196
zb 176,1,6272
zb 178,1,7808
za 88,200,84
zb 180,2,6272
zb 182,2,7808
za 92,204,84
s_branch Lf8_amR0
Lf8_as3R0:
zc0
s_cbranch_scc1 Lf8_as3G0
Lf8_as3Rb0:
ze 15
za 96,136,64
zb 192,1,49216
zb 194,1,50752
za 100,140,64
zb 196,2,49216
zb 198,2,50752
za 104,144,64
zb 200,1,49280
zb 202,1,50816
za 108,148,64
ze 15
zb 204,2,49280
zb 206,2,50816
za 112,152,64
zb 184,1,49152
zb 186,1,50688
za 116,156,64
ze 12
zb 188,2,49152
zb 190,2,50688
za 96,176,68
ze 12
zi 76,8,4608
zi 78,8,4624
za 100,180,68
zi 80,8,4672
zi 82,8,4688
za 104,160,68
zi 84,8,4736
zi 86,8,4752
za 108,164,68
ze 6
s_barrier
zbr 0x10000
zbb 1
zbb 2
za 112,168,68
zb2 50
zb3 50
za 116,172,68
zbz 21,50
zbc 0x5800
zbw
zbd
za 96,192,72
zbe
zal 24,50
zbc 0x9800
za 100,196,72
zby
zbd
zbe
za 104,200,72
zal 25,50
zb5
za 108,204,72
zb6 0x1d800
zal 26,50
zb7 50
zbv 22,4
za 112,184,72
zbk 22,50
zb8
za 116,188,72
zb9 22
Lf8_as3R1:
zcf
s_cbranch_scc1 Lf8_as3G1
Lf8_as3Rb1:
ze 0
za 120,136,76
zbn
zbo
zbq 8,0
za 124,140,76
zbp
zdk 64,8
zi 66,8,16
za 128,144,76
zi 68,8,64
zi 70,8,80
za 132,148,76
zi 72,8,128
zi 74,8,144
za 136,152,76
za 140,156,76
zu 6
zo 136,1
zb 138,1,1536
za 120,176,80
zo 140,2
zb 142,2,1536
za 124,180,80
zb 144,1,64
zb 146,1,1600
za 128,160,80
zb 148,2,64
zb 150,2,1600
za 132,164,80
zb 152,1,128
zb 154,1,1664
za 136,168,80
zb 156,2,128
zb 158,2,1664
za 140,172,80
zu 0
zb 160,1,6144
zb 162,1,7680
za 120,192,84
zb 164,2,6144
zb 166,2,7680
za 124,196,84
zb 168,1,6208
zb 170,1,7744
za 128,200,84
zb 172,2,6208
zb 174,2,7744
za 132,204,84
zb 176,1,6272
zb 178,1,7808
za 136,184,84
zb 180,2,6272
zb 182,2,7808
za 140,188,84
s_branch Lf8_amR0
.p2align 6
Lf8_amR0:
zda
s_cbranch_scc1 Lf8_amG0
Lf8_amRb0:
ze 15
zf 208,136,64
ze3
zu 0
zb 184,1,12288
zb 186,1,13824
zf 212,140,64
zed
zb 188,2,12288
zb 190,2,13824
za 0,144,64
zee 0x4800
zb 192,1,12352
zb 194,1,13888
za 4,148,64
zef
zb 196,2,12352
zb 198,2,13888
ze 15
za 8,152,64
zeg
zb 200,1,12416
zb 202,1,13952
za 12,156,64
zeh 0x1200
zb 204,2,12416
zb 206,2,13952
zf 208,160,68
zei
zi 76,8,4608
zi 78,8,4624
zf 212,164,68
zej 0xd0
zi 80,8,4672
zi 82,8,4688
ze 15
za 0,168,68
zek 0x12d0
zi 84,8,4736
zi 86,8,4752
za 4,172,68
zel
zx 32,59
zr 33,59
za 8,176,68
zem
zd 59,60
zd 60,61
za 12,180,68
zen
zeo
zd 61,62
ze 10
zf 208,184,72
zf 212,188,72
za 0,192,72
za 4,196,72
ze 4
za 8,200,72
za 12,204,72
Lf8_amR1:
zdb
s_cbranch_scc1 Lf8_amG1
Lf8_amRb1:
zf 216,136,76
ze 0
zi 64,8,9216
zi 66,8,9232
zf 216,160,80
zi 68,8,9280
zi 70,8,9296
zf 216,184,84
zi 72,8,9344
zi 74,8,9360
zf 220,140,76
zcg
zcu
z0 38
zf 220,164,80
zn 39,1024
zf 220,188,84
zn 49,2048
za 16,144,76
zd 62,63
zci 34,44
za 16,168,80
zbs 35,29
z2 34
za 16,192,84
z2 35
zg 32,34
za 20,148,76
zg 33,35
zs 34
za 20,172,80
zs 35
zs 32
za 20,196,84
zs 33
zq 34,35
za 24,152,76
zq 32,33
zr 33,32
za 24,176,80
zav 32,34
zaw 32
za 24,200,84
za 28,156,76
za 28,180,80
za 28,204,84
Lf8_amR2:
zdc
s_cbranch_scc1 Lf8_amG2
Lf8_amRb2:
ze 0
zf 224,136,64
zi 76,8,13824
zi 78,8,13840
zi 80,8,13888
zf 224,160,68
zi 82,8,13904
zi 84,8,13952
zi 86,8,13968
zf 224,184,72
zn 38,3072
z6 0x1000
zag 0x1000
z0 39
zf 228,140,64
zn 49,1024
zn 38,2048
zf 228,164,68
z3 41,33
z3 40,32
z4 43,33,41
zf 228,188,72
z4 42,32,40
zax 43
za 32,144,64
z5 32,42
z5 33,43
za 32,168,68
zbg 36,40,45
zay 37,41,46
za 32,192,72
zw 34,32,33
zaz 32,43
za 36,148,64
za0 33,42
zw 35,42,43
za 36,172,68
za1 37,41
za2 37,47
za 36,196,72
za3 32,33
zas 33
za 40,152,64
za4 37,36
zq 34,35
za 40,176,68
zq 32,33
za5 33,48
za 40,200,72
zca 36,40
zcb 35
za 44,156,64
za6 10,37
z8 14,34,7
z8 16,32,7
za 44,180,68
zcc
zau 12,33,10
zcd
zce
za 44,204,72
Lf8_amR3:
zc5
s_cbranch_scc1 Lf8_amG3
Lf8_amRb3:
ze 0
zf 232,136,76
zi 64,8,18432
zi 66,8,18448
zf 232,160,80
zi 68,8,18496
zi 70,8,18512
zf 232,184,84
zi 72,8,18560
zi 74,8,18576
zf 236,140,76
zn 39,3072
zf 236,164,80
z6 0x2000
zag 0x2000
z0 49
zf 236,188,84
zn 38,1024
za 48,144,76
za 48,168,80
za 48,192,84
za 52,148,76
za 52,172,80
za 52,196,84
za 56,152,76
za 56,176,80
za 56,200,84
za 60,156,76
za 60,180,80
za 60,204,84
Lf8_amR4:
zc0
s_cbranch_scc1 Lf8_amG4
Lf8_amRb4:
ze 0
zf 240,136,64
zi 76,8,23040
zi 78,8,23056
zf 240,160,68
zi 80,8,23104
zi 82,8,23120
zf 240,184,72
zi 84,8,23168
zi 86,8,23184
zf 244,140,64
zn 39,2048
zf 244,164,68
zn 49,3072
zf 244,188,72
z6 0x3000
zag 0x3000
z0 38
z7 64,144
zn 39,1024
za 64,168,68
zx 32,54
zr 33,54
za 64,192,72
zd 54,55
zd 55,56
za 68,148,64
zd 56,57
zdx 34,44
z7 68,172
zcj 35,29
z2 34
za 68,196,72
z2 35
zg 32,34
za 72,152,64
zg 33,35
za 72,176,68
z7 72,200
za 76,156,64
za 76,180,68
za 76,204,72
Lf8_amR5:
zd4
s_cbranch_scc1 Lf8_amG5
Lf8_amRb5:
ze 0
zf 248,136,76
zi 64,8,27648
zi 66,8,27664
zf 248,160,80
zi 68,8,27712
zi 70,8,27728
zf 248,184,84
zi 72,8,27776
zi 74,8,27792
zf 252,140,76
zn 49,2048
zf 252,164,80
zn 38,3072
zf 252,188,84
z6 0x4000
zag 0x4000
z0 39
za 80,144,76
zn 49,1024
z7 80,168
zs 34
zs 35
za 80,192,84
zs 32
zs 33
za 84,148,76
zq 34,35
zq 32,33
za 84,172,80
zr 33,32
zav 32,34
z7 84,196
zaw 32
z3 41,33
za 88,152,76
z3 40,32
z4 43,33,41
za 88,176,80
z4 42,32,40
za 88,200,84
za 92,156,76
za 92,180,80
za 92,204,84
Lf8_amR6:
zd5
s_cbranch_scc1 Lf8_amG6
Lf8_amRb6:
ze 0
za 96,136,64
zi 76,8,32256
zi 78,8,32272
za 96,160,68
zi 80,8,32320
zi 82,8,32336
za 96,184,72
zi 84,8,32384
zi 86,8,32400
za 100,140,64
zax 43
z5 32,42
za 100,164,68
z5 33,43
zbg 36,40,45
za 100,188,72
zay 37,41,46
zw 34,32,33
za 104,144,64
zaz 32,43
za0 33,42
za 104,168,68
zw 35,42,43
za1 37,41
za 104,192,72
za2 37,47
za3 32,33
za 108,148,64
zas 33
za4 37,36
za 108,172,68
zq 34,35
zq 32,33
za 108,196,72
za5 33,48
zdf 36,40
za 112,152,64
zdg 35
za6 9,37
za 112,176,68
z8 13,34,7
z8 15,32,7
za 112,200,72
zdh
zau 11,33,9
zdi
za 116,156,64
zdj
za 116,180,68
za 116,204,72
Lf8_amR7:
zcf
s_cbranch_scc1 Lf8_amG7
Lf8_amRb7:
ze 0
za 120,136,76
zbn
zbo
zbq 8,0
za 124,140,76
zbp
zdk 64,8
zi 66,8,16
za 128,144,76
zf5
zi 68,8,64
zi 70,8,80
za 132,148,76
zi 72,8,128
zi 74,8,144
za 136,152,76
za 140,156,76
zu 12
zo 136,1
zb 138,1,1536
za 120,160,80
zo 140,2
zb 142,2,1536
za 124,164,80
zb 144,1,64
zb 146,1,1600
za 128,168,80
zb 148,2,64
zb 150,2,1600
za 132,172,80
zb 152,1,128
zb 154,1,1664
za 136,176,80
zb 156,2,128
zb 158,2,1664
za 140,180,80
zu 6
zb 160,1,6144
zb 162,1,7680
za 120,184,84
zb 164,2,6144
zb 166,2,7680
za 124,188,84
zb 168,1,6208
zb 170,1,7744
za 128,192,84
zb 172,2,6208
zb 174,2,7744
za 132,196,84
zb 176,1,6272
zb 178,1,7808
za 136,200,84
zb 180,2,6272
zb 182,2,7808
za 140,204,84
zgx
s_cbranch_scc1 Lf8_amR0
zde
s_cbranch_scc1 Lf8_ayR0
Lf8_azR0:
zda
s_cbranch_scc1 Lf8_azG0
Lf8_azRb0:
zi 76,8,4608
zi 78,8,4624
zi 80,8,4672
zi 82,8,4688
ze 15
za 0,144,64
zu 0
zi 84,8,4736
zi 86,8,4752
zb 192,1,12352
zb 194,1,13888
za 4,148,64
zb 196,2,12352
zb 198,2,13888
zb 200,1,12416
zb 202,1,13952
za 8,152,64
zb 204,2,12416
zb 206,2,13952
zb 184,1,12288
zb 186,1,13824
za 12,156,64
zb 188,2,12288
zb 190,2,13824
zx 32,59
zr 33,59
zf 208,136,64
zci 34,44
zbs 35,29
z2 34
z2 35
zf 212,140,64
ze 15
zg 32,34
zg 33,35
zs 34
zs 35
za 0,168,68
zs 32
zs 33
zq 34,35
zq 32,33
za 4,172,68
zr 33,32
zav 32,34
zaw 32
z3 41,33
za 8,176,68
z3 40,32
z4 43,33,41
z4 42,32,40
zax 43
za 12,180,68
z5 32,42
z5 33,43
zbg 36,40,45
zay 37,41,46
zf 208,160,68
zw 34,32,33
zaz 32,43
za0 33,42
zw 35,42,43
zf 212,164,68
ze 0
za1 37,41
za2 37,47
za3 32,33
zas 33
za 0,192,72
za4 37,36
zq 34,35
zq 32,33
za5 33,48
za 4,196,72
zca 36,40
zcb 35
za6 10,37
z8 14,34,7
za 8,200,72
zk 0,21,2048
za 12,204,72
zv
zk 4,21,3072
zf 208,184,72
z8 16,32,7
zcc
zau 12,33,10
zcd
zf 212,188,72
zce
Lf8_azR1:
zdb
s_cbranch_scc1 Lf8_azG1
Lf8_azRb1:
zi 64,8,9216
zi 66,8,9232
zi 68,8,9280
zi 70,8,9296
za 16,144,76
zfo 0xffff0000
zi 72,8,9344
zi 74,8,9360
za 16,168,80
zf6 0xffff0000
zk 8,21,4096
za 16,192,84
zk 12,21,5120
za 20,148,76
za 20,172,80
za 20,196,84
zbl
zk 16,21,8192
za 24,152,76
ze 1
s_barrier
za7 28,24
za 24,176,80
za7 32,25
zk 20,21,9216
za 24,200,84
za7 36,26
zl 40,24,1024
za 28,156,76
zl 44,25,1024
zl 48,26,1024
za 28,180,80
za 28,204,84
zv
zk 24,21,10240
zf 216,136,76
zf 216,160,80
zf 216,184,84
zb0
zk 28,21,11264
zf 220,140,76
zf 220,164,80
zf 220,188,84
Lf8_azR2:
zdc
s_cbranch_scc1 Lf8_azG2
Lf8_azRb2:
zi 76,8,13824
zi 78,8,13840
zi 80,8,13888
zi 82,8,13904
za 32,144,64
ze 9
zi 84,8,13952
zi 86,8,13968
zm 32,28
zg 36,208
za 32,168,68
zm 33,29
zg 37,209
zm 34,30
zg 38,210
za 32,192,72
zm 35,31
zg 39,211
zg 32,36
zg 33,37
za 36,148,64
zg 34,38
zg 35,39
zc 36,32,33
zc 37,34,35
za 36,172,68
zk 32,21,14336
za 36,196,72
ze 7
zm 44,40
zg 48,212
zm 45,41
zg 49,213
za 40,152,64
s_barrier
zl 28,24,6144
zl 32,25,6144
zm 46,42
za 40,176,68
zk 36,21,15360
za 40,200,72
zg 50,214
zm 47,43
zg 51,215
zg 44,48
za 44,156,64
zl 40,24,7168
zg 45,49
zg 46,50
zg 47,51
za 44,180,68
zk 40,21,16384
za 44,204,72
zc 48,44,45
zc 49,46,47
zah 38,48,36
zf 224,136,64
zl 44,25,7168
zah 39,49,37
zai 36,48
zf 224,160,68
zk 44,21,17408
zf 224,184,72
zai 37,49
zf 228,140,64
zfn
zbf 36,22
zl 48,26,7168
zf 228,164,68
zl 36,26,6144
zf 228,188,72
Lf8_azR3:
zc5
s_cbranch_scc1 Lf8_azG3
Lf8_azRb3:
zi 64,8,18432
zi 66,8,18448
zi 68,8,18496
zi 70,8,18512
ze 10
za 48,144,76
zi 72,8,18560
zi 74,8,18576
zm 32,28
ze 6
zg 36,216
za 48,168,80
zm 33,29
zg 37,217
zm 34,30
zg 38,218
za 48,192,84
zm 35,31
zg 39,219
zg 32,36
zg 33,37
za 52,148,76
zg 34,38
zg 35,39
zc 36,32,33
zc 37,34,35
za 52,172,80
zk 48,21,2048
za 52,196,84
zm 44,40
zg 48,220
zm 45,41
zg 49,221
za 56,152,76
s_barrier
zl 28,24,12288
zl 32,25,12288
zm 46,42
za 56,176,80
zk 52,21,3072
za 56,200,84
zg 50,222
zm 47,43
zg 51,223
zg 44,48
za 60,156,76
zl 40,24,13312
zg 45,49
zg 46,50
zg 47,51
za 60,180,80
zk 56,21,4096
za 60,204,84
zc 48,44,45
zc 49,46,47
zah 38,48,36
zf 232,136,76
zl 44,25,13312
zah 39,49,37
zai 36,48
zf 232,160,80
zk 60,21,5120
zf 232,184,84
zai 37,49
zf 236,140,76
zbh 0xa800
zbf 36,22
zl 48,26,13312
zf 236,164,80
zl 36,26,12288
zf 236,188,84
Lf8_azR4:
zc0
s_cbranch_scc1 Lf8_azG4
Lf8_azRb4:
zi 76,8,23040
zi 78,8,23056
zi 80,8,23104
zi 82,8,23120
ze 10
z7 64,144
zi 84,8,23168
zi 86,8,23184
zm 32,28
ze 6
zg 36,224
za 64,168,68
zm 33,29
zg 37,225
zm 34,30
zg 38,226
za 64,192,72
zm 35,31
zg 39,227
zg 32,36
zg 33,37
za 68,148,64
zg 34,38
zg 35,39
zc 36,32,33
zc 37,34,35
z7 68,172
zk 64,21,8192
za 68,196,72
zm 44,40
zg 48,228
zm 45,41
zg 49,229
za 72,152,64
s_barrier
za7 28,24
za7 32,25
zm 46,42
za 72,176,68
zk 68,21,9216
z7 72,200
zg 50,230
zm 47,43
zg 51,231
zg 44,48
za 76,156,64
zl 40,24,1024
zg 45,49
zg 46,50
zg 47,51
za 76,180,68
zk 72,21,10240
za 76,204,72
zc 48,44,45
zc 49,46,47
zah 38,48,36
zf 240,136,64
zl 44,25,1024
zah 39,49,37
zai 36,48
zf 240,160,68
zk 76,21,11264
zf 240,184,72
zai 37,49
zf 244,140,64
zbh 0x15000
zbf 36,22
zl 48,26,1024
zf 244,164,68
za7 36,26
zf 244,188,72
Lf8_azR5:
zd4
s_cbranch_scc1 Lf8_azG5
Lf8_azRb5:
zi 64,8,27648
zi 66,8,27664
zi 68,8,27712
zi 70,8,27728
ze 10
za 80,144,76
zi 72,8,27776
zi 74,8,27792
zm 32,28
ze 6
zg 36,232
z7 80,168
zm 33,29
zg 37,233
zm 34,30
zg 38,234
za 80,192,84
zm 35,31
zg 39,235
zg 32,36
zg 33,37
za 84,148,76
zg 34,38
zg 35,39
zc 36,32,33
zc 37,34,35
za 84,172,80
zk 80,21,14336
z7 84,196
zm 44,40
zg 48,236
zm 45,41
zg 49,237
za 88,152,76
s_barrier
zl 28,24,6144
zl 32,25,6144
zm 46,42
za 88,176,80
zk 84,21,15360
za 88,200,84
zg 50,238
zm 47,43
zg 51,239
zg 44,48
za 92,156,76
zl 40,24,7168
zg 45,49
zg 46,50
zg 47,51
za 92,180,80
zk 88,21,16384
za 92,204,84
zc 48,44,45
zc 49,46,47
zah 38,48,36
zf 248,136,76
zl 44,25,7168
zah 39,49,37
zai 36,48
zf 248,160,80
zk 92,21,17408
zf 248,184,84
zai 37,49
zf 252,140,76
zbh 0x1f800
zbf 36,22
zl 48,26,7168
zf 252,164,80
zl 36,26,6144
zf 252,188,84
Lf8_azR6:
zd5
s_cbranch_scc1 Lf8_azG6
Lf8_azRb6:
zi 76,8,32256
zi 78,8,32272
zi 80,8,32320
zi 82,8,32336
ze 10
za 104,144,64
zi 84,8,32384
zi 86,8,32400
zm 32,28
ze 6
zg 36,240
za 104,168,68
zm 33,29
zg 37,241
zm 34,30
zg 38,242
za 104,192,72
zm 35,31
zg 39,243
zg 32,36
zg 33,37
za 108,148,64
zg 34,38
zg 35,39
zc 36,32,33
zc 37,34,35
za 108,172,68
zk 104,21,2048
za 108,196,72
zm 44,40
zg 48,244
zm 45,41
zg 49,245
za 112,152,64
s_barrier
zl 28,24,12288
zl 32,25,12288
zm 46,42
za 112,176,68
zk 108,21,3072
za 112,200,72
zg 50,246
zm 47,43
zg 51,247
zg 44,48
za 116,156,64
zl 40,24,13312
zg 45,49
zg 46,50
zg 47,51
za 116,180,68
zk 112,21,4096
za 116,204,72
zc 48,44,45
zc 49,46,47
zah 38,48,36
za 96,136,64
zl 44,25,13312
zah 39,49,37
zai 36,48
za 96,160,68
zk 116,21,5120
za 96,184,72
zai 37,49
za 100,140,64
zbh 0x2a000
zbf 36,22
zl 48,26,13312
za 100,164,68
zl 36,26,12288
za 100,188,72
Lf8_azR7:
Lf8_azH7:
ze 6
zm 32,28
ze 0
zg 36,248
zm 33,29
zg 37,249
za 128,144,76
zm 34,30
zg 38,250
zm 35,31
zg 39,251
za 128,168,80
zg 32,36
zg 33,37
zg 34,38
zg 35,39
za 128,192,84
zc 36,32,33
zc 37,34,35
zm 44,40
zg 48,252
za 132,148,76
zm 45,41
zg 49,253
zm 46,42
zg 50,254
za 132,172,80
zk 128,21,8192
za 132,196,84
zm 47,43
zg 51,255
zg 44,48
za 136,152,76
s_barrier
za7 28,24
za7 32,25
za 136,176,80
zl 40,24,1024
zk 132,21,9216
za 136,200,84
zg 45,49
zg 46,50
zg 47,51
za 140,156,76
zc 48,44,45
zc 49,46,47
zah 38,48,36
za 140,180,80
zk 136,21,10240
za 140,204,84
zl 44,25,1024
zah 39,49,37
zai 36,48
za 120,136,76
zai 37,49
za 120,160,80
zbh 0x34800
zbf 36,22
zl 48,26,1024
za 120,184,84
zk 140,21,11264
za 124,140,76
za7 36,26
za 124,164,80
za 124,188,84
ze 1
s_barrier
zm 32,28
z9 28,96
ze 0
zg 36,28
zm 33,29
z9 29,97
zg 37,29
zm 34,30
z9 30,98
zg 38,30
zm 35,31
z9 31,99
zg 39,31
zg 32,36
zg 33,37
zg 34,38
zg 35,39
zc 36,32,33
zc 37,34,35
zm 44,40
z9 40,100
zg 48,40
zm 45,41
z9 41,101
zg 49,41
zm 46,42
z9 42,102
zg 50,42
zm 47,43
z9 43,103
zg 51,43
zg 44,48
zg 45,49
zg 46,50
zg 47,51
zc 48,44,45
zc 49,46,47
zah 38,48,36
zah 39,49,37
zai 36,48
zai 37,49
zl 28,24,6144
zl 32,25,6144
zl 40,24,7168
zl 44,25,7168
zl 48,26,7168
zbh 0x3f000
zbf 36,22
zv
zl 36,26,6144
ze 4
zm 32,28
z9 28,120
zm 33,29
z9 29,121
zm 34,30
z9 30,122
zm 35,31
z9 31,123
ze 0
zg 36,28
zg 37,29
zg 38,30
zg 39,31
zg 32,36
zg 33,37
zg 34,38
zg 35,39
zc 36,32,33
zc 37,34,35
zm 44,40
z9 40,124
zg 48,40
zm 45,41
z9 41,125
zg 49,41
zm 46,42
z9 42,126
zg 50,42
zm 47,43
z9 43,127
zg 51,43
zg 44,48
zg 45,49
zg 46,50
zg 47,51
zc 48,44,45
zc 49,46,47
zah 38,48,36
zah 39,49,37
zai 36,48
zai 37,49
zbh 0x49800
zbf 36,22
s_endpgm
Lf8_ayR0:
zda
s_cbranch_scc1 Lf8_ayG0
Lf8_ayRb0:
zi 76,8,4608
zi 78,8,4624
zi 80,8,4672
zi 82,8,4688
ze 15
za 0,144,64
zu 0
zi 84,8,4736
zi 86,8,4752
zb 192,1,12352
zb 194,1,13888
za 4,148,64
zb 196,2,12352
zb 198,2,13888
zb 200,1,12416
zb 202,1,13952
za 8,152,64
zb 204,2,12416
zb 206,2,13952
zb 184,1,12288
zb 186,1,13824
za 12,156,64
zb 188,2,12288
zb 190,2,13824
zx 32,59
zr 33,59
zf 208,136,64
zci 34,44
zbs 35,29
z2 34
z2 35
zf 212,140,64
ze 15
zg 32,34
zg 33,35
zs 34
zs 35
za 0,168,68
zs 32
zs 33
zq 34,35
zq 32,33
za 4,172,68
zr 33,32
zav 32,34
zaw 32
z3 41,33
za 8,176,68
z3 40,32
z4 43,33,41
z4 42,32,40
zax 43
za 12,180,68
z5 32,42
z5 33,43
zbg 36,40,45
zay 37,41,46
zf 208,160,68
zw 34,32,33
zaz 32,43
za0 33,42
zw 35,42,43
zf 212,164,68
ze 0
za1 37,41
za2 37,47
za3 32,33
zas 33
za 0,192,72
za4 37,36
zq 34,35
zq 32,33
za5 33,48
za 4,196,72
zca 36,40
zcb 35
za6 10,37
z8 14,34,7
za 8,200,72
zk 0,21,2048
za 12,204,72
zv
zk 4,21,3072
zf 208,184,72
z8 16,32,7
zcc
zau 12,33,10
zcd
zf 212,188,72
zce
Lf8_ayR1:
zdb
s_cbranch_scc1 Lf8_ayG1
Lf8_ayRb1:
zi 64,8,9216
zi 66,8,9232
zi 68,8,9280
zi 70,8,9296
za 16,144,76
zi 72,8,9344
zi 74,8,9360
za 16,168,80
zk 8,21,4096
za 16,192,84
zk 12,21,5120
za 20,148,76
zdl 208,21
za 20,172,80
zat 212,21,1024
za 20,196,84
zam
zk 16,21,8192
za 24,152,76
za 24,176,80
za 24,200,84
ze 1
s_barrier
zk 20,21,9216
za 28,156,76
za 28,180,80
za 28,204,84
zam
zk 24,21,10240
zf 216,136,76
zf 216,160,80
zf 216,184,84
zam
zk 28,21,11264
zf 220,140,76
zf 220,164,80
zf 220,188,84
zam
zat 216,21,6144
Lf8_ayR2:
zdc
s_cbranch_scc1 Lf8_ayG2
Lf8_ayRb2:
zi 76,8,13824
zi 78,8,13840
zi 80,8,13888
zi 82,8,13904
za 32,144,64
zi 84,8,13952
zi 86,8,13968
za 32,168,68
zat 220,21,7168
za 32,192,72
za 36,148,64
za 36,172,68
za 36,196,72
za 40,152,64
ze 0
s_barrier
zam
zk 32,21,14336
za 40,176,68
zv
zk 36,21,15360
za 40,200,72
za 44,156,64
za 44,180,68
za 44,204,72
zf 224,136,64
zbl
zk 40,21,16384
zf 224,160,68
zv
zk 44,21,17408
zf 224,184,72
zf 228,140,64
zf 228,164,68
zf 228,188,72
zcr
zat 224,21,12288
Lf8_ayR3:
zc5
s_cbranch_scc1 Lf8_ayG3
Lf8_ayRb3:
zi 64,8,18432
zi 66,8,18448
zi 68,8,18496
zi 70,8,18512
za 48,144,76
zi 72,8,18560
zi 74,8,18576
za 48,168,80
zat 228,21,13312
za 48,192,84
za 52,148,76
za 52,172,80
za 52,196,84
za 56,152,76
ze 0
s_barrier
zam
zk 48,21,2048
za 56,176,80
zv
zk 52,21,3072
za 56,200,84
za 60,156,76
za 60,180,80
za 60,204,84
zf 232,136,76
zbl
zk 56,21,4096
zf 232,160,80
zv
zk 60,21,5120
zf 232,184,84
zf 236,140,76
zf 236,164,80
zf 236,188,84
zcr
zdl 232,21
Lf8_ayR4:
zc0
s_cbranch_scc1 Lf8_ayG4
Lf8_ayRb4:
zi 76,8,23040
zi 78,8,23056
zi 80,8,23104
zi 82,8,23120
z7 64,144
zi 84,8,23168
zi 86,8,23184
za 64,168,68
zat 236,21,1024
za 64,192,72
za 68,148,64
z7 68,172
za 68,196,72
za 72,152,64
ze 0
s_barrier
zam
zk 64,21,8192
za 72,176,68
zv
zk 68,21,9216
z7 72,200
za 76,156,64
za 76,180,68
za 76,204,72
zf 240,136,64
zbl
zk 72,21,10240
zf 240,160,68
zv
zk 76,21,11264
zf 240,184,72
zf 244,140,64
zf 244,164,68
zf 244,188,72
zcr
zat 240,21,6144
Lf8_ayR5:
zd4
s_cbranch_scc1 Lf8_ayG5
Lf8_ayRb5:
zi 64,8,27648
zi 66,8,27664
zi 68,8,27712
zi 70,8,27728
za 80,144,76
zi 72,8,27776
zi 74,8,27792
z7 80,168
zat 244,21,7168
za 80,192,84
za 84,148,76
za 84,172,80
z7 84,196
za 88,152,76
ze 0
s_barrier
zam
zk 80,21,14336
za 88,176,80
zv
zk 84,21,15360
za 88,200,84
za 92,156,76
za 92,180,80
za 92,204,84
zf 248,136,76
zbl
zk 88,21,16384
zf 248,160,80
zv
zk 92,21,17408
zf 248,184,84
zf 252,140,76
zf 252,164,80
zf 252,188,84
zcr
zat 248,21,12288
Lf8_ayR6:
zd5
s_cbranch_scc1 Lf8_ayG6
Lf8_ayRb6:
zi 76,8,32256
zi 78,8,32272
zi 80,8,32320
zi 82,8,32336
za 104,144,64
zi 84,8,32384
zi 86,8,32400
za 104,168,68
zat 252,21,13312
za 104,192,72
za 108,148,64
za 108,172,68
za 108,196,72
za 112,152,64
ze 0
s_barrier
zam
zk 104,21,2048
za 112,176,68
zv
zk 108,21,3072
za 112,200,72
za 116,156,64
za 116,180,68
za 116,204,72
za 96,136,64
zbl
zk 112,21,4096
za 96,160,68
zv
zk 116,21,5120
za 96,184,72
za 100,140,64
za 100,164,68
za 100,188,72
zcr
zfr 96,21
Lf8_ayR7:
Lf8_ayH7:
za 128,144,76
za 128,168,80
za 128,192,84
zcr
zk 100,21,1024
za 132,148,76
za 132,172,80
za 132,196,84
zk 128,21,8192
za 136,152,76
ze 1
s_barrier
za 136,176,80
za 136,200,84
zam
zk 132,21,9216
za 140,156,76
za 140,180,80
za 140,204,84
zam
zk 136,21,10240
za 120,136,76
za 120,160,80
za 120,184,84
zam
zk 140,21,11264
za 124,140,76
za 124,164,80
za 124,188,84
zam
zk 120,21,6144
zcr
zk 124,21,7168
ze 0
s_barrier
s_endpgm
Lf8_amH0:
zd6
zfm
zgm
s_cbranch_scc0 Lf8_amD0
Lf8_amGb0:
ze 15
zf 208,136,64
ze3
zac 17,9,6
zac 18,11,6
zad 128,13,3
zf 212,140,64
zed
zo 88,17
zo 90,18
za 0,144,64
zee 0x4800
zb 92,17,16
zb 94,18,16
za 4,148,64
zef
zb 96,17,64
zb 98,18,64
ze 13
za 8,152,64
zeg
zb 100,17,80
zb 102,18,80
za 12,156,64
zeh 0x1200
zb 104,17,128
zb 106,18,128
zf 208,160,68
zei
zb 108,17,144
zb 110,18,144
zf 212,164,68
zej 0xd0
zad 129,13,5
zad 130,15,3
ze 12
za 0,168,68
zek 0x12d0
zu 0
zb 184,1,12288
zad 131,15,5
za 4,172,68
ze 11
zb 186,1,13824
zb 188,2,12288
zh 112,88,128
ze 11
zb 190,2,13824
zb 192,1,12352
zh 116,92,128
ze 11
zb 194,1,13888
zb 196,2,12352
zh 120,96,128
ze 11
zb 198,2,13888
zc 76,112,113
zh 124,100,128
zel
zc 77,114,115
zc 78,116,117
za 8,176,68
zem
zc 79,118,119
zc 80,120,121
ze 8
zh 112,104,128
zc 81,122,123
zc 82,124,125
zh 116,108,128
zen
zb 200,1,12416
zc 83,126,127
za 12,180,68
ze 7
zb 202,1,13952
zc 84,112,113
zf 208,184,72
ze 6
zc 85,114,115
zc 86,116,117
zf 212,188,72
ze 4
zb 204,2,12416
zc 87,118,119
za 0,192,72
ze 3
zb 206,2,13952
zx 32,59
za 4,196,72
zr 33,59
zd 59,60
zd 60,61
zd 61,62
zeo
ze 2
za 8,200,72
ze 0
za 12,204,72
Lf8_amH1:
zd7
zfm
zg8
s_cbranch_scc0 Lf8_amD1
Lf8_amGb1:
zf 216,136,76
ze 0
zaj 17,9,6
zaj 18,11,6
zak 128,13,3
zf 216,160,80
zo 88,17
zo 90,18
zb 92,17,16
zf 216,184,84
zb 94,18,16
zb 96,17,64
zb 98,18,64
zf 220,140,76
zb 100,17,80
zb 102,18,80
zb 104,17,128
zf 220,164,80
zb 106,18,128
zb 108,17,144
zb 110,18,144
zf 220,188,84
zak 129,13,5
zak 130,15,3
zak 131,15,5
za 16,144,76
zcg
zcu
z0 38
za 16,168,80
zn 39,1024
za 16,192,84
ze 10
zn 49,2048
zh 112,88,128
ze 8
zd 62,63
zci 34,44
zh 116,92,128
ze 6
zbs 35,29
z2 34
zh 120,96,128
ze 3
z2 35
zc 64,112,113
zh 124,100,128
zc 65,114,115
zc 66,116,117
za 20,148,76
ze 0
zc 67,118,119
zc 68,120,121
zh 112,104,128
zc 69,122,123
zc 70,124,125
zh 116,108,128
zc 71,126,127
zg 32,34
za 20,172,80
zg 33,35
zv
zc 72,112,113
za 20,196,84
zc 73,114,115
zc 74,116,117
za 24,152,76
zc 75,118,119
zs 34
za 24,176,80
zs 35
zs 32
za 24,200,84
zs 33
zq 34,35
za 28,156,76
zq 32,33
zr 33,32
za 28,180,80
zav 32,34
zaw 32
za 28,204,84
Lf8_amH2:
zd8
zfm
zg9
s_cbranch_scc0 Lf8_amD2
Lf8_amGb2:
ze 0
zf 224,136,64
zaq 17,9,6
zaq 18,11,6
zar 128,13,3
zf 224,160,68
zo 88,17
zo 90,18
zb 92,17,16
zf 224,184,72
zb 94,18,16
zb 96,17,64
zb 98,18,64
zf 228,140,64
zb 100,17,80
zb 102,18,80
zb 104,17,128
zf 228,164,68
zb 106,18,128
zb 108,17,144
zb 110,18,144
zf 228,188,72
zar 129,13,5
zar 130,15,3
zar 131,15,5
za 32,144,64
zn 38,3072
z6 0x1000
zag 0x1000
z0 39
za 32,168,68
ze 10
zn 49,1024
zn 38,2048
zh 112,88,128
ze 8
z3 41,33
z3 40,32
z4 43,33,41
zh 116,92,128
ze 4
z4 42,32,40
zax 43
z5 32,42
zh 120,96,128
zc 76,112,113
zc 77,114,115
z5 33,43
zh 124,100,128
ze 0
zc 78,116,117
zc 79,118,119
zbg 36,40,45
zh 112,104,128
zc 80,120,121
zc 81,122,123
zay 37,41,46
zh 116,108,128
zc 82,124,125
zc 83,126,127
zw 34,32,33
za 32,192,72
zc 84,112,113
zc 85,114,115
zaz 32,43
za 36,148,64
zc 86,116,117
zc 87,118,119
za0 33,42
za 36,172,68
zw 35,42,43
za1 37,41
za2 37,47
za 36,196,72
za3 32,33
zas 33
za 40,152,64
za4 37,36
zq 34,35
za 40,176,68
zq 32,33
za5 33,48
za 40,200,72
zca 36,40
zcb 35
za 44,156,64
za6 10,37
z8 14,34,7
z8 16,32,7
za 44,180,68
zcc
zau 12,33,10
zcd
zce
za 44,204,72
Lf8_amH3:
zdt
ze4
zgs
s_cbranch_scc0 Lf8_amD3
Lf8_amGb3:
ze 0
zf 232,136,76
zaa 17,10,6
zaa 18,12,6
zf 232,160,80
zo 88,17
zo 90,18
zf 232,184,84
zb 92,17,16
zb 94,18,16
zf 236,140,76
zb 96,17,64
zb 98,18,64
zf 236,164,80
zb 100,17,80
zb 102,18,80
zf 236,188,84
zb 104,17,128
zb 106,18,128
za 48,144,76
zb 108,17,144
zb 110,18,144
za 48,168,80
zab 128,14,3
zab 129,14,5
za 48,192,84
zab 130,16,3
zab 131,16,5
za 52,148,76
ze 10
zn 39,3072
zh 112,88,128
z6 0x2000
zag 0x2000
z0 49
ze 8
zh 116,92,128
ze 6
zn 38,1024
zh 120,96,128
ze 4
zc 64,112,113
zc 65,114,115
zh 124,100,128
za 52,172,80
ze 0
zc 66,116,117
zc 67,118,119
zh 112,104,128
zc 68,120,121
zc 69,122,123
zh 116,108,128
zc 70,124,125
zc 71,126,127
za 52,196,84
za 56,152,76
zv
zc 72,112,113
zc 73,114,115
za 56,176,80
zc 74,116,117
zc 75,118,119
za 56,200,84
za 60,156,76
za 60,180,80
za 60,204,84
Lf8_amH4:
zc2
ze4
zgm
s_cbranch_scc0 Lf8_amD4
Lf8_amGb4:
ze 0
zf 240,136,64
zac 17,10,6
zac 18,12,6
zad 128,14,3
zf 240,160,68
zo 88,17
zo 90,18
zb 92,17,16
zf 240,184,72
zb 94,18,16
zb 96,17,64
zb 98,18,64
zf 244,140,64
zb 100,17,80
zb 102,18,80
zb 104,17,128
zf 244,164,68
zb 106,18,128
zb 108,17,144
zf 244,188,72
zb 110,18,144
zad 129,14,5
z7 64,144
zad 130,16,3
zad 131,16,5
za 64,168,68
zn 39,2048
za 64,192,72
ze 10
zn 49,3072
zh 112,88,128
z6 0x3000
zag 0x3000
z0 38
ze 8
zh 116,92,128
ze 6
zn 39,1024
zh 120,96,128
ze 3
zc 76,112,113
zc 77,114,115
zh 124,100,128
zx 32,54
zc 78,116,117
za 68,148,64
ze 0
zc 79,118,119
zc 80,120,121
zh 112,104,128
zc 81,122,123
zc 82,124,125
zh 116,108,128
zc 83,126,127
zr 33,54
z7 68,172
zd 54,55
zv
zc 84,112,113
za 68,196,72
zc 85,114,115
zc 86,116,117
za 72,152,64
zc 87,118,119
zd 55,56
za 72,176,68
zd 56,57
zdx 34,44
z7 72,200
zcj 35,29
z2 34
za 76,156,64
z2 35
zg 32,34
za 76,180,68
zg 33,35
za 76,204,72
Lf8_amH5:
zey
ze4
zg8
s_cbranch_scc0 Lf8_amD5
Lf8_amGb5:
ze 0
zf 248,136,76
zaj 17,10,6
zaj 18,12,6
zak 128,14,3
zf 248,160,80
zo 88,17
zo 90,18
zb 92,17,16
zf 248,184,84
zb 94,18,16
zb 96,17,64
zb 98,18,64
zf 252,140,76
zb 100,17,80
zb 102,18,80
zb 104,17,128
zf 252,164,80
zb 106,18,128
zb 108,17,144
zb 110,18,144
zf 252,188,84
zak 129,14,5
zak 130,16,3
zak 131,16,5
za 80,144,76
zn 49,2048
z7 80,168
zn 38,3072
za 80,192,84
z6 0x4000
zag 0x4000
z0 39
ze 10
zh 112,88,128
ze 8
zn 49,1024
zh 116,92,128
ze 5
zs 34
zs 35
zh 120,96,128
ze 2
zs 32
zc 64,112,113
zh 124,100,128
zc 65,114,115
zc 66,116,117
za 84,148,76
zc 67,118,119
zc 68,120,121
zh 112,104,128
ze 0
zc 69,122,123
zc 70,124,125
zh 116,108,128
zc 71,126,127
zs 33
za 84,172,80
zq 34,35
zc 72,112,113
z7 84,196
zc 73,114,115
zv
zc 74,116,117
za 88,152,76
zc 75,118,119
zq 32,33
za 88,176,80
zr 33,32
zav 32,34
za 88,200,84
zaw 32
z3 41,33
za 92,156,76
z3 40,32
z4 43,33,41
za 92,180,80
z4 42,32,40
za 92,204,84
Lf8_amH6:
zez
ze4
zg9
s_cbranch_scc0 Lf8_amD6
Lf8_amGb6:
ze 0
za 96,136,64
zaq 17,10,6
zaq 18,12,6
zar 128,14,3
za 96,160,68
zo 88,17
zo 90,18
zb 92,17,16
za 96,184,72
zb 94,18,16
zb 96,17,64
zb 98,18,64
za 100,140,64
zb 100,17,80
zb 102,18,80
zb 104,17,128
za 100,164,68
zb 106,18,128
zb 108,17,144
zb 110,18,144
za 100,188,72
zar 129,14,5
zar 130,16,3
zar 131,16,5
za 104,144,64
zax 43
z5 32,42
z5 33,43
za 104,168,68
zbg 36,40,45
zay 37,41,46
za 104,192,72
ze 10
zw 34,32,33
zaz 32,43
zh 112,88,128
ze 8
za0 33,42
zw 35,42,43
zh 116,92,128
ze 6
za1 37,41
za2 37,47
zh 120,96,128
ze 4
za3 32,33
zc 76,112,113
zh 124,100,128
zc 77,114,115
zc 78,116,117
za 108,148,64
ze 0
zc 79,118,119
zc 80,120,121
zh 112,104,128
zc 81,122,123
zc 82,124,125
zh 116,108,128
zc 83,126,127
zas 33
za 108,172,68
za4 37,36
zv
zc 84,112,113
za 108,196,72
zc 85,114,115
zc 86,116,117
za 112,152,64
zc 87,118,119
zq 34,35
za 112,176,68
zq 32,33
za5 33,48
za 112,200,72
zdf 36,40
zdg 35
za 116,156,64
za6 9,37
z8 13,34,7
z8 15,32,7
za 116,180,68
zdh
zau 11,33,9
zdi
zdj
za 116,204,72
Lf8_amH7:
zct
zfm
zgs
s_cbranch_scc0 Lf8_amD7
Lf8_amGb7:
ze 0
za 120,136,76
zbn
zbq 8,0
zaa 17,9,6
zaa 18,11,6
za 124,140,76
zbo
zo 88,17
zo 90,18
zb 92,17,16
za 128,144,76
zbp
zb 94,18,16
zb 96,17,64
zb 98,18,64
za 132,148,76
zf5
zb 100,17,80
zb 102,18,80
zb 104,17,128
za 136,152,76
zb 106,18,128
zb 108,17,144
zb 110,18,144
za 140,156,76
zab 128,13,3
zab 129,13,5
zab 130,15,3
za 120,160,80
zu 12
zo 136,1
zb 138,1,1536
zab 131,15,5
za 124,164,80
ze 12
zo 140,2
zb 142,2,1536
zb 144,1,64
zh 112,88,128
ze 13
zb 146,1,1600
zb 148,2,64
zb 150,2,1600
zh 116,92,128
ze 14
zb 152,1,128
zb 154,1,1664
zh 120,96,128
ze 14
zc 64,112,113
zc 65,114,115
zh 124,100,128
zb 156,2,128
zc 66,116,117
za 128,168,80
ze 11
zc 67,118,119
zc 68,120,121
zh 112,104,128
zc 69,122,123
zc 70,124,125
zh 116,108,128
zb 158,2,1664
zc 71,126,127
za 132,172,80
za 136,176,80
zv
zc 72,112,113
zc 73,114,115
za 140,180,80
zu 6
zb 160,1,6144
zc 74,116,117
zc 75,118,119
za 120,184,84
zb 162,1,7680
zb 164,2,6144
zb 166,2,7680
za 124,188,84
zb 168,1,6208
zb 170,1,7744
za 128,192,84
zb 172,2,6208
zb 174,2,7744
za 132,196,84
zb 176,1,6272
zb 178,1,7808
za 136,200,84
zb 180,2,6272
zb 182,2,7808
za 140,204,84
Lf8_amE2:
zgx
s_cbranch_scc1 Lf8_amH0
zde
s_cbranch_scc1 Lf8_ayH0
s_branch Lf8_azH0
Lf8_azH0:
zd6
zfm
zgm
s_cbranch_scc0 Lf8_azD0
Lf8_azGb0:
ze 15
za 0,144,64
zac 17,9,6
zac 18,11,6
zad 128,13,3
zad 129,13,5
zad 130,15,3
za 4,148,64
ze 12
zo 88,17
zo 90,18
zb 92,17,16
zb 94,18,16
zb 96,17,64
za 8,152,64
zb 98,18,64
zb 100,17,80
zb 102,18,80
zb 104,17,128
za 12,156,64
zb 106,18,128
zb 108,17,144
zb 110,18,144
zad 131,15,5
zf 208,136,64
zu 0
zb 192,1,12352
zb 194,1,13888
zb 196,2,12352
zb 198,2,13888
zf 212,140,64
ze 15
zb 200,1,12416
zb 202,1,13952
zb 204,2,12416
zb 206,2,13952
za 0,168,68
ze 15
zb 184,1,12288
zb 186,1,13824
zb 188,2,12288
zb 190,2,13824
zh 112,88,128
zx 32,59
zr 33,59
zci 34,44
zbs 35,29
zh 116,92,128
ze 15
z2 34
z2 35
zg 32,34
zc 76,112,113
zh 120,96,128
zc 77,114,115
zg 33,35
zs 34
zc 78,116,117
zh 124,100,128
ze 11
zc 79,118,119
zs 35
zs 32
zc 80,120,121
zh 112,104,128
zc 81,122,123
zs 33
zc 82,124,125
zc 83,126,127
zh 116,108,128
zq 34,35
zq 32,33
zr 33,32
zc 84,112,113
za 4,172,68
zc 85,114,115
zav 32,34
zaw 32
zc 86,116,117
za 8,176,68
zc 87,118,119
z3 41,33
z3 40,32
z4 43,33,41
za 12,180,68
z4 42,32,40
zax 43
z5 32,42
z5 33,43
zf 208,160,68
zbg 36,40,45
zay 37,41,46
zw 34,32,33
zaz 32,43
zf 212,164,68
ze 0
za0 33,42
zw 35,42,43
za1 37,41
za2 37,47
za 0,192,72
za3 32,33
zas 33
za4 37,36
zq 34,35
za 4,196,72
zq 32,33
za5 33,48
zca 36,40
zcb 35
za 8,200,72
zk 0,21,2048
za 12,204,72
zv
zk 4,21,3072
za6 10,37
zf 208,184,72
z8 14,34,7
z8 16,32,7
zcc
zau 12,33,10
zcd
zf 212,188,72
zce
Lf8_azH1:
zd7
zfm
zg8
s_cbranch_scc0 Lf8_azD1
Lf8_azGb1:
za 16,144,76
zfo 0xffff0000
zaj 17,9,6
zaj 18,11,6
zak 128,13,3
za 16,168,80
zf6 0xffff0000
zo 88,17
zo 90,18
zb 92,17,16
za 16,192,84
zb 94,18,16
zb 96,17,64
zb 98,18,64
za 20,148,76
zb 100,17,80
zb 102,18,80
zb 104,17,128
za 20,172,80
zb 106,18,128
zb 108,17,144
zb 110,18,144
za 20,196,84
zak 129,13,5
zak 130,15,3
zak 131,15,5
za 24,152,76
zk 8,21,4096
za 24,176,80
ze 11
zk 12,21,5120
zh 112,88,128
ze 10
zk 16,21,8192
zh 116,92,128
ze 9
zk 20,21,9216
zh 120,96,128
ze 2
s_barrier
za7 28,24
za7 32,25
zh 124,100,128
za7 36,26
zl 40,24,1024
za 24,200,84
zl 44,25,1024
zl 48,26,1024
za 28,156,76
zc 64,112,113
zc 65,114,115
za 28,180,80
zc 66,116,117
zc 67,118,119
zh 112,104,128
zk 24,21,10240
zh 116,108,128
zc 68,120,121
zc 69,122,123
za 28,204,84
zc 70,124,125
zc 71,126,127
zf 216,136,76
zc 72,112,113
zc 73,114,115
zf 216,160,80
zc 74,116,117
zc 75,118,119
zf 216,184,84
zk 28,21,11264
zf 220,140,76
zf 220,164,80
zf 220,188,84
Lf8_azH2:
zd8
zfm
zg9
s_cbranch_scc0 Lf8_azD2
Lf8_azGb2:
za 32,144,64
zaq 17,9,6
zaq 18,11,6
zar 128,13,3
zar 129,13,5
za 32,168,68
zo 88,17
zo 90,18
zb 92,17,16
zb 94,18,16
za 32,192,72
zb 96,17,64
zb 98,18,64
zb 100,17,80
zb 102,18,80
za 36,148,64
zb 104,17,128
zb 106,18,128
zb 108,17,144
zb 110,18,144
za 36,172,68
zk 32,21,14336
zar 130,15,3
zar 131,15,5
za 36,196,72
ze 13
zm 32,28
zg 36,208
zm 33,29
zg 37,209
za 40,152,64
s_barrier
zm 34,30
zg 38,210
zm 35,31
ze 11
zh 112,88,128
ze 9
zk 36,21,15360
zh 116,92,128
ze 8
zl 28,24,6144
zg 39,211
zg 32,36
zg 33,37
zh 120,96,128
ze 7
zg 34,38
zg 35,39
zc 36,32,33
zc 37,34,35
zh 124,100,128
zl 32,25,6144
zc 76,112,113
zc 77,114,115
zc 78,116,117
za 40,176,68
ze 4
zc 79,118,119
zc 80,120,121
zc 81,122,123
zc 82,124,125
zh 112,104,128
zc 83,126,127
zm 44,40
zg 48,212
zm 45,41
zh 116,108,128
zg 49,213
zm 46,42
zg 50,214
zc 84,112,113
za 40,200,72
zc 85,114,115
zm 47,43
zg 51,215
zc 86,116,117
za 44,156,64
zl 40,24,7168
zc 87,118,119
zg 44,48
zg 45,49
za 44,180,68
zk 40,21,16384
za 44,204,72
zg 46,50
zg 47,51
zc 48,44,45
zc 49,46,47
zf 224,136,64
zl 44,25,7168
zah 38,48,36
zah 39,49,37
zf 224,160,68
zk 44,21,17408
zf 224,184,72
zai 36,48
zai 37,49
zf 228,140,64
zfn
zbf 36,22
zl 48,26,7168
zf 228,164,68
zl 36,26,6144
zf 228,188,72
Lf8_azH3:
zdt
ze4
zgs
s_cbranch_scc0 Lf8_azD3
Lf8_azGb3:
ze 6
za 48,144,76
zaa 17,10,6
zaa 18,12,6
zab 128,14,3
zab 129,14,5
za 48,168,80
zo 88,17
zo 90,18
zb 92,17,16
zb 94,18,16
za 48,192,84
zb 96,17,64
zb 98,18,64
zb 100,17,80
zb 102,18,80
za 52,148,76
zb 104,17,128
zb 106,18,128
zb 108,17,144
zb 110,18,144
za 52,172,80
zk 48,21,2048
zab 130,16,3
zab 131,16,5
za 52,196,84
ze 13
zm 32,28
zg 36,216
zm 33,29
zg 37,217
za 56,152,76
s_barrier
zm 34,30
zg 38,218
zm 35,31
ze 11
zh 112,88,128
ze 9
zk 52,21,3072
zh 116,92,128
ze 8
zl 28,24,12288
zg 39,219
zg 32,36
zg 33,37
zh 120,96,128
ze 7
zg 34,38
zg 35,39
zc 36,32,33
zc 37,34,35
zh 124,100,128
zl 32,25,12288
zc 64,112,113
zc 65,114,115
zc 66,116,117
za 56,176,80
ze 4
zc 67,118,119
zc 68,120,121
zc 69,122,123
zc 70,124,125
zh 112,104,128
zc 71,126,127
zm 44,40
zg 48,220
zm 45,41
zh 116,108,128
zg 49,221
zm 46,42
zg 50,222
zc 72,112,113
za 56,200,84
zc 73,114,115
zm 47,43
zg 51,223
zc 74,116,117
za 60,156,76
zl 40,24,13312
zc 75,118,119
zg 44,48
zg 45,49
za 60,180,80
zk 56,21,4096
za 60,204,84
zg 46,50
zg 47,51
zc 48,44,45
zc 49,46,47
zf 232,136,76
zl 44,25,13312
zah 38,48,36
zah 39,49,37
zf 232,160,80
zk 60,21,5120
zf 232,184,84
zai 36,48
zai 37,49
zf 236,140,76
zbh 0xa800
zbf 36,22
zl 48,26,13312
zf 236,164,80
zl 36,26,12288
zf 236,188,84
Lf8_azH4:
zc2
ze4
zgm
s_cbranch_scc0 Lf8_azD4
Lf8_azGb4:
ze 6
z7 64,144
zac 17,10,6
zac 18,12,6
zad 128,14,3
zad 129,14,5
za 64,168,68
zo 88,17
zo 90,18
zb 92,17,16
zb 94,18,16
za 64,192,72
zb 96,17,64
zb 98,18,64
zb 100,17,80
zb 102,18,80
za 68,148,64
zb 104,17,128
zb 106,18,128
zb 108,17,144
zb 110,18,144
z7 68,172
zk 64,21,8192
zad 130,16,3
zad 131,16,5
za 68,196,72
ze 13
zm 32,28
zg 36,224
zm 33,29
zg 37,225
za 72,152,64
s_barrier
zm 34,30
zg 38,226
zm 35,31
ze 11
zh 112,88,128
ze 9
zk 68,21,9216
zh 116,92,128
ze 8
za7 28,24
zg 39,227
zg 32,36
zg 33,37
zh 120,96,128
ze 7
zg 34,38
zg 35,39
zc 36,32,33
zc 37,34,35
zh 124,100,128
za7 32,25
zc 76,112,113
zc 77,114,115
zc 78,116,117
za 72,176,68
ze 4
zc 79,118,119
zc 80,120,121
zc 81,122,123
zc 82,124,125
zh 112,104,128
zc 83,126,127
zm 44,40
zg 48,228
zm 45,41
zh 116,108,128
zg 49,229
zm 46,42
zg 50,230
zc 84,112,113
z7 72,200
zc 85,114,115
zm 47,43
zg 51,231
zc 86,116,117
za 76,156,64
zl 40,24,1024
zc 87,118,119
zg 44,48
zg 45,49
za 76,180,68
zk 72,21,10240
za 76,204,72
zg 46,50
zg 47,51
zc 48,44,45
zc 49,46,47
zf 240,136,64
zl 44,25,1024
zah 38,48,36
zah 39,49,37
zf 240,160,68
zk 76,21,11264
zf 240,184,72
zai 36,48
zai 37,49
zf 244,140,64
zbh 0x15000
zbf 36,22
zl 48,26,1024
zf 244,164,68
za7 36,26
zf 244,188,72
Lf8_azH5:
zey
ze4
zg8
s_cbranch_scc0 Lf8_azD5
Lf8_azGb5:
ze 6
za 80,144,76
zaj 17,10,6
zaj 18,12,6
zak 128,14,3
zak 129,14,5
z7 80,168
zo 88,17
zo 90,18
zb 92,17,16
zb 94,18,16
za 80,192,84
zb 96,17,64
zb 98,18,64
zb 100,17,80
zb 102,18,80
za 84,148,76
zb 104,17,128
zb 106,18,128
zb 108,17,144
zb 110,18,144
za 84,172,80
zk 80,21,14336
zak 130,16,3
zak 131,16,5
z7 84,196
ze 13
zm 32,28
zg 36,232
zm 33,29
zg 37,233
za 88,152,76
s_barrier
zm 34,30
zg 38,234
zm 35,31
ze 11
zh 112,88,128
ze 9
zk 84,21,15360
zh 116,92,128
ze 8
zl 28,24,6144
zg 39,235
zg 32,36
zg 33,37
zh 120,96,128
ze 7
zg 34,38
zg 35,39
zc 36,32,33
zc 37,34,35
zh 124,100,128
zl 32,25,6144
zc 64,112,113
zc 65,114,115
zc 66,116,117
za 88,176,80
ze 4
zc 67,118,119
zc 68,120,121
zc 69,122,123
zc 70,124,125
zh 112,104,128
zc 71,126,127
zm 44,40
zg 48,236
zm 45,41
zh 116,108,128
zg 49,237
zm 46,42
zg 50,238
zc 72,112,113
za 88,200,84
zc 73,114,115
zm 47,43
zg 51,239
zc 74,116,117
za 92,156,76
zl 40,24,7168
zc 75,118,119
zg 44,48
zg 45,49
za 92,180,80
zk 88,21,16384
za 92,204,84
zg 46,50
zg 47,51
zc 48,44,45
zc 49,46,47
zf 248,136,76
zl 44,25,7168
zah 38,48,36
zah 39,49,37
zf 248,160,80
zk 92,21,17408
zf 248,184,84
zai 36,48
zai 37,49
zf 252,140,76
zbh 0x1f800
zbf 36,22
zl 48,26,7168
zf 252,164,80
zl 36,26,6144
zf 252,188,84
Lf8_azH6:
zez
ze4
zg9
s_cbranch_scc0 Lf8_azD6
Lf8_azGb6:
ze 6
za 104,144,64
zaq 17,10,6
zaq 18,12,6
zar 128,14,3
zar 129,14,5
za 104,168,68
zo 88,17
zo 90,18
zb 92,17,16
zb 94,18,16
za 104,192,72
zb 96,17,64
zb 98,18,64
zb 100,17,80
zb 102,18,80
za 108,148,64
zb 104,17,128
zb 106,18,128
zb 108,17,144
zb 110,18,144
za 108,172,68
zk 104,21,2048
zar 130,16,3
zar 131,16,5
za 108,196,72
ze 13
zm 32,28
zg 36,240
zm 33,29
zg 37,241
za 112,152,64
s_barrier
zm 34,30
zg 38,242
zm 35,31
ze 11
zh 112,88,128
ze 9
zk 108,21,3072
zh 116,92,128
ze 8
zl 28,24,12288
zg 39,243
zg 32,36
zg 33,37
zh 120,96,128
ze 7
zg 34,38
zg 35,39
zc 36,32,33
zc 37,34,35
zh 124,100,128
zl 32,25,12288
zc 76,112,113
zc 77,114,115
zc 78,116,117
za 112,176,68
ze 4
zc 79,118,119
zc 80,120,121
zc 81,122,123
zc 82,124,125
zh 112,104,128
zc 83,126,127
zm 44,40
zg 48,244
zm 45,41
zh 116,108,128
zg 49,245
zm 46,42
zg 50,246
zc 84,112,113
za 112,200,72
zc 85,114,115
zm 47,43
zg 51,247
zc 86,116,117
za 116,156,64
zl 40,24,13312
zc 87,118,119
zg 44,48
zg 45,49
za 116,180,68
zk 112,21,4096
za 116,204,72
zg 46,50
zg 47,51
zc 48,44,45
zc 49,46,47
za 96,136,64
zl 44,25,13312
zah 38,48,36
zah 39,49,37
za 96,160,68
zk 116,21,5120
za 96,184,72
zai 36,48
zai 37,49
za 100,140,64
zbh 0x2a000
zbf 36,22
zl 48,26,13312
za 100,164,68
zl 36,26,12288
za 100,188,72
s_branch Lf8_azR7
Lf8_azE2:
Lf8_ayH0:
zd6
zfm
zgm
s_cbranch_scc0 Lf8_ayD0
Lf8_ayGb0:
ze 15
za 0,144,64
zac 17,9,6
zac 18,11,6
zad 128,13,3
zad 129,13,5
zad 130,15,3
za 4,148,64
ze 12
zo 88,17
zo 90,18
zb 92,17,16
zb 94,18,16
zb 96,17,64
za 8,152,64
zb 98,18,64
zb 100,17,80
zb 102,18,80
zb 104,17,128
za 12,156,64
zb 106,18,128
zb 108,17,144
zb 110,18,144
zad 131,15,5
zf 208,136,64
zu 0
zb 192,1,12352
zb 194,1,13888
zb 196,2,12352
zb 198,2,13888
zf 212,140,64
ze 15
zb 200,1,12416
zb 202,1,13952
zb 204,2,12416
zb 206,2,13952
za 0,168,68
ze 15
zb 184,1,12288
zb 186,1,13824
zb 188,2,12288
zb 190,2,13824
zh 112,88,128
zx 32,59
zr 33,59
zci 34,44
zbs 35,29
zh 116,92,128
ze 15
z2 34
z2 35
zg 32,34
zc 76,112,113
zh 120,96,128
zc 77,114,115
zg 33,35
zs 34
zc 78,116,117
zh 124,100,128
ze 11
zc 79,118,119
zs 35
zs 32
zc 80,120,121
zh 112,104,128
zc 81,122,123
zs 33
zc 82,124,125
zc 83,126,127
zh 116,108,128
zq 34,35
zq 32,33
zr 33,32
zc 84,112,113
za 4,172,68
zc 85,114,115
zav 32,34
zaw 32
zc 86,116,117
za 8,176,68
zc 87,118,119
z3 41,33
z3 40,32
z4 43,33,41
za 12,180,68
z4 42,32,40
zax 43
z5 32,42
z5 33,43
zf 208,160,68
zbg 36,40,45
zay 37,41,46
zw 34,32,33
zaz 32,43
zf 212,164,68
ze 0
za0 33,42
zw 35,42,43
za1 37,41
za2 37,47
za 0,192,72
za3 32,33
zas 33
za4 37,36
zq 34,35
za 4,196,72
zq 32,33
za5 33,48
zca 36,40
zcb 35
za 8,200,72
zk 0,21,2048
za 12,204,72
zv
zk 4,21,3072
za6 10,37
zf 208,184,72
z8 14,34,7
z8 16,32,7
zcc
zau 12,33,10
zcd
zf 212,188,72
zce
Lf8_ayH1:
zd7
zfm
zg8
s_cbranch_scc0 Lf8_ayD1
Lf8_ayGb1:
za 16,144,76
zaj 17,9,6
zaj 18,11,6
zak 128,13,3
za 16,168,80
zo 88,17
zo 90,18
zb 92,17,16
za 16,192,84
zb 94,18,16
zb 96,17,64
zb 98,18,64
za 20,148,76
zb 100,17,80
zb 102,18,80
zb 104,17,128
za 20,172,80
zb 106,18,128
zb 108,17,144
zb 110,18,144
za 20,196,84
zak 129,13,5
zak 130,15,3
zak 131,15,5
za 24,152,76
zk 8,21,4096
za 24,176,80
ze 11
zk 12,21,5120
zh 112,88,128
ze 10
zdl 208,21
zh 116,92,128
ze 9
zat 212,21,1024
zh 120,96,128
ze 8
zk 16,21,8192
zh 124,100,128
zk 20,21,9216
za 24,200,84
ze 2
s_barrier
zc 64,112,113
zc 65,114,115
za 28,156,76
zc 66,116,117
zc 67,118,119
zc 68,120,121
zh 112,104,128
zk 24,21,10240
zc 69,122,123
zh 116,108,128
zc 70,124,125
zc 71,126,127
za 28,180,80
zam
zc 72,112,113
zc 73,114,115
za 28,204,84
zf 216,136,76
zc 74,116,117
zc 75,118,119
zf 216,160,80
zf 216,184,84
zf 220,140,76
zam
zk 28,21,11264
zf 220,164,80
zb0
zat 216,21,6144
zf 220,188,84
Lf8_ayH2:
zd8
zfm
zg9
s_cbranch_scc0 Lf8_ayD2
Lf8_ayGb2:
za 32,144,64
zaq 17,9,6
zaq 18,11,6
zar 128,13,3
za 32,168,68
zo 88,17
zo 90,18
zb 92,17,16
za 32,192,72
zb 94,18,16
zb 96,17,64
zb 98,18,64
za 36,148,64
zb 100,17,80
zb 102,18,80
zb 104,17,128
za 36,172,68
zb 106,18,128
zb 108,17,144
zb 110,18,144
za 36,196,72
zar 129,13,5
zar 130,15,3
zar 131,15,5
za 40,152,64
zat 220,21,7168
za 40,176,68
ze 11
zk 32,21,14336
zh 112,88,128
ze 10
zk 36,21,15360
zh 116,92,128
ze 2
s_barrier
zh 120,96,128
zh 124,100,128
zv
zc 76,112,113
zc 77,114,115
za 40,200,72
za 44,156,64
zc 78,116,117
zc 79,118,119
zc 80,120,121
zh 112,104,128
zb0
zk 40,21,16384
zc 81,122,123
zh 116,108,128
zc 82,124,125
zc 83,126,127
za 44,180,68
zc 84,112,113
zc 85,114,115
za 44,204,72
zf 224,136,64
zv
zc 86,116,117
zc 87,118,119
zf 224,160,68
zf 224,184,72
zf 228,140,64
zv
zk 44,21,17408
zf 228,164,68
zbl
zat 224,21,12288
zf 228,188,72
Lf8_ayH3:
zdt
ze4
zgs
s_cbranch_scc0 Lf8_ayD3
Lf8_ayGb3:
za 48,144,76
zaa 17,10,6
zaa 18,12,6
zab 128,14,3
za 48,168,80
zo 88,17
zo 90,18
zb 92,17,16
za 48,192,84
zb 94,18,16
zb 96,17,64
zb 98,18,64
za 52,148,76
zb 100,17,80
zb 102,18,80
zb 104,17,128
za 52,172,80
zb 106,18,128
zb 108,17,144
zb 110,18,144
za 52,196,84
zab 129,14,5
zab 130,16,3
zab 131,16,5
za 56,152,76
zat 228,21,13312
za 56,176,80
ze 11
zk 48,21,2048
zh 112,88,128
ze 10
zk 52,21,3072
zh 116,92,128
ze 2
s_barrier
zh 120,96,128
zh 124,100,128
zv
zc 64,112,113
zc 65,114,115
za 56,200,84
za 60,156,76
zc 66,116,117
zc 67,118,119
zc 68,120,121
zh 112,104,128
zb0
zk 56,21,4096
zc 69,122,123
zh 116,108,128
zc 70,124,125
zc 71,126,127
za 60,180,80
zc 72,112,113
zc 73,114,115
za 60,204,84
zf 232,136,76
zv
zc 74,116,117
zc 75,118,119
zf 232,160,80
zf 232,184,84
zf 236,140,76
zv
zk 60,21,5120
zf 236,164,80
zbl
zdl 232,21
zf 236,188,84
Lf8_ayH4:
zc2
ze4
zgm
s_cbranch_scc0 Lf8_ayD4
Lf8_ayGb4:
z7 64,144
zac 17,10,6
zac 18,12,6
zad 128,14,3
za 64,168,68
zo 88,17
zo 90,18
zb 92,17,16
za 64,192,72
zb 94,18,16
zb 96,17,64
zb 98,18,64
za 68,148,64
zb 100,17,80
zb 102,18,80
zb 104,17,128
z7 68,172
zb 106,18,128
zb 108,17,144
zb 110,18,144
za 68,196,72
zad 129,14,5
zad 130,16,3
zad 131,16,5
za 72,152,64
zat 236,21,1024
za 72,176,68
ze 11
zk 64,21,8192
zh 112,88,128
ze 10
zk 68,21,9216
zh 116,92,128
ze 2
s_barrier
zh 120,96,128
zh 124,100,128
zv
zc 76,112,113
zc 77,114,115
z7 72,200
za 76,156,64
zc 78,116,117
zc 79,118,119
zc 80,120,121
zh 112,104,128
zb0
zk 72,21,10240
zc 81,122,123
zh 116,108,128
zc 82,124,125
zc 83,126,127
za 76,180,68
zc 84,112,113
zc 85,114,115
za 76,204,72
zf 240,136,64
zv
zc 86,116,117
zc 87,118,119
zf 240,160,68
zf 240,184,72
zf 244,140,64
zv
zk 76,21,11264
zf 244,164,68
zbl
zat 240,21,6144
zf 244,188,72
Lf8_ayH5:
zey
ze4
zg8
s_cbranch_scc0 Lf8_ayD5
Lf8_ayGb5:
za 80,144,76
zaj 17,10,6
zaj 18,12,6
zak 128,14,3
z7 80,168
zo 88,17
zo 90,18
zb 92,17,16
za 80,192,84
zb 94,18,16
zb 96,17,64
zb 98,18,64
za 84,148,76
zb 100,17,80
zb 102,18,80
zb 104,17,128
za 84,172,80
zb 106,18,128
zb 108,17,144
zb 110,18,144
z7 84,196
zak 129,14,5
zak 130,16,3
zak 131,16,5
za 88,152,76
zat 244,21,7168
za 88,176,80
ze 11
zk 80,21,14336
zh 112,88,128
ze 10
zk 84,21,15360
zh 116,92,128
ze 2
s_barrier
zh 120,96,128
zh 124,100,128
zv
zc 64,112,113
zc 65,114,115
za 88,200,84
za 92,156,76
zc 66,116,117
zc 67,118,119
zc 68,120,121
zh 112,104,128
zb0
zk 88,21,16384
zc 69,122,123
zh 116,108,128
zc 70,124,125
zc 71,126,127
za 92,180,80
zc 72,112,113
zc 73,114,115
za 92,204,84
zf 248,136,76
zv
zc 74,116,117
zc 75,118,119
zf 248,160,80
zf 248,184,84
zf 252,140,76
zv
zk 92,21,17408
zf 252,164,80
zbl
zat 248,21,12288
zf 252,188,84
Lf8_ayH6:
zez
ze4
zg9
s_cbranch_scc0 Lf8_ayD6
Lf8_ayGb6:
za 104,144,64
zaq 17,10,6
zaq 18,12,6
zar 128,14,3
za 104,168,68
zo 88,17
zo 90,18
zb 92,17,16
za 104,192,72
zb 94,18,16
zb 96,17,64
zb 98,18,64
za 108,148,64
zb 100,17,80
zb 102,18,80
zb 104,17,128
za 108,172,68
zb 106,18,128
zb 108,17,144
zb 110,18,144
za 108,196,72
zar 129,14,5
zar 130,16,3
zar 131,16,5
za 112,152,64
zat 252,21,13312
za 112,176,68
ze 11
zk 104,21,2048
zh 112,88,128
ze 10
zk 108,21,3072
zh 116,92,128
ze 2
s_barrier
zh 120,96,128
zh 124,100,128
zv
zc 76,112,113
zc 77,114,115
za 112,200,72
za 116,156,64
zc 78,116,117
zc 79,118,119
zc 80,120,121
zh 112,104,128
zb0
zk 112,21,4096
zc 81,122,123
zh 116,108,128
zc 82,124,125
zc 83,126,127
za 116,180,68
zc 84,112,113
zc 85,114,115
za 116,204,72
za 96,136,64
zv
zc 86,116,117
zc 87,118,119
za 96,160,68
za 96,184,72
za 100,140,64
zv
zk 116,21,5120
za 100,164,68
zbl
zfr 96,21
za 100,188,72
s_branch Lf8_ayR7
Lf8_ayE2:
Lf8_aqH0:
zu 19
s_barrier
zct
zfm
zgs
s_cbranch_scc0 Lf8_aqD0
Lf8_aqGb0:
zaa 17,9,6
zaa 18,11,6
zab 128,13,3
zab 129,13,5
zab 130,15,3
zab 131,15,5
zo 88,17
zo 90,18
zb 92,17,16
zb 94,18,16
zb 96,17,64
zb 98,18,64
zb 100,17,80
zb 102,18,80
zb 104,17,128
zb 106,18,128
zb 108,17,144
zb 110,18,144
zu 13
zo 136,1
zb 138,1,1536
zo 140,2
zb 142,2,1536
zb 144,1,64
zb 146,1,1600
zb 148,2,64
zb 150,2,1600
zb 152,1,128
zb 154,1,1664
zb 156,2,128
zb 158,2,1664
zu 7
zb 160,1,6144
zb 162,1,7680
zb 164,2,6144
zb 166,2,7680
zb 168,1,6208
zb 170,1,7744
zb 172,2,6208
zb 174,2,7744
zb 176,1,6272
ze 15
zh 112,88,128
zb 178,1,7808
zb 180,2,6272
zb 182,2,7808
zh 116,92,128
zh 120,96,128
zh 124,100,128
zam
zc 64,112,113
zc 65,114,115
zam
zc 66,116,117
zc 67,118,119
zh 112,104,128
zc 68,120,121
zc 69,122,123
zc 70,124,125
zc 71,126,127
zh 116,108,128
zb0
zc 72,112,113
zc 73,114,115
zb0
zc 74,116,117
zc 75,118,119
Lf8_aqE2:
s_branch Lf8_atH0
Lf8_atH0:
zd6
zfm
zgm
s_cbranch_scc0 Lf8_atD0
Lf8_atGb0:
ze 15
zh 208,136,64
zac 17,9,6
zac 18,11,6
zad 128,13,3
zh 212,140,64
zo 88,17
zo 90,18
zb 92,17,16
zp 0,144,64
zb 94,18,16
zb 96,17,64
zb 98,18,64
zp 4,148,64
ze 15
zb 100,17,80
zb 102,18,80
zb 104,17,128
zp 8,152,64
zb 106,18,128
zb 108,17,144
zb 110,18,144
zp 12,156,64
zad 129,13,5
zad 130,15,3
zad 131,15,5
zf 208,160,68
zu 1
zb 184,1,12288
zb 186,1,13824
zb 188,2,12288
ze 15
zf 212,164,68
ze 13
zb 190,2,13824
zb 192,1,12352
zb 194,1,13888
zh 112,88,128
ze 14
zb 196,2,12352
zb 198,2,13888
zb 200,1,12416
zh 116,92,128
ze 15
zb 202,1,13952
zb 204,2,12416
zb 206,2,13952
zh 120,96,128
zf1
zcv
zcw 0xdf
zbt 0xa800
zdd 0x9000
zc 76,112,113
zc 77,114,115
ze 12
zh 124,100,128
zc 78,116,117
zc 79,118,119
zh 112,104,128
zc 80,120,121
zc 81,122,123
zh 116,108,128
zam
zc 82,124,125
zc 83,126,127
za 0,168,68
zcx
zv
zae 21
za 4,172,68
zc 84,112,113
zc 85,114,115
za 8,176,68
zc 86,116,117
zc 87,118,119
za 12,180,68
zan 0x400
zv
zae 22
ze 0
zf 208,184,72
zan 0x800
zv
zae 23
zf 212,188,72
zan 0xc00
zv
zae 24
za 0,192,72
zcy 0x3fffffff
zan 0x1000
zv
zae 25
zcz
za 4,196,72
za 8,200,72
za 12,204,72
Lf8_atH1:
zd7
zfm
zg8
s_cbranch_scc0 Lf8_atD1
Lf8_atGb1:
ze 0
zh 216,136,76
zaj 17,9,6
zaj 18,11,6
zak 128,13,3
zf 216,160,80
zo 88,17
zo 90,18
zb 92,17,16
zf 216,184,84
zb 94,18,16
zb 96,17,64
zb 98,18,64
zh 220,140,76
zb 100,17,80
zb 102,18,80
zb 104,17,128
zf 220,164,80
zb 106,18,128
zb 108,17,144
zb 110,18,144
zf 220,188,84
zak 129,13,5
zak 130,15,3
zak 131,15,5
zp 16,144,76
zgj
zcv
zcw 0xdf
zbt 0xa800
zdd 0xd800
za 16,168,80
zbw
zgk
s_cselect_b32 s42, 0x22000, s42
zcx
zv
zae 21
ze 10
zh 112,88,128
zan 0x400
zv
zae 22
zan 0x800
zv
zae 23
ze 3
zh 116,92,128
zan 0xc00
zv
zae 24
zh 120,96,128
zc 64,112,113
zc 65,114,115
zh 124,100,128
ze 0
zc 66,116,117
zc 67,118,119
zh 112,104,128
zv
zc 68,120,121
zc 69,122,123
zh 116,108,128
zc 70,124,125
zc 71,126,127
za 16,192,84
zcy 0x3fffffff
zan 0x1000
zv
zae 25
zcz
zp 20,148,76
zc 72,112,113
zc 73,114,115
za 20,172,80
zc 74,116,117
zc 75,118,119
za 20,196,84
zu 10
zf2 28,31
zx 32,58
zp 24,152,76
zr 33,58
zci 34,44
za 24,176,80
zbs 35,29
z2 34
za 24,200,84
z2 35
zg 32,34
zp 28,156,76
zbr 0x10000
zdw 1
zdw 2
za 28,180,80
za 28,204,84
Lf8_atH2:
zu 6
s_barrier
zd8
zfm
zg9
s_cbranch_scc0 Lf8_atD2
Lf8_atGb2:
ze 0
zh 224,136,64
zaq 17,9,6
zaq 18,11,6
zar 128,13,3
zar 129,13,5
zf 224,160,68
zo 88,17
zo 90,18
zb 92,17,16
zb 94,18,16
zf 224,184,72
zb 96,17,64
zb 98,18,64
zb 100,17,80
zb 102,18,80
zh 228,140,64
zb 104,17,128
zb 106,18,128
zb 108,17,144
zb 110,18,144
zf 228,164,68
ze5
zc6 56,31,16
z6 0x3000
zc7 0x3000
z0 38
zar 130,15,3
zar 131,15,5
zf 228,188,72
zn 39,1024
zn 49,2048
zp 32,144,64
ze 10
zn 38,3072
zg 33,35
zs 34
zh 112,88,128
ze 7
zs 35
zs 32
zs 33
zq 34,35
zh 116,92,128
ze 2
zq 32,33
zr 33,32
zav 32,34
zc 76,112,113
zh 120,96,128
zc 77,114,115
zaw 32
z3 41,33
zc 78,116,117
zh 124,100,128
zc 79,118,119
z3 40,32
z4 43,33,41
zh 112,104,128
ze 0
zc 80,120,121
zc 81,122,123
z4 42,32,40
zh 116,108,128
zc 82,124,125
zc 83,126,127
zci 34,44
za 32,168,68
zc 84,112,113
zc 85,114,115
z2 34
za 32,192,72
zc 86,116,117
zc 87,118,119
zd1 35,45
zp 36,148,64
zd2 34,35
zax 43
z5 32,42
za 36,172,68
z5 33,43
zd3 36,40,45,34
zay 37,41,46
za 36,196,72
zw 34,32,33
zaz 32,43
za0 33,42
zp 40,152,64
zw 35,42,43
za1 37,41
za2 37,47
za 40,176,68
za3 32,33
zas 33
za4 37,36
za 40,200,72
zq 34,35
zq 32,33
za5 33,48
zp 44,156,64
zca 36,40
zcb 35
za6 10,37
z8 14,34,7
za 44,180,68
z8 16,32,7
zcc
zau 12,33,10
zcd
za 44,204,72
zce
Lf8_atH3:
zdt
ze4
zgs
s_cbranch_scc0 Lf8_atD3
Lf8_atGb3:
ze 0
zh 232,136,76
zaa 17,10,6
zaa 18,12,6
zf 232,160,80
zo 88,17
zo 90,18
zf 232,184,84
zb 92,17,16
zb 94,18,16
zh 236,140,76
zb 96,17,64
zb 98,18,64
zf 236,164,80
zb 100,17,80
zb 102,18,80
zf 236,188,84
zb 104,17,128
zb 106,18,128
zp 48,144,76
zb 108,17,144
zb 110,18,144
za 48,168,80
zab 128,14,3
zab 129,14,5
za 48,192,84
zab 130,16,3
zab 131,16,5
zp 52,148,76
zc8 0x15e00
zc6 62,31,16
z6 0x4000
zc7 0x4000
z0 39
ze 10
zh 112,88,128
ze 8
zn 49,1024
zh 116,92,128
zcg
zcu
z0 38
ze 4
zh 120,96,128
zc 64,112,113
zc 65,114,115
zh 124,100,128
ze 0
zc 66,116,117
zc 67,118,119
zh 112,104,128
zv
zc 68,120,121
zc 69,122,123
zh 116,108,128
zc 70,124,125
zc 71,126,127
za 52,172,80
zn 39,1024
za 52,196,84
zc 72,112,113
zc 73,114,115
zp 56,152,76
zc 74,116,117
zc 75,118,119
za 56,176,80
zn 49,2048
za 56,200,84
zp 60,156,76
za 60,180,80
za 60,204,84
Lf8_atH4:
zc2
ze4
zgm
s_cbranch_scc0 Lf8_atD4
Lf8_atGb4:
ze 0
zh 240,136,64
zac 17,10,6
zac 18,12,6
zad 128,14,3
zf 240,160,68
zo 88,17
zo 90,18
zb 92,17,16
zf 240,184,72
zb 94,18,16
zb 96,17,64
zb 98,18,64
zh 244,140,64
zb 100,17,80
zb 102,18,80
zb 104,17,128
zf 244,164,68
zb 106,18,128
zb 108,17,144
zb 110,18,144
zf 244,188,72
zad 129,14,5
zad 130,16,3
zad 131,16,5
zex 64,144
zn 38,3072
z6 0x1000
zag 0x1000
z0 39
za 64,168,68
ze 10
zn 49,1024
zn 38,2048
zh 112,88,128
ze 8
zx 32,53
zr 33,53
zdx 34,44
zh 116,92,128
ze 4
zcj 35,29
z2 34
z2 35
zh 120,96,128
zc 76,112,113
zc 77,114,115
zh 124,100,128
ze 0
zc 78,116,117
zc 79,118,119
zh 112,104,128
zv
zc 80,120,121
zc 81,122,123
zh 116,108,128
zc 82,124,125
zc 83,126,127
za 64,192,72
zg 32,34
zc 84,112,113
zp 68,148,64
zc 85,114,115
zv
zc 86,116,117
z7 68,172
zc 87,118,119
zg 33,35
za 68,196,72
zs 34
zs 35
zp 72,152,64
zs 32
zs 33
za 72,176,68
zq 34,35
zq 32,33
z7 72,200
zr 33,32
zav 32,34
zp 76,156,64
zaw 32
z3 41,33
za 76,180,68
z3 40,32
z4 43,33,41
za 76,204,72
Lf8_atH5:
zey
ze4
zg8
s_cbranch_scc0 Lf8_atD5
Lf8_atGb5:
ze 0
zh 248,136,76
zaj 17,10,6
zaj 18,12,6
zak 128,14,3
zf 248,160,80
zo 88,17
zo 90,18
zb 92,17,16
zf 248,184,84
zb 94,18,16
zb 96,17,64
zb 98,18,64
zh 252,140,76
zb 100,17,80
zb 102,18,80
zb 104,17,128
zf 252,164,80
zb 106,18,128
zb 108,17,144
zb 110,18,144
zf 252,188,84
zak 129,14,5
zak 130,16,3
zak 131,16,5
zp 80,144,76
zn 39,3072
z6 0x2000
zag 0x2000
z0 49
z7 80,168
ze 10
zn 38,1024
zn 39,2048
zh 112,88,128
ze 8
zn 49,3072
z4 42,32,40
zh 116,92,128
ze 3
zax 43
z5 32,42
z5 33,43
zh 120,96,128
zc 64,112,113
zc 65,114,115
zbg 36,40,45
zh 124,100,128
ze 0
zc 66,116,117
zc 67,118,119
zay 37,41,46
zh 112,104,128
zc 68,120,121
zc 69,122,123
zw 34,32,33
zh 116,108,128
zc 70,124,125
zc 71,126,127
zaz 32,43
za 80,192,84
zc 72,112,113
zc 73,114,115
za0 33,42
zp 84,148,76
zc 74,116,117
zc 75,118,119
za 84,172,80
zw 35,42,43
za1 37,41
z7 84,196
za2 37,47
za3 32,33
zp 88,152,76
zas 33
za4 37,36
za 88,176,80
zq 34,35
zq 32,33
za 88,200,84
za5 33,48
zdf 36,40
zp 92,156,76
zdg 35
za6 9,37
za 92,180,80
z8 13,34,7
z8 15,32,7
za 92,204,84
zdh
Lf8_atH6:
zu 21
s_barrier
zez
ze4
zg9
s_cbranch_scc0 Lf8_atD6
Lf8_atGb6:
ze 0
zp 96,136,64
zaq 17,10,6
zaq 18,12,6
zar 128,14,3
zar 129,14,5
za 96,160,68
zo 88,17
zo 90,18
zb 92,17,16
zb 94,18,16
za 96,184,72
zb 96,17,64
zb 98,18,64
zb 100,17,80
zb 102,18,80
zp 100,140,64
zb 104,17,128
zb 106,18,128
zb 108,17,144
zb 110,18,144
za 100,164,68
zar 130,16,3
zar 131,16,5
zau 11,33,9
zdi
za 100,188,72
zdj
zu 20
zx 32,28
zr 33,28
zf3 34,44
ze2 35,29
zp 104,144,64
ze 10
z2 34
z2 35
zg 32,34
zg 33,35
zh 112,88,128
ze 8
zs 34
zs 35
zs 32
zh 116,92,128
ze 6
zs 33
zq 34,35
zq 32,33
zh 120,96,128
ze 3
zc 76,112,113
zc 77,114,115
zr 33,32
zh 124,100,128
ze 0
zc 78,116,117
zc 79,118,119
zav 32,34
zh 112,104,128
zc 80,120,121
zc 81,122,123
zaw 32
zh 116,108,128
zc 82,124,125
zc 83,126,127
z3 41,33
za 104,168,68
zc 84,112,113
zc 85,114,115
z3 40,32
za 104,192,72
zc 86,116,117
zc 87,118,119
z4 43,33,41
zp 108,148,64
z4 42,32,40
zax 43
z5 32,42
za 108,172,68
z5 33,43
zbg 36,40,45
zay 37,41,46
za 108,196,72
zw 34,32,33
zaz 32,43
za0 33,42
zp 112,152,64
zw 35,42,43
za1 37,41
za2 37,47
za 112,176,68
za3 32,33
zas 33
za4 37,36
za 112,200,72
zq 34,35
zq 32,33
za5 33,48
zp 116,156,64
zca 36,40
zcb 35
za6 10,37
z8 14,34,7
za 116,180,68
z8 16,32,7
zcc
zau 12,33,10
zcd
za 116,204,72
zce
Lf8_atH7:
zu 12
s_barrier
zdt
ze4
zgs
s_cbranch_scc0 Lf8_atD7
Lf8_atGb7:
ze 0
zp 120,136,76
zf4 8,0
zaa 17,10,6
zaa 18,12,6
zp 124,140,76
zo 88,17
zo 90,18
zb 92,17,16
zp 128,144,76
zb 94,18,16
zb 96,17,64
zb 98,18,64
zp 132,148,76
zb 100,17,80
zb 102,18,80
zb 104,17,128
zp 136,152,76
zb 106,18,128
zb 108,17,144
zb 110,18,144
zp 140,156,76
zab 128,14,3
zab 129,14,5
zab 130,16,3
za 120,160,80
zb 136,1,12288
zb 138,1,13824
zab 131,16,5
za 124,164,80
ze 12
zb 140,2,12288
zb 142,2,13824
zb 144,1,12352
zh 112,88,128
ze 13
zb 146,1,13888
zb 148,2,12352
zb 150,2,13888
zh 116,92,128
ze 14
zb 152,1,12416
zb 154,1,13952
zh 120,96,128
ze 14
zc 64,112,113
zc 65,114,115
zh 124,100,128
zb 156,2,12416
zc 66,116,117
za 128,168,80
ze 11
zc 67,118,119
zc 68,120,121
zh 112,104,128
zc 69,122,123
zc 70,124,125
zh 116,108,128
zb 158,2,13952
zc 71,126,127
za 132,172,80
za 136,176,80
zv
zc 72,112,113
zc 73,114,115
za 140,180,80
zb 160,1,30720
zc 74,116,117
zc 75,118,119
za 120,184,84
zb 162,1,32256
zb 164,2,30720
zb 166,2,32256
za 124,188,84
zb 168,1,30784
zb 170,1,32320
za 128,192,84
zb 172,2,30784
zb 174,2,32320
za 132,196,84
zb 176,1,30848
zb 178,1,32384
za 136,200,84
zb 180,2,30848
zb 182,2,32384
za 140,204,84
Lf8_atE2:
zfz
s_cbranch_scc1 Lf8_as1H0
zf0
s_cbranch_scc1 Lf8_as2H0
zde
s_cbranch_scc1 Lf8_as3H0
s_branch Lf8_as0H0
Lf8_as0H0:
zc2
ze4
zgm
s_cbranch_scc0 Lf8_as0D0
Lf8_as0Gb0:
ze 15
zf 208,136,64
zac 17,10,6
zac 18,12,6
zad 128,14,3
zad 129,14,5
zf 212,140,64
zo 88,17
zo 90,18
zb 92,17,16
zb 94,18,16
za 0,144,64
zb 96,17,64
zb 98,18,64
zb 100,17,80
za 4,148,64
ze 15
zb 102,18,80
zb 104,17,128
zb 106,18,128
za 8,152,64
zb 108,17,144
zb 110,18,144
zad 130,16,3
za 12,156,64
ze 14
zb 192,1,49216
zb 194,1,50752
zad 131,16,5
zf 208,176,68
ze 14
zb 196,2,49216
zb 198,2,50752
zb 200,1,49280
zf 212,180,68
ze 15
zb 202,1,50816
zb 204,2,49280
zb 206,2,50816
zh 112,88,128
ze 15
zb 184,1,49152
zb 186,1,50688
zb 188,2,49152
zh 116,92,128
ze 15
zb 190,2,50688
zbr 0x10000
zbb 1
zbb 2
zh 120,96,128
zc 76,112,113
zc 77,114,115
zb2 50
zh 124,100,128
ze 12
zc 78,116,117
zc 79,118,119
zb3 50
zh 112,104,128
zc 80,120,121
zc 81,122,123
zbz 21,50
zh 116,108,128
zbc 0x5800
zbw
zbd
zc 82,124,125
zc 83,126,127
za 0,160,68
zbe
zc 84,112,113
zc 85,114,115
zal 24,50
za 4,164,68
zc 86,116,117
zc 87,118,119
ze 0
s_barrier
za 8,168,68
z6 0x3000
zag 0x3000
z0 38
zn 39,1024
za 12,172,68
zn 49,2048
zn 38,3072
zf 208,192,72
z6 0x4000
zag 0x4000
z0 39
zf 212,196,72
zbc 0x9800
zn 49,1024
zby
zbd
za 0,200,72
zbe
zal 25,50
zb5
zb6 0x1d800
za 4,204,72
zal 26,50
zb7 50
zbv 22,4
za 8,184,72
zbk 22,50
zb8
za 12,188,72
zb9 22
Lf8_as0H1:
zct
zfm
zgs
s_cbranch_scc0 Lf8_as0D1
Lf8_as0Gb1:
ze 0
zf 216,136,76
zbn
zbq 8,0
zaa 17,9,6
zaa 18,11,6
zf 220,140,76
zbo
zo 88,17
zo 90,18
zb 92,17,16
za 16,144,76
zbp
zb 94,18,16
zb 96,17,64
zb 98,18,64
za 20,148,76
zb 100,17,80
zb 102,18,80
zb 104,17,128
za 24,152,76
zb 106,18,128
zb 108,17,144
zb 110,18,144
za 28,156,76
zab 128,13,3
zab 129,13,5
zab 130,15,3
zf 216,176,80
zu 12
zo 136,1
zb 138,1,1536
zab 131,15,5
zf 220,180,80
ze 12
zo 140,2
zb 142,2,1536
zb 144,1,64
zh 112,88,128
ze 13
zb 146,1,1600
zb 148,2,64
zb 150,2,1600
zh 116,92,128
ze 14
zb 152,1,128
zb 154,1,1664
zh 120,96,128
ze 14
zc 64,112,113
zc 65,114,115
zh 124,100,128
zb 156,2,128
zc 66,116,117
za 16,160,80
ze 11
zc 67,118,119
zc 68,120,121
zh 112,104,128
zc 69,122,123
zc 70,124,125
zh 116,108,128
zb 158,2,1664
zc 71,126,127
za 20,164,80
za 24,168,80
zv
zc 72,112,113
zc 73,114,115
za 28,172,80
zu 6
zb 160,1,6144
zc 74,116,117
zc 75,118,119
zf 216,192,84
zb 162,1,7680
zb 164,2,6144
zb 166,2,7680
zf 220,196,84
zb 168,1,6208
zb 170,1,7744
za 16,200,84
zb 172,2,6208
zb 174,2,7744
za 20,204,84
zb 176,1,6272
zb 178,1,7808
za 24,184,84
zb 180,2,6272
zb 182,2,7808
za 28,188,84
Lf8_as0E2:
s_branch Lf8_amH0
Lf8_as1H0:
zc2
ze4
zgm
s_cbranch_scc0 Lf8_as1D0
Lf8_as1Gb0:
ze 15
zf 224,144,64
zac 17,10,6
zac 18,12,6
zad 128,14,3
zad 129,14,5
zf 228,148,64
ze 14
zo 88,17
zo 90,18
zb 92,17,16
zb 94,18,16
za 32,152,64
ze 15
zb 96,17,64
zb 98,18,64
zb 100,17,80
za 36,156,64
zb 102,18,80
zb 104,17,128
zb 106,18,128
za 40,136,64
zb 108,17,144
zb 110,18,144
zad 130,16,3
za 44,140,64
ze 14
zb 200,1,49280
zb 202,1,50816
zad 131,16,5
zf 224,160,68
zb 204,2,49280
zb 206,2,50816
zb 184,1,49152
zf 228,164,68
ze 15
zb 186,1,50688
zb 188,2,49152
zb 190,2,50688
zh 112,88,128
ze 15
zb 192,1,49216
zb 194,1,50752
zb 196,2,49216
zh 116,92,128
ze 15
zb 198,2,50752
zbr 0x10000
zbb 1
zbb 2
zh 120,96,128
zc 76,112,113
zc 77,114,115
zb2 50
zh 124,100,128
ze 12
zc 78,116,117
zc 79,118,119
zb3 50
zh 112,104,128
zc 80,120,121
zc 81,122,123
zbz 21,50
zh 116,108,128
zbc 0x5800
zbw
zbd
zc 82,124,125
zc 83,126,127
za 32,168,68
zbe
zc 84,112,113
zc 85,114,115
zal 24,50
za 36,172,68
zc 86,116,117
zc 87,118,119
ze 0
s_barrier
za 40,176,68
z6 0x3000
zag 0x3000
z0 38
zn 39,1024
za 44,180,68
zn 49,2048
zn 38,3072
zf 224,200,72
z6 0x4000
zag 0x4000
z0 39
zf 228,204,72
zbc 0x9800
zn 49,1024
zby
zbd
za 32,184,72
zbe
zal 25,50
zb5
zb6 0x1d800
za 36,188,72
zal 26,50
zb7 50
zbv 22,4
za 40,192,72
zbk 22,50
zb8
za 44,196,72
zb9 22
Lf8_as1H1:
zct
zfm
zgs
s_cbranch_scc0 Lf8_as1D1
Lf8_as1Gb1:
ze 0
zf 232,144,76
zbn
zbq 8,0
zaa 17,9,6
zaa 18,11,6
zf 236,148,76
zbo
zo 88,17
zo 90,18
zb 92,17,16
za 48,152,76
zbp
zb 94,18,16
zb 96,17,64
zb 98,18,64
za 52,156,76
zb 100,17,80
zb 102,18,80
zb 104,17,128
za 56,136,76
zb 106,18,128
zb 108,17,144
zb 110,18,144
za 60,140,76
zab 128,13,3
zab 129,13,5
zab 130,15,3
zf 232,160,80
zu 12
zo 136,1
zb 138,1,1536
zab 131,15,5
zf 236,164,80
ze 12
zo 140,2
zb 142,2,1536
zb 144,1,64
zh 112,88,128
ze 13
zb 146,1,1600
zb 148,2,64
zb 150,2,1600
zh 116,92,128
ze 14
zb 152,1,128
zb 154,1,1664
zh 120,96,128
ze 14
zc 64,112,113
zc 65,114,115
zh 124,100,128
zb 156,2,128
zc 66,116,117
za 48,168,80
ze 11
zc 67,118,119
zc 68,120,121
zh 112,104,128
zc 69,122,123
zc 70,124,125
zh 116,108,128
zb 158,2,1664
zc 71,126,127
za 52,172,80
za 56,176,80
zv
zc 72,112,113
zc 73,114,115
za 60,180,80
zu 6
zb 160,1,6144
zc 74,116,117
zc 75,118,119
zf 232,200,84
zb 162,1,7680
zb 164,2,6144
zb 166,2,7680
zf 236,204,84
zb 168,1,6208
zb 170,1,7744
za 48,184,84
zb 172,2,6208
zb 174,2,7744
za 52,188,84
zb 176,1,6272
zb 178,1,7808
za 56,192,84
zb 180,2,6272
zb 182,2,7808
za 60,196,84
Lf8_as1E2:
s_branch Lf8_amH0
Lf8_as2H0:
zc2
ze4
zgm
s_cbranch_scc0 Lf8_as2D0
Lf8_as2Gb0:
ze 14
zf 240,152,64
ze 12
zac 17,10,6
zac 18,12,6
zad 128,14,3
zad 129,14,5
zf 244,156,64
zo 88,17
zo 90,18
zb 92,17,16
zb 94,18,16
z7 64,136
zb 96,17,64
zb 98,18,64
zb 100,17,80
za 68,140,64
zb 102,18,80
zb 104,17,128
zb 106,18,128
za 72,144,64
zb 108,17,144
zb 110,18,144
zad 130,16,3
za 76,148,64
ze 14
zb 184,1,49152
zb 186,1,50688
zad 131,16,5
zf 240,168,68
zb 188,2,49152
zb 190,2,50688
zb 192,1,49216
zf 244,172,68
ze 15
zb 194,1,50752
zb 196,2,49216
zb 198,2,50752
zh 112,88,128
ze 15
zb 200,1,49280
zb 202,1,50816
zb 204,2,49280
zh 116,92,128
ze 15
zb 206,2,50816
zbr 0x10000
zbb 1
zbb 2
zh 120,96,128
zc 76,112,113
zc 77,114,115
zb2 50
zh 124,100,128
ze 12
zc 78,116,117
zc 79,118,119
zb3 50
zh 112,104,128
zc 80,120,121
zc 81,122,123
zbz 21,50
zh 116,108,128
zbc 0x5800
zbw
zbd
zc 82,124,125
zc 83,126,127
za 64,176,68
zbe
zc 84,112,113
zc 85,114,115
zal 24,50
z7 68,180
zc 86,116,117
zc 87,118,119
ze 0
s_barrier
za 72,160,68
z6 0x3000
zag 0x3000
z0 38
zn 39,1024
za 76,164,68
zn 49,2048
zn 38,3072
zf 240,184,72
z6 0x4000
zag 0x4000
z0 39
zf 244,188,72
zbc 0x9800
zn 49,1024
zby
zbd
za 64,192,72
zbe
zal 25,50
zb5
zb6 0x1d800
za 68,196,72
zal 26,50
zb7 50
zbv 22,4
z7 72,200
zbk 22,50
zb8
za 76,204,72
zb9 22
Lf8_as2H1:
zct
zfm
zgs
s_cbranch_scc0 Lf8_as2D1
Lf8_as2Gb1:
ze 0
zf 248,152,76
zbn
zbq 8,0
zaa 17,9,6
zaa 18,11,6
zf 252,156,76
zbo
zo 88,17
zo 90,18
zb 92,17,16
za 80,136,76
zbp
zb 94,18,16
zb 96,17,64
zb 98,18,64
za 84,140,76
zb 100,17,80
zb 102,18,80
zb 104,17,128
za 88,144,76
zb 106,18,128
zb 108,17,144
zb 110,18,144
za 92,148,76
zab 128,13,3
zab 129,13,5
zab 130,15,3
zf 248,168,80
zu 12
zo 136,1
zb 138,1,1536
zab 131,15,5
zf 252,172,80
ze 12
zo 140,2
zb 142,2,1536
zb 144,1,64
zh 112,88,128
ze 13
zb 146,1,1600
zb 148,2,64
zb 150,2,1600
zh 116,92,128
ze 14
zb 152,1,128
zb 154,1,1664
zh 120,96,128
ze 14
zc 64,112,113
zc 65,114,115
zh 124,100,128
zb 156,2,128
zc 66,116,117
z7 80,176
ze 11
zc 67,118,119
zc 68,120,121
zh 112,104,128
zc 69,122,123
zc 70,124,125
zh 116,108,128
zb 158,2,1664
zc 71,126,127
za 84,180,80
za 88,160,80
zv
zc 72,112,113
zc 73,114,115
za 92,164,80
zu 6
zb 160,1,6144
zc 74,116,117
zc 75,118,119
zf 248,184,84
zb 162,1,7680
zb 164,2,6144
zb 166,2,7680
zf 252,188,84
zb 168,1,6208
zb 170,1,7744
za 80,192,84
zb 172,2,6208
zb 174,2,7744
z7 84,196
zb 176,1,6272
zb 178,1,7808
za 88,200,84
zb 180,2,6272
zb 182,2,7808
za 92,204,84
Lf8_as2E2:
s_branch Lf8_amH0
Lf8_as3H0:
zc2
ze4
zgm
s_cbranch_scc0 Lf8_as3D0
Lf8_as3Gb0:
ze 15
za 96,136,64
zac 17,10,6
zac 18,12,6
zad 128,14,3
za 100,140,64
zo 88,17
zo 90,18
zb 92,17,16
za 104,144,64
zb 94,18,16
zb 96,17,64
zb 98,18,64
za 108,148,64
ze 15
zb 100,17,80
zb 102,18,80
zb 104,17,128
za 112,152,64
zb 106,18,128
zb 108,17,144
zb 110,18,144
za 116,156,64
ze 14
zad 129,14,5
zad 130,16,3
zad 131,16,5
za 96,176,68
ze 12
zb 192,1,49216
zb 194,1,50752
zb 196,2,49216
za 100,180,68
ze 13
zb 198,2,50752
zb 200,1,49280
zb 202,1,50816
zh 112,88,128
ze 14
zb 204,2,49280
zb 206,2,50816
zb 184,1,49152
zh 116,92,128
ze 15
zb 186,1,50688
zb 188,2,49152
zb 190,2,50688
zh 120,96,128
ze 15
zc 76,112,113
zc 77,114,115
zbr 0x10000
zbb 1
zbb 2
zh 124,100,128
ze 12
zc 78,116,117
zc 79,118,119
zh 112,104,128
zc 80,120,121
zc 81,122,123
zh 116,108,128
zv
zc 82,124,125
zc 83,126,127
za 104,160,68
zb2 50
zc 84,112,113
za 108,164,68
zc 85,114,115
zc 86,116,117
za 112,168,68
zc 87,118,119
ze 0
s_barrier
zb3 50
za 116,172,68
zbz 21,50
zbc 0x5800
zbw
zbd
za 96,192,72
zbe
zal 24,50
zbc 0x9800
za 100,196,72
zby
zbd
zbe
za 104,200,72
zal 25,50
zb5
za 108,204,72
zb6 0x1d800
zal 26,50
zb7 50
zbv 22,4
za 112,184,72
zbk 22,50
zb8
za 116,188,72
zb9 22
Lf8_as3H1:
zct
zfm
zgs
s_cbranch_scc0 Lf8_as3D1
Lf8_as3Gb1:
ze 0
za 120,136,76
zbn
zbq 8,0
zaa 17,9,6
zaa 18,11,6
za 124,140,76
zbo
zo 88,17
zo 90,18
zb 92,17,16
za 128,144,76
zbp
zb 94,18,16
zb 96,17,64
zb 98,18,64
za 132,148,76
zb 100,17,80
zb 102,18,80
zb 104,17,128
za 136,152,76
zb 106,18,128
zb 108,17,144
zb 110,18,144
za 140,156,76
zab 128,13,3
zab 129,13,5
zab 130,15,3
za 120,176,80
zu 6
zo 136,1
zb 138,1,1536
zab 131,15,5
za 124,180,80
ze 12
zo 140,2
zb 142,2,1536
zb 144,1,64
zh 112,88,128
ze 13
zb 146,1,1600
zb 148,2,64
zb 150,2,1600
zh 116,92,128
ze 14
zb 152,1,128
zb 154,1,1664
zh 120,96,128
ze 14
zc 64,112,113
zc 65,114,115
zh 124,100,128
zb 156,2,128
zc 66,116,117
za 128,160,80
ze 11
zc 67,118,119
zc 68,120,121
zh 112,104,128
zc 69,122,123
zc 70,124,125
zh 116,108,128
zb 158,2,1664
zc 71,126,127
za 132,164,80
za 136,168,80
zv
zc 72,112,113
zc 73,114,115
za 140,172,80
zu 0
zb 160,1,6144
zc 74,116,117
zc 75,118,119
za 120,192,84
zb 162,1,7680
zb 164,2,6144
zb 166,2,7680
za 124,196,84
zb 168,1,6208
zb 170,1,7744
za 128,200,84
zb 172,2,6208
zb 174,2,7744
za 132,204,84
zb 176,1,6272
zb 178,1,7808
za 136,184,84
zb 180,2,6272
zb 182,2,7808
za 140,188,84
Lf8_as3E2:
s_branch Lf8_amH0
Lf8_amG0:
zd6
s_cbranch_scc0 Lf8_amGb0
s_branch Lf8_amS0
Lf8_amD0:
zd6
s_cbranch_scc0 Lf8_amRb0
Lf8_amS0:
ze8
s_cbranch_scc0 Lf8_amY0
ze9
zap 0x5780
zao
s_call_b64 s[88:89], Lf8_far
s_branch Lf8_amXb0
Lf8_amY0:
zac 17,9,6
zac 18,11,6
za9 19,13
za9 20,15
s_call_b64 s[88:89], Lf8_four
Lf8_amXb0:
ze 15
zf 208,136,64
ze3
zd 76,88
zd 77,89
zf 212,140,64
zed
zd 78,90
zd 79,91
za 0,144,64
zee 0x4800
zd 80,92
zd 81,93
za 4,148,64
zef
zd 82,94
zd 83,95
ze 8
za 8,152,64
zeg
zd 84,96
zd 85,97
za 12,156,64
zeh 0x1200
zd 86,98
zd 87,99
zf 208,160,68
zei
zu 0
zb 184,1,12288
zb 186,1,13824
zf 212,164,68
zej 0xd0
zb 188,2,12288
zb 190,2,13824
ze 4
za 0,168,68
zek 0x12d0
zb 192,1,12352
zb 194,1,13888
za 4,172,68
zel
zb 196,2,12352
zb 198,2,13888
za 8,176,68
zem
zb 200,1,12416
zb 202,1,13952
za 12,180,68
zb 204,2,12416
zb 206,2,13952
zx 32,59
zr 33,59
zd 59,60
zd 60,61
zd 61,62
zen
zeo
ze 10
zf 208,184,72
ze 8
zf 212,188,72
ze 6
za 0,192,72
ze 4
za 4,196,72
ze 2
za 8,200,72
ze 0
za 12,204,72
s_branch Lf8_amH1
Lf8_amG1:
zd7
s_cbranch_scc0 Lf8_amGb1
s_branch Lf8_amS1
Lf8_amD1:
zd7
s_cbranch_scc0 Lf8_amRb1
Lf8_amS1:
zfa
s_cbranch_scc0 Lf8_amY1
zfb
zap 0xaf00
zao
s_call_b64 s[88:89], Lf8_far
s_branch Lf8_amXb1
Lf8_amY1:
zaj 17,9,6
zaj 18,11,6
zbm 19,13
zbm 20,15
s_call_b64 s[88:89], Lf8_four
Lf8_amXb1:
zf 216,136,76
ze 0
zd 64,88
zd 65,89
zd 66,90
zf 216,160,80
zd 67,91
zd 68,92
zf 216,184,84
zd 69,93
zd 70,94
zf 220,140,76
zd 71,95
zd 72,96
zf 220,164,80
zd 73,97
zd 74,98
zf 220,188,84
zcg
zcu
z0 38
zd 75,99
za 16,144,76
zn 39,1024
za 16,168,80
zn 49,2048
za 16,192,84
zd 62,63
zci 34,44
za 20,148,76
zbs 35,29
z2 34
za 20,172,80
z2 35
zg 32,34
za 20,196,84
zg 33,35
zs 34
za 24,152,76
zs 35
zs 32
za 24,176,80
zs 33
zq 34,35
za 24,200,84
zq 32,33
zr 33,32
za 28,156,76
zav 32,34
zaw 32
za 28,180,80
za 28,204,84
s_branch Lf8_amH2
Lf8_amG2:
zd8
s_cbranch_scc0 Lf8_amGb2
s_branch Lf8_amS2
Lf8_amD2:
zd8
s_cbranch_scc0 Lf8_amRb2
Lf8_amS2:
zfc
s_cbranch_scc0 Lf8_amY2
zfd
zap 0x10680
zao
s_call_b64 s[88:89], Lf8_far
s_branch Lf8_amXb2
Lf8_amY2:
zaq 17,9,6
zaq 18,11,6
zbu 19,13
zbu 20,15
s_call_b64 s[88:89], Lf8_four
Lf8_amXb2:
ze 0
zf 224,136,64
zd 76,88
zd 77,89
zd 78,90
zf 224,160,68
zd 79,91
zd 80,92
zd 81,93
zf 224,184,72
zd 82,94
zd 83,95
zd 84,96
zf 228,140,64
zd 85,97
zd 86,98
zd 87,99
zf 228,164,68
zn 38,3072
z6 0x1000
zag 0x1000
z0 39
zf 228,188,72
zn 49,1024
zn 38,2048
za 32,144,64
z3 41,33
z3 40,32
z4 43,33,41
za 32,168,68
z4 42,32,40
zax 43
z5 32,42
za 32,192,72
z5 33,43
zbg 36,40,45
zay 37,41,46
za 36,148,64
zw 34,32,33
zaz 32,43
za0 33,42
za 36,172,68
zw 35,42,43
za1 37,41
za2 37,47
za 36,196,72
za3 32,33
zas 33
za 40,152,64
za4 37,36
zq 34,35
za 40,176,68
zq 32,33
za5 33,48
za 40,200,72
zca 36,40
zcb 35
za 44,156,64
za6 10,37
z8 14,34,7
z8 16,32,7
za 44,180,68
zcc
zau 12,33,10
zcd
zce
za 44,204,72
s_branch Lf8_amH3
Lf8_amG3:
zdt
s_cbranch_scc0 Lf8_amGb3
s_branch Lf8_amS3
Lf8_amD3:
zdt
s_cbranch_scc0 Lf8_amRb3
Lf8_amS3:
ze1
s_cbranch_scc0 Lf8_amY3
zfe
zap 0x15e00
zao
s_call_b64 s[88:89], Lf8_far
s_branch Lf8_amXb3
Lf8_amY3:
zaa 17,10,6
zaa 18,12,6
za8 19,14
za8 20,16
s_call_b64 s[88:89], Lf8_four
Lf8_amXb3:
ze 0
zf 232,136,76
zd 64,88
zd 65,89
zf 232,160,80
zd 66,90
zd 67,91
zf 232,184,84
zd 68,92
zd 69,93
zf 236,140,76
zd 70,94
zd 71,95
zf 236,164,80
zd 72,96
zd 73,97
zf 236,188,84
zd 74,98
zd 75,99
za 48,144,76
zn 39,3072
za 48,168,80
z6 0x2000
zag 0x2000
z0 49
za 48,192,84
zn 38,1024
za 52,148,76
za 52,172,80
za 52,196,84
za 56,152,76
za 56,176,80
za 56,200,84
za 60,156,76
za 60,180,80
za 60,204,84
s_branch Lf8_amH4
Lf8_amG4:
zc2
s_cbranch_scc0 Lf8_amGb4
s_branch Lf8_amS4
Lf8_amD4:
zc2
s_cbranch_scc0 Lf8_amRb4
Lf8_amS4:
ze0
s_cbranch_scc0 Lf8_amY4
zfs
zap 0x1b580
zao
s_call_b64 s[88:89], Lf8_far
s_branch Lf8_amXb4
Lf8_amY4:
zac 17,10,6
zac 18,12,6
za9 19,14
za9 20,16
s_call_b64 s[88:89], Lf8_four
Lf8_amXb4:
ze 0
zf 240,136,64
zd 76,88
zd 77,89
zf 240,160,68
zd 78,90
zd 79,91
zf 240,184,72
zd 80,92
zd 81,93
zf 244,140,64
zd 82,94
zd 83,95
zf 244,164,68
zd 84,96
zd 85,97
zf 244,188,72
zd 86,98
zd 87,99
z7 64,144
zn 39,2048
za 64,168,68
zn 49,3072
za 64,192,72
z6 0x3000
zag 0x3000
z0 38
za 68,148,64
zn 39,1024
z7 68,172
zx 32,54
zr 33,54
za 68,196,72
zd 54,55
zd 55,56
za 72,152,64
zd 56,57
zdx 34,44
za 72,176,68
zcj 35,29
z2 34
z7 72,200
z2 35
zg 32,34
za 76,156,64
zg 33,35
za 76,180,68
za 76,204,72
s_branch Lf8_amH5
Lf8_amG5:
zey
s_cbranch_scc0 Lf8_amGb5
s_branch Lf8_amS5
Lf8_amD5:
zey
s_cbranch_scc0 Lf8_amRb5
Lf8_amS5:
zft
s_cbranch_scc0 Lf8_amY5
zfu
zap 0x20d00
zao
s_call_b64 s[88:89], Lf8_far
s_branch Lf8_amXb5
Lf8_amY5:
zaj 17,10,6
zaj 18,12,6
zbm 19,14
zbm 20,16
s_call_b64 s[88:89], Lf8_four
Lf8_amXb5:
ze 0
zf 248,136,76
zd 64,88
zd 65,89
zf 248,160,80
zd 66,90
zd 67,91
zf 248,184,84
zd 68,92
zd 69,93
zf 252,140,76
zd 70,94
zd 71,95
zf 252,164,80
zd 72,96
zd 73,97
zf 252,188,84
zd 74,98
zd 75,99
za 80,144,76
zn 49,2048
z7 80,168
zn 38,3072
za 80,192,84
z6 0x4000
zag 0x4000
z0 39
za 84,148,76
zn 49,1024
za 84,172,80
zs 34
zs 35
z7 84,196
zs 32
zs 33
za 88,152,76
zq 34,35
zq 32,33
za 88,176,80
zr 33,32
zav 32,34
za 88,200,84
zaw 32
z3 41,33
za 92,156,76
z3 40,32
z4 43,33,41
za 92,180,80
z4 42,32,40
za 92,204,84
s_branch Lf8_amH6
Lf8_amG6:
zez
s_cbranch_scc0 Lf8_amGb6
s_branch Lf8_amS6
Lf8_amD6:
zez
s_cbranch_scc0 Lf8_amRb6
Lf8_amS6:
zfv
s_cbranch_scc0 Lf8_amY6
zfw
zap 0x26480
zao
s_call_b64 s[88:89], Lf8_far
s_branch Lf8_amXb6
Lf8_amY6:
zaq 17,10,6
zaq 18,12,6
zbu 19,14
zbu 20,16
s_call_b64 s[88:89], Lf8_four
Lf8_amXb6:
ze 0
za 96,136,64
zd 76,88
zd 77,89
zd 78,90
za 96,160,68
zd 79,91
zd 80,92
za 96,184,72
zd 81,93
zd 82,94
za 100,140,64
zd 83,95
zd 84,96
za 100,164,68
zd 85,97
zd 86,98
za 100,188,72
zd 87,99
zax 43
za 104,144,64
z5 32,42
z5 33,43
za 104,168,68
zbg 36,40,45
zay 37,41,46
za 104,192,72
zw 34,32,33
zaz 32,43
za 108,148,64
za0 33,42
zw 35,42,43
za 108,172,68
za1 37,41
za2 37,47
za 108,196,72
za3 32,33
zas 33
za 112,152,64
za4 37,36
zq 34,35
za 112,176,68
zq 32,33
za5 33,48
za 112,200,72
zdf 36,40
zdg 35
za 116,156,64
za6 9,37
z8 13,34,7
z8 15,32,7
za 116,180,68
zdh
zau 11,33,9
zdi
zdj
za 116,204,72
s_branch Lf8_amH7
Lf8_amG7:
zct
s_cbranch_scc0 Lf8_amGb7
s_branch Lf8_amS7
Lf8_amD7:
zct
s_cbranch_scc0 Lf8_amRb7
Lf8_amS7:
zdz
s_cbranch_scc0 Lf8_amY7
zet
zeu
zev
s_call_b64 s[88:89], Lf8_far
s_branch Lf8_amXb7
Lf8_amY7:
zaa 17,9,6
zaa 18,11,6
za8 19,13
za8 20,15
s_call_b64 s[88:89], Lf8_four
Lf8_amXb7:
ze 0
za 120,136,76
zbn
zbq 8,0
zd 64,88
zd 65,89
za 124,140,76
zbo
zd 66,90
zd 67,91
zd 68,92
za 128,144,76
zbp
zd 69,93
zd 70,94
zd 71,95
za 132,148,76
zf5
zd 72,96
zd 73,97
za 136,152,76
zd 74,98
zd 75,99
za 140,156,76
zu 12
zo 136,1
zb 138,1,1536
za 120,160,80
zo 140,2
zb 142,2,1536
za 124,164,80
zb 144,1,64
zb 146,1,1600
za 128,168,80
zb 148,2,64
zb 150,2,1600
za 132,172,80
zb 152,1,128
zb 154,1,1664
za 136,176,80
zb 156,2,128
zb 158,2,1664
za 140,180,80
zu 6
zb 160,1,6144
zb 162,1,7680
za 120,184,84
zb 164,2,6144
zb 166,2,7680
za 124,188,84
zb 168,1,6208
zb 170,1,7744
za 128,192,84
zb 172,2,6208
zb 174,2,7744
za 132,196,84
zb 176,1,6272
zb 178,1,7808
za 136,200,84
zb 180,2,6272
zb 182,2,7808
za 140,204,84
s_branch Lf8_amE2
Lf8_azG0:
zd6
s_cbranch_scc0 Lf8_azGb0
s_branch Lf8_azS0
Lf8_azD0:
zd6
s_cbranch_scc0 Lf8_azRb0
Lf8_azS0:
ze8
s_cbranch_scc0 Lf8_azY0
ze9
zap 0x5780
zao
s_call_b64 s[88:89], Lf8_far
s_branch Lf8_azXb0
Lf8_azY0:
zac 17,9,6
zac 18,11,6
za9 19,13
za9 20,15
s_call_b64 s[88:89], Lf8_four
Lf8_azXb0:
zd 76,88
zd 77,89
zd 78,90
zd 79,91
ze 15
za 0,144,64
zd 80,92
zd 81,93
zd 82,94
zd 83,95
zd 84,96
za 4,148,64
zu 0
zb 192,1,12352
zb 194,1,13888
zd 85,97
zd 86,98
zd 87,99
ze 10
za 8,152,64
zb 196,2,12352
zb 198,2,13888
zb 200,1,12416
zb 202,1,13952
zb 204,2,12416
za 12,156,64
zb 206,2,13952
zb 184,1,12288
zb 186,1,13824
zb 188,2,12288
zb 190,2,13824
zf 208,136,64
zx 32,59
zr 33,59
zci 34,44
zbs 35,29
zf 212,140,64
ze 12
z2 34
z2 35
zg 32,34
zg 33,35
za 0,168,68
zs 34
zs 35
zs 32
zs 33
za 4,172,68
zq 34,35
zq 32,33
zr 33,32
zav 32,34
za 8,176,68
zaw 32
z3 41,33
z3 40,32
z4 43,33,41
za 12,180,68
z4 42,32,40
zax 43
z5 32,42
z5 33,43
zf 208,160,68
zbg 36,40,45
zay 37,41,46
zw 34,32,33
zaz 32,43
zf 212,164,68
ze 0
za0 33,42
zw 35,42,43
za1 37,41
za2 37,47
za 0,192,72
za3 32,33
zas 33
za4 37,36
zq 34,35
za 4,196,72
zq 32,33
za5 33,48
zca 36,40
zcb 35
za 8,200,72
zk 0,21,2048
za 12,204,72
zv
zk 4,21,3072
za6 10,37
zf 208,184,72
z8 14,34,7
z8 16,32,7
zcc
zau 12,33,10
zcd
zf 212,188,72
zce
s_branch Lf8_azH1
Lf8_azG1:
zd7
s_cbranch_scc0 Lf8_azGb1
s_branch Lf8_azS1
Lf8_azD1:
zd7
s_cbranch_scc0 Lf8_azRb1
Lf8_azS1:
zfa
s_cbranch_scc0 Lf8_azY1
zfb
zap 0xaf00
zao
s_call_b64 s[88:89], Lf8_far
s_branch Lf8_azXb1
Lf8_azY1:
zaj 17,9,6
zaj 18,11,6
zbm 19,13
zbm 20,15
s_call_b64 s[88:89], Lf8_four
Lf8_azXb1:
zd 64,88
zd 65,89
zd 66,90
zd 67,91
za 16,144,76
zfo 0xffff0000
zd 68,92
zd 69,93
zd 70,94
za 16,168,80
zf6 0xffff0000
zd 71,95
zd 72,96
zd 73,97
za 16,192,84
zk 8,21,4096
zd 74,98
zd 75,99
za 20,148,76
zk 12,21,5120
za 20,172,80
zam
zk 16,21,8192
za 20,196,84
za 24,152,76
za 24,176,80
ze 1
s_barrier
za7 28,24
za 24,200,84
za7 32,25
za7 36,26
za 28,156,76
zk 20,21,9216
za 28,180,80
zb0
zk 24,21,10240
za 28,204,84
zl 40,24,1024
zl 44,25,1024
zf 216,136,76
zl 48,26,1024
zf 216,160,80
zf 216,184,84
zf 220,140,76
zv
zk 28,21,11264
zf 220,164,80
zf 220,188,84
s_branch Lf8_azH2
Lf8_azG2:
zd8
s_cbranch_scc0 Lf8_azGb2
s_branch Lf8_azS2
Lf8_azD2:
zd8
s_cbranch_scc0 Lf8_azRb2
Lf8_azS2:
zfc
s_cbranch_scc0 Lf8_azY2
zfd
zap 0x10680
zao
s_call_b64 s[88:89], Lf8_far
s_branch Lf8_azXb2
Lf8_azY2:
zaq 17,9,6
zaq 18,11,6
zbu 19,13
zbu 20,15
s_call_b64 s[88:89], Lf8_four
Lf8_azXb2:
zd 76,88
zd 77,89
zd 78,90
zd 79,91
za 32,144,64
zd 80,92
zd 81,93
zd 82,94
zd 83,95
za 32,168,68
zd 84,96
zd 85,97
zd 86,98
zd 87,99
za 32,192,72
ze 2
zm 32,28
zg 36,208
zm 33,29
zg 37,209
za 36,148,64
zm 34,30
zg 38,210
zm 35,31
zg 39,211
za 36,172,68
zk 32,21,14336
za 36,196,72
zg 32,36
zg 33,37
zg 34,38
zg 35,39
za 40,152,64
ze 1
s_barrier
zl 28,24,6144
zc 36,32,33
zc 37,34,35
za 40,176,68
zk 36,21,15360
za 40,200,72
zl 32,25,6144
zm 44,40
zg 48,212
zm 45,41
za 44,156,64
zg 49,213
zm 46,42
zg 50,214
zm 47,43
za 44,180,68
zk 40,21,16384
za 44,204,72
zl 40,24,7168
zg 51,215
zg 44,48
zg 45,49
zf 224,136,64
zg 46,50
zg 47,51
zc 48,44,45
zc 49,46,47
zf 224,160,68
zk 44,21,17408
zf 224,184,72
zl 44,25,7168
zah 38,48,36
zah 39,49,37
zai 36,48
zf 228,140,64
zai 37,49
zf 228,164,68
zfn
zbf 36,22
zl 48,26,7168
zl 36,26,6144
zf 228,188,72
s_branch Lf8_azH3
Lf8_azG3:
zdt
s_cbranch_scc0 Lf8_azGb3
s_branch Lf8_azS3
Lf8_azD3:
zdt
s_cbranch_scc0 Lf8_azRb3
Lf8_azS3:
ze1
s_cbranch_scc0 Lf8_azY3
zfe
zap 0x15e00
zao
s_call_b64 s[88:89], Lf8_far
s_branch Lf8_azXb3
Lf8_azY3:
zaa 17,10,6
zaa 18,12,6
za8 19,14
za8 20,16
s_call_b64 s[88:89], Lf8_four
Lf8_azXb3:
zd 64,88
zd 65,89
zd 66,90
zd 67,91
ze 6
za 48,144,76
zd 68,92
zd 69,93
zd 70,94
zd 71,95
za 48,168,80
zd 72,96
zd 73,97
zd 74,98
zd 75,99
za 48,192,84
zm 32,28
ze 0
zg 36,216
zm 33,29
zg 37,217
za 52,148,76
zm 34,30
zg 38,218
zm 35,31
zg 39,219
za 52,172,80
zk 48,21,2048
za 52,196,84
zg 32,36
zg 33,37
zg 34,38
zg 35,39
za 56,152,76
s_barrier
zl 28,24,12288
zc 36,32,33
zc 37,34,35
za 56,176,80
zk 52,21,3072
za 56,200,84
zl 32,25,12288
zm 44,40
zg 48,220
zm 45,41
za 60,156,76
zg 49,221
zm 46,42
zg 50,222
zm 47,43
za 60,180,80
zk 56,21,4096
za 60,204,84
zl 40,24,13312
zg 51,223
zg 44,48
zg 45,49
zf 232,136,76
zg 46,50
zg 47,51
zc 48,44,45
zc 49,46,47
zf 232,160,80
zk 60,21,5120
zf 232,184,84
zl 44,25,13312
zah 38,48,36
zah 39,49,37
zai 36,48
zf 236,140,76
zai 37,49
zf 236,164,80
zbh 0xa800
zbf 36,22
zl 48,26,13312
zl 36,26,12288
zf 236,188,84
s_branch Lf8_azH4
Lf8_azG4:
zc2
s_cbranch_scc0 Lf8_azGb4
s_branch Lf8_azS4
Lf8_azD4:
zc2
s_cbranch_scc0 Lf8_azRb4
Lf8_azS4:
ze0
s_cbranch_scc0 Lf8_azY4
zfs
zap 0x1b580
zao
s_call_b64 s[88:89], Lf8_far
s_branch Lf8_azXb4
Lf8_azY4:
zac 17,10,6
zac 18,12,6
za9 19,14
za9 20,16
s_call_b64 s[88:89], Lf8_four
Lf8_azXb4:
zd 76,88
zd 77,89
zd 78,90
zd 79,91
ze 6
z7 64,144
zd 80,92
zd 81,93
zd 82,94
zd 83,95
za 64,168,68
zd 84,96
zd 85,97
zd 86,98
zd 87,99
za 64,192,72
zm 32,28
ze 0
zg 36,224
zm 33,29
zg 37,225
za 68,148,64
zm 34,30
zg 38,226
zm 35,31
zg 39,227
z7 68,172
zk 64,21,8192
za 68,196,72
zg 32,36
zg 33,37
zg 34,38
zg 35,39
za 72,152,64
s_barrier
za7 28,24
zc 36,32,33
zc 37,34,35
za 72,176,68
zk 68,21,9216
z7 72,200
za7 32,25
zm 44,40
zg 48,228
zm 45,41
za 76,156,64
zg 49,229
zm 46,42
zg 50,230
zm 47,43
za 76,180,68
zk 72,21,10240
za 76,204,72
zl 40,24,1024
zg 51,231
zg 44,48
zg 45,49
zf 240,136,64
zg 46,50
zg 47,51
zc 48,44,45
zc 49,46,47
zf 240,160,68
zk 76,21,11264
zf 240,184,72
zl 44,25,1024
zah 38,48,36
zah 39,49,37
zai 36,48
zf 244,140,64
zai 37,49
zf 244,164,68
zbh 0x15000
zbf 36,22
zl 48,26,1024
za7 36,26
zf 244,188,72
s_branch Lf8_azH5
Lf8_azG5:
zey
s_cbranch_scc0 Lf8_azGb5
s_branch Lf8_azS5
Lf8_azD5:
zey
s_cbranch_scc0 Lf8_azRb5
Lf8_azS5:
zft
s_cbranch_scc0 Lf8_azY5
zfu
zap 0x20d00
zao
s_call_b64 s[88:89], Lf8_far
s_branch Lf8_azXb5
Lf8_azY5:
zaj 17,10,6
zaj 18,12,6
zbm 19,14
zbm 20,16
s_call_b64 s[88:89], Lf8_four
Lf8_azXb5:
zd 64,88
zd 65,89
zd 66,90
zd 67,91
ze 6
za 80,144,76
zd 68,92
zd 69,93
zd 70,94
zd 71,95
z7 80,168
zd 72,96
zd 73,97
zd 74,98
zd 75,99
za 80,192,84
zm 32,28
ze 0
zg 36,232
zm 33,29
zg 37,233
za 84,148,76
zm 34,30
zg 38,234
zm 35,31
zg 39,235
za 84,172,80
zk 80,21,14336
z7 84,196
zg 32,36
zg 33,37
zg 34,38
zg 35,39
za 88,152,76
s_barrier
zl 28,24,6144
zc 36,32,33
zc 37,34,35
za 88,176,80
zk 84,21,15360
za 88,200,84
zl 32,25,6144
zm 44,40
zg 48,236
zm 45,41
za 92,156,76
zg 49,237
zm 46,42
zg 50,238
zm 47,43
za 92,180,80
zk 88,21,16384
za 92,204,84
zl 40,24,7168
zg 51,239
zg 44,48
zg 45,49
zf 248,136,76
zg 46,50
zg 47,51
zc 48,44,45
zc 49,46,47
zf 248,160,80
zk 92,21,17408
zf 248,184,84
zl 44,25,7168
zah 38,48,36
zah 39,49,37
zai 36,48
zf 252,140,76
zai 37,49
zf 252,164,80
zbh 0x1f800
zbf 36,22
zl 48,26,7168
zl 36,26,6144
zf 252,188,84
s_branch Lf8_azH6
Lf8_azG6:
zez
s_cbranch_scc0 Lf8_azGb6
s_branch Lf8_azS6
Lf8_azD6:
zez
s_cbranch_scc0 Lf8_azRb6
Lf8_azS6:
zfv
s_cbranch_scc0 Lf8_azY6
zfw
zap 0x26480
zao
s_call_b64 s[88:89], Lf8_far
s_branch Lf8_azXb6
Lf8_azY6:
zaq 17,10,6
zaq 18,12,6
zbu 19,14
zbu 20,16
s_call_b64 s[88:89], Lf8_four
Lf8_azXb6:
zd 76,88
zd 77,89
zd 78,90
zd 79,91
ze 6
za 104,144,64
zd 80,92
zd 81,93
zd 82,94
zd 83,95
za 104,168,68
zd 84,96
zd 85,97
zd 86,98
zd 87,99
za 104,192,72
zm 32,28
ze 0
zg 36,240
zm 33,29
zg 37,241
za 108,148,64
zm 34,30
zg 38,242
zm 35,31
zg 39,243
za 108,172,68
zk 104,21,2048
za 108,196,72
zg 32,36
zg 33,37
zg 34,38
zg 35,39
za 112,152,64
s_barrier
zl 28,24,12288
zc 36,32,33
zc 37,34,35
za 112,176,68
zk 108,21,3072
za 112,200,72
zl 32,25,12288
zm 44,40
zg 48,244
zm 45,41
za 116,156,64
zg 49,245
zm 46,42
zg 50,246
zm 47,43
za 116,180,68
zk 112,21,4096
za 116,204,72
zl 40,24,13312
zg 51,247
zg 44,48
zg 45,49
za 96,136,64
zg 46,50
zg 47,51
zc 48,44,45
zc 49,46,47
za 96,160,68
zk 116,21,5120
za 96,184,72
zl 44,25,13312
zah 38,48,36
zah 39,49,37
zai 36,48
za 100,140,64
zai 37,49
za 100,164,68
zbh 0x2a000
zbf 36,22
zl 48,26,13312
zl 36,26,12288
za 100,188,72
s_branch Lf8_azH7
Lf8_ayG0:
zd6
s_cbranch_scc0 Lf8_ayGb0
s_branch Lf8_ayS0
Lf8_ayD0:
zd6
s_cbranch_scc0 Lf8_ayRb0
Lf8_ayS0:
ze8
s_cbranch_scc0 Lf8_ayY0
ze9
zap 0x5780
zao
s_call_b64 s[88:89], Lf8_far
s_branch Lf8_ayXb0
Lf8_ayY0:
zac 17,9,6
zac 18,11,6
za9 19,13
za9 20,15
s_call_b64 s[88:89], Lf8_four
Lf8_ayXb0:
zd 76,88
zd 77,89
zd 78,90
zd 79,91
ze 15
za 0,144,64
zd 80,92
zd 81,93
zd 82,94
zd 83,95
zd 84,96
za 4,148,64
zu 0
zb 192,1,12352
zb 194,1,13888
zd 85,97
zd 86,98
zd 87,99
ze 10
za 8,152,64
zb 196,2,12352
zb 198,2,13888
zb 200,1,12416
zb 202,1,13952
zb 204,2,12416
za 12,156,64
zb 206,2,13952
zb 184,1,12288
zb 186,1,13824
zb 188,2,12288
zb 190,2,13824
zf 208,136,64
zx 32,59
zr 33,59
zci 34,44
zbs 35,29
zf 212,140,64
ze 12
z2 34
z2 35
zg 32,34
zg 33,35
za 0,168,68
zs 34
zs 35
zs 32
zs 33
za 4,172,68
zq 34,35
zq 32,33
zr 33,32
zav 32,34
za 8,176,68
zaw 32
z3 41,33
z3 40,32
z4 43,33,41
za 12,180,68
z4 42,32,40
zax 43
z5 32,42
z5 33,43
zf 208,160,68
zbg 36,40,45
zay 37,41,46
zw 34,32,33
zaz 32,43
zf 212,164,68
ze 0
za0 33,42
zw 35,42,43
za1 37,41
za2 37,47
za 0,192,72
za3 32,33
zas 33
za4 37,36
zq 34,35
za 4,196,72
zq 32,33
za5 33,48
zca 36,40
zcb 35
za 8,200,72
zk 0,21,2048
za 12,204,72
zv
zk 4,21,3072
za6 10,37
zf 208,184,72
z8 14,34,7
z8 16,32,7
zcc
zau 12,33,10
zcd
zf 212,188,72
zce
s_branch Lf8_ayH1
Lf8_ayG1:
zd7
s_cbranch_scc0 Lf8_ayGb1
s_branch Lf8_ayS1
Lf8_ayD1:
zd7
s_cbranch_scc0 Lf8_ayRb1
Lf8_ayS1:
zfa
s_cbranch_scc0 Lf8_ayY1
zfb
zap 0xaf00
zao
s_call_b64 s[88:89], Lf8_far
s_branch Lf8_ayXb1
Lf8_ayY1:
zaj 17,9,6
zaj 18,11,6
zbm 19,13
zbm 20,15
s_call_b64 s[88:89], Lf8_four
Lf8_ayXb1:
zd 64,88
zd 65,89
zd 66,90
zd 67,91
za 16,144,76
zd 68,92
zd 69,93
zd 70,94
za 16,168,80
zd 71,95
zd 72,96
zd 73,97
za 16,192,84
zk 8,21,4096
zd 74,98
zd 75,99
za 20,148,76
zk 12,21,5120
za 20,172,80
zdl 208,21
za 20,196,84
zat 212,21,1024
za 24,152,76
zk 16,21,8192
za 24,176,80
zbl
zk 20,21,9216
za 24,200,84
ze 2
s_barrier
za 28,156,76
za 28,180,80
za 28,204,84
zf 216,136,76
zam
zk 24,21,10240
zf 216,160,80
zb0
zk 28,21,11264
zf 216,184,84
zf 220,140,76
zf 220,164,80
zf 220,188,84
zcr
zat 216,21,6144
s_branch Lf8_ayH2
Lf8_ayG2:
zd8
s_cbranch_scc0 Lf8_ayGb2
s_branch Lf8_ayS2
Lf8_ayD2:
zd8
s_cbranch_scc0 Lf8_ayRb2
Lf8_ayS2:
zfc
s_cbranch_scc0 Lf8_ayY2
zfd
zap 0x10680
zao
s_call_b64 s[88:89], Lf8_far
s_branch Lf8_ayXb2
Lf8_ayY2:
zaq 17,9,6
zaq 18,11,6
zbu 19,13
zbu 20,15
s_call_b64 s[88:89], Lf8_four
Lf8_ayXb2:
zd 76,88
zd 77,89
zd 78,90
zd 79,91
za 32,144,64
zd 80,92
zd 81,93
za 32,168,68
zd 82,94
zd 83,95
za 32,192,72
zd 84,96
zd 85,97
za 36,148,64
zd 86,98
zd 87,99
za 36,172,68
zat 220,21,7168
za 36,196,72
zk 32,21,14336
za 40,152,64
za 40,176,68
za 40,200,72
ze 1
s_barrier
zam
zk 36,21,15360
za 44,156,64
za 44,180,68
za 44,204,72
zk 40,21,16384
zf 224,136,64
zf 224,160,68
zf 224,184,72
zbl
zk 44,21,17408
zf 228,140,64
zf 228,164,68
zf 228,188,72
zat 224,21,12288
s_branch Lf8_ayH3
Lf8_ayG3:
zdt
s_cbranch_scc0 Lf8_ayGb3
s_branch Lf8_ayS3
Lf8_ayD3:
zdt
s_cbranch_scc0 Lf8_ayRb3
Lf8_ayS3:
ze1
s_cbranch_scc0 Lf8_ayY3
zfe
zap 0x15e00
zao
s_call_b64 s[88:89], Lf8_far
s_branch Lf8_ayXb3
Lf8_ayY3:
zaa 17,10,6
zaa 18,12,6
za8 19,14
za8 20,16
s_call_b64 s[88:89], Lf8_four
Lf8_ayXb3:
zd 64,88
zd 65,89
zd 66,90
zd 67,91
za 48,144,76
zd 68,92
zd 69,93
za 48,168,80
zd 70,94
zd 71,95
za 48,192,84
zd 72,96
zd 73,97
za 52,148,76
zd 74,98
zd 75,99
za 52,172,80
zat 228,21,13312
za 52,196,84
zk 48,21,2048
za 56,152,76
za 56,176,80
za 56,200,84
ze 1
s_barrier
zam
zk 52,21,3072
za 60,156,76
za 60,180,80
za 60,204,84
zk 56,21,4096
zf 232,136,76
zf 232,160,80
zf 232,184,84
zbl
zk 60,21,5120
zf 236,140,76
zf 236,164,80
zf 236,188,84
zdl 232,21
s_branch Lf8_ayH4
Lf8_ayG4:
zc2
s_cbranch_scc0 Lf8_ayGb4
s_branch Lf8_ayS4
Lf8_ayD4:
zc2
s_cbranch_scc0 Lf8_ayRb4
Lf8_ayS4:
ze0
s_cbranch_scc0 Lf8_ayY4
zfs
zap 0x1b580
zao
s_call_b64 s[88:89], Lf8_far
s_branch Lf8_ayXb4
Lf8_ayY4:
zac 17,10,6
zac 18,12,6
za9 19,14
za9 20,16
s_call_b64 s[88:89], Lf8_four
Lf8_ayXb4:
zd 76,88
zd 77,89
zd 78,90
zd 79,91
z7 64,144
zd 80,92
zd 81,93
za 64,168,68
zd 82,94
zd 83,95
za 64,192,72
zd 84,96
zd 85,97
za 68,148,64
zd 86,98
zd 87,99
z7 68,172
zat 236,21,1024
za 68,196,72
zk 64,21,8192
za 72,152,64
za 72,176,68
z7 72,200
ze 1
s_barrier
zam
zk 68,21,9216
za 76,156,64
za 76,180,68
za 76,204,72
zk 72,21,10240
zf 240,136,64
zf 240,160,68
zf 240,184,72
zbl
zk 76,21,11264
zf 244,140,64
zf 244,164,68
zf 244,188,72
zat 240,21,6144
s_branch Lf8_ayH5
Lf8_ayG5:
zey
s_cbranch_scc0 Lf8_ayGb5
s_branch Lf8_ayS5
Lf8_ayD5:
zey
s_cbranch_scc0 Lf8_ayRb5
Lf8_ayS5:
zft
s_cbranch_scc0 Lf8_ayY5
zfu
zap 0x20d00
zao
s_call_b64 s[88:89], Lf8_far
s_branch Lf8_ayXb5
Lf8_ayY5:
zaj 17,10,6
zaj 18,12,6
zbm 19,14
zbm 20,16
s_call_b64 s[88:89], Lf8_four
Lf8_ayXb5:
zd 64,88
zd 65,89
zd 66,90
zd 67,91
za 80,144,76
zd 68,92
zd 69,93
z7 80,168
zd 70,94
zd 71,95
za 80,192,84
zd 72,96
zd 73,97
za 84,148,76
zd 74,98
zd 75,99
za 84,172,80
zat 244,21,7168
z7 84,196
zk 80,21,14336
za 88,152,76
za 88,176,80
za 88,200,84
ze 1
s_barrier
zam
zk 84,21,15360
za 92,156,76
za 92,180,80
za 92,204,84
zk 88,21,16384
zf 248,136,76
zf 248,160,80
zf 248,184,84
zbl
zk 92,21,17408
zf 252,140,76
zf 252,164,80
zf 252,188,84
zat 248,21,12288
s_branch Lf8_ayH6
Lf8_ayG6:
zez
s_cbranch_scc0 Lf8_ayGb6
s_branch Lf8_ayS6
Lf8_ayD6:
zez
s_cbranch_scc0 Lf8_ayRb6
Lf8_ayS6:
zfv
s_cbranch_scc0 Lf8_ayY6
zfw
zap 0x26480
zao
s_call_b64 s[88:89], Lf8_far
s_branch Lf8_ayXb6
Lf8_ayY6:
zaq 17,10,6
zaq 18,12,6
zbu 19,14
zbu 20,16
s_call_b64 s[88:89], Lf8_four
Lf8_ayXb6:
zd 76,88
zd 77,89
zd 78,90
zd 79,91
za 104,144,64
zd 80,92
zd 81,93
za 104,168,68
zd 82,94
zd 83,95
za 104,192,72
zd 84,96
zd 85,97
za 108,148,64
zd 86,98
zd 87,99
za 108,172,68
zat 252,21,13312
za 108,196,72
zk 104,21,2048
za 112,152,64
za 112,176,68
za 112,200,72
ze 1
s_barrier
zam
zk 108,21,3072
za 116,156,64
za 116,180,68
za 116,204,72
zk 112,21,4096
za 96,136,64
za 96,160,68
za 96,184,72
zbl
zk 116,21,5120
za 100,140,64
za 100,164,68
za 100,188,72
zfr 96,21
s_branch Lf8_ayH7
Lf8_aqG0:
zct
s_cbranch_scc0 Lf8_aqGb0
s_branch Lf8_aqS0
Lf8_aqD0:
zct
s_cbranch_scc0 Lf8_aqRb0
Lf8_aqS0:
zdz
s_cbranch_scc0 Lf8_aqY0
s_add_u32 s90, s64, 0
s_add_u32 s91, s66, 0
zao
s_call_b64 s[88:89], Lf8_far
s_branch Lf8_aqXb0
Lf8_aqY0:
zaa 17,9,6
zaa 18,11,6
za8 19,13
za8 20,15
s_call_b64 s[88:89], Lf8_four
Lf8_aqXb0:
zd 64,88
zd 65,89
zd 66,90
zd 67,91
zd 68,92
zd 69,93
zd 70,94
zd 71,95
zd 72,96
zd 73,97
zd 74,98
zd 75,99
zu 13
zo 136,1
zb 138,1,1536
zo 140,2
zb 142,2,1536
zb 144,1,64
zb 146,1,1600
zb 148,2,64
zb 150,2,1600
zb 152,1,128
zb 154,1,1664
zb 156,2,128
zb 158,2,1664
zu 7
zb 160,1,6144
zb 162,1,7680
zb 164,2,6144
zb 166,2,7680
zb 168,1,6208
zb 170,1,7744
zb 172,2,6208
zb 174,2,7744
zb 176,1,6272
zb 178,1,7808
zb 180,2,6272
zb 182,2,7808
s_branch Lf8_aqE2
Lf8_atG0:
zd6
s_cbranch_scc0 Lf8_atGb0
s_branch Lf8_atS0
Lf8_atD0:
zd6
s_cbranch_scc0 Lf8_atRb0
Lf8_atS0:
ze8
s_cbranch_scc0 Lf8_atY0
ze9
zap 0x5780
zao
s_call_b64 s[88:89], Lf8_far
s_branch Lf8_atXb0
Lf8_atY0:
zac 17,9,6
zac 18,11,6
za9 19,13
za9 20,15
s_call_b64 s[88:89], Lf8_four
Lf8_atXb0:
ze 15
zh 208,136,64
zd 76,88
zd 77,89
zd 78,90
zh 212,140,64
zd 79,91
zd 80,92
zd 81,93
zp 0,144,64
zd 82,94
zd 83,95
zd 84,96
zp 4,148,64
ze 14
zd 85,97
zd 86,98
zd 87,99
zp 8,152,64
zu 1
zb 184,1,12288
zb 186,1,13824
zb 188,2,12288
ze 13
zp 12,156,64
zb 190,2,13824
zb 192,1,12352
zb 194,1,13888
zf 208,160,68
ze 8
zb 196,2,12352
zb 198,2,13888
zf 212,164,68
zb 200,1,12416
zb 202,1,13952
za 0,168,68
zb 204,2,12416
zb 206,2,13952
za 4,172,68
zf1
zcv
zcw 0xdf
zbt 0xa800
zdd 0x9000
za 8,176,68
zcx
zv
zae 21
ze 12
za 12,180,68
zan 0x400
zv
zae 22
ze 9
zf 208,184,72
zan 0x800
zv
zae 23
ze 4
zf 212,188,72
zan 0xc00
zv
zae 24
za 0,192,72
zcy 0x3fffffff
zan 0x1000
zv
zae 25
zcz
za 4,196,72
ze 0
za 8,200,72
za 12,204,72
s_branch Lf8_atH1
Lf8_atG1:
zd7
s_cbranch_scc0 Lf8_atGb1
s_branch Lf8_atS1
Lf8_atD1:
zd7
s_cbranch_scc0 Lf8_atRb1
Lf8_atS1:
zfa
s_cbranch_scc0 Lf8_atY1
zfb
zap 0xaf00
zao
s_call_b64 s[88:89], Lf8_far
s_branch Lf8_atXb1
Lf8_atY1:
zaj 17,9,6
zaj 18,11,6
zbm 19,13
zbm 20,15
s_call_b64 s[88:89], Lf8_four
Lf8_atXb1:
ze 0
zh 216,136,76
zd 64,88
zd 65,89
zd 66,90
zf 216,160,80
zd 67,91
zd 68,92
zd 69,93
zf 216,184,84
zd 70,94
zd 71,95
zd 72,96
zh 220,140,76
zd 73,97
zd 74,98
zd 75,99
zf 220,164,80
zgj
zcv
zcw 0xdf
zbt 0xa800
zdd 0xd800
zf 220,188,84
zbw
zgk
s_cselect_b32 s42, 0x22000, s42
zp 16,144,76
zcx
zv
zae 21
za 16,168,80
zan 0x400
zv
zae 22
za 16,192,84
zan 0x800
zv
zae 23
zp 20,148,76
zan 0xc00
zv
zae 24
za 20,172,80
zcy 0x3fffffff
zan 0x1000
zv
zae 25
zcz
za 20,196,84
zu 10
zf2 28,31
zx 32,58
zp 24,152,76
zr 33,58
zci 34,44
za 24,176,80
zbs 35,29
z2 34
za 24,200,84
z2 35
zg 32,34
zp 28,156,76
zbr 0x10000
zdw 1
zdw 2
za 28,180,80
za 28,204,84
s_branch Lf8_atH2
Lf8_atG2:
zd8
s_cbranch_scc0 Lf8_atGb2
s_branch Lf8_atS2
Lf8_atD2:
zd8
s_cbranch_scc0 Lf8_atRb2
Lf8_atS2:
zfc
s_cbranch_scc0 Lf8_atY2
zfd
zap 0x10680
zao
s_call_b64 s[88:89], Lf8_far
s_branch Lf8_atXb2
Lf8_atY2:
zaq 17,9,6
zaq 18,11,6
zbu 19,13
zbu 20,15
s_call_b64 s[88:89], Lf8_four
Lf8_atXb2:
ze 0
zh 224,136,64
zd 76,88
zd 77,89
zd 78,90
zd 79,91
zf 224,160,68
zd 80,92
zd 81,93
zd 82,94
zd 83,95
zf 224,184,72
zd 84,96
zd 85,97
zd 86,98
zd 87,99
zh 228,140,64
ze5
zc6 56,31,16
z6 0x3000
zc7 0x3000
z0 38
zf 228,164,68
zn 39,1024
zn 49,2048
zf 228,188,72
zn 38,3072
zg 33,35
zs 34
zp 32,144,64
zs 35
zs 32
zs 33
zq 34,35
za 32,168,68
zq 32,33
zr 33,32
zav 32,34
zaw 32
za 32,192,72
z3 41,33
z3 40,32
z4 43,33,41
z4 42,32,40
zp 36,148,64
zci 34,44
z2 34
zd1 35,45
zd2 34,35
za 36,172,68
zax 43
z5 32,42
z5 33,43
zd3 36,40,45,34
za 36,196,72
zay 37,41,46
zw 34,32,33
zaz 32,43
za0 33,42
zp 40,152,64
zw 35,42,43
za1 37,41
za2 37,47
za 40,176,68
za3 32,33
zas 33
za4 37,36
za 40,200,72
zq 34,35
zq 32,33
za5 33,48
zp 44,156,64
zca 36,40
zcb 35
za6 10,37
z8 14,34,7
za 44,180,68
z8 16,32,7
zcc
zau 12,33,10
zcd
za 44,204,72
zce
s_branch Lf8_atH3
Lf8_atG3:
zdt
s_cbranch_scc0 Lf8_atGb3
s_branch Lf8_atS3
Lf8_atD3:
zdt
s_cbranch_scc0 Lf8_atRb3
Lf8_atS3:
ze1
s_cbranch_scc0 Lf8_atY3
zfe
zap 0x15e00
zao
s_call_b64 s[88:89], Lf8_far
s_branch Lf8_atXb3
Lf8_atY3:
zaa 17,10,6
zaa 18,12,6
za8 19,14
za8 20,16
s_call_b64 s[88:89], Lf8_four
Lf8_atXb3:
ze 0
zh 232,136,76
zd 64,88
zd 65,89
zf 232,160,80
zd 66,90
zd 67,91
zf 232,184,84
zd 68,92
zd 69,93
zh 236,140,76
zd 70,94
zd 71,95
zf 236,164,80
zd 72,96
zd 73,97
zf 236,188,84
zd 74,98
zd 75,99
zp 48,144,76
zc8 0x15e00
zc6 62,31,16
z6 0x4000
zc7 0x4000
z0 39
za 48,168,80
zn 49,1024
za 48,192,84
zcg
zcu
z0 38
zp 52,148,76
zn 39,1024
za 52,172,80
zn 49,2048
za 52,196,84
zp 56,152,76
za 56,176,80
za 56,200,84
zp 60,156,76
za 60,180,80
za 60,204,84
s_branch Lf8_atH4
Lf8_atG4:
zc2
s_cbranch_scc0 Lf8_atGb4
s_branch Lf8_atS4
Lf8_atD4:
zc2
s_cbranch_scc0 Lf8_atRb4
Lf8_atS4:
ze0
s_cbranch_scc0 Lf8_atY4
zfs
zap 0x1b580
zao
s_call_b64 s[88:89], Lf8_far
s_branch Lf8_atXb4
Lf8_atY4:
zac 17,10,6
zac 18,12,6
za9 19,14
za9 20,16
s_call_b64 s[88:89], Lf8_four
Lf8_atXb4:
ze 0
zh 240,136,64
zd 76,88
zd 77,89
zd 78,90
zf 240,160,68
zd 79,91
zd 80,92
zd 81,93
zf 240,184,72
zd 82,94
zd 83,95
zd 84,96
zh 244,140,64
zd 85,97
zd 86,98
zd 87,99
zf 244,164,68
zn 38,3072
z6 0x1000
zag 0x1000
z0 39
zf 244,188,72
zn 49,1024
zex 64,144
zn 38,2048
za 64,168,68
zx 32,53
zr 33,53
za 64,192,72
zdx 34,44
zcj 35,29
zp 68,148,64
z2 34
z2 35
z7 68,172
zg 32,34
zg 33,35
za 68,196,72
zs 34
zs 35
zp 72,152,64
zs 32
zs 33
za 72,176,68
zq 34,35
zq 32,33
z7 72,200
zr 33,32
zav 32,34
zp 76,156,64
zaw 32
z3 41,33
za 76,180,68
z3 40,32
z4 43,33,41
za 76,204,72
s_branch Lf8_atH5
Lf8_atG5:
zey
s_cbranch_scc0 Lf8_atGb5
s_branch Lf8_atS5
Lf8_atD5:
zey
s_cbranch_scc0 Lf8_atRb5
Lf8_atS5:
zft
s_cbranch_scc0 Lf8_atY5
zfu
zap 0x20d00
zao
s_call_b64 s[88:89], Lf8_far
s_branch Lf8_atXb5
Lf8_atY5:
zaj 17,10,6
zaj 18,12,6
zbm 19,14
zbm 20,16
s_call_b64 s[88:89], Lf8_four
Lf8_atXb5:
ze 0
zh 248,136,76
zd 64,88
zd 65,89
zd 66,90
zf 248,160,80
zd 67,91
zd 68,92
zd 69,93
zf 248,184,84
zd 70,94
zd 71,95
zd 72,96
zh 252,140,76
zd 73,97
zd 74,98
zd 75,99
zf 252,164,80
zn 39,3072
z6 0x2000
zag 0x2000
z0 49
zf 252,188,84
zn 38,1024
zn 39,2048
zp 80,144,76
zn 49,3072
z4 42,32,40
z7 80,168
zax 43
z5 32,42
z5 33,43
za 80,192,84
zbg 36,40,45
zay 37,41,46
zw 34,32,33
zp 84,148,76
zaz 32,43
za0 33,42
za 84,172,80
zw 35,42,43
za1 37,41
z7 84,196
za2 37,47
za3 32,33
zp 88,152,76
zas 33
za4 37,36
za 88,176,80
zq 34,35
zq 32,33
za 88,200,84
za5 33,48
zdf 36,40
zp 92,156,76
zdg 35
za6 9,37
za 92,180,80
z8 13,34,7
z8 15,32,7
za 92,204,84
zdh
s_branch Lf8_atH6
Lf8_atG6:
zez
s_cbranch_scc0 Lf8_atGb6
s_branch Lf8_atS6
Lf8_atD6:
zez
s_cbranch_scc0 Lf8_atRb6
Lf8_atS6:
zfv
s_cbranch_scc0 Lf8_atY6
zfw
zap 0x26480
zao
s_call_b64 s[88:89], Lf8_far
s_branch Lf8_atXb6
Lf8_atY6:
zaq 17,10,6
zaq 18,12,6
zbu 19,14
zbu 20,16
s_call_b64 s[88:89], Lf8_four
Lf8_atXb6:
ze 0
zp 96,136,64
zd 76,88
zd 77,89
zd 78,90
zd 79,91
za 96,160,68
zd 80,92
zd 81,93
zd 82,94
zd 83,95
za 96,184,72
zd 84,96
zd 85,97
zd 86,98
zd 87,99
zp 100,140,64
zu 20
zau 11,33,9
zdi
zdj
zx 32,28
za 100,164,68
zr 33,28
zf3 34,44
ze2 35,29
z2 34
za 100,188,72
z2 35
zg 32,34
zg 33,35
zs 34
zp 104,144,64
zs 35
zs 32
zs 33
zq 34,35
za 104,168,68
zq 32,33
zr 33,32
zav 32,34
zaw 32
za 104,192,72
z3 41,33
z3 40,32
z4 43,33,41
zp 108,148,64
z4 42,32,40
zax 43
z5 32,42
za 108,172,68
z5 33,43
zbg 36,40,45
zay 37,41,46
za 108,196,72
zw 34,32,33
zaz 32,43
za0 33,42
zp 112,152,64
zw 35,42,43
za1 37,41
za2 37,47
za 112,176,68
za3 32,33
zas 33
za4 37,36
za 112,200,72
zq 34,35
zq 32,33
za5 33,48
zp 116,156,64
zca 36,40
zcb 35
za6 10,37
z8 14,34,7
za 116,180,68
z8 16,32,7
zcc
zau 12,33,10
zcd
za 116,204,72
zce
s_branch Lf8_atH7
Lf8_atG7:
zdt
s_cbranch_scc0 Lf8_atGb7
s_branch Lf8_atS7
Lf8_atD7:
zdt
s_cbranch_scc0 Lf8_atRb7
Lf8_atS7:
ze1
s_cbranch_scc0 Lf8_atY7
s_add_u32 s90, s78, 0
s_add_u32 s91, s79, 0
zdu
s_call_b64 s[88:89], Lf8_far
s_branch Lf8_atXb7
Lf8_atY7:
zaa 17,10,6
zaa 18,12,6
za8 19,14
za8 20,16
s_call_b64 s[88:89], Lf8_four
Lf8_atXb7:
ze 0
zp 120,136,76
zf4 8,0
zd 64,88
zd 65,89
zp 124,140,76
zd 66,90
zd 67,91
zd 68,92
zp 128,144,76
zd 69,93
zd 70,94
zd 71,95
zp 132,148,76
zd 72,96
zd 73,97
zp 136,152,76
zd 74,98
zd 75,99
zp 140,156,76
zb 136,1,12288
zb 138,1,13824
za 120,160,80
zb 140,2,12288
zb 142,2,13824
za 124,164,80
zb 144,1,12352
zb 146,1,13888
za 128,168,80
zb 148,2,12352
zb 150,2,13888
za 132,172,80
zb 152,1,12416
zb 154,1,13952
za 136,176,80
zb 156,2,12416
zb 158,2,13952
za 140,180,80
zb 160,1,30720
zb 162,1,32256
za 120,184,84
zb 164,2,30720
zb 166,2,32256
za 124,188,84
zb 168,1,30784
zb 170,1,32320
za 128,192,84
zb 172,2,30784
zb 174,2,32320
za 132,196,84
zb 176,1,30848
zb 178,1,32384
za 136,200,84
zb 180,2,30848
zb 182,2,32384
za 140,204,84
s_branch Lf8_atE2
Lf8_as0G0:
zc2
s_cbranch_scc0 Lf8_as0Gb0
s_branch Lf8_as0S0
Lf8_as0D0:
zc2
s_cbranch_scc0 Lf8_as0Rb0
Lf8_as0S0:
ze0
s_cbranch_scc0 Lf8_as0Y0
zfg
zec 0x5780
zdu
s_call_b64 s[88:89], Lf8_far
s_branch Lf8_as0Xb0
Lf8_as0Y0:
zac 17,10,6
zac 18,12,6
za9 19,14
za9 20,16
s_call_b64 s[88:89], Lf8_four
Lf8_as0Xb0:
ze 15
zf 208,136,64
zd 76,88
zd 77,89
zd 78,90
zd 79,91
zf 212,140,64
zd 80,92
zd 81,93
zd 82,94
zd 83,95
za 0,144,64
zd 84,96
zd 85,97
zd 86,98
za 4,148,64
ze 8
zb 192,1,49216
zb 194,1,50752
zd 87,99
za 8,152,64
zb 196,2,49216
zb 198,2,50752
zb 200,1,49280
za 12,156,64
ze 7
zb 202,1,50816
zb 204,2,49280
zb 206,2,50816
zf 208,176,68
ze 8
zb 184,1,49152
zb 186,1,50688
zb 188,2,49152
zb 190,2,50688
zf 212,180,68
zbr 0x10000
zbb 1
zbb 2
zb2 50
za 0,160,68
zb3 50
zbz 21,50
zbc 0x5800
zbw
zbd
za 4,164,68
ze 0
s_barrier
z6 0x3000
zag 0x3000
z0 38
za 8,168,68
zbe
zn 39,1024
zn 49,2048
za 12,172,68
zn 38,3072
z6 0x4000
zag 0x4000
z0 39
zf 208,192,72
zn 49,1024
zal 24,50
zf 212,196,72
zbc 0x9800
zby
zbd
zbe
za 0,200,72
zal 25,50
zb5
za 4,204,72
zb6 0x1d800
zal 26,50
zb7 50
zbv 22,4
za 8,184,72
zbk 22,50
zb8
za 12,188,72
zb9 22
s_branch Lf8_as0H1
Lf8_as0G1:
zct
s_cbranch_scc0 Lf8_as0Gb1
s_branch Lf8_as0S1
Lf8_as0D1:
zct
s_cbranch_scc0 Lf8_as0Rb1
Lf8_as0S1:
zdz
s_cbranch_scc0 Lf8_as0Y1
zet
zeu
zev
s_call_b64 s[88:89], Lf8_far
s_branch Lf8_as0Xb1
Lf8_as0Y1:
zaa 17,9,6
zaa 18,11,6
za8 19,13
za8 20,15
s_call_b64 s[88:89], Lf8_four
Lf8_as0Xb1:
ze 0
zf 216,136,76
zbn
zbq 8,0
zd 64,88
zd 65,89
zf 220,140,76
zbo
zd 66,90
zd 67,91
zd 68,92
za 16,144,76
zbp
zd 69,93
zd 70,94
zd 71,95
za 20,148,76
zd 72,96
zd 73,97
za 24,152,76
zd 74,98
zd 75,99
za 28,156,76
zu 12
zo 136,1
zb 138,1,1536
zf 216,176,80
zo 140,2
zb 142,2,1536
zf 220,180,80
zb 144,1,64
zb 146,1,1600
za 16,160,80
zb 148,2,64
zb 150,2,1600
za 20,164,80
zb 152,1,128
zb 154,1,1664
za 24,168,80
zb 156,2,128
zb 158,2,1664
za 28,172,80
zu 6
zb 160,1,6144
zb 162,1,7680
zf 216,192,84
zb 164,2,6144
zb 166,2,7680
zf 220,196,84
zb 168,1,6208
zb 170,1,7744
za 16,200,84
zb 172,2,6208
zb 174,2,7744
za 20,204,84
zb 176,1,6272
zb 178,1,7808
za 24,184,84
zb 180,2,6272
zb 182,2,7808
za 28,188,84
s_branch Lf8_as0E2
Lf8_as1G0:
zc2
s_cbranch_scc0 Lf8_as1Gb0
s_branch Lf8_as1S0
Lf8_as1D0:
zc2
s_cbranch_scc0 Lf8_as1Rb0
Lf8_as1S0:
ze0
s_cbranch_scc0 Lf8_as1Y0
zfg
zec 0x5780
zdu
s_call_b64 s[88:89], Lf8_far
s_branch Lf8_as1Xb0
Lf8_as1Y0:
zac 17,10,6
zac 18,12,6
za9 19,14
za9 20,16
s_call_b64 s[88:89], Lf8_four
Lf8_as1Xb0:
ze 15
zf 224,144,64
zd 76,88
zd 77,89
zd 78,90
zd 79,91
zf 228,148,64
ze 14
zd 80,92
zd 81,93
zd 82,94
zd 83,95
za 32,152,64
ze 11
zd 84,96
zd 85,97
zd 86,98
za 36,156,64
zb 200,1,49280
zb 202,1,50816
zd 87,99
za 40,136,64
zb 204,2,49280
zb 206,2,50816
zb 184,1,49152
za 44,140,64
ze 7
zb 186,1,50688
zb 188,2,49152
zb 190,2,50688
zf 224,160,68
zb 192,1,49216
zb 194,1,50752
zb 196,2,49216
zb 198,2,50752
zf 228,164,68
zbr 0x10000
zbb 1
zbb 2
zb2 50
za 32,168,68
zb3 50
zbz 21,50
zbc 0x5800
zbw
zbd
za 36,172,68
ze 0
s_barrier
z6 0x3000
zag 0x3000
z0 38
za 40,176,68
zbe
zn 39,1024
zn 49,2048
za 44,180,68
zn 38,3072
z6 0x4000
zag 0x4000
z0 39
zf 224,200,72
zn 49,1024
zal 24,50
zf 228,204,72
zbc 0x9800
zby
zbd
zbe
za 32,184,72
zal 25,50
zb5
za 36,188,72
zb6 0x1d800
zal 26,50
zb7 50
zbv 22,4
za 40,192,72
zbk 22,50
zb8
za 44,196,72
zb9 22
s_branch Lf8_as1H1
Lf8_as1G1:
zct
s_cbranch_scc0 Lf8_as1Gb1
s_branch Lf8_as1S1
Lf8_as1D1:
zct
s_cbranch_scc0 Lf8_as1Rb1
Lf8_as1S1:
zdz
s_cbranch_scc0 Lf8_as1Y1
zet
zeu
zev
s_call_b64 s[88:89], Lf8_far
s_branch Lf8_as1Xb1
Lf8_as1Y1:
zaa 17,9,6
zaa 18,11,6
za8 19,13
za8 20,15
s_call_b64 s[88:89], Lf8_four
Lf8_as1Xb1:
ze 0
zf 232,144,76
zbn
zbq 8,0
zd 64,88
zd 65,89
zf 236,148,76
zbo
zd 66,90
zd 67,91
zd 68,92
za 48,152,76
zbp
zd 69,93
zd 70,94
zd 71,95
za 52,156,76
zd 72,96
zd 73,97
za 56,136,76
zd 74,98
zd 75,99
za 60,140,76
zu 12
zo 136,1
zb 138,1,1536
zf 232,160,80
zo 140,2
zb 142,2,1536
zf 236,164,80
zb 144,1,64
zb 146,1,1600
za 48,168,80
zb 148,2,64
zb 150,2,1600
za 52,172,80
zb 152,1,128
zb 154,1,1664
za 56,176,80
zb 156,2,128
zb 158,2,1664
za 60,180,80
zu 6
zb 160,1,6144
zb 162,1,7680
zf 232,200,84
zb 164,2,6144
zb 166,2,7680
zf 236,204,84
zb 168,1,6208
zb 170,1,7744
za 48,184,84
zb 172,2,6208
zb 174,2,7744
za 52,188,84
zb 176,1,6272
zb 178,1,7808
za 56,192,84
zb 180,2,6272
zb 182,2,7808
za 60,196,84
s_branch Lf8_as1E2
Lf8_as2G0:
zc2
s_cbranch_scc0 Lf8_as2Gb0
s_branch Lf8_as2S0
Lf8_as2D0:
zc2
s_cbranch_scc0 Lf8_as2Rb0
Lf8_as2S0:
ze0
s_cbranch_scc0 Lf8_as2Y0
zfg
zec 0x5780
zdu
s_call_b64 s[88:89], Lf8_far
s_branch Lf8_as2Xb0
Lf8_as2Y0:
zac 17,10,6
zac 18,12,6
za9 19,14
za9 20,16
s_call_b64 s[88:89], Lf8_four
Lf8_as2Xb0:
ze 14
zf 240,152,64
ze 12
zd 76,88
zd 77,89
zd 78,90
zd 79,91
zf 244,156,64
zd 80,92
zd 81,93
zd 82,94
zd 83,95
z7 64,136
zd 84,96
zd 85,97
zd 86,98
za 68,140,64
zb 184,1,49152
zb 186,1,50688
zd 87,99
za 72,144,64
zb 188,2,49152
zb 190,2,50688
zb 192,1,49216
za 76,148,64
ze 7
zb 194,1,50752
zb 196,2,49216
zb 198,2,50752
zf 240,168,68
zb 200,1,49280
zb 202,1,50816
zb 204,2,49280
zb 206,2,50816
zf 244,172,68
zbr 0x10000
zbb 1
zbb 2
zb2 50
za 64,176,68
ze 12
zb3 50
zbz 21,50
zbc 0x5800
zbw
zbd
z7 68,180
ze 0
s_barrier
z6 0x3000
zag 0x3000
z0 38
za 72,160,68
zbe
zn 39,1024
zn 49,2048
za 76,164,68
zn 38,3072
z6 0x4000
zag 0x4000
z0 39
zf 240,184,72
zn 49,1024
zal 24,50
zf 244,188,72
zbc 0x9800
zby
zbd
zbe
za 64,192,72
zal 25,50
zb5
za 68,196,72
zb6 0x1d800
zal 26,50
zb7 50
zbv 22,4
z7 72,200
zbk 22,50
zb8
za 76,204,72
zb9 22
s_branch Lf8_as2H1
Lf8_as2G1:
zct
s_cbranch_scc0 Lf8_as2Gb1
s_branch Lf8_as2S1
Lf8_as2D1:
zct
s_cbranch_scc0 Lf8_as2Rb1
Lf8_as2S1:
zdz
s_cbranch_scc0 Lf8_as2Y1
zet
zeu
zev
s_call_b64 s[88:89], Lf8_far
s_branch Lf8_as2Xb1
Lf8_as2Y1:
zaa 17,9,6
zaa 18,11,6
za8 19,13
za8 20,15
s_call_b64 s[88:89], Lf8_four
Lf8_as2Xb1:
ze 0
zf 248,152,76
zbn
zbq 8,0
zd 64,88
zd 65,89
zf 252,156,76
zbo
zd 66,90
zd 67,91
zd 68,92
za 80,136,76
zbp
zd 69,93
zd 70,94
zd 71,95
za 84,140,76
zd 72,96
zd 73,97
za 88,144,76
zd 74,98
zd 75,99
za 92,148,76
zu 12
zo 136,1
zb 138,1,1536
zf 248,168,80
zo 140,2
zb 142,2,1536
zf 252,172,80
zb 144,1,64
zb 146,1,1600
z7 80,176
zb 148,2,64
zb 150,2,1600
za 84,180,80
zb 152,1,128
zb 154,1,1664
za 88,160,80
zb 156,2,128
zb 158,2,1664
za 92,164,80
zu 6
zb 160,1,6144
zb 162,1,7680
zf 248,184,84
zb 164,2,6144
zb 166,2,7680
zf 252,188,84
zb 168,1,6208
zb 170,1,7744
za 80,192,84
zb 172,2,6208
zb 174,2,7744
z7 84,196
zb 176,1,6272
zb 178,1,7808
za 88,200,84
zb 180,2,6272
zb 182,2,7808
za 92,204,84
s_branch Lf8_as2E2
Lf8_as3G0:
zc2
s_cbranch_scc0 Lf8_as3Gb0
s_branch Lf8_as3S0
Lf8_as3D0:
zc2
s_cbranch_scc0 Lf8_as3Rb0
Lf8_as3S0:
ze0
s_cbranch_scc0 Lf8_as3Y0
zfg
zec 0x5780
zdu
s_call_b64 s[88:89], Lf8_far
s_branch Lf8_as3Xb0
Lf8_as3Y0:
zac 17,10,6
zac 18,12,6
za9 19,14
za9 20,16
s_call_b64 s[88:89], Lf8_four
Lf8_as3Xb0:
ze 15
za 96,136,64
zd 76,88
zd 77,89
zd 78,90
za 100,140,64
zd 79,91
zd 80,92
zd 81,93
za 104,144,64
zd 82,94
zd 83,95
zd 84,96
za 108,148,64
ze 9
zd 85,97
zd 86,98
zd 87,99
za 112,152,64
zb 192,1,49216
zb 194,1,50752
zb 196,2,49216
za 116,156,64
ze 5
zb 198,2,50752
zb 200,1,49280
za 96,176,68
ze 5
zb 202,1,50816
zb 204,2,49280
za 100,180,68
zb 206,2,50816
zb 184,1,49152
za 104,160,68
zb 186,1,50688
zb 188,2,49152
zb 190,2,50688
za 108,164,68
ze 0
s_barrier
zbr 0x10000
zbb 1
zbb 2
za 112,168,68
zb2 50
zb3 50
za 116,172,68
zbz 21,50
zbc 0x5800
zbw
zbd
za 96,192,72
zbe
zal 24,50
zbc 0x9800
za 100,196,72
zby
zbd
zbe
za 104,200,72
zal 25,50
zb5
za 108,204,72
zb6 0x1d800
zal 26,50
zb7 50
zbv 22,4
za 112,184,72
zbk 22,50
zb8
za 116,188,72
zb9 22
s_branch Lf8_as3H1
Lf8_as3G1:
zct
s_cbranch_scc0 Lf8_as3Gb1
s_branch Lf8_as3S1
Lf8_as3D1:
zct
s_cbranch_scc0 Lf8_as3Rb1
Lf8_as3S1:
zdz
s_cbranch_scc0 Lf8_as3Y1
zet
zeu
zev
s_call_b64 s[88:89], Lf8_far
s_branch Lf8_as3Xb1
Lf8_as3Y1:
zaa 17,9,6
zaa 18,11,6
za8 19,13
za8 20,15
s_call_b64 s[88:89], Lf8_four
Lf8_as3Xb1:
ze 0
za 120,136,76
zbn
zbq 8,0
zd 64,88
zd 65,89
za 124,140,76
zbo
zd 66,90
zd 67,91
zd 68,92
za 128,144,76
zbp
zd 69,93
zd 70,94
zd 71,95
za 132,148,76
zd 72,96
zd 73,97
za 136,152,76
zd 74,98
zd 75,99
za 140,156,76
zu 6
zo 136,1
zb 138,1,1536
za 120,176,80
zo 140,2
zb 142,2,1536
za 124,180,80
zb 144,1,64
zb 146,1,1600
za 128,160,80
zb 148,2,64
zb 150,2,1600
za 132,164,80
zb 152,1,128
zb 154,1,1664
za 136,168,80
zb 156,2,128
zb 158,2,1664
za 140,172,80
zu 0
zb 160,1,6144
zb 162,1,7680
za 120,192,84
zb 164,2,6144
zb 166,2,7680
za 124,196,84
zb 168,1,6208
zb 170,1,7744
za 128,200,84
zb 172,2,6208
zb 174,2,7744
za 132,204,84
zb 176,1,6272
zb 178,1,7808
za 136,184,84
zb 180,2,6272
zb 182,2,7808
za 140,188,84
s_branch Lf8_as3E2
Lf8_four:
ze 0
zo 92,17
zo 94,18
zb 96,17,16
zb 98,18,16
zb 88,17,4608
zb 90,17,4816
zb 100,17,4624
zb 102,17,4832
zb 104,17,64
zb 106,18,64
zb 108,17,80
zb 110,18,80
zc3 128,19,3
zc3 129,19,5
zc3 130,20,3
zc3 131,20,5
zg0 19
zg0 20
zc3 132,20,3
zc3 133,20,5
zc3 134,19,3
ze 10
zh 112,92,128
zb 92,17,4672
zb 94,17,4880
ze 10
zh 116,96,128
zb 96,17,4688
zb 98,17,4896
ze 6
zh 120,104,128
zb 104,17,144
zb 106,18,144
ze 6
zh 124,108,128
zb 108,17,4736
zb 110,17,4944
zc3 135,19,5
zam
zf 112,88,132
zf 116,100,132
zb 100,17,128
zb 102,18,128
ze 8
zf 120,92,132
ze 6
zf 124,96,132
zb 96,17,4752
zb 98,17,4960
zc 88,112,113
zc 89,114,115
zc 90,116,117
zc 91,118,119
ze 6
zh 116,104,128
zc 92,120,121
zc 93,122,123
zc 94,124,125
zc 95,126,127
ze 2
zh 112,100,128
zf 112,108,132
ze 0
zf 116,96,132
s_nop 5
zc 96,112,113
zc 97,114,115
zc 98,116,117
zc 99,118,119
zgb
Lf8_far:
ze 0
zh6 98,4
zh7 88,98
zh8
v_mul_u32_u24 v95, 52, v4
v_sub_u32 v95, v0, v95
zh9
zgr 92,4
zia 91
zib 92
z2 92
zu 0
zx 89,88
zr 90,88
zg 89,91
zg 90,92
zs 89
zs 90
zc 88,89,90
zx 89,88
zr 90,88
z3 91,89
z3 92,90
z4 93,89,91
z4 94,90,92
z5 89,93
z5 90,94
zw 132,89,90
zw 133,89,94
zw 134,93,90
zw 135,93,94
zgf 91
zgf 92
zgg 96,91
zgg 97,92
zgh 96
zgh 97
zgi 91
zgi 96
zck 92
zck 97
ze 0
zew 128,91,92,95
zew 129,91,97,95
zew 130,96,92,95
zew 131,96,97,95
zfh 112,128
zbi 114,128,16
zbi 116,128,64
zbi 118,128,80
buffer_load_dwordx2 v[120:121], v128, s[4:7], 0 offen offset:128
zbi 122,128,144
zu 5
zx 128,112
zw 88,132,128
zr 128,112
zw 89,132,128
zx 128,113
zw 90,132,128
zr 128,113
zw 91,132,128
zu 4
zx 128,114
zw 92,132,128
zr 128,114
zw 93,132,128
zx 128,115
zw 94,132,128
zr 128,115
zw 95,132,128
zu 3
zx 128,116
zw 96,132,128
zr 128,116
zw 97,132,128
zx 128,117
zw 98,132,128
zr 128,117
zw 99,132,128
zu 2
zx 128,118
zw 100,132,128
zr 128,118
zw 101,132,128
zx 128,119
zw 102,132,128
zr 128,119
zw 103,132,128
zu 1
zx 128,120
zw 104,132,128
zr 128,120
zw 105,132,128
zx 128,121
zw 106,132,128
zr 128,121
zw 107,132,128
zu 0
zx 128,122
zw 108,132,128
zr 128,122
zw 109,132,128
zx 128,123
zw 110,132,128
zr 128,123
zw 111,132,128
zfh 112,129
zbi 114,129,16
zbi 116,129,64
zbi 118,129,80
zbi 120,129,128
zbi 122,129,144
zu 5
zx 129,112
zy 88,133,129
zr 129,112
zy 89,133,129
zx 129,113
zy 90,133,129
zr 129,113
zy 91,133,129
zu 4
zx 129,114
zy 92,133,129
zr 129,114
zy 93,133,129
zx 129,115
zy 94,133,129
zr 129,115
zy 95,133,129
zu 3
zx 129,116
zy 96,133,129
zr 129,116
zy 97,133,129
zx 129,117
zy 98,133,129
zr 129,117
zy 99,133,129
zu 2
zx 129,118
zy 100,133,129
zr 129,118
zy 101,133,129
zx 129,119
zy 102,133,129
zr 129,119
zy 103,133,129
zu 1
zx 129,120
zy 104,133,129
zr 129,120
zy 105,133,129
zx 129,121
zy 106,133,129
zr 129,121
zy 107,133,129
zu 0
zx 129,122
zy 108,133,129
zr 129,122
zy 109,133,129
zx 129,123
zy 110,133,129
zr 129,123
zy 111,133,129
zfh 112,130
zbi 114,130,16
zbi 116,130,64
zbi 118,130,80
zbi 120,130,128
zbi 122,130,144
zu 5
zx 130,112
zy 88,134,130
zr 130,112
zy 89,134,130
zx 130,113
zy 90,134,130
zr 130,113
zy 91,134,130
zu 4
zx 130,114
zy 92,134,130
zr 130,114
zy 93,134,130
zx 130,115
zy 94,134,130
zr 130,115
zy 95,134,130
zu 3
zx 130,116
zy 96,134,130
zr 130,116
zy 97,134,130
zx 130,117
zy 98,134,130
zr 130,117
zy 99,134,130
zu 2
zx 130,118
zy 100,134,130
zr 130,118
zy 101,134,130
zx 130,119
zy 102,134,130
zr 130,119
zy 103,134,130
zu 1
zx 130,120
zy 104,134,130
zr 130,120
zy 105,134,130
zx 130,121
zy 106,134,130
zr 130,121
zy 107,134,130
zu 0
zx 130,122
zy 108,134,130
zr 130,122
zy 109,134,130
zx 130,123
zy 110,134,130
zr 130,123
zy 111,134,130
zfh 112,131
zbi 114,131,16
zbi 116,131,64
zbi 118,131,80
zbi 120,131,128
zbi 122,131,144
zu 5
zx 131,112
zy 88,135,131
zr 131,112
zy 89,135,131
zx 131,113
zy 90,135,131
zr 131,113
zy 91,135,131
zu 4
zx 131,114
zy 92,135,131
zr 131,114
zy 93,135,131
zx 131,115
zy 94,135,131
zr 131,115
zy 95,135,131
zu 3
zx 131,116
zy 96,135,131
zr 131,116
zy 97,135,131
zx 131,117
zy 98,135,131
zr 131,117
zy 99,135,131
zu 2
zx 131,118
zy 100,135,131
zr 131,118
zy 101,135,131
zx 131,119
zy 102,135,131
zr 131,119
zy 103,135,131
zu 1
zx 131,120
zy 104,135,131
zr 131,120
zy 105,135,131
zx 131,121
zy 106,135,131
zr 131,121
zy 107,135,131
zu 0
zx 131,122
zy 108,135,131
zr 131,122
zy 109,135,131
zx 131,123
zy 110,135,131
zr 131,123
zy 111,135,131
zq 88,89
zc 89,90,91
zc 90,92,93
zc 91,94,95
zc 92,96,97
zc 93,98,99
zc 94,100,101
zc 95,102,103
zc 96,104,105
zc 97,106,107
zc 98,108,109
zc 99,110,111
zgb
Lf5_start:
zhf 112,0
zhr 0x4800
s_add_u32 s73, s73, 0xc800
s_mul_i32 s81, s21, 0xe0
s_add_u32 s81, s81, s22
s_mul_i32 s93, s81, 0xc0
s_mul_i32 s77, s81, 0x64
zhb 113,112
zhc 114,112
zgd 116,112
v_and_b32 v118, 12, v112
zgu 115,118,114
v_add_u32 v44, s21, v116
v_add_u32 v29, s22, v115
zh4 117,116
zh5 118,115
zgu 31,117,118
s_mul_i32 s25, s20, 13
s_lshr_b32 s25, s25, 1
zed
zee 0x4800
zef
zeg
zeh 0x1200
zei
zej 0xd0
zek 0x12d0
zel
zem
zen
zeo
zbn
zbo
zbp
zhg 0x930000
zhh 0x20000
zhi 0x20000
zha 0x70880
zhj 0x20000
zhk 0x20000
zhw
zhz 0x1200
s_sub_u32 s85, s21, 3
s_add_u32 s85, s85, s20
s_add_u32 s97, s85, 0
zcv
zcw 0xdf
zbt 0xa800
s_add_u32 s42, s35, 0
ze2 117,112
zep 118,117
zd9 118
zeq 21,118
zd0 117,21
zer 117
zea 118
zes 118
zeb 118
zck 118
zbk 118,117
zc9 117,0x40000000
zcs 21,118,117
ze 0
zhl 0xffff
zhp 0xffff
zcx
zv
zae 21
ze5
zfi 52,31
zhs 117,112
zep 118,117
zd9 118
zeq 22,118
zd0 117,22
zer 117
zea 118
zes 118
zeb 118
zck 118
zbk 118,117
zc9 117,0x40000000
zcs 22,118,117
zan 0x400
zv
zae 22
zht 117,112
zep 118,117
zd9 118
zeq 23,118
zd0 117,23
zer 117
zea 118
zes 118
zeb 118
zck 118
zbk 118,117
zc9 117,0x40000000
zcs 23,118,117
zan 0x800
zv
zae 23
v_add_u32 v117, 0xc0, v112
zep 118,117
zd9 118
zeq 24,118
zd0 117,24
zer 117
zea 118
zes 118
zeb 118
zck 118
zbk 118,117
zc9 117,0x40000000
zcs 24,118,117
zan 0xc00
zv
zae 24
v_add_u32 v117, 0x100, v112
zep 118,117
zd9 118
zeq 25,118
zd0 117,25
zer 117
zea 118
zes 118
zeb 118
zck 118
zbk 118,117
zc9 117,0x40000000
zcs 25,118,117
zcy 0x3fffffff
zan 0x1000
zv
zae 25
zcz
s_add_u32 s97, s85, 4
zcv
zcw 0xdf
zbt 0xa800
zdd 0x4800
zcx
zv
zae 21
zan 0x400
zv
zae 22
zan 0x800
zv
zae 23
zan 0xc00
zv
zae 24
zcy 0x3fffffff
zan 0x1000
zv
zae 25
zcz
zhm 0x80
zhn
zho 0xffff
zhq 0xffff
zde
s_cselect_b32 s82, 0, s20
s_lshl_b32 s83, s82, 6
s_add_u32 s83, s83, 0x80
s_mul_i32 s82, s82, 5
s_lshr_b32 s82, 0x5880, s82
zh0 117,112
v_lshl_add_u32 v118, v112, 4, s83
v_lshl_add_u32 v117, v117, 4, s83
zgr 115,112
v_mul_u32_u24 v116, 0x56, v115
v_lshrrev_b32 v116, 8, v116
v_mad_i32_i24 v115, v116, -3, v115
v_cmp_le_u32 vcc, 48, v112
zam
zcs 38,118,117
v_cmp_gt_u32 vcc, 32, v112
zam
zcs 39,118,117
v_cmp_le_u32 vcc, 16, v112
zam
zcs 49,118,117
s_mov_b32 s84, 0xffffff40
zfx 116,115
zfy 38,116
zgv
zfx 116,115
zfy 39,116
zgv
zfx 116,115
zfy 49,116
zcg
zcu
z0 38
zn 39,1024
zn 49,2048
zn 38,3072
z6 0x1000
zag 0x1000
z0 39
zn 49,1024
zn 38,2048
zn 39,3072
z6 0x2000
zag 0x2000
z0 49
zn 38,1024
zn 39,2048
zn 49,3072
z6 0x3000
zag 0x3000
z0 38
zn 39,1024
zn 49,2048
zn 38,3072
z6 0x4000
zag 0x4000
z0 39
zn 49,1024
zc8 0x15e00
zfi 58,31
zhd 115,112
zgd 116,112
zfk 119,114
zg3 4,113
zh1 0x435f0000
zgc 118,114
zgp 0,119
zgn 0,118
v_mul_u32_u24 v117, 0xd0, v113
v_add_u32 v0, v117, v0
zf9 117,118
zg2 117,119
zhe 117,115
zck 117
zgq 118,116,119
zbk 117,118
v_add_u32 v117, s73, v117
zfk 118,116
zh2 1,118,117
zh3 2,1
s_mov_b32 s3, 0
zfz
s_cselect_b32 s3, 2, s3
zf0
s_cselect_b32 s3, 4, s3
zde
s_cselect_b32 s3, 0, s3
s_mov_b32 s78, s3
s_mul_i32 s79, s3, 0x5780
s_add_u32 s79, s79, s77
s_add_u32 s79, s79, 48
s_mul_i32 s94, s3, 0x1200
s_add_u32 s94, s94, 0x3870
zbq 8,0
ze3
zed
zee 0x4800
zef
zeg
zeh 0x1200
zei
zej 0xd0
zek 0x12d0
zel
zem
zen
zeo
s_mov_b32 s80, 0
s_mul_i32 s58, s20, 0x1800
s_add_u32 s58, s58, 0x33000
zde
s_cselect_b32 s58, s71, s58
zgp 6,118
zgc 118,116
zgn 6,118
zfk 118,115
zf9 7,118
zc9 117,0xffff
v_lshlrev_b32 v117, v7, v117
v_cmp_eq_u32 vcc, v116, v114
zam
zas 117
v_cmp_gt_u32 vcc, 2, v115
zam
v_cndmask_b32 v3, 0, v117, vcc
zgq 5,3,117
s_sub_u32 s82, s21, 3
s_sub_u32 s83, s22, 3
v_cvt_f32_i32 v45, s82
v_cvt_f32_i32 v46, s83
v_add_f32 v117, 0x41100000, v45
v_add_f32 v118, 0x41a00000, v46
v_mul_f32 v47, 0xc3500000, v46
v_fmamk_f32 v47, v45, 0xc5900000, v47
v_readfirstlane_b32 s75, v117
v_readfirstlane_b32 s76, v118
zc9 48,0x120
s_mov_b32 s26, 0x11111111
s_mov_b32 s27, 0x11111111
s_mov_b32 s28, 0x22222222
s_mov_b32 s29, 0x22222222
s_mov_b32 s30, 0x44444444
s_mov_b32 s31, 0x44444444
s_mov_b32 s32, 0x88888888
s_mov_b32 s33, 0x88888888
zu 28
zx 32,52
zr 33,52
zgw 34,44
zbs 35,29
z2 34
z2 35
zg 32,34
zg 33,35
zs 34
zs 35
zs 32
zs 33
zq 34,35
zq 32,33
zr 33,32
zav 32,34
zaw 32
z3 41,33
z3 40,32
z4 43,33,41
z4 42,32,40
zgw 34,44
z2 34
zd1 35,45
zd2 34,35
zax 43
z5 32,42
z5 33,43
zd3 36,40,45,34
zay 37,41,46
zw 34,32,33
zaz 32,43
za0 33,42
zw 35,42,43
za1 37,41
za2 37,47
za3 32,33
zas 33
za4 37,36
zq 34,35
zq 32,33
za5 33,48
zdf 36,40
zdg 35
za6 9,37
z8 13,34,7
z8 15,32,7
zdh
zau 11,33,9
zdi
zdj
Lf5_aqR0:
zu 19
s_barrier
zcf
s_cbranch_scc1 Lf5_aqG0
Lf5_aqRb0:
zdk 64,8
zi 66,8,16
zi 68,8,64
zi 70,8,80
zi 72,8,128
zi 74,8,144
zu 13
zo 136,1
zb 138,1,1536
zo 140,2
zb 142,2,1536
zb 144,1,64
zb 146,1,1600
zb 148,2,64
zb 150,2,1600
zb 152,1,128
zb 154,1,1664
zb 156,2,128
zb 158,2,1664
zu 7
zb 160,1,6144
zb 162,1,7680
zb 164,2,6144
zb 166,2,7680
zb 168,1,6208
zb 170,1,7744
zb 172,2,6208
zb 174,2,7744
zb 176,1,6272
zb 178,1,7808
zb 180,2,6272
zb 182,2,7808
Lf5_atR0:
zda
s_cbranch_scc1 Lf5_atG0
Lf5_atRb0:
ze 15
zh 208,136,64
zu 1
zb 184,1,12288
zb 186,1,13824
zb 188,2,12288
zh 212,140,64
zb 190,2,13824
zb 192,1,12352
zb 194,1,13888
zp 0,144,64
zb 196,2,12352
zb 198,2,13888
zp 4,148,64
ze 15
zb 200,1,12416
zb 202,1,13952
zp 8,152,64
zb 204,2,12416
zb 206,2,13952
zp 12,156,64
zi 76,8,4608
zi 78,8,4624
zf 208,160,68
zi 80,8,4672
zi 82,8,4688
zf 212,164,68
ze 15
zi 84,8,4736
zi 86,8,4752
za 0,168,68
zf1
zcv
zcw 0xdf
zbt 0xa800
zdd 0x9000
za 4,172,68
zid
zgk
s_cselect_b32 s42, 0x1e800, s42
za 8,176,68
zcx
zv
zae 21
za 12,180,68
zan 0x400
zv
zae 22
ze 6
zf 208,184,72
zan 0x800
zv
zae 23
zf 212,188,72
zan 0xc00
zv
zae 24
za 0,192,72
zcy 0x3fffffff
zan 0x1000
zv
zae 25
zcz
za 4,196,72
za 8,200,72
za 12,204,72
Lf5_atR1:
zdb
s_cbranch_scc1 Lf5_atG1
Lf5_atRb1:
ze 0
zh 216,136,76
zi 64,8,9216
zi 66,8,9232
zi 68,8,9280
zi 70,8,9296
zf 216,160,80
zi 72,8,9344
zi 74,8,9360
zf2 28,31
ze5
zc6 56,31,16
zf 216,184,84
zc8 0x15e00
zc6 62,31,16
z6 0x3000
zc7 0x3000
z0 38
zh 220,140,76
zn 39,1024
zn 49,2048
zf 220,164,80
zn 38,3072
z6 0x4000
zc7 0x4000
z0 39
zf 220,188,84
zn 49,1024
zcg
zcu
z0 38
zp 16,144,76
zn 39,1024
zn 49,2048
za 16,168,80
zu 17
zx 32,58
zr 33,58
zci 34,44
zbs 35,29
za 16,192,84
z2 34
z2 35
zg 32,34
zg 33,35
zp 20,148,76
zs 34
zs 35
zs 32
zs 33
za 20,172,80
zq 34,35
zq 32,33
zr 33,32
zav 32,34
za 20,196,84
zaw 32
z3 41,33
z3 40,32
z4 43,33,41
zp 24,152,76
z4 42,32,40
zci 34,44
z2 34
za 24,176,80
zd1 35,45
zd2 34,35
zax 43
za 24,200,84
z5 32,42
z5 33,43
zd3 36,40,45,34
zp 28,156,76
zay 37,41,46
zw 34,32,33
zaz 32,43
za 28,180,80
za0 33,42
zbr 0xc800
zdw 1
zdw 2
za 28,204,84
Lf5_atR2:
zu 12
s_barrier
zdc
s_cbranch_scc1 Lf5_atG2
Lf5_atRb2:
ze 0
zh 224,136,64
zi 76,8,13824
zi 78,8,13840
zi 80,8,13888
zh 228,140,64
zi 82,8,13904
zn 38,3072
zp 32,144,64
z6 0x1000
zag 0x1000
z0 39
zp 36,148,64
zn 49,1024
zn 38,2048
zp 40,152,64
zn 39,3072
z6 0x2000
zag 0x2000
z0 49
zp 44,156,64
zi 64,8,13952
zi 66,8,13968
zn 38,1024
zf 224,160,68
zn 39,2048
zn 49,3072
zf 228,164,68
zw 35,42,43
za1 37,41
za2 37,47
za 32,168,68
za3 32,33
zas 33
za4 37,36
za 36,172,68
zq 34,35
zq 32,33
za5 33,48
za 40,176,68
zca 36,40
zcb 35
za 44,180,68
za6 10,37
z8 14,34,7
zf 224,184,72
z8 16,32,7
zcc
zf 228,188,72
zau 12,33,10
zcd
zce
za 32,192,72
zx 32,53
zr 33,53
zdx 34,44
za 36,196,72
zcj 35,29
z2 34
z2 35
za 40,200,72
zg 32,34
zg 33,35
za 44,204,72
Lf5_atR3:
zc5
s_cbranch_scc1 Lf5_atG3
Lf5_atRb3:
ze 0
zh 232,136,76
zi 72,8,18432
zi 74,8,18448
zi 84,8,18496
zi 86,8,18512
zs 34
zs 35
zh 236,140,76
zs 32
zs 33
zq 34,35
zq 32,33
zr 33,32
zp 48,144,76
zav 32,34
zaw 32
z3 41,33
z3 40,32
z4 43,33,41
zp 52,148,76
z4 42,32,40
zax 43
z5 32,42
z5 33,43
zbg 36,40,45
zp 56,152,76
zay 37,41,46
zw 34,32,33
zaz 32,43
za0 33,42
zw 35,42,43
zp 60,156,76
zi 76,8,18560
zi 78,8,18576
za1 37,41
za2 37,47
za3 32,33
zf 232,160,80
zas 33
za4 37,36
zq 34,35
zq 32,33
za5 33,48
zf 236,164,80
zdf 36,40
zdg 35
za6 9,37
z8 13,34,7
z8 15,32,7
za 48,168,80
zdh
zau 11,33,9
zdi
zdj
zu 20
zx 32,28
zr 33,28
za 52,172,80
zf3 34,44
ze2 35,29
z2 34
z2 35
zg 32,34
zg 33,35
za 56,176,80
zs 34
zs 35
zs 32
zs 33
zq 34,35
zq 32,33
za 60,180,80
zr 33,32
zav 32,34
zaw 32
z3 41,33
z3 40,32
zf 232,184,64
z4 43,33,41
z4 42,32,40
zax 43
z5 32,42
z5 33,43
zf 236,188,64
zbg 36,40,45
zay 37,41,46
zw 34,32,33
zaz 32,43
za0 33,42
za 48,192,64
zw 35,42,43
za1 37,41
za2 37,47
za3 32,33
zas 33
za 52,196,64
za4 37,36
zq 34,35
zq 32,33
za5 33,48
zca 36,40
zcb 35
za 56,200,64
za6 10,37
z8 14,34,7
z8 16,32,7
zcc
zau 12,33,10
zcd
za 60,204,64
zce
Lf5_atR4:
zu 12
s_barrier
zc5
s_cbranch_scc1 Lf5_atG4
Lf5_atRb4:
ze 0
zh 240,136,72
zf4 8,0
zh 244,140,72
zdk 64,8
zi 66,8,16
zp 64,144,72
zi 68,8,64
zi 70,8,80
zp 68,148,72
zex 72,152
zp 76,156,72
zi 72,8,128
zi 74,8,144
zb 136,1,12288
zf 240,160,84
zb 138,1,13824
zb 140,2,12288
zb 142,2,13824
zf 244,164,84
zb 144,1,12352
zb 146,1,13888
za 64,168,84
zb 148,2,12352
zb 150,2,13888
za 68,172,84
zb 152,1,12416
zb 154,1,13952
za 72,176,84
zb 156,2,12416
zb 158,2,13952
za 76,180,84
zb 160,1,30720
zb 162,1,32256
zf 240,184,76
zb 164,2,30720
zb 166,2,32256
zf 244,188,76
zb 168,1,30784
zb 170,1,32320
za 64,192,76
zb 172,2,30784
zb 174,2,32320
za 68,196,76
zb 176,1,30848
zb 178,1,32384
za 72,200,76
zb 180,2,30848
zb 182,2,32384
z7 76,204
zfz
s_cbranch_scc1 Lf5_as1R0
zf0
s_cbranch_scc1 Lf5_as2R0
zde
s_cbranch_scc1 Lf5_as3R0
Lf5_as0R0:
zc0
s_cbranch_scc1 Lf5_as0G0
Lf5_as0Rb0:
ze 15
zf 208,136,64
zb 192,1,49216
zb 194,1,50752
zb 196,2,49216
zf 212,140,64
zb 198,2,50752
zb 200,1,49280
zb 202,1,50816
za 0,144,64
zb 204,2,49280
zb 206,2,50816
zb 184,1,49152
za 4,148,64
ze 15
zb 186,1,50688
zb 188,2,49152
zb 190,2,50688
za 8,152,64
zi 76,8,4608
zi 78,8,4624
zi 80,8,4672
za 12,156,64
ze 15
zi 82,8,4688
zi 84,8,4736
zi 86,8,4752
zf 208,176,68
zbr 0xc800
zbb 1
zbb 2
zf 212,180,68
zb2 50
zb3 50
zbz 21,50
za 0,160,68
zbc 0x5800
zbw
zbd
zbe
za 4,164,68
ze 6
s_barrier
z6 0x3000
zag 0x3000
z0 38
za 8,168,68
zn 39,1024
zn 49,2048
za 12,172,68
zn 38,3072
z6 0x4000
zag 0x4000
z0 39
zf 208,192,72
zn 49,1024
zal 24,50
zf 212,196,72
zbc 0x9800
zby
zbd
zbe
za 0,200,72
zal 25,50
zb5
za 4,204,72
zb6 0x1a000
zal 26,50
zb7 50
zbv 22,4
za 8,184,72
zbk 22,50
zb8
za 12,188,72
zb9 22
Lf5_as0R1:
zcf
s_cbranch_scc1 Lf5_as0G1
Lf5_as0Rb1:
ze 0
zf 216,136,76
zbn
zbo
zbq 8,0
zf 220,140,76
zbp
zdk 64,8
zi 66,8,16
za 16,144,76
zi 68,8,64
zi 70,8,80
za 20,148,76
zi 72,8,128
zi 74,8,144
za 24,152,76
za 28,156,76
zu 12
zo 136,1
zb 138,1,1536
zf 216,176,80
zo 140,2
zb 142,2,1536
zf 220,180,80
zb 144,1,64
zb 146,1,1600
za 16,160,80
zb 148,2,64
zb 150,2,1600
za 20,164,80
zb 152,1,128
zb 154,1,1664
za 24,168,80
zb 156,2,128
zb 158,2,1664
za 28,172,80
zu 6
zb 160,1,6144
zb 162,1,7680
zf 216,192,84
zb 164,2,6144
zb 166,2,7680
zf 220,196,84
zb 168,1,6208
zb 170,1,7744
za 16,200,84
zb 172,2,6208
zb 174,2,7744
za 20,204,84
zb 176,1,6272
zb 178,1,7808
za 24,184,84
zb 180,2,6272
zb 182,2,7808
za 28,188,84
s_branch Lf5_amR0
Lf5_as1R0:
zc0
s_cbranch_scc1 Lf5_as1G0
Lf5_as1Rb0:
ze 15
zf 224,144,64
zb 200,1,49280
zb 202,1,50816
zb 204,2,49280
zf 228,148,64
ze 15
zb 206,2,50816
zb 184,1,49152
zb 186,1,50688
za 32,152,64
zb 188,2,49152
zb 190,2,50688
zb 192,1,49216
za 36,156,64
zb 194,1,50752
zb 196,2,49216
zb 198,2,50752
za 40,136,64
zi 76,8,4608
zi 78,8,4624
zi 80,8,4672
za 44,140,64
ze 15
zi 82,8,4688
zi 84,8,4736
zi 86,8,4752
zf 224,160,68
zbr 0xc800
zbb 1
zbb 2
zf 228,164,68
zb2 50
zb3 50
zbz 21,50
za 32,168,68
zbc 0x5800
zbw
zbd
zbe
za 36,172,68
ze 6
s_barrier
z6 0x3000
zag 0x3000
z0 38
za 40,176,68
zn 39,1024
zn 49,2048
za 44,180,68
zn 38,3072
z6 0x4000
zag 0x4000
z0 39
zf 224,200,72
zn 49,1024
zal 24,50
zf 228,204,72
zbc 0x9800
zby
zbd
zbe
za 32,184,72
zal 25,50
zb5
za 36,188,72
zb6 0x1a000
zal 26,50
zb7 50
zbv 22,4
za 40,192,72
zbk 22,50
zb8
za 44,196,72
zb9 22
Lf5_as1R1:
zcf
s_cbranch_scc1 Lf5_as1G1
Lf5_as1Rb1:
ze 0
zf 232,144,76
zbn
zbo
zbq 8,0
zf 236,148,76
zbp
zdk 64,8
zi 66,8,16
za 48,152,76
zi 68,8,64
zi 70,8,80
za 52,156,76
zi 72,8,128
zi 74,8,144
za 56,136,76
za 60,140,76
zu 12
zo 136,1
zb 138,1,1536
zf 232,160,80
zo 140,2
zb 142,2,1536
zf 236,164,80
zb 144,1,64
zb 146,1,1600
za 48,168,80
zb 148,2,64
zb 150,2,1600
za 52,172,80
zb 152,1,128
zb 154,1,1664
za 56,176,80
zb 156,2,128
zb 158,2,1664
za 60,180,80
zu 6
zb 160,1,6144
zb 162,1,7680
zf 232,200,84
zb 164,2,6144
zb 166,2,7680
zf 236,204,84
zb 168,1,6208
zb 170,1,7744
za 48,184,84
zb 172,2,6208
zb 174,2,7744
za 52,188,84
zb 176,1,6272
zb 178,1,7808
za 56,192,84
zb 180,2,6272
zb 182,2,7808
za 60,196,84
s_branch Lf5_amR0
Lf5_as2R0:
zc0
s_cbranch_scc1 Lf5_as2G0
Lf5_as2Rb0:
ze 14
zf 240,152,64
ze 12
zb 184,1,49152
zb 186,1,50688
zb 188,2,49152
zf 244,156,64
zb 190,2,50688
zb 192,1,49216
zb 194,1,50752
z7 64,136
zb 196,2,49216
zb 198,2,50752
zb 200,1,49280
za 68,140,64
zb 202,1,50816
zb 204,2,49280
zb 206,2,50816
za 72,144,64
zi 76,8,4608
zi 78,8,4624
zi 80,8,4672
za 76,148,64
ze 15
zi 82,8,4688
zi 84,8,4736
zi 86,8,4752
zf 240,168,68
zbr 0xc800
zbb 1
zbb 2
zf 244,172,68
zb2 50
zb3 50
zbz 21,50
za 64,176,68
zbc 0x5800
zbw
zbd
zbe
z7 68,180
ze 6
s_barrier
z6 0x3000
zag 0x3000
z0 38
za 72,160,68
zn 39,1024
zn 49,2048
za 76,164,68
zn 38,3072
z6 0x4000
zag 0x4000
z0 39
zf 240,184,72
zn 49,1024
zal 24,50
zf 244,188,72
zbc 0x9800
zby
zbd
zbe
za 64,192,72
zal 25,50
zb5
za 68,196,72
zb6 0x1a000
zal 26,50
zb7 50
zbv 22,4
z7 72,200
zbk 22,50
zb8
za 76,204,72
zb9 22
Lf5_as2R1:
zcf
s_cbranch_scc1 Lf5_as2G1
Lf5_as2Rb1:
zbq 8,0
zbn
zbo
zdk 64,8
zi 66,8,16
zi 68,8,64
zi 70,8,80
zi 72,8,128
zi 74,8,144
zu 12
zo 136,1
zb 138,1,1536
zo 140,2
zb 142,2,1536
zb 144,1,64
zb 146,1,1600
zb 148,2,64
zb 150,2,1600
zb 152,1,128
zb 154,1,1664
zb 156,2,128
zb 158,2,1664
zu 6
zb 160,1,6144
zb 162,1,7680
zb 164,2,6144
zb 166,2,7680
zb 168,1,6208
zb 170,1,7744
zb 172,2,6208
zb 174,2,7744
zb 176,1,6272
zb 178,1,7808
zb 180,2,6272
zb 182,2,7808
zbp
s_branch Lf5_amR0
Lf5_as3R0:
zc0
s_cbranch_scc1 Lf5_as3G0
Lf5_as3Rb0:
zi 76,8,4608
zi 78,8,4624
zi 80,8,4672
zi 82,8,4688
zi 84,8,4736
zi 86,8,4752
ze 6
s_barrier
zbr 0xc800
zbb 1
zbb 2
zb2 50
zb3 50
zbz 21,50
zbc 0x5800
zbw
zbd
zbe
zal 24,50
zbc 0x9800
zby
zbd
zbe
zal 25,50
zb5
zb6 0x1a000
zal 26,50
zb7 50
zbv 22,4
zbk 22,50
zb8
zb9 22
Lf5_as3R1:
zcf
s_cbranch_scc1 Lf5_as3G1
Lf5_as3Rb1:
zbq 8,0
zbn
zbo
zdk 64,8
zi 66,8,16
zi 68,8,64
zi 70,8,80
zi 72,8,128
zi 74,8,144
zu 6
zo 136,1
zb 138,1,1536
zo 140,2
zb 142,2,1536
zb 144,1,64
zb 146,1,1600
zb 148,2,64
zb 150,2,1600
zb 152,1,128
zb 154,1,1664
zb 156,2,128
zb 158,2,1664
zu 0
zb 160,1,6144
zb 162,1,7680
zb 164,2,6144
zb 166,2,7680
zb 168,1,6208
zb 170,1,7744
zb 172,2,6208
zb 174,2,7744
zb 176,1,6272
zb 178,1,7808
zb 180,2,6272
zb 182,2,7808
zbp
s_branch Lf5_amR0
.p2align 6
Lf5_amR0:
zda
s_cbranch_scc1 Lf5_amG0
Lf5_amRb0:
ze 15
zf 208,136,64
ze3
zu 0
zb 184,1,12288
zb 186,1,13824
zb 188,2,12288
zf 212,140,64
zed
zb 190,2,13824
zb 192,1,12352
zb 194,1,13888
za 0,144,64
zee 0x4800
zb 196,2,12352
zb 198,2,13888
zb 200,1,12416
za 4,148,64
zef
zb 202,1,13952
zb 204,2,12416
zb 206,2,13952
ze 15
za 8,152,64
zeg
zi 76,8,4608
zi 78,8,4624
zi 80,8,4672
za 12,156,64
zeh 0x1200
zi 82,8,4688
zi 84,8,4736
zi 86,8,4752
zf 208,160,68
zei
zx 32,59
zr 33,59
zf 212,164,68
zej 0xd0
zd 59,60
zd 60,61
za 0,168,68
zek 0x12d0
zd 61,62
zd 62,63
za 4,172,68
zel
zci 34,44
zbs 35,29
ze 9
za 8,176,68
zem
z2 34
z2 35
za 12,180,68
zg 32,34
zg 33,35
zf 208,184,72
zen
zs 34
zs 35
zf 212,188,72
zeo
zs 32
zs 33
za 0,192,72
zq 34,35
zq 32,33
za 4,196,72
ze 0
zr 33,32
zav 32,34
za 8,200,72
zaw 32
z3 41,33
za 12,204,72
Lf5_amR1:
zdb
s_cbranch_scc1 Lf5_amG1
Lf5_amRb1:
zf 216,136,76
zi 64,8,9216
zi 66,8,9232
zi 68,8,9280
zf 216,160,80
zi 70,8,9296
zi 72,8,9344
zi 74,8,9360
zf 216,184,84
zcg
zcu
z0 38
zf 220,140,76
zn 39,1024
zn 49,2048
zf 220,164,80
zn 38,3072
zf 220,188,84
z6 0x1000
zag 0x1000
z0 39
za 16,144,76
zn 49,1024
za 16,168,80
zn 38,2048
za 16,192,84
zn 39,3072
za 20,148,76
z6 0x2000
zag 0x2000
z0 49
za 20,172,80
z3 40,32
z4 43,33,41
za 20,196,84
z4 42,32,40
zax 43
za 24,152,76
z5 32,42
z5 33,43
za 24,176,80
zbg 36,40,45
zay 37,41,46
za 24,200,84
zw 34,32,33
zaz 32,43
za 28,156,76
za0 33,42
za 28,180,80
za 28,204,84
Lf5_amR2:
zdc
s_cbranch_scc1 Lf5_amG2
Lf5_amRb2:
ze 0
zf 224,136,64
zi 76,8,13824
zi 78,8,13840
zi 80,8,13888
zf 228,140,64
zi 82,8,13904
zn 38,1024
za 32,144,64
zn 39,2048
zn 49,3072
za 36,148,64
z6 0x3000
zag 0x3000
z0 38
za 40,152,64
zn 39,1024
zn 49,2048
za 44,156,64
zi 64,8,13952
zi 66,8,13968
zf 224,160,68
zn 38,3072
zf 228,164,68
z6 0x4000
zag 0x4000
z0 39
za 32,168,68
zn 49,1024
za 36,172,68
zw 35,42,43
za1 37,41
za 40,176,68
za2 37,47
za3 32,33
za 44,180,68
zas 33
za4 37,36
zf 224,184,72
zq 34,35
zq 32,33
zf 228,188,72
za5 33,48
zca 36,40
za 32,192,72
zcb 35
za6 10,37
za 36,196,72
z8 14,34,7
z8 16,32,7
za 40,200,72
zcc
zau 12,33,10
zcd
zce
za 44,204,72
Lf5_amR3:
zc5
s_cbranch_scc1 Lf5_amG3
Lf5_amRb3:
ze 0
zf 232,136,76
zi 72,8,18432
zi 74,8,18448
zi 84,8,18496
zi 86,8,18512
zf 236,140,76
zx 32,54
zr 33,54
zd 54,55
zd 55,56
za 48,144,76
zd 56,57
zdx 34,44
zcj 35,29
za 52,148,76
z2 34
z2 35
zg 32,34
za 56,152,76
zg 33,35
zs 34
zs 35
za 60,156,76
zi 76,8,18560
zi 78,8,18576
zs 32
zf 232,160,80
zs 33
zq 34,35
zq 32,33
zf 236,164,80
zr 33,32
zav 32,34
zaw 32
za 48,168,80
z3 41,33
z3 40,32
z4 43,33,41
za 52,172,80
z4 42,32,40
zax 43
z5 32,42
za 56,176,80
z5 33,43
zbg 36,40,45
zay 37,41,46
za 60,180,80
zw 34,32,33
zaz 32,43
za0 33,42
zf 232,184,64
zw 35,42,43
za1 37,41
za2 37,47
zf 236,188,64
za3 32,33
zas 33
za4 37,36
za 48,192,64
zq 34,35
zq 32,33
za5 33,48
za 52,196,64
zdf 36,40
zdg 35
za6 9,37
z8 13,34,7
za 56,200,64
z8 15,32,7
zdh
zau 11,33,9
zdi
za 60,204,64
zdj
Lf5_amR4:
zcf
s_cbranch_scc1 Lf5_amG4
Lf5_amRb4:
ze 0
zf 240,136,72
zbn
zbo
zbq 8,0
zf 244,140,72
zbp
zdk 64,8
zi 66,8,16
za 64,144,72
zf5
zi 68,8,64
zi 70,8,80
za 68,148,72
z7 72,152
za 76,156,72
zu 12
zi 72,8,128
zi 74,8,144
zo 136,1
zf 240,160,84
zb 138,1,1536
zo 140,2
zb 142,2,1536
zf 244,164,84
zb 144,1,64
zb 146,1,1600
za 64,168,84
zb 148,2,64
zb 150,2,1600
za 68,172,84
zb 152,1,128
zb 154,1,1664
za 72,176,84
zb 156,2,128
zb 158,2,1664
za 76,180,84
zu 6
zb 160,1,6144
zb 162,1,7680
zf 240,184,76
zb 164,2,6144
zb 166,2,7680
zf 244,188,76
zb 168,1,6208
zb 170,1,7744
za 64,192,76
zb 172,2,6208
zb 174,2,7744
za 68,196,76
zb 176,1,6272
zb 178,1,7808
za 72,200,76
zb 180,2,6272
zb 182,2,7808
z7 76,204
zgx
s_cbranch_scc1 Lf5_amR0
zde
s_cbranch_scc1 Lf5_ayR0
Lf5_azR0:
zda
s_cbranch_scc1 Lf5_azG0
Lf5_azRb0:
zi 76,8,4608
zi 78,8,4624
zi 80,8,4672
zi 82,8,4688
ze 15
za 0,144,64
zu 0
zi 84,8,4736
zi 86,8,4752
zb 192,1,12352
zb 194,1,13888
za 4,148,64
zb 196,2,12352
zb 198,2,13888
zb 200,1,12416
zb 202,1,13952
za 8,152,64
zb 204,2,12416
zb 206,2,13952
zb 184,1,12288
zb 186,1,13824
za 12,156,64
zb 188,2,12288
zb 190,2,13824
zx 32,59
zr 33,59
zf 208,136,64
zci 34,44
zbs 35,29
z2 34
z2 35
zf 212,140,64
ze 15
zg 32,34
zg 33,35
zs 34
zs 35
za 0,168,68
zs 32
zs 33
zq 34,35
zq 32,33
za 4,172,68
zr 33,32
zav 32,34
zaw 32
z3 41,33
za 8,176,68
z3 40,32
z4 43,33,41
z4 42,32,40
zax 43
za 12,180,68
z5 32,42
z5 33,43
zbg 36,40,45
zay 37,41,46
zf 208,160,68
zw 34,32,33
zaz 32,43
za0 33,42
zw 35,42,43
zf 212,164,68
ze 0
za1 37,41
za2 37,47
za3 32,33
zas 33
za 0,192,72
za4 37,36
zq 34,35
zq 32,33
za5 33,48
za 4,196,72
zca 36,40
zcb 35
za6 10,37
z8 14,34,7
za 8,200,72
zk 0,21,2048
za 12,204,72
zv
zk 4,21,3072
zf 208,184,72
z8 16,32,7
zcc
zau 12,33,10
zcd
zf 212,188,72
zce
Lf5_azR1:
zdb
s_cbranch_scc1 Lf5_azG1
Lf5_azRb1:
zi 64,8,9216
zi 66,8,9232
zi 68,8,9280
zi 70,8,9296
za 16,144,76
zfo 0xffff0000
zi 72,8,9344
zi 74,8,9360
za 16,168,80
zf6 0xffff0000
zk 8,21,4096
za 16,192,84
zk 12,21,5120
za 20,148,76
za 20,172,80
za 20,196,84
zbl
zk 16,21,8192
za 24,152,76
ze 1
s_barrier
za7 28,24
za 24,176,80
za7 32,25
zk 20,21,9216
za 24,200,84
za7 36,26
zl 40,24,1024
za 28,156,76
zl 44,25,1024
zl 48,26,1024
za 28,180,80
za 28,204,84
zv
zk 24,21,10240
zf 216,136,76
zf 216,160,80
zf 216,184,84
zb0
zk 28,21,11264
zf 220,140,76
zf 220,164,80
zf 220,188,84
Lf5_azR2:
zdc
s_cbranch_scc1 Lf5_azG2
Lf5_azRb2:
zi 76,8,13824
zi 78,8,13840
zi 80,8,13888
zi 82,8,13904
za 32,144,64
ze 9
zi 84,8,13952
zi 86,8,13968
zm 32,28
zg 36,208
za 32,168,68
zm 33,29
zg 37,209
zm 34,30
zg 38,210
za 32,192,72
zm 35,31
zg 39,211
zg 32,36
zg 33,37
za 36,148,64
zg 34,38
zg 35,39
zc 36,32,33
zc 37,34,35
za 36,172,68
zk 32,21,14336
za 36,196,72
ze 7
zm 44,40
zg 48,212
zm 45,41
zg 49,213
za 40,152,64
s_barrier
zl 28,24,6144
zl 32,25,6144
zm 46,42
za 40,176,68
zk 36,21,15360
za 40,200,72
zg 50,214
zm 47,43
zg 51,215
zg 44,48
za 44,156,64
zl 40,24,7168
zg 45,49
zg 46,50
zg 47,51
za 44,180,68
zk 40,21,16384
za 44,204,72
zc 48,44,45
zc 49,46,47
zah 38,48,36
zf 224,136,64
zl 44,25,7168
zah 39,49,37
zai 36,48
zf 224,160,68
zk 44,21,17408
zf 224,184,72
zai 37,49
zf 228,140,64
zfn
zbf 36,22
zl 48,26,7168
zf 228,164,68
zl 36,26,6144
zf 228,188,72
Lf5_azR3:
zc5
s_cbranch_scc1 Lf5_azG3
Lf5_azRb3:
zi 64,8,18432
zi 66,8,18448
zi 68,8,18496
zi 70,8,18512
ze 10
za 48,144,76
zi 72,8,18560
zi 74,8,18576
zm 32,28
ze 6
zg 36,216
za 48,168,80
zm 33,29
zg 37,217
zm 34,30
zg 38,218
za 48,192,84
zm 35,31
zg 39,219
zg 32,36
zg 33,37
za 52,148,76
zg 34,38
zg 35,39
zc 36,32,33
zc 37,34,35
za 52,172,80
zk 48,21,2048
za 52,196,84
zm 44,40
zg 48,220
zm 45,41
zg 49,221
za 56,152,76
s_barrier
zl 28,24,12288
zl 32,25,12288
zm 46,42
za 56,176,80
zk 52,21,3072
za 56,200,84
zg 50,222
zm 47,43
zg 51,223
zg 44,48
za 60,156,76
zl 40,24,13312
zg 45,49
zg 46,50
zg 47,51
za 60,180,80
zk 56,21,4096
za 60,204,84
zc 48,44,45
zc 49,46,47
zah 38,48,36
zf 232,136,76
zl 44,25,13312
zah 39,49,37
zai 36,48
zf 232,160,80
zk 60,21,5120
zf 232,184,84
zai 37,49
zf 236,140,76
zbh 0xa800
zbf 36,22
zl 48,26,13312
zf 236,164,80
zl 36,26,12288
zf 236,188,84
Lf5_azR4:
Lf5_azH4:
ze 6
zm 32,28
ze 0
zg 36,224
zm 33,29
zg 37,225
z7 64,144
zm 34,30
zg 38,226
zm 35,31
zg 39,227
za 64,168,68
zg 32,36
zg 33,37
zg 34,38
zg 35,39
za 64,192,72
zc 36,32,33
zc 37,34,35
zm 44,40
zg 48,228
za 68,148,64
zm 45,41
zg 49,229
zm 46,42
zg 50,230
z7 68,172
zk 64,21,8192
za 68,196,72
zm 47,43
zg 51,231
zg 44,48
za 72,152,64
s_barrier
za7 28,24
za7 32,25
za 72,176,68
zl 40,24,1024
zk 68,21,9216
z7 72,200
zg 45,49
zg 46,50
zg 47,51
za 76,156,64
zc 48,44,45
zc 49,46,47
zah 38,48,36
za 76,180,68
zk 72,21,10240
za 76,204,72
zl 44,25,1024
zah 39,49,37
zai 36,48
zf 240,136,64
zai 37,49
zf 240,160,68
zbh 0x15000
zbf 36,22
zl 48,26,1024
zf 240,184,72
zk 76,21,11264
zf 244,140,64
za7 36,26
zf 244,164,68
zf 244,188,72
ze 1
s_barrier
zm 32,28
ze 0
zg 36,232
zm 33,29
zg 37,233
zm 34,30
zg 38,234
zm 35,31
zg 39,235
zg 32,36
zg 33,37
zg 34,38
zg 35,39
zc 36,32,33
zc 37,34,35
zm 44,40
zg 48,236
zm 45,41
zg 49,237
zm 46,42
zg 50,238
zm 47,43
zg 51,239
zg 44,48
zg 45,49
zg 46,50
zg 47,51
zc 48,44,45
zc 49,46,47
zah 38,48,36
zah 39,49,37
zai 36,48
zai 37,49
zl 28,24,6144
zl 32,25,6144
zl 40,24,7168
zl 44,25,7168
zl 48,26,7168
zbh 0x1f800
zbf 36,22
zv
zl 36,26,6144
ze 4
zm 32,28
zm 33,29
zm 34,30
zm 35,31
ze 2
zm 44,40
ze 1
zg 48,244
ze 0
zg 36,240
zg 37,241
zg 38,242
zg 39,243
zg 32,36
zg 33,37
zg 34,38
zg 35,39
zc 36,32,33
zc 37,34,35
zm 45,41
zg 49,245
zm 46,42
zg 50,246
zm 47,43
zg 51,247
zg 44,48
zg 45,49
zg 46,50
zg 47,51
zc 48,44,45
zc 49,46,47
zah 38,48,36
zah 39,49,37
zai 36,48
zai 37,49
zbh 0x2a000
zbf 36,22
s_endpgm
Lf5_ayR0:
zda
s_cbranch_scc1 Lf5_ayG0
Lf5_ayRb0:
zi 76,8,4608
zi 78,8,4624
zi 80,8,4672
zi 82,8,4688
ze 15
za 0,144,64
zu 0
zi 84,8,4736
zi 86,8,4752
zb 192,1,12352
zb 194,1,13888
za 4,148,64
zb 196,2,12352
zb 198,2,13888
zb 200,1,12416
zb 202,1,13952
za 8,152,64
zb 204,2,12416
zb 206,2,13952
zb 184,1,12288
zb 186,1,13824
za 12,156,64
zb 188,2,12288
zb 190,2,13824
zx 32,59
zr 33,59
zf 208,136,64
zci 34,44
zbs 35,29
z2 34
z2 35
zf 212,140,64
ze 15
zg 32,34
zg 33,35
zs 34
zs 35
za 0,168,68
zs 32
zs 33
zq 34,35
zq 32,33
za 4,172,68
zr 33,32
zav 32,34
zaw 32
z3 41,33
za 8,176,68
z3 40,32
z4 43,33,41
z4 42,32,40
zax 43
za 12,180,68
z5 32,42
z5 33,43
zbg 36,40,45
zay 37,41,46
zf 208,160,68
zw 34,32,33
zaz 32,43
za0 33,42
zw 35,42,43
zf 212,164,68
ze 0
za1 37,41
za2 37,47
za3 32,33
zas 33
za 0,192,72
za4 37,36
zq 34,35
zq 32,33
za5 33,48
za 4,196,72
zca 36,40
zcb 35
za6 10,37
z8 14,34,7
za 8,200,72
zk 0,21,2048
za 12,204,72
zv
zk 4,21,3072
zf 208,184,72
z8 16,32,7
zcc
zau 12,33,10
zcd
zf 212,188,72
zce
Lf5_ayR1:
zdb
s_cbranch_scc1 Lf5_ayG1
Lf5_ayRb1:
zi 64,8,9216
zi 66,8,9232
zi 68,8,9280
zi 70,8,9296
za 16,144,76
zi 72,8,9344
zi 74,8,9360
za 16,168,80
zk 8,21,4096
za 16,192,84
zk 12,21,5120
za 20,148,76
zdl 208,21
za 20,172,80
zat 212,21,1024
za 20,196,84
zam
zk 16,21,8192
za 24,152,76
za 24,176,80
za 24,200,84
ze 1
s_barrier
zk 20,21,9216
za 28,156,76
za 28,180,80
za 28,204,84
zam
zk 24,21,10240
zf 216,136,76
zf 216,160,80
zf 216,184,84
zam
zk 28,21,11264
zf 220,140,76
zf 220,164,80
zf 220,188,84
zam
zat 216,21,6144
Lf5_ayR2:
zdc
s_cbranch_scc1 Lf5_ayG2
Lf5_ayRb2:
zi 76,8,13824
zi 78,8,13840
zi 80,8,13888
zi 82,8,13904
za 32,144,64
zi 84,8,13952
zi 86,8,13968
za 32,168,68
zat 220,21,7168
za 32,192,72
za 36,148,64
za 36,172,68
za 36,196,72
za 40,152,64
ze 0
s_barrier
zam
zk 32,21,14336
za 40,176,68
zv
zk 36,21,15360
za 40,200,72
za 44,156,64
za 44,180,68
za 44,204,72
zf 224,136,64
zbl
zk 40,21,16384
zf 224,160,68
zv
zk 44,21,17408
zf 224,184,72
zf 228,140,64
zf 228,164,68
zf 228,188,72
zcr
zat 224,21,12288
Lf5_ayR3:
zc5
s_cbranch_scc1 Lf5_ayG3
Lf5_ayRb3:
zi 64,8,18432
zi 66,8,18448
zi 68,8,18496
zi 70,8,18512
za 48,144,76
zi 72,8,18560
zi 74,8,18576
za 48,168,80
zat 228,21,13312
za 48,192,84
za 52,148,76
za 52,172,80
za 52,196,84
za 56,152,76
ze 0
s_barrier
zam
zk 48,21,2048
za 56,176,80
zv
zk 52,21,3072
za 56,200,84
za 60,156,76
za 60,180,80
za 60,204,84
zf 232,136,76
zbl
zk 56,21,4096
zf 232,160,80
zv
zk 60,21,5120
zf 232,184,84
zf 236,140,76
zf 236,164,80
zf 236,188,84
zcr
zdl 232,21
Lf5_ayR4:
Lf5_ayH4:
z7 64,144
za 64,168,68
za 64,192,72
zcr
zat 236,21,1024
za 68,148,64
z7 68,172
za 68,196,72
zk 64,21,8192
za 72,152,64
ze 1
s_barrier
za 72,176,68
z7 72,200
zam
zk 68,21,9216
za 76,156,64
za 76,180,68
za 76,204,72
zam
zk 72,21,10240
zf 240,136,64
zf 240,160,68
zf 240,184,72
zam
zk 76,21,11264
zf 244,140,64
zf 244,164,68
zf 244,188,72
zam
zat 240,21,6144
zcr
zat 244,21,7168
ze 0
s_barrier
s_endpgm
Lf5_amH0:
Lf5_amG0:
zd6
s_cbranch_scc1 Lf5_amS0
zda
s_cbranch_scc0 Lf5_amRb0
ze 15
zf 208,136,64
ze3
zac 17,9,6
zac 18,11,6
zad 128,13,3
zf 212,140,64
zed
zo 88,17
zo 90,18
zb 92,17,16
za 0,144,64
zee 0x4800
zb 94,18,16
zb 96,17,64
zb 98,18,64
za 4,148,64
zef
zb 100,17,80
zb 102,18,80
zb 104,17,128
ze 15
za 8,152,64
zeg
zb 106,18,128
zb 108,17,144
zb 110,18,144
za 12,156,64
zeh 0x1200
zad 129,13,5
zad 130,15,3
zad 131,15,5
zf 208,160,68
zei
zu 0
zb 184,1,12288
zb 186,1,13824
zb 188,2,12288
zf 212,164,68
zej 0xd0
zb 190,2,13824
zb 192,1,12352
zb 194,1,13888
ze 15
zh 112,88,128
ze 14
zb 196,2,12352
zb 198,2,13888
zb 200,1,12416
zh 116,92,128
ze 15
zb 202,1,13952
zb 204,2,12416
zb 206,2,13952
zh 120,96,128
ze 15
zc 76,112,113
zc 77,114,115
zx 32,59
zh 124,100,128
zek 0x12d0
zc 78,116,117
zc 79,118,119
zr 33,59
ze 12
zh 112,104,128
zc 80,120,121
zc 81,122,123
zd 59,60
zh 116,108,128
zel
zc 82,124,125
zc 83,126,127
zd 60,61
za 0,168,68
zem
zc 84,112,113
zc 85,114,115
zd 61,62
za 4,172,68
zen
zc 86,116,117
zc 87,118,119
zd 62,63
za 8,176,68
zeo
zci 34,44
zbs 35,29
z2 34
za 12,180,68
ze 0
z2 35
zg 32,34
zg 33,35
zf 208,184,72
zs 34
zs 35
zf 212,188,72
zs 32
zs 33
za 0,192,72
zq 34,35
zq 32,33
za 4,196,72
zr 33,32
zav 32,34
za 8,200,72
zaw 32
z3 41,33
za 12,204,72
Lf5_amH1:
Lf5_amG1:
zd7
s_cbranch_scc1 Lf5_amS1
zdb
s_cbranch_scc0 Lf5_amRb1
zf 216,136,76
zaj 17,9,6
zaj 18,11,6
zak 128,13,3
zf 216,160,80
zo 88,17
zo 90,18
zb 92,17,16
zf 216,184,84
zb 94,18,16
zb 96,17,64
zb 98,18,64
zf 220,140,76
zb 100,17,80
zb 102,18,80
zb 104,17,128
zf 220,164,80
zb 106,18,128
zb 108,17,144
zb 110,18,144
zf 220,188,84
zak 129,13,5
zak 130,15,3
zak 131,15,5
za 16,144,76
zcg
zcu
z0 38
za 16,168,80
ze 10
zn 39,1024
zn 49,2048
zh 112,88,128
ze 8
zn 38,3072
z6 0x1000
zag 0x1000
z0 39
zh 116,92,128
ze 3
zn 49,1024
zc 64,112,113
zh 120,96,128
zn 38,2048
zc 65,114,115
zh 124,100,128
ze 0
zn 39,3072
zc 66,116,117
zc 67,118,119
zh 112,104,128
zc 68,120,121
zc 69,122,123
zh 116,108,128
zc 70,124,125
zc 71,126,127
za 16,192,84
z6 0x2000
zag 0x2000
z0 49
za 20,148,76
zc 72,112,113
zc 73,114,115
za 20,172,80
zc 74,116,117
zc 75,118,119
za 20,196,84
z3 40,32
z4 43,33,41
za 24,152,76
z4 42,32,40
zax 43
za 24,176,80
z5 32,42
z5 33,43
za 24,200,84
zbg 36,40,45
zay 37,41,46
za 28,156,76
zw 34,32,33
zaz 32,43
za 28,180,80
za0 33,42
za 28,204,84
Lf5_amH2:
Lf5_amG2:
zd8
s_cbranch_scc1 Lf5_amS2
zdc
s_cbranch_scc0 Lf5_amRb2
ze 0
zf 224,136,64
zaq 17,9,6
zaq 18,11,6
zar 128,13,3
zf 228,140,64
zo 88,17
zo 90,18
zb 92,17,16
za 32,144,64
zb 94,18,16
zb 96,17,64
zb 98,18,64
za 36,148,64
zb 100,17,80
zb 102,18,80
zb 104,17,128
za 40,152,64
zb 106,18,128
zb 108,17,144
zb 110,18,144
za 44,156,64
zar 129,13,5
zar 130,15,3
zar 131,15,5
zf 224,160,68
zn 38,1024
zn 39,2048
zf 228,164,68
ze 10
zn 49,3072
z6 0x3000
zag 0x3000
z0 38
zh 112,88,128
ze 8
zn 39,1024
zn 49,2048
zh 116,92,128
ze 3
zn 38,3072
z6 0x4000
zag 0x4000
z0 39
zh 120,96,128
zc 76,112,113
zc 77,114,115
zc 78,116,117
zh 124,100,128
ze 0
zn 49,1024
zc 79,118,119
zh 112,104,128
zc 80,120,121
zc 81,122,123
zw 35,42,43
zh 116,108,128
zc 82,124,125
zc 83,126,127
za 32,168,68
zv
zc 64,112,113
zc 65,114,115
za 36,172,68
za1 37,41
zc 66,116,117
za 40,176,68
zc 67,118,119
za2 37,47
za 44,180,68
za3 32,33
zas 33
zf 224,184,72
za4 37,36
zq 34,35
zf 228,188,72
zq 32,33
za5 33,48
za 32,192,72
zca 36,40
zcb 35
za 36,196,72
za6 10,37
z8 14,34,7
z8 16,32,7
za 40,200,72
zcc
zau 12,33,10
zcd
zce
za 44,204,72
Lf5_amH3:
Lf5_amG3:
zdt
s_cbranch_scc1 Lf5_amS3
zc5
s_cbranch_scc0 Lf5_amRb3
ze 0
zf 232,136,76
zaa 17,10,6
zaa 18,12,6
zab 128,14,3
zab 129,14,5
zf 236,140,76
zo 88,17
zo 90,18
zb 92,17,16
zb 94,18,16
za 48,144,76
zb 96,17,64
zb 98,18,64
zb 100,17,80
zb 102,18,80
za 52,148,76
zb 104,17,128
zb 106,18,128
zb 108,17,144
zb 110,18,144
za 56,152,76
zab 130,16,3
zab 131,16,5
zx 32,54
zr 33,54
za 60,156,76
zd 54,55
zd 55,56
zd 56,57
zdx 34,44
zf 232,160,80
ze 10
zcj 35,29
z2 34
z2 35
zg 32,34
zh 112,88,128
ze 8
zg 33,35
zs 34
zs 35
zs 32
zh 116,92,128
ze 6
zs 33
zq 34,35
zq 32,33
zh 120,96,128
ze 4
zc 72,112,113
zc 73,114,115
zr 33,32
zh 124,100,128
ze 0
zc 74,116,117
zc 75,118,119
zav 32,34
zh 112,104,128
zc 84,120,121
zc 85,122,123
zaw 32
zh 116,108,128
zc 86,124,125
zc 87,126,127
z3 41,33
zf 236,164,80
zc 76,112,113
zc 77,114,115
z3 40,32
za 48,168,80
zc 78,116,117
zc 79,118,119
z4 43,33,41
za 52,172,80
z4 42,32,40
zax 43
z5 32,42
za 56,176,80
z5 33,43
zbg 36,40,45
zay 37,41,46
za 60,180,80
zw 34,32,33
zaz 32,43
za0 33,42
zf 232,184,64
zw 35,42,43
za1 37,41
za2 37,47
zf 236,188,64
za3 32,33
zas 33
za4 37,36
za 48,192,64
zq 34,35
zq 32,33
za5 33,48
za 52,196,64
zdf 36,40
zdg 35
za6 9,37
z8 13,34,7
za 56,200,64
z8 15,32,7
zdh
zau 11,33,9
zdi
za 60,204,64
zdj
Lf5_amH4:
Lf5_amG4:
zct
s_cbranch_scc1 Lf5_amS4
zcf
s_cbranch_scc0 Lf5_amRb4
ze 0
zf 240,136,72
zbn
zbq 8,0
zaa 17,9,6
zaa 18,11,6
zf 244,140,72
zbo
zo 88,17
zo 90,18
zb 92,17,16
za 64,144,72
zbp
zb 94,18,16
zb 96,17,64
zb 98,18,64
za 68,148,72
zf5
zb 100,17,80
zb 102,18,80
zb 104,17,128
z7 72,152
zb 106,18,128
zb 108,17,144
zb 110,18,144
za 76,156,72
zab 128,13,3
zab 129,13,5
zab 130,15,3
zf 240,160,84
zu 12
zo 136,1
zb 138,1,1536
zab 131,15,5
zf 244,164,84
ze 12
zo 140,2
zb 142,2,1536
zb 144,1,64
zh 112,88,128
ze 13
zb 146,1,1600
zb 148,2,64
zb 150,2,1600
zh 116,92,128
ze 14
zb 152,1,128
zb 154,1,1664
zh 120,96,128
ze 14
zc 64,112,113
zc 65,114,115
zh 124,100,128
zb 156,2,128
zc 66,116,117
za 64,168,84
ze 11
zc 67,118,119
zc 68,120,121
zh 112,104,128
zc 69,122,123
zc 70,124,125
zh 116,108,128
zb 158,2,1664
zc 71,126,127
za 68,172,84
za 72,176,84
zv
zc 72,112,113
zc 73,114,115
za 76,180,84
zu 6
zb 160,1,6144
zc 74,116,117
zc 75,118,119
zf 240,184,76
zb 162,1,7680
zb 164,2,6144
zb 166,2,7680
zf 244,188,76
zb 168,1,6208
zb 170,1,7744
za 64,192,76
zb 172,2,6208
zb 174,2,7744
za 68,196,76
zb 176,1,6272
zb 178,1,7808
za 72,200,76
zb 180,2,6272
zb 182,2,7808
z7 76,204
Lf5_amE2:
zgx
s_cbranch_scc1 Lf5_amH0
zde
s_cbranch_scc1 Lf5_ayH0
s_branch Lf5_azH0
Lf5_azH0:
Lf5_azG0:
zd6
s_cbranch_scc1 Lf5_azS0
zda
s_cbranch_scc0 Lf5_azRb0
ze 15
za 0,144,64
zac 17,9,6
zac 18,11,6
zad 128,13,3
zad 129,13,5
zad 130,15,3
za 4,148,64
ze 12
zo 88,17
zo 90,18
zb 92,17,16
zb 94,18,16
zb 96,17,64
za 8,152,64
zb 98,18,64
zb 100,17,80
zb 102,18,80
zb 104,17,128
za 12,156,64
zb 106,18,128
zb 108,17,144
zb 110,18,144
zad 131,15,5
zf 208,136,64
zu 0
zb 192,1,12352
zb 194,1,13888
zb 196,2,12352
zb 198,2,13888
zf 212,140,64
ze 15
zb 200,1,12416
zb 202,1,13952
zb 204,2,12416
zb 206,2,13952
za 0,168,68
ze 15
zb 184,1,12288
zb 186,1,13824
zb 188,2,12288
zb 190,2,13824
zh 112,88,128
zx 32,59
zr 33,59
zci 34,44
zbs 35,29
zh 116,92,128
ze 15
z2 34
z2 35
zg 32,34
zc 76,112,113
zh 120,96,128
zc 77,114,115
zg 33,35
zs 34
zc 78,116,117
zh 124,100,128
ze 11
zc 79,118,119
zs 35
zs 32
zc 80,120,121
zh 112,104,128
zc 81,122,123
zs 33
zc 82,124,125
zc 83,126,127
zh 116,108,128
zq 34,35
zq 32,33
zr 33,32
zc 84,112,113
za 4,172,68
zc 85,114,115
zav 32,34
zaw 32
zc 86,116,117
za 8,176,68
zc 87,118,119
z3 41,33
z3 40,32
z4 43,33,41
za 12,180,68
z4 42,32,40
zax 43
z5 32,42
z5 33,43
zf 208,160,68
zbg 36,40,45
zay 37,41,46
zw 34,32,33
zaz 32,43
zf 212,164,68
ze 0
za0 33,42
zw 35,42,43
za1 37,41
za2 37,47
za 0,192,72
za3 32,33
zas 33
za4 37,36
zq 34,35
za 4,196,72
zq 32,33
za5 33,48
zca 36,40
zcb 35
za 8,200,72
zk 0,21,2048
za 12,204,72
zv
zk 4,21,3072
za6 10,37
zf 208,184,72
z8 14,34,7
z8 16,32,7
zcc
zau 12,33,10
zcd
zf 212,188,72
zce
Lf5_azH1:
Lf5_azG1:
zd7
s_cbranch_scc1 Lf5_azS1
zdb
s_cbranch_scc0 Lf5_azRb1
za 16,144,76
zfo 0xffff0000
zaj 17,9,6
zaj 18,11,6
zak 128,13,3
za 16,168,80
zf6 0xffff0000
zo 88,17
zo 90,18
zb 92,17,16
za 16,192,84
zb 94,18,16
zb 96,17,64
zb 98,18,64
za 20,148,76
zb 100,17,80
zb 102,18,80
zb 104,17,128
za 20,172,80
zb 106,18,128
zb 108,17,144
zb 110,18,144
za 20,196,84
zak 129,13,5
zak 130,15,3
zak 131,15,5
za 24,152,76
zk 8,21,4096
za 24,176,80
ze 11
zk 12,21,5120
zh 112,88,128
ze 10
zk 16,21,8192
zh 116,92,128
ze 9
zk 20,21,9216
zh 120,96,128
ze 2
s_barrier
za7 28,24
za7 32,25
zh 124,100,128
za7 36,26
zl 40,24,1024
za 24,200,84
zl 44,25,1024
zl 48,26,1024
za 28,156,76
zc 64,112,113
zc 65,114,115
za 28,180,80
zc 66,116,117
zc 67,118,119
zh 112,104,128
zk 24,21,10240
zh 116,108,128
zc 68,120,121
zc 69,122,123
za 28,204,84
zc 70,124,125
zc 71,126,127
zf 216,136,76
zc 72,112,113
zc 73,114,115
zf 216,160,80
zc 74,116,117
zc 75,118,119
zf 216,184,84
zk 28,21,11264
zf 220,140,76
zf 220,164,80
zf 220,188,84
Lf5_azH2:
Lf5_azG2:
zd8
s_cbranch_scc1 Lf5_azS2
zdc
s_cbranch_scc0 Lf5_azRb2
za 32,144,64
zaq 17,9,6
zaq 18,11,6
zar 128,13,3
zar 129,13,5
za 32,168,68
zo 88,17
zo 90,18
zb 92,17,16
zb 94,18,16
za 32,192,72
zb 96,17,64
zb 98,18,64
zb 100,17,80
zb 102,18,80
za 36,148,64
zb 104,17,128
zb 106,18,128
zb 108,17,144
zb 110,18,144
za 36,172,68
zk 32,21,14336
zar 130,15,3
zar 131,15,5
za 36,196,72
ze 13
zm 32,28
zg 36,208
zm 33,29
zg 37,209
za 40,152,64
s_barrier
zm 34,30
zg 38,210
zm 35,31
ze 11
zh 112,88,128
ze 9
zk 36,21,15360
zh 116,92,128
ze 8
zl 28,24,6144
zg 39,211
zg 32,36
zg 33,37
zh 120,96,128
ze 7
zg 34,38
zg 35,39
zc 36,32,33
zc 37,34,35
zh 124,100,128
zl 32,25,6144
zc 76,112,113
zc 77,114,115
zc 78,116,117
za 40,176,68
ze 4
zc 79,118,119
zc 80,120,121
zc 81,122,123
zc 82,124,125
zh 112,104,128
zc 83,126,127
zm 44,40
zg 48,212
zm 45,41
zh 116,108,128
zg 49,213
zm 46,42
zg 50,214
zc 84,112,113
za 40,200,72
zc 85,114,115
zm 47,43
zg 51,215
zc 86,116,117
za 44,156,64
zl 40,24,7168
zc 87,118,119
zg 44,48
zg 45,49
za 44,180,68
zk 40,21,16384
za 44,204,72
zg 46,50
zg 47,51
zc 48,44,45
zc 49,46,47
zf 224,136,64
zl 44,25,7168
zah 38,48,36
zah 39,49,37
zf 224,160,68
zk 44,21,17408
zf 224,184,72
zai 36,48
zai 37,49
zf 228,140,64
zfn
zbf 36,22
zl 48,26,7168
zf 228,164,68
zl 36,26,6144
zf 228,188,72
Lf5_azH3:
Lf5_azG3:
zdt
s_cbranch_scc1 Lf5_azS3
zc5
s_cbranch_scc0 Lf5_azRb3
ze 6
za 48,144,76
zaa 17,10,6
zaa 18,12,6
zab 128,14,3
zab 129,14,5
za 48,168,80
zo 88,17
zo 90,18
zb 92,17,16
zb 94,18,16
za 48,192,84
zb 96,17,64
zb 98,18,64
zb 100,17,80
zb 102,18,80
za 52,148,76
zb 104,17,128
zb 106,18,128
zb 108,17,144
zb 110,18,144
za 52,172,80
zk 48,21,2048
zab 130,16,3
zab 131,16,5
za 52,196,84
ze 13
zm 32,28
zg 36,216
zm 33,29
zg 37,217
za 56,152,76
s_barrier
zm 34,30
zg 38,218
zm 35,31
ze 11
zh 112,88,128
ze 9
zk 52,21,3072
zh 116,92,128
ze 8
zl 28,24,12288
zg 39,219
zg 32,36
zg 33,37
zh 120,96,128
ze 7
zg 34,38
zg 35,39
zc 36,32,33
zc 37,34,35
zh 124,100,128
zl 32,25,12288
zc 64,112,113
zc 65,114,115
zc 66,116,117
za 56,176,80
ze 4
zc 67,118,119
zc 68,120,121
zc 69,122,123
zc 70,124,125
zh 112,104,128
zc 71,126,127
zm 44,40
zg 48,220
zm 45,41
zh 116,108,128
zg 49,221
zm 46,42
zg 50,222
zc 72,112,113
za 56,200,84
zc 73,114,115
zm 47,43
zg 51,223
zc 74,116,117
za 60,156,76
zl 40,24,13312
zc 75,118,119
zg 44,48
zg 45,49
za 60,180,80
zk 56,21,4096
za 60,204,84
zg 46,50
zg 47,51
zc 48,44,45
zc 49,46,47
zf 232,136,76
zl 44,25,13312
zah 38,48,36
zah 39,49,37
zf 232,160,80
zk 60,21,5120
zf 232,184,84
zai 36,48
zai 37,49
zf 236,140,76
zbh 0xa800
zbf 36,22
zl 48,26,13312
zf 236,164,80
zl 36,26,12288
zf 236,188,84
s_branch Lf5_azR4
Lf5_azE2:
Lf5_ayH0:
Lf5_ayG0:
zd6
s_cbranch_scc1 Lf5_ayS0
zda
s_cbranch_scc0 Lf5_ayRb0
ze 15
za 0,144,64
zac 17,9,6
zac 18,11,6
zad 128,13,3
zad 129,13,5
zad 130,15,3
za 4,148,64
ze 12
zo 88,17
zo 90,18
zb 92,17,16
zb 94,18,16
zb 96,17,64
za 8,152,64
zb 98,18,64
zb 100,17,80
zb 102,18,80
zb 104,17,128
za 12,156,64
zb 106,18,128
zb 108,17,144
zb 110,18,144
zad 131,15,5
zf 208,136,64
zu 0
zb 192,1,12352
zb 194,1,13888
zb 196,2,12352
zb 198,2,13888
zf 212,140,64
ze 15
zb 200,1,12416
zb 202,1,13952
zb 204,2,12416
zb 206,2,13952
za 0,168,68
ze 15
zb 184,1,12288
zb 186,1,13824
zb 188,2,12288
zb 190,2,13824
zh 112,88,128
zx 32,59
zr 33,59
zci 34,44
zbs 35,29
zh 116,92,128
ze 15
z2 34
z2 35
zg 32,34
zc 76,112,113
zh 120,96,128
zc 77,114,115
zg 33,35
zs 34
zc 78,116,117
zh 124,100,128
ze 11
zc 79,118,119
zs 35
zs 32
zc 80,120,121
zh 112,104,128
zc 81,122,123
zs 33
zc 82,124,125
zc 83,126,127
zh 116,108,128
zq 34,35
zq 32,33
zr 33,32
zc 84,112,113
za 4,172,68
zc 85,114,115
zav 32,34
zaw 32
zc 86,116,117
za 8,176,68
zc 87,118,119
z3 41,33
z3 40,32
z4 43,33,41
za 12,180,68
z4 42,32,40
zax 43
z5 32,42
z5 33,43
zf 208,160,68
zbg 36,40,45
zay 37,41,46
zw 34,32,33
zaz 32,43
zf 212,164,68
ze 0
za0 33,42
zw 35,42,43
za1 37,41
za2 37,47
za 0,192,72
za3 32,33
zas 33
za4 37,36
zq 34,35
za 4,196,72
zq 32,33
za5 33,48
zca 36,40
zcb 35
za 8,200,72
zk 0,21,2048
za 12,204,72
zv
zk 4,21,3072
za6 10,37
zf 208,184,72
z8 14,34,7
z8 16,32,7
zcc
zau 12,33,10
zcd
zf 212,188,72
zce
Lf5_ayH1:
Lf5_ayG1:
zd7
s_cbranch_scc1 Lf5_ayS1
zdb
s_cbranch_scc0 Lf5_ayRb1
za 16,144,76
zaj 17,9,6
zaj 18,11,6
zak 128,13,3
za 16,168,80
zo 88,17
zo 90,18
zb 92,17,16
za 16,192,84
zb 94,18,16
zb 96,17,64
zb 98,18,64
za 20,148,76
zb 100,17,80
zb 102,18,80
zb 104,17,128
za 20,172,80
zb 106,18,128
zb 108,17,144
zb 110,18,144
za 20,196,84
zak 129,13,5
zak 130,15,3
zak 131,15,5
za 24,152,76
zk 8,21,4096
za 24,176,80
ze 11
zk 12,21,5120
zh 112,88,128
ze 10
zdl 208,21
zh 116,92,128
ze 9
zat 212,21,1024
zh 120,96,128
ze 8
zk 16,21,8192
zh 124,100,128
zk 20,21,9216
za 24,200,84
ze 2
s_barrier
zc 64,112,113
zc 65,114,115
za 28,156,76
zc 66,116,117
zc 67,118,119
zc 68,120,121
zh 112,104,128
zk 24,21,10240
zc 69,122,123
zh 116,108,128
zc 70,124,125
zc 71,126,127
za 28,180,80
zam
zc 72,112,113
zc 73,114,115
za 28,204,84
zf 216,136,76
zc 74,116,117
zc 75,118,119
zf 216,160,80
zf 216,184,84
zf 220,140,76
zam
zk 28,21,11264
zf 220,164,80
zb0
zat 216,21,6144
zf 220,188,84
Lf5_ayH2:
Lf5_ayG2:
zd8
s_cbranch_scc1 Lf5_ayS2
zdc
s_cbranch_scc0 Lf5_ayRb2
za 32,144,64
zaq 17,9,6
zaq 18,11,6
zar 128,13,3
za 32,168,68
zo 88,17
zo 90,18
zb 92,17,16
za 32,192,72
zb 94,18,16
zb 96,17,64
zb 98,18,64
za 36,148,64
zb 100,17,80
zb 102,18,80
zb 104,17,128
za 36,172,68
zb 106,18,128
zb 108,17,144
zb 110,18,144
za 36,196,72
zar 129,13,5
zar 130,15,3
zar 131,15,5
za 40,152,64
zat 220,21,7168
za 40,176,68
ze 11
zk 32,21,14336
zh 112,88,128
ze 10
zk 36,21,15360
zh 116,92,128
ze 2
s_barrier
zh 120,96,128
zh 124,100,128
zv
zc 76,112,113
zc 77,114,115
za 40,200,72
za 44,156,64
zc 78,116,117
zc 79,118,119
zc 80,120,121
zh 112,104,128
zb0
zk 40,21,16384
zc 81,122,123
zh 116,108,128
zc 82,124,125
zc 83,126,127
za 44,180,68
zc 84,112,113
zc 85,114,115
za 44,204,72
zf 224,136,64
zv
zc 86,116,117
zc 87,118,119
zf 224,160,68
zf 224,184,72
zf 228,140,64
zv
zk 44,21,17408
zf 228,164,68
zbl
zat 224,21,12288
zf 228,188,72
Lf5_ayH3:
Lf5_ayG3:
zdt
s_cbranch_scc1 Lf5_ayS3
zc5
s_cbranch_scc0 Lf5_ayRb3
za 48,144,76
zaa 17,10,6
zaa 18,12,6
zab 128,14,3
za 48,168,80
zo 88,17
zo 90,18
zb 92,17,16
za 48,192,84
zb 94,18,16
zb 96,17,64
zb 98,18,64
za 52,148,76
zb 100,17,80
zb 102,18,80
zb 104,17,128
za 52,172,80
zb 106,18,128
zb 108,17,144
zb 110,18,144
za 52,196,84
zab 129,14,5
zab 130,16,3
zab 131,16,5
za 56,152,76
zat 228,21,13312
za 56,176,80
ze 11
zk 48,21,2048
zh 112,88,128
ze 10
zk 52,21,3072
zh 116,92,128
ze 2
s_barrier
zh 120,96,128
zh 124,100,128
zv
zc 64,112,113
zc 65,114,115
za 56,200,84
za 60,156,76
zc 66,116,117
zc 67,118,119
zc 68,120,121
zh 112,104,128
zb0
zk 56,21,4096
zc 69,122,123
zh 116,108,128
zc 70,124,125
zc 71,126,127
za 60,180,80
zc 72,112,113
zc 73,114,115
za 60,204,84
zf 232,136,76
zv
zc 74,116,117
zc 75,118,119
zf 232,160,80
zf 232,184,84
zf 236,140,76
zv
zk 60,21,5120
zf 236,164,80
zbl
zdl 232,21
zf 236,188,84
s_branch Lf5_ayR4
Lf5_ayE2:
Lf5_aqH0:
zu 19
s_barrier
Lf5_aqG0:
zct
s_cbranch_scc1 Lf5_aqS0
zcf
s_cbranch_scc0 Lf5_aqRb0
zaa 17,9,6
zaa 18,11,6
zab 128,13,3
zab 129,13,5
zab 130,15,3
zab 131,15,5
zo 88,17
zo 90,18
zb 92,17,16
zb 94,18,16
zb 96,17,64
zb 98,18,64
zb 100,17,80
zb 102,18,80
zb 104,17,128
zb 106,18,128
zb 108,17,144
zb 110,18,144
zu 13
zo 136,1
zb 138,1,1536
zo 140,2
zb 142,2,1536
zb 144,1,64
zb 146,1,1600
zb 148,2,64
zb 150,2,1600
zb 152,1,128
zb 154,1,1664
zb 156,2,128
zb 158,2,1664
zu 7
zb 160,1,6144
zb 162,1,7680
zb 164,2,6144
zb 166,2,7680
zb 168,1,6208
zb 170,1,7744
zb 172,2,6208
zb 174,2,7744
zb 176,1,6272
ze 15
zh 112,88,128
zb 178,1,7808
zb 180,2,6272
zb 182,2,7808
zh 116,92,128
zh 120,96,128
zh 124,100,128
zam
zc 64,112,113
zc 65,114,115
zam
zc 66,116,117
zc 67,118,119
zh 112,104,128
zc 68,120,121
zc 69,122,123
zc 70,124,125
zc 71,126,127
zh 116,108,128
zb0
zc 72,112,113
zc 73,114,115
zb0
zc 74,116,117
zc 75,118,119
Lf5_aqE2:
s_branch Lf5_atH0
Lf5_atH0:
Lf5_atG0:
zd6
s_cbranch_scc1 Lf5_atS0
zda
s_cbranch_scc0 Lf5_atRb0
ze 15
zh 208,136,64
zac 17,9,6
zac 18,11,6
zad 128,13,3
zh 212,140,64
zo 88,17
zo 90,18
zb 92,17,16
zp 0,144,64
zb 94,18,16
zb 96,17,64
zb 98,18,64
zp 4,148,64
ze 15
zb 100,17,80
zb 102,18,80
zb 104,17,128
zp 8,152,64
zb 106,18,128
zb 108,17,144
zb 110,18,144
zp 12,156,64
zad 129,13,5
zad 130,15,3
zad 131,15,5
zf 208,160,68
zu 1
zb 184,1,12288
zb 186,1,13824
zb 188,2,12288
ze 15
zf 212,164,68
ze 13
zb 190,2,13824
zb 192,1,12352
zb 194,1,13888
zh 112,88,128
ze 14
zb 196,2,12352
zb 198,2,13888
zb 200,1,12416
zh 116,92,128
ze 15
zb 202,1,13952
zb 204,2,12416
zb 206,2,13952
zh 120,96,128
zf1
zcv
zcw 0xdf
zbt 0xa800
zdd 0x9000
zc 76,112,113
zc 77,114,115
ze 12
zh 124,100,128
zc 78,116,117
zc 79,118,119
zh 112,104,128
zc 80,120,121
zc 81,122,123
zh 116,108,128
zam
zc 82,124,125
zc 83,126,127
za 0,168,68
zid
zgk
s_cselect_b32 s42, 0x1e800, s42
za 4,172,68
zc 84,112,113
zc 85,114,115
za 8,176,68
zc 86,116,117
zc 87,118,119
za 12,180,68
zcx
zv
zae 21
ze 0
zf 208,184,72
zan 0x400
zv
zae 22
zf 212,188,72
zan 0x800
zv
zae 23
za 0,192,72
zan 0xc00
zv
zae 24
za 4,196,72
zcy 0x3fffffff
zan 0x1000
zv
zae 25
zcz
za 8,200,72
za 12,204,72
Lf5_atH1:
Lf5_atG1:
zd7
s_cbranch_scc1 Lf5_atS1
zdb
s_cbranch_scc0 Lf5_atRb1
ze 0
zh 216,136,76
zaj 17,9,6
zaj 18,11,6
zak 128,13,3
zak 129,13,5
zf 216,160,80
zo 88,17
zo 90,18
zb 92,17,16
zb 94,18,16
zf 216,184,84
zb 96,17,64
zb 98,18,64
zb 100,17,80
zb 102,18,80
zh 220,140,76
zb 104,17,128
zb 106,18,128
zb 108,17,144
zb 110,18,144
zf 220,164,80
zf2 28,31
ze5
zc6 56,31,16
zak 130,15,3
zak 131,15,5
zf 220,188,84
zc8 0x15e00
zc6 62,31,16
z6 0x3000
zc7 0x3000
z0 38
zp 16,144,76
ze 10
zn 39,1024
zn 49,2048
zh 112,88,128
ze 8
zn 38,3072
z6 0x4000
zc7 0x4000
z0 39
zh 116,92,128
ze 0
zn 49,1024
zc 64,112,113
zc 65,114,115
zh 120,96,128
zcg
zcu
z0 38
zc 66,116,117
zh 124,100,128
zn 39,1024
zc 67,118,119
zv
zc 68,120,121
zh 112,104,128
zn 49,2048
zc 69,122,123
zv
zc 70,124,125
zh 116,108,128
zu 17
zc 71,126,127
zx 32,58
zr 33,58
zc 72,112,113
za 16,168,80
zc 73,114,115
zci 34,44
zbs 35,29
zc 74,116,117
za 16,192,84
zc 75,118,119
z2 34
z2 35
zg 32,34
zp 20,148,76
zg 33,35
zs 34
zs 35
zs 32
za 20,172,80
zs 33
zq 34,35
zq 32,33
zr 33,32
za 20,196,84
zav 32,34
zaw 32
z3 41,33
z3 40,32
zp 24,152,76
z4 43,33,41
z4 42,32,40
zci 34,44
z2 34
za 24,176,80
zd1 35,45
zd2 34,35
zax 43
za 24,200,84
z5 32,42
z5 33,43
zd3 36,40,45,34
zp 28,156,76
zay 37,41,46
zw 34,32,33
zaz 32,43
za 28,180,80
za0 33,42
zbr 0xc800
zdw 1
zdw 2
za 28,204,84
Lf5_atH2:
zu 12
s_barrier
Lf5_atG2:
zd8
s_cbranch_scc1 Lf5_atS2
zdc
s_cbranch_scc0 Lf5_atRb2
ze 0
zh 224,136,64
zaq 17,9,6
zaq 18,11,6
zar 128,13,3
zar 129,13,5
zh 228,140,64
zo 88,17
zo 90,18
zb 92,17,16
zb 94,18,16
zp 32,144,64
zb 96,17,64
zb 98,18,64
zb 100,17,80
zb 102,18,80
zp 36,148,64
zb 104,17,128
zb 106,18,128
zb 108,17,144
zb 110,18,144
zp 40,152,64
zn 38,3072
zar 130,15,3
zar 131,15,5
zp 44,156,64
z6 0x1000
zag 0x1000
z0 39
zf 224,160,68
ze 10
zn 49,1024
zn 38,2048
zh 112,88,128
ze 8
zn 39,3072
z6 0x2000
zag 0x2000
z0 49
zh 116,92,128
ze 2
zn 38,1024
zc 76,112,113
zh 120,96,128
zn 39,2048
zc 77,114,115
zh 124,100,128
zn 49,3072
zc 78,116,117
zc 79,118,119
zh 112,104,128
ze 0
zc 80,120,121
zc 81,122,123
zv
zc 82,124,125
zh 116,108,128
zc 83,126,127
zw 35,42,43
za1 37,41
zf 228,164,68
zc 64,112,113
zc 65,114,115
za2 37,47
za 32,168,68
zc 66,116,117
zc 67,118,119
za3 32,33
za 36,172,68
zas 33
za4 37,36
zq 34,35
za 40,176,68
zq 32,33
za5 33,48
zca 36,40
za 44,180,68
zcb 35
za6 10,37
z8 14,34,7
zf 224,184,72
z8 16,32,7
zcc
zf 228,188,72
zau 12,33,10
zcd
zce
za 32,192,72
zx 32,53
zr 33,53
zdx 34,44
za 36,196,72
zcj 35,29
z2 34
z2 35
za 40,200,72
zg 32,34
zg 33,35
za 44,204,72
Lf5_atH3:
Lf5_atG3:
zdt
s_cbranch_scc1 Lf5_atS3
zc5
s_cbranch_scc0 Lf5_atRb3
ze 0
zh 232,136,76
zaa 17,10,6
zaa 18,12,6
zab 128,14,3
zab 129,14,5
zab 130,16,3
zh 236,140,76
zo 88,17
zo 90,18
zb 92,17,16
zb 94,18,16
zb 96,17,64
zp 48,144,76
zb 98,18,64
zb 100,17,80
zb 102,18,80
zb 104,17,128
zb 106,18,128
zp 52,148,76
zb 108,17,144
zb 110,18,144
zab 131,16,5
zs 34
zs 35
zp 56,152,76
zs 32
zs 33
zq 34,35
zq 32,33
zr 33,32
zp 60,156,76
ze 10
zav 32,34
zaw 32
z3 41,33
z3 40,32
z4 43,33,41
zh 112,88,128
ze 8
z4 42,32,40
zax 43
z5 32,42
z5 33,43
zbg 36,40,45
zh 116,92,128
ze 6
zay 37,41,46
zw 34,32,33
zc 72,112,113
zc 73,114,115
zaz 32,43
zh 120,96,128
ze 2
za0 33,42
zw 35,42,43
zc 74,116,117
zc 75,118,119
za1 37,41
zh 124,100,128
za2 37,47
za3 32,33
zc 84,120,121
zc 85,122,123
zas 33
zh 112,104,128
ze 0
za4 37,36
zq 34,35
zc 86,124,125
zc 87,126,127
zq 32,33
zh 116,108,128
za5 33,48
zdf 36,40
zc 76,112,113
zc 77,114,115
zdg 35
zf 232,160,80
za6 9,37
z8 13,34,7
zc 78,116,117
zc 79,118,119
z8 15,32,7
zf 236,164,80
zdh
zau 11,33,9
zdi
zdj
zu 20
zx 32,28
zr 33,28
za 48,168,80
zf3 34,44
ze2 35,29
z2 34
z2 35
zg 32,34
za 52,172,80
zg 33,35
zs 34
zs 35
zs 32
zs 33
za 56,176,80
zq 34,35
zq 32,33
zr 33,32
zav 32,34
zaw 32
za 60,180,80
z3 41,33
z3 40,32
z4 43,33,41
z4 42,32,40
zax 43
zf 232,184,64
z5 32,42
z5 33,43
zbg 36,40,45
zay 37,41,46
zw 34,32,33
zf 236,188,64
zaz 32,43
za0 33,42
zw 35,42,43
za1 37,41
za2 37,47
za 48,192,64
za3 32,33
zas 33
za4 37,36
zq 34,35
za 52,196,64
zq 32,33
za5 33,48
zca 36,40
zcb 35
za6 10,37
za 56,200,64
z8 14,34,7
z8 16,32,7
zcc
zau 12,33,10
zcd
za 60,204,64
zce
Lf5_atH4:
zu 12
s_barrier
Lf5_atG4:
zdt
s_cbranch_scc1 Lf5_atS4
zc5
s_cbranch_scc0 Lf5_atRb4
ze 0
zh 240,136,72
zf4 8,0
zaa 17,10,6
zaa 18,12,6
zh 244,140,72
zo 88,17
zo 90,18
zb 92,17,16
zp 64,144,72
zb 94,18,16
zb 96,17,64
zb 98,18,64
zp 68,148,72
zb 100,17,80
zb 102,18,80
zb 104,17,128
zex 72,152
zb 106,18,128
zb 108,17,144
zb 110,18,144
zp 76,156,72
zab 128,14,3
zab 129,14,5
zab 130,16,3
zf 240,160,84
zb 136,1,12288
zb 138,1,13824
zab 131,16,5
zf 244,164,84
ze 12
zb 140,2,12288
zb 142,2,13824
zb 144,1,12352
zh 112,88,128
ze 13
zb 146,1,13888
zb 148,2,12352
zb 150,2,13888
zh 116,92,128
ze 14
zb 152,1,12416
zb 154,1,13952
zh 120,96,128
ze 14
zc 64,112,113
zc 65,114,115
zh 124,100,128
zb 156,2,12416
zc 66,116,117
za 64,168,84
ze 11
zc 67,118,119
zc 68,120,121
zh 112,104,128
zc 69,122,123
zc 70,124,125
zh 116,108,128
zb 158,2,13952
zc 71,126,127
za 68,172,84
za 72,176,84
zv
zc 72,112,113
zc 73,114,115
za 76,180,84
zb 160,1,30720
zc 74,116,117
zc 75,118,119
zf 240,184,76
zb 162,1,32256
zb 164,2,30720
zb 166,2,32256
zf 244,188,76
zb 168,1,30784
zb 170,1,32320
za 64,192,76
zb 172,2,30784
zb 174,2,32320
za 68,196,76
zb 176,1,30848
zb 178,1,32384
za 72,200,76
zb 180,2,30848
zb 182,2,32384
z7 76,204
Lf5_atE2:
zfz
s_cbranch_scc1 Lf5_as1H0
zf0
s_cbranch_scc1 Lf5_as2H0
zde
s_cbranch_scc1 Lf5_as3H0
s_branch Lf5_as0H0
Lf5_as0H0:
Lf5_as0G0:
zc2
s_cbranch_scc1 Lf5_as0S0
zc0
s_cbranch_scc0 Lf5_as0Rb0
ze 15
zf 208,136,64
zac 17,10,6
zac 18,12,6
zad 128,14,3
zad 129,14,5
zf 212,140,64
zo 88,17
zo 90,18
zb 92,17,16
zb 94,18,16
za 0,144,64
zb 96,17,64
zb 98,18,64
zb 100,17,80
za 4,148,64
ze 15
zb 102,18,80
zb 104,17,128
zb 106,18,128
za 8,152,64
zb 108,17,144
zb 110,18,144
zad 130,16,3
za 12,156,64
ze 14
zb 192,1,49216
zb 194,1,50752
zad 131,16,5
zf 208,176,68
ze 14
zb 196,2,49216
zb 198,2,50752
zb 200,1,49280
zf 212,180,68
ze 15
zb 202,1,50816
zb 204,2,49280
zb 206,2,50816
zh 112,88,128
ze 15
zb 184,1,49152
zb 186,1,50688
zb 188,2,49152
zh 116,92,128
ze 15
zb 190,2,50688
zbr 0xc800
zbb 1
zbb 2
zh 120,96,128
zc 76,112,113
zc 77,114,115
zb2 50
zh 124,100,128
ze 12
zc 78,116,117
zc 79,118,119
zb3 50
zh 112,104,128
zc 80,120,121
zc 81,122,123
zbz 21,50
zh 116,108,128
zbc 0x5800
zbw
zbd
zc 82,124,125
zc 83,126,127
za 0,160,68
zbe
zc 84,112,113
zc 85,114,115
zal 24,50
za 4,164,68
zc 86,116,117
zc 87,118,119
ze 0
s_barrier
za 8,168,68
z6 0x3000
zag 0x3000
z0 38
zn 39,1024
za 12,172,68
zn 49,2048
zn 38,3072
zf 208,192,72
z6 0x4000
zag 0x4000
z0 39
zf 212,196,72
zbc 0x9800
zn 49,1024
zby
zbd
za 0,200,72
zbe
zal 25,50
zb5
zb6 0x1a000
za 4,204,72
zal 26,50
zb7 50
zbv 22,4
za 8,184,72
zbk 22,50
zb8
za 12,188,72
zb9 22
Lf5_as0H1:
Lf5_as0G1:
zct
s_cbranch_scc1 Lf5_as0S1
zcf
s_cbranch_scc0 Lf5_as0Rb1
ze 0
zf 216,136,76
zbn
zbq 8,0
zaa 17,9,6
zaa 18,11,6
zf 220,140,76
zbo
zo 88,17
zo 90,18
zb 92,17,16
za 16,144,76
zbp
zb 94,18,16
zb 96,17,64
zb 98,18,64
za 20,148,76
zb 100,17,80
zb 102,18,80
zb 104,17,128
za 24,152,76
zb 106,18,128
zb 108,17,144
zb 110,18,144
za 28,156,76
zab 128,13,3
zab 129,13,5
zab 130,15,3
zf 216,176,80
zu 12
zo 136,1
zb 138,1,1536
zab 131,15,5
zf 220,180,80
ze 12
zo 140,2
zb 142,2,1536
zb 144,1,64
zh 112,88,128
ze 13
zb 146,1,1600
zb 148,2,64
zb 150,2,1600
zh 116,92,128
ze 14
zb 152,1,128
zb 154,1,1664
zh 120,96,128
ze 14
zc 64,112,113
zc 65,114,115
zh 124,100,128
zb 156,2,128
zc 66,116,117
za 16,160,80
ze 11
zc 67,118,119
zc 68,120,121
zh 112,104,128
zc 69,122,123
zc 70,124,125
zh 116,108,128
zb 158,2,1664
zc 71,126,127
za 20,164,80
za 24,168,80
zv
zc 72,112,113
zc 73,114,115
za 28,172,80
zu 6
zb 160,1,6144
zc 74,116,117
zc 75,118,119
zf 216,192,84
zb 162,1,7680
zb 164,2,6144
zb 166,2,7680
zf 220,196,84
zb 168,1,6208
zb 170,1,7744
za 16,200,84
zb 172,2,6208
zb 174,2,7744
za 20,204,84
zb 176,1,6272
zb 178,1,7808
za 24,184,84
zb 180,2,6272
zb 182,2,7808
za 28,188,84
Lf5_as0E2:
s_branch Lf5_amH0
Lf5_as1H0:
Lf5_as1G0:
zc2
s_cbranch_scc1 Lf5_as1S0
zc0
s_cbranch_scc0 Lf5_as1Rb0
ze 15
zf 224,144,64
zac 17,10,6
zac 18,12,6
zad 128,14,3
zad 129,14,5
zf 228,148,64
ze 14
zo 88,17
zo 90,18
zb 92,17,16
zb 94,18,16
za 32,152,64
ze 15
zb 96,17,64
zb 98,18,64
zb 100,17,80
za 36,156,64
zb 102,18,80
zb 104,17,128
zb 106,18,128
za 40,136,64
zb 108,17,144
zb 110,18,144
zad 130,16,3
za 44,140,64
ze 14
zb 200,1,49280
zb 202,1,50816
zad 131,16,5
zf 224,160,68
zb 204,2,49280
zb 206,2,50816
zb 184,1,49152
zf 228,164,68
ze 15
zb 186,1,50688
zb 188,2,49152
zb 190,2,50688
zh 112,88,128
ze 15
zb 192,1,49216
zb 194,1,50752
zb 196,2,49216
zh 116,92,128
ze 15
zb 198,2,50752
zbr 0xc800
zbb 1
zbb 2
zh 120,96,128
zc 76,112,113
zc 77,114,115
zb2 50
zh 124,100,128
ze 12
zc 78,116,117
zc 79,118,119
zb3 50
zh 112,104,128
zc 80,120,121
zc 81,122,123
zbz 21,50
zh 116,108,128
zbc 0x5800
zbw
zbd
zc 82,124,125
zc 83,126,127
za 32,168,68
zbe
zc 84,112,113
zc 85,114,115
zal 24,50
za 36,172,68
zc 86,116,117
zc 87,118,119
ze 0
s_barrier
za 40,176,68
z6 0x3000
zag 0x3000
z0 38
zn 39,1024
za 44,180,68
zn 49,2048
zn 38,3072
zf 224,200,72
z6 0x4000
zag 0x4000
z0 39
zf 228,204,72
zbc 0x9800
zn 49,1024
zby
zbd
za 32,184,72
zbe
zal 25,50
zb5
zb6 0x1a000
za 36,188,72
zal 26,50
zb7 50
zbv 22,4
za 40,192,72
zbk 22,50
zb8
za 44,196,72
zb9 22
Lf5_as1H1:
Lf5_as1G1:
zct
s_cbranch_scc1 Lf5_as1S1
zcf
s_cbranch_scc0 Lf5_as1Rb1
ze 0
zf 232,144,76
zbn
zbq 8,0
zaa 17,9,6
zaa 18,11,6
zf 236,148,76
zbo
zo 88,17
zo 90,18
zb 92,17,16
za 48,152,76
zbp
zb 94,18,16
zb 96,17,64
zb 98,18,64
za 52,156,76
zb 100,17,80
zb 102,18,80
zb 104,17,128
za 56,136,76
zb 106,18,128
zb 108,17,144
zb 110,18,144
za 60,140,76
zab 128,13,3
zab 129,13,5
zab 130,15,3
zf 232,160,80
zu 12
zo 136,1
zb 138,1,1536
zab 131,15,5
zf 236,164,80
ze 12
zo 140,2
zb 142,2,1536
zb 144,1,64
zh 112,88,128
ze 13
zb 146,1,1600
zb 148,2,64
zb 150,2,1600
zh 116,92,128
ze 14
zb 152,1,128
zb 154,1,1664
zh 120,96,128
ze 14
zc 64,112,113
zc 65,114,115
zh 124,100,128
zb 156,2,128
zc 66,116,117
za 48,168,80
ze 11
zc 67,118,119
zc 68,120,121
zh 112,104,128
zc 69,122,123
zc 70,124,125
zh 116,108,128
zb 158,2,1664
zc 71,126,127
za 52,172,80
za 56,176,80
zv
zc 72,112,113
zc 73,114,115
za 60,180,80
zu 6
zb 160,1,6144
zc 74,116,117
zc 75,118,119
zf 232,200,84
zb 162,1,7680
zb 164,2,6144
zb 166,2,7680
zf 236,204,84
zb 168,1,6208
zb 170,1,7744
za 48,184,84
zb 172,2,6208
zb 174,2,7744
za 52,188,84
zb 176,1,6272
zb 178,1,7808
za 56,192,84
zb 180,2,6272
zb 182,2,7808
za 60,196,84
Lf5_as1E2:
s_branch Lf5_amH0
Lf5_as2H0:
Lf5_as2G0:
zc2
s_cbranch_scc1 Lf5_as2S0
zc0
s_cbranch_scc0 Lf5_as2Rb0
ze 14
zf 240,152,64
ze 12
zac 17,10,6
zac 18,12,6
zad 128,14,3
zad 129,14,5
zf 244,156,64
zo 88,17
zo 90,18
zb 92,17,16
zb 94,18,16
z7 64,136
zb 96,17,64
zb 98,18,64
zb 100,17,80
za 68,140,64
zb 102,18,80
zb 104,17,128
zb 106,18,128
za 72,144,64
zb 108,17,144
zb 110,18,144
zad 130,16,3
za 76,148,64
ze 14
zb 184,1,49152
zb 186,1,50688
zad 131,16,5
zf 240,168,68
zb 188,2,49152
zb 190,2,50688
zb 192,1,49216
zf 244,172,68
ze 15
zb 194,1,50752
zb 196,2,49216
zb 198,2,50752
zh 112,88,128
ze 15
zb 200,1,49280
zb 202,1,50816
zb 204,2,49280
zh 116,92,128
ze 15
zb 206,2,50816
zbr 0xc800
zbb 1
zbb 2
zh 120,96,128
zc 76,112,113
zc 77,114,115
zb2 50
zh 124,100,128
ze 12
zc 78,116,117
zc 79,118,119
zb3 50
zh 112,104,128
zc 80,120,121
zc 81,122,123
zbz 21,50
zh 116,108,128
zbc 0x5800
zbw
zbd
zc 82,124,125
zc 83,126,127
za 64,176,68
zbe
zc 84,112,113
zc 85,114,115
zal 24,50
z7 68,180
zc 86,116,117
zc 87,118,119
ze 0
s_barrier
za 72,160,68
z6 0x3000
zag 0x3000
z0 38
zn 39,1024
za 76,164,68
zn 49,2048
zn 38,3072
zf 240,184,72
z6 0x4000
zag 0x4000
z0 39
zf 244,188,72
zbc 0x9800
zn 49,1024
zby
zbd
za 64,192,72
zbe
zal 25,50
zb5
zb6 0x1a000
za 68,196,72
zal 26,50
zb7 50
zbv 22,4
z7 72,200
zbk 22,50
zb8
za 76,204,72
zb9 22
Lf5_as2H1:
Lf5_as2G1:
zct
s_cbranch_scc1 Lf5_as2S1
zcf
s_cbranch_scc0 Lf5_as2Rb1
zbq 8,0
zaa 17,9,6
zaa 18,11,6
zab 128,13,3
zab 129,13,5
zab 130,15,3
zab 131,15,5
zbn
zbo
zo 88,17
zo 90,18
zb 92,17,16
zb 94,18,16
zb 96,17,64
zb 98,18,64
zb 100,17,80
zb 102,18,80
zb 104,17,128
zb 106,18,128
zb 108,17,144
zb 110,18,144
zu 12
zo 136,1
zb 138,1,1536
zo 140,2
zb 142,2,1536
zb 144,1,64
zb 146,1,1600
zb 148,2,64
zb 150,2,1600
zb 152,1,128
zb 154,1,1664
zb 156,2,128
zb 158,2,1664
zu 6
zb 160,1,6144
zb 162,1,7680
zb 164,2,6144
zb 166,2,7680
zb 168,1,6208
zb 170,1,7744
zb 172,2,6208
zb 174,2,7744
zb 176,1,6272
ze 15
zh 112,88,128
zb 178,1,7808
zb 180,2,6272
zb 182,2,7808
zh 116,92,128
zbp
zh 120,96,128
zh 124,100,128
zv
zc 64,112,113
zc 65,114,115
zam
zc 66,116,117
zc 67,118,119
zh 112,104,128
zc 68,120,121
zc 69,122,123
zc 70,124,125
zc 71,126,127
zh 116,108,128
zb0
zc 72,112,113
zc 73,114,115
zb0
zc 74,116,117
zc 75,118,119
Lf5_as2E2:
s_branch Lf5_amH0
Lf5_as3H0:
Lf5_as3G0:
zc2
s_cbranch_scc1 Lf5_as3S0
zc0
s_cbranch_scc0 Lf5_as3Rb0
zac 17,10,6
zac 18,12,6
zad 128,14,3
zad 129,14,5
zad 130,16,3
zad 131,16,5
ze 0
s_barrier
zbr 0xc800
zbb 1
zbb 2
zb2 50
zb3 50
zbz 21,50
zbc 0x5800
zbw
zbd
zo 88,17
zo 90,18
zb 92,17,16
zb 94,18,16
zb 96,17,64
zb 98,18,64
zb 100,17,80
zb 102,18,80
zb 104,17,128
zb 106,18,128
zb 108,17,144
zb 110,18,144
zbe
zal 24,50
zbc 0x9800
zby
zbd
zbe
zal 25,50
zb5
zb6 0x1a000
zal 26,50
zb7 50
zbv 22,4
zbk 22,50
zb8
zb9 22
ze 10
zh 112,88,128
ze 8
zh 116,92,128
ze 6
zh 120,96,128
ze 4
zh 124,100,128
ze 2
zv
zc 76,112,113
zc 77,114,115
zc 78,116,117
zc 79,118,119
zh 112,104,128
ze 0
zc 80,120,121
zc 81,122,123
zc 82,124,125
zc 83,126,127
zh 116,108,128
zam
zc 84,112,113
zc 85,114,115
zbl
zc 86,116,117
zc 87,118,119
Lf5_as3H1:
Lf5_as3G1:
zct
s_cbranch_scc1 Lf5_as3S1
zcf
s_cbranch_scc0 Lf5_as3Rb1
zbq 8,0
zaa 17,9,6
zaa 18,11,6
zab 128,13,3
zab 129,13,5
zab 130,15,3
zab 131,15,5
zbn
zbo
zo 88,17
zo 90,18
zb 92,17,16
zb 94,18,16
zb 96,17,64
zb 98,18,64
zb 100,17,80
zb 102,18,80
zb 104,17,128
zb 106,18,128
zb 108,17,144
zb 110,18,144
zu 6
zo 136,1
zb 138,1,1536
zo 140,2
zb 142,2,1536
zb 144,1,64
zb 146,1,1600
zb 148,2,64
zb 150,2,1600
zb 152,1,128
zb 154,1,1664
zb 156,2,128
zb 158,2,1664
zu 0
zb 160,1,6144
zb 162,1,7680
zb 164,2,6144
zb 166,2,7680
zb 168,1,6208
zb 170,1,7744
zb 172,2,6208
zb 174,2,7744
zb 176,1,6272
ze 15
zh 112,88,128
zb 178,1,7808
zb 180,2,6272
zb 182,2,7808
zh 116,92,128
zbp
zh 120,96,128
zh 124,100,128
zv
zc 64,112,113
zc 65,114,115
zam
zc 66,116,117
zc 67,118,119
zh 112,104,128
zc 68,120,121
zc 69,122,123
zc 70,124,125
zc 71,126,127
zh 116,108,128
zb0
zc 72,112,113
zc 73,114,115
zb0
zc 74,116,117
zc 75,118,119
Lf5_as3E2:
s_branch Lf5_amH0
Lf5_amS0:
ze8
s_cbranch_scc0 Lf5_amY0
ze9
zap 0x5780
zao
s_call_b64 s[88:89], Lf5_far
s_branch Lf5_amXb0
Lf5_amY0:
zac 17,9,6
zac 18,11,6
za9 19,13
za9 20,15
s_call_b64 s[88:89], Lf5_four
Lf5_amXb0:
ze 15
zf 208,136,64
ze3
zd 76,88
zd 77,89
zd 78,90
zf 212,140,64
zed
zd 79,91
zd 80,92
zd 81,93
za 0,144,64
zee 0x4800
zd 82,94
zd 83,95
zd 84,96
za 4,148,64
zef
zd 85,97
zd 86,98
zd 87,99
ze 12
za 8,152,64
zeg
zu 0
zb 184,1,12288
zb 186,1,13824
zb 188,2,12288
za 12,156,64
zeh 0x1200
zb 190,2,13824
zb 192,1,12352
zb 194,1,13888
ze 6
zf 208,160,68
zei
zb 196,2,12352
zb 198,2,13888
zb 200,1,12416
zf 212,164,68
zej 0xd0
zb 202,1,13952
zb 204,2,12416
zb 206,2,13952
za 0,168,68
zek 0x12d0
zx 32,59
zr 33,59
zd 59,60
za 4,172,68
zel
zd 60,61
zd 61,62
zd 62,63
za 8,176,68
zem
zci 34,44
zbs 35,29
z2 34
za 12,180,68
ze 9
z2 35
zg 32,34
zg 33,35
zf 208,184,72
ze 6
zs 34
zs 35
zf 212,188,72
zs 32
zs 33
za 0,192,72
ze 3
zq 34,35
zq 32,33
za 4,196,72
ze 0
zr 33,32
zav 32,34
za 8,200,72
zen
zeo
zaw 32
z3 41,33
za 12,204,72
s_branch Lf5_amH1
Lf5_amS1:
zfa
s_cbranch_scc0 Lf5_amY1
zfb
zap 0xaf00
zao
s_call_b64 s[88:89], Lf5_far
s_branch Lf5_amXb1
Lf5_amY1:
zaj 17,9,6
zaj 18,11,6
zbm 19,13
zbm 20,15
s_call_b64 s[88:89], Lf5_four
Lf5_amXb1:
zf 216,136,76
zd 64,88
zd 65,89
zd 66,90
zf 216,160,80
zd 67,91
zd 68,92
zd 69,93
zf 216,184,84
zd 70,94
zd 71,95
zd 72,96
zf 220,140,76
zd 73,97
zd 74,98
zd 75,99
zf 220,164,80
zcg
zcu
z0 38
zf 220,188,84
zn 39,1024
zn 49,2048
za 16,144,76
zn 38,3072
z6 0x1000
zag 0x1000
z0 39
za 16,168,80
zn 49,1024
za 16,192,84
zn 38,2048
za 20,148,76
zn 39,3072
za 20,172,80
z6 0x2000
zag 0x2000
z0 49
za 20,196,84
z3 40,32
z4 43,33,41
za 24,152,76
z4 42,32,40
zax 43
za 24,176,80
z5 32,42
z5 33,43
za 24,200,84
zbg 36,40,45
zay 37,41,46
za 28,156,76
zw 34,32,33
zaz 32,43
za 28,180,80
za0 33,42
za 28,204,84
s_branch Lf5_amH2
Lf5_amS2:
zfc
s_cbranch_scc0 Lf5_amY2
zfd
zap 0x10680
zao
s_call_b64 s[88:89], Lf5_far
s_branch Lf5_amXb2
Lf5_amY2:
zaq 17,9,6
zaq 18,11,6
zbu 19,13
zbu 20,15
s_call_b64 s[88:89], Lf5_four
Lf5_amXb2:
ze 0
zf 224,136,64
zd 76,88
zd 77,89
zd 78,90
zf 228,140,64
zd 79,91
zd 80,92
zd 81,93
za 32,144,64
zn 38,1024
zd 82,94
zd 83,95
za 36,148,64
zn 39,2048
zn 49,3072
za 40,152,64
z6 0x3000
zag 0x3000
z0 38
za 44,156,64
zd 64,96
zd 65,97
zd 66,98
zf 224,160,68
zn 39,1024
zd 67,99
zf 228,164,68
zn 49,2048
zn 38,3072
za 32,168,68
z6 0x4000
zag 0x4000
z0 39
za 36,172,68
zn 49,1024
zw 35,42,43
za 40,176,68
za1 37,41
za2 37,47
za 44,180,68
za3 32,33
zas 33
zf 224,184,72
za4 37,36
zq 34,35
zf 228,188,72
zq 32,33
za5 33,48
za 32,192,72
zca 36,40
zcb 35
za 36,196,72
za6 10,37
z8 14,34,7
z8 16,32,7
za 40,200,72
zcc
zau 12,33,10
zcd
zce
za 44,204,72
s_branch Lf5_amH3
Lf5_amS3:
ze1
s_cbranch_scc0 Lf5_amY3
zfe
zap 0x15e00
zao
s_call_b64 s[88:89], Lf5_far
s_branch Lf5_amXb3
Lf5_amY3:
zaa 17,10,6
zaa 18,12,6
za8 19,14
za8 20,16
s_call_b64 s[88:89], Lf5_four
Lf5_amXb3:
ze 0
zf 232,136,76
zd 72,88
zd 73,89
zd 74,90
zd 75,91
zf 236,140,76
zd 84,92
zd 85,93
zd 86,94
zd 87,95
za 48,144,76
zx 32,54
zr 33,54
zd 54,55
zd 55,56
za 52,148,76
zd 56,57
zdx 34,44
zcj 35,29
z2 34
za 56,152,76
z2 35
zg 32,34
zg 33,35
zs 34
za 60,156,76
zd 76,96
zd 77,97
zd 78,98
zd 79,99
zf 232,160,80
zs 35
zs 32
zs 33
zq 34,35
zf 236,164,80
zq 32,33
zr 33,32
zav 32,34
zaw 32
za 48,168,80
z3 41,33
z3 40,32
z4 43,33,41
za 52,172,80
z4 42,32,40
zax 43
z5 32,42
za 56,176,80
z5 33,43
zbg 36,40,45
zay 37,41,46
za 60,180,80
zw 34,32,33
zaz 32,43
za0 33,42
zf 232,184,64
zw 35,42,43
za1 37,41
za2 37,47
zf 236,188,64
za3 32,33
zas 33
za4 37,36
za 48,192,64
zq 34,35
zq 32,33
za5 33,48
za 52,196,64
zdf 36,40
zdg 35
za6 9,37
z8 13,34,7
za 56,200,64
z8 15,32,7
zdh
zau 11,33,9
zdi
za 60,204,64
zdj
s_branch Lf5_amH4
Lf5_amS4:
zdz
s_cbranch_scc0 Lf5_amY4
zet
zeu
zev
s_call_b64 s[88:89], Lf5_far
s_branch Lf5_amXb4
Lf5_amY4:
zaa 17,9,6
zaa 18,11,6
za8 19,13
za8 20,15
s_call_b64 s[88:89], Lf5_four
Lf5_amXb4:
ze 0
zf 240,136,72
zbn
zbq 8,0
zd 64,88
zd 65,89
zf 244,140,72
zbo
zd 66,90
zd 67,91
zd 68,92
za 64,144,72
zbp
zd 69,93
zd 70,94
zd 71,95
za 68,148,72
zf5
z7 72,152
za 76,156,72
zd 72,96
zd 73,97
zd 74,98
zf 240,160,84
zu 12
zo 136,1
zb 138,1,1536
zd 75,99
zf 244,164,84
zo 140,2
zb 142,2,1536
zb 144,1,64
za 64,168,84
zb 146,1,1600
zb 148,2,64
zb 150,2,1600
za 68,172,84
zb 152,1,128
zb 154,1,1664
za 72,176,84
zb 156,2,128
zb 158,2,1664
za 76,180,84
zu 6
zb 160,1,6144
zb 162,1,7680
zf 240,184,76
zb 164,2,6144
zb 166,2,7680
zf 244,188,76
zb 168,1,6208
zb 170,1,7744
za 64,192,76
zb 172,2,6208
zb 174,2,7744
za 68,196,76
zb 176,1,6272
zb 178,1,7808
za 72,200,76
zb 180,2,6272
zb 182,2,7808
z7 76,204
s_branch Lf5_amE2
Lf5_azS0:
ze8
s_cbranch_scc0 Lf5_azY0
ze9
zap 0x5780
zao
s_call_b64 s[88:89], Lf5_far
s_branch Lf5_azXb0
Lf5_azY0:
zac 17,9,6
zac 18,11,6
za9 19,13
za9 20,15
s_call_b64 s[88:89], Lf5_four
Lf5_azXb0:
zd 76,88
zd 77,89
zd 78,90
zd 79,91
ze 15
za 0,144,64
zd 80,92
zd 81,93
zd 82,94
zd 83,95
zd 84,96
za 4,148,64
zu 0
zb 192,1,12352
zb 194,1,13888
zd 85,97
zd 86,98
zd 87,99
ze 10
za 8,152,64
zb 196,2,12352
zb 198,2,13888
zb 200,1,12416
zb 202,1,13952
zb 204,2,12416
za 12,156,64
zb 206,2,13952
zb 184,1,12288
zb 186,1,13824
zb 188,2,12288
zb 190,2,13824
zf 208,136,64
zx 32,59
zr 33,59
zci 34,44
zbs 35,29
zf 212,140,64
ze 12
z2 34
z2 35
zg 32,34
zg 33,35
za 0,168,68
zs 34
zs 35
zs 32
zs 33
za 4,172,68
zq 34,35
zq 32,33
zr 33,32
zav 32,34
za 8,176,68
zaw 32
z3 41,33
z3 40,32
z4 43,33,41
za 12,180,68
z4 42,32,40
zax 43
z5 32,42
z5 33,43
zf 208,160,68
zbg 36,40,45
zay 37,41,46
zw 34,32,33
zaz 32,43
zf 212,164,68
ze 0
za0 33,42
zw 35,42,43
za1 37,41
za2 37,47
za 0,192,72
za3 32,33
zas 33
za4 37,36
zq 34,35
za 4,196,72
zq 32,33
za5 33,48
zca 36,40
zcb 35
za 8,200,72
zk 0,21,2048
za 12,204,72
zv
zk 4,21,3072
za6 10,37
zf 208,184,72
z8 14,34,7
z8 16,32,7
zcc
zau 12,33,10
zcd
zf 212,188,72
zce
s_branch Lf5_azH1
Lf5_azS1:
zfa
s_cbranch_scc0 Lf5_azY1
zfb
zap 0xaf00
zao
s_call_b64 s[88:89], Lf5_far
s_branch Lf5_azXb1
Lf5_azY1:
zaj 17,9,6
zaj 18,11,6
zbm 19,13
zbm 20,15
s_call_b64 s[88:89], Lf5_four
Lf5_azXb1:
zd 64,88
zd 65,89
zd 66,90
zd 67,91
za 16,144,76
zfo 0xffff0000
zd 68,92
zd 69,93
zd 70,94
za 16,168,80
zf6 0xffff0000
zd 71,95
zd 72,96
zd 73,97
za 16,192,84
zk 8,21,4096
zd 74,98
zd 75,99
za 20,148,76
zk 12,21,5120
za 20,172,80
zam
zk 16,21,8192
za 20,196,84
za 24,152,76
za 24,176,80
ze 1
s_barrier
za7 28,24
za 24,200,84
za7 32,25
za7 36,26
za 28,156,76
zk 20,21,9216
za 28,180,80
zb0
zk 24,21,10240
za 28,204,84
zl 40,24,1024
zl 44,25,1024
zf 216,136,76
zl 48,26,1024
zf 216,160,80
zf 216,184,84
zf 220,140,76
zv
zk 28,21,11264
zf 220,164,80
zf 220,188,84
s_branch Lf5_azH2
Lf5_azS2:
zfc
s_cbranch_scc0 Lf5_azY2
zfd
zap 0x10680
zao
s_call_b64 s[88:89], Lf5_far
s_branch Lf5_azXb2
Lf5_azY2:
zaq 17,9,6
zaq 18,11,6
zbu 19,13
zbu 20,15
s_call_b64 s[88:89], Lf5_four
Lf5_azXb2:
zd 76,88
zd 77,89
zd 78,90
zd 79,91
za 32,144,64
zd 80,92
zd 81,93
zd 82,94
zd 83,95
za 32,168,68
zd 84,96
zd 85,97
zd 86,98
zd 87,99
za 32,192,72
ze 2
zm 32,28
zg 36,208
zm 33,29
zg 37,209
za 36,148,64
zm 34,30
zg 38,210
zm 35,31
zg 39,211
za 36,172,68
zk 32,21,14336
za 36,196,72
zg 32,36
zg 33,37
zg 34,38
zg 35,39
za 40,152,64
ze 1
s_barrier
zl 28,24,6144
zc 36,32,33
zc 37,34,35
za 40,176,68
zk 36,21,15360
za 40,200,72
zl 32,25,6144
zm 44,40
zg 48,212
zm 45,41
za 44,156,64
zg 49,213
zm 46,42
zg 50,214
zm 47,43
za 44,180,68
zk 40,21,16384
za 44,204,72
zl 40,24,7168
zg 51,215
zg 44,48
zg 45,49
zf 224,136,64
zg 46,50
zg 47,51
zc 48,44,45
zc 49,46,47
zf 224,160,68
zk 44,21,17408
zf 224,184,72
zl 44,25,7168
zah 38,48,36
zah 39,49,37
zai 36,48
zf 228,140,64
zai 37,49
zf 228,164,68
zfn
zbf 36,22
zl 48,26,7168
zl 36,26,6144
zf 228,188,72
s_branch Lf5_azH3
Lf5_azS3:
ze1
s_cbranch_scc0 Lf5_azY3
zfe
zap 0x15e00
zao
s_call_b64 s[88:89], Lf5_far
s_branch Lf5_azXb3
Lf5_azY3:
zaa 17,10,6
zaa 18,12,6
za8 19,14
za8 20,16
s_call_b64 s[88:89], Lf5_four
Lf5_azXb3:
zd 64,88
zd 65,89
zd 66,90
zd 67,91
ze 6
za 48,144,76
zd 68,92
zd 69,93
zd 70,94
zd 71,95
za 48,168,80
zd 72,96
zd 73,97
zd 74,98
zd 75,99
za 48,192,84
zm 32,28
ze 0
zg 36,216
zm 33,29
zg 37,217
za 52,148,76
zm 34,30
zg 38,218
zm 35,31
zg 39,219
za 52,172,80
zk 48,21,2048
za 52,196,84
zg 32,36
zg 33,37
zg 34,38
zg 35,39
za 56,152,76
s_barrier
zl 28,24,12288
zc 36,32,33
zc 37,34,35
za 56,176,80
zk 52,21,3072
za 56,200,84
zl 32,25,12288
zm 44,40
zg 48,220
zm 45,41
za 60,156,76
zg 49,221
zm 46,42
zg 50,222
zm 47,43
za 60,180,80
zk 56,21,4096
za 60,204,84
zl 40,24,13312
zg 51,223
zg 44,48
zg 45,49
zf 232,136,76
zg 46,50
zg 47,51
zc 48,44,45
zc 49,46,47
zf 232,160,80
zk 60,21,5120
zf 232,184,84
zl 44,25,13312
zah 38,48,36
zah 39,49,37
zai 36,48
zf 236,140,76
zai 37,49
zf 236,164,80
zbh 0xa800
zbf 36,22
zl 48,26,13312
zl 36,26,12288
zf 236,188,84
s_branch Lf5_azH4
Lf5_ayS0:
ze8
s_cbranch_scc0 Lf5_ayY0
ze9
zap 0x5780
zao
s_call_b64 s[88:89], Lf5_far
s_branch Lf5_ayXb0
Lf5_ayY0:
zac 17,9,6
zac 18,11,6
za9 19,13
za9 20,15
s_call_b64 s[88:89], Lf5_four
Lf5_ayXb0:
zd 76,88
zd 77,89
zd 78,90
zd 79,91
ze 15
za 0,144,64
zd 80,92
zd 81,93
zd 82,94
zd 83,95
zd 84,96
za 4,148,64
zu 0
zb 192,1,12352
zb 194,1,13888
zd 85,97
zd 86,98
zd 87,99
ze 10
za 8,152,64
zb 196,2,12352
zb 198,2,13888
zb 200,1,12416
zb 202,1,13952
zb 204,2,12416
za 12,156,64
zb 206,2,13952
zb 184,1,12288
zb 186,1,13824
zb 188,2,12288
zb 190,2,13824
zf 208,136,64
zx 32,59
zr 33,59
zci 34,44
zbs 35,29
zf 212,140,64
ze 12
z2 34
z2 35
zg 32,34
zg 33,35
za 0,168,68
zs 34
zs 35
zs 32
zs 33
za 4,172,68
zq 34,35
zq 32,33
zr 33,32
zav 32,34
za 8,176,68
zaw 32
z3 41,33
z3 40,32
z4 43,33,41
za 12,180,68
z4 42,32,40
zax 43
z5 32,42
z5 33,43
zf 208,160,68
zbg 36,40,45
zay 37,41,46
zw 34,32,33
zaz 32,43
zf 212,164,68
ze 0
za0 33,42
zw 35,42,43
za1 37,41
za2 37,47
za 0,192,72
za3 32,33
zas 33
za4 37,36
zq 34,35
za 4,196,72
zq 32,33
za5 33,48
zca 36,40
zcb 35
za 8,200,72
zk 0,21,2048
za 12,204,72
zv
zk 4,21,3072
za6 10,37
zf 208,184,72
z8 14,34,7
z8 16,32,7
zcc
zau 12,33,10
zcd
zf 212,188,72
zce
s_branch Lf5_ayH1
Lf5_ayS1:
zfa
s_cbranch_scc0 Lf5_ayY1
zfb
zap 0xaf00
zao
s_call_b64 s[88:89], Lf5_far
s_branch Lf5_ayXb1
Lf5_ayY1:
zaj 17,9,6
zaj 18,11,6
zbm 19,13
zbm 20,15
s_call_b64 s[88:89], Lf5_four
Lf5_ayXb1:
zd 64,88
zd 65,89
zd 66,90
zd 67,91
za 16,144,76
zd 68,92
zd 69,93
zd 70,94
za 16,168,80
zd 71,95
zd 72,96
zd 73,97
za 16,192,84
zk 8,21,4096
zd 74,98
zd 75,99
za 20,148,76
zk 12,21,5120
za 20,172,80
zdl 208,21
za 20,196,84
zat 212,21,1024
za 24,152,76
zk 16,21,8192
za 24,176,80
zbl
zk 20,21,9216
za 24,200,84
ze 2
s_barrier
za 28,156,76
za 28,180,80
za 28,204,84
zf 216,136,76
zam
zk 24,21,10240
zf 216,160,80
zb0
zk 28,21,11264
zf 216,184,84
zf 220,140,76
zf 220,164,80
zf 220,188,84
zcr
zat 216,21,6144
s_branch Lf5_ayH2
Lf5_ayS2:
zfc
s_cbranch_scc0 Lf5_ayY2
zfd
zap 0x10680
zao
s_call_b64 s[88:89], Lf5_far
s_branch Lf5_ayXb2
Lf5_ayY2:
zaq 17,9,6
zaq 18,11,6
zbu 19,13
zbu 20,15
s_call_b64 s[88:89], Lf5_four
Lf5_ayXb2:
zd 76,88
zd 77,89
zd 78,90
zd 79,91
za 32,144,64
zd 80,92
zd 81,93
za 32,168,68
zd 82,94
zd 83,95
za 32,192,72
zd 84,96
zd 85,97
za 36,148,64
zd 86,98
zd 87,99
za 36,172,68
zat 220,21,7168
za 36,196,72
zk 32,21,14336
za 40,152,64
za 40,176,68
za 40,200,72
ze 1
s_barrier
zam
zk 36,21,15360
za 44,156,64
za 44,180,68
za 44,204,72
zk 40,21,16384
zf 224,136,64
zf 224,160,68
zf 224,184,72
zbl
zk 44,21,17408
zf 228,140,64
zf 228,164,68
zf 228,188,72
zat 224,21,12288
s_branch Lf5_ayH3
Lf5_ayS3:
ze1
s_cbranch_scc0 Lf5_ayY3
zfe
zap 0x15e00
zao
s_call_b64 s[88:89], Lf5_far
s_branch Lf5_ayXb3
Lf5_ayY3:
zaa 17,10,6
zaa 18,12,6
za8 19,14
za8 20,16
s_call_b64 s[88:89], Lf5_four
Lf5_ayXb3:
zd 64,88
zd 65,89
zd 66,90
zd 67,91
za 48,144,76
zd 68,92
zd 69,93
za 48,168,80
zd 70,94
zd 71,95
za 48,192,84
zd 72,96
zd 73,97
za 52,148,76
zd 74,98
zd 75,99
za 52,172,80
zat 228,21,13312
za 52,196,84
zk 48,21,2048
za 56,152,76
za 56,176,80
za 56,200,84
ze 1
s_barrier
zam
zk 52,21,3072
za 60,156,76
za 60,180,80
za 60,204,84
zk 56,21,4096
zf 232,136,76
zf 232,160,80
zf 232,184,84
zbl
zk 60,21,5120
zf 236,140,76
zf 236,164,80
zf 236,188,84
zdl 232,21
s_branch Lf5_ayH4
Lf5_aqS0:
zdz
s_cbranch_scc0 Lf5_aqY0
s_add_u32 s90, s64, 0
s_add_u32 s91, s66, 0
zao
s_call_b64 s[88:89], Lf5_far
s_branch Lf5_aqXb0
Lf5_aqY0:
zaa 17,9,6
zaa 18,11,6
za8 19,13
za8 20,15
s_call_b64 s[88:89], Lf5_four
Lf5_aqXb0:
zd 64,88
zd 65,89
zd 66,90
zd 67,91
zd 68,92
zd 69,93
zd 70,94
zd 71,95
zd 72,96
zd 73,97
zd 74,98
zd 75,99
zu 13
zo 136,1
zb 138,1,1536
zo 140,2
zb 142,2,1536
zb 144,1,64
zb 146,1,1600
zb 148,2,64
zb 150,2,1600
zb 152,1,128
zb 154,1,1664
zb 156,2,128
zb 158,2,1664
zu 7
zb 160,1,6144
zb 162,1,7680
zb 164,2,6144
zb 166,2,7680
zb 168,1,6208
zb 170,1,7744
zb 172,2,6208
zb 174,2,7744
zb 176,1,6272
zb 178,1,7808
zb 180,2,6272
zb 182,2,7808
s_branch Lf5_aqE2
Lf5_atS0:
ze8
s_cbranch_scc0 Lf5_atY0
ze9
zap 0x5780
zao
s_call_b64 s[88:89], Lf5_far
s_branch Lf5_atXb0
Lf5_atY0:
zac 17,9,6
zac 18,11,6
za9 19,13
za9 20,15
s_call_b64 s[88:89], Lf5_four
Lf5_atXb0:
ze 15
zh 208,136,64
zd 76,88
zd 77,89
zd 78,90
zh 212,140,64
zd 79,91
zd 80,92
zd 81,93
zp 0,144,64
zd 82,94
zd 83,95
zd 84,96
zp 4,148,64
ze 14
zd 85,97
zd 86,98
zd 87,99
zp 8,152,64
zu 1
zb 184,1,12288
zb 186,1,13824
zb 188,2,12288
ze 13
zp 12,156,64
zb 190,2,13824
zb 192,1,12352
zb 194,1,13888
zf 208,160,68
ze 8
zb 196,2,12352
zb 198,2,13888
zb 200,1,12416
zf 212,164,68
zb 202,1,13952
zb 204,2,12416
zb 206,2,13952
za 0,168,68
zf1
zcv
zcw 0xdf
zbt 0xa800
zdd 0x9000
za 4,172,68
zid
zgk
s_cselect_b32 s42, 0x1e800, s42
za 8,176,68
zcx
zv
zae 21
ze 11
za 12,180,68
zan 0x400
zv
zae 22
ze 6
zf 208,184,72
zan 0x800
zv
zae 23
zf 212,188,72
zan 0xc00
zv
zae 24
za 0,192,72
zcy 0x3fffffff
zan 0x1000
zv
zae 25
zcz
ze 0
za 4,196,72
za 8,200,72
za 12,204,72
s_branch Lf5_atH1
Lf5_atS1:
zfa
s_cbranch_scc0 Lf5_atY1
zfb
zap 0xaf00
zao
s_call_b64 s[88:89], Lf5_far
s_branch Lf5_atXb1
Lf5_atY1:
zaj 17,9,6
zaj 18,11,6
zbm 19,13
zbm 20,15
s_call_b64 s[88:89], Lf5_four
Lf5_atXb1:
ze 0
zh 216,136,76
zd 64,88
zd 65,89
zd 66,90
zd 67,91
zd 68,92
zf 216,160,80
zd 69,93
zd 70,94
zd 71,95
zd 72,96
zd 73,97
zf 216,184,84
zf2 28,31
ze5
zc6 56,31,16
zc8 0x15e00
zc6 62,31,16
zd 74,98
zd 75,99
zh 220,140,76
z6 0x3000
zc7 0x3000
z0 38
zn 39,1024
zf 220,164,80
zn 49,2048
zn 38,3072
zf 220,188,84
z6 0x4000
zc7 0x4000
z0 39
zn 49,1024
zp 16,144,76
zcg
zcu
z0 38
zn 39,1024
za 16,168,80
zu 16
zn 49,2048
zx 32,58
zr 33,58
za 16,192,84
zci 34,44
zbs 35,29
z2 34
z2 35
zp 20,148,76
zg 32,34
zg 33,35
zs 34
zs 35
za 20,172,80
zs 32
zs 33
zq 34,35
zq 32,33
za 20,196,84
zr 33,32
zav 32,34
zaw 32
z3 41,33
zp 24,152,76
z3 40,32
z4 43,33,41
z4 42,32,40
zci 34,44
za 24,176,80
z2 34
zd1 35,45
zd2 34,35
zax 43
za 24,200,84
z5 32,42
z5 33,43
zd3 36,40,45,34
zp 28,156,76
zay 37,41,46
zw 34,32,33
zaz 32,43
za 28,180,80
za0 33,42
zbr 0xc800
zdw 1
zdw 2
za 28,204,84
s_branch Lf5_atH2
Lf5_atS2:
zfc
s_cbranch_scc0 Lf5_atY2
zfd
zap 0x10680
zao
s_call_b64 s[88:89], Lf5_far
s_branch Lf5_atXb2
Lf5_atY2:
zaq 17,9,6
zaq 18,11,6
zbu 19,13
zbu 20,15
s_call_b64 s[88:89], Lf5_four
Lf5_atXb2:
ze 0
zh 224,136,64
zd 76,88
zd 77,89
zd 78,90
zd 79,91
zh 228,140,64
zd 80,92
zd 81,93
zd 82,94
zd 83,95
zp 32,144,64
zn 38,3072
z6 0x1000
zag 0x1000
z0 39
zp 36,148,64
zn 49,1024
zn 38,2048
zp 40,152,64
zn 39,3072
z6 0x2000
zag 0x2000
z0 49
zp 44,156,64
zd 64,96
zd 65,97
zd 66,98
zf 224,160,68
zn 38,1024
zd 67,99
zf 228,164,68
zn 39,2048
zn 49,3072
za 32,168,68
zw 35,42,43
za1 37,41
za2 37,47
za 36,172,68
za3 32,33
zas 33
za4 37,36
za 40,176,68
zq 34,35
zq 32,33
za5 33,48
za 44,180,68
zca 36,40
zcb 35
za6 10,37
zf 224,184,72
z8 14,34,7
z8 16,32,7
zcc
zf 228,188,72
zau 12,33,10
zcd
zce
za 32,192,72
zx 32,53
zr 33,53
zdx 34,44
za 36,196,72
zcj 35,29
z2 34
z2 35
za 40,200,72
zg 32,34
zg 33,35
za 44,204,72
s_branch Lf5_atH3
Lf5_atS3:
ze1
s_cbranch_scc0 Lf5_atY3
zfe
zap 0x15e00
zao
s_call_b64 s[88:89], Lf5_far
s_branch Lf5_atXb3
Lf5_atY3:
zaa 17,10,6
zaa 18,12,6
za8 19,14
za8 20,16
s_call_b64 s[88:89], Lf5_four
Lf5_atXb3:
ze 0
zh 232,136,76
zd 72,88
zd 73,89
zd 74,90
zd 75,91
zd 84,92
zd 85,93
zh 236,140,76
zd 86,94
zd 87,95
zs 34
zs 35
zs 32
zs 33
zp 48,144,76
zq 34,35
zq 32,33
zr 33,32
zav 32,34
zaw 32
z3 41,33
zp 52,148,76
z3 40,32
z4 43,33,41
z4 42,32,40
zax 43
z5 32,42
z5 33,43
zp 56,152,76
zbg 36,40,45
zay 37,41,46
zw 34,32,33
zaz 32,43
za0 33,42
zw 35,42,43
zp 60,156,76
zd 76,96
zd 77,97
zd 78,98
zd 79,99
za1 37,41
za2 37,47
zf 232,160,80
za3 32,33
zas 33
za4 37,36
zq 34,35
zq 32,33
za5 33,48
zf 236,164,80
zdf 36,40
zdg 35
za6 9,37
z8 13,34,7
z8 15,32,7
za 48,168,80
zdh
zau 11,33,9
zdi
zdj
zu 20
zx 32,28
zr 33,28
za 52,172,80
zf3 34,44
ze2 35,29
z2 34
z2 35
zg 32,34
zg 33,35
za 56,176,80
zs 34
zs 35
zs 32
zs 33
zq 34,35
zq 32,33
za 60,180,80
zr 33,32
zav 32,34
zaw 32
z3 41,33
z3 40,32
zf 232,184,64
z4 43,33,41
z4 42,32,40
zax 43
z5 32,42
z5 33,43
zf 236,188,64
zbg 36,40,45
zay 37,41,46
zw 34,32,33
zaz 32,43
za0 33,42
za 48,192,64
zw 35,42,43
za1 37,41
za2 37,47
za3 32,33
zas 33
za 52,196,64
za4 37,36
zq 34,35
zq 32,33
za5 33,48
zca 36,40
zcb 35
za 56,200,64
za6 10,37
z8 14,34,7
z8 16,32,7
zcc
zau 12,33,10
zcd
za 60,204,64
zce
s_branch Lf5_atH4
Lf5_atS4:
ze1
s_cbranch_scc0 Lf5_atY4
s_add_u32 s90, s78, 0
s_add_u32 s91, s79, 0
zdu
s_call_b64 s[88:89], Lf5_far
s_branch Lf5_atXb4
Lf5_atY4:
zaa 17,10,6
zaa 18,12,6
za8 19,14
za8 20,16
s_call_b64 s[88:89], Lf5_four
Lf5_atXb4:
ze 0
zh 240,136,72
zf4 8,0
zd 64,88
zd 65,89
zh 244,140,72
zd 66,90
zd 67,91
zd 68,92
zp 64,144,72
zd 69,93
zd 70,94
zd 71,95
zp 68,148,72
zex 72,152
zp 76,156,72
zd 72,96
zd 73,97
zd 74,98
zf 240,160,84
zb 136,1,12288
zb 138,1,13824
zd 75,99
zf 244,164,84
zb 140,2,12288
zb 142,2,13824
zb 144,1,12352
za 64,168,84
zb 146,1,13888
zb 148,2,12352
zb 150,2,13888
za 68,172,84
zb 152,1,12416
zb 154,1,13952
za 72,176,84
zb 156,2,12416
zb 158,2,13952
za 76,180,84
zb 160,1,30720
zb 162,1,32256
zf 240,184,76
zb 164,2,30720
zb 166,2,32256
zf 244,188,76
zb 168,1,30784
zb 170,1,32320
za 64,192,76
zb 172,2,30784
zb 174,2,32320
za 68,196,76
zb 176,1,30848
zb 178,1,32384
za 72,200,76
zb 180,2,30848
zb 182,2,32384
z7 76,204
s_branch Lf5_atE2
Lf5_as0S0:
ze0
s_cbranch_scc0 Lf5_as0Y0
zfg
zec 0x5780
zdu
s_call_b64 s[88:89], Lf5_far
s_branch Lf5_as0Xb0
Lf5_as0Y0:
zac 17,10,6
zac 18,12,6
za9 19,14
za9 20,16
s_call_b64 s[88:89], Lf5_four
Lf5_as0Xb0:
ze 15
zf 208,136,64
zd 76,88
zd 77,89
zd 78,90
zd 79,91
zf 212,140,64
zd 80,92
zd 81,93
zd 82,94
zd 83,95
za 0,144,64
zd 84,96
zd 85,97
zd 86,98
za 4,148,64
ze 8
zb 192,1,49216
zb 194,1,50752
zd 87,99
za 8,152,64
zb 196,2,49216
zb 198,2,50752
zb 200,1,49280
za 12,156,64
ze 7
zb 202,1,50816
zb 204,2,49280
zb 206,2,50816
zf 208,176,68
ze 8
zb 184,1,49152
zb 186,1,50688
zb 188,2,49152
zb 190,2,50688
zf 212,180,68
zbr 0xc800
zbb 1
zbb 2
zb2 50
za 0,160,68
zb3 50
zbz 21,50
zbc 0x5800
zbw
zbd
za 4,164,68
ze 0
s_barrier
z6 0x3000
zag 0x3000
z0 38
za 8,168,68
zbe
zn 39,1024
zn 49,2048
za 12,172,68
zn 38,3072
z6 0x4000
zag 0x4000
z0 39
zf 208,192,72
zn 49,1024
zal 24,50
zf 212,196,72
zbc 0x9800
zby
zbd
zbe
za 0,200,72
zal 25,50
zb5
za 4,204,72
zb6 0x1a000
zal 26,50
zb7 50
zbv 22,4
za 8,184,72
zbk 22,50
zb8
za 12,188,72
zb9 22
s_branch Lf5_as0H1
Lf5_as0S1:
zdz
s_cbranch_scc0 Lf5_as0Y1
zet
zeu
zev
s_call_b64 s[88:89], Lf5_far
s_branch Lf5_as0Xb1
Lf5_as0Y1:
zaa 17,9,6
zaa 18,11,6
za8 19,13
za8 20,15
s_call_b64 s[88:89], Lf5_four
Lf5_as0Xb1:
ze 0
zf 216,136,76
zbn
zbq 8,0
zd 64,88
zd 65,89
zf 220,140,76
zbo
zd 66,90
zd 67,91
zd 68,92
za 16,144,76
zbp
zd 69,93
zd 70,94
zd 71,95
za 20,148,76
zd 72,96
zd 73,97
za 24,152,76
zd 74,98
zd 75,99
za 28,156,76
zu 12
zo 136,1
zb 138,1,1536
zf 216,176,80
zo 140,2
zb 142,2,1536
zf 220,180,80
zb 144,1,64
zb 146,1,1600
za 16,160,80
zb 148,2,64
zb 150,2,1600
za 20,164,80
zb 152,1,128
zb 154,1,1664
za 24,168,80
zb 156,2,128
zb 158,2,1664
za 28,172,80
zu 6
zb 160,1,6144
zb 162,1,7680
zf 216,192,84
zb 164,2,6144
zb 166,2,7680
zf 220,196,84
zb 168,1,6208
zb 170,1,7744
za 16,200,84
zb 172,2,6208
zb 174,2,7744
za 20,204,84
zb 176,1,6272
zb 178,1,7808
za 24,184,84
zb 180,2,6272
zb 182,2,7808
za 28,188,84
s_branch Lf5_as0E2
Lf5_as1S0:
ze0
s_cbranch_scc0 Lf5_as1Y0
zfg
zec 0x5780
zdu
s_call_b64 s[88:89], Lf5_far
s_branch Lf5_as1Xb0
Lf5_as1Y0:
zac 17,10,6
zac 18,12,6
za9 19,14
za9 20,16
s_call_b64 s[88:89], Lf5_four
Lf5_as1Xb0:
ze 15
zf 224,144,64
zd 76,88
zd 77,89
zd 78,90
zd 79,91
zf 228,148,64
ze 14
zd 80,92
zd 81,93
zd 82,94
zd 83,95
za 32,152,64
ze 11
zd 84,96
zd 85,97
zd 86,98
za 36,156,64
zb 200,1,49280
zb 202,1,50816
zd 87,99
za 40,136,64
zb 204,2,49280
zb 206,2,50816
zb 184,1,49152
za 44,140,64
ze 7
zb 186,1,50688
zb 188,2,49152
zb 190,2,50688
zf 224,160,68
zb 192,1,49216
zb 194,1,50752
zb 196,2,49216
zb 198,2,50752
zf 228,164,68
zbr 0xc800
zbb 1
zbb 2
zb2 50
za 32,168,68
zb3 50
zbz 21,50
zbc 0x5800
zbw
zbd
za 36,172,68
ze 0
s_barrier
z6 0x3000
zag 0x3000
z0 38
za 40,176,68
zbe
zn 39,1024
zn 49,2048
za 44,180,68
zn 38,3072
z6 0x4000
zag 0x4000
z0 39
zf 224,200,72
zn 49,1024
zal 24,50
zf 228,204,72
zbc 0x9800
zby
zbd
zbe
za 32,184,72
zal 25,50
zb5
za 36,188,72
zb6 0x1a000
zal 26,50
zb7 50
zbv 22,4
za 40,192,72
zbk 22,50
zb8
za 44,196,72
zb9 22
s_branch Lf5_as1H1
Lf5_as1S1:
zdz
s_cbranch_scc0 Lf5_as1Y1
zet
zeu
zev
s_call_b64 s[88:89], Lf5_far
s_branch Lf5_as1Xb1
Lf5_as1Y1:
zaa 17,9,6
zaa 18,11,6
za8 19,13
za8 20,15
s_call_b64 s[88:89], Lf5_four
Lf5_as1Xb1:
ze 0
zf 232,144,76
zbn
zbq 8,0
zd 64,88
zd 65,89
zf 236,148,76
zbo
zd 66,90
zd 67,91
zd 68,92
za 48,152,76
zbp
zd 69,93
zd 70,94
zd 71,95
za 52,156,76
zd 72,96
zd 73,97
za 56,136,76
zd 74,98
zd 75,99
za 60,140,76
zu 12
zo 136,1
zb 138,1,1536
zf 232,160,80
zo 140,2
zb 142,2,1536
zf 236,164,80
zb 144,1,64
zb 146,1,1600
za 48,168,80
zb 148,2,64
zb 150,2,1600
za 52,172,80
zb 152,1,128
zb 154,1,1664
za 56,176,80
zb 156,2,128
zb 158,2,1664
za 60,180,80
zu 6
zb 160,1,6144
zb 162,1,7680
zf 232,200,84
zb 164,2,6144
zb 166,2,7680
zf 236,204,84
zb 168,1,6208
zb 170,1,7744
za 48,184,84
zb 172,2,6208
zb 174,2,7744
za 52,188,84
zb 176,1,6272
zb 178,1,7808
za 56,192,84
zb 180,2,6272
zb 182,2,7808
za 60,196,84
s_branch Lf5_as1E2
Lf5_as2S0:
ze0
s_cbranch_scc0 Lf5_as2Y0
zfg
zec 0x5780
zdu
s_call_b64 s[88:89], Lf5_far
s_branch Lf5_as2Xb0
Lf5_as2Y0:
zac 17,10,6
zac 18,12,6
za9 19,14
za9 20,16
s_call_b64 s[88:89], Lf5_four
Lf5_as2Xb0:
ze 14
zf 240,152,64
ze 12
zd 76,88
zd 77,89
zd 78,90
zd 79,91
zf 244,156,64
zd 80,92
zd 81,93
zd 82,94
zd 83,95
z7 64,136
zd 84,96
zd 85,97
zd 86,98
za 68,140,64
zb 184,1,49152
zb 186,1,50688
zd 87,99
za 72,144,64
zb 188,2,49152
zb 190,2,50688
zb 192,1,49216
za 76,148,64
ze 7
zb 194,1,50752
zb 196,2,49216
zb 198,2,50752
zf 240,168,68
zb 200,1,49280
zb 202,1,50816
zb 204,2,49280
zb 206,2,50816
zf 244,172,68
zbr 0xc800
zbb 1
zbb 2
zb2 50
za 64,176,68
ze 12
zb3 50
zbz 21,50
zbc 0x5800
zbw
zbd
z7 68,180
ze 0
s_barrier
z6 0x3000
zag 0x3000
z0 38
za 72,160,68
zbe
zn 39,1024
zn 49,2048
za 76,164,68
zn 38,3072
z6 0x4000
zag 0x4000
z0 39
zf 240,184,72
zn 49,1024
zal 24,50
zf 244,188,72
zbc 0x9800
zby
zbd
zbe
za 64,192,72
zal 25,50
zb5
za 68,196,72
zb6 0x1a000
zal 26,50
zb7 50
zbv 22,4
z7 72,200
zbk 22,50
zb8
za 76,204,72
zb9 22
s_branch Lf5_as2H1
Lf5_as2S1:
zdz
s_cbranch_scc0 Lf5_as2Y1
zet
zeu
zev
s_call_b64 s[88:89], Lf5_far
s_branch Lf5_as2Xb1
Lf5_as2Y1:
zaa 17,9,6
zaa 18,11,6
za8 19,13
za8 20,15
s_call_b64 s[88:89], Lf5_four
Lf5_as2Xb1:
zbq 8,0
zd 64,88
zd 65,89
zd 66,90
zd 67,91
zd 68,92
zd 69,93
zd 70,94
zd 71,95
zd 72,96
zd 73,97
zd 74,98
zd 75,99
zbn
zbo
zu 12
zo 136,1
zb 138,1,1536
zo 140,2
zb 142,2,1536
zb 144,1,64
zb 146,1,1600
zb 148,2,64
zb 150,2,1600
zb 152,1,128
zb 154,1,1664
zb 156,2,128
zb 158,2,1664
zu 6
zb 160,1,6144
zb 162,1,7680
zb 164,2,6144
zb 166,2,7680
zb 168,1,6208
zb 170,1,7744
zb 172,2,6208
zb 174,2,7744
zb 176,1,6272
zb 178,1,7808
zb 180,2,6272
zb 182,2,7808
zbp
s_branch Lf5_as2E2
Lf5_as3S0:
ze0
s_cbranch_scc0 Lf5_as3Y0
zfg
zec 0x5780
zdu
s_call_b64 s[88:89], Lf5_far
s_branch Lf5_as3Xb0
Lf5_as3Y0:
zac 17,10,6
zac 18,12,6
za9 19,14
za9 20,16
s_call_b64 s[88:89], Lf5_four
Lf5_as3Xb0:
zd 76,88
zd 77,89
zd 78,90
zd 79,91
zd 80,92
zd 81,93
zd 82,94
zd 83,95
zd 84,96
zd 85,97
zd 86,98
zd 87,99
ze 0
s_barrier
zbr 0xc800
zbb 1
zbb 2
zb2 50
zb3 50
zbz 21,50
zbc 0x5800
zbw
zbd
zbe
zal 24,50
zbc 0x9800
zby
zbd
zbe
zal 25,50
zb5
zb6 0x1a000
zal 26,50
zb7 50
zbv 22,4
zbk 22,50
zb8
zb9 22
s_branch Lf5_as3H1
Lf5_as3S1:
zdz
s_cbranch_scc0 Lf5_as3Y1
zet
zeu
zev
s_call_b64 s[88:89], Lf5_far
s_branch Lf5_as3Xb1
Lf5_as3Y1:
zaa 17,9,6
zaa 18,11,6
za8 19,13
za8 20,15
s_call_b64 s[88:89], Lf5_four
Lf5_as3Xb1:
zbq 8,0
zd 64,88
zd 65,89
zd 66,90
zd 67,91
zd 68,92
zd 69,93
zd 70,94
zd 71,95
zd 72,96
zd 73,97
zd 74,98
zd 75,99
zbn
zbo
zu 6
zo 136,1
zb 138,1,1536
zo 140,2
zb 142,2,1536
zb 144,1,64
zb 146,1,1600
zb 148,2,64
zb 150,2,1600
zb 152,1,128
zb 154,1,1664
zb 156,2,128
zb 158,2,1664
zu 0
zb 160,1,6144
zb 162,1,7680
zb 164,2,6144
zb 166,2,7680
zb 168,1,6208
zb 170,1,7744
zb 172,2,6208
zb 174,2,7744
zb 176,1,6272
zb 178,1,7808
zb 180,2,6272
zb 182,2,7808
zbp
s_branch Lf5_as3E2
Lf5_four:
ze 0
zo 92,17
zo 94,18
zb 96,17,16
zb 98,18,16
zb 88,17,4608
zb 90,17,4816
zb 100,17,4624
zb 102,17,4832
zb 104,17,64
zb 106,18,64
zb 108,17,80
zb 110,18,80
zc3 128,19,3
zc3 129,19,5
zc3 130,20,3
zc3 131,20,5
zg0 19
zg0 20
zc3 132,20,3
zc3 133,20,5
zc3 134,19,3
ze 10
zh 112,92,128
zb 92,17,4672
zb 94,17,4880
ze 10
zh 116,96,128
zb 96,17,4688
zb 98,17,4896
ze 6
zh 120,104,128
zb 104,17,144
zb 106,18,144
ze 6
zh 124,108,128
zb 108,17,4736
zb 110,17,4944
zc3 135,19,5
zam
zf 112,88,132
zf 116,100,132
zb 100,17,128
zb 102,18,128
ze 8
zf 120,92,132
ze 6
zf 124,96,132
zb 96,17,4752
zb 98,17,4960
zc 88,112,113
zc 89,114,115
zc 90,116,117
zc 91,118,119
ze 6
zh 116,104,128
zc 92,120,121
zc 93,122,123
zc 94,124,125
zc 95,126,127
ze 2
zh 112,100,128
zf 112,108,132
ze 0
zf 116,96,132
s_nop 5
zc 96,112,113
zc 97,114,115
zc 98,116,117
zc 99,118,119
zgb
Lf5_far:
ze 0
zh6 98,4
zh7 88,98
zh8
v_mul_u32_u24 v95, 52, v4
v_sub_u32 v95, v0, v95
zh9
zgr 92,4
zia 91
zib 92
z2 92
zu 0
zx 89,88
zr 90,88
zg 89,91
zg 90,92
zs 89
zs 90
zc 88,89,90
zx 89,88
zr 90,88
z3 91,89
z3 92,90
z4 93,89,91
z4 94,90,92
z5 89,93
z5 90,94
zw 132,89,90
zw 133,89,94
zw 134,93,90
zw 135,93,94
zgf 91
zgf 92
zgg 96,91
zgg 97,92
zgh 96
zgh 97
zgi 91
zgi 96
zck 92
zck 97
ze 0
zew 128,91,92,95
zew 129,91,97,95
zew 130,96,92,95
zew 131,96,97,95
zfh 112,128
zbi 114,128,16
zbi 116,128,64
zbi 118,128,80
buffer_load_dwordx2 v[120:121], v128, s[4:7], 0 offen offset:128
zbi 122,128,144
zu 5
zx 128,112
zw 88,132,128
zr 128,112
zw 89,132,128
zx 128,113
zw 90,132,128
zr 128,113
zw 91,132,128
zu 4
zx 128,114
zw 92,132,128
zr 128,114
zw 93,132,128
zx 128,115
zw 94,132,128
zr 128,115
zw 95,132,128
zu 3
zx 128,116
zw 96,132,128
zr 128,116
zw 97,132,128
zx 128,117
zw 98,132,128
zr 128,117
zw 99,132,128
zu 2
zx 128,118
zw 100,132,128
zr 128,118
zw 101,132,128
zx 128,119
zw 102,132,128
zr 128,119
zw 103,132,128
zu 1
zx 128,120
zw 104,132,128
zr 128,120
zw 105,132,128
zx 128,121
zw 106,132,128
zr 128,121
zw 107,132,128
zu 0
zx 128,122
zw 108,132,128
zr 128,122
zw 109,132,128
zx 128,123
zw 110,132,128
zr 128,123
zw 111,132,128
zfh 112,129
zbi 114,129,16
zbi 116,129,64
zbi 118,129,80
zbi 120,129,128
zbi 122,129,144
zu 5
zx 129,112
zy 88,133,129
zr 129,112
zy 89,133,129
zx 129,113
zy 90,133,129
zr 129,113
zy 91,133,129
zu 4
zx 129,114
zy 92,133,129
zr 129,114
zy 93,133,129
zx 129,115
zy 94,133,129
zr 129,115
zy 95,133,129
zu 3
zx 129,116
zy 96,133,129
zr 129,116
zy 97,133,129
zx 129,117
zy 98,133,129
zr 129,117
zy 99,133,129
zu 2
zx 129,118
zy 100,133,129
zr 129,118
zy 101,133,129
zx 129,119
zy 102,133,129
zr 129,119
zy 103,133,129
zu 1
zx 129,120
zy 104,133,129
zr 129,120
zy 105,133,129
zx 129,121
zy 106,133,129
zr 129,121
zy 107,133,129
zu 0
zx 129,122
zy 108,133,129
zr 129,122
zy 109,133,129
zx 129,123
zy 110,133,129
zr 129,123
zy 111,133,129
zfh 112,130
zbi 114,130,16
zbi 116,130,64
zbi 118,130,80
zbi 120,130,128
zbi 122,130,144
zu 5
zx 130,112
zy 88,134,130
zr 130,112
zy 89,134,130
zx 130,113
zy 90,134,130
zr 130,113
zy 91,134,130
zu 4
zx 130,114
zy 92,134,130
zr 130,114
zy 93,134,130
zx 130,115
zy 94,134,130
zr 130,115
zy 95,134,130
zu 3
zx 130,116
zy 96,134,130
zr 130,116
zy 97,134,130
zx 130,117
zy 98,134,130
zr 130,117
zy 99,134,130
zu 2
zx 130,118
zy 100,134,130
zr 130,118
zy 101,134,130
zx 130,119
zy 102,134,130
zr 130,119
zy 103,134,130
zu 1
zx 130,120
zy 104,134,130
zr 130,120
zy 105,134,130
zx 130,121
zy 106,134,130
zr 130,121
zy 107,134,130
zu 0
zx 130,122
zy 108,134,130
zr 130,122
zy 109,134,130
zx 130,123
zy 110,134,130
zr 130,123
zy 111,134,130
zfh 112,131
zbi 114,131,16
zbi 116,131,64
zbi 118,131,80
zbi 120,131,128
zbi 122,131,144
zu 5
zx 131,112
zy 88,135,131
zr 131,112
zy 89,135,131
zx 131,113
zy 90,135,131
zr 131,113
zy 91,135,131
zu 4
zx 131,114
zy 92,135,131
zr 131,114
zy 93,135,131
zx 131,115
zy 94,135,131
zr 131,115
zy 95,135,131
zu 3
zx 131,116
zy 96,135,131
zr 131,116
zy 97,135,131
zx 131,117
zy 98,135,131
zr 131,117
zy 99,135,131
zu 2
zx 131,118
zy 100,135,131
zr 131,118
zy 101,135,131
zx 131,119
zy 102,135,131
zr 131,119
zy 103,135,131
zu 1
zx 131,120
zy 104,135,131
zr 131,120
zy 105,135,131
zx 131,121
zy 106,135,131
zr 131,121
zy 107,135,131
zu 0
zx 131,122
zy 108,135,131
zr 131,122
zy 109,135,131
zx 131,123
zy 110,135,131
zr 131,123
zy 111,135,131
zq 88,89
zc 89,90,91
zc 90,92,93
zc 91,94,95
zc 92,96,97
zc 93,98,99
zc 94,100,101
zc 95,102,103
zc 96,104,105
zc 97,106,107
zc 98,108,109
zc 99,110,111
zgb
Lend:
.section .rodata,"a"
.p2align 6
.amdhsa_kernel standalone__deformable_dcnv1__vision_kernel
  .amdhsa_next_free_vgpr 512
  .amdhsa_next_free_sgpr 102
  .amdhsa_accum_offset 256
  .amdhsa_group_segment_fixed_size 0
  .amdhsa_kernarg_size 48
  .amdhsa_user_sgpr_count 2
  .amdhsa_user_sgpr_kernarg_segment_ptr 1
  .amdhsa_system_sgpr_workgroup_id_x 1
.end_amdhsa_kernel
```
